```python
import torch

def _softmax(x, axis=-1):
    return torch.softmax(x, dim=axis)
def _gelu(x):
    return torch.nn.functional.gelu(x, approximate="tanh")
def _silu(x):
    return torch.nn.functional.silu(x)
def _sigmoid(x):
    return torch.sigmoid(x)
def _layernorm(x, axis=-1, eps=1e-5):
    m = x.mean(dim=axis, keepdim=True)
    v = x.var(dim=axis, keepdim=True, unbiased=False)
    return (x - m) / torch.sqrt(v + eps)
def _scatter_add(tgt, idx, src, axis=0):
    return tgt.clone().index_add_(axis, idx, src)
def _segment_sum(src, seg, n):
    out = torch.zeros((n,) + src.shape[1:], dtype=src.dtype)
    return out.index_add_(0, seg, src)
def _pad(x, pw):
    flat = tuple(v for pair in reversed(pw) for v in pair)
    return torch.nn.functional.pad(x, flat)

kernel_name = 'interleave_layers__linear_attn_block__dense_activation_gelu__prompt'

def setup_inputs():

    _w = (lambda a: (lambda t: t.to(torch.bfloat16) if t.is_floating_point() else t)(torch.as_tensor(a)))
    def _A_setup():
        B, S, D = 1, 2048, 1024
        return {
            "x": _w((lambda *s: torch.randn(*s, dtype=torch.bfloat16) * 0.05)(B, S, D)),
            "wqkv": _w((lambda *s: torch.randn(*s, dtype=torch.bfloat16) * 0.05)(D, 3 * D)),
            "wo": _w((lambda *s: torch.randn(*s, dtype=torch.bfloat16) * 0.05)(D, D)),
        }
    _A_in = _A_setup()

    def _B_setup():
        B, S, D, F = 1, 2048, 1024, 3584
        return {
            "x": _w((lambda *s: torch.randn(*s, dtype=torch.bfloat16) * 0.05)(B, S, D)),
            "w1": _w((lambda *s: torch.randn(*s, dtype=torch.bfloat16) * 3.2)(D, F) * (D ** -0.5)),
            "b1": _w((lambda *s: torch.randn(*s, dtype=torch.bfloat16) * 0.8)(F) * 0.01),
            "w2": _w((lambda *s: torch.randn(*s, dtype=torch.bfloat16) * 0.8)(F, D) * (F ** -0.5)),
            "b2": _w((lambda *s: torch.randn(*s, dtype=torch.bfloat16) * 0.8)(D) * 0.01),
        }
    _B_in = _B_setup()

    return {
        "A_x": _A_in["x"],
        "A_wqkv": _A_in["wqkv"],
        "A_wo": _A_in["wo"],
        "B_x": _B_in["x"],
        "B_w1": _B_in["w1"],
        "B_b1": _B_in["b1"],
        "B_w2": _B_in["w2"],
        "B_b2": _B_in["b2"],
    }

def reference(A_x, A_wqkv, A_wo, B_x, B_w1, B_b1, B_w2, B_b2):
    def _A_ref(x, wqkv, wo):
        B, S, D = x.shape
        H = 32; Dh = D // H
        qkv = (lambda x, *d: x.permute(*d))((x @ wqkv).reshape(B, S, 3, H, Dh), 2, 0, 3, 1, 4)
        q, k, v = qkv[0], qkv[1], qkv[2]
        phi = lambda t: torch.where(t > 0, t + 1, torch.exp(t)) + 1e-6
        pq, pk = phi(q), phi(k)
        kv = torch.einsum("bhsd,bhse->bhde", pk, v)
        z = torch.einsum("bhsd->bhd", pk)
        num = torch.einsum("bhqd,bhde->bhqe", pq, kv)
        den = torch.einsum("bhqd,bhd->bhq", pq, z)[..., None] + 1e-6
        o = num / den
        return (lambda x, *d: x.permute(*d))(o, 0, 2, 1, 3).reshape(B, S, D) @ wo

    def _B_ref(x, w1, b1, w2, b2):
        h = torch.einsum("bsd,df->bsf", x, w1) + b1
        h = _gelu(h)
        return torch.einsum("bsf,fd->bsd", h, w2) + b2

    x = A_x
    x = x + _A_ref(_layernorm(x, axis=-1), A_wqkv, A_wo)
    x = x + _B_ref(_layernorm(x, axis=-1), B_w1, B_b1, B_w2, B_b2)
    x = x + _A_ref(_layernorm(x, axis=-1), A_wqkv, A_wo)
    x = x + _B_ref(_layernorm(x, axis=-1), B_w1, B_b1, B_w2, B_b2)
    return x
```

```asm
; @launch grid=(256,1,1) block=(256,1,1) lds=155904
.amdgcn_target "amdgcn-amd-amdhsa--gfx950"
.text
.globl interleave_layers__linear_attn_block__dense_activation_gelu__prompt_kernel
.p2align 8
.type interleave_layers__linear_attn_block__dense_activation_gelu__prompt_kernel,@function
interleave_layers__linear_attn_block__dense_activation_gelu__prompt_kernel:
s_cmp_ge_u32 s2, 256
s_cbranch_scc1 L_end
s_load_dwordx16 s[44:59], s[0:1], 0
s_load_dwordx2 s[20:21], s[0:1], 80
v_lshrrev_b32 v208, 6, v0
v_and_b32 v11, 63, v0
v_readfirstlane_b32 s34, v208
v_lshlrev_b32 v0, 4, v11
v_mov_b32 v10, 0
s_and_b32 s36, s2, 1
s_bfe_u32 s37, s2, 0x20001
s_bfe_u32 s38, s2, 0x20003
s_lshl_b32 s37, s37, 2
s_add_u32 s32, s37, s38
s_lshr_b32 s37, s2, 5
s_lshl_b32 s37, s37, 1
s_add_u32 s33, s37, s36
s_lshl_b32 s35, s32, 2
s_add_u32 s35, s35, s34
s_lshl_b32 s37, s36, 6
s_add_u32 s37, s37, s35
s_lshl_b32 s37, s37, 7
s_getpc_b64 s[6:7]
L_pc:
s_add_u32 s37, s37, L_tab-L_pc
s_add_u32 s6, s6, s37
s_addc_u32 s7, s7, 0
s_getpc_b64 s[4:5]
s_lshr_b32 s39, s2, 3
s_lshl_b32 s39, s39, 2
s_add_u32 s39, s39, s34
s_mul_i32 s39, s39, 1152
v_min_u32 v219, 8, v11
v_lshl_add_u32 v219, v219, 7, s39
v_min_u32 v219, L_tab-L_pc, v219
global_load_dword v219, v219, s[4:5]
v_and_b32 v208, 15, v11
v_lshlrev_b32 v2, 2, v208
s_lshl_b32 s96, s34, 1
s_xor_b32 s96, s96, s33
s_xor_b32 s97, s96, 1
s_lshl_b32 s37, s35, 16
s_lshl_b32 s38, s97, 7
s_add_u32 s37, s37, s38
s_mul_i32 s43, s34, 28672
v_lshrrev_b32 v210, 3, v11
v_and_b32 v211, 7, v11
v_and_b32 v217, 6, v210
v_xor_b32 v211, v211, v217
v_lshlrev_b32 v211, 4, v211
s_add_u32 m0, s43, 24576
v_mul_u32_u24 v24, 2048, v210
v_add_u32 v24, v24, v211
v_add_u32 v25, 15360, v24
v_add_u32 v26, 30720, v24
v_add_u32 v27, 46080, v24
v_mul_u32_u24 v20, 7168, v210
v_add_u32 v20, v20, v211
v_add_u32 v21, 56320, v20
v_add_u32 v22, 112640, v20
v_add_u32 v23, 168960, v20
s_mov_b32 s26, 0x400000
s_mov_b32 s27, 0x20000
s_mov_b32 s22, 0x10000000
s_mov_b32 s23, 0x20000
v_mov_b32 v212, 0
v_mov_b32 v213, 0
v_mov_b32 v214, 0
v_mov_b32 v215, 0
v_min_u32 v1, 1, v11
v_lshlrev_b32 v1, 30, v1
s_waitcnt lgkmcnt(0)
s_mov_b64 s[24:25], s[44:45]
s_mov_b64 s[4:5], s[46:47]
s_mov_b64 s[8:9], s[48:49]
s_mov_b64 s[12:13], s[52:53]
s_mov_b64 s[28:29], s[54:55]
s_mov_b64 s[16:17], s[56:57]
s_mov_b64 s[100:101], s[58:59]
s_load_dwordx16 s[64:79], s[6:7], 0
s_load_dwordx16 s[80:95], s[6:7], 64
s_load_dword s44, s[20:21], 24576
buffer_load_dwordx4 v24, s[24:27], s37 offen offset:0 nt lds
buffer_load_dwordx4 v25, s[24:27], s37 offen offset:1024 nt lds
buffer_load_dwordx4 v26, s[24:27], s37 offen offset:2048 nt lds
buffer_load_dwordx4 v27, s[24:27], s37 offen offset:3072 nt lds
s_mov_b32 s40, 6144
s_cmp_eq_u32 s34, 3
s_cselect_b32 s8, s8, s4
s_cselect_b32 s9, s9, s5
s_cselect_b32 s40, 2048, s40
s_lshl_b32 s10, s40, 10
s_mov_b32 s11, 0x20000
s_mov_b32 s14, 7340032
s_mov_b32 s15, 0x20000
s_mov_b32 s18, 7340032
s_mov_b32 s19, 0x20000
s_mov_b32 s30, 7168
s_mov_b32 s31, 0x20000
v_mul_u32_u24 v16, s40, v210
v_add_u32 v16, v16, v211
s_mul_i32 s98, s32, s40
s_lshl_b32 s98, s98, 6
s_add_u32 s39, s34, 1
s_cmp_lt_u32 s34, 2
s_cselect_b32 s39, s39, 0
s_lshl_b32 s39, s39, 4
s_add_u32 s39, s39, s96
s_lshl_b32 s39, s39, 7
s_add_u32 s98, s98, s39
s_lshl_b32 s39, s40, 5
s_add_u32 s99, s98, s39
s_lshl_b32 s40, s40, 3
s_sub_u32 s40, s40, 1024
v_add_u32 v17, s40, v16
v_add_u32 v18, s40, v17
v_add_u32 v19, s40, v18
s_add_u32 m0, s43, 0
s_nop 0
buffer_load_dwordx4 v16, s[8:11], s98 offen offset:0 nt lds
buffer_load_dwordx4 v17, s[8:11], s98 offen offset:1024 nt lds
buffer_load_dwordx4 v18, s[8:11], s98 offen offset:2048 nt lds
buffer_load_dwordx4 v19, s[8:11], s98 offen offset:3072 nt lds
s_add_u32 m0, s43, 4096
s_nop 0
buffer_load_dwordx4 v16, s[8:11], s99 offen offset:0 nt lds
buffer_load_dwordx4 v17, s[8:11], s99 offen offset:1024 nt lds
buffer_load_dwordx4 v18, s[8:11], s99 offen offset:2048 nt lds
buffer_load_dwordx4 v19, s[8:11], s99 offen offset:3072 nt lds
s_mul_i32 s50, s33, 8704
s_add_u32 s50, s50, 786432
s_and_b32 s37, s35, 31
s_min_u32 s37, s37, 16
s_lshl_b32 s37, s37, 9
s_lshr_b32 s38, s35, 5
s_mul_i32 s38, s38, 139264
s_add_u32 s37, s37, s38
s_mul_i32 s38, s96, 8704
s_add_u32 s37, s37, s38
s_add_u32 s37, s37, 786432
v_lshlrev_b32 v210, 3, v11
buffer_store_dwordx2 v[212:213], v210, s[20:23], s37 offen sc1
s_mov_b32 s24, s100
s_mov_b32 s25, s101
s_mov_b32 s26, 2048
v_lshlrev_b32 v210, 1, v11
s_lshl_b32 s37, s33, 7
buffer_load_ushort v216, v210, s[24:27], s37 offen
s_load_dwordx2 s[24:25], s[0:1], 64
s_mov_b32 s26, 0x400000
v_lshrrev_b32 v210, 2, v11
v_and_b32 v211, 3, v11
v_lshlrev_b32 v211, 3, v211
v_lshl_add_u32 v28, v210, 7, v211
v_and_b32 v217, 6, v210
v_lshl_add_u32 v28, v217, 4, v28
v_add_u32 v28, s43, v28
v_xor_b32 v29, 32, v28
v_xor_b32 v30, 64, v28
v_xor_b32 v31, 96, v28
v_lshrrev_b32 v210, 4, v11
v_lshlrev_b32 v210, 2, v210
v_lshl_add_u32 v3, v208, 4, v210
v_lshlrev_b32 v8, 4, v208
v_add_u32 v8, 147456, v8
v_mov_b32 v67, 0
v_mov_b32 v71, 0
v_mov_b32 v6, v0
v_add_u32 v7, 0x10000, v0
s_mul_i32 s37, s33, 1443840
s_add_u32 s37, s37, 71303168
s_lshl_b32 s39, s34, 12
s_add_u32 s39, s39, s37
v_add_u32 v4, s39, v0
s_mul_i32 s38, s96, 1443840
s_add_u32 s38, s38, 71303168
s_waitcnt lgkmcnt(0)
s_lshr_b32 s39, s33, 1
s_mul_i32 s40, s39, 896
s_lshr_b32 s39, s96, 1
s_lshl_b32 s39, s39, 8
s_add_u32 s66, s66, s40
s_add_u32 s67, s67, s40
s_add_u32 s68, s68, s39
s_add_u32 s69, s69, s39
s_add_u32 s72, s72, s38
s_add_u32 s73, s73, s38
s_add_u32 s74, s74, s38
s_add_u32 s75, s75, s38
s_add_u32 s76, s76, s38
s_add_u32 s77, s77, s38
s_add_u32 s78, s78, s38
s_add_u32 s79, s79, s38
s_add_u32 s80, s80, s37
s_add_u32 s81, s81, s37
s_add_u32 s82, s82, s37
s_add_u32 s83, s83, s37
s_add_u32 s84, s84, s37
s_add_u32 s85, s85, s37
s_add_u32 s86, s86, s37
s_add_u32 s87, s87, s37
s_add_u32 s88, s88, s38
s_add_u32 s89, s89, s38
s_add_u32 s90, s90, s38
s_add_u32 s91, s91, s38
s_add_u32 s92, s92, s38
s_add_u32 s93, s93, s38
s_add_u32 s94, s94, s38
s_add_u32 s95, s95, s38
s_mov_b32 s46, 0x40000
s_mul_i32 s39, s35, 66048
s_lshl_b32 s40, s36, 15
s_sub_u32 s60, 8192, s40
s_add_u32 s61, 8192, s40
s_lshl_b32 s40, s36, 14
s_add_u32 s41, s39, s40
v_add_u32 v14, s41, v0
s_xor_b32 s40, s40, 16384
s_add_u32 s48, s39, s40
s_lshr_b32 s40, s97, 1
s_lshl_b32 s40, s40, 11
s_add_u32 s48, s48, s40
s_mul_i32 s47, s35, 229888
s_mul_i32 s39, s36, 114688
s_add_u32 s47, s47, s39
v_add_u32 v15, s47, v0
s_lshr_b32 s39, s33, 1
s_lshl_b32 s39, s39, 11
s_add_u32 s47, s47, s39
s_add_u32 s41, s41, s39
s_lshl_b32 s49, s35, 12
s_add_u32 s49, s49, 1310720
s_lshl_b32 s39, s35, 4
s_add_u32 s39, s39, s33
s_lshl_b32 s52, s39, 12
s_add_u32 s52, s52, 31457280
s_xor_b32 s51, s52, 4096
s_lshl_b32 s53, s35, 8
s_lshl_b32 s39, s33, 2
s_add_u32 s54, s53, s39
s_xor_b32 s55, s54, 4
s_lshl_b32 s39, s36, 2
s_add_u32 s57, s53, s39
s_mov_b32 s45, 1
s_mov_b64 s[98:99], 0xffff
s_lshl_b32 s56, s33, 2
s_add_u32 s56, s56, s34
s_lshl_b32 s56, s56, 7
s_add_u32 s56, s56, 16384
s_mov_b32 s62, 0x35c1a2a0
s_mov_b32 s63, 0x3f317218
s_lshl_b32 s37, s33, 14
s_add_u32 s37, s37, 49152
s_cmp_eq_u32 s33, 0
s_cselect_b32 s37, 0, s37
s_cmp_gt_u32 s33, 3
s_cselect_b32 s37, 1073741824, s37
s_add_u32 s37, s37, s53
v_lshlrev_b32 v217, 2, v11
buffer_store_dword v212, v217, s[20:23], s37 offen sc1
s_min_u32 s37, s32, 1
s_lshl_b32 s37, s37, 29
s_lshl_b32 s38, s96, 2
s_add_u32 s38, s38, s34
s_lshl_b32 s38, s38, 7
s_add_u32 s37, s37, s38
s_add_u32 s37, s37, 16384
buffer_store_dwordx4 v[212:215], v1, s[20:23], s37 offen sc1
s_waitcnt lgkmcnt(0)
v_lshrrev_b32 v210, 4, v11
v_lshlrev_b32 v210, 3, v210
v_lshl_add_u32 v32, v208, 7, v210
v_and_b32 v210, 6, v208
v_lshl_add_u32 v32, v210, 4, v32
v_add_u32 v32, s43, v32
v_xor_b32 v33, 32, v32
v_xor_b32 v34, 64, v32
v_xor_b32 v35, 96, v32
s_waitcnt vmcnt(12)
ds_read_b64 v[48:49], v32 offset:24576
ds_read_b64 v[52:53], v32 offset:26624
ds_read_b64 v[50:51], v33 offset:24576
ds_read_b64 v[54:55], v33 offset:26624
ds_read_b64 v[56:57], v34 offset:24576
ds_read_b64 v[60:61], v34 offset:26624
ds_read_b64 v[58:59], v35 offset:24576
ds_read_b64 v[62:63], v35 offset:26624
s_add_u32 s37, s48, 3145728
s_waitcnt lgkmcnt(5)
buffer_store_dwordx4 v[48:51], v0, s[20:23], s37 offen offset:0 sc1
s_waitcnt lgkmcnt(4)
buffer_store_dwordx4 v[52:55], v0, s[20:23], s37 offen offset:1024 sc1
v_mov_b32 v212, 0x3f803f80
v_dot2_f32_bf16 v208, v48, v212, 0
v_dot2_f32_bf16 v209, v48, v48, 0
v_dot2_f32_bf16 v210, v52, v212, 0
v_dot2_f32_bf16 v211, v52, v52, 0
v_dot2_f32_bf16 v208, v49, v212, v208
v_dot2_f32_bf16 v209, v49, v49, v209
v_dot2_f32_bf16 v210, v53, v212, v210
v_dot2_f32_bf16 v211, v53, v53, v211
v_dot2_f32_bf16 v208, v50, v212, v208
v_dot2_f32_bf16 v209, v50, v50, v209
v_dot2_f32_bf16 v210, v54, v212, v210
v_dot2_f32_bf16 v211, v54, v54, v211
v_dot2_f32_bf16 v208, v51, v212, v208
v_dot2_f32_bf16 v209, v51, v51, v209
v_dot2_f32_bf16 v210, v55, v212, v210
v_dot2_f32_bf16 v211, v55, v55, v211
s_add_u32 s37, s48, 3178496
s_waitcnt lgkmcnt(1)
buffer_store_dwordx4 v[56:59], v0, s[20:23], s37 offen offset:0 sc1
s_waitcnt lgkmcnt(0)
buffer_store_dwordx4 v[60:63], v0, s[20:23], s37 offen offset:1024 sc1
v_dot2_f32_bf16 v208, v56, v212, v208
v_dot2_f32_bf16 v209, v56, v56, v209
v_dot2_f32_bf16 v210, v60, v212, v210
v_dot2_f32_bf16 v211, v60, v60, v211
v_dot2_f32_bf16 v208, v57, v212, v208
v_dot2_f32_bf16 v209, v57, v57, v209
v_dot2_f32_bf16 v210, v61, v212, v210
v_dot2_f32_bf16 v211, v61, v61, v211
v_dot2_f32_bf16 v208, v58, v212, v208
v_dot2_f32_bf16 v209, v58, v58, v209
v_dot2_f32_bf16 v210, v62, v212, v210
v_dot2_f32_bf16 v211, v62, v62, v211
v_dot2_f32_bf16 v208, v59, v212, v208
v_dot2_f32_bf16 v209, v59, v59, v209
v_dot2_f32_bf16 v210, v63, v212, v210
v_dot2_f32_bf16 v211, v63, v63, v211
s_lshl_b32 s37, s97, 8
s_add_u32 s37, s37, s49
s_add_u32 s37, s37, 0
v_permlane32_swap_b32 v208, v210
v_permlane32_swap_b32 v209, v211
v_add_f32 v208, v208, v210
v_add_f32 v209, v209, v211
s_nop 1
v_permlane16_swap_b32 v208, v209
v_add_f32 v208, v208, v209
buffer_store_dword v208, v3, s[20:23], s37 offen sc1
s_mov_b32 s48, s41
v_mov_b32 v220, 0x3f803f80
v_mov_b32 v221, 0x3f803f80
v_mov_b32 v222, 0x3f803f80
v_mov_b32 v223, 0x3f803f80
s_lshl_b32 s37, s35, 4
s_add_u32 s37, s37, s33
s_lshl_b32 s38, s96, 2
s_add_u32 s38, s38, s34
s_lshl_b32 s38, s38, 4
s_add_u32 s38, s38, s32
s_add_u32 s38, s38, 1024
v_mov_b32 v224, 134217728
v_writelane_b32 v224, s37, 0
v_writelane_b32 v224, s38, 1
v_lshlrev_b32 v224, 3, v224
s_lshl_b32 s37, s35, 7
s_lshl_b32 s38, s33, 2
s_add_u32 s38, s38, s34
s_lshl_b32 s38, s38, 7
s_add_u32 s38, s38, 8192
v_lshl_add_u32 v225, v2, 1, s37
v_lshl_add_u32 v210, v2, 1, s38
s_nop 1
v_mov_b32_dpp v225, v210 quad_perm:[0,1,2,3] row_mask:0xa bank_mask:0xf
s_mov_b32 s40, 32768
s_add_u32 s44, s44, 0x9e3779b9
v_mov_b32 v210, s44
s_waitcnt vmcnt(13)
ds_read_b64_tr_b16 v[80:81], v28 offset:0
ds_read_b64_tr_b16 v[82:83], v28 offset:2048
ds_read_b64_tr_b16 v[84:85], v29 offset:0
ds_read_b64_tr_b16 v[86:87], v29 offset:2048
ds_read_b64_tr_b16 v[88:89], v30 offset:0
ds_read_b64_tr_b16 v[90:91], v30 offset:2048
ds_read_b64_tr_b16 v[92:93], v31 offset:0
ds_read_b64_tr_b16 v[94:95], v31 offset:2048
s_waitcnt lgkmcnt(6)
buffer_store_dwordx4 v[80:83], v0, s[20:23], s72 offen sc1
s_waitcnt lgkmcnt(4)
buffer_store_dwordx4 v[84:87], v0, s[20:23], s73 offen sc1
s_waitcnt lgkmcnt(2)
buffer_store_dwordx4 v[88:91], v0, s[20:23], s74 offen sc1
s_waitcnt lgkmcnt(0)
buffer_store_dwordx4 v[92:95], v0, s[20:23], s75 offen sc1
v_mfma_f32_16x16x32_bf16 v[112:115], v[220:223], v[80:83], 0
v_mfma_f32_16x16x32_bf16 v[116:119], v[220:223], v[84:87], 0
v_mfma_f32_16x16x32_bf16 v[120:123], v[220:223], v[88:91], 0
v_mfma_f32_16x16x32_bf16 v[124:127], v[220:223], v[92:95], 0
s_waitcnt vmcnt(13)
ds_read_b64_tr_b16 v[96:97], v28 offset:4096
ds_read_b64_tr_b16 v[98:99], v28 offset:6144
ds_read_b64_tr_b16 v[100:101], v29 offset:4096
ds_read_b64_tr_b16 v[102:103], v29 offset:6144
ds_read_b64_tr_b16 v[104:105], v30 offset:4096
ds_read_b64_tr_b16 v[106:107], v30 offset:6144
ds_read_b64_tr_b16 v[108:109], v31 offset:4096
ds_read_b64_tr_b16 v[110:111], v31 offset:6144
s_waitcnt lgkmcnt(6)
buffer_store_dwordx4 v[96:99], v0, s[20:23], s76 offen sc1
s_waitcnt lgkmcnt(4)
buffer_store_dwordx4 v[100:103], v0, s[20:23], s77 offen sc1
s_waitcnt lgkmcnt(2)
buffer_store_dwordx4 v[104:107], v0, s[20:23], s78 offen sc1
s_waitcnt lgkmcnt(0)
buffer_store_dwordx4 v[108:111], v0, s[20:23], s79 offen sc1
v_mfma_f32_16x16x32_bf16 v[112:115], v[220:223], v[96:99], v[112:115]
v_mfma_f32_16x16x32_bf16 v[116:119], v[220:223], v[100:103], v[116:119]
v_mfma_f32_16x16x32_bf16 v[120:123], v[220:223], v[104:107], v[120:123]
v_mfma_f32_16x16x32_bf16 v[124:127], v[220:223], v[108:111], v[124:127]
s_lshl_b32 s37, s32, 6
s_lshl_b32 s38, s96, 2
s_add_u32 s37, s37, s38
s_add_u32 s37, s37, s34
s_lshl_b32 s37, s37, 8
s_add_u32 s37, s37, 262144
v_lshlrev_b32 v217, 2, v11
v_mov_b32_dpp v112, v116 quad_perm:[0,1,2,3] row_mask:0x2 bank_mask:0xf
s_nop 1
v_mov_b32_dpp v112, v120 quad_perm:[0,1,2,3] row_mask:0x4 bank_mask:0xf
s_nop 1
v_mov_b32_dpp v112, v124 quad_perm:[0,1,2,3] row_mask:0x8 bank_mask:0xf
buffer_store_dword v112, v217, s[20:23], s37 offen sc1
s_add_u32 m0, s43, 8192
s_nop 0
buffer_load_dwordx4 v20, s[12:15], s66 offen offset:0 nt lds
buffer_load_dwordx4 v21, s[12:15], s66 offen offset:1024 nt lds
buffer_load_dwordx4 v22, s[12:15], s66 offen offset:2048 nt lds
buffer_load_dwordx4 v23, s[12:15], s66 offen offset:3072 nt lds
s_waitcnt vmcnt(20)
v_lshlrev_b32 v216, 16, v216
v_add_u32 v218, 155648, v217
ds_write_b32 v218, v216
s_waitcnt vmcnt(4)
buffer_store_dword v210, v224, s[20:23], s40 offen sc1
s_add_u32 m0, s43, 12288
s_nop 0
buffer_load_dwordx4 v20, s[12:15], s67 offen offset:0 nt lds
buffer_load_dwordx4 v21, s[12:15], s67 offen offset:1024 nt lds
buffer_load_dwordx4 v22, s[12:15], s67 offen offset:2048 nt lds
buffer_load_dwordx4 v23, s[12:15], s67 offen offset:3072 nt lds
s_add_u32 m0, s43, 16384
s_nop 0
buffer_load_dwordx4 v24, s[16:19], s68 offen offset:0 nt lds
buffer_load_dwordx4 v25, s[16:19], s68 offen offset:1024 nt lds
buffer_load_dwordx4 v26, s[16:19], s68 offen offset:2048 nt lds
buffer_load_dwordx4 v27, s[16:19], s68 offen offset:3072 nt lds
s_waitcnt vmcnt(9)
ds_read_b64_tr_b16 v[144:145], v28 offset:8192
ds_read_b64_tr_b16 v[146:147], v28 offset:10240
ds_read_b64_tr_b16 v[148:149], v29 offset:8192
ds_read_b64_tr_b16 v[150:151], v29 offset:10240
ds_read_b64_tr_b16 v[152:153], v30 offset:8192
ds_read_b64_tr_b16 v[154:155], v30 offset:10240
ds_read_b64_tr_b16 v[156:157], v31 offset:8192
ds_read_b64_tr_b16 v[158:159], v31 offset:10240
s_waitcnt lgkmcnt(6)
v_mfma_f32_16x16x32_bf16 v[112:115], v[220:223], v[144:147], 0
s_waitcnt lgkmcnt(4)
v_mfma_f32_16x16x32_bf16 v[116:119], v[220:223], v[148:151], 0
s_waitcnt lgkmcnt(2)
v_mfma_f32_16x16x32_bf16 v[120:123], v[220:223], v[152:155], 0
s_waitcnt lgkmcnt(0)
v_mfma_f32_16x16x32_bf16 v[124:127], v[220:223], v[156:159], 0
s_add_u32 m0, s43, 20480
s_nop 0
buffer_load_dwordx4 v24, s[16:19], s69 offen offset:0 nt lds
buffer_load_dwordx4 v25, s[16:19], s69 offen offset:1024 nt lds
buffer_load_dwordx4 v26, s[16:19], s69 offen offset:2048 nt lds
buffer_load_dwordx4 v27, s[16:19], s69 offen offset:3072 nt lds
s_waitcnt vmcnt(8)
ds_read_b64_tr_b16 v[160:161], v28 offset:12288
ds_read_b64_tr_b16 v[162:163], v28 offset:14336
ds_read_b64_tr_b16 v[164:165], v29 offset:12288
ds_read_b64_tr_b16 v[166:167], v29 offset:14336
ds_read_b64_tr_b16 v[168:169], v30 offset:12288
ds_read_b64_tr_b16 v[170:171], v30 offset:14336
ds_read_b64_tr_b16 v[172:173], v31 offset:12288
ds_read_b64_tr_b16 v[174:175], v31 offset:14336
s_waitcnt lgkmcnt(6)
v_mfma_f32_16x16x32_bf16 v[112:115], v[220:223], v[160:163], v[112:115]
s_waitcnt lgkmcnt(4)
v_mfma_f32_16x16x32_bf16 v[116:119], v[220:223], v[164:167], v[116:119]
s_waitcnt lgkmcnt(2)
v_mfma_f32_16x16x32_bf16 v[120:123], v[220:223], v[168:171], v[120:123]
s_waitcnt lgkmcnt(0)
v_mfma_f32_16x16x32_bf16 v[124:127], v[220:223], v[172:175], v[124:127]
s_lshl_b32 s37, s32, 6
s_lshl_b32 s38, s33, 2
s_add_u32 s37, s37, s38
s_add_u32 s37, s37, s34
s_lshl_b32 s37, s37, 8
s_add_u32 s37, s37, 524288
v_lshlrev_b32 v217, 2, v11
v_mov_b32_dpp v112, v116 quad_perm:[0,1,2,3] row_mask:0x2 bank_mask:0xf
s_nop 1
v_mov_b32_dpp v112, v120 quad_perm:[0,1,2,3] row_mask:0x4 bank_mask:0xf
s_nop 1
v_mov_b32_dpp v112, v124 quad_perm:[0,1,2,3] row_mask:0x8 bank_mask:0xf
buffer_store_dword v112, v217, s[20:23], s37 offen sc1
s_waitcnt vmcnt(5)
ds_read_b64_tr_b16 v[176:177], v28 offset:16384
ds_read_b64_tr_b16 v[178:179], v28 offset:18432
ds_read_b64_tr_b16 v[180:181], v29 offset:16384
ds_read_b64_tr_b16 v[182:183], v29 offset:18432
ds_read_b64_tr_b16 v[184:185], v30 offset:16384
ds_read_b64_tr_b16 v[186:187], v30 offset:18432
ds_read_b64_tr_b16 v[188:189], v31 offset:16384
ds_read_b64_tr_b16 v[190:191], v31 offset:18432
s_mov_b32 exec_hi, 0
v_mov_b32 v9, 0
buffer_atomic_add v9, v225, s[20:23], s40 offen sc0 sc1
s_mov_b32 exec_hi, -1
s_waitcnt vmcnt(2)
ds_read_b64_tr_b16 v[192:193], v28 offset:20480
ds_read_b64_tr_b16 v[194:195], v28 offset:22528
ds_read_b64_tr_b16 v[196:197], v29 offset:20480
ds_read_b64_tr_b16 v[198:199], v29 offset:22528
ds_read_b64_tr_b16 v[200:201], v30 offset:20480
ds_read_b64_tr_b16 v[202:203], v30 offset:22528
ds_read_b64_tr_b16 v[204:205], v31 offset:20480
ds_read_b64_tr_b16 v[206:207], v31 offset:22528
s_waitcnt vmcnt(0)
v_cmp_ne_u32 s[100:101], s44, v9
s_nop 0
s_cmp_lg_u32 s100, 0
s_cbranch_scc1 L_slowx
L_backx:
s_waitcnt lgkmcnt(0)
s_lshl_b32 s43, s34, 12
s_barrier
s_add_u32 m0, s43, 0
s_nop 0
global_load_lds_dwordx4 v4, s[20:21] offset:0 sc1
global_load_lds_dwordx4 v4, s[20:21] offset:1024 sc1
global_load_lds_dwordx4 v4, s[20:21] offset:2048 sc1
global_load_lds_dwordx4 v4, s[20:21] offset:3072 sc1
s_add_u32 m0, s43, 16384
v_add_u32 v4, 16384, v4
global_load_lds_dwordx4 v4, s[20:21] offset:0 sc1
global_load_lds_dwordx4 v4, s[20:21] offset:1024 sc1
global_load_lds_dwordx4 v4, s[20:21] offset:2048 sc1
global_load_lds_dwordx4 v4, s[20:21] offset:3072 sc1
s_lshr_b32 s6, s2, 3
s_lshl_b32 s6, s6, 2
s_add_u32 s6, s6, s34
s_lshl_b32 s6, s6, 7
s_add_u32 s6, s6, 6144
v_mov_b32 v12, s6
v_add_u32 v5, 3149824, v14
global_load_dwordx4 a[0:3], v5, s[20:21] offset:-4096 sc1
global_load_dwordx4 a[4:7], v5, s[20:21] offset:-3072 sc1
global_load_dwordx4 a[8:11], v5, s[20:21] offset:-2048 sc1
global_load_dwordx4 a[12:15], v5, s[20:21] offset:-1024 sc1
global_load_dwordx4 a[16:19], v5, s[20:21] offset:0 sc1
global_load_dwordx4 a[20:23], v5, s[20:21] offset:1024 sc1
s_add_u32 m0, s43, 32768
v_add_u32 v4, 16384, v4
global_load_lds_dwordx4 v4, s[20:21] offset:0 sc1
global_load_lds_dwordx4 v4, s[20:21] offset:1024 sc1
s_add_u32 s41, s50, 0
s_add_u32 s42, s50, 8192
s_add_u32 s37, s49, 0
s_waitcnt vmcnt(12)
s_barrier
ds_read_b128 v[16:19], v6 offset:0
ds_read_b128 v[20:23], v6 offset:1024
ds_read_b128 v[24:27], v6 offset:2048
ds_read_b128 v[28:31], v6 offset:3072
ds_read_b128 v[32:35], v6 offset:4096
ds_read_b128 v[36:39], v6 offset:5120
ds_read_b128 v[40:43], v6 offset:6144
s_waitcnt vmcnt(6) lgkmcnt(3)
v_mfma_f32_16x16x32_bf16 v[80:83], a[0:3], v[16:19], 0
ds_read_b128 v[44:47], v6 offset:7168
buffer_load_dwordx4 v[208:211], v0, s[20:23], s37 offen offset:0 sc1
v_mfma_f32_16x16x32_bf16 v[84:87], a[4:7], v[16:19], 0
buffer_load_dwordx4 v[212:215], v0, s[20:23], s37 offen offset:1024 sc1
v_mfma_f32_16x16x32_bf16 v[88:91], a[0:3], v[20:23], 0
ds_read_b128 v[16:19], v6 offset:8192
s_getpc_b64 s[4:5]
v_mfma_f32_16x16x32_bf16 v[92:95], a[4:7], v[20:23], 0
global_load_dword v13, v12, s[4:5]
global_load_lds_dwordx4 v4, s[20:21] offset:2048 sc1
v_mfma_f32_16x16x32_bf16 v[96:99], a[0:3], v[24:27], 0
ds_read_b128 v[20:23], v6 offset:9216
global_load_lds_dwordx4 v4, s[20:21] offset:3072 sc1
buffer_load_dwordx4 v[216:219], v0, s[20:23], s37 offen offset:2048 sc1
v_mfma_f32_16x16x32_bf16 v[100:103], a[4:7], v[24:27], 0
global_load_dwordx4 a[24:27], v5, s[20:21] offset:2048 sc1
global_load_dwordx4 a[28:31], v5, s[20:21] offset:3072 sc1
v_mfma_f32_16x16x32_bf16 v[104:107], a[0:3], v[28:31], 0
ds_read_b128 v[24:27], v6 offset:10240
v_mfma_f32_16x16x32_bf16 v[108:111], a[4:7], v[28:31], 0
s_waitcnt lgkmcnt(3)
v_mfma_f32_16x16x32_bf16 v[112:115], a[0:3], v[32:35], 0
ds_read_b128 v[28:31], v6 offset:11264
buffer_load_dwordx4 v[220:223], v0, s[20:23], s37 offen offset:3072 sc1
v_mfma_f32_16x16x32_bf16 v[116:119], a[4:7], v[32:35], 0
v_lshrrev_b32 v240, 4, v11
v_lshlrev_b32 v242, 14, v240
v_mfma_f32_16x16x32_bf16 v[120:123], a[0:3], v[36:39], 0
ds_read_b128 v[32:35], v6 offset:12288
v_lshl_add_u32 v242, v2, 2, v242
v_mfma_f32_16x16x32_bf16 v[124:127], a[4:7], v[36:39], 0
v_add_u32 v241, v2, v240
s_lshl_b32 s39, s33, 2
v_mfma_f32_16x16x32_bf16 v[128:131], a[0:3], v[40:43], 0
ds_read_b128 v[36:39], v6 offset:13312
s_add_u32 s39, s39, s34
v_mfma_f32_16x16x32_bf16 v[132:135], a[4:7], v[40:43], 0
s_lshl_b32 s39, s39, 8
s_add_u32 s39, s39, 262144
v_mfma_f32_16x16x32_bf16 v[136:139], a[0:3], v[44:47], 0
buffer_load_dwordx4 v[224:227], v242, s[20:23], s39 offen sc1
v_mfma_f32_16x16x32_bf16 v[140:143], a[4:7], v[44:47], 0
ds_read_b128 v[40:43], v6 offset:14336
s_waitcnt vmcnt(14) lgkmcnt(3)
v_mfma_f32_16x16x32_bf16 v[80:83], a[8:11], v[16:19], v[80:83]
ds_read_b128 v[44:47], v6 offset:15360
s_add_u32 s39, s39, 65536
v_mfma_f32_16x16x32_bf16 v[84:87], a[12:15], v[16:19], v[84:87]
buffer_load_dwordx4 v[228:231], v242, s[20:23], s39 offen sc1
v_mfma_f32_16x16x32_bf16 v[88:91], a[8:11], v[20:23], v[88:91]
s_barrier
ds_read_b128 v[16:19], v6 offset:16384
v_mfma_f32_16x16x32_bf16 v[92:95], a[12:15], v[20:23], v[92:95]
v_add_u32 v5, 8192, v5
s_add_u32 s39, s39, 65536
v_mfma_f32_16x16x32_bf16 v[96:99], a[8:11], v[24:27], v[96:99]
ds_read_b128 v[20:23], v6 offset:17408
global_load_dwordx4 a[32:35], v5, s[20:21] offset:-4096 sc1
v_mfma_f32_16x16x32_bf16 v[100:103], a[12:15], v[24:27], v[100:103]
global_load_dwordx4 a[36:39], v5, s[20:21] offset:-3072 sc1
v_mfma_f32_16x16x32_bf16 v[104:107], a[8:11], v[28:31], v[104:107]
ds_read_b128 v[24:27], v6 offset:18432
v_mfma_f32_16x16x32_bf16 v[108:111], a[12:15], v[28:31], v[108:111]
s_waitcnt lgkmcnt(3)
v_mfma_f32_16x16x32_bf16 v[112:115], a[8:11], v[32:35], v[112:115]
ds_read_b128 v[28:31], v6 offset:19456
buffer_load_dwordx4 v[232:235], v242, s[20:23], s39 offen sc1
v_mfma_f32_16x16x32_bf16 v[116:119], a[12:15], v[32:35], v[116:119]
s_add_u32 s39, s39, 65536
v_mfma_f32_16x16x32_bf16 v[120:123], a[8:11], v[36:39], v[120:123]
ds_read_b128 v[32:35], v6 offset:20480
v_mfma_f32_16x16x32_bf16 v[124:127], a[12:15], v[36:39], v[124:127]
s_add_u32 m0, s43, 49152
v_add_u32 v4, 16384, v4
v_mfma_f32_16x16x32_bf16 v[128:131], a[8:11], v[40:43], v[128:131]
ds_read_b128 v[36:39], v6 offset:21504
global_load_lds_dwordx4 v4, s[20:21] offset:0 sc1
v_mfma_f32_16x16x32_bf16 v[132:135], a[12:15], v[40:43], v[132:135]
global_load_lds_dwordx4 v4, s[20:21] offset:1024 sc1
global_load_lds_dwordx4 v4, s[20:21] offset:2048 sc1
v_mfma_f32_16x16x32_bf16 v[136:139], a[8:11], v[44:47], v[136:139]
ds_read_b128 v[40:43], v6 offset:22528
global_load_lds_dwordx4 v4, s[20:21] offset:3072 sc1
v_mfma_f32_16x16x32_bf16 v[140:143], a[12:15], v[44:47], v[140:143]
s_waitcnt vmcnt(20) lgkmcnt(3)
v_mfma_f32_16x16x32_bf16 v[80:83], a[16:19], v[16:19], v[80:83]
ds_read_b128 v[44:47], v6 offset:23552
v_mfma_f32_16x16x32_bf16 v[84:87], a[20:23], v[16:19], v[84:87]
global_load_dwordx4 a[40:43], v5, s[20:21] offset:-2048 sc1
global_load_dwordx4 a[44:47], v5, s[20:21] offset:-1024 sc1
v_mfma_f32_16x16x32_bf16 v[88:91], a[16:19], v[20:23], v[88:91]
ds_read_b128 v[16:19], v6 offset:24576
v_mfma_f32_16x16x32_bf16 v[92:95], a[20:23], v[20:23], v[92:95]
v_mfma_f32_16x16x32_bf16 v[96:99], a[16:19], v[24:27], v[96:99]
ds_read_b128 v[20:23], v6 offset:25600
buffer_load_dwordx4 v[236:239], v242, s[20:23], s39 offen sc1
v_mfma_f32_16x16x32_bf16 v[100:103], a[20:23], v[24:27], v[100:103]
v_mfma_f32_16x16x32_bf16 v[104:107], a[16:19], v[28:31], v[104:107]
ds_read_b128 v[24:27], v6 offset:26624
v_mfma_f32_16x16x32_bf16 v[108:111], a[20:23], v[28:31], v[108:111]
s_waitcnt lgkmcnt(3)
v_mfma_f32_16x16x32_bf16 v[112:115], a[16:19], v[32:35], v[112:115]
ds_read_b128 v[28:31], v6 offset:27648
v_mfma_f32_16x16x32_bf16 v[116:119], a[20:23], v[32:35], v[116:119]
v_mfma_f32_16x16x32_bf16 v[120:123], a[16:19], v[36:39], v[120:123]
ds_read_b128 v[32:35], v6 offset:28672
v_mfma_f32_16x16x32_bf16 v[124:127], a[20:23], v[36:39], v[124:127]
v_mfma_f32_16x16x32_bf16 v[128:131], a[16:19], v[40:43], v[128:131]
ds_read_b128 v[36:39], v6 offset:29696
v_mfma_f32_16x16x32_bf16 v[132:135], a[20:23], v[40:43], v[132:135]
v_mfma_f32_16x16x32_bf16 v[136:139], a[16:19], v[44:47], v[136:139]
ds_read_b128 v[40:43], v6 offset:30720
global_load_dwordx4 a[48:51], v5, s[20:21] offset:0 sc1
v_mfma_f32_16x16x32_bf16 v[140:143], a[20:23], v[44:47], v[140:143]
s_waitcnt vmcnt(14) lgkmcnt(3)
v_mfma_f32_16x16x32_bf16 v[80:83], a[24:27], v[16:19], v[80:83]
ds_read_b128 v[44:47], v6 offset:31744
v_mfma_f32_16x16x32_bf16 v[84:87], a[28:31], v[16:19], v[84:87]
global_load_dwordx4 a[52:55], v5, s[20:21] offset:1024 sc1
v_mfma_f32_16x16x32_bf16 v[88:91], a[24:27], v[20:23], v[88:91]
s_barrier
ds_read_b128 v[16:19], v6 offset:32768
v_mfma_f32_16x16x32_bf16 v[92:95], a[28:31], v[20:23], v[92:95]
v_mfma_f32_16x16x32_bf16 v[96:99], a[24:27], v[24:27], v[96:99]
ds_read_b128 v[20:23], v6 offset:33792
v_mfma_f32_16x16x32_bf16 v[100:103], a[28:31], v[24:27], v[100:103]
v_mfma_f32_16x16x32_bf16 v[104:107], a[24:27], v[28:31], v[104:107]
ds_read_b128 v[24:27], v6 offset:34816
v_mfma_f32_16x16x32_bf16 v[108:111], a[28:31], v[28:31], v[108:111]
s_waitcnt lgkmcnt(3)
v_mfma_f32_16x16x32_bf16 v[112:115], a[24:27], v[32:35], v[112:115]
ds_read_b128 v[28:31], v6 offset:35840
s_add_u32 m0, s43, 65536
v_mfma_f32_16x16x32_bf16 v[116:119], a[28:31], v[32:35], v[116:119]
v_add_u32 v4, 16384, v4
v_mfma_f32_16x16x32_bf16 v[120:123], a[24:27], v[36:39], v[120:123]
ds_read_b128 v[32:35], v6 offset:36864
global_load_lds_dwordx4 v4, s[20:21] offset:0 sc1
v_mfma_f32_16x16x32_bf16 v[124:127], a[28:31], v[36:39], v[124:127]
global_load_lds_dwordx4 v4, s[20:21] offset:1024 sc1
global_load_lds_dwordx4 v4, s[20:21] offset:2048 sc1
v_mfma_f32_16x16x32_bf16 v[128:131], a[24:27], v[40:43], v[128:131]
ds_read_b128 v[36:39], v6 offset:37888
global_load_lds_dwordx4 v4, s[20:21] offset:3072 sc1
v_mfma_f32_16x16x32_bf16 v[132:135], a[28:31], v[40:43], v[132:135]
v_mfma_f32_16x16x32_bf16 v[136:139], a[24:27], v[44:47], v[136:139]
ds_read_b128 v[40:43], v6 offset:38912
v_mfma_f32_16x16x32_bf16 v[140:143], a[28:31], v[44:47], v[140:143]
s_waitcnt vmcnt(14) lgkmcnt(3)
v_mfma_f32_16x16x32_bf16 v[80:83], a[32:35], v[16:19], v[80:83]
ds_read_b128 v[44:47], v6 offset:39936
v_mfma_f32_16x16x32_bf16 v[84:87], a[36:39], v[16:19], v[84:87]
global_load_dwordx4 a[56:59], v5, s[20:21] offset:2048 sc1
global_load_dwordx4 a[60:63], v5, s[20:21] offset:3072 sc1
v_mfma_f32_16x16x32_bf16 v[88:91], a[32:35], v[20:23], v[88:91]
ds_read_b128 v[16:19], v6 offset:40960
v_mfma_f32_16x16x32_bf16 v[92:95], a[36:39], v[20:23], v[92:95]
v_mfma_f32_16x16x32_bf16 v[96:99], a[32:35], v[24:27], v[96:99]
ds_read_b128 v[20:23], v6 offset:41984
v_mfma_f32_16x16x32_bf16 v[100:103], a[36:39], v[24:27], v[100:103]
v_mfma_f32_16x16x32_bf16 v[104:107], a[32:35], v[28:31], v[104:107]
ds_read_b128 v[24:27], v6 offset:43008
v_mfma_f32_16x16x32_bf16 v[108:111], a[36:39], v[28:31], v[108:111]
s_waitcnt lgkmcnt(3)
v_mfma_f32_16x16x32_bf16 v[112:115], a[32:35], v[32:35], v[112:115]
ds_read_b128 v[28:31], v6 offset:44032
v_add_f32 v208, v208, v212
v_mfma_f32_16x16x32_bf16 v[116:119], a[36:39], v[32:35], v[116:119]
v_add_f32 v216, v216, v220
v_add_f32 v209, v209, v213
v_add_f32 v217, v217, v221
v_mfma_f32_16x16x32_bf16 v[120:123], a[32:35], v[36:39], v[120:123]
ds_read_b128 v[32:35], v6 offset:45056
v_add_u32 v5, s60, v5
v_mfma_f32_16x16x32_bf16 v[124:127], a[36:39], v[36:39], v[124:127]
global_load_dwordx4 a[64:67], v5, s[20:21] offset:-4096 sc1
v_add_f32 v210, v210, v214
v_add_f32 v218, v218, v222
v_mfma_f32_16x16x32_bf16 v[128:131], a[32:35], v[40:43], v[128:131]
ds_read_b128 v[36:39], v6 offset:46080
v_add_f32 v211, v211, v215
v_mfma_f32_16x16x32_bf16 v[132:135], a[36:39], v[40:43], v[132:135]
v_add_f32 v219, v219, v223
v_add_f32 v208, v208, v216
v_mfma_f32_16x16x32_bf16 v[136:139], a[32:35], v[44:47], v[136:139]
ds_read_b128 v[40:43], v6 offset:47104
global_load_dwordx4 a[68:71], v5, s[20:21] offset:-3072 sc1
v_mfma_f32_16x16x32_bf16 v[140:143], a[36:39], v[44:47], v[140:143]
v_add_f32 v209, v209, v217
s_waitcnt vmcnt(11) lgkmcnt(3)
v_mfma_f32_16x16x32_bf16 v[80:83], a[40:43], v[16:19], v[80:83]
ds_read_b128 v[44:47], v6 offset:48128
v_add_f32 v210, v210, v218
v_mfma_f32_16x16x32_bf16 v[84:87], a[44:47], v[16:19], v[84:87]
v_add_f32 v211, v211, v219
v_mov_b32 v212, v208
v_mfma_f32_16x16x32_bf16 v[88:91], a[40:43], v[20:23], v[88:91]
s_barrier
ds_read_b128 v[16:19], v6 offset:49152
v_mfma_f32_16x16x32_bf16 v[92:95], a[44:47], v[20:23], v[92:95]
s_add_u32 m0, s43, 81920
v_add_u32 v4, 16384, v4
v_mov_b32 v213, v209
v_mfma_f32_16x16x32_bf16 v[96:99], a[40:43], v[24:27], v[96:99]
ds_read_b128 v[20:23], v6 offset:50176
global_load_lds_dwordx4 v4, s[20:21] offset:0 sc1
v_mfma_f32_16x16x32_bf16 v[100:103], a[44:47], v[24:27], v[100:103]
v_mov_b32 v214, v210
v_mov_b32 v215, v211
v_mfma_f32_16x16x32_bf16 v[104:107], a[40:43], v[28:31], v[104:107]
ds_read_b128 v[24:27], v6 offset:51200
global_load_lds_dwordx4 v4, s[20:21] offset:1024 sc1
v_mfma_f32_16x16x32_bf16 v[108:111], a[44:47], v[28:31], v[108:111]
v_permlane32_swap_b32 v208, v212
v_permlane32_swap_b32 v209, v213
s_waitcnt lgkmcnt(3)
v_mfma_f32_16x16x32_bf16 v[112:115], a[40:43], v[32:35], v[112:115]
ds_read_b128 v[28:31], v6 offset:52224
v_permlane32_swap_b32 v210, v214
v_mfma_f32_16x16x32_bf16 v[116:119], a[44:47], v[32:35], v[116:119]
v_permlane32_swap_b32 v211, v215
v_add_f32 v208, v208, v212
v_mfma_f32_16x16x32_bf16 v[120:123], a[40:43], v[36:39], v[120:123]
ds_read_b128 v[32:35], v6 offset:53248
global_load_lds_dwordx4 v4, s[20:21] offset:2048 sc1
v_mfma_f32_16x16x32_bf16 v[124:127], a[44:47], v[36:39], v[124:127]
global_load_lds_dwordx4 v4, s[20:21] offset:3072 sc1
v_add_f32 v209, v209, v213
v_mfma_f32_16x16x32_bf16 v[128:131], a[40:43], v[40:43], v[128:131]
ds_read_b128 v[36:39], v6 offset:54272
v_add_f32 v210, v210, v214
v_mfma_f32_16x16x32_bf16 v[132:135], a[44:47], v[40:43], v[132:135]
v_add_f32 v211, v211, v215
v_mov_b32 v212, v208
v_mfma_f32_16x16x32_bf16 v[136:139], a[40:43], v[44:47], v[136:139]
ds_read_b128 v[40:43], v6 offset:55296
v_mov_b32 v213, v209
v_mfma_f32_16x16x32_bf16 v[140:143], a[44:47], v[44:47], v[140:143]
v_mov_b32 v214, v210
s_waitcnt vmcnt(12) lgkmcnt(3)
v_mfma_f32_16x16x32_bf16 v[80:83], a[48:51], v[16:19], v[80:83]
ds_read_b128 v[44:47], v6 offset:56320
v_mov_b32 v215, v211
v_mfma_f32_16x16x32_bf16 v[84:87], a[52:55], v[16:19], v[84:87]
global_load_dwordx4 a[72:75], v5, s[20:21] offset:-2048 sc1
global_load_dwordx4 a[76:79], v5, s[20:21] offset:-1024 sc1
v_mfma_f32_16x16x32_bf16 v[88:91], a[48:51], v[20:23], v[88:91]
ds_read_b128 v[16:19], v6 offset:57344
v_permlane16_swap_b32 v208, v212
v_mfma_f32_16x16x32_bf16 v[92:95], a[52:55], v[20:23], v[92:95]
v_permlane16_swap_b32 v209, v213
v_permlane16_swap_b32 v210, v214
v_mfma_f32_16x16x32_bf16 v[96:99], a[48:51], v[24:27], v[96:99]
ds_read_b128 v[20:23], v6 offset:58368
v_permlane16_swap_b32 v211, v215
v_mfma_f32_16x16x32_bf16 v[100:103], a[52:55], v[24:27], v[100:103]
v_add_f32 v208, v208, v212
v_add_f32 v209, v209, v213
v_mfma_f32_16x16x32_bf16 v[104:107], a[48:51], v[28:31], v[104:107]
ds_read_b128 v[24:27], v6 offset:59392
v_add_f32 v210, v210, v214
v_mfma_f32_16x16x32_bf16 v[108:111], a[52:55], v[28:31], v[108:111]
v_add_f32 v211, v211, v215
s_waitcnt lgkmcnt(3)
v_mfma_f32_16x16x32_bf16 v[112:115], a[48:51], v[32:35], v[112:115]
ds_read_b128 v[28:31], v6 offset:60416
v_mul_f32 v208, 0xba800000, v208
v_mfma_f32_16x16x32_bf16 v[116:119], a[52:55], v[32:35], v[116:119]
v_mul_f32 v209, 0x3a800000, v209
v_mul_f32 v210, 0xba800000, v210
v_mfma_f32_16x16x32_bf16 v[120:123], a[48:51], v[36:39], v[120:123]
ds_read_b128 v[32:35], v6 offset:61440
global_load_dwordx4 a[80:83], v5, s[20:21] offset:0 sc1
v_mfma_f32_16x16x32_bf16 v[124:127], a[52:55], v[36:39], v[124:127]
v_mul_f32 v211, 0x3a800000, v211
v_fma_f32 v209, -v208, v208, v209
v_mfma_f32_16x16x32_bf16 v[128:131], a[48:51], v[40:43], v[128:131]
ds_read_b128 v[36:39], v6 offset:62464
v_fma_f32 v211, -v210, v210, v211
v_mfma_f32_16x16x32_bf16 v[132:135], a[52:55], v[40:43], v[132:135]
v_max_f32 v209, 0, v209
v_max_f32 v211, 0, v211
v_mfma_f32_16x16x32_bf16 v[136:139], a[48:51], v[44:47], v[136:139]
ds_read_b128 v[40:43], v6 offset:63488
global_load_dwordx4 a[84:87], v5, s[20:21] offset:1024 sc1
v_mfma_f32_16x16x32_bf16 v[140:143], a[52:55], v[44:47], v[140:143]
v_add_f32 v209, 0x3727c5ac, v209
s_waitcnt vmcnt(10) lgkmcnt(3)
v_mfma_f32_16x16x32_bf16 v[80:83], a[56:59], v[16:19], v[80:83]
ds_read_b128 v[44:47], v6 offset:64512
v_add_f32 v211, 0x3727c5ac, v211
v_mfma_f32_16x16x32_bf16 v[84:87], a[60:63], v[16:19], v[84:87]
v_rsq_f32 v212, v209
v_mfma_f32_16x16x32_bf16 v[88:91], a[56:59], v[20:23], v[88:91]
s_barrier
ds_read_b128 v[16:19], v7 offset:0
v_mfma_f32_16x16x32_bf16 v[92:95], a[60:63], v[20:23], v[92:95]
s_add_u32 m0, s43, 98304
v_add_u32 v4, 16384, v4
v_mfma_f32_16x16x32_bf16 v[96:99], a[56:59], v[24:27], v[96:99]
ds_read_b128 v[20:23], v7 offset:1024
global_load_lds_dwordx4 v4, s[20:21] offset:0 sc1
v_mfma_f32_16x16x32_bf16 v[100:103], a[60:63], v[24:27], v[100:103]
v_rsq_f32 v213, v211
v_mfma_f32_16x16x32_bf16 v[104:107], a[56:59], v[28:31], v[104:107]
ds_read_b128 v[24:27], v7 offset:2048
v_mul_f32 v209, v209, v212
v_mfma_f32_16x16x32_bf16 v[108:111], a[60:63], v[28:31], v[108:111]
v_mul_f32 v211, v211, v213
s_waitcnt lgkmcnt(3)
v_mfma_f32_16x16x32_bf16 v[112:115], a[56:59], v[32:35], v[112:115]
ds_read_b128 v[28:31], v7 offset:3072
global_load_lds_dwordx4 v4, s[20:21] offset:1024 sc1
v_mfma_f32_16x16x32_bf16 v[116:119], a[60:63], v[32:35], v[116:119]
v_cvt_pk_bf16_f32 v214, v208, v208
v_cvt_pk_bf16_f32 v215, v209, v209
v_mfma_f32_16x16x32_bf16 v[120:123], a[56:59], v[36:39], v[120:123]
ds_read_b128 v[32:35], v7 offset:4096
v_lshlrev_b32 v216, 16, v214
v_mfma_f32_16x16x32_bf16 v[124:127], a[60:63], v[36:39], v[124:127]
global_load_lds_dwordx4 v4, s[20:21] offset:2048 sc1
global_load_lds_dwordx4 v4, s[20:21] offset:3072 sc1
v_mfma_f32_16x16x32_bf16 v[128:131], a[56:59], v[40:43], v[128:131]
ds_read_b128 v[36:39], v7 offset:5120
v_lshlrev_b32 v217, 16, v215
v_mfma_f32_16x16x32_bf16 v[132:135], a[60:63], v[40:43], v[132:135]
v_sub_f32 v216, v208, v216
v_sub_f32 v217, v209, v217
v_mfma_f32_16x16x32_bf16 v[136:139], a[56:59], v[44:47], v[136:139]
ds_read_b128 v[40:43], v7 offset:6144
v_cvt_pk_bf16_f32 v216, v216, v209
v_mfma_f32_16x16x32_bf16 v[140:143], a[60:63], v[44:47], v[140:143]
v_cvt_pk_bf16_f32 v217, v217, 0
s_waitcnt vmcnt(12) lgkmcnt(3)
v_mfma_f32_16x16x32_bf16 v[80:83], a[64:67], v[16:19], v[80:83]
ds_read_b128 v[44:47], v7 offset:7168
v_cndmask_b32 v64, 0, v214, s[98:99]
v_mfma_f32_16x16x32_bf16 v[84:87], a[68:71], v[16:19], v[84:87]
global_load_dwordx4 a[88:91], v5, s[20:21] offset:2048 sc1
global_load_dwordx4 a[92:95], v5, s[20:21] offset:3072 sc1
v_mfma_f32_16x16x32_bf16 v[88:91], a[64:67], v[20:23], v[88:91]
ds_read_b128 v[16:19], v7 offset:8192
v_cndmask_b32 v65, 0, v216, s[98:99]
v_mfma_f32_16x16x32_bf16 v[92:95], a[68:71], v[20:23], v[92:95]
v_cndmask_b32 v66, 0, v217, s[98:99]
v_cvt_pk_bf16_f32 v214, v210, v210
v_mfma_f32_16x16x32_bf16 v[96:99], a[64:67], v[24:27], v[96:99]
ds_read_b128 v[20:23], v7 offset:9216
v_cvt_pk_bf16_f32 v215, v211, v211
v_mfma_f32_16x16x32_bf16 v[100:103], a[68:71], v[24:27], v[100:103]
v_lshlrev_b32 v216, 16, v214
v_lshlrev_b32 v217, 16, v215
v_mfma_f32_16x16x32_bf16 v[104:107], a[64:67], v[28:31], v[104:107]
ds_read_b128 v[24:27], v7 offset:10240
v_sub_f32 v216, v210, v216
v_mfma_f32_16x16x32_bf16 v[108:111], a[68:71], v[28:31], v[108:111]
v_sub_f32 v217, v211, v217
s_waitcnt lgkmcnt(3)
v_mfma_f32_16x16x32_bf16 v[112:115], a[64:67], v[32:35], v[112:115]
ds_read_b128 v[28:31], v7 offset:11264
v_cvt_pk_bf16_f32 v216, v216, v211
v_mfma_f32_16x16x32_bf16 v[116:119], a[68:71], v[32:35], v[116:119]
v_cvt_pk_bf16_f32 v217, v217, 0
v_cndmask_b32 v68, 0, v214, s[98:99]
v_mfma_f32_16x16x32_bf16 v[120:123], a[64:67], v[36:39], v[120:123]
ds_read_b128 v[32:35], v7 offset:12288
v_add_u32 v5, 8192, v5
v_mfma_f32_16x16x32_bf16 v[124:127], a[68:71], v[36:39], v[124:127]
global_load_dwordx4 a[96:99], v5, s[20:21] offset:-4096 sc1
v_cndmask_b32 v69, 0, v216, s[98:99]
v_mfma_f32_16x16x32_bf16 v[128:131], a[64:67], v[40:43], v[128:131]
ds_read_b128 v[36:39], v7 offset:13312
v_cndmask_b32 v70, 0, v217, s[98:99]
v_mfma_f32_16x16x32_bf16 v[132:135], a[68:71], v[40:43], v[132:135]
v_mul_f32 v254, 0x3fb8aa3b, v212
v_mul_f32 v255, 0x3fb8aa3b, v213
v_mfma_f32_16x16x32_bf16 v[136:139], a[64:67], v[44:47], v[136:139]
ds_read_b128 v[40:43], v7 offset:14336
global_load_dwordx4 a[100:103], v5, s[20:21] offset:-3072 sc1
v_mfma_f32_16x16x32_bf16 v[140:143], a[68:71], v[44:47], v[140:143]
v_and_b32 v214, 48, v11
s_waitcnt vmcnt(10) lgkmcnt(3)
v_mfma_f32_16x16x32_bf16 v[80:83], a[72:75], v[16:19], v[80:83]
ds_read_b128 v[44:47], v7 offset:15360
ds_bpermute_b32 v72, v214, v254 offset:0
v_mfma_f32_16x16x32_bf16 v[84:87], a[76:79], v[16:19], v[84:87]
ds_bpermute_b32 v73, v214, v254 offset:4
ds_bpermute_b32 v74, v214, v254 offset:8
v_mfma_f32_16x16x32_bf16 v[88:91], a[72:75], v[20:23], v[88:91]
s_barrier
ds_read_b128 v[16:19], v7 offset:16384
v_mfma_f32_16x16x32_bf16 v[92:95], a[76:79], v[20:23], v[92:95]
ds_bpermute_b32 v75, v214, v254 offset:12
ds_bpermute_b32 v76, v214, v255 offset:0
v_mfma_f32_16x16x32_bf16 v[96:99], a[72:75], v[24:27], v[96:99]
ds_read_b128 v[20:23], v7 offset:17408
ds_bpermute_b32 v77, v214, v255 offset:4
v_mfma_f32_16x16x32_bf16 v[100:103], a[76:79], v[24:27], v[100:103]
ds_bpermute_b32 v78, v214, v255 offset:8
ds_bpermute_b32 v79, v214, v255 offset:12
v_mfma_f32_16x16x32_bf16 v[104:107], a[72:75], v[28:31], v[104:107]
ds_read_b128 v[24:27], v7 offset:18432
s_add_u32 m0, s43, 114688
v_mfma_f32_16x16x32_bf16 v[108:111], a[76:79], v[28:31], v[108:111]
v_add_u32 v4, 16384, v4
s_waitcnt lgkmcnt(11)
v_mfma_f32_16x16x32_bf16 v[112:115], a[72:75], v[32:35], v[112:115]
ds_read_b128 v[28:31], v7 offset:19456
global_load_lds_dwordx4 v4, s[20:21] offset:0 sc1
v_mfma_f32_16x16x32_bf16 v[116:119], a[76:79], v[32:35], v[116:119]
global_load_lds_dwordx4 v4, s[20:21] offset:1024 sc1
v_add_f32 v224, v224, v228
v_mfma_f32_16x16x32_bf16 v[120:123], a[72:75], v[36:39], v[120:123]
ds_read_b128 v[32:35], v7 offset:20480
v_add_f32 v232, v232, v236
v_mfma_f32_16x16x32_bf16 v[124:127], a[76:79], v[36:39], v[124:127]
global_load_lds_dwordx4 v4, s[20:21] offset:2048 sc1
global_load_lds_dwordx4 v4, s[20:21] offset:3072 sc1
v_mfma_f32_16x16x32_bf16 v[128:131], a[72:75], v[40:43], v[128:131]
ds_read_b128 v[36:39], v7 offset:21504
v_add_f32 v225, v225, v229
v_mfma_f32_16x16x32_bf16 v[132:135], a[76:79], v[40:43], v[132:135]
v_add_f32 v233, v233, v237
v_add_f32 v226, v226, v230
v_mfma_f32_16x16x32_bf16 v[136:139], a[72:75], v[44:47], v[136:139]
ds_read_b128 v[40:43], v7 offset:22528
v_add_f32 v234, v234, v238
v_mfma_f32_16x16x32_bf16 v[140:143], a[76:79], v[44:47], v[140:143]
v_add_f32 v227, v227, v231
s_waitcnt vmcnt(12) lgkmcnt(3)
v_mfma_f32_16x16x32_bf16 v[80:83], a[80:83], v[16:19], v[80:83]
ds_read_b128 v[44:47], v7 offset:23552
v_add_f32 v235, v235, v239
v_mfma_f32_16x16x32_bf16 v[84:87], a[84:87], v[16:19], v[84:87]
global_load_dwordx4 a[104:107], v5, s[20:21] offset:-2048 sc1
global_load_dwordx4 a[108:111], v5, s[20:21] offset:-1024 sc1
v_mfma_f32_16x16x32_bf16 v[88:91], a[80:83], v[20:23], v[88:91]
ds_read_b128 v[16:19], v7 offset:24576
v_add_f32 v224, v224, v232
v_mfma_f32_16x16x32_bf16 v[92:95], a[84:87], v[20:23], v[92:95]
v_add_f32 v225, v225, v233
v_add_f32 v226, v226, v234
v_mfma_f32_16x16x32_bf16 v[96:99], a[80:83], v[24:27], v[96:99]
ds_read_b128 v[20:23], v7 offset:25600
v_add_f32 v227, v227, v235
v_mfma_f32_16x16x32_bf16 v[100:103], a[84:87], v[24:27], v[100:103]
v_permlane32_swap_b32 v224, v226
v_permlane32_swap_b32 v225, v227
v_mfma_f32_16x16x32_bf16 v[104:107], a[80:83], v[28:31], v[104:107]
ds_read_b128 v[24:27], v7 offset:26624
v_add_f32 v224, v224, v226
v_mfma_f32_16x16x32_bf16 v[108:111], a[84:87], v[28:31], v[108:111]
v_add_f32 v225, v225, v227
s_waitcnt lgkmcnt(3)
v_mfma_f32_16x16x32_bf16 v[112:115], a[80:83], v[32:35], v[112:115]
ds_read_b128 v[28:31], v7 offset:27648
v_permlane16_swap_b32 v224, v225
v_mfma_f32_16x16x32_bf16 v[116:119], a[84:87], v[32:35], v[116:119]
v_add_f32 v224, v224, v225
v_cvt_pk_bf16_f32 v229, v224, 0
v_mfma_f32_16x16x32_bf16 v[120:123], a[80:83], v[36:39], v[120:123]
ds_read_b128 v[32:35], v7 offset:28672
global_load_dwordx4 a[112:115], v5, s[20:21] offset:0 sc1
v_mfma_f32_16x16x32_bf16 v[124:127], a[84:87], v[36:39], v[124:127]
s_lshl_b32 s39, s34, 10
v_lshlrev_b32 v232, 16, v229
v_mfma_f32_16x16x32_bf16 v[128:131], a[80:83], v[40:43], v[128:131]
ds_read_b128 v[36:39], v7 offset:29696
v_sub_f32 v232, v224, v232
v_mfma_f32_16x16x32_bf16 v[132:135], a[84:87], v[40:43], v[132:135]
v_cvt_pk_bf16_f32 v228, v224, v232
s_add_u32 s39, s39, 147456
v_mfma_f32_16x16x32_bf16 v[136:139], a[80:83], v[44:47], v[136:139]
ds_read_b128 v[40:43], v7 offset:30720
global_load_dwordx4 a[116:119], v5, s[20:21] offset:1024 sc1
v_mfma_f32_16x16x32_bf16 v[140:143], a[84:87], v[44:47], v[140:143]
v_mov_b32 v231, 0
s_waitcnt vmcnt(10) lgkmcnt(3)
v_mfma_f32_16x16x32_bf16 v[80:83], a[88:91], v[16:19], v[80:83]
ds_read_b128 v[44:47], v7 offset:31744
v_mov_b32 v230, 0
v_mfma_f32_16x16x32_bf16 v[84:87], a[92:95], v[16:19], v[84:87]
v_lshl_add_u32 v241, v241, 4, s39
v_mfma_f32_16x16x32_bf16 v[88:91], a[88:91], v[20:23], v[88:91]
s_barrier
ds_read_b128 v[16:19], v7 offset:32768
v_mfma_f32_16x16x32_bf16 v[92:95], a[92:95], v[20:23], v[92:95]
ds_write_b128 v241, v[228:231]
s_add_u32 m0, s43, 0
v_mfma_f32_16x16x32_bf16 v[96:99], a[88:91], v[24:27], v[96:99]
ds_read_b128 v[20:23], v7 offset:33792
v_add_u32 v4, 16384, v4
v_mfma_f32_16x16x32_bf16 v[100:103], a[92:95], v[24:27], v[100:103]
global_load_lds_dwordx4 v4, s[20:21] offset:0 sc1
v_mfma_f32_16x16x32_bf16 v[104:107], a[88:91], v[28:31], v[104:107]
ds_read_b128 v[24:27], v7 offset:34816
v_mfma_f32_16x16x32_bf16 v[108:111], a[92:95], v[28:31], v[108:111]
s_waitcnt lgkmcnt(4)
v_mfma_f32_16x16x32_bf16 v[112:115], a[88:91], v[32:35], v[112:115]
ds_read_b128 v[28:31], v7 offset:35840
global_load_lds_dwordx4 v4, s[20:21] offset:1024 sc1
v_mfma_f32_16x16x32_bf16 v[116:119], a[92:95], v[32:35], v[116:119]
v_mfma_f32_16x16x32_bf16 v[120:123], a[88:91], v[36:39], v[120:123]
ds_read_b128 v[32:35], v7 offset:36864
v_mfma_f32_16x16x32_bf16 v[124:127], a[92:95], v[36:39], v[124:127]
global_load_lds_dwordx4 v4, s[20:21] offset:2048 sc1
global_load_lds_dwordx4 v4, s[20:21] offset:3072 sc1
v_mfma_f32_16x16x32_bf16 v[128:131], a[88:91], v[40:43], v[128:131]
ds_read_b128 v[36:39], v7 offset:37888
v_mfma_f32_16x16x32_bf16 v[132:135], a[92:95], v[40:43], v[132:135]
s_waitcnt lgkmcnt(5)
s_barrier
s_add_u32 s37, s43, 131072
v_add_u32 v247, s37, v0
v_mfma_f32_16x16x32_bf16 v[136:139], a[88:91], v[44:47], v[136:139]
ds_read_b128 v[40:43], v7 offset:38912
s_lshr_b32 s37, s34, 1
v_mfma_f32_16x16x32_bf16 v[140:143], a[92:95], v[44:47], v[140:143]
s_and_b32 s38, s34, 1
s_lshl_b32 s39, s37, 10
s_waitcnt vmcnt(12)
v_mfma_f32_16x16x32_bf16 v[80:83], a[96:99], v[16:19], v[80:83]
ds_read_b128 v[44:47], v7 offset:39936
s_add_u32 s40, s39, 131072
v_mfma_f32_16x16x32_bf16 v[84:87], a[100:103], v[16:19], v[84:87]
global_load_dwordx4 a[120:123], v5, s[20:21] offset:2048 sc1
s_waitcnt lgkmcnt(3)
v_mfma_f32_16x16x32_bf16 v[88:91], a[96:99], v[20:23], v[88:91]
ds_read_b128 v[16:19], v7 offset:40960
global_load_dwordx4 a[124:127], v5, s[20:21] offset:3072 sc1
v_mfma_f32_16x16x32_bf16 v[92:95], a[100:103], v[20:23], v[92:95]
v_add_u32 v248, s40, v0
s_lshl_b32 s40, s38, 10
v_mfma_f32_16x16x32_bf16 v[96:99], a[96:99], v[24:27], v[96:99]
ds_read_b128 v[20:23], v7 offset:41984
s_add_u32 s40, s40, 133120
v_mfma_f32_16x16x32_bf16 v[100:103], a[100:103], v[24:27], v[100:103]
v_add_u32 v249, s40, v0
v_and_b32 v253, 48, v11
v_mfma_f32_16x16x32_bf16 v[104:107], a[96:99], v[28:31], v[104:107]
ds_read_b128 v[24:27], v7 offset:43008
v_lshl_add_u32 v252, v2, 4, v253
v_mfma_f32_16x16x32_bf16 v[108:111], a[100:103], v[28:31], v[108:111]
v_lshl_add_u32 v251, v253, 25, v2
v_lshl_add_u32 v250, v253, 4, v2
v_mfma_f32_16x16x32_bf16 v[112:115], a[96:99], v[32:35], v[112:115]
ds_read_b128 v[28:31], v7 offset:44032
s_lshl_b32 s40, s38, 11
v_mfma_f32_16x16x32_bf16 v[116:119], a[100:103], v[32:35], v[116:119]
s_add_u32 s39, s39, s40
s_waitcnt vmcnt(8) lgkmcnt(3)
v_mfma_f32_16x16x32_bf16 v[120:123], a[96:99], v[36:39], v[120:123]
ds_read_b128 v[32:35], v7 offset:45056
v_add_u32 v250, s39, v250
v_mfma_f32_16x16x32_bf16 v[124:127], a[100:103], v[36:39], v[124:127]
s_lshl_b32 s37, s37, 6
s_lshl_b32 s38, s38, 28
v_mfma_f32_16x16x32_bf16 v[128:131], a[96:99], v[40:43], v[128:131]
ds_read_b128 v[36:39], v7 offset:46080
v_add_u32 v5, s61, v5
v_mfma_f32_16x16x32_bf16 v[132:135], a[100:103], v[40:43], v[132:135]
global_load_dwordx4 a[128:131], v5, s[20:21] offset:-4096 sc1
s_add_u32 s37, s37, s38
v_mfma_f32_16x16x32_bf16 v[136:139], a[96:99], v[44:47], v[136:139]
ds_read_b128 v[40:43], v7 offset:47104
v_add_u32 v251, s37, v251
v_mfma_f32_16x16x32_bf16 v[140:143], a[100:103], v[44:47], v[140:143]
v_mov_b32 v246, 0x3fb8aa3b
v_mov_b32 v240, 0x3f803f80
v_mfma_f32_16x16x32_bf16 v[80:83], a[104:107], v[16:19], v[80:83]
ds_read_b128 v[44:47], v7 offset:48128
global_load_dwordx4 a[132:135], v5, s[20:21] offset:-3072 sc1
v_mfma_f32_16x16x32_bf16 v[84:87], a[108:111], v[16:19], v[84:87]
v_mov_b32 v241, 0x3f803f80
s_waitcnt lgkmcnt(3)
v_mfma_f32_16x16x32_bf16 v[88:91], a[104:107], v[20:23], v[88:91]
s_barrier
ds_read_b128 v[16:19], v7 offset:49152
v_mfma_f32_16x16x32_bf16 v[92:95], a[108:111], v[20:23], v[92:95]
v_mov_b32 v242, 0x3f803f80
v_mov_b32 v243, 0x3f803f80
v_mfma_f32_16x16x32_bf16 v[96:99], a[104:107], v[24:27], v[96:99]
ds_read_b128 v[20:23], v7 offset:50176
global_load_dwordx4 a[136:139], v5, s[20:21] offset:-2048 sc1
v_mfma_f32_16x16x32_bf16 v[100:103], a[108:111], v[24:27], v[100:103]
v_mfma_f32_16x16x32_bf16 v[104:107], a[104:107], v[28:31], v[104:107]
ds_read_b128 v[24:27], v7 offset:51200
v_mfma_f32_16x16x32_bf16 v[108:111], a[108:111], v[28:31], v[108:111]
v_mfma_f32_16x16x32_bf16 v[112:115], a[104:107], v[32:35], v[112:115]
ds_read_b128 v[28:31], v7 offset:52224
v_mfma_f32_16x16x32_bf16 v[116:119], a[108:111], v[32:35], v[116:119]
s_waitcnt vmcnt(9) lgkmcnt(3)
v_mfma_f32_16x16x32_bf16 v[120:123], a[104:107], v[36:39], v[120:123]
ds_read_b128 v[32:35], v7 offset:53248
global_load_dwordx4 a[140:143], v5, s[20:21] offset:-1024 sc1
v_mfma_f32_16x16x32_bf16 v[124:127], a[108:111], v[36:39], v[124:127]
v_mfma_f32_16x16x32_bf16 v[128:131], a[104:107], v[40:43], v[128:131]
ds_read_b128 v[36:39], v7 offset:54272
v_mfma_f32_16x16x32_bf16 v[132:135], a[108:111], v[40:43], v[132:135]
v_mfma_f32_16x16x32_bf16 v[136:139], a[104:107], v[44:47], v[136:139]
ds_read_b128 v[40:43], v7 offset:55296
s_add_u32 m0, s43, 16384
v_mfma_f32_16x16x32_bf16 v[140:143], a[108:111], v[44:47], v[140:143]
v_add_u32 v4, 16384, v4
v_mfma_f32_16x16x32_bf16 v[80:83], a[112:115], v[16:19], v[80:83]
ds_read_b128 v[44:47], v7 offset:56320
global_load_lds_dwordx4 v4, s[20:21] offset:0 sc1
v_mfma_f32_16x16x32_bf16 v[84:87], a[116:119], v[16:19], v[84:87]
s_waitcnt lgkmcnt(3)
v_mfma_f32_16x16x32_bf16 v[88:91], a[112:115], v[20:23], v[88:91]
ds_read_b128 v[16:19], v7 offset:57344
global_load_lds_dwordx4 v4, s[20:21] offset:1024 sc1
v_mfma_f32_16x16x32_bf16 v[92:95], a[116:119], v[20:23], v[92:95]
v_mfma_f32_16x16x32_bf16 v[96:99], a[112:115], v[24:27], v[96:99]
ds_read_b128 v[20:23], v7 offset:58368
v_mfma_f32_16x16x32_bf16 v[100:103], a[116:119], v[24:27], v[100:103]
v_mfma_f32_16x16x32_bf16 v[104:107], a[112:115], v[28:31], v[104:107]
ds_read_b128 v[24:27], v7 offset:59392
global_load_lds_dwordx4 v4, s[20:21] offset:2048 sc1
v_mfma_f32_16x16x32_bf16 v[108:111], a[116:119], v[28:31], v[108:111]
v_mfma_f32_16x16x32_bf16 v[112:115], a[112:115], v[32:35], v[112:115]
ds_read_b128 v[28:31], v7 offset:60416
v_mfma_f32_16x16x32_bf16 v[116:119], a[116:119], v[32:35], v[116:119]
s_waitcnt vmcnt(7) lgkmcnt(3)
v_mfma_f32_16x16x32_bf16 v[120:123], a[112:115], v[36:39], v[120:123]
ds_read_b128 v[32:35], v7 offset:61440
v_mfma_f32_16x16x32_bf16 v[124:127], a[116:119], v[36:39], v[124:127]
global_load_lds_dwordx4 v4, s[20:21] offset:3072 sc1
v_mfma_f32_16x16x32_bf16 v[128:131], a[112:115], v[40:43], v[128:131]
ds_read_b128 v[36:39], v7 offset:62464
v_mfma_f32_16x16x32_bf16 v[132:135], a[116:119], v[40:43], v[132:135]
v_mfma_f32_16x16x32_bf16 v[136:139], a[112:115], v[44:47], v[136:139]
ds_read_b128 v[40:43], v7 offset:63488
v_mfma_f32_16x16x32_bf16 v[140:143], a[116:119], v[44:47], v[140:143]
v_mfma_f32_16x16x32_bf16 v[80:83], a[120:123], v[16:19], v[80:83]
ds_read_b128 v[44:47], v7 offset:64512
global_load_dwordx4 a[144:147], v5, s[20:21] offset:0 sc1
v_mfma_f32_16x16x32_bf16 v[84:87], a[124:127], v[16:19], v[84:87]
s_waitcnt lgkmcnt(3)
v_mfma_f32_16x16x32_bf16 v[88:91], a[120:123], v[20:23], v[88:91]
s_barrier
ds_read_b128 v[16:19], v6 offset:0
v_mfma_f32_16x16x32_bf16 v[92:95], a[124:127], v[20:23], v[92:95]
v_mfma_f32_16x16x32_bf16 v[96:99], a[120:123], v[24:27], v[96:99]
ds_read_b128 v[20:23], v6 offset:1024
global_load_dwordx4 a[148:151], v5, s[20:21] offset:1024 sc1
v_mfma_f32_16x16x32_bf16 v[100:103], a[124:127], v[24:27], v[100:103]
v_mfma_f32_16x16x32_bf16 v[104:107], a[120:123], v[28:31], v[104:107]
ds_read_b128 v[24:27], v6 offset:2048
v_mfma_f32_16x16x32_bf16 v[108:111], a[124:127], v[28:31], v[108:111]
v_mfma_f32_16x16x32_bf16 v[112:115], a[120:123], v[32:35], v[112:115]
ds_read_b128 v[28:31], v6 offset:3072
global_load_dwordx4 a[152:155], v5, s[20:21] offset:2048 sc1
v_mfma_f32_16x16x32_bf16 v[116:119], a[124:127], v[32:35], v[116:119]
s_waitcnt vmcnt(9) lgkmcnt(3)
v_mfma_f32_16x16x32_bf16 v[120:123], a[120:123], v[36:39], v[120:123]
ds_read_b128 v[32:35], v6 offset:4096
v_mfma_f32_16x16x32_bf16 v[124:127], a[124:127], v[36:39], v[124:127]
v_mfma_f32_16x16x32_bf16 v[128:131], a[120:123], v[40:43], v[128:131]
ds_read_b128 v[36:39], v6 offset:5120
v_mfma_f32_16x16x32_bf16 v[132:135], a[124:127], v[40:43], v[132:135]
v_mfma_f32_16x16x32_bf16 v[136:139], a[120:123], v[44:47], v[136:139]
ds_read_b128 v[40:43], v6 offset:6144
global_load_dwordx4 a[156:159], v5, s[20:21] offset:3072 sc1
v_mfma_f32_16x16x32_bf16 v[140:143], a[124:127], v[44:47], v[140:143]
v_mfma_f32_16x16x32_bf16 v[80:83], a[128:131], v[16:19], v[80:83]
ds_read_b128 v[44:47], v6 offset:7168
v_mfma_f32_16x16x32_bf16 v[84:87], a[132:135], v[16:19], v[84:87]
s_waitcnt lgkmcnt(3)
v_mfma_f32_16x16x32_bf16 v[88:91], a[128:131], v[20:23], v[88:91]
ds_read_b128 v[16:19], v6 offset:8192
v_add_u32 v5, 8192, v5
v_mfma_f32_16x16x32_bf16 v[92:95], a[132:135], v[20:23], v[92:95]
global_load_dwordx4 a[160:163], v5, s[20:21] offset:-4096 sc1
v_mfma_f32_16x16x32_bf16 v[96:99], a[128:131], v[24:27], v[96:99]
ds_read_b128 v[20:23], v6 offset:9216
v_mfma_f32_16x16x32_bf16 v[100:103], a[132:135], v[24:27], v[100:103]
v_mfma_f32_16x16x32_bf16 v[104:107], a[128:131], v[28:31], v[104:107]
ds_read_b128 v[24:27], v6 offset:10240
global_load_dwordx4 a[164:167], v5, s[20:21] offset:-3072 sc1
v_mfma_f32_16x16x32_bf16 v[108:111], a[132:135], v[28:31], v[108:111]
v_mfma_f32_16x16x32_bf16 v[112:115], a[128:131], v[32:35], v[112:115]
ds_read_b128 v[28:31], v6 offset:11264
v_mfma_f32_16x16x32_bf16 v[116:119], a[132:135], v[32:35], v[116:119]
s_waitcnt vmcnt(10) lgkmcnt(3)
v_mfma_f32_16x16x32_bf16 v[120:123], a[128:131], v[36:39], v[120:123]
ds_read_b128 v[32:35], v6 offset:12288
s_add_u32 m0, s43, 32768
v_mfma_f32_16x16x32_bf16 v[124:127], a[132:135], v[36:39], v[124:127]
v_add_u32 v4, 16384, v4
v_mfma_f32_16x16x32_bf16 v[128:131], a[128:131], v[40:43], v[128:131]
ds_read_b128 v[36:39], v6 offset:13312
global_load_lds_dwordx4 v4, s[20:21] offset:0 sc1
v_mfma_f32_16x16x32_bf16 v[132:135], a[132:135], v[40:43], v[132:135]
global_load_lds_dwordx4 v4, s[20:21] offset:1024 sc1
global_load_lds_dwordx4 v4, s[20:21] offset:2048 sc1
v_mfma_f32_16x16x32_bf16 v[136:139], a[128:131], v[44:47], v[136:139]
ds_read_b128 v[40:43], v6 offset:14336
global_load_lds_dwordx4 v4, s[20:21] offset:3072 sc1
v_mfma_f32_16x16x32_bf16 v[140:143], a[132:135], v[44:47], v[140:143]
global_load_dwordx4 a[168:171], v5, s[20:21] offset:-2048 sc1
global_load_dwordx4 a[172:175], v5, s[20:21] offset:-1024 sc1
v_mfma_f32_16x16x32_bf16 v[80:83], a[136:139], v[16:19], v[80:83]
ds_read_b128 v[44:47], v6 offset:15360
v_mfma_f32_16x16x32_bf16 v[84:87], a[140:143], v[16:19], v[84:87]
global_load_dwordx4 a[176:179], v5, s[20:21] offset:0 sc1
s_waitcnt lgkmcnt(3)
v_mfma_f32_16x16x32_bf16 v[88:91], a[136:139], v[20:23], v[88:91]
ds_read_b128 v[16:19], v8 offset:0
global_load_dwordx4 a[180:183], v5, s[20:21] offset:1024 sc1
v_mfma_f32_16x16x32_bf16 v[92:95], a[140:143], v[20:23], v[92:95]
v_mfma_f32_16x16x32_bf16 v[96:99], a[136:139], v[24:27], v[96:99]
ds_read_b128 v[20:23], v8 offset:256
v_mfma_f32_16x16x32_bf16 v[100:103], a[140:143], v[24:27], v[100:103]
global_load_dwordx4 a[184:187], v5, s[20:21] offset:2048 sc1
global_load_dwordx4 a[188:191], v5, s[20:21] offset:3072 sc1
v_mfma_f32_16x16x32_bf16 v[104:107], a[136:139], v[28:31], v[104:107]
ds_read_b128 v[24:27], v8 offset:512
v_mfma_f32_16x16x32_bf16 v[108:111], a[140:143], v[28:31], v[108:111]
v_mfma_f32_16x16x32_bf16 v[112:115], a[136:139], v[32:35], v[112:115]
ds_read_b128 v[28:31], v8 offset:768
v_mfma_f32_16x16x32_bf16 v[116:119], a[140:143], v[32:35], v[116:119]
v_add_u32 v5, s60, v5
s_waitcnt lgkmcnt(3)
v_mfma_f32_16x16x32_bf16 v[120:123], a[136:139], v[36:39], v[120:123]
ds_read_b128 v[32:35], v8 offset:1024
global_load_dwordx4 a[192:195], v5, s[20:21] offset:-4096 sc1
v_mfma_f32_16x16x32_bf16 v[124:127], a[140:143], v[36:39], v[124:127]
global_load_dwordx4 a[196:199], v5, s[20:21] offset:-3072 sc1
v_mfma_f32_16x16x32_bf16 v[128:131], a[136:139], v[40:43], v[128:131]
ds_read_b128 v[36:39], v8 offset:1280
v_mfma_f32_16x16x32_bf16 v[132:135], a[140:143], v[40:43], v[132:135]
global_load_dwordx4 a[200:203], v5, s[20:21] offset:-2048 sc1
global_load_dwordx4 a[204:207], v5, s[20:21] offset:-1024 sc1
v_mfma_f32_16x16x32_bf16 v[136:139], a[136:139], v[44:47], v[136:139]
ds_read_b128 v[40:43], v8 offset:1536
v_mfma_f32_16x16x32_bf16 v[140:143], a[140:143], v[44:47], v[140:143]
v_mfma_f32_16x16x32_bf16 v[80:83], v[64:67], v[16:19], v[80:83]
ds_read_b128 v[44:47], v8 offset:1792
v_mfma_f32_16x16x32_bf16 v[84:87], v[68:71], v[16:19], v[84:87]
global_load_dwordx4 a[208:211], v5, s[20:21] offset:0 sc1
s_waitcnt vmcnt(21) lgkmcnt(3)
v_mfma_f32_16x16x32_bf16 v[88:91], v[64:67], v[20:23], v[88:91]
s_barrier
ds_read_b128 v[16:19], v6 offset:16384
v_mfma_f32_16x16x32_bf16 v[92:95], v[68:71], v[20:23], v[92:95]
global_load_dwordx4 a[212:215], v5, s[20:21] offset:1024 sc1
v_mfma_f32_16x16x32_bf16 v[112:115], v[64:67], v[24:27], v[112:115]
ds_read_b128 v[20:23], v6 offset:17408
v_mfma_f32_16x16x32_bf16 v[116:119], v[68:71], v[24:27], v[116:119]
global_load_dwordx4 a[216:219], v5, s[20:21] offset:2048 sc1
global_load_dwordx4 a[220:223], v5, s[20:21] offset:3072 sc1
v_mfma_f32_16x16x32_bf16 v[120:123], v[64:67], v[28:31], v[120:123]
ds_read_b128 v[24:27], v6 offset:18432
v_mfma_f32_16x16x32_bf16 v[124:127], v[68:71], v[28:31], v[124:127]
v_mfma_f32_16x16x32_bf16 v[96:99], v[64:67], v[32:35], v[96:99]
ds_read_b128 v[28:31], v6 offset:19456
v_mfma_f32_16x16x32_bf16 v[100:103], v[68:71], v[32:35], v[100:103]
v_add_u32 v5, 8192, v5
s_waitcnt vmcnt(22) lgkmcnt(3)
v_mfma_f32_16x16x32_bf16 v[104:107], v[64:67], v[36:39], v[104:107]
ds_read_b128 v[32:35], v6 offset:20480
global_load_dwordx4 a[224:227], v5, s[20:21] offset:-4096 sc1
v_mfma_f32_16x16x32_bf16 v[108:111], v[68:71], v[36:39], v[108:111]
global_load_dwordx4 a[228:231], v5, s[20:21] offset:-3072 sc1
s_add_u32 m0, s43, 49152
v_mfma_f32_16x16x32_bf16 v[128:131], v[64:67], v[40:43], v[128:131]
ds_read_b128 v[36:39], v6 offset:21504
v_add_u32 v4, 16384, v4
v_mfma_f32_16x16x32_bf16 v[132:135], v[68:71], v[40:43], v[132:135]
global_load_lds_dwordx4 v4, s[20:21] offset:0 sc1
global_load_lds_dwordx4 v4, s[20:21] offset:1024 sc1
buffer_store_dwordx4 v[144:147], v0, s[20:23], s80 offen sc1
v_mfma_f32_16x16x32_bf16 v[136:139], v[64:67], v[44:47], v[136:139]
ds_read_b128 v[40:43], v6 offset:22528
global_load_lds_dwordx4 v4, s[20:21] offset:2048 sc1
v_mfma_f32_16x16x32_bf16 v[140:143], v[68:71], v[44:47], v[140:143]
global_load_lds_dwordx4 v4, s[20:21] offset:3072 sc1
global_load_dwordx4 a[232:235], v5, s[20:21] offset:-2048 sc1
v_mfma_f32_16x16x32_bf16 v[80:83], a[144:147], v[16:19], v[80:83]
ds_read_b128 v[44:47], v6 offset:23552
global_load_dwordx4 a[236:239], v5, s[20:21] offset:-1024 sc1
v_mfma_f32_16x16x32_bf16 v[84:87], a[148:151], v[16:19], v[84:87]
global_load_dwordx4 a[240:243], v5, s[20:21] offset:0 sc1
s_waitcnt vmcnt(28) lgkmcnt(3)
v_mfma_f32_16x16x32_bf16 v[88:91], a[144:147], v[20:23], v[88:91]
ds_read_b128 v[16:19], v6 offset:24576
global_load_dwordx4 a[244:247], v5, s[20:21] offset:1024 sc1
v_mfma_f32_16x16x32_bf16 v[92:95], a[148:151], v[20:23], v[92:95]
v_mfma_f32_16x16x32_bf16 v[80:83], a[152:155], v[24:27], v[80:83]
ds_read_b128 v[20:23], v6 offset:25600
v_mfma_f32_16x16x32_bf16 v[84:87], a[156:159], v[24:27], v[84:87]
global_load_dwordx4 a[248:251], v5, s[20:21] offset:2048 sc1
global_load_dwordx4 a[252:255], v5, s[20:21] offset:3072 sc1
v_mfma_f32_16x16x32_bf16 v[88:91], a[152:155], v[28:31], v[88:91]
ds_read_b128 v[24:27], v6 offset:26624
v_mfma_f32_16x16x32_bf16 v[92:95], a[156:159], v[28:31], v[92:95]
v_mfma_f32_16x16x32_bf16 v[80:83], a[160:163], v[32:35], v[80:83]
ds_read_b128 v[28:31], v6 offset:27648
v_mfma_f32_16x16x32_bf16 v[84:87], a[164:167], v[32:35], v[84:87]
s_waitcnt vmcnt(23) lgkmcnt(3)
v_mfma_f32_16x16x32_bf16 v[88:91], a[160:163], v[36:39], v[88:91]
ds_read_b128 v[32:35], v6 offset:28672
v_mfma_f32_16x16x32_bf16 v[92:95], a[164:167], v[36:39], v[92:95]
v_mfma_f32_16x16x32_bf16 v[80:83], a[168:171], v[40:43], v[80:83]
ds_read_b128 v[36:39], v6 offset:29696
v_mfma_f32_16x16x32_bf16 v[84:87], a[172:175], v[40:43], v[84:87]
v_mfma_f32_16x16x32_bf16 v[88:91], a[168:171], v[44:47], v[88:91]
ds_read_b128 v[40:43], v6 offset:30720
s_add_u32 m0, s43, 65536
v_mfma_f32_16x16x32_bf16 v[92:95], a[172:175], v[44:47], v[92:95]
v_add_u32 v4, 16384, v4
v_mfma_f32_16x16x32_bf16 v[80:83], a[176:179], v[16:19], v[80:83]
ds_read_b128 v[44:47], v6 offset:31744
global_load_lds_dwordx4 v4, s[20:21] offset:0 sc1
v_mfma_f32_16x16x32_bf16 v[84:87], a[180:183], v[16:19], v[84:87]
buffer_store_dwordx4 v[148:151], v0, s[20:23], s81 offen sc1
s_waitcnt vmcnt(21) lgkmcnt(3)
v_mfma_f32_16x16x32_bf16 v[88:91], a[176:179], v[20:23], v[88:91]
s_barrier
ds_read_b128 v[16:19], v6 offset:32768
v_mfma_f32_16x16x32_bf16 v[92:95], a[180:183], v[20:23], v[92:95]
v_mfma_f32_16x16x32_bf16 v[80:83], a[184:187], v[24:27], v[80:83]
ds_read_b128 v[20:23], v6 offset:33792
v_mfma_f32_16x16x32_bf16 v[84:87], a[188:191], v[24:27], v[84:87]
v_mfma_f32_16x16x32_bf16 v[88:91], a[184:187], v[28:31], v[88:91]
ds_read_b128 v[24:27], v6 offset:34816
v_mfma_f32_16x16x32_bf16 v[92:95], a[188:191], v[28:31], v[92:95]
v_mfma_f32_16x16x32_bf16 v[80:83], a[192:195], v[32:35], v[80:83]
ds_read_b128 v[28:31], v6 offset:35840
v_mfma_f32_16x16x32_bf16 v[84:87], a[196:199], v[32:35], v[84:87]
s_waitcnt vmcnt(17) lgkmcnt(3)
v_mfma_f32_16x16x32_bf16 v[88:91], a[192:195], v[36:39], v[88:91]
ds_read_b128 v[32:35], v6 offset:36864
v_mfma_f32_16x16x32_bf16 v[92:95], a[196:199], v[36:39], v[92:95]
global_load_lds_dwordx4 v4, s[20:21] offset:1024 sc1
global_load_lds_dwordx4 v4, s[20:21] offset:2048 sc1
v_mfma_f32_16x16x32_bf16 v[80:83], a[200:203], v[40:43], v[80:83]
ds_read_b128 v[36:39], v6 offset:37888
global_load_lds_dwordx4 v4, s[20:21] offset:3072 sc1
v_mfma_f32_16x16x32_bf16 v[84:87], a[204:207], v[40:43], v[84:87]
v_mfma_f32_16x16x32_bf16 v[88:91], a[200:203], v[44:47], v[88:91]
ds_read_b128 v[40:43], v6 offset:38912
v_mfma_f32_16x16x32_bf16 v[92:95], a[204:207], v[44:47], v[92:95]
v_mfma_f32_16x16x32_bf16 v[80:83], a[208:211], v[16:19], v[80:83]
ds_read_b128 v[44:47], v6 offset:39936
v_mfma_f32_16x16x32_bf16 v[84:87], a[212:215], v[16:19], v[84:87]
s_waitcnt vmcnt(16) lgkmcnt(3)
v_mfma_f32_16x16x32_bf16 v[88:91], a[208:211], v[20:23], v[88:91]
ds_read_b128 v[16:19], v6 offset:40960
v_mfma_f32_16x16x32_bf16 v[92:95], a[212:215], v[20:23], v[92:95]
v_mfma_f32_16x16x32_bf16 v[80:83], a[216:219], v[24:27], v[80:83]
ds_read_b128 v[20:23], v6 offset:41984
v_mfma_f32_16x16x32_bf16 v[84:87], a[220:223], v[24:27], v[84:87]
buffer_store_dwordx4 v[152:155], v0, s[20:23], s82 offen sc1
v_mfma_f32_16x16x32_bf16 v[88:91], a[216:219], v[28:31], v[88:91]
ds_read_b128 v[24:27], v6 offset:43008
v_mfma_f32_16x16x32_bf16 v[92:95], a[220:223], v[28:31], v[92:95]
v_mfma_f32_16x16x32_bf16 v[80:83], a[224:227], v[32:35], v[80:83]
ds_read_b128 v[28:31], v6 offset:44032
v_mfma_f32_16x16x32_bf16 v[84:87], a[228:231], v[32:35], v[84:87]
s_waitcnt vmcnt(8) lgkmcnt(3)
v_mfma_f32_16x16x32_bf16 v[88:91], a[224:227], v[36:39], v[88:91]
ds_read_b128 v[32:35], v6 offset:45056
v_mfma_f32_16x16x32_bf16 v[92:95], a[228:231], v[36:39], v[92:95]
v_mfma_f32_16x16x32_bf16 v[80:83], a[232:235], v[40:43], v[80:83]
ds_read_b128 v[36:39], v6 offset:46080
v_mfma_f32_16x16x32_bf16 v[84:87], a[236:239], v[40:43], v[84:87]
v_mfma_f32_16x16x32_bf16 v[88:91], a[232:235], v[44:47], v[88:91]
ds_read_b128 v[40:43], v6 offset:47104
v_mfma_f32_16x16x32_bf16 v[92:95], a[236:239], v[44:47], v[92:95]
v_mfma_f32_16x16x32_bf16 v[80:83], a[240:243], v[16:19], v[80:83]
ds_read_b128 v[44:47], v6 offset:48128
s_add_u32 m0, s43, 81920
v_mfma_f32_16x16x32_bf16 v[84:87], a[244:247], v[16:19], v[84:87]
v_add_u32 v4, 16384, v4
s_waitcnt vmcnt(6) lgkmcnt(3)
v_mfma_f32_16x16x32_bf16 v[88:91], a[240:243], v[20:23], v[88:91]
s_barrier
ds_read_b128 v[16:19], v6 offset:49152
v_mfma_f32_16x16x32_bf16 v[92:95], a[244:247], v[20:23], v[92:95]
global_load_lds_dwordx4 v4, s[20:21] offset:0 sc1
v_mfma_f32_16x16x32_bf16 v[80:83], a[248:251], v[24:27], v[80:83]
ds_read_b128 v[20:23], v6 offset:50176
global_load_lds_dwordx4 v4, s[20:21] offset:1024 sc1
v_mfma_f32_16x16x32_bf16 v[84:87], a[252:255], v[24:27], v[84:87]
v_mfma_f32_16x16x32_bf16 v[88:91], a[248:251], v[28:31], v[88:91]
ds_read_b128 v[24:27], v6 offset:51200
v_mfma_f32_16x16x32_bf16 v[92:95], a[252:255], v[28:31], v[92:95]
v_mfma_f32_16x16x32_bf16 v[96:99], a[144:147], v[32:35], v[96:99]
ds_read_b128 v[28:31], v6 offset:52224
v_mfma_f32_16x16x32_bf16 v[100:103], a[148:151], v[32:35], v[100:103]
buffer_store_dwordx4 v[156:159], v0, s[20:23], s83 offen sc1
v_mul_f32 v80, v80, v72
v_mul_f32 v81, v81, v73
s_waitcnt lgkmcnt(3)
v_mfma_f32_16x16x32_bf16 v[104:107], a[144:147], v[36:39], v[104:107]
ds_read_b128 v[32:35], v6 offset:53248
v_mul_f32 v82, v82, v74
v_mfma_f32_16x16x32_bf16 v[108:111], a[148:151], v[36:39], v[108:111]
global_load_lds_dwordx4 v4, s[20:21] offset:2048 sc1
global_load_lds_dwordx4 v4, s[20:21] offset:3072 sc1
v_exp_f32 v208, v80 clamp
v_mfma_f32_16x16x32_bf16 v[96:99], a[152:155], v[40:43], v[96:99]
ds_read_b128 v[36:39], v6 offset:54272
v_max_f32 v80, s62, v80
v_mfma_f32_16x16x32_bf16 v[100:103], a[156:159], v[40:43], v[100:103]
v_exp_f32 v209, v81 clamp
v_mul_f32 v83, v83, v75
v_mfma_f32_16x16x32_bf16 v[104:107], a[152:155], v[44:47], v[104:107]
ds_read_b128 v[40:43], v6 offset:55296
v_max_f32 v81, s62, v81
v_mfma_f32_16x16x32_bf16 v[108:111], a[156:159], v[44:47], v[108:111]
v_exp_f32 v210, v82 clamp
v_mfma_f32_16x16x32_bf16 v[96:99], a[160:163], v[16:19], v[96:99]
ds_read_b128 v[44:47], v6 offset:56320
v_fma_f32 v80, v80, s63, v208
v_mfma_f32_16x16x32_bf16 v[100:103], a[164:167], v[16:19], v[100:103]
v_mul_f32 v84, v84, v76
v_exp_f32 v211, v83 clamp
s_waitcnt lgkmcnt(3)
v_mfma_f32_16x16x32_bf16 v[104:107], a[160:163], v[20:23], v[104:107]
ds_read_b128 v[16:19], v6 offset:57344
v_max_f32 v82, s62, v82
v_mfma_f32_16x16x32_bf16 v[108:111], a[164:167], v[20:23], v[108:111]
v_exp_f32 v208, v84 clamp
v_mfma_f32_16x16x32_bf16 v[96:99], a[168:171], v[24:27], v[96:99]
ds_read_b128 v[20:23], v6 offset:58368
s_add_u32 m0, s43, 98304
v_mfma_f32_16x16x32_bf16 v[100:103], a[172:175], v[24:27], v[100:103]
v_add_u32 v4, 16384, v4
v_fma_f32 v81, v81, s63, v209
v_mul_f32 v85, v85, v77
v_max_f32 v83, s62, v83
v_mfma_f32_16x16x32_bf16 v[104:107], a[168:171], v[28:31], v[104:107]
ds_read_b128 v[24:27], v6 offset:59392
global_load_lds_dwordx4 v4, s[20:21] offset:0 sc1
v_mfma_f32_16x16x32_bf16 v[108:111], a[172:175], v[28:31], v[108:111]
global_load_lds_dwordx4 v4, s[20:21] offset:1024 sc1
v_fma_f32 v82, v82, s63, v210
v_cvt_pk_bf16_f32 v216, v80, v81
v_mul_f32 v86, v86, v78
v_mfma_f32_16x16x32_bf16 v[96:99], a[176:179], v[32:35], v[96:99]
v_exp_f32 v209, v85 clamp
v_mfma_f32_16x16x32_bf16 v[100:103], a[180:183], v[32:35], v[100:103]
ds_read_b128 v[28:31], v6 offset:60416
v_max_f32 v84, s62, v84
s_waitcnt lgkmcnt(3)
v_mfma_f32_16x16x32_bf16 v[104:107], a[176:179], v[36:39], v[104:107]
ds_read_b128 v[32:35], v6 offset:61440
global_load_lds_dwordx4 v4, s[20:21] offset:2048 sc1
v_mfma_f32_16x16x32_bf16 v[108:111], a[180:183], v[36:39], v[108:111]
v_exp_f32 v210, v86 clamp
v_fma_f32 v83, v83, s63, v211
v_mul_f32 v87, v87, v79
v_mfma_f32_16x16x32_bf16 v[96:99], a[184:187], v[40:43], v[96:99]
ds_read_b128 v[36:39], v6 offset:62464
v_max_f32 v85, s62, v85
v_mfma_f32_16x16x32_bf16 v[100:103], a[188:191], v[40:43], v[100:103]
buffer_store_dwordx4 v[160:163], v0, s[20:23], s84 offen sc1
v_mfma_f32_16x16x32_bf16 v[104:107], a[184:187], v[44:47], v[104:107]
ds_read_b128 v[40:43], v6 offset:63488
v_fma_f32 v84, v84, s63, v208
v_mfma_f32_16x16x32_bf16 v[108:111], a[188:191], v[44:47], v[108:111]
v_exp_f32 v211, v87 clamp
v_mfma_f32_16x16x32_bf16 v[96:99], a[192:195], v[16:19], v[96:99]
ds_read_b128 v[44:47], v6 offset:64512
s_getpc_b64 s[4:5]
v_mfma_f32_16x16x32_bf16 v[100:103], a[196:199], v[16:19], v[100:103]
global_load_dword v13, v12, s[4:5]
v_cvt_pk_bf16_f32 v217, v82, v83
v_mul_f32 v88, v88, v72
v_max_f32 v86, s62, v86
s_waitcnt vmcnt(11) lgkmcnt(3)
v_mfma_f32_16x16x32_bf16 v[104:107], a[192:195], v[20:23], v[104:107]
s_barrier
ds_read_b128 v[16:19], v7 offset:0
v_mfma_f32_16x16x32_bf16 v[108:111], a[196:199], v[20:23], v[108:111]
v_exp_f32 v208, v88 clamp
v_fma_f32 v85, v85, s63, v209
v_mfma_f32_16x16x32_bf16 v[96:99], a[200:203], v[24:27], v[96:99]
ds_read_b128 v[20:23], v7 offset:1024
v_mul_f32 v89, v89, v73
v_mfma_f32_16x16x32_bf16 v[100:103], a[204:207], v[24:27], v[100:103]
v_max_f32 v87, s62, v87
v_fma_f32 v86, v86, s63, v210
v_cvt_pk_bf16_f32 v218, v84, v85
v_mfma_f32_16x16x32_bf16 v[104:107], a[200:203], v[28:31], v[104:107]
ds_read_b128 v[24:27], v7 offset:2048
global_load_lds_dwordx4 v4, s[20:21] offset:3072 sc1
v_mfma_f32_16x16x32_bf16 v[108:111], a[204:207], v[28:31], v[108:111]
v_exp_f32 v209, v89 clamp
v_mul_f32 v90, v90, v74
v_mfma_f32_16x16x32_bf16 v[96:99], a[208:211], v[32:35], v[96:99]
ds_read_b128 v[28:31], v7 offset:3072
v_max_f32 v88, s62, v88
v_mfma_f32_16x16x32_bf16 v[100:103], a[212:215], v[32:35], v[100:103]
v_fma_f32 v87, v87, s63, v211
v_mul_f32 v91, v91, v75
s_waitcnt lgkmcnt(3)
v_mfma_f32_16x16x32_bf16 v[104:107], a[208:211], v[36:39], v[104:107]
ds_read_b128 v[32:35], v7 offset:4096
s_add_u32 m0, s43, 114688
v_mfma_f32_16x16x32_bf16 v[108:111], a[212:215], v[36:39], v[108:111]
v_add_u32 v4, 16384, v4
v_max_f32 v89, s62, v89
v_exp_f32 v210, v90 clamp
v_mfma_f32_16x16x32_bf16 v[96:99], a[216:219], v[40:43], v[96:99]
ds_read_b128 v[36:39], v7 offset:5120
global_load_lds_dwordx4 v4, s[20:21] offset:0 sc1
v_mfma_f32_16x16x32_bf16 v[100:103], a[220:223], v[40:43], v[100:103]
v_exp_f32 v211, v91 clamp
v_fma_f32 v88, v88, s63, v208
v_mfma_f32_16x16x32_bf16 v[104:107], a[216:219], v[44:47], v[104:107]
ds_read_b128 v[40:43], v7 offset:6144
global_load_lds_dwordx4 v4, s[20:21] offset:1024 sc1
v_mfma_f32_16x16x32_bf16 v[108:111], a[220:223], v[44:47], v[108:111]
v_cvt_pk_bf16_f32 v219, v86, v87
v_mul_f32 v92, v92, v76
v_max_f32 v90, s62, v90
v_fma_f32 v89, v89, s63, v209
v_mfma_f32_16x16x32_bf16 v[96:99], a[224:227], v[16:19], v[96:99]
ds_read_b128 v[44:47], v7 offset:7168
global_load_lds_dwordx4 v4, s[20:21] offset:2048 sc1
v_mfma_f32_16x16x32_bf16 v[100:103], a[228:231], v[16:19], v[100:103]
buffer_store_dwordx4 v[164:167], v0, s[20:23], s85 offen sc1
v_mul_f32 v93, v93, v77
s_waitcnt lgkmcnt(3)
v_mfma_f32_16x16x32_bf16 v[104:107], a[224:227], v[20:23], v[104:107]
ds_read_b128 v[16:19], v7 offset:8192
v_max_f32 v91, s62, v91
v_mfma_f32_16x16x32_bf16 v[108:111], a[228:231], v[20:23], v[108:111]
v_exp_f32 v208, v92 clamp
v_mfma_f32_16x16x32_bf16 v[96:99], a[232:235], v[24:27], v[96:99]
ds_read_b128 v[20:23], v7 offset:9216
v_fma_f32 v90, v90, s63, v210
v_mfma_f32_16x16x32_bf16 v[100:103], a[236:239], v[24:27], v[100:103]
v_exp_f32 v209, v93 clamp
v_mfma_f32_16x16x32_bf16 v[104:107], a[232:235], v[28:31], v[104:107]
ds_read_b128 v[24:27], v7 offset:10240
v_cvt_pk_bf16_f32 v220, v88, v89
v_mfma_f32_16x16x32_bf16 v[108:111], a[236:239], v[28:31], v[108:111]
v_mul_f32 v94, v94, v78
v_max_f32 v92, s62, v92
v_mfma_f32_16x16x32_bf16 v[96:99], a[240:243], v[32:35], v[96:99]
ds_read_b128 v[28:31], v7 offset:11264
v_fma_f32 v91, v91, s63, v211
v_mfma_f32_16x16x32_bf16 v[100:103], a[244:247], v[32:35], v[100:103]
v_mul_f32 v95, v95, v79
v_exp_f32 v210, v94 clamp
s_waitcnt lgkmcnt(3)
v_mfma_f32_16x16x32_bf16 v[104:107], a[240:243], v[36:39], v[104:107]
ds_read_b128 v[32:35], v7 offset:12288
v_max_f32 v93, s62, v93
v_mfma_f32_16x16x32_bf16 v[108:111], a[244:247], v[36:39], v[108:111]
v_exp_f32 v211, v95 clamp
v_mfma_f32_16x16x32_bf16 v[96:99], a[248:251], v[40:43], v[96:99]
ds_read_b128 v[36:39], v7 offset:13312
v_fma_f32 v92, v92, s63, v208
v_mfma_f32_16x16x32_bf16 v[100:103], a[252:255], v[40:43], v[100:103]
v_cvt_pk_bf16_f32 v221, v90, v91
v_max_f32 v94, s62, v94
v_mfma_f32_16x16x32_bf16 v[104:107], a[248:251], v[44:47], v[104:107]
ds_read_b128 v[40:43], v7 offset:14336
global_load_lds_dwordx4 v4, s[20:21] offset:3072 sc1
v_mfma_f32_16x16x32_bf16 v[108:111], a[252:255], v[44:47], v[108:111]
v_fma_f32 v93, v93, s63, v209
v_max_f32 v95, s62, v95
v_fma_f32 v94, v94, s63, v210
v_mfma_f32_16x16x32_bf16 v[112:115], a[144:147], v[16:19], v[112:115]
ds_read_b128 v[44:47], v7 offset:15360
v_cvt_pk_bf16_f32 v222, v92, v93
v_mfma_f32_16x16x32_bf16 v[116:119], a[148:151], v[16:19], v[116:119]
v_fma_f32 v95, v95, s63, v211
v_cvt_pk_bf16_f32 v223, v94, v95
s_waitcnt vmcnt(11) lgkmcnt(3)
v_mfma_f32_16x16x32_bf16 v[120:123], a[144:147], v[20:23], v[120:123]
s_barrier
ds_read_b128 v[16:19], v7 offset:16384
ds_write_b128 v247, v[216:219] offset:0
v_mfma_f32_16x16x32_bf16 v[124:127], a[148:151], v[20:23], v[124:127]
s_add_u32 m0, s43, 0
v_add_u32 v4, 16384, v4
v_mfma_f32_16x16x32_bf16 v[112:115], a[152:155], v[24:27], v[112:115]
ds_read_b128 v[20:23], v7 offset:17408
global_load_lds_dwordx4 v4, s[20:21] offset:0 sc1
ds_write_b128 v247, v[220:223] offset:1024
v_mfma_f32_16x16x32_bf16 v[116:119], a[156:159], v[24:27], v[116:119]
buffer_store_dwordx4 v[168:171], v0, s[20:23], s86 offen sc1
v_mfma_f32_16x16x32_bf16 v[120:123], a[152:155], v[28:31], v[120:123]
ds_read_b128 v[24:27], v7 offset:18432
s_add_u32 s37, s50, 0
v_mfma_f32_16x16x32_bf16 v[124:127], a[156:159], v[28:31], v[124:127]
s_add_u32 s38, s50, 8192
v_mul_f32 v96, v96, v72
v_mul_f32 v97, v97, v73
v_mul_f32 v98, v98, v74
v_mfma_f32_16x16x32_bf16 v[112:115], a[160:163], v[32:35], v[112:115]
ds_read_b128 v[28:31], v7 offset:19456
v_mul_f32 v99, v99, v75
v_mfma_f32_16x16x32_bf16 v[116:119], a[164:167], v[32:35], v[116:119]
v_mul_f32 v100, v100, v76
v_mul_f32 v101, v101, v77
s_waitcnt lgkmcnt(5)
v_mfma_f32_16x16x32_bf16 v[120:123], a[160:163], v[36:39], v[120:123]
ds_read_b128 v[32:35], v7 offset:20480
v_mul_f32 v102, v102, v78
v_mfma_f32_16x16x32_bf16 v[124:127], a[164:167], v[36:39], v[124:127]
v_mul_f32 v103, v103, v79
v_cvt_pk_bf16_f32 v216, v96, v97
v_mfma_f32_16x16x32_bf16 v[112:115], a[168:171], v[40:43], v[112:115]
ds_read_b128 v[36:39], v7 offset:21504
v_cvt_pk_bf16_f32 v217, v98, v99
v_mfma_f32_16x16x32_bf16 v[116:119], a[172:175], v[40:43], v[116:119]
v_cvt_pk_bf16_f32 v218, v100, v101
v_cvt_pk_bf16_f32 v219, v102, v103
v_mfma_f32_16x16x32_bf16 v[120:123], a[168:171], v[44:47], v[120:123]
ds_read_b128 v[40:43], v7 offset:22528
global_load_lds_dwordx4 v4, s[20:21] offset:1024 sc1
ds_write_b128 v247, v[216:219] offset:2048
v_mfma_f32_16x16x32_bf16 v[124:127], a[172:175], v[44:47], v[124:127]
v_mul_f32 v104, v104, v72
v_mul_f32 v105, v105, v73
v_mfma_f32_16x16x32_bf16 v[112:115], a[176:179], v[16:19], v[112:115]
ds_read_b128 v[44:47], v7 offset:23552
v_mul_f32 v106, v106, v74
v_mfma_f32_16x16x32_bf16 v[116:119], a[180:183], v[16:19], v[116:119]
v_mul_f32 v107, v107, v75
v_mul_f32 v108, v108, v76
s_waitcnt lgkmcnt(4)
v_mfma_f32_16x16x32_bf16 v[120:123], a[176:179], v[20:23], v[120:123]
ds_read_b128 v[16:19], v7 offset:24576
global_load_lds_dwordx4 v4, s[20:21] offset:2048 sc1
v_mfma_f32_16x16x32_bf16 v[124:127], a[180:183], v[20:23], v[124:127]
v_mul_f32 v109, v109, v77
v_mul_f32 v110, v110, v78
v_mul_f32 v111, v111, v79
v_mfma_f32_16x16x32_bf16 v[112:115], a[184:187], v[24:27], v[112:115]
ds_read_b128 v[20:23], v7 offset:25600
v_cvt_pk_bf16_f32 v220, v104, v105
v_mfma_f32_16x16x32_bf16 v[116:119], a[188:191], v[24:27], v[116:119]
v_cvt_pk_bf16_f32 v221, v106, v107
v_cvt_pk_bf16_f32 v222, v108, v109
v_mfma_f32_16x16x32_bf16 v[120:123], a[184:187], v[28:31], v[120:123]
ds_read_b128 v[24:27], v7 offset:26624
global_load_lds_dwordx4 v4, s[20:21] offset:3072 sc1
v_mfma_f32_16x16x32_bf16 v[124:127], a[188:191], v[28:31], v[124:127]
v_cvt_pk_bf16_f32 v223, v110, v111
v_mfma_f32_16x16x32_bf16 v[112:115], a[192:195], v[32:35], v[112:115]
ds_write_b128 v247, v[220:223] offset:3072
v_mfma_f32_16x16x32_bf16 v[116:119], a[196:199], v[32:35], v[116:119]
ds_read_b128 v[28:31], v7 offset:27648
buffer_store_dwordx4 v[172:175], v0, s[20:23], s87 offen sc1
s_waitcnt lgkmcnt(4)
v_mfma_f32_16x16x32_bf16 v[120:123], a[192:195], v[36:39], v[120:123]
ds_read_b128 v[32:35], v7 offset:28672
v_mfma_f32_16x16x32_bf16 v[124:127], a[196:199], v[36:39], v[124:127]
v_mfma_f32_16x16x32_bf16 v[112:115], a[200:203], v[40:43], v[112:115]
ds_read_b128 v[36:39], v7 offset:29696
v_mfma_f32_16x16x32_bf16 v[116:119], a[204:207], v[40:43], v[116:119]
v_mfma_f32_16x16x32_bf16 v[120:123], a[200:203], v[44:47], v[120:123]
ds_read_b128 v[40:43], v7 offset:30720
v_mfma_f32_16x16x32_bf16 v[124:127], a[204:207], v[44:47], v[124:127]
s_waitcnt lgkmcnt(4)
s_barrier
ds_read_b128 v[80:83], v248 offset:0
ds_read_b128 v[96:99], v249 offset:0
v_mfma_f32_16x16x32_bf16 v[112:115], a[208:211], v[16:19], v[112:115]
ds_read_b128 v[44:47], v7 offset:31744
ds_read_b128 v[84:87], v248 offset:4096
ds_read_b128 v[100:103], v249 offset:4096
v_mfma_f32_16x16x32_bf16 v[116:119], a[212:215], v[16:19], v[116:119]
v_mfma_f32_16x16x32_bf16 v[120:123], a[208:211], v[20:23], v[120:123]
s_waitcnt vmcnt(11)
s_barrier
ds_read_b128 v[16:19], v7 offset:32768
ds_read_b128 v[88:91], v248 offset:8192
ds_read_b128 v[104:107], v249 offset:8192
v_mfma_f32_16x16x32_bf16 v[124:127], a[212:215], v[20:23], v[124:127]
v_mfma_f32_16x16x32_bf16 v[112:115], a[216:219], v[24:27], v[112:115]
ds_read_b128 v[20:23], v7 offset:33792
ds_read_b128 v[92:95], v248 offset:12288
ds_read_b128 v[108:111], v249 offset:12288
v_mfma_f32_16x16x32_bf16 v[116:119], a[220:223], v[24:27], v[116:119]
s_add_u32 m0, s43, 16384
s_waitcnt lgkmcnt(11)
v_mfma_f32_16x16x32_bf16 v[120:123], a[216:219], v[28:31], v[120:123]
ds_read_b128 v[24:27], v7 offset:34816
v_add_u32 v4, 16384, v4
v_mfma_f32_16x16x32_bf16 v[124:127], a[220:223], v[28:31], v[124:127]
global_load_lds_dwordx4 v4, s[20:21] offset:0 sc1
v_mfma_f32_16x16x32_bf16 v[112:115], a[224:227], v[32:35], v[112:115]
ds_read_b128 v[28:31], v7 offset:35840
global_load_lds_dwordx4 v4, s[20:21] offset:1024 sc1
v_mfma_f32_16x16x32_bf16 v[116:119], a[228:231], v[32:35], v[116:119]
v_mfma_f32_16x16x32_bf16 v[120:123], a[224:227], v[36:39], v[120:123]
ds_read_b128 v[32:35], v7 offset:36864
v_mfma_f32_16x16x32_bf16 v[124:127], a[228:231], v[36:39], v[124:127]
v_mfma_f32_16x16x32_bf16 v[112:115], a[232:235], v[40:43], v[112:115]
ds_read_b128 v[36:39], v7 offset:37888
v_mfma_f32_16x16x32_bf16 v[116:119], a[236:239], v[40:43], v[116:119]
buffer_store_dwordx4 v[176:179], v0, s[20:23], s88 offen sc1
s_waitcnt lgkmcnt(3)
v_mfma_f32_16x16x32_bf16 v[120:123], a[232:235], v[44:47], v[120:123]
ds_read_b128 v[40:43], v7 offset:38912
v_mfma_f32_16x16x32_bf16 v[124:127], a[236:239], v[44:47], v[124:127]
v_mfma_f32_16x16x32_bf16 v[232:235], v[96:99], v[80:83], 0
v_mfma_f32_16x16x32_bf16 v[236:239], v[240:243], v[80:83], 0
v_mfma_f32_16x16x32_bf16 v[112:115], a[240:243], v[16:19], v[112:115]
ds_read_b128 v[44:47], v7 offset:39936
v_mfma_f32_16x16x32_bf16 v[116:119], a[244:247], v[16:19], v[116:119]
v_mfma_f32_16x16x32_bf16 v[232:235], v[100:103], v[84:87], v[232:235]
v_mfma_f32_16x16x32_bf16 v[236:239], v[240:243], v[84:87], v[236:239]
v_mfma_f32_16x16x32_bf16 v[120:123], a[240:243], v[20:23], v[120:123]
ds_read_b128 v[16:19], v7 offset:40960
v_mfma_f32_16x16x32_bf16 v[124:127], a[244:247], v[20:23], v[124:127]
v_mfma_f32_16x16x32_bf16 v[232:235], v[104:107], v[88:91], v[232:235]
v_mfma_f32_16x16x32_bf16 v[112:115], a[248:251], v[24:27], v[112:115]
ds_read_b128 v[20:23], v7 offset:41984
global_load_lds_dwordx4 v4, s[20:21] offset:2048 sc1
v_mfma_f32_16x16x32_bf16 v[116:119], a[252:255], v[24:27], v[116:119]
v_mfma_f32_16x16x32_bf16 v[236:239], v[240:243], v[88:91], v[236:239]
v_mfma_f32_16x16x32_bf16 v[232:235], v[108:111], v[92:95], v[232:235]
s_waitcnt lgkmcnt(3)
v_mfma_f32_16x16x32_bf16 v[120:123], a[248:251], v[28:31], v[120:123]
ds_read_b128 v[24:27], v7 offset:43008
v_mfma_f32_16x16x32_bf16 v[124:127], a[252:255], v[28:31], v[124:127]
v_mfma_f32_16x16x32_bf16 v[236:239], v[240:243], v[92:95], v[236:239]
v_mfma_f32_16x16x32_bf16 v[128:131], a[144:147], v[32:35], v[128:131]
ds_read_b128 v[28:31], v7 offset:44032
global_load_lds_dwordx4 v4, s[20:21] offset:3072 sc1
v_mfma_f32_16x16x32_bf16 v[132:135], a[148:151], v[32:35], v[132:135]
v_mfma_f32_16x16x32_bf16 v[136:139], a[144:147], v[36:39], v[136:139]
ds_read_b128 v[32:35], v7 offset:45056
v_mfma_f32_16x16x32_bf16 v[140:143], a[148:151], v[36:39], v[140:143]
v_mfma_f32_16x16x32_bf16 v[128:131], a[152:155], v[40:43], v[128:131]
ds_read_b128 v[36:39], v7 offset:46080
buffer_atomic_add_f32 v232, v250, s[20:23], s37 offen offset:0 sc1
buffer_atomic_add_f32 v233, v250, s[20:23], s37 offen offset:64 sc1
v_mfma_f32_16x16x32_bf16 v[132:135], a[156:159], v[40:43], v[132:135]
s_add_u32 m0, s43, 32768
s_waitcnt vmcnt(13) lgkmcnt(3)
v_mfma_f32_16x16x32_bf16 v[136:139], a[152:155], v[44:47], v[136:139]
ds_read_b128 v[40:43], v7 offset:47104
buffer_atomic_add_f32 v234, v250, s[20:23], s37 offen offset:128 sc1
buffer_atomic_add_f32 v235, v250, s[20:23], s37 offen offset:192 sc1
v_mfma_f32_16x16x32_bf16 v[140:143], a[156:159], v[44:47], v[140:143]
buffer_atomic_add_f32 v236, v251, s[20:23], s38 offen sc1
s_mov_b32 s59, 0
v_mfma_f32_16x16x32_bf16 v[128:131], a[160:163], v[16:19], v[128:131]
ds_read_b128 v[44:47], v7 offset:48128
v_add_u32 v4, 16384, v4
v_mfma_f32_16x16x32_bf16 v[132:135], a[164:167], v[16:19], v[132:135]
global_load_lds_dwordx4 v4, s[20:21] offset:0 sc1
buffer_store_dwordx4 v[180:183], v0, s[20:23], s89 offen sc1
v_mfma_f32_16x16x32_bf16 v[136:139], a[160:163], v[20:23], v[136:139]
s_barrier
ds_read_b128 v[16:19], v7 offset:49152
v_mfma_f32_16x16x32_bf16 v[140:143], a[164:167], v[20:23], v[140:143]
v_mul_f32 v112, v112, v72
v_mul_f32 v113, v113, v73
v_mfma_f32_16x16x32_bf16 v[128:131], a[168:171], v[24:27], v[128:131]
v_exp_f32 v208, v112 clamp
v_mfma_f32_16x16x32_bf16 v[132:135], a[172:175], v[24:27], v[132:135]
ds_read_b128 v[20:23], v7 offset:50176
v_mul_f32 v114, v114, v74
s_waitcnt lgkmcnt(3)
v_mfma_f32_16x16x32_bf16 v[136:139], a[168:171], v[28:31], v[136:139]
ds_read_b128 v[24:27], v7 offset:51200
v_max_f32 v112, s62, v112
v_mfma_f32_16x16x32_bf16 v[140:143], a[172:175], v[28:31], v[140:143]
v_exp_f32 v209, v113 clamp
v_mfma_f32_16x16x32_bf16 v[128:131], a[176:179], v[32:35], v[128:131]
ds_read_b128 v[28:31], v7 offset:52224
v_mul_f32 v115, v115, v75
v_mfma_f32_16x16x32_bf16 v[132:135], a[180:183], v[32:35], v[132:135]
v_exp_f32 v210, v114 clamp
v_mfma_f32_16x16x32_bf16 v[136:139], a[176:179], v[36:39], v[136:139]
ds_read_b128 v[32:35], v7 offset:53248
v_max_f32 v113, s62, v113
v_mfma_f32_16x16x32_bf16 v[140:143], a[180:183], v[36:39], v[140:143]
v_exp_f32 v211, v115 clamp
v_mfma_f32_16x16x32_bf16 v[128:131], a[184:187], v[40:43], v[128:131]
ds_read_b128 v[36:39], v7 offset:54272
v_fma_f32 v112, v112, s63, v208
v_mfma_f32_16x16x32_bf16 v[132:135], a[188:191], v[40:43], v[132:135]
v_mul_f32 v116, v116, v76
v_max_f32 v114, s62, v114
s_waitcnt lgkmcnt(3)
v_mfma_f32_16x16x32_bf16 v[136:139], a[184:187], v[44:47], v[136:139]
ds_read_b128 v[40:43], v7 offset:55296
global_load_lds_dwordx4 v4, s[20:21] offset:1024 sc1
v_mfma_f32_16x16x32_bf16 v[140:143], a[188:191], v[44:47], v[140:143]
v_exp_f32 v208, v116 clamp
v_fma_f32 v113, v113, s63, v209
v_mul_f32 v117, v117, v77
v_mfma_f32_16x16x32_bf16 v[128:131], a[192:195], v[16:19], v[128:131]
ds_read_b128 v[44:47], v7 offset:56320
v_max_f32 v115, s62, v115
v_mfma_f32_16x16x32_bf16 v[132:135], a[196:199], v[16:19], v[132:135]
v_exp_f32 v209, v117 clamp
v_mfma_f32_16x16x32_bf16 v[136:139], a[192:195], v[20:23], v[136:139]
ds_read_b128 v[16:19], v7 offset:57344
global_load_lds_dwordx4 v4, s[20:21] offset:2048 sc1
v_mfma_f32_16x16x32_bf16 v[140:143], a[196:199], v[20:23], v[140:143]
v_fma_f32 v114, v114, s63, v210
v_cvt_pk_bf16_f32 v216, v112, v113
v_mul_f32 v118, v118, v78
v_mfma_f32_16x16x32_bf16 v[128:131], a[200:203], v[24:27], v[128:131]
ds_read_b128 v[20:23], v7 offset:58368
v_max_f32 v116, s62, v116
v_mfma_f32_16x16x32_bf16 v[132:135], a[204:207], v[24:27], v[132:135]
buffer_store_dwordx4 v[184:187], v0, s[20:23], s90 offen sc1
s_waitcnt lgkmcnt(3)
v_mfma_f32_16x16x32_bf16 v[136:139], a[200:203], v[28:31], v[136:139]
ds_read_b128 v[24:27], v7 offset:59392
v_fma_f32 v115, v115, s63, v211
v_mfma_f32_16x16x32_bf16 v[140:143], a[204:207], v[28:31], v[140:143]
v_exp_f32 v210, v118 clamp
v_mfma_f32_16x16x32_bf16 v[128:131], a[208:211], v[32:35], v[128:131]
ds_read_b128 v[28:31], v7 offset:60416
v_mul_f32 v119, v119, v79
v_mfma_f32_16x16x32_bf16 v[132:135], a[212:215], v[32:35], v[132:135]
v_max_f32 v117, s62, v117
v_fma_f32 v116, v116, s63, v208
v_cvt_pk_bf16_f32 v217, v114, v115
v_mfma_f32_16x16x32_bf16 v[136:139], a[208:211], v[36:39], v[136:139]
ds_read_b128 v[32:35], v7 offset:61440
v_mul_f32 v120, v120, v72
v_mfma_f32_16x16x32_bf16 v[140:143], a[212:215], v[36:39], v[140:143]
v_exp_f32 v211, v119 clamp
v_mfma_f32_16x16x32_bf16 v[128:131], a[216:219], v[40:43], v[128:131]
ds_read_b128 v[36:39], v7 offset:62464
v_max_f32 v118, s62, v118
v_mfma_f32_16x16x32_bf16 v[132:135], a[220:223], v[40:43], v[132:135]
v_fma_f32 v117, v117, s63, v209
v_mul_f32 v121, v121, v73
s_waitcnt lgkmcnt(3)
v_mfma_f32_16x16x32_bf16 v[136:139], a[216:219], v[44:47], v[136:139]
ds_read_b128 v[40:43], v7 offset:63488
global_load_lds_dwordx4 v4, s[20:21] offset:3072 sc1
v_mfma_f32_16x16x32_bf16 v[140:143], a[220:223], v[44:47], v[140:143]
v_exp_f32 v208, v120 clamp
v_max_f32 v119, s62, v119
v_mfma_f32_16x16x32_bf16 v[128:131], a[224:227], v[16:19], v[128:131]
ds_read_b128 v[44:47], v7 offset:64512
v_fma_f32 v118, v118, s63, v210
v_mfma_f32_16x16x32_bf16 v[132:135], a[228:231], v[16:19], v[132:135]
v_exp_f32 v209, v121 clamp
v_mfma_f32_16x16x32_bf16 v[136:139], a[224:227], v[20:23], v[136:139]
ds_read_b128 v[16:19], v8 offset:2048
s_add_u32 m0, s43, 49152
v_mfma_f32_16x16x32_bf16 v[140:143], a[228:231], v[20:23], v[140:143]
v_add_u32 v4, 16384, v4
v_cvt_pk_bf16_f32 v218, v116, v117
v_mul_f32 v122, v122, v74
v_max_f32 v120, s62, v120
v_fma_f32 v119, v119, s63, v211
v_mfma_f32_16x16x32_bf16 v[128:131], a[232:235], v[24:27], v[128:131]
ds_read_b128 v[20:23], v8 offset:2304
global_load_lds_dwordx4 v4, s[20:21] offset:0 sc1
v_mfma_f32_16x16x32_bf16 v[132:135], a[236:239], v[24:27], v[132:135]
v_mul_f32 v123, v123, v75
v_exp_f32 v210, v122 clamp
s_waitcnt vmcnt(18) lgkmcnt(3)
v_mfma_f32_16x16x32_bf16 v[136:139], a[232:235], v[28:31], v[136:139]
ds_read_b128 v[24:27], v8 offset:2560
global_load_lds_dwordx4 v4, s[20:21] offset:1024 sc1
v_mfma_f32_16x16x32_bf16 v[140:143], a[236:239], v[28:31], v[140:143]
v_max_f32 v121, s62, v121
v_fma_f32 v120, v120, s63, v208
v_cvt_pk_bf16_f32 v219, v118, v119
v_mfma_f32_16x16x32_bf16 v[128:131], a[240:243], v[32:35], v[128:131]
ds_read_b128 v[28:31], v8 offset:2816
v_mul_f32 v124, v124, v76
v_mfma_f32_16x16x32_bf16 v[132:135], a[244:247], v[32:35], v[132:135]
buffer_store_dwordx4 v[188:191], v0, s[20:23], s91 offen sc1
v_mfma_f32_16x16x32_bf16 v[136:139], a[240:243], v[36:39], v[136:139]
s_barrier
ds_read_b128 v[32:35], v6 offset:0
v_mfma_f32_16x16x32_bf16 v[140:143], a[244:247], v[36:39], v[140:143]
v_exp_f32 v211, v123 clamp
v_max_f32 v122, s62, v122
v_mfma_f32_16x16x32_bf16 v[128:131], a[248:251], v[40:43], v[128:131]
ds_read_b128 v[36:39], v6 offset:1024
v_fma_f32 v121, v121, s63, v209
v_mfma_f32_16x16x32_bf16 v[132:135], a[252:255], v[40:43], v[132:135]
v_mul_f32 v125, v125, v77
v_exp_f32 v208, v124 clamp
s_waitcnt lgkmcnt(3)
v_mfma_f32_16x16x32_bf16 v[136:139], a[248:251], v[44:47], v[136:139]
ds_read_b128 v[40:43], v6 offset:2048
v_max_f32 v123, s62, v123
v_mfma_f32_16x16x32_bf16 v[140:143], a[252:255], v[44:47], v[140:143]
v_exp_f32 v209, v125 clamp
v_mfma_f32_16x16x32_bf16 v[144:147], v[16:19], v[64:67], 0
ds_read_b128 v[44:47], v6 offset:3072
v_fma_f32 v122, v122, s63, v210
v_mfma_f32_16x16x32_bf16 v[152:155], v[16:19], v[68:71], 0
v_cvt_pk_bf16_f32 v220, v120, v121
v_mul_f32 v126, v126, v78
v_max_f32 v124, s62, v124
v_fma_f32 v123, v123, s63, v211
v_mfma_f32_16x16x32_bf16 v[148:151], v[20:23], v[64:67], 0
ds_read_b128 v[16:19], v6 offset:4096
global_load_lds_dwordx4 v4, s[20:21] offset:2048 sc1
v_mfma_f32_16x16x32_bf16 v[156:159], v[20:23], v[68:71], 0
v_exp_f32 v210, v126 clamp
v_mul_f32 v127, v127, v79
v_max_f32 v125, s62, v125
v_fma_f32 v124, v124, s63, v208
v_mfma_f32_16x16x32_bf16 v[160:163], v[24:27], v[64:67], 0
s_waitcnt vmcnt(10)
s_atomic_add s45, s[20:21], s56 offset:0
v_mfma_f32_16x16x32_bf16 v[168:171], v[24:27], v[68:71], 0
ds_read_b128 v[20:23], v6 offset:5120
v_cvt_pk_bf16_f32 v221, v122, v123
v_exp_f32 v211, v127 clamp
s_waitcnt lgkmcnt(4)
v_mfma_f32_16x16x32_bf16 v[164:167], v[28:31], v[64:67], 0
ds_read_b128 v[24:27], v6 offset:6144
global_load_lds_dwordx4 v4, s[20:21] offset:3072 sc1
v_mfma_f32_16x16x32_bf16 v[172:175], v[28:31], v[68:71], 0
v_max_f32 v126, s62, v126
v_fma_f32 v125, v125, s63, v209
v_max_f32 v127, s62, v127
v_fma_f32 v126, v126, s63, v210
v_cvt_pk_bf16_f32 v222, v124, v125
v_mfma_f32_16x16x32_bf16 v[144:147], v[32:35], a[0:3], v[144:147]
ds_read_b128 v[28:31], v6 offset:7168
v_fma_f32 v127, v127, s63, v211
v_mfma_f32_16x16x32_bf16 v[152:155], v[32:35], a[4:7], v[152:155]
v_cvt_pk_bf16_f32 v223, v126, v127
s_barrier
v_mfma_f32_16x16x32_bf16 v[148:151], v[36:39], a[0:3], v[148:151]
ds_read_b128 v[32:35], v6 offset:8192
ds_write_b128 v247, v[216:219] offset:0
v_mfma_f32_16x16x32_bf16 v[156:159], v[36:39], a[4:7], v[156:159]
s_add_u32 m0, s43, 65536
s_waitcnt lgkmcnt(5)
v_mfma_f32_16x16x32_bf16 v[144:147], v[40:43], a[8:11], v[144:147]
ds_read_b128 v[36:39], v6 offset:9216
v_add_u32 v4, 16384, v4
v_mfma_f32_16x16x32_bf16 v[152:155], v[40:43], a[12:15], v[152:155]
global_load_lds_dwordx4 v4, s[20:21] offset:0 sc1
buffer_store_dwordx4 v[192:195], v0, s[20:23], s92 offen sc1
v_mfma_f32_16x16x32_bf16 v[148:151], v[44:47], a[8:11], v[148:151]
ds_read_b128 v[40:43], v6 offset:10240
ds_write_b128 v247, v[220:223] offset:1024
v_mfma_f32_16x16x32_bf16 v[156:159], v[44:47], a[12:15], v[156:159]
v_mfma_f32_16x16x32_bf16 v[144:147], v[16:19], a[16:19], v[144:147]
ds_read_b128 v[44:47], v6 offset:11264
v_mfma_f32_16x16x32_bf16 v[152:155], v[16:19], a[20:23], v[152:155]
s_waitcnt lgkmcnt(6)
v_mfma_f32_16x16x32_bf16 v[148:151], v[20:23], a[16:19], v[148:151]
ds_read_b128 v[16:19], v6 offset:12288
s_add_u32 s37, s50, 4096
v_mfma_f32_16x16x32_bf16 v[156:159], v[20:23], a[20:23], v[156:159]
s_add_u32 s38, s50, 8320
v_mul_f32 v128, v128, v72
v_mul_f32 v129, v129, v73
v_mul_f32 v130, v130, v74
v_mul_f32 v131, v131, v75
v_mul_f32 v132, v132, v76
v_mfma_f32_16x16x32_bf16 v[144:147], v[24:27], a[24:27], v[144:147]
ds_read_b128 v[20:23], v6 offset:13312
v_mul_f32 v133, v133, v77
v_mfma_f32_16x16x32_bf16 v[152:155], v[24:27], a[28:31], v[152:155]
v_mul_f32 v134, v134, v78
v_mul_f32 v135, v135, v79
v_cvt_pk_bf16_f32 v216, v128, v129
v_cvt_pk_bf16_f32 v217, v130, v131
v_mfma_f32_16x16x32_bf16 v[148:151], v[28:31], a[24:27], v[148:151]
ds_read_b128 v[24:27], v6 offset:14336
global_load_lds_dwordx4 v4, s[20:21] offset:1024 sc1
v_mfma_f32_16x16x32_bf16 v[156:159], v[28:31], a[28:31], v[156:159]
v_cvt_pk_bf16_f32 v218, v132, v133
v_cvt_pk_bf16_f32 v219, v134, v135
s_waitcnt lgkmcnt(5)
v_mfma_f32_16x16x32_bf16 v[144:147], v[32:35], a[32:35], v[144:147]
ds_read_b128 v[28:31], v6 offset:15360
ds_write_b128 v247, v[216:219] offset:2048
v_mfma_f32_16x16x32_bf16 v[152:155], v[32:35], a[36:39], v[152:155]
v_mul_f32 v136, v136, v72
v_mul_f32 v137, v137, v73
v_mul_f32 v138, v138, v74
v_mul_f32 v139, v139, v75
v_mul_f32 v140, v140, v76
v_mfma_f32_16x16x32_bf16 v[148:151], v[36:39], a[32:35], v[148:151]
s_barrier
ds_read_b128 v[32:35], v6 offset:16384
v_mfma_f32_16x16x32_bf16 v[156:159], v[36:39], a[36:39], v[156:159]
global_load_lds_dwordx4 v4, s[20:21] offset:2048 sc1
v_mul_f32 v141, v141, v77
v_mul_f32 v142, v142, v78
v_mul_f32 v143, v143, v79
v_cvt_pk_bf16_f32 v220, v136, v137
v_cvt_pk_bf16_f32 v221, v138, v139
v_mfma_f32_16x16x32_bf16 v[144:147], v[40:43], a[40:43], v[144:147]
ds_read_b128 v[36:39], v6 offset:17408
global_load_lds_dwordx4 v4, s[20:21] offset:3072 sc1
v_mfma_f32_16x16x32_bf16 v[152:155], v[40:43], a[44:47], v[152:155]
v_cvt_pk_bf16_f32 v222, v140, v141
v_cvt_pk_bf16_f32 v223, v142, v143
s_waitcnt lgkmcnt(5)
v_mfma_f32_16x16x32_bf16 v[148:151], v[44:47], a[40:43], v[148:151]
ds_read_b128 v[40:43], v6 offset:18432
ds_write_b128 v247, v[220:223] offset:3072
v_mfma_f32_16x16x32_bf16 v[156:159], v[44:47], a[44:47], v[156:159]
v_mfma_f32_16x16x32_bf16 v[144:147], v[16:19], a[48:51], v[144:147]
ds_read_b128 v[44:47], v6 offset:19456
s_add_u32 m0, s43, 81920
v_mfma_f32_16x16x32_bf16 v[152:155], v[16:19], a[52:55], v[152:155]
buffer_store_dwordx4 v[196:199], v0, s[20:23], s93 offen sc1
v_mfma_f32_16x16x32_bf16 v[148:151], v[20:23], a[48:51], v[148:151]
ds_read_b128 v[16:19], v6 offset:20480
v_add_u32 v4, 16384, v4
v_mfma_f32_16x16x32_bf16 v[156:159], v[20:23], a[52:55], v[156:159]
global_load_lds_dwordx4 v4, s[20:21] offset:0 sc1
s_atomic_add s59, s[20:21], s56 offset:0 glc
s_waitcnt lgkmcnt(2)
s_barrier
ds_read_b128 v[112:115], v248 offset:0
ds_read_b128 v[128:131], v249 offset:0
v_mfma_f32_16x16x32_bf16 v[144:147], v[24:27], a[56:59], v[144:147]
ds_read_b128 v[20:23], v6 offset:21504
ds_read_b128 v[116:119], v248 offset:4096
ds_read_b128 v[132:135], v249 offset:4096
v_mfma_f32_16x16x32_bf16 v[152:155], v[24:27], a[60:63], v[152:155]
v_mfma_f32_16x16x32_bf16 v[148:151], v[28:31], a[56:59], v[148:151]
ds_read_b128 v[24:27], v6 offset:22528
ds_read_b128 v[120:123], v248 offset:8192
ds_read_b128 v[136:139], v249 offset:8192
v_mfma_f32_16x16x32_bf16 v[156:159], v[28:31], a[60:63], v[156:159]
v_mfma_f32_16x16x32_bf16 v[144:147], v[32:35], a[64:67], v[144:147]
ds_read_b128 v[28:31], v6 offset:23552
ds_read_b128 v[124:127], v248 offset:12288
ds_read_b128 v[140:143], v249 offset:12288
v_mfma_f32_16x16x32_bf16 v[152:155], v[32:35], a[68:71], v[152:155]
v_mfma_f32_16x16x32_bf16 v[148:151], v[36:39], a[64:67], v[148:151]
ds_read_b128 v[32:35], v6 offset:24576
v_mfma_f32_16x16x32_bf16 v[156:159], v[36:39], a[68:71], v[156:159]
v_mfma_f32_16x16x32_bf16 v[144:147], v[40:43], a[72:75], v[144:147]
ds_read_b128 v[36:39], v6 offset:25600
global_load_lds_dwordx4 v4, s[20:21] offset:1024 sc1
v_mfma_f32_16x16x32_bf16 v[152:155], v[40:43], a[76:79], v[152:155]
s_waitcnt lgkmcnt(10)
v_mfma_f32_16x16x32_bf16 v[148:151], v[44:47], a[72:75], v[148:151]
ds_read_b128 v[40:43], v6 offset:26624
v_mfma_f32_16x16x32_bf16 v[156:159], v[44:47], a[76:79], v[156:159]
v_mfma_f32_16x16x32_bf16 v[144:147], v[16:19], a[80:83], v[144:147]
ds_read_b128 v[44:47], v6 offset:27648
global_load_lds_dwordx4 v4, s[20:21] offset:2048 sc1
v_mfma_f32_16x16x32_bf16 v[152:155], v[16:19], a[84:87], v[152:155]
v_mfma_f32_16x16x32_bf16 v[148:151], v[20:23], a[80:83], v[148:151]
v_mfma_f32_16x16x32_bf16 v[232:235], v[128:131], v[112:115], 0
v_mfma_f32_16x16x32_bf16 v[156:159], v[20:23], a[84:87], v[156:159]
ds_read_b128 v[16:19], v6 offset:28672
v_mfma_f32_16x16x32_bf16 v[236:239], v[240:243], v[112:115], 0
s_waitcnt lgkmcnt(11)
v_mfma_f32_16x16x32_bf16 v[232:235], v[132:135], v[116:119], v[232:235]
s_waitcnt lgkmcnt(4)
v_mfma_f32_16x16x32_bf16 v[144:147], v[24:27], a[88:91], v[144:147]
ds_read_b128 v[20:23], v6 offset:29696
global_load_lds_dwordx4 v4, s[20:21] offset:3072 sc1
v_mfma_f32_16x16x32_bf16 v[152:155], v[24:27], a[92:95], v[152:155]
buffer_store_dwordx4 v[200:203], v0, s[20:23], s94 offen sc1
v_mfma_f32_16x16x32_bf16 v[236:239], v[240:243], v[116:119], v[236:239]
v_mfma_f32_16x16x32_bf16 v[232:235], v[136:139], v[120:123], v[232:235]
v_mfma_f32_16x16x32_bf16 v[148:151], v[28:31], a[88:91], v[148:151]
ds_read_b128 v[24:27], v6 offset:30720
v_mfma_f32_16x16x32_bf16 v[156:159], v[28:31], a[92:95], v[156:159]
v_mfma_f32_16x16x32_bf16 v[236:239], v[240:243], v[120:123], v[236:239]
v_mfma_f32_16x16x32_bf16 v[232:235], v[140:143], v[124:127], v[232:235]
v_mfma_f32_16x16x32_bf16 v[144:147], v[32:35], a[96:99], v[144:147]
v_mfma_f32_16x16x32_bf16 v[236:239], v[240:243], v[124:127], v[236:239]
v_mfma_f32_16x16x32_bf16 v[152:155], v[32:35], a[100:103], v[152:155]
ds_read_b128 v[28:31], v6 offset:31744
s_waitcnt vmcnt(16) lgkmcnt(4)
v_mfma_f32_16x16x32_bf16 v[148:151], v[36:39], a[96:99], v[148:151]
s_barrier
ds_read_b128 v[32:35], v6 offset:32768
v_mfma_f32_16x16x32_bf16 v[156:159], v[36:39], a[100:103], v[156:159]
v_mfma_f32_16x16x32_bf16 v[144:147], v[40:43], a[104:107], v[144:147]
ds_read_b128 v[36:39], v6 offset:33792
s_add_u32 m0, s43, 98304
v_mfma_f32_16x16x32_bf16 v[152:155], v[40:43], a[108:111], v[152:155]
v_add_u32 v4, 16384, v4
v_mfma_f32_16x16x32_bf16 v[148:151], v[44:47], a[104:107], v[148:151]
ds_read_b128 v[40:43], v6 offset:34816
global_load_lds_dwordx4 v4, s[20:21] offset:0 sc1
v_mfma_f32_16x16x32_bf16 v[156:159], v[44:47], a[108:111], v[156:159]
s_waitcnt lgkmcnt(4)
v_mfma_f32_16x16x32_bf16 v[144:147], v[16:19], a[112:115], v[144:147]
ds_read_b128 v[44:47], v6 offset:35840
global_load_lds_dwordx4 v4, s[20:21] offset:1024 sc1
v_mfma_f32_16x16x32_bf16 v[152:155], v[16:19], a[116:119], v[152:155]
v_mfma_f32_16x16x32_bf16 v[148:151], v[20:23], a[112:115], v[148:151]
ds_read_b128 v[16:19], v6 offset:36864
v_mfma_f32_16x16x32_bf16 v[156:159], v[20:23], a[116:119], v[156:159]
v_mfma_f32_16x16x32_bf16 v[144:147], v[24:27], a[120:123], v[144:147]
ds_read_b128 v[20:23], v6 offset:37888
v_mfma_f32_16x16x32_bf16 v[152:155], v[24:27], a[124:127], v[152:155]
s_waitcnt lgkmcnt(4)
v_mfma_f32_16x16x32_bf16 v[148:151], v[28:31], a[120:123], v[148:151]
ds_read_b128 v[24:27], v6 offset:38912
global_load_lds_dwordx4 v4, s[20:21] offset:2048 sc1
v_mfma_f32_16x16x32_bf16 v[156:159], v[28:31], a[124:127], v[156:159]
v_mfma_f32_16x16x32_bf16 v[144:147], v[32:35], a[128:131], v[144:147]
ds_read_b128 v[28:31], v6 offset:39936
v_mfma_f32_16x16x32_bf16 v[152:155], v[32:35], a[132:135], v[152:155]
buffer_store_dwordx4 v[204:207], v0, s[20:23], s95 offen sc1
buffer_atomic_add_f32 v232, v250, s[20:23], s37 offen offset:0 sc1
s_cmp_lt_u32 s59, 16
s_cbranch_scc0 L_back0
L_slow0:
s_waitcnt lgkmcnt(0)
s_cmp_ge_u32 s59, 16
s_cbranch_scc1 L_back0
s_mov_b32 s59, 0
s_atomic_add s59, s[20:21], s56 offset:0 glc
s_sub_u32 s46, s46, 1
s_cbranch_scc0 L_slow0
s_endpgm
L_back0:
s_barrier
buffer_load_dwordx4 v[80:83], v252, s[20:23], s41 offen offset:0 sc1
v_mfma_f32_16x16x32_bf16 v[148:151], v[36:39], a[128:131], v[148:151]
buffer_load_dwordx4 v[84:87], v252, s[20:23], s41 offen offset:1024 sc1
buffer_atomic_add_f32 v233, v250, s[20:23], s37 offen offset:64 sc1
buffer_load_dwordx4 v[88:91], v252, s[20:23], s41 offen offset:2048 sc1
v_mfma_f32_16x16x32_bf16 v[156:159], v[36:39], a[132:135], v[156:159]
ds_read_b128 v[32:35], v6 offset:40960
s_waitcnt lgkmcnt(3)
v_mfma_f32_16x16x32_bf16 v[144:147], v[40:43], a[136:139], v[144:147]
ds_read_b128 v[36:39], v6 offset:41984
buffer_atomic_add_f32 v234, v250, s[20:23], s37 offen offset:128 sc1
buffer_load_dwordx4 v[92:95], v252, s[20:23], s41 offen offset:3072 sc1
v_mfma_f32_16x16x32_bf16 v[152:155], v[40:43], a[140:143], v[152:155]
buffer_atomic_add_f32 v235, v250, s[20:23], s37 offen offset:192 sc1
buffer_load_dwordx4 v[96:99], v253, s[20:23], s42 offen offset:0 sc1
buffer_load_dwordx4 v[100:103], v253, s[20:23], s42 offen offset:64 sc1
s_add_u32 s41, s50, 4096
s_add_u32 s42, s50, 8320
v_mfma_f32_16x16x32_bf16 v[148:151], v[44:47], a[136:139], v[148:151]
ds_read_b128 v[40:43], v6 offset:43008
v_mfma_f32_16x16x32_bf16 v[156:159], v[44:47], a[140:143], v[156:159]
buffer_atomic_add_f32 v236, v251, s[20:23], s38 offen sc1
s_mov_b32 s59, 0
v_mfma_f32_16x16x32_bf16 v[144:147], v[16:19], a[144:147], v[144:147]
ds_read_b128 v[44:47], v6 offset:44032
s_add_u32 s37, s48, 3145728
v_mfma_f32_16x16x32_bf16 v[152:155], v[16:19], a[148:151], v[152:155]
s_add_u32 s38, s48, 3178496
v_mfma_f32_16x16x32_bf16 v[148:151], v[20:23], a[144:147], v[148:151]
ds_read_b128 v[16:19], v6 offset:45056
global_load_lds_dwordx4 v4, s[20:21] offset:3072 sc1
buffer_load_dwordx4 v[48:51], v0, s[20:23], s37 offen offset:0 sc1
v_mfma_f32_16x16x32_bf16 v[156:159], v[20:23], a[148:151], v[156:159]
s_waitcnt vmcnt(28) lgkmcnt(3)
v_mfma_f32_16x16x32_bf16 v[144:147], v[24:27], a[152:155], v[144:147]
ds_read_b128 v[20:23], v6 offset:46080
buffer_load_dwordx4 v[52:55], v0, s[20:23], s37 offen offset:1024 sc1
v_mfma_f32_16x16x32_bf16 v[152:155], v[24:27], a[156:159], v[152:155]
v_mfma_f32_16x16x32_bf16 v[148:151], v[28:31], a[152:155], v[148:151]
ds_read_b128 v[24:27], v6 offset:47104
v_mfma_f32_16x16x32_bf16 v[156:159], v[28:31], a[156:159], v[156:159]
v_mfma_f32_16x16x32_bf16 v[144:147], v[32:35], a[160:163], v[144:147]
ds_read_b128 v[28:31], v6 offset:48128
buffer_load_dwordx4 v[56:59], v0, s[20:23], s38 offen offset:0 sc1
v_mfma_f32_16x16x32_bf16 v[152:155], v[32:35], a[164:167], v[152:155]
v_mfma_f32_16x16x32_bf16 v[148:151], v[36:39], a[160:163], v[148:151]
s_barrier
ds_read_b128 v[32:35], v6 offset:49152
v_mfma_f32_16x16x32_bf16 v[156:159], v[36:39], a[164:167], v[156:159]
s_waitcnt lgkmcnt(3)
v_mfma_f32_16x16x32_bf16 v[144:147], v[40:43], a[168:171], v[144:147]
ds_read_b128 v[36:39], v6 offset:50176
buffer_load_dwordx4 v[60:63], v0, s[20:23], s38 offen offset:1024 sc1
v_mfma_f32_16x16x32_bf16 v[152:155], v[40:43], a[172:175], v[152:155]
v_mfma_f32_16x16x32_bf16 v[148:151], v[44:47], a[168:171], v[148:151]
ds_read_b128 v[40:43], v6 offset:51200
v_mfma_f32_16x16x32_bf16 v[156:159], v[44:47], a[172:175], v[156:159]
v_mfma_f32_16x16x32_bf16 v[144:147], v[16:19], a[176:179], v[144:147]
ds_read_b128 v[44:47], v6 offset:52224
v_mfma_f32_16x16x32_bf16 v[152:155], v[16:19], a[180:183], v[152:155]
v_mfma_f32_16x16x32_bf16 v[148:151], v[20:23], a[176:179], v[148:151]
ds_read_b128 v[16:19], v6 offset:53248
v_mfma_f32_16x16x32_bf16 v[156:159], v[20:23], a[180:183], v[156:159]
s_waitcnt lgkmcnt(3)
v_mfma_f32_16x16x32_bf16 v[144:147], v[24:27], a[184:187], v[144:147]
ds_read_b128 v[20:23], v6 offset:54272
v_mfma_f32_16x16x32_bf16 v[152:155], v[24:27], a[188:191], v[152:155]
v_mfma_f32_16x16x32_bf16 v[148:151], v[28:31], a[184:187], v[148:151]
ds_read_b128 v[24:27], v6 offset:55296
s_add_u32 m0, s43, 114688
v_mfma_f32_16x16x32_bf16 v[156:159], v[28:31], a[188:191], v[156:159]
v_add_u32 v4, 16384, v4
v_mfma_f32_16x16x32_bf16 v[144:147], v[32:35], a[192:195], v[144:147]
ds_read_b128 v[28:31], v6 offset:56320
global_load_lds_dwordx4 v4, s[20:21] offset:0 sc1
v_mfma_f32_16x16x32_bf16 v[152:155], v[32:35], a[196:199], v[152:155]
v_mfma_f32_16x16x32_bf16 v[148:151], v[36:39], a[192:195], v[148:151]
ds_read_b128 v[32:35], v6 offset:57344
global_load_lds_dwordx4 v4, s[20:21] offset:1024 sc1
v_mfma_f32_16x16x32_bf16 v[156:159], v[36:39], a[196:199], v[156:159]
s_waitcnt lgkmcnt(3)
v_mfma_f32_16x16x32_bf16 v[144:147], v[40:43], a[200:203], v[144:147]
ds_read_b128 v[36:39], v6 offset:58368
v_mfma_f32_16x16x32_bf16 v[152:155], v[40:43], a[204:207], v[152:155]
v_mfma_f32_16x16x32_bf16 v[148:151], v[44:47], a[200:203], v[148:151]
ds_read_b128 v[40:43], v6 offset:59392
v_mfma_f32_16x16x32_bf16 v[156:159], v[44:47], a[204:207], v[156:159]
v_mfma_f32_16x16x32_bf16 v[144:147], v[16:19], a[208:211], v[144:147]
ds_read_b128 v[44:47], v6 offset:60416
global_load_lds_dwordx4 v4, s[20:21] offset:2048 sc1
v_mfma_f32_16x16x32_bf16 v[152:155], v[16:19], a[212:215], v[152:155]
v_mfma_f32_16x16x32_bf16 v[148:151], v[20:23], a[208:211], v[148:151]
ds_read_b128 v[16:19], v6 offset:61440
v_mfma_f32_16x16x32_bf16 v[156:159], v[20:23], a[212:215], v[156:159]
s_waitcnt vmcnt(29) lgkmcnt(3)
v_mfma_f32_16x16x32_bf16 v[144:147], v[24:27], a[216:219], v[144:147]
ds_read_b128 v[20:23], v6 offset:62464
global_load_lds_dwordx4 v4, s[20:21] offset:3072 sc1
v_mfma_f32_16x16x32_bf16 v[152:155], v[24:27], a[220:223], v[152:155]
v_mfma_f32_16x16x32_bf16 v[148:151], v[28:31], a[216:219], v[148:151]
ds_read_b128 v[24:27], v6 offset:63488
v_mfma_f32_16x16x32_bf16 v[156:159], v[28:31], a[220:223], v[156:159]
v_mfma_f32_16x16x32_bf16 v[144:147], v[32:35], a[224:227], v[144:147]
ds_read_b128 v[28:31], v6 offset:64512
s_add_u32 m0, s43, 0
v_mfma_f32_16x16x32_bf16 v[152:155], v[32:35], a[228:231], v[152:155]
v_add_u32 v4, 16384, v4
v_mfma_f32_16x16x32_bf16 v[148:151], v[36:39], a[224:227], v[148:151]
s_barrier
ds_read_b128 v[32:35], v7 offset:0
v_mfma_f32_16x16x32_bf16 v[156:159], v[36:39], a[228:231], v[156:159]
global_load_lds_dwordx4 v4, s[20:21] offset:0 sc1
s_waitcnt lgkmcnt(3)
v_mfma_f32_16x16x32_bf16 v[144:147], v[40:43], a[232:235], v[144:147]
ds_read_b128 v[36:39], v7 offset:1024
global_load_lds_dwordx4 v4, s[20:21] offset:1024 sc1
v_mfma_f32_16x16x32_bf16 v[152:155], v[40:43], a[236:239], v[152:155]
v_mfma_f32_16x16x32_bf16 v[148:151], v[44:47], a[232:235], v[148:151]
ds_read_b128 v[40:43], v7 offset:2048
v_mfma_f32_16x16x32_bf16 v[156:159], v[44:47], a[236:239], v[156:159]
v_mfma_f32_16x16x32_bf16 v[144:147], v[16:19], a[240:243], v[144:147]
ds_read_b128 v[44:47], v7 offset:3072
v_mfma_f32_16x16x32_bf16 v[152:155], v[16:19], a[244:247], v[152:155]
v_mfma_f32_16x16x32_bf16 v[148:151], v[20:23], a[240:243], v[148:151]
ds_read_b128 v[16:19], v7 offset:4096
global_load_lds_dwordx4 v4, s[20:21] offset:2048 sc1
v_mfma_f32_16x16x32_bf16 v[156:159], v[20:23], a[244:247], v[156:159]
s_waitcnt vmcnt(10)
v_lshlrev_b32 v176, 16, v48
v_and_b32 v177, 0xffff0000, v48
v_lshlrev_b32 v178, 16, v49
v_and_b32 v179, 0xffff0000, v49
v_lshlrev_b32 v180, 16, v50
v_and_b32 v181, 0xffff0000, v50
v_lshlrev_b32 v182, 16, v51
s_waitcnt lgkmcnt(3)
v_mfma_f32_16x16x32_bf16 v[144:147], v[24:27], a[248:251], v[144:147]
ds_read_b128 v[20:23], v7 offset:5120
global_load_lds_dwordx4 v4, s[20:21] offset:3072 sc1
v_mfma_f32_16x16x32_bf16 v[152:155], v[24:27], a[252:255], v[152:155]
v_and_b32 v183, 0xffff0000, v51
s_waitcnt vmcnt(10)
v_lshlrev_b32 v184, 16, v52
v_and_b32 v185, 0xffff0000, v52
v_lshlrev_b32 v186, 16, v53
v_and_b32 v187, 0xffff0000, v53
v_mfma_f32_16x16x32_bf16 v[148:151], v[28:31], a[248:251], v[148:151]
ds_read_b128 v[24:27], v7 offset:6144
v_lshlrev_b32 v188, 16, v54
v_mfma_f32_16x16x32_bf16 v[156:159], v[28:31], a[252:255], v[156:159]
v_and_b32 v189, 0xffff0000, v54
v_lshlrev_b32 v190, 16, v55
v_and_b32 v191, 0xffff0000, v55
s_waitcnt vmcnt(9)
v_lshlrev_b32 v192, 16, v56
v_mfma_f32_16x16x32_bf16 v[160:163], v[32:35], a[0:3], v[160:163]
ds_read_b128 v[28:31], v7 offset:7168
s_add_u32 m0, s43, 16384
v_mfma_f32_16x16x32_bf16 v[168:171], v[32:35], a[4:7], v[168:171]
v_add_u32 v4, 16384, v4
v_and_b32 v193, 0xffff0000, v56
v_lshlrev_b32 v194, 16, v57
v_and_b32 v195, 0xffff0000, v57
v_lshlrev_b32 v196, 16, v58
v_and_b32 v197, 0xffff0000, v58
v_mfma_f32_16x16x32_bf16 v[164:167], v[36:39], a[0:3], v[164:167]
ds_read_b128 v[32:35], v7 offset:8192
global_load_lds_dwordx4 v4, s[20:21] offset:0 sc1
v_mfma_f32_16x16x32_bf16 v[172:175], v[36:39], a[4:7], v[172:175]
global_load_lds_dwordx4 v4, s[20:21] offset:1024 sc1
v_lshlrev_b32 v198, 16, v59
v_and_b32 v199, 0xffff0000, v59
s_waitcnt vmcnt(10)
v_lshlrev_b32 v200, 16, v60
v_and_b32 v201, 0xffff0000, v60
v_lshlrev_b32 v202, 16, v61
s_waitcnt lgkmcnt(3)
v_mfma_f32_16x16x32_bf16 v[160:163], v[40:43], a[8:11], v[160:163]
ds_read_b128 v[36:39], v7 offset:9216
v_mfma_f32_16x16x32_bf16 v[168:171], v[40:43], a[12:15], v[168:171]
s_atomic_add s45, s[20:21], s56 offset:4
v_and_b32 v203, 0xffff0000, v61
v_lshlrev_b32 v204, 16, v62
v_and_b32 v205, 0xffff0000, v62
v_mfma_f32_16x16x32_bf16 v[164:167], v[44:47], a[8:11], v[164:167]
ds_read_b128 v[40:43], v7 offset:10240
global_load_lds_dwordx4 v4, s[20:21] offset:2048 sc1
v_mfma_f32_16x16x32_bf16 v[172:175], v[44:47], a[12:15], v[172:175]
v_lshlrev_b32 v206, 16, v63
v_and_b32 v207, 0xffff0000, v63
v_mul_f32 v144, v144, v254
v_mul_f32 v145, v145, v254
v_mfma_f32_16x16x32_bf16 v[160:163], v[16:19], a[16:19], v[160:163]
ds_read_b128 v[44:47], v7 offset:11264
v_mul_f32 v146, v146, v254
v_mfma_f32_16x16x32_bf16 v[168:171], v[16:19], a[20:23], v[168:171]
v_exp_f32 v208, v144 clamp
v_exp_f32 v209, v145 clamp
v_max_f32 v144, s62, v144
v_mfma_f32_16x16x32_bf16 v[164:167], v[20:23], a[16:19], v[164:167]
ds_read_b128 v[16:19], v7 offset:12288
global_load_lds_dwordx4 v4, s[20:21] offset:3072 sc1
v_mfma_f32_16x16x32_bf16 v[172:175], v[20:23], a[20:23], v[172:175]
v_mul_f32 v147, v147, v254
v_exp_f32 v210, v146 clamp
v_max_f32 v145, s62, v145
v_fma_f32 v144, v144, s63, v208
s_waitcnt lgkmcnt(4)
v_mfma_f32_16x16x32_bf16 v[160:163], v[24:27], a[24:27], v[160:163]
ds_read_b128 v[20:23], v7 offset:13312
s_add_u32 m0, s43, 32768
v_mfma_f32_16x16x32_bf16 v[168:171], v[24:27], a[28:31], v[168:171]
v_add_u32 v4, 16384, v4
v_mul_f32 v148, v148, v254
v_exp_f32 v211, v147 clamp
v_max_f32 v146, s62, v146
v_fma_f32 v145, v145, s63, v209
v_mfma_f32_16x16x32_bf16 v[164:167], v[28:31], a[24:27], v[164:167]
ds_read_b128 v[24:27], v7 offset:14336
global_load_lds_dwordx4 v4, s[20:21] offset:0 sc1
v_mfma_f32_16x16x32_bf16 v[172:175], v[28:31], a[28:31], v[172:175]
v_exp_f32 v208, v148 clamp
v_mul_f32 v149, v149, v254
v_max_f32 v147, s62, v147
v_fma_f32 v146, v146, s63, v210
v_mfma_f32_16x16x32_bf16 v[160:163], v[32:35], a[32:35], v[160:163]
ds_read_b128 v[28:31], v7 offset:15360
global_load_lds_dwordx4 v4, s[20:21] offset:1024 sc1
v_mfma_f32_16x16x32_bf16 v[168:171], v[32:35], a[36:39], v[168:171]
v_cvt_pk_bf16_f32 v224, v144, v145
v_mul_f32 v150, v150, v254
v_exp_f32 v209, v149 clamp
v_max_f32 v148, s62, v148
s_waitcnt lgkmcnt(4)
v_mfma_f32_16x16x32_bf16 v[164:167], v[36:39], a[32:35], v[164:167]
s_barrier
ds_read_b128 v[32:35], v7 offset:16384
v_mfma_f32_16x16x32_bf16 v[172:175], v[36:39], a[36:39], v[172:175]
global_load_lds_dwordx4 v4, s[20:21] offset:2048 sc1
v_fma_f32 v147, v147, s63, v211
v_mul_f32 v151, v151, v254
v_exp_f32 v210, v150 clamp
v_max_f32 v149, s62, v149
v_mfma_f32_16x16x32_bf16 v[160:163], v[40:43], a[40:43], v[160:163]
ds_read_b128 v[36:39], v7 offset:17408
v_fma_f32 v148, v148, s63, v208
v_mfma_f32_16x16x32_bf16 v[168:171], v[40:43], a[44:47], v[168:171]
v_exp_f32 v211, v151 clamp
v_cvt_pk_bf16_f32 v225, v146, v147
v_mul_f32 v152, v152, v255
v_mfma_f32_16x16x32_bf16 v[164:167], v[44:47], a[40:43], v[164:167]
ds_read_b128 v[40:43], v7 offset:18432
global_load_lds_dwordx4 v4, s[20:21] offset:3072 sc1
v_mfma_f32_16x16x32_bf16 v[172:175], v[44:47], a[44:47], v[172:175]
v_max_f32 v150, s62, v150
v_fma_f32 v149, v149, s63, v209
v_mul_f32 v153, v153, v255
v_exp_f32 v208, v152 clamp
s_waitcnt lgkmcnt(4)
v_mfma_f32_16x16x32_bf16 v[160:163], v[16:19], a[48:51], v[160:163]
ds_read_b128 v[44:47], v7 offset:19456
s_add_u32 m0, s43, 49152
v_mfma_f32_16x16x32_bf16 v[168:171], v[16:19], a[52:55], v[168:171]
v_add_u32 v4, 16384, v4
v_max_f32 v151, s62, v151
v_fma_f32 v150, v150, s63, v210
v_cvt_pk_bf16_f32 v226, v148, v149
v_mul_f32 v154, v154, v255
v_mfma_f32_16x16x32_bf16 v[164:167], v[20:23], a[48:51], v[164:167]
ds_read_b128 v[16:19], v7 offset:20480
global_load_lds_dwordx4 v4, s[20:21] offset:0 sc1
v_mfma_f32_16x16x32_bf16 v[172:175], v[20:23], a[52:55], v[172:175]
v_exp_f32 v209, v153 clamp
v_max_f32 v152, s62, v152
v_fma_f32 v151, v151, s63, v211
v_mul_f32 v155, v155, v255
v_mfma_f32_16x16x32_bf16 v[160:163], v[24:27], a[56:59], v[160:163]
ds_read_b128 v[20:23], v7 offset:21504
global_load_lds_dwordx4 v4, s[20:21] offset:1024 sc1
v_mfma_f32_16x16x32_bf16 v[168:171], v[24:27], a[60:63], v[168:171]
v_max_f32 v153, s62, v153
v_exp_f32 v210, v154 clamp
v_fma_f32 v152, v152, s63, v208
v_cvt_pk_bf16_f32 v227, v150, v151
v_mul_f32 v156, v156, v255
s_waitcnt lgkmcnt(4)
v_mfma_f32_16x16x32_bf16 v[164:167], v[28:31], a[56:59], v[164:167]
ds_read_b128 v[24:27], v7 offset:22528
v_max_f32 v154, s62, v154
v_mfma_f32_16x16x32_bf16 v[172:175], v[28:31], a[60:63], v[172:175]
v_exp_f32 v211, v155 clamp
v_fma_f32 v153, v153, s63, v209
v_mul_f32 v157, v157, v255
v_mfma_f32_16x16x32_bf16 v[160:163], v[32:35], a[64:67], v[160:163]
ds_read_b128 v[28:31], v7 offset:23552
global_load_lds_dwordx4 v4, s[20:21] offset:2048 sc1
v_mfma_f32_16x16x32_bf16 v[168:171], v[32:35], a[68:71], v[168:171]
v_exp_f32 v208, v156 clamp
v_max_f32 v155, s62, v155
v_fma_f32 v154, v154, s63, v210
v_cvt_pk_bf16_f32 v228, v152, v153
v_mfma_f32_16x16x32_bf16 v[164:167], v[36:39], a[64:67], v[164:167]
ds_read_b128 v[32:35], v7 offset:24576
global_load_lds_dwordx4 v4, s[20:21] offset:3072 sc1
v_mfma_f32_16x16x32_bf16 v[172:175], v[36:39], a[68:71], v[172:175]
v_mul_f32 v158, v158, v255
v_exp_f32 v209, v157 clamp
v_max_f32 v156, s62, v156
v_fma_f32 v155, v155, s63, v211
s_waitcnt lgkmcnt(4)
v_mfma_f32_16x16x32_bf16 v[160:163], v[40:43], a[72:75], v[160:163]
ds_read_b128 v[36:39], v7 offset:25600
v_mfma_f32_16x16x32_bf16 v[168:171], v[40:43], a[76:79], v[168:171]
s_atomic_add s59, s[20:21], s56 offset:4 glc
v_mul_f32 v159, v159, v255
v_exp_f32 v210, v158 clamp
v_mfma_f32_16x16x32_bf16 v[164:167], v[44:47], a[72:75], v[164:167]
ds_read_b128 v[40:43], v7 offset:26624
v_max_f32 v157, s62, v157
v_mfma_f32_16x16x32_bf16 v[172:175], v[44:47], a[76:79], v[172:175]
v_exp_f32 v211, v159 clamp
v_fma_f32 v156, v156, s63, v208
v_cvt_pk_bf16_f32 v229, v154, v155
v_mfma_f32_16x16x32_bf16 v[160:163], v[16:19], a[80:83], v[160:163]
ds_read_b128 v[44:47], v7 offset:27648
v_max_f32 v158, s62, v158
v_mfma_f32_16x16x32_bf16 v[168:171], v[16:19], a[84:87], v[168:171]
v_fma_f32 v157, v157, s63, v209
v_max_f32 v159, s62, v159
v_fma_f32 v158, v158, s63, v210
v_cvt_pk_bf16_f32 v230, v156, v157
s_waitcnt lgkmcnt(4)
v_mfma_f32_16x16x32_bf16 v[164:167], v[20:23], a[80:83], v[164:167]
ds_read_b128 v[16:19], v7 offset:28672
v_fma_f32 v159, v159, s63, v211
v_mfma_f32_16x16x32_bf16 v[172:175], v[20:23], a[84:87], v[172:175]
v_cvt_pk_bf16_f32 v231, v158, v159
s_add_u32 s37, s48, 20971520
v_cvt_pk_bf16_f32 v80, v80, v81
v_cvt_pk_bf16_f32 v81, v82, v83
v_mfma_f32_16x16x32_bf16 v[160:163], v[24:27], a[88:91], v[160:163]
ds_read_b128 v[20:23], v7 offset:29696
v_cvt_pk_bf16_f32 v82, v84, v85
v_mfma_f32_16x16x32_bf16 v[168:171], v[24:27], a[92:95], v[168:171]
v_cvt_pk_bf16_f32 v83, v86, v87
v_cvt_pk_bf16_f32 v88, v88, v89
v_cvt_pk_bf16_f32 v89, v90, v91
v_cvt_pk_bf16_f32 v90, v92, v93
v_mfma_f32_16x16x32_bf16 v[164:167], v[28:31], a[88:91], v[164:167]
ds_read_b128 v[24:27], v7 offset:30720
v_cvt_pk_bf16_f32 v91, v94, v95
v_mfma_f32_16x16x32_bf16 v[172:175], v[28:31], a[92:95], v[172:175]
v_cvt_pk_bf16_f32 v96, v96, v97
v_cvt_pk_bf16_f32 v97, v98, v99
v_cvt_pk_bf16_f32 v98, v100, v101
v_cvt_pk_bf16_f32 v99, v102, v103
s_waitcnt lgkmcnt(4)
v_mfma_f32_16x16x32_bf16 v[160:163], v[32:35], a[96:99], v[160:163]
ds_read_b128 v[28:31], v7 offset:31744
v_mfma_f32_16x16x32_bf16 v[168:171], v[32:35], a[100:103], v[168:171]
v_mfma_f32_16x16x32_bf16 v[104:107], v[96:99], v[224:227], 0
v_mfma_f32_16x16x32_bf16 v[108:111], v[96:99], v[228:231], 0
v_mfma_f32_16x16x32_bf16 v[164:167], v[36:39], a[96:99], v[164:167]
s_barrier
ds_read_b128 v[32:35], v7 offset:32768
v_mfma_f32_16x16x32_bf16 v[172:175], v[36:39], a[100:103], v[172:175]
s_add_u32 m0, s43, 65536
v_add_u32 v4, 16384, v4
v_mfma_f32_16x16x32_bf16 v[144:147], v[80:83], v[224:227], 0
v_mfma_f32_16x16x32_bf16 v[152:155], v[80:83], v[228:231], 0
v_mfma_f32_16x16x32_bf16 v[148:151], v[88:91], v[224:227], 0
v_mfma_f32_16x16x32_bf16 v[160:163], v[40:43], a[104:107], v[160:163]
ds_read_b128 v[36:39], v7 offset:33792
global_load_lds_dwordx4 v4, s[20:21] offset:0 sc1
v_mfma_f32_16x16x32_bf16 v[168:171], v[40:43], a[108:111], v[168:171]
global_load_lds_dwordx4 v4, s[20:21] offset:1024 sc1
v_mfma_f32_16x16x32_bf16 v[156:159], v[88:91], v[228:231], 0
v_fma_f32 v244, v104, v246, s62
v_fma_f32 v245, v108, v246, s62
s_waitcnt lgkmcnt(4)
v_mfma_f32_16x16x32_bf16 v[164:167], v[44:47], a[104:107], v[164:167]
ds_read_b128 v[40:43], v7 offset:34816
global_load_lds_dwordx4 v4, s[20:21] offset:2048 sc1
v_mfma_f32_16x16x32_bf16 v[172:175], v[44:47], a[108:111], v[172:175]
global_load_lds_dwordx4 v4, s[20:21] offset:3072 sc1
v_rcp_f32 v244, v244
v_rcp_f32 v245, v245
v_mul_f32 v144, v144, v244
v_mul_f32 v145, v145, v244
v_mfma_f32_16x16x32_bf16 v[160:163], v[16:19], a[112:115], v[160:163]
ds_read_b128 v[44:47], v7 offset:35840
v_mul_f32 v146, v146, v244
v_mfma_f32_16x16x32_bf16 v[168:171], v[16:19], a[116:119], v[168:171]
v_mul_f32 v147, v147, v244
v_mul_f32 v148, v148, v244
v_mul_f32 v149, v149, v244
v_mul_f32 v150, v150, v244
v_mfma_f32_16x16x32_bf16 v[164:167], v[20:23], a[112:115], v[164:167]
ds_read_b128 v[16:19], v7 offset:36864
v_mul_f32 v151, v151, v244
v_mfma_f32_16x16x32_bf16 v[172:175], v[20:23], a[116:119], v[172:175]
v_cvt_pk_bf16_f32 v104, v144, v145
v_cvt_pk_bf16_f32 v105, v146, v147
v_cvt_pk_bf16_f32 v106, v148, v149
v_cvt_pk_bf16_f32 v107, v150, v151
s_waitcnt lgkmcnt(4)
v_mfma_f32_16x16x32_bf16 v[160:163], v[24:27], a[120:123], v[160:163]
ds_read_b128 v[20:23], v7 offset:37888
v_mul_f32 v152, v152, v245
v_mfma_f32_16x16x32_bf16 v[168:171], v[24:27], a[124:127], v[168:171]
v_mul_f32 v153, v153, v245
v_mul_f32 v154, v154, v245
v_mul_f32 v155, v155, v245
v_mul_f32 v156, v156, v245
v_mfma_f32_16x16x32_bf16 v[164:167], v[28:31], a[120:123], v[164:167]
ds_read_b128 v[24:27], v7 offset:38912
v_mul_f32 v157, v157, v245
v_mfma_f32_16x16x32_bf16 v[172:175], v[28:31], a[124:127], v[172:175]
v_mul_f32 v158, v158, v245
v_mul_f32 v159, v159, v245
v_cvt_pk_bf16_f32 v108, v152, v153
v_cvt_pk_bf16_f32 v109, v154, v155
v_mfma_f32_16x16x32_bf16 v[160:163], v[32:35], a[128:131], v[160:163]
s_barrier
ds_read_b128 v[28:31], v7 offset:39936
v_mfma_f32_16x16x32_bf16 v[168:171], v[32:35], a[132:135], v[168:171]
s_add_u32 m0, s43, 81920
v_cvt_pk_bf16_f32 v110, v156, v157
v_cvt_pk_bf16_f32 v111, v158, v159
s_waitcnt lgkmcnt(4)
v_mfma_f32_16x16x32_bf16 v[164:167], v[36:39], a[128:131], v[164:167]
ds_read_b128 v[32:35], v7 offset:40960
buffer_store_dwordx4 v[104:107], v0, s[20:23], s37 offen offset:0 sc1
buffer_store_dwordx4 v[108:111], v0, s[20:23], s37 offen offset:1024 sc1
v_mfma_f32_16x16x32_bf16 v[172:175], v[36:39], a[132:135], v[172:175]
v_add_u32 v4, 16384, v4
s_mov_b32 s58, 0
v_mfma_f32_16x16x32_bf16 v[160:163], v[40:43], a[136:139], v[160:163]
ds_read_b128 v[36:39], v7 offset:41984
global_load_lds_dwordx4 v4, s[20:21] offset:0 sc1
v_mfma_f32_16x16x32_bf16 v[168:171], v[40:43], a[140:143], v[168:171]
global_load_lds_dwordx4 v4, s[20:21] offset:1024 sc1
v_mfma_f32_16x16x32_bf16 v[164:167], v[44:47], a[136:139], v[164:167]
ds_read_b128 v[40:43], v7 offset:43008
global_load_lds_dwordx4 v4, s[20:21] offset:2048 sc1
v_mfma_f32_16x16x32_bf16 v[172:175], v[44:47], a[140:143], v[172:175]
s_cmp_lt_u32 s59, 16
s_cbranch_scc0 L_back1
L_slow1:
s_waitcnt lgkmcnt(0)
s_cmp_ge_u32 s59, 16
s_cbranch_scc1 L_back1
s_mov_b32 s59, 0
s_atomic_add s59, s[20:21], s56 offset:4 glc
s_sub_u32 s46, s46, 1
s_cbranch_scc0 L_slow1
s_endpgm
L_back1:
s_barrier
buffer_load_dwordx4 v[112:115], v252, s[20:23], s41 offen offset:0 sc1
s_waitcnt lgkmcnt(3)
v_mfma_f32_16x16x32_bf16 v[160:163], v[16:19], a[144:147], v[160:163]
ds_read_b128 v[44:47], v7 offset:44032
v_mfma_f32_16x16x32_bf16 v[168:171], v[16:19], a[148:151], v[168:171]
v_mfma_f32_16x16x32_bf16 v[164:167], v[20:23], a[144:147], v[164:167]
ds_read_b128 v[16:19], v7 offset:45056
v_mfma_f32_16x16x32_bf16 v[172:175], v[20:23], a[148:151], v[172:175]
v_mfma_f32_16x16x32_bf16 v[160:163], v[24:27], a[152:155], v[160:163]
ds_read_b128 v[20:23], v7 offset:46080
buffer_load_dwordx4 v[116:119], v252, s[20:23], s41 offen offset:1024 sc1
v_mfma_f32_16x16x32_bf16 v[168:171], v[24:27], a[156:159], v[168:171]
v_mfma_f32_16x16x32_bf16 v[164:167], v[28:31], a[152:155], v[164:167]
ds_read_b128 v[24:27], v7 offset:47104
v_mfma_f32_16x16x32_bf16 v[172:175], v[28:31], a[156:159], v[172:175]
s_waitcnt vmcnt(27) lgkmcnt(3)
v_mfma_f32_16x16x32_bf16 v[160:163], v[32:35], a[160:163], v[160:163]
ds_read_b128 v[28:31], v7 offset:48128
v_mfma_f32_16x16x32_bf16 v[168:171], v[32:35], a[164:167], v[168:171]
v_mfma_f32_16x16x32_bf16 v[164:167], v[36:39], a[160:163], v[164:167]
s_barrier
ds_read_b128 v[32:35], v7 offset:49152
v_mfma_f32_16x16x32_bf16 v[172:175], v[36:39], a[164:167], v[172:175]
v_mfma_f32_16x16x32_bf16 v[160:163], v[40:43], a[168:171], v[160:163]
ds_read_b128 v[36:39], v7 offset:50176
buffer_load_dwordx4 v[120:123], v252, s[20:23], s41 offen offset:2048 sc1
v_mfma_f32_16x16x32_bf16 v[168:171], v[40:43], a[172:175], v[168:171]
v_mfma_f32_16x16x32_bf16 v[164:167], v[44:47], a[168:171], v[164:167]
ds_read_b128 v[40:43], v7 offset:51200
v_mfma_f32_16x16x32_bf16 v[172:175], v[44:47], a[172:175], v[172:175]
s_waitcnt lgkmcnt(3)
v_mfma_f32_16x16x32_bf16 v[160:163], v[16:19], a[176:179], v[160:163]
ds_read_b128 v[44:47], v7 offset:52224
v_mfma_f32_16x16x32_bf16 v[168:171], v[16:19], a[180:183], v[168:171]
v_mfma_f32_16x16x32_bf16 v[164:167], v[20:23], a[176:179], v[164:167]
ds_read_b128 v[16:19], v7 offset:53248
v_mfma_f32_16x16x32_bf16 v[172:175], v[20:23], a[180:183], v[172:175]
v_mfma_f32_16x16x32_bf16 v[160:163], v[24:27], a[184:187], v[160:163]
ds_read_b128 v[20:23], v7 offset:54272
buffer_load_dwordx4 v[124:127], v252, s[20:23], s41 offen offset:3072 sc1
v_mfma_f32_16x16x32_bf16 v[168:171], v[24:27], a[188:191], v[168:171]
v_mfma_f32_16x16x32_bf16 v[164:167], v[28:31], a[184:187], v[164:167]
ds_read_b128 v[24:27], v7 offset:55296
v_mfma_f32_16x16x32_bf16 v[172:175], v[28:31], a[188:191], v[172:175]
s_waitcnt lgkmcnt(3)
v_mfma_f32_16x16x32_bf16 v[160:163], v[32:35], a[192:195], v[160:163]
ds_read_b128 v[28:31], v7 offset:56320
v_mfma_f32_16x16x32_bf16 v[168:171], v[32:35], a[196:199], v[168:171]
v_mfma_f32_16x16x32_bf16 v[164:167], v[36:39], a[192:195], v[164:167]
ds_read_b128 v[32:35], v7 offset:57344
v_mfma_f32_16x16x32_bf16 v[172:175], v[36:39], a[196:199], v[172:175]
v_mfma_f32_16x16x32_bf16 v[160:163], v[40:43], a[200:203], v[160:163]
ds_read_b128 v[36:39], v7 offset:58368
buffer_load_dwordx4 v[128:131], v253, s[20:23], s42 offen offset:0 sc1
buffer_load_dwordx4 v[132:135], v253, s[20:23], s42 offen offset:64 sc1
v_mfma_f32_16x16x32_bf16 v[168:171], v[40:43], a[204:207], v[168:171]
v_mfma_f32_16x16x32_bf16 v[164:167], v[44:47], a[200:203], v[164:167]
s_waitcnt vmcnt(9)
s_atomic_add s45, s[20:21], s53 offset:0
v_mfma_f32_16x16x32_bf16 v[172:175], v[44:47], a[204:207], v[172:175]
ds_read_b128 v[40:43], v7 offset:59392
s_waitcnt lgkmcnt(4)
v_mfma_f32_16x16x32_bf16 v[160:163], v[16:19], a[208:211], v[160:163]
ds_read_b128 v[44:47], v7 offset:60416
s_getpc_b64 s[4:5]
v_mfma_f32_16x16x32_bf16 v[168:171], v[16:19], a[212:215], v[168:171]
global_load_dword v13, v12, s[4:5]
v_mfma_f32_16x16x32_bf16 v[164:167], v[20:23], a[208:211], v[164:167]
ds_read_b128 v[16:19], v7 offset:61440
v_mfma_f32_16x16x32_bf16 v[172:175], v[20:23], a[212:215], v[172:175]
v_mfma_f32_16x16x32_bf16 v[160:163], v[24:27], a[216:219], v[160:163]
ds_read_b128 v[20:23], v7 offset:62464
global_load_lds_dwordx4 v4, s[20:21] offset:3072 sc1
v_mfma_f32_16x16x32_bf16 v[168:171], v[24:27], a[220:223], v[168:171]
s_waitcnt lgkmcnt(4)
v_mfma_f32_16x16x32_bf16 v[164:167], v[28:31], a[216:219], v[164:167]
ds_read_b128 v[24:27], v7 offset:63488
v_mfma_f32_16x16x32_bf16 v[172:175], v[28:31], a[220:223], v[172:175]
v_mfma_f32_16x16x32_bf16 v[160:163], v[32:35], a[224:227], v[160:163]
ds_read_b128 v[28:31], v7 offset:64512
v_mfma_f32_16x16x32_bf16 v[168:171], v[32:35], a[228:231], v[168:171]
v_mfma_f32_16x16x32_bf16 v[164:167], v[36:39], a[224:227], v[164:167]
s_barrier
ds_read_b128 v[32:35], v6 offset:0
v_mfma_f32_16x16x32_bf16 v[172:175], v[36:39], a[228:231], v[172:175]
s_add_u32 m0, s43, 98304
s_waitcnt lgkmcnt(4)
v_mfma_f32_16x16x32_bf16 v[160:163], v[40:43], a[232:235], v[160:163]
ds_read_b128 v[36:39], v6 offset:1024
v_add_u32 v4, 16384, v4
v_mfma_f32_16x16x32_bf16 v[168:171], v[40:43], a[236:239], v[168:171]
global_load_lds_dwordx4 v4, s[20:21] offset:0 sc1
global_load_lds_dwordx4 v4, s[20:21] offset:1024 sc1
v_mfma_f32_16x16x32_bf16 v[164:167], v[44:47], a[232:235], v[164:167]
ds_read_b128 v[40:43], v6 offset:2048
v_mfma_f32_16x16x32_bf16 v[172:175], v[44:47], a[236:239], v[172:175]
v_mfma_f32_16x16x32_bf16 v[160:163], v[16:19], a[240:243], v[160:163]
ds_read_b128 v[44:47], v6 offset:3072
global_load_lds_dwordx4 v4, s[20:21] offset:2048 sc1
v_mfma_f32_16x16x32_bf16 v[168:171], v[16:19], a[244:247], v[168:171]
s_waitcnt lgkmcnt(4)
v_mfma_f32_16x16x32_bf16 v[164:167], v[20:23], a[240:243], v[164:167]
ds_read_b128 v[16:19], v6 offset:4096
v_mfma_f32_16x16x32_bf16 v[172:175], v[20:23], a[244:247], v[172:175]
v_mfma_f32_16x16x32_bf16 v[160:163], v[24:27], a[248:251], v[160:163]
ds_read_b128 v[20:23], v6 offset:5120
global_load_lds_dwordx4 v4, s[20:21] offset:3072 sc1
v_mfma_f32_16x16x32_bf16 v[168:171], v[24:27], a[252:255], v[168:171]
v_mfma_f32_16x16x32_bf16 v[164:167], v[28:31], a[248:251], v[164:167]
ds_read_b128 v[24:27], v6 offset:6144
v_mfma_f32_16x16x32_bf16 v[172:175], v[28:31], a[252:255], v[172:175]
s_nop 1
v_mul_f32 v160, v160, v254
v_mul_f32 v161, v161, v254
v_exp_f32 v208, v160 clamp
v_mul_f32 v162, v162, v254
v_exp_f32 v209, v161 clamp
v_max_f32 v160, s62, v160
v_mul_f32 v163, v163, v254
s_atomic_add s58, s[20:21], s53 offset:0 glc
v_exp_f32 v210, v162 clamp
v_max_f32 v161, s62, v161
v_fma_f32 v160, v160, s63, v208
v_mul_f32 v164, v164, v254
v_exp_f32 v211, v163 clamp
v_max_f32 v162, s62, v162
v_fma_f32 v161, v161, s63, v209
v_mul_f32 v165, v165, v254
v_exp_f32 v208, v164 clamp
v_max_f32 v163, s62, v163
v_fma_f32 v162, v162, s63, v210
v_cvt_pk_bf16_f32 v224, v160, v161
v_mul_f32 v166, v166, v254
v_exp_f32 v209, v165 clamp
v_max_f32 v164, s62, v164
v_fma_f32 v163, v163, s63, v211
v_mul_f32 v167, v167, v254
v_exp_f32 v210, v166 clamp
v_max_f32 v165, s62, v165
v_fma_f32 v164, v164, s63, v208
v_cvt_pk_bf16_f32 v225, v162, v163
v_mul_f32 v168, v168, v255
v_exp_f32 v211, v167 clamp
v_max_f32 v166, s62, v166
v_fma_f32 v165, v165, s63, v209
v_mul_f32 v169, v169, v255
v_exp_f32 v208, v168 clamp
v_max_f32 v167, s62, v167
v_fma_f32 v166, v166, s63, v210
v_cvt_pk_bf16_f32 v226, v164, v165
v_mul_f32 v170, v170, v255
v_exp_f32 v209, v169 clamp
v_max_f32 v168, s62, v168
v_fma_f32 v167, v167, s63, v211
v_mul_f32 v171, v171, v255
v_exp_f32 v210, v170 clamp
v_max_f32 v169, s62, v169
v_fma_f32 v168, v168, s63, v208
v_cvt_pk_bf16_f32 v227, v166, v167
v_mul_f32 v172, v172, v255
v_exp_f32 v211, v171 clamp
v_max_f32 v170, s62, v170
v_fma_f32 v169, v169, s63, v209
v_mul_f32 v173, v173, v255
v_exp_f32 v208, v172 clamp
v_max_f32 v171, s62, v171
v_fma_f32 v170, v170, s63, v210
v_cvt_pk_bf16_f32 v228, v168, v169
v_mul_f32 v174, v174, v255
v_exp_f32 v209, v173 clamp
v_max_f32 v172, s62, v172
v_fma_f32 v171, v171, s63, v211
v_mul_f32 v175, v175, v255
v_exp_f32 v210, v174 clamp
v_max_f32 v173, s62, v173
v_fma_f32 v172, v172, s63, v208
v_cvt_pk_bf16_f32 v229, v170, v171
v_exp_f32 v211, v175 clamp
v_max_f32 v174, s62, v174
v_fma_f32 v173, v173, s63, v209
v_max_f32 v175, s62, v175
v_fma_f32 v174, v174, s63, v210
v_cvt_pk_bf16_f32 v230, v172, v173
v_fma_f32 v175, v175, s63, v211
v_cvt_pk_bf16_f32 v231, v174, v175
s_add_u32 s37, s48, 21004288
s_waitcnt vmcnt(11)
v_cvt_pk_bf16_f32 v112, v112, v113
v_cvt_pk_bf16_f32 v113, v114, v115
s_waitcnt vmcnt(10)
v_cvt_pk_bf16_f32 v114, v116, v117
v_cvt_pk_bf16_f32 v115, v118, v119
s_waitcnt vmcnt(9)
v_cvt_pk_bf16_f32 v120, v120, v121
v_cvt_pk_bf16_f32 v121, v122, v123
s_waitcnt vmcnt(8)
v_cvt_pk_bf16_f32 v122, v124, v125
v_cvt_pk_bf16_f32 v123, v126, v127
s_waitcnt vmcnt(7)
v_cvt_pk_bf16_f32 v128, v128, v129
v_cvt_pk_bf16_f32 v129, v130, v131
s_waitcnt vmcnt(6)
v_cvt_pk_bf16_f32 v130, v132, v133
v_cvt_pk_bf16_f32 v131, v134, v135
s_nop 1
v_mfma_f32_16x16x32_bf16 v[136:139], v[128:131], v[224:227], 0
v_mfma_f32_16x16x32_bf16 v[140:143], v[128:131], v[228:231], 0
v_mfma_f32_16x16x32_bf16 v[160:163], v[112:115], v[224:227], 0
v_mfma_f32_16x16x32_bf16 v[168:171], v[112:115], v[228:231], 0
v_mfma_f32_16x16x32_bf16 v[164:167], v[120:123], v[224:227], 0
v_mfma_f32_16x16x32_bf16 v[172:175], v[120:123], v[228:231], 0
s_nop 2
v_fma_f32 v244, v136, v246, s62
v_fma_f32 v245, v140, v246, s62
v_rcp_f32 v244, v244
v_rcp_f32 v245, v245
v_mul_f32 v160, v160, v244
v_mul_f32 v161, v161, v244
v_mul_f32 v162, v162, v244
v_mul_f32 v163, v163, v244
v_mul_f32 v164, v164, v244
v_mul_f32 v165, v165, v244
v_mul_f32 v166, v166, v244
v_mul_f32 v167, v167, v244
v_cvt_pk_bf16_f32 v136, v160, v161
v_cvt_pk_bf16_f32 v137, v162, v163
v_cvt_pk_bf16_f32 v138, v164, v165
v_cvt_pk_bf16_f32 v139, v166, v167
v_mul_f32 v168, v168, v245
v_mul_f32 v169, v169, v245
v_mul_f32 v170, v170, v245
v_mul_f32 v171, v171, v245
v_mul_f32 v172, v172, v245
v_mul_f32 v173, v173, v245
v_mul_f32 v174, v174, v245
v_mul_f32 v175, v175, v245
v_cvt_pk_bf16_f32 v140, v168, v169
v_cvt_pk_bf16_f32 v141, v170, v171
v_cvt_pk_bf16_f32 v142, v172, v173
v_cvt_pk_bf16_f32 v143, v174, v175
buffer_store_dwordx4 v[136:139], v0, s[20:23], s37 offen offset:0 sc1
buffer_store_dwordx4 v[140:143], v0, s[20:23], s37 offen offset:1024 sc1
s_cmp_lt_u32 s58, 16
s_cbranch_scc0 L_back2
L_slow2:
s_waitcnt lgkmcnt(0)
s_cmp_ge_u32 s58, 16
s_cbranch_scc1 L_back2
s_mov_b32 s58, 0
s_atomic_add s58, s[20:21], s53 offset:0 glc
s_sub_u32 s46, s46, 1
s_cbranch_scc0 L_slow2
s_endpgm
L_back2:
v_add_u32 v5, 20975616, v14
global_load_dwordx4 a[0:3], v5, s[20:21] offset:-4096 sc1
global_load_dwordx4 a[4:7], v5, s[20:21] offset:-3072 sc1
global_load_dwordx4 a[8:11], v5, s[20:21] offset:-2048 sc1
global_load_dwordx4 a[12:15], v5, s[20:21] offset:-1024 sc1
global_load_dwordx4 a[16:19], v5, s[20:21] offset:0 sc1
global_load_dwordx4 a[20:23], v5, s[20:21] offset:1024 sc1
global_load_dwordx4 a[24:27], v5, s[20:21] offset:2048 sc1
global_load_dwordx4 a[28:31], v5, s[20:21] offset:3072 sc1
s_waitcnt vmcnt(6) lgkmcnt(4)
v_mfma_f32_16x16x32_bf16 v[176:179], v[32:35], a[0:3], v[176:179]
ds_read_b128 v[28:31], v6 offset:7168
v_add_u32 v5, 8192, v5
v_mfma_f32_16x16x32_bf16 v[184:187], v[32:35], a[4:7], v[184:187]
global_load_dwordx4 a[32:35], v5, s[20:21] offset:-4096 sc1
global_load_dwordx4 a[36:39], v5, s[20:21] offset:-3072 sc1
s_mov_b32 s58, 0
s_atomic_add s45, s[20:21], s53 offset:4
v_lshrrev_b32 v232, 4, v11
v_lshlrev_b32 v234, 14, v232
v_lshl_add_u32 v234, v2, 2, v234
v_add_u32 v233, v2, v232
s_lshl_b32 s39, s33, 2
v_mfma_f32_16x16x32_bf16 v[180:183], v[36:39], a[0:3], v[180:183]
ds_read_b128 v[32:35], v6 offset:8192
global_load_dwordx4 a[40:43], v5, s[20:21] offset:-2048 sc1
global_load_dwordx4 a[44:47], v5, s[20:21] offset:-1024 sc1
v_mfma_f32_16x16x32_bf16 v[188:191], v[36:39], a[4:7], v[188:191]
global_load_dwordx4 a[48:51], v5, s[20:21] offset:0 sc1
global_load_dwordx4 a[52:55], v5, s[20:21] offset:1024 sc1
s_add_u32 s39, s39, s34
s_lshl_b32 s39, s39, 8
s_add_u32 s39, s39, 524288
v_mfma_f32_16x16x32_bf16 v[192:195], v[40:43], a[0:3], v[192:195]
buffer_load_dwordx4 v[216:219], v234, s[20:23], s39 offen sc1
v_mfma_f32_16x16x32_bf16 v[200:203], v[40:43], a[4:7], v[200:203]
ds_read_b128 v[36:39], v6 offset:9216
s_add_u32 s39, s39, 65536
s_waitcnt vmcnt(11) lgkmcnt(4)
v_mfma_f32_16x16x32_bf16 v[196:199], v[44:47], a[0:3], v[196:199]
ds_read_b128 v[40:43], v6 offset:10240
v_mfma_f32_16x16x32_bf16 v[204:207], v[44:47], a[4:7], v[204:207]
v_mfma_f32_16x16x32_bf16 v[176:179], v[16:19], a[8:11], v[176:179]
ds_read_b128 v[44:47], v6 offset:11264
buffer_load_dwordx4 v[220:223], v234, s[20:23], s39 offen sc1
v_mfma_f32_16x16x32_bf16 v[184:187], v[16:19], a[12:15], v[184:187]
global_load_dwordx4 a[56:59], v5, s[20:21] offset:2048 sc1
global_load_dwordx4 a[60:63], v5, s[20:21] offset:3072 sc1
s_add_u32 s39, s39, 65536
v_mfma_f32_16x16x32_bf16 v[180:183], v[20:23], a[8:11], v[180:183]
ds_read_b128 v[16:19], v6 offset:12288
v_mfma_f32_16x16x32_bf16 v[188:191], v[20:23], a[12:15], v[188:191]
s_waitcnt vmcnt(12) lgkmcnt(4)
v_mfma_f32_16x16x32_bf16 v[192:195], v[24:27], a[8:11], v[192:195]
ds_read_b128 v[20:23], v6 offset:13312
buffer_load_dwordx4 v[224:227], v234, s[20:23], s39 offen sc1
v_mfma_f32_16x16x32_bf16 v[200:203], v[24:27], a[12:15], v[200:203]
s_add_u32 s39, s39, 65536
v_mfma_f32_16x16x32_bf16 v[196:199], v[28:31], a[8:11], v[196:199]
ds_read_b128 v[24:27], v6 offset:14336
v_mfma_f32_16x16x32_bf16 v[204:207], v[28:31], a[12:15], v[204:207]
s_atomic_add s58, s[20:21], s53 offset:4 glc
v_mfma_f32_16x16x32_bf16 v[176:179], v[32:35], a[16:19], v[176:179]
buffer_load_dwordx4 v[228:231], v234, s[20:23], s39 offen sc1
v_mfma_f32_16x16x32_bf16 v[184:187], v[32:35], a[20:23], v[184:187]
ds_read_b128 v[28:31], v6 offset:15360
v_lshlrev_b32 v234, 1, v233
s_lshl_b32 s40, s36, 6
s_lshl_b32 s39, s34, 7
s_add_u32 s39, s39, s40
s_cmp_eq_u32 s39, 448
s_cselect_b32 s39, -64, s39
s_cselect_b32 s40, 32, 0
v_xor_b32 v233, s40, v233
s_waitcnt lgkmcnt(5)
v_mfma_f32_16x16x32_bf16 v[180:183], v[36:39], a[16:19], v[180:183]
s_barrier
ds_read_b128 v[32:35], v6 offset:16384
v_mfma_f32_16x16x32_bf16 v[188:191], v[36:39], a[20:23], v[188:191]
v_add_u32 v5, s60, v5
s_mul_i32 s40, s33, 448
s_add_u32 s39, s39, s40
v_mfma_f32_16x16x32_bf16 v[192:195], v[40:43], a[16:19], v[192:195]
ds_read_b128 v[36:39], v6 offset:17408
global_load_dwordx4 a[64:67], v5, s[20:21] offset:-4096 sc1
v_mfma_f32_16x16x32_bf16 v[200:203], v[40:43], a[20:23], v[200:203]
global_load_dwordx4 a[68:71], v5, s[20:21] offset:-3072 sc1
s_waitcnt vmcnt(14) lgkmcnt(5)
v_mfma_f32_16x16x32_bf16 v[196:199], v[44:47], a[16:19], v[196:199]
ds_read_b128 v[40:43], v6 offset:18432
v_mfma_f32_16x16x32_bf16 v[204:207], v[44:47], a[20:23], v[204:207]
v_mfma_f32_16x16x32_bf16 v[176:179], v[16:19], a[24:27], v[176:179]
buffer_load_ushort v235, v234, s[28:31], s39 offen
v_mfma_f32_16x16x32_bf16 v[184:187], v[16:19], a[28:31], v[184:187]
ds_read_b128 v[44:47], v6 offset:19456
s_waitcnt lgkmcnt(5)
v_mfma_f32_16x16x32_bf16 v[180:183], v[20:23], a[24:27], v[180:183]
ds_read_b128 v[16:19], v6 offset:20480
global_load_dwordx4 a[72:75], v5, s[20:21] offset:-2048 sc1
v_mfma_f32_16x16x32_bf16 v[188:191], v[20:23], a[28:31], v[188:191]
global_load_dwordx4 a[76:79], v5, s[20:21] offset:-1024 sc1
v_mfma_f32_16x16x32_bf16 v[192:195], v[24:27], a[24:27], v[192:195]
ds_read_b128 v[20:23], v6 offset:21504
v_mfma_f32_16x16x32_bf16 v[200:203], v[24:27], a[28:31], v[200:203]
s_waitcnt vmcnt(15) lgkmcnt(4)
v_mfma_f32_16x16x32_bf16 v[196:199], v[28:31], a[24:27], v[196:199]
ds_read_b128 v[24:27], v6 offset:22528
v_mfma_f32_16x16x32_bf16 v[204:207], v[28:31], a[28:31], v[204:207]
v_mfma_f32_16x16x32_bf16 v[176:179], v[32:35], a[32:35], v[176:179]
ds_read_b128 v[28:31], v6 offset:23552
v_mfma_f32_16x16x32_bf16 v[184:187], v[32:35], a[36:39], v[184:187]
global_load_dwordx4 a[80:83], v5, s[20:21] offset:0 sc1
global_load_dwordx4 a[84:87], v5, s[20:21] offset:1024 sc1
v_mfma_f32_16x16x32_bf16 v[180:183], v[36:39], a[32:35], v[180:183]
ds_read_b128 v[32:35], v6 offset:24576
v_mfma_f32_16x16x32_bf16 v[188:191], v[36:39], a[36:39], v[188:191]
s_waitcnt vmcnt(15) lgkmcnt(4)
v_mfma_f32_16x16x32_bf16 v[192:195], v[40:43], a[32:35], v[192:195]
ds_read_b128 v[36:39], v6 offset:25600
v_mfma_f32_16x16x32_bf16 v[200:203], v[40:43], a[36:39], v[200:203]
v_mfma_f32_16x16x32_bf16 v[196:199], v[44:47], a[32:35], v[196:199]
ds_read_b128 v[40:43], v6 offset:26624
v_mfma_f32_16x16x32_bf16 v[204:207], v[44:47], a[36:39], v[204:207]
v_mfma_f32_16x16x32_bf16 v[176:179], v[16:19], a[40:43], v[176:179]
ds_read_b128 v[44:47], v6 offset:27648
v_mfma_f32_16x16x32_bf16 v[184:187], v[16:19], a[44:47], v[184:187]
global_load_dwordx4 a[88:91], v5, s[20:21] offset:2048 sc1
s_waitcnt lgkmcnt(4)
v_mfma_f32_16x16x32_bf16 v[180:183], v[20:23], a[40:43], v[180:183]
ds_read_b128 v[16:19], v6 offset:28672
global_load_dwordx4 a[92:95], v5, s[20:21] offset:3072 sc1
v_mfma_f32_16x16x32_bf16 v[188:191], v[20:23], a[44:47], v[188:191]
v_mfma_f32_16x16x32_bf16 v[192:195], v[24:27], a[40:43], v[192:195]
ds_read_b128 v[20:23], v6 offset:29696
v_mfma_f32_16x16x32_bf16 v[200:203], v[24:27], a[44:47], v[200:203]
v_mfma_f32_16x16x32_bf16 v[196:199], v[28:31], a[40:43], v[196:199]
s_cmp_lt_u32 s58, 16
s_cbranch_scc0 L_back3
L_slow3:
s_waitcnt lgkmcnt(0)
s_cmp_ge_u32 s58, 16
s_cbranch_scc1 L_back3
s_mov_b32 s58, 0
s_atomic_add s58, s[20:21], s53 offset:4 glc
s_sub_u32 s46, s46, 1
s_cbranch_scc0 L_slow3
s_endpgm
L_back3:
v_mfma_f32_16x16x32_bf16 v[204:207], v[28:31], a[44:47], v[204:207]
ds_read_b128 v[24:27], v6 offset:30720
s_waitcnt vmcnt(15) lgkmcnt(3)
v_mfma_f32_16x16x32_bf16 v[176:179], v[32:35], a[48:51], v[176:179]
ds_read_b128 v[28:31], v6 offset:31744
v_mfma_f32_16x16x32_bf16 v[184:187], v[32:35], a[52:55], v[184:187]
v_add_u32 v5, 8192, v5
v_mfma_f32_16x16x32_bf16 v[180:183], v[36:39], a[48:51], v[180:183]
s_barrier
ds_read_b128 v[32:35], v6 offset:32768
v_mfma_f32_16x16x32_bf16 v[188:191], v[36:39], a[52:55], v[188:191]
global_load_dwordx4 a[96:99], v5, s[20:21] offset:-4096 sc1
global_load_dwordx4 a[100:103], v5, s[20:21] offset:-3072 sc1
v_mfma_f32_16x16x32_bf16 v[192:195], v[40:43], a[48:51], v[192:195]
ds_read_b128 v[36:39], v6 offset:33792
v_mfma_f32_16x16x32_bf16 v[200:203], v[40:43], a[52:55], v[200:203]
v_mfma_f32_16x16x32_bf16 v[196:199], v[44:47], a[48:51], v[196:199]
ds_read_b128 v[40:43], v6 offset:34816
v_mfma_f32_16x16x32_bf16 v[204:207], v[44:47], a[52:55], v[204:207]
s_waitcnt vmcnt(13) lgkmcnt(3)
v_mfma_f32_16x16x32_bf16 v[176:179], v[16:19], a[56:59], v[176:179]
ds_read_b128 v[44:47], v6 offset:35840
v_mfma_f32_16x16x32_bf16 v[184:187], v[16:19], a[60:63], v[184:187]
global_load_dwordx4 a[104:107], v5, s[20:21] offset:-2048 sc1
global_load_dwordx4 a[108:111], v5, s[20:21] offset:-1024 sc1
v_mfma_f32_16x16x32_bf16 v[180:183], v[20:23], a[56:59], v[180:183]
ds_read_b128 v[16:19], v6 offset:36864
v_mfma_f32_16x16x32_bf16 v[188:191], v[20:23], a[60:63], v[188:191]
v_mfma_f32_16x16x32_bf16 v[192:195], v[24:27], a[56:59], v[192:195]
ds_read_b128 v[20:23], v6 offset:37888
v_add_f32 v216, v216, v220
v_mfma_f32_16x16x32_bf16 v[200:203], v[24:27], a[60:63], v[200:203]
s_waitcnt vmcnt(13)
v_add_f32 v224, v224, v228
v_add_f32 v217, v217, v221
v_add_f32 v225, v225, v229
v_add_f32 v218, v218, v222
v_add_f32 v226, v226, v230
v_add_f32 v219, v219, v223
v_add_f32 v227, v227, v231
v_add_f32 v216, v216, v224
v_add_f32 v217, v217, v225
v_mfma_f32_16x16x32_bf16 v[196:199], v[28:31], a[56:59], v[196:199]
ds_read_b128 v[24:27], v6 offset:38912
v_add_f32 v218, v218, v226
v_mfma_f32_16x16x32_bf16 v[204:207], v[28:31], a[60:63], v[204:207]
v_add_f32 v219, v219, v227
v_permlane32_swap_b32 v216, v218
s_nop 0
v_permlane32_swap_b32 v217, v219
v_add_f32 v216, v216, v218
v_add_f32 v217, v217, v219
s_nop 1
v_permlane16_swap_b32 v216, v217
v_add_f32 v216, v216, v217
s_waitcnt vmcnt(11) lgkmcnt(3)
v_mfma_f32_16x16x32_bf16 v[176:179], v[32:35], a[64:67], v[176:179]
ds_read_b128 v[28:31], v6 offset:39936
global_load_dwordx4 a[112:115], v5, s[20:21] offset:0 sc1
v_mfma_f32_16x16x32_bf16 v[184:187], v[32:35], a[68:71], v[184:187]
global_load_dwordx4 a[116:119], v5, s[20:21] offset:1024 sc1
v_cvt_pk_bf16_f32 v221, v216, 0
s_lshl_b32 s39, s34, 10
v_lshlrev_b32 v224, 16, v221
v_sub_f32 v224, v216, v224
v_cvt_pk_bf16_f32 v220, v216, v224
s_add_u32 s39, s39, 151552
v_mov_b32 v223, 0
s_waitcnt vmcnt(12)
v_lshl_add_u32 v221, v235, 16, v221
v_mfma_f32_16x16x32_bf16 v[180:183], v[36:39], a[64:67], v[180:183]
ds_read_b128 v[32:35], v6 offset:40960
v_mov_b32 v222, v235
v_mfma_f32_16x16x32_bf16 v[188:191], v[36:39], a[68:71], v[188:191]
v_lshl_add_u32 v233, v233, 4, s39
v_mfma_f32_16x16x32_bf16 v[192:195], v[40:43], a[64:67], v[192:195]
ds_read_b128 v[36:39], v6 offset:41984
ds_write_b128 v233, v[220:223]
v_mfma_f32_16x16x32_bf16 v[200:203], v[40:43], a[68:71], v[200:203]
v_mfma_f32_16x16x32_bf16 v[196:199], v[44:47], a[64:67], v[196:199]
ds_read_b128 v[40:43], v6 offset:43008
global_load_dwordx4 a[120:123], v5, s[20:21] offset:2048 sc1
v_mfma_f32_16x16x32_bf16 v[204:207], v[44:47], a[68:71], v[204:207]
s_waitcnt vmcnt(11) lgkmcnt(4)
v_mfma_f32_16x16x32_bf16 v[176:179], v[16:19], a[72:75], v[176:179]
ds_read_b128 v[44:47], v6 offset:44032
v_mfma_f32_16x16x32_bf16 v[184:187], v[16:19], a[76:79], v[184:187]
global_load_dwordx4 a[124:127], v5, s[20:21] offset:3072 sc1
v_mfma_f32_16x16x32_bf16 v[180:183], v[20:23], a[72:75], v[180:183]
ds_read_b128 v[16:19], v6 offset:45056
v_mfma_f32_16x16x32_bf16 v[188:191], v[20:23], a[76:79], v[188:191]
v_mfma_f32_16x16x32_bf16 v[192:195], v[24:27], a[72:75], v[192:195]
ds_read_b128 v[20:23], v6 offset:46080
v_mfma_f32_16x16x32_bf16 v[200:203], v[24:27], a[76:79], v[200:203]
v_mfma_f32_16x16x32_bf16 v[196:199], v[28:31], a[72:75], v[196:199]
ds_read_b128 v[24:27], v6 offset:47104
v_add_u32 v5, s61, v5
v_mfma_f32_16x16x32_bf16 v[204:207], v[28:31], a[76:79], v[204:207]
global_load_dwordx4 a[128:131], v5, s[20:21] offset:-4096 sc1
s_waitcnt lgkmcnt(5)
s_barrier
s_waitcnt vmcnt(11)
v_mfma_f32_16x16x32_bf16 v[176:179], v[32:35], a[80:83], v[176:179]
ds_read_b128 v[28:31], v6 offset:48128
v_mfma_f32_16x16x32_bf16 v[184:187], v[32:35], a[84:87], v[184:187]
global_load_dwordx4 a[132:135], v5, s[20:21] offset:-3072 sc1
v_mfma_f32_16x16x32_bf16 v[180:183], v[36:39], a[80:83], v[180:183]
s_barrier
ds_read_b128 v[32:35], v6 offset:49152
v_mfma_f32_16x16x32_bf16 v[188:191], v[36:39], a[84:87], v[188:191]
s_waitcnt vmcnt(10) lgkmcnt(3)
v_mfma_f32_16x16x32_bf16 v[192:195], v[40:43], a[80:83], v[192:195]
ds_read_b128 v[36:39], v6 offset:50176
v_mfma_f32_16x16x32_bf16 v[200:203], v[40:43], a[84:87], v[200:203]
global_load_dwordx4 a[136:139], v5, s[20:21] offset:-2048 sc1
global_load_dwordx4 a[140:143], v5, s[20:21] offset:-1024 sc1
v_mfma_f32_16x16x32_bf16 v[196:199], v[44:47], a[80:83], v[196:199]
ds_read_b128 v[40:43], v6 offset:51200
v_mfma_f32_16x16x32_bf16 v[204:207], v[44:47], a[84:87], v[204:207]
v_mfma_f32_16x16x32_bf16 v[176:179], v[16:19], a[88:91], v[176:179]
ds_read_b128 v[44:47], v6 offset:52224
v_mfma_f32_16x16x32_bf16 v[184:187], v[16:19], a[92:95], v[184:187]
global_load_dwordx4 a[144:147], v5, s[20:21] offset:0 sc1
global_load_dwordx4 a[148:151], v5, s[20:21] offset:1024 sc1
v_mfma_f32_16x16x32_bf16 v[180:183], v[20:23], a[88:91], v[180:183]
ds_read_b128 v[16:19], v6 offset:53248
v_mfma_f32_16x16x32_bf16 v[188:191], v[20:23], a[92:95], v[188:191]
s_waitcnt vmcnt(12) lgkmcnt(3)
v_mfma_f32_16x16x32_bf16 v[192:195], v[24:27], a[88:91], v[192:195]
ds_read_b128 v[20:23], v6 offset:54272
v_mfma_f32_16x16x32_bf16 v[200:203], v[24:27], a[92:95], v[200:203]
global_load_dwordx4 a[152:155], v5, s[20:21] offset:2048 sc1
global_load_dwordx4 a[156:159], v5, s[20:21] offset:3072 sc1
v_mfma_f32_16x16x32_bf16 v[196:199], v[28:31], a[88:91], v[196:199]
ds_read_b128 v[24:27], v6 offset:55296
v_mfma_f32_16x16x32_bf16 v[204:207], v[28:31], a[92:95], v[204:207]
v_mfma_f32_16x16x32_bf16 v[176:179], v[32:35], a[96:99], v[176:179]
ds_read_b128 v[28:31], v6 offset:56320
v_mfma_f32_16x16x32_bf16 v[184:187], v[32:35], a[100:103], v[184:187]
v_add_u32 v5, 8192, v5
v_mfma_f32_16x16x32_bf16 v[180:183], v[36:39], a[96:99], v[180:183]
ds_read_b128 v[32:35], v6 offset:57344
global_load_dwordx4 a[160:163], v5, s[20:21] offset:-4096 sc1
v_mfma_f32_16x16x32_bf16 v[188:191], v[36:39], a[100:103], v[188:191]
global_load_dwordx4 a[164:167], v5, s[20:21] offset:-3072 sc1
s_waitcnt vmcnt(14) lgkmcnt(3)
v_mfma_f32_16x16x32_bf16 v[192:195], v[40:43], a[96:99], v[192:195]
ds_read_b128 v[36:39], v6 offset:58368
v_mfma_f32_16x16x32_bf16 v[200:203], v[40:43], a[100:103], v[200:203]
global_load_dwordx4 a[168:171], v5, s[20:21] offset:-2048 sc1
global_load_dwordx4 a[172:175], v5, s[20:21] offset:-1024 sc1
v_mfma_f32_16x16x32_bf16 v[196:199], v[44:47], a[96:99], v[196:199]
ds_read_b128 v[40:43], v6 offset:59392
v_mfma_f32_16x16x32_bf16 v[204:207], v[44:47], a[100:103], v[204:207]
v_mfma_f32_16x16x32_bf16 v[176:179], v[16:19], a[104:107], v[176:179]
ds_read_b128 v[44:47], v6 offset:60416
v_mfma_f32_16x16x32_bf16 v[184:187], v[16:19], a[108:111], v[184:187]
global_load_dwordx4 a[176:179], v5, s[20:21] offset:0 sc1
global_load_dwordx4 a[180:183], v5, s[20:21] offset:1024 sc1
v_mfma_f32_16x16x32_bf16 v[180:183], v[20:23], a[104:107], v[180:183]
ds_read_b128 v[16:19], v6 offset:61440
v_mfma_f32_16x16x32_bf16 v[188:191], v[20:23], a[108:111], v[188:191]
s_waitcnt vmcnt(16) lgkmcnt(3)
v_mfma_f32_16x16x32_bf16 v[192:195], v[24:27], a[104:107], v[192:195]
ds_read_b128 v[20:23], v6 offset:62464
v_mfma_f32_16x16x32_bf16 v[200:203], v[24:27], a[108:111], v[200:203]
global_load_dwordx4 a[184:187], v5, s[20:21] offset:2048 sc1
global_load_dwordx4 a[188:191], v5, s[20:21] offset:3072 sc1
v_mfma_f32_16x16x32_bf16 v[196:199], v[28:31], a[104:107], v[196:199]
ds_read_b128 v[24:27], v6 offset:63488
v_mfma_f32_16x16x32_bf16 v[204:207], v[28:31], a[108:111], v[204:207]
v_mfma_f32_16x16x32_bf16 v[176:179], v[32:35], a[112:115], v[176:179]
ds_read_b128 v[28:31], v6 offset:64512
v_mfma_f32_16x16x32_bf16 v[184:187], v[32:35], a[116:119], v[184:187]
v_add_u32 v5, s60, v5
v_mfma_f32_16x16x32_bf16 v[180:183], v[36:39], a[112:115], v[180:183]
s_barrier
ds_read_b128 v[32:35], v7 offset:0
v_mfma_f32_16x16x32_bf16 v[188:191], v[36:39], a[116:119], v[188:191]
global_load_dwordx4 a[192:195], v5, s[20:21] offset:-4096 sc1
s_waitcnt vmcnt(17) lgkmcnt(3)
v_mfma_f32_16x16x32_bf16 v[192:195], v[40:43], a[112:115], v[192:195]
ds_read_b128 v[36:39], v7 offset:1024
global_load_dwordx4 a[196:199], v5, s[20:21] offset:-3072 sc1
v_mfma_f32_16x16x32_bf16 v[200:203], v[40:43], a[116:119], v[200:203]
global_load_dwordx4 a[200:203], v5, s[20:21] offset:-2048 sc1
global_load_dwordx4 a[204:207], v5, s[20:21] offset:-1024 sc1
v_mfma_f32_16x16x32_bf16 v[196:199], v[44:47], a[112:115], v[196:199]
ds_read_b128 v[40:43], v7 offset:2048
v_mfma_f32_16x16x32_bf16 v[204:207], v[44:47], a[116:119], v[204:207]
v_mfma_f32_16x16x32_bf16 v[176:179], v[16:19], a[120:123], v[176:179]
ds_read_b128 v[44:47], v7 offset:3072
v_mfma_f32_16x16x32_bf16 v[184:187], v[16:19], a[124:127], v[184:187]
global_load_dwordx4 a[208:211], v5, s[20:21] offset:0 sc1
global_load_dwordx4 a[212:215], v5, s[20:21] offset:1024 sc1
v_mfma_f32_16x16x32_bf16 v[180:183], v[20:23], a[120:123], v[180:183]
ds_read_b128 v[16:19], v7 offset:4096
v_mfma_f32_16x16x32_bf16 v[188:191], v[20:23], a[124:127], v[188:191]
s_waitcnt vmcnt(20) lgkmcnt(3)
v_mfma_f32_16x16x32_bf16 v[192:195], v[24:27], a[120:123], v[192:195]
ds_read_b128 v[20:23], v7 offset:5120
v_mfma_f32_16x16x32_bf16 v[200:203], v[24:27], a[124:127], v[200:203]
global_load_dwordx4 a[216:219], v5, s[20:21] offset:2048 sc1
global_load_dwordx4 a[220:223], v5, s[20:21] offset:3072 sc1
v_mfma_f32_16x16x32_bf16 v[196:199], v[28:31], a[120:123], v[196:199]
ds_read_b128 v[24:27], v7 offset:6144
v_mfma_f32_16x16x32_bf16 v[204:207], v[28:31], a[124:127], v[204:207]
v_mfma_f32_16x16x32_bf16 v[176:179], v[32:35], a[128:131], v[176:179]
ds_read_b128 v[28:31], v7 offset:7168
v_mfma_f32_16x16x32_bf16 v[184:187], v[32:35], a[132:135], v[184:187]
v_add_u32 v5, 8192, v5
v_mfma_f32_16x16x32_bf16 v[180:183], v[36:39], a[128:131], v[180:183]
ds_read_b128 v[32:35], v7 offset:8192
global_load_dwordx4 a[224:227], v5, s[20:21] offset:-4096 sc1
v_mfma_f32_16x16x32_bf16 v[188:191], v[36:39], a[132:135], v[188:191]
global_load_dwordx4 a[228:231], v5, s[20:21] offset:-3072 sc1
s_waitcnt vmcnt(20) lgkmcnt(3)
v_mfma_f32_16x16x32_bf16 v[176:179], v[40:43], a[136:139], v[176:179]
ds_read_b128 v[36:39], v7 offset:9216
v_mfma_f32_16x16x32_bf16 v[184:187], v[40:43], a[140:143], v[184:187]
global_load_dwordx4 a[232:235], v5, s[20:21] offset:-2048 sc1
global_load_dwordx4 a[236:239], v5, s[20:21] offset:-1024 sc1
v_mfma_f32_16x16x32_bf16 v[180:183], v[44:47], a[136:139], v[180:183]
ds_read_b128 v[40:43], v7 offset:10240
v_mfma_f32_16x16x32_bf16 v[188:191], v[44:47], a[140:143], v[188:191]
v_mfma_f32_16x16x32_bf16 v[176:179], v[16:19], a[144:147], v[176:179]
ds_read_b128 v[44:47], v7 offset:11264
v_mfma_f32_16x16x32_bf16 v[184:187], v[16:19], a[148:151], v[184:187]
global_load_dwordx4 a[240:243], v5, s[20:21] offset:0 sc1
global_load_dwordx4 a[244:247], v5, s[20:21] offset:1024 sc1
v_mfma_f32_16x16x32_bf16 v[180:183], v[20:23], a[144:147], v[180:183]
ds_read_b128 v[16:19], v7 offset:12288
v_mfma_f32_16x16x32_bf16 v[188:191], v[20:23], a[148:151], v[188:191]
s_waitcnt vmcnt(20) lgkmcnt(3)
v_mfma_f32_16x16x32_bf16 v[176:179], v[24:27], a[152:155], v[176:179]
ds_read_b128 v[20:23], v7 offset:13312
v_mfma_f32_16x16x32_bf16 v[184:187], v[24:27], a[156:159], v[184:187]
global_load_dwordx4 a[248:251], v5, s[20:21] offset:2048 sc1
global_load_dwordx4 a[252:255], v5, s[20:21] offset:3072 sc1
v_mfma_f32_16x16x32_bf16 v[180:183], v[28:31], a[152:155], v[180:183]
ds_read_b128 v[24:27], v7 offset:14336
v_mfma_f32_16x16x32_bf16 v[188:191], v[28:31], a[156:159], v[188:191]
v_mfma_f32_16x16x32_bf16 v[176:179], v[32:35], a[160:163], v[176:179]
ds_read_b128 v[28:31], v7 offset:15360
v_mfma_f32_16x16x32_bf16 v[184:187], v[32:35], a[164:167], v[184:187]
v_mfma_f32_16x16x32_bf16 v[180:183], v[36:39], a[160:163], v[180:183]
s_barrier
ds_read_b128 v[32:35], v7 offset:16384
v_mfma_f32_16x16x32_bf16 v[188:191], v[36:39], a[164:167], v[188:191]
s_waitcnt vmcnt(18) lgkmcnt(3)
v_mfma_f32_16x16x32_bf16 v[176:179], v[40:43], a[168:171], v[176:179]
ds_read_b128 v[36:39], v7 offset:17408
v_mfma_f32_16x16x32_bf16 v[184:187], v[40:43], a[172:175], v[184:187]
v_mfma_f32_16x16x32_bf16 v[180:183], v[44:47], a[168:171], v[180:183]
ds_read_b128 v[40:43], v7 offset:18432
s_add_u32 m0, s43, 114688
v_mfma_f32_16x16x32_bf16 v[188:191], v[44:47], a[172:175], v[188:191]
v_add_u32 v4, 16384, v4
v_mfma_f32_16x16x32_bf16 v[176:179], v[16:19], a[176:179], v[176:179]
ds_read_b128 v[44:47], v7 offset:19456
global_load_lds_dwordx4 v4, s[20:21] offset:0 sc1
v_mfma_f32_16x16x32_bf16 v[184:187], v[16:19], a[180:183], v[184:187]
v_mfma_f32_16x16x32_bf16 v[180:183], v[20:23], a[176:179], v[180:183]
ds_read_b128 v[16:19], v7 offset:20480
global_load_lds_dwordx4 v4, s[20:21] offset:1024 sc1
v_mfma_f32_16x16x32_bf16 v[188:191], v[20:23], a[180:183], v[188:191]
global_load_lds_dwordx4 v4, s[20:21] offset:2048 sc1
s_waitcnt vmcnt(17) lgkmcnt(3)
v_mfma_f32_16x16x32_bf16 v[176:179], v[24:27], a[184:187], v[176:179]
ds_read_b128 v[20:23], v7 offset:21504
global_load_lds_dwordx4 v4, s[20:21] offset:3072 sc1
v_mfma_f32_16x16x32_bf16 v[184:187], v[24:27], a[188:191], v[184:187]
v_mfma_f32_16x16x32_bf16 v[180:183], v[28:31], a[184:187], v[180:183]
ds_read_b128 v[24:27], v7 offset:22528
v_mfma_f32_16x16x32_bf16 v[188:191], v[28:31], a[188:191], v[188:191]
v_mfma_f32_16x16x32_bf16 v[176:179], v[32:35], a[192:195], v[176:179]
ds_read_b128 v[28:31], v7 offset:23552
v_mfma_f32_16x16x32_bf16 v[184:187], v[32:35], a[196:199], v[184:187]
v_mfma_f32_16x16x32_bf16 v[180:183], v[36:39], a[192:195], v[180:183]
ds_read_b128 v[32:35], v7 offset:24576
v_mfma_f32_16x16x32_bf16 v[188:191], v[36:39], a[196:199], v[188:191]
s_waitcnt vmcnt(14) lgkmcnt(3)
v_mfma_f32_16x16x32_bf16 v[176:179], v[40:43], a[200:203], v[176:179]
ds_read_b128 v[36:39], v7 offset:25600
v_mfma_f32_16x16x32_bf16 v[184:187], v[40:43], a[204:207], v[184:187]
v_mfma_f32_16x16x32_bf16 v[180:183], v[44:47], a[200:203], v[180:183]
ds_read_b128 v[40:43], v7 offset:26624
s_add_u32 m0, s43, 0
v_mfma_f32_16x16x32_bf16 v[188:191], v[44:47], a[204:207], v[188:191]
v_add_u32 v4, 16384, v4
v_mfma_f32_16x16x32_bf16 v[176:179], v[16:19], a[208:211], v[176:179]
ds_read_b128 v[44:47], v7 offset:27648
global_load_lds_dwordx4 v4, s[20:21] offset:0 sc1
v_mfma_f32_16x16x32_bf16 v[184:187], v[16:19], a[212:215], v[184:187]
v_mfma_f32_16x16x32_bf16 v[180:183], v[20:23], a[208:211], v[180:183]
ds_read_b128 v[16:19], v7 offset:28672
global_load_lds_dwordx4 v4, s[20:21] offset:1024 sc1
v_mfma_f32_16x16x32_bf16 v[188:191], v[20:23], a[212:215], v[188:191]
s_waitcnt vmcnt(12) lgkmcnt(3)
v_mfma_f32_16x16x32_bf16 v[176:179], v[24:27], a[216:219], v[176:179]
ds_read_b128 v[20:23], v7 offset:29696
v_mfma_f32_16x16x32_bf16 v[184:187], v[24:27], a[220:223], v[184:187]
v_mfma_f32_16x16x32_bf16 v[180:183], v[28:31], a[216:219], v[180:183]
ds_read_b128 v[24:27], v7 offset:30720
v_mfma_f32_16x16x32_bf16 v[188:191], v[28:31], a[220:223], v[188:191]
v_mfma_f32_16x16x32_bf16 v[176:179], v[32:35], a[224:227], v[176:179]
ds_read_b128 v[28:31], v7 offset:31744
global_load_lds_dwordx4 v4, s[20:21] offset:2048 sc1
v_mfma_f32_16x16x32_bf16 v[184:187], v[32:35], a[228:231], v[184:187]
v_mfma_f32_16x16x32_bf16 v[180:183], v[36:39], a[224:227], v[180:183]
s_barrier
ds_read_b128 v[32:35], v7 offset:32768
v_mfma_f32_16x16x32_bf16 v[188:191], v[36:39], a[228:231], v[188:191]
s_waitcnt vmcnt(9) lgkmcnt(3)
v_mfma_f32_16x16x32_bf16 v[176:179], v[40:43], a[232:235], v[176:179]
ds_read_b128 v[36:39], v7 offset:33792
global_load_lds_dwordx4 v4, s[20:21] offset:3072 sc1
v_mfma_f32_16x16x32_bf16 v[184:187], v[40:43], a[236:239], v[184:187]
v_mfma_f32_16x16x32_bf16 v[180:183], v[44:47], a[232:235], v[180:183]
ds_read_b128 v[40:43], v7 offset:34816
v_mfma_f32_16x16x32_bf16 v[188:191], v[44:47], a[236:239], v[188:191]
v_mfma_f32_16x16x32_bf16 v[176:179], v[16:19], a[240:243], v[176:179]
ds_read_b128 v[44:47], v7 offset:35840
s_add_u32 m0, s43, 16384
v_mfma_f32_16x16x32_bf16 v[184:187], v[16:19], a[244:247], v[184:187]
v_add_u32 v4, 16384, v4
v_mfma_f32_16x16x32_bf16 v[180:183], v[20:23], a[240:243], v[180:183]
ds_read_b128 v[16:19], v7 offset:36864
global_load_lds_dwordx4 v4, s[20:21] offset:0 sc1
v_mfma_f32_16x16x32_bf16 v[188:191], v[20:23], a[244:247], v[188:191]
s_waitcnt vmcnt(9) lgkmcnt(3)
v_mfma_f32_16x16x32_bf16 v[176:179], v[24:27], a[248:251], v[176:179]
ds_read_b128 v[20:23], v7 offset:37888
global_load_lds_dwordx4 v4, s[20:21] offset:1024 sc1
v_mfma_f32_16x16x32_bf16 v[184:187], v[24:27], a[252:255], v[184:187]
v_mfma_f32_16x16x32_bf16 v[180:183], v[28:31], a[248:251], v[180:183]
ds_read_b128 v[24:27], v7 offset:38912
v_mfma_f32_16x16x32_bf16 v[188:191], v[28:31], a[252:255], v[188:191]
v_mfma_f32_16x16x32_bf16 v[192:195], v[32:35], a[128:131], v[192:195]
ds_read_b128 v[28:31], v7 offset:39936
v_mfma_f32_16x16x32_bf16 v[200:203], v[32:35], a[132:135], v[200:203]
v_cvt_pk_bf16_f32 v48, v176, v177
v_cvt_pk_bf16_f32 v49, v178, v179
s_nop 0
v_cvt_pk_bf16_f32 v50, v180, v181
v_cvt_pk_bf16_f32 v51, v182, v183
v_cvt_pk_bf16_f32 v52, v184, v185
v_cvt_pk_bf16_f32 v53, v186, v187
v_cvt_pk_bf16_f32 v54, v188, v189
v_cvt_pk_bf16_f32 v55, v190, v191
s_add_u32 s37, s48, 7602176
v_mfma_f32_16x16x32_bf16 v[196:199], v[36:39], a[128:131], v[196:199]
ds_read_b128 v[32:35], v7 offset:40960
global_load_lds_dwordx4 v4, s[20:21] offset:2048 sc1
buffer_store_dwordx4 v[48:51], v0, s[20:23], s37 offen offset:0 sc1
buffer_store_dwordx4 v[52:55], v0, s[20:23], s37 offen offset:1024 sc1
v_mfma_f32_16x16x32_bf16 v[204:207], v[36:39], a[132:135], v[204:207]
s_mov_b32 s58, 0
v_mov_b32 v212, 0x3f803f80
v_dot2_f32_bf16 v208, v48, v212, 0
v_dot2_f32_bf16 v209, v48, v48, 0
v_dot2_f32_bf16 v210, v52, v212, 0
v_dot2_f32_bf16 v211, v52, v52, 0
v_dot2_f32_bf16 v208, v49, v212, v208
v_dot2_f32_bf16 v209, v49, v49, v209
v_dot2_f32_bf16 v210, v53, v212, v210
v_dot2_f32_bf16 v211, v53, v53, v211
v_dot2_f32_bf16 v208, v50, v212, v208
v_dot2_f32_bf16 v209, v50, v50, v209
v_dot2_f32_bf16 v210, v54, v212, v210
v_dot2_f32_bf16 v211, v54, v54, v211
v_dot2_f32_bf16 v208, v51, v212, v208
v_dot2_f32_bf16 v209, v51, v51, v209
v_dot2_f32_bf16 v210, v55, v212, v210
v_dot2_f32_bf16 v211, v55, v55, v211
s_waitcnt lgkmcnt(3)
v_mfma_f32_16x16x32_bf16 v[192:195], v[40:43], a[136:139], v[192:195]
ds_read_b128 v[36:39], v7 offset:41984
v_mfma_f32_16x16x32_bf16 v[200:203], v[40:43], a[140:143], v[200:203]
v_mfma_f32_16x16x32_bf16 v[196:199], v[44:47], a[136:139], v[196:199]
ds_read_b128 v[40:43], v7 offset:43008
v_mfma_f32_16x16x32_bf16 v[204:207], v[44:47], a[140:143], v[204:207]
v_mfma_f32_16x16x32_bf16 v[192:195], v[16:19], a[144:147], v[192:195]
ds_read_b128 v[44:47], v7 offset:44032
global_load_lds_dwordx4 v4, s[20:21] offset:3072 sc1
v_mfma_f32_16x16x32_bf16 v[200:203], v[16:19], a[148:151], v[200:203]
v_mfma_f32_16x16x32_bf16 v[196:199], v[20:23], a[144:147], v[196:199]
ds_read_b128 v[16:19], v7 offset:45056
v_mfma_f32_16x16x32_bf16 v[204:207], v[20:23], a[148:151], v[204:207]
s_waitcnt vmcnt(10) lgkmcnt(3)
v_mfma_f32_16x16x32_bf16 v[192:195], v[24:27], a[152:155], v[192:195]
ds_read_b128 v[20:23], v7 offset:46080
s_add_u32 m0, s43, 32768
v_mfma_f32_16x16x32_bf16 v[200:203], v[24:27], a[156:159], v[200:203]
v_add_u32 v4, 16384, v4
v_mfma_f32_16x16x32_bf16 v[196:199], v[28:31], a[152:155], v[196:199]
ds_read_b128 v[24:27], v7 offset:47104
global_load_lds_dwordx4 v4, s[20:21] offset:0 sc1
v_mfma_f32_16x16x32_bf16 v[204:207], v[28:31], a[156:159], v[204:207]
v_mfma_f32_16x16x32_bf16 v[192:195], v[32:35], a[160:163], v[192:195]
ds_read_b128 v[28:31], v7 offset:48128
v_mfma_f32_16x16x32_bf16 v[200:203], v[32:35], a[164:167], v[200:203]
v_mfma_f32_16x16x32_bf16 v[196:199], v[36:39], a[160:163], v[196:199]
s_barrier
ds_read_b128 v[32:35], v7 offset:49152
v_mfma_f32_16x16x32_bf16 v[204:207], v[36:39], a[164:167], v[204:207]
global_load_lds_dwordx4 v4, s[20:21] offset:1024 sc1
s_waitcnt lgkmcnt(3)
v_mfma_f32_16x16x32_bf16 v[192:195], v[40:43], a[168:171], v[192:195]
ds_read_b128 v[36:39], v7 offset:50176
v_mfma_f32_16x16x32_bf16 v[200:203], v[40:43], a[172:175], v[200:203]
v_mfma_f32_16x16x32_bf16 v[196:199], v[44:47], a[168:171], v[196:199]
ds_read_b128 v[40:43], v7 offset:51200
global_load_lds_dwordx4 v4, s[20:21] offset:2048 sc1
v_mfma_f32_16x16x32_bf16 v[204:207], v[44:47], a[172:175], v[204:207]
v_mfma_f32_16x16x32_bf16 v[192:195], v[16:19], a[176:179], v[192:195]
ds_read_b128 v[44:47], v7 offset:52224
v_mfma_f32_16x16x32_bf16 v[200:203], v[16:19], a[180:183], v[200:203]
v_mfma_f32_16x16x32_bf16 v[196:199], v[20:23], a[176:179], v[196:199]
ds_read_b128 v[16:19], v7 offset:53248
global_load_lds_dwordx4 v4, s[20:21] offset:3072 sc1
v_mfma_f32_16x16x32_bf16 v[204:207], v[20:23], a[180:183], v[204:207]
s_waitcnt lgkmcnt(3)
v_mfma_f32_16x16x32_bf16 v[192:195], v[24:27], a[184:187], v[192:195]
ds_read_b128 v[20:23], v7 offset:54272
v_mfma_f32_16x16x32_bf16 v[200:203], v[24:27], a[188:191], v[200:203]
v_mfma_f32_16x16x32_bf16 v[196:199], v[28:31], a[184:187], v[196:199]
ds_read_b128 v[24:27], v7 offset:55296
s_add_u32 m0, s43, 49152
v_mfma_f32_16x16x32_bf16 v[204:207], v[28:31], a[188:191], v[204:207]
v_add_u32 v4, 16384, v4
v_mfma_f32_16x16x32_bf16 v[192:195], v[32:35], a[192:195], v[192:195]
ds_read_b128 v[28:31], v7 offset:56320
global_load_lds_dwordx4 v4, s[20:21] offset:0 sc1
v_mfma_f32_16x16x32_bf16 v[200:203], v[32:35], a[196:199], v[200:203]
v_mfma_f32_16x16x32_bf16 v[196:199], v[36:39], a[192:195], v[196:199]
ds_read_b128 v[32:35], v7 offset:57344
v_mfma_f32_16x16x32_bf16 v[204:207], v[36:39], a[196:199], v[204:207]
s_waitcnt lgkmcnt(3)
v_mfma_f32_16x16x32_bf16 v[192:195], v[40:43], a[200:203], v[192:195]
ds_read_b128 v[36:39], v7 offset:58368
global_load_lds_dwordx4 v4, s[20:21] offset:1024 sc1
v_mfma_f32_16x16x32_bf16 v[200:203], v[40:43], a[204:207], v[200:203]
v_mfma_f32_16x16x32_bf16 v[196:199], v[44:47], a[200:203], v[196:199]
ds_read_b128 v[40:43], v7 offset:59392
v_mfma_f32_16x16x32_bf16 v[204:207], v[44:47], a[204:207], v[204:207]
s_waitcnt vmcnt(7)
s_atomic_add s45, s[20:21], s53 offset:8
v_mfma_f32_16x16x32_bf16 v[192:195], v[16:19], a[208:211], v[192:195]
ds_read_b128 v[44:47], v7 offset:60416
global_load_lds_dwordx4 v4, s[20:21] offset:2048 sc1
v_mfma_f32_16x16x32_bf16 v[200:203], v[16:19], a[212:215], v[200:203]
v_mfma_f32_16x16x32_bf16 v[196:199], v[20:23], a[208:211], v[196:199]
ds_read_b128 v[16:19], v7 offset:61440
v_mfma_f32_16x16x32_bf16 v[204:207], v[20:23], a[212:215], v[204:207]
s_waitcnt lgkmcnt(4)
v_mfma_f32_16x16x32_bf16 v[192:195], v[24:27], a[216:219], v[192:195]
ds_read_b128 v[20:23], v7 offset:62464
global_load_lds_dwordx4 v4, s[20:21] offset:3072 sc1
v_mfma_f32_16x16x32_bf16 v[200:203], v[24:27], a[220:223], v[200:203]
v_mfma_f32_16x16x32_bf16 v[196:199], v[28:31], a[216:219], v[196:199]
ds_read_b128 v[24:27], v7 offset:63488
v_mfma_f32_16x16x32_bf16 v[204:207], v[28:31], a[220:223], v[204:207]
v_mfma_f32_16x16x32_bf16 v[192:195], v[32:35], a[224:227], v[192:195]
ds_read_b128 v[28:31], v7 offset:64512
s_add_u32 m0, s43, 65536
v_mfma_f32_16x16x32_bf16 v[200:203], v[32:35], a[228:231], v[200:203]
v_add_u32 v4, 16384, v4
s_waitcnt lgkmcnt(4)
v_mfma_f32_16x16x32_bf16 v[196:199], v[36:39], a[224:227], v[196:199]
s_barrier
ds_read_b128 v[32:35], v6 offset:0
v_mfma_f32_16x16x32_bf16 v[204:207], v[36:39], a[228:231], v[204:207]
global_load_lds_dwordx4 v4, s[20:21] offset:0 sc1
v_mfma_f32_16x16x32_bf16 v[192:195], v[40:43], a[232:235], v[192:195]
ds_read_b128 v[36:39], v6 offset:1024
v_mfma_f32_16x16x32_bf16 v[200:203], v[40:43], a[236:239], v[200:203]
v_mfma_f32_16x16x32_bf16 v[196:199], v[44:47], a[232:235], v[196:199]
ds_read_b128 v[40:43], v6 offset:2048
global_load_lds_dwordx4 v4, s[20:21] offset:1024 sc1
v_mfma_f32_16x16x32_bf16 v[204:207], v[44:47], a[236:239], v[204:207]
s_waitcnt lgkmcnt(4)
v_mfma_f32_16x16x32_bf16 v[192:195], v[16:19], a[240:243], v[192:195]
ds_read_b128 v[44:47], v6 offset:3072
v_mfma_f32_16x16x32_bf16 v[200:203], v[16:19], a[244:247], v[200:203]
v_mfma_f32_16x16x32_bf16 v[196:199], v[20:23], a[240:243], v[196:199]
ds_read_b128 v[16:19], v6 offset:4096
global_load_lds_dwordx4 v4, s[20:21] offset:2048 sc1
v_mfma_f32_16x16x32_bf16 v[204:207], v[20:23], a[244:247], v[204:207]
v_mfma_f32_16x16x32_bf16 v[192:195], v[24:27], a[248:251], v[192:195]
ds_read_b128 v[20:23], v6 offset:5120
v_mfma_f32_16x16x32_bf16 v[200:203], v[24:27], a[252:255], v[200:203]
s_waitcnt lgkmcnt(4)
v_mfma_f32_16x16x32_bf16 v[196:199], v[28:31], a[248:251], v[196:199]
ds_read_b128 v[24:27], v6 offset:6144
global_load_lds_dwordx4 v4, s[20:21] offset:3072 sc1
v_mfma_f32_16x16x32_bf16 v[204:207], v[28:31], a[252:255], v[204:207]
s_nop 0
v_cvt_pk_bf16_f32 v56, v192, v193
v_cvt_pk_bf16_f32 v57, v194, v195
s_nop 1
v_cvt_pk_bf16_f32 v58, v196, v197
v_cvt_pk_bf16_f32 v59, v198, v199
v_cvt_pk_bf16_f32 v60, v200, v201
v_cvt_pk_bf16_f32 v61, v202, v203
v_cvt_pk_bf16_f32 v62, v204, v205
v_cvt_pk_bf16_f32 v63, v206, v207
s_add_u32 s37, s48, 7634944
s_atomic_add s58, s[20:21], s53 offset:8 glc
buffer_store_dwordx4 v[56:59], v0, s[20:23], s37 offen offset:0 sc1
buffer_store_dwordx4 v[60:63], v0, s[20:23], s37 offen offset:1024 sc1
v_dot2_f32_bf16 v208, v56, v212, v208
v_dot2_f32_bf16 v209, v56, v56, v209
v_dot2_f32_bf16 v210, v60, v212, v210
v_dot2_f32_bf16 v211, v60, v60, v211
v_dot2_f32_bf16 v208, v57, v212, v208
v_dot2_f32_bf16 v209, v57, v57, v209
v_dot2_f32_bf16 v210, v61, v212, v210
v_dot2_f32_bf16 v211, v61, v61, v211
v_dot2_f32_bf16 v208, v58, v212, v208
v_dot2_f32_bf16 v209, v58, v58, v209
v_dot2_f32_bf16 v210, v62, v212, v210
v_dot2_f32_bf16 v211, v62, v62, v211
v_dot2_f32_bf16 v208, v59, v212, v208
v_dot2_f32_bf16 v209, v59, v59, v209
v_dot2_f32_bf16 v210, v63, v212, v210
v_dot2_f32_bf16 v211, v63, v63, v211
s_add_u32 s37, s53, 65536
s_nop 0
v_permlane32_swap_b32 v208, v210
v_permlane32_swap_b32 v209, v211
v_add_f32 v208, v208, v210
v_add_f32 v209, v209, v211
s_nop 1
v_permlane16_swap_b32 v208, v209
v_add_f32 v208, v208, v209
buffer_atomic_add_f32 v208, v3, s[20:23], s37 offen sc1
s_cmp_lt_u32 s58, 16
s_cbranch_scc0 L_back4
L_slow4:
s_waitcnt lgkmcnt(0)
s_cmp_ge_u32 s58, 16
s_cbranch_scc1 L_back4
s_mov_b32 s58, 0
s_atomic_add s58, s[20:21], s53 offset:8 glc
s_sub_u32 s46, s46, 1
s_cbranch_scc0 L_slow4
s_endpgm
L_back4:
v_add_u32 v5, 7606272, v14
global_load_dwordx4 a[0:3], v5, s[20:21] offset:-4096 sc1
global_load_dwordx4 a[4:7], v5, s[20:21] offset:-3072 sc1
global_load_dwordx4 a[8:11], v5, s[20:21] offset:-2048 sc1
global_load_dwordx4 a[12:15], v5, s[20:21] offset:-1024 sc1
global_load_dwordx4 a[16:19], v5, s[20:21] offset:0 sc1
global_load_dwordx4 a[20:23], v5, s[20:21] offset:1024 sc1
global_load_dwordx4 a[24:27], v5, s[20:21] offset:2048 sc1
global_load_dwordx4 a[28:31], v5, s[20:21] offset:3072 sc1
s_waitcnt vmcnt(6)
v_mfma_f32_16x16x32_bf16 v[80:83], v[32:35], a[0:3], 0
ds_read_b128 v[28:31], v6 offset:7168
v_add_u32 v5, 8192, v5
v_mfma_f32_16x16x32_bf16 v[88:91], v[32:35], a[4:7], 0
global_load_dwordx4 a[32:35], v5, s[20:21] offset:-4096 sc1
global_load_dwordx4 a[36:39], v5, s[20:21] offset:-3072 sc1
s_mov_b32 s58, 0
v_mfma_f32_16x16x32_bf16 v[84:87], v[36:39], a[0:3], 0
ds_read_b128 v[32:35], v6 offset:8192
global_load_dwordx4 a[40:43], v5, s[20:21] offset:-2048 sc1
v_mfma_f32_16x16x32_bf16 v[92:95], v[36:39], a[4:7], 0
global_load_dwordx4 a[44:47], v5, s[20:21] offset:-1024 sc1
s_atomic_add s45, s[20:21], s53 offset:12
s_waitcnt lgkmcnt(4)
v_mfma_f32_16x16x32_bf16 v[96:99], v[40:43], a[0:3], 0
ds_read_b128 v[36:39], v6 offset:9216
global_load_dwordx4 a[48:51], v5, s[20:21] offset:0 sc1
v_mfma_f32_16x16x32_bf16 v[104:107], v[40:43], a[4:7], 0
v_mfma_f32_16x16x32_bf16 v[100:103], v[44:47], a[0:3], 0
ds_read_b128 v[40:43], v6 offset:10240
v_mfma_f32_16x16x32_bf16 v[108:111], v[44:47], a[4:7], 0
v_mfma_f32_16x16x32_bf16 v[112:115], v[16:19], a[0:3], 0
ds_read_b128 v[44:47], v6 offset:11264
global_load_dwordx4 a[52:55], v5, s[20:21] offset:1024 sc1
v_mfma_f32_16x16x32_bf16 v[120:123], v[16:19], a[4:7], 0
s_waitcnt lgkmcnt(4)
v_mfma_f32_16x16x32_bf16 v[116:119], v[20:23], a[0:3], 0
ds_read_b128 v[16:19], v6 offset:12288
v_mfma_f32_16x16x32_bf16 v[124:127], v[20:23], a[4:7], 0
v_mfma_f32_16x16x32_bf16 v[128:131], v[24:27], a[0:3], 0
ds_read_b128 v[20:23], v6 offset:13312
global_load_dwordx4 a[56:59], v5, s[20:21] offset:2048 sc1
v_mfma_f32_16x16x32_bf16 v[136:139], v[24:27], a[4:7], 0
v_mfma_f32_16x16x32_bf16 v[132:135], v[28:31], a[0:3], 0
ds_read_b128 v[24:27], v6 offset:14336
v_mfma_f32_16x16x32_bf16 v[140:143], v[28:31], a[4:7], 0
s_waitcnt vmcnt(11) lgkmcnt(4)
v_mfma_f32_16x16x32_bf16 v[80:83], v[32:35], a[8:11], v[80:83]
ds_read_b128 v[28:31], v6 offset:15360
global_load_dwordx4 a[60:63], v5, s[20:21] offset:3072 sc1
v_mfma_f32_16x16x32_bf16 v[88:91], v[32:35], a[12:15], v[88:91]
v_mfma_f32_16x16x32_bf16 v[84:87], v[36:39], a[8:11], v[84:87]
s_barrier
ds_read_b128 v[32:35], v6 offset:16384
v_mfma_f32_16x16x32_bf16 v[92:95], v[36:39], a[12:15], v[92:95]
v_mfma_f32_16x16x32_bf16 v[96:99], v[40:43], a[8:11], v[96:99]
ds_read_b128 v[36:39], v6 offset:17408
v_mfma_f32_16x16x32_bf16 v[104:107], v[40:43], a[12:15], v[104:107]
s_waitcnt lgkmcnt(4)
v_mfma_f32_16x16x32_bf16 v[100:103], v[44:47], a[8:11], v[100:103]
ds_read_b128 v[40:43], v6 offset:18432
v_add_u32 v5, s60, v5
v_mfma_f32_16x16x32_bf16 v[108:111], v[44:47], a[12:15], v[108:111]
global_load_dwordx4 a[64:67], v5, s[20:21] offset:-4096 sc1
v_mfma_f32_16x16x32_bf16 v[112:115], v[16:19], a[8:11], v[112:115]
ds_read_b128 v[44:47], v6 offset:19456
v_mfma_f32_16x16x32_bf16 v[120:123], v[16:19], a[12:15], v[120:123]
v_mfma_f32_16x16x32_bf16 v[116:119], v[20:23], a[8:11], v[116:119]
ds_read_b128 v[16:19], v6 offset:20480
global_load_dwordx4 a[68:71], v5, s[20:21] offset:-3072 sc1
v_mfma_f32_16x16x32_bf16 v[124:127], v[20:23], a[12:15], v[124:127]
s_waitcnt vmcnt(12) lgkmcnt(4)
v_mfma_f32_16x16x32_bf16 v[128:131], v[24:27], a[8:11], v[128:131]
ds_read_b128 v[20:23], v6 offset:21504
v_mfma_f32_16x16x32_bf16 v[136:139], v[24:27], a[12:15], v[136:139]
v_mfma_f32_16x16x32_bf16 v[132:135], v[28:31], a[8:11], v[132:135]
ds_read_b128 v[24:27], v6 offset:22528
s_add_u32 m0, s43, 81920
v_mfma_f32_16x16x32_bf16 v[140:143], v[28:31], a[12:15], v[140:143]
v_add_u32 v4, 16384, v4
v_mfma_f32_16x16x32_bf16 v[80:83], v[32:35], a[16:19], v[80:83]
ds_read_b128 v[28:31], v6 offset:23552
global_load_lds_dwordx4 v4, s[20:21] offset:0 sc1
v_mfma_f32_16x16x32_bf16 v[88:91], v[32:35], a[20:23], v[88:91]
s_atomic_add s58, s[20:21], s53 offset:12 glc
s_waitcnt lgkmcnt(5)
v_mfma_f32_16x16x32_bf16 v[84:87], v[36:39], a[16:19], v[84:87]
ds_read_b128 v[32:35], v6 offset:24576
global_load_lds_dwordx4 v4, s[20:21] offset:1024 sc1
v_mfma_f32_16x16x32_bf16 v[92:95], v[36:39], a[20:23], v[92:95]
v_mfma_f32_16x16x32_bf16 v[96:99], v[40:43], a[16:19], v[96:99]
ds_read_b128 v[36:39], v6 offset:25600
v_mfma_f32_16x16x32_bf16 v[104:107], v[40:43], a[20:23], v[104:107]
s_waitcnt lgkmcnt(5)
v_mfma_f32_16x16x32_bf16 v[100:103], v[44:47], a[16:19], v[100:103]
ds_read_b128 v[40:43], v6 offset:26624
v_mfma_f32_16x16x32_bf16 v[108:111], v[44:47], a[20:23], v[108:111]
v_mfma_f32_16x16x32_bf16 v[112:115], v[16:19], a[16:19], v[112:115]
ds_read_b128 v[44:47], v6 offset:27648
global_load_lds_dwordx4 v4, s[20:21] offset:2048 sc1
v_mfma_f32_16x16x32_bf16 v[120:123], v[16:19], a[20:23], v[120:123]
s_waitcnt lgkmcnt(5)
v_mfma_f32_16x16x32_bf16 v[116:119], v[20:23], a[16:19], v[116:119]
ds_read_b128 v[16:19], v6 offset:28672
v_mfma_f32_16x16x32_bf16 v[124:127], v[20:23], a[20:23], v[124:127]
v_mfma_f32_16x16x32_bf16 v[128:131], v[24:27], a[16:19], v[128:131]
ds_read_b128 v[20:23], v6 offset:29696
global_load_lds_dwordx4 v4, s[20:21] offset:3072 sc1
v_mfma_f32_16x16x32_bf16 v[136:139], v[24:27], a[20:23], v[136:139]
s_waitcnt vmcnt(14) lgkmcnt(5)
v_mfma_f32_16x16x32_bf16 v[132:135], v[28:31], a[16:19], v[132:135]
ds_read_b128 v[24:27], v6 offset:30720
v_mfma_f32_16x16x32_bf16 v[140:143], v[28:31], a[20:23], v[140:143]
v_mfma_f32_16x16x32_bf16 v[80:83], v[32:35], a[24:27], v[80:83]
ds_read_b128 v[28:31], v6 offset:31744
global_load_dwordx4 a[72:75], v5, s[20:21] offset:-2048 sc1
v_mfma_f32_16x16x32_bf16 v[88:91], v[32:35], a[28:31], v[88:91]
s_waitcnt lgkmcnt(5)
v_mfma_f32_16x16x32_bf16 v[84:87], v[36:39], a[24:27], v[84:87]
s_barrier
ds_read_b128 v[32:35], v6 offset:32768
v_mfma_f32_16x16x32_bf16 v[92:95], v[36:39], a[28:31], v[92:95]
v_mfma_f32_16x16x32_bf16 v[96:99], v[40:43], a[24:27], v[96:99]
ds_read_b128 v[36:39], v6 offset:33792
global_load_dwordx4 a[76:79], v5, s[20:21] offset:-1024 sc1
v_mfma_f32_16x16x32_bf16 v[104:107], v[40:43], a[28:31], v[104:107]
s_waitcnt lgkmcnt(4)
v_mfma_f32_16x16x32_bf16 v[100:103], v[44:47], a[24:27], v[100:103]
ds_read_b128 v[40:43], v6 offset:34816
v_mfma_f32_16x16x32_bf16 v[108:111], v[44:47], a[28:31], v[108:111]
v_mfma_f32_16x16x32_bf16 v[112:115], v[16:19], a[24:27], v[112:115]
ds_read_b128 v[44:47], v6 offset:35840
v_mfma_f32_16x16x32_bf16 v[120:123], v[16:19], a[28:31], v[120:123]
v_mfma_f32_16x16x32_bf16 v[116:119], v[20:23], a[24:27], v[116:119]
ds_read_b128 v[16:19], v6 offset:36864
global_load_dwordx4 a[80:83], v5, s[20:21] offset:0 sc1
v_mfma_f32_16x16x32_bf16 v[124:127], v[20:23], a[28:31], v[124:127]
s_waitcnt vmcnt(15) lgkmcnt(4)
v_mfma_f32_16x16x32_bf16 v[128:131], v[24:27], a[24:27], v[128:131]
ds_read_b128 v[20:23], v6 offset:37888
v_mfma_f32_16x16x32_bf16 v[136:139], v[24:27], a[28:31], v[136:139]
v_mfma_f32_16x16x32_bf16 v[132:135], v[28:31], a[24:27], v[132:135]
ds_read_b128 v[24:27], v6 offset:38912
global_load_dwordx4 a[84:87], v5, s[20:21] offset:1024 sc1
v_mfma_f32_16x16x32_bf16 v[140:143], v[28:31], a[28:31], v[140:143]
v_mfma_f32_16x16x32_bf16 v[80:83], v[32:35], a[32:35], v[80:83]
ds_read_b128 v[28:31], v6 offset:39936
v_mfma_f32_16x16x32_bf16 v[88:91], v[32:35], a[36:39], v[88:91]
s_waitcnt lgkmcnt(4)
v_mfma_f32_16x16x32_bf16 v[84:87], v[36:39], a[32:35], v[84:87]
ds_read_b128 v[32:35], v6 offset:40960
s_add_u32 m0, s43, 98304
v_mfma_f32_16x16x32_bf16 v[92:95], v[36:39], a[36:39], v[92:95]
v_add_u32 v4, 16384, v4
v_mfma_f32_16x16x32_bf16 v[96:99], v[40:43], a[32:35], v[96:99]
ds_read_b128 v[36:39], v6 offset:41984
global_load_lds_dwordx4 v4, s[20:21] offset:0 sc1
v_mfma_f32_16x16x32_bf16 v[104:107], v[40:43], a[36:39], v[104:107]
v_mfma_f32_16x16x32_bf16 v[100:103], v[44:47], a[32:35], v[100:103]
ds_read_b128 v[40:43], v6 offset:43008
global_load_lds_dwordx4 v4, s[20:21] offset:1024 sc1
v_mfma_f32_16x16x32_bf16 v[108:111], v[44:47], a[36:39], v[108:111]
s_waitcnt lgkmcnt(4)
v_mfma_f32_16x16x32_bf16 v[112:115], v[16:19], a[32:35], v[112:115]
ds_read_b128 v[44:47], v6 offset:44032
v_mfma_f32_16x16x32_bf16 v[120:123], v[16:19], a[36:39], v[120:123]
v_mfma_f32_16x16x32_bf16 v[116:119], v[20:23], a[32:35], v[116:119]
ds_read_b128 v[16:19], v6 offset:45056
v_mfma_f32_16x16x32_bf16 v[124:127], v[20:23], a[36:39], v[124:127]
v_mfma_f32_16x16x32_bf16 v[128:131], v[24:27], a[32:35], v[128:131]
ds_read_b128 v[20:23], v6 offset:46080
global_load_lds_dwordx4 v4, s[20:21] offset:2048 sc1
v_mfma_f32_16x16x32_bf16 v[136:139], v[24:27], a[36:39], v[136:139]
s_cmp_lt_u32 s58, 16
s_cbranch_scc0 L_back5
L_slow5:
s_waitcnt lgkmcnt(0)
s_cmp_ge_u32 s58, 16
s_cbranch_scc1 L_back5
s_mov_b32 s58, 0
s_atomic_add s58, s[20:21], s53 offset:12 glc
s_sub_u32 s46, s46, 1
s_cbranch_scc0 L_slow5
s_endpgm
L_back5:
s_add_u32 s37, s53, 65536
v_lshlrev_b32 v212, 2, v2
s_waitcnt vmcnt(17) lgkmcnt(3)
v_mfma_f32_16x16x32_bf16 v[132:135], v[28:31], a[32:35], v[132:135]
ds_read_b128 v[24:27], v6 offset:47104
buffer_load_dwordx4 v[208:211], v212, s[20:23], s37 offen sc1
v_mfma_f32_16x16x32_bf16 v[140:143], v[28:31], a[36:39], v[140:143]
v_mfma_f32_16x16x32_bf16 v[80:83], v[32:35], a[40:43], v[80:83]
ds_read_b128 v[28:31], v6 offset:48128
global_load_lds_dwordx4 v4, s[20:21] offset:3072 sc1
v_mfma_f32_16x16x32_bf16 v[88:91], v[32:35], a[44:47], v[88:91]
v_mfma_f32_16x16x32_bf16 v[84:87], v[36:39], a[40:43], v[84:87]
s_barrier
ds_read_b128 v[32:35], v6 offset:49152
v_mfma_f32_16x16x32_bf16 v[92:95], v[36:39], a[44:47], v[92:95]
v_mfma_f32_16x16x32_bf16 v[96:99], v[40:43], a[40:43], v[96:99]
ds_read_b128 v[36:39], v6 offset:50176
v_mfma_f32_16x16x32_bf16 v[104:107], v[40:43], a[44:47], v[104:107]
s_waitcnt lgkmcnt(3)
v_mfma_f32_16x16x32_bf16 v[100:103], v[44:47], a[40:43], v[100:103]
ds_read_b128 v[40:43], v6 offset:51200
global_load_dwordx4 a[88:91], v5, s[20:21] offset:2048 sc1
v_mfma_f32_16x16x32_bf16 v[108:111], v[44:47], a[44:47], v[108:111]
v_mfma_f32_16x16x32_bf16 v[112:115], v[16:19], a[40:43], v[112:115]
ds_read_b128 v[44:47], v6 offset:52224
v_mfma_f32_16x16x32_bf16 v[120:123], v[16:19], a[44:47], v[120:123]
v_mfma_f32_16x16x32_bf16 v[116:119], v[20:23], a[40:43], v[116:119]
ds_read_b128 v[16:19], v6 offset:53248
global_load_dwordx4 a[92:95], v5, s[20:21] offset:3072 sc1
v_mfma_f32_16x16x32_bf16 v[124:127], v[20:23], a[44:47], v[124:127]
v_mfma_f32_16x16x32_bf16 v[128:131], v[24:27], a[40:43], v[128:131]
ds_read_b128 v[20:23], v6 offset:54272
v_mfma_f32_16x16x32_bf16 v[136:139], v[24:27], a[44:47], v[136:139]
s_waitcnt vmcnt(19) lgkmcnt(3)
v_mfma_f32_16x16x32_bf16 v[132:135], v[28:31], a[40:43], v[132:135]
ds_read_b128 v[24:27], v6 offset:55296
v_add_u32 v5, 8192, v5
v_mfma_f32_16x16x32_bf16 v[140:143], v[28:31], a[44:47], v[140:143]
global_load_dwordx4 a[96:99], v5, s[20:21] offset:-4096 sc1
v_mfma_f32_16x16x32_bf16 v[80:83], v[32:35], a[48:51], v[80:83]
ds_read_b128 v[28:31], v6 offset:56320
v_mfma_f32_16x16x32_bf16 v[88:91], v[32:35], a[52:55], v[88:91]
v_mfma_f32_16x16x32_bf16 v[84:87], v[36:39], a[48:51], v[84:87]
ds_read_b128 v[32:35], v6 offset:57344
global_load_dwordx4 a[100:103], v5, s[20:21] offset:-3072 sc1
v_mfma_f32_16x16x32_bf16 v[92:95], v[36:39], a[52:55], v[92:95]
v_mfma_f32_16x16x32_bf16 v[96:99], v[40:43], a[48:51], v[96:99]
ds_read_b128 v[36:39], v6 offset:58368
v_mfma_f32_16x16x32_bf16 v[104:107], v[40:43], a[52:55], v[104:107]
s_waitcnt lgkmcnt(3)
v_mfma_f32_16x16x32_bf16 v[100:103], v[44:47], a[48:51], v[100:103]
ds_read_b128 v[40:43], v6 offset:59392
v_mfma_f32_16x16x32_bf16 v[108:111], v[44:47], a[52:55], v[108:111]
v_mfma_f32_16x16x32_bf16 v[112:115], v[16:19], a[48:51], v[112:115]
ds_read_b128 v[44:47], v6 offset:60416
s_getpc_b64 s[4:5]
v_mfma_f32_16x16x32_bf16 v[120:123], v[16:19], a[52:55], v[120:123]
global_load_dword v13, v12, s[4:5]
s_add_u32 m0, s43, 114688
v_mfma_f32_16x16x32_bf16 v[116:119], v[20:23], a[48:51], v[116:119]
ds_read_b128 v[16:19], v6 offset:61440
v_add_u32 v4, 16384, v4
v_mfma_f32_16x16x32_bf16 v[124:127], v[20:23], a[52:55], v[124:127]
global_load_lds_dwordx4 v4, s[20:21] offset:0 sc1
v_mfma_f32_16x16x32_bf16 v[128:131], v[24:27], a[48:51], v[128:131]
ds_read_b128 v[20:23], v6 offset:62464
global_load_lds_dwordx4 v4, s[20:21] offset:1024 sc1
v_mfma_f32_16x16x32_bf16 v[136:139], v[24:27], a[52:55], v[136:139]
s_waitcnt vmcnt(22) lgkmcnt(3)
v_mfma_f32_16x16x32_bf16 v[132:135], v[28:31], a[48:51], v[132:135]
ds_read_b128 v[24:27], v6 offset:63488
v_mfma_f32_16x16x32_bf16 v[140:143], v[28:31], a[52:55], v[140:143]
v_mfma_f32_16x16x32_bf16 v[80:83], v[32:35], a[56:59], v[80:83]
ds_read_b128 v[28:31], v6 offset:64512
global_load_lds_dwordx4 v4, s[20:21] offset:2048 sc1
v_mfma_f32_16x16x32_bf16 v[88:91], v[32:35], a[60:63], v[88:91]
v_mfma_f32_16x16x32_bf16 v[84:87], v[36:39], a[56:59], v[84:87]
s_barrier
ds_read_b128 v[32:35], v7 offset:0
v_mfma_f32_16x16x32_bf16 v[92:95], v[36:39], a[60:63], v[92:95]
v_mfma_f32_16x16x32_bf16 v[96:99], v[40:43], a[56:59], v[96:99]
ds_read_b128 v[36:39], v7 offset:1024
v_mfma_f32_16x16x32_bf16 v[104:107], v[40:43], a[60:63], v[104:107]
s_waitcnt lgkmcnt(3)
v_mfma_f32_16x16x32_bf16 v[100:103], v[44:47], a[56:59], v[100:103]
ds_read_b128 v[40:43], v7 offset:2048
global_load_lds_dwordx4 v4, s[20:21] offset:3072 sc1
v_mfma_f32_16x16x32_bf16 v[108:111], v[44:47], a[60:63], v[108:111]
v_mfma_f32_16x16x32_bf16 v[112:115], v[16:19], a[56:59], v[112:115]
ds_read_b128 v[44:47], v7 offset:3072
v_mfma_f32_16x16x32_bf16 v[120:123], v[16:19], a[60:63], v[120:123]
v_mfma_f32_16x16x32_bf16 v[116:119], v[20:23], a[56:59], v[116:119]
ds_read_b128 v[16:19], v7 offset:4096
global_load_dwordx4 a[104:107], v5, s[20:21] offset:-2048 sc1
v_mfma_f32_16x16x32_bf16 v[124:127], v[20:23], a[60:63], v[124:127]
v_mfma_f32_16x16x32_bf16 v[128:131], v[24:27], a[56:59], v[128:131]
ds_read_b128 v[20:23], v7 offset:5120
v_mfma_f32_16x16x32_bf16 v[136:139], v[24:27], a[60:63], v[136:139]
s_waitcnt vmcnt(23) lgkmcnt(3)
v_mfma_f32_16x16x32_bf16 v[132:135], v[28:31], a[56:59], v[132:135]
ds_read_b128 v[24:27], v7 offset:6144
global_load_dwordx4 a[108:111], v5, s[20:21] offset:-1024 sc1
v_mfma_f32_16x16x32_bf16 v[140:143], v[28:31], a[60:63], v[140:143]
v_mfma_f32_16x16x32_bf16 v[80:83], v[32:35], a[64:67], v[80:83]
ds_read_b128 v[28:31], v7 offset:7168
v_mfma_f32_16x16x32_bf16 v[88:91], v[32:35], a[68:71], v[88:91]
v_mfma_f32_16x16x32_bf16 v[84:87], v[36:39], a[64:67], v[84:87]
ds_read_b128 v[32:35], v7 offset:8192
global_load_dwordx4 a[112:115], v5, s[20:21] offset:0 sc1
v_mfma_f32_16x16x32_bf16 v[92:95], v[36:39], a[68:71], v[92:95]
v_mfma_f32_16x16x32_bf16 v[96:99], v[40:43], a[64:67], v[96:99]
ds_read_b128 v[36:39], v7 offset:9216
v_mfma_f32_16x16x32_bf16 v[104:107], v[40:43], a[68:71], v[104:107]
s_waitcnt lgkmcnt(3)
v_mfma_f32_16x16x32_bf16 v[100:103], v[44:47], a[64:67], v[100:103]
ds_read_b128 v[40:43], v7 offset:10240
v_mfma_f32_16x16x32_bf16 v[108:111], v[44:47], a[68:71], v[108:111]
v_mfma_f32_16x16x32_bf16 v[112:115], v[16:19], a[64:67], v[112:115]
ds_read_b128 v[44:47], v7 offset:11264
global_load_dwordx4 a[116:119], v5, s[20:21] offset:1024 sc1
v_mfma_f32_16x16x32_bf16 v[120:123], v[16:19], a[68:71], v[120:123]
v_mfma_f32_16x16x32_bf16 v[116:119], v[20:23], a[64:67], v[116:119]
ds_read_b128 v[16:19], v7 offset:12288
v_mfma_f32_16x16x32_bf16 v[124:127], v[20:23], a[68:71], v[124:127]
v_mfma_f32_16x16x32_bf16 v[128:131], v[24:27], a[64:67], v[128:131]
ds_read_b128 v[20:23], v7 offset:13312
s_add_u32 m0, s43, 0
v_mfma_f32_16x16x32_bf16 v[136:139], v[24:27], a[68:71], v[136:139]
v_add_u32 v4, 16384, v4
s_waitcnt vmcnt(20) lgkmcnt(3)
v_mfma_f32_16x16x32_bf16 v[132:135], v[28:31], a[64:67], v[132:135]
ds_read_b128 v[24:27], v7 offset:14336
global_load_lds_dwordx4 v4, s[20:21] offset:0 sc1
v_mfma_f32_16x16x32_bf16 v[140:143], v[28:31], a[68:71], v[140:143]
v_mfma_f32_16x16x32_bf16 v[80:83], v[32:35], a[72:75], v[80:83]
ds_read_b128 v[28:31], v7 offset:15360
global_load_lds_dwordx4 v4, s[20:21] offset:1024 sc1
v_mfma_f32_16x16x32_bf16 v[88:91], v[32:35], a[76:79], v[88:91]
v_mfma_f32_16x16x32_bf16 v[84:87], v[36:39], a[72:75], v[84:87]
s_barrier
ds_read_b128 v[32:35], v7 offset:16384
v_mfma_f32_16x16x32_bf16 v[92:95], v[36:39], a[76:79], v[92:95]
v_mfma_f32_16x16x32_bf16 v[96:99], v[40:43], a[72:75], v[96:99]
ds_read_b128 v[36:39], v7 offset:17408
global_load_lds_dwordx4 v4, s[20:21] offset:2048 sc1
v_mfma_f32_16x16x32_bf16 v[104:107], v[40:43], a[76:79], v[104:107]
s_waitcnt vmcnt(17)
v_mul_f32 v208, 0xba800000, v208
v_mul_f32 v209, 0x3a800000, v209
v_mul_f32 v210, 0xba800000, v210
v_mul_f32 v211, 0x3a800000, v211
s_waitcnt lgkmcnt(3)
v_mfma_f32_16x16x32_bf16 v[100:103], v[44:47], a[72:75], v[100:103]
ds_read_b128 v[40:43], v7 offset:18432
v_fma_f32 v209, -v208, v208, v209
v_mfma_f32_16x16x32_bf16 v[108:111], v[44:47], a[76:79], v[108:111]
v_fma_f32 v211, -v210, v210, v211
v_max_f32 v209, 0, v209
v_mfma_f32_16x16x32_bf16 v[112:115], v[16:19], a[72:75], v[112:115]
ds_read_b128 v[44:47], v7 offset:19456
global_load_lds_dwordx4 v4, s[20:21] offset:3072 sc1
v_mfma_f32_16x16x32_bf16 v[120:123], v[16:19], a[76:79], v[120:123]
v_max_f32 v211, 0, v211
v_add_f32 v209, 0x3727c5ac, v209
v_mfma_f32_16x16x32_bf16 v[116:119], v[20:23], a[72:75], v[116:119]
ds_read_b128 v[16:19], v7 offset:20480
v_add_f32 v211, 0x3727c5ac, v211
v_mfma_f32_16x16x32_bf16 v[124:127], v[20:23], a[76:79], v[124:127]
v_rsq_f32 v212, v209
v_mfma_f32_16x16x32_bf16 v[128:131], v[24:27], a[72:75], v[128:131]
ds_read_b128 v[20:23], v7 offset:21504
global_load_dwordx4 a[120:123], v5, s[20:21] offset:2048 sc1
v_mfma_f32_16x16x32_bf16 v[136:139], v[24:27], a[76:79], v[136:139]
v_mul_f32 v209, v209, v212
s_waitcnt lgkmcnt(3)
v_mfma_f32_16x16x32_bf16 v[132:135], v[28:31], a[72:75], v[132:135]
ds_read_b128 v[24:27], v7 offset:22528
v_cvt_pk_bf16_f32 v214, v208, v208
v_mfma_f32_16x16x32_bf16 v[140:143], v[28:31], a[76:79], v[140:143]
v_rsq_f32 v213, v211
v_mfma_f32_16x16x32_bf16 v[80:83], v[32:35], a[80:83], v[80:83]
ds_read_b128 v[28:31], v7 offset:23552
v_mul_f32 v211, v211, v213
v_mfma_f32_16x16x32_bf16 v[88:91], v[32:35], a[84:87], v[88:91]
v_cvt_pk_bf16_f32 v215, v209, v209
v_lshlrev_b32 v216, 16, v214
v_mfma_f32_16x16x32_bf16 v[84:87], v[36:39], a[80:83], v[84:87]
ds_read_b128 v[32:35], v7 offset:24576
global_load_dwordx4 a[124:127], v5, s[20:21] offset:3072 sc1
v_mfma_f32_16x16x32_bf16 v[92:95], v[36:39], a[84:87], v[92:95]
v_lshlrev_b32 v217, 16, v215
v_sub_f32 v216, v208, v216
v_mfma_f32_16x16x32_bf16 v[96:99], v[40:43], a[80:83], v[96:99]
ds_read_b128 v[36:39], v7 offset:25600
v_sub_f32 v217, v209, v217
v_mfma_f32_16x16x32_bf16 v[104:107], v[40:43], a[84:87], v[104:107]
v_cvt_pk_bf16_f32 v216, v216, v209
s_waitcnt lgkmcnt(3)
v_mfma_f32_16x16x32_bf16 v[100:103], v[44:47], a[80:83], v[100:103]
ds_read_b128 v[40:43], v7 offset:26624
v_add_u32 v5, s61, v5
v_mfma_f32_16x16x32_bf16 v[108:111], v[44:47], a[84:87], v[108:111]
global_load_dwordx4 a[128:131], v5, s[20:21] offset:-4096 sc1
v_cvt_pk_bf16_f32 v217, v217, 0
v_mfma_f32_16x16x32_bf16 v[112:115], v[16:19], a[80:83], v[112:115]
ds_read_b128 v[44:47], v7 offset:27648
v_cndmask_b32 v64, 0, v214, s[98:99]
v_mfma_f32_16x16x32_bf16 v[120:123], v[16:19], a[84:87], v[120:123]
v_cndmask_b32 v65, 0, v216, s[98:99]
v_cndmask_b32 v66, 0, v217, s[98:99]
v_mfma_f32_16x16x32_bf16 v[116:119], v[20:23], a[80:83], v[116:119]
ds_read_b128 v[16:19], v7 offset:28672
global_load_dwordx4 a[132:135], v5, s[20:21] offset:-3072 sc1
v_mfma_f32_16x16x32_bf16 v[124:127], v[20:23], a[84:87], v[124:127]
v_cvt_pk_bf16_f32 v214, v210, v210
v_cvt_pk_bf16_f32 v215, v211, v211
v_mfma_f32_16x16x32_bf16 v[128:131], v[24:27], a[80:83], v[128:131]
ds_read_b128 v[20:23], v7 offset:29696
v_lshlrev_b32 v216, 16, v214
v_mfma_f32_16x16x32_bf16 v[136:139], v[24:27], a[84:87], v[136:139]
v_lshlrev_b32 v217, 16, v215
s_waitcnt vmcnt(19) lgkmcnt(3)
v_mfma_f32_16x16x32_bf16 v[132:135], v[28:31], a[80:83], v[132:135]
ds_read_b128 v[24:27], v7 offset:30720
s_add_u32 m0, s43, 16384
v_mfma_f32_16x16x32_bf16 v[140:143], v[28:31], a[84:87], v[140:143]
v_add_u32 v4, 16384, v4
v_sub_f32 v216, v210, v216
v_mfma_f32_16x16x32_bf16 v[80:83], v[32:35], a[88:91], v[80:83]
ds_read_b128 v[28:31], v7 offset:31744
global_load_lds_dwordx4 v4, s[20:21] offset:0 sc1
v_mfma_f32_16x16x32_bf16 v[88:91], v[32:35], a[92:95], v[88:91]
v_sub_f32 v217, v211, v217
v_cvt_pk_bf16_f32 v216, v216, v211
v_mfma_f32_16x16x32_bf16 v[84:87], v[36:39], a[88:91], v[84:87]
s_barrier
ds_read_b128 v[32:35], v7 offset:32768
v_mfma_f32_16x16x32_bf16 v[92:95], v[36:39], a[92:95], v[92:95]
global_load_lds_dwordx4 v4, s[20:21] offset:1024 sc1
v_cvt_pk_bf16_f32 v217, v217, 0
v_mfma_f32_16x16x32_bf16 v[96:99], v[40:43], a[88:91], v[96:99]
ds_read_b128 v[36:39], v7 offset:33792
v_cndmask_b32 v68, 0, v214, s[98:99]
v_mfma_f32_16x16x32_bf16 v[104:107], v[40:43], a[92:95], v[104:107]
v_cndmask_b32 v69, 0, v216, s[98:99]
s_waitcnt lgkmcnt(3)
v_mfma_f32_16x16x32_bf16 v[100:103], v[44:47], a[88:91], v[100:103]
ds_read_b128 v[40:43], v7 offset:34816
v_cndmask_b32 v70, 0, v217, s[98:99]
v_mfma_f32_16x16x32_bf16 v[108:111], v[44:47], a[92:95], v[108:111]
v_mul_f32 v72, 0xc0135761, v212
v_mul_f32 v214, v212, v212
v_mfma_f32_16x16x32_bf16 v[112:115], v[16:19], a[88:91], v[112:115]
ds_read_b128 v[44:47], v7 offset:35840
global_load_lds_dwordx4 v4, s[20:21] offset:2048 sc1
v_mfma_f32_16x16x32_bf16 v[120:123], v[16:19], a[92:95], v[120:123]
v_mov_b32 v74, v209
v_mul_f32 v214, 0x3d372713, v214
v_mfma_f32_16x16x32_bf16 v[116:119], v[20:23], a[88:91], v[116:119]
ds_read_b128 v[16:19], v7 offset:36864
v_mul_f32 v73, v214, v72
v_mfma_f32_16x16x32_bf16 v[124:127], v[20:23], a[92:95], v[124:127]
v_mul_f32 v75, 0xc0135761, v213
v_mul_f32 v214, v213, v213
v_mfma_f32_16x16x32_bf16 v[128:131], v[24:27], a[88:91], v[128:131]
ds_read_b128 v[20:23], v7 offset:37888
global_load_lds_dwordx4 v4, s[20:21] offset:3072 sc1
v_mfma_f32_16x16x32_bf16 v[136:139], v[24:27], a[92:95], v[136:139]
v_mov_b32 v77, v211
s_waitcnt vmcnt(21) lgkmcnt(3)
v_mfma_f32_16x16x32_bf16 v[132:135], v[28:31], a[88:91], v[132:135]
ds_read_b128 v[24:27], v7 offset:38912
v_mul_f32 v214, 0x3d372713, v214
v_mfma_f32_16x16x32_bf16 v[140:143], v[28:31], a[92:95], v[140:143]
v_mul_f32 v76, v214, v75
v_and_b32 v208, 48, v11
v_mfma_f32_16x16x32_bf16 v[80:83], v[32:35], a[96:99], v[80:83]
ds_read_b128 v[28:31], v7 offset:39936
global_load_dwordx4 a[136:139], v5, s[20:21] offset:-2048 sc1
v_mfma_f32_16x16x32_bf16 v[88:91], v[32:35], a[100:103], v[88:91]
v_add_u32 v208, 155648, v208
v_mfma_f32_16x16x32_bf16 v[84:87], v[36:39], a[96:99], v[84:87]
ds_read_b128 v[32:35], v7 offset:40960
ds_read_b128 v[224:227], v208 offset:0
v_mfma_f32_16x16x32_bf16 v[92:95], v[36:39], a[100:103], v[92:95]
ds_read_b128 v[228:231], v208 offset:64
ds_read_b128 v[232:235], v208 offset:128
v_mfma_f32_16x16x32_bf16 v[96:99], v[40:43], a[96:99], v[96:99]
ds_read_b128 v[36:39], v7 offset:41984
global_load_dwordx4 a[140:143], v5, s[20:21] offset:-1024 sc1
v_mfma_f32_16x16x32_bf16 v[104:107], v[40:43], a[100:103], v[104:107]
ds_read_b128 v[236:239], v208 offset:192
s_waitcnt lgkmcnt(7)
v_mfma_f32_16x16x32_bf16 v[100:103], v[44:47], a[96:99], v[100:103]
ds_read_b128 v[40:43], v7 offset:43008
v_mfma_f32_16x16x32_bf16 v[108:111], v[44:47], a[100:103], v[108:111]
v_mfma_f32_16x16x32_bf16 v[112:115], v[16:19], a[96:99], v[112:115]
ds_read_b128 v[44:47], v7 offset:44032
global_load_dwordx4 a[144:147], v5, s[20:21] offset:0 sc1
v_mfma_f32_16x16x32_bf16 v[120:123], v[16:19], a[100:103], v[120:123]
v_mfma_f32_16x16x32_bf16 v[116:119], v[20:23], a[96:99], v[116:119]
ds_read_b128 v[16:19], v7 offset:45056
v_mfma_f32_16x16x32_bf16 v[124:127], v[20:23], a[100:103], v[124:127]
v_mfma_f32_16x16x32_bf16 v[128:131], v[24:27], a[96:99], v[128:131]
ds_read_b128 v[20:23], v7 offset:46080
v_lshlrev_b32 v192, 16, v48
v_mfma_f32_16x16x32_bf16 v[136:139], v[24:27], a[100:103], v[136:139]
v_and_b32 v193, 0xffff0000, v48
s_waitcnt lgkmcnt(8)
v_add_f32 v192, v192, v224
v_add_f32 v193, v193, v225
v_mfma_f32_16x16x32_bf16 v[132:135], v[28:31], a[96:99], v[132:135]
ds_read_b128 v[24:27], v7 offset:47104
global_load_dwordx4 a[148:151], v5, s[20:21] offset:1024 sc1
v_mfma_f32_16x16x32_bf16 v[140:143], v[28:31], a[100:103], v[140:143]
v_lshlrev_b32 v194, 16, v49
v_and_b32 v195, 0xffff0000, v49
s_waitcnt vmcnt(18)
v_mfma_f32_16x16x32_bf16 v[80:83], v[32:35], a[104:107], v[80:83]
ds_read_b128 v[28:31], v7 offset:48128
v_add_f32 v194, v194, v226
v_mfma_f32_16x16x32_bf16 v[88:91], v[32:35], a[108:111], v[88:91]
v_add_f32 v195, v195, v227
s_waitcnt lgkmcnt(3)
v_mfma_f32_16x16x32_bf16 v[84:87], v[36:39], a[104:107], v[84:87]
s_barrier
ds_read_b128 v[32:35], v7 offset:49152
v_mfma_f32_16x16x32_bf16 v[92:95], v[36:39], a[108:111], v[92:95]
s_add_u32 m0, s43, 32768
v_add_u32 v4, 16384, v4
v_lshlrev_b32 v196, 16, v50
v_and_b32 v197, 0xffff0000, v50
v_mfma_f32_16x16x32_bf16 v[96:99], v[40:43], a[104:107], v[96:99]
ds_read_b128 v[36:39], v7 offset:50176
global_load_lds_dwordx4 v4, s[20:21] offset:0 sc1
v_mfma_f32_16x16x32_bf16 v[104:107], v[40:43], a[108:111], v[104:107]
global_load_lds_dwordx4 v4, s[20:21] offset:1024 sc1
v_add_f32 v196, v196, v228
v_add_f32 v197, v197, v229
v_mfma_f32_16x16x32_bf16 v[100:103], v[44:47], a[104:107], v[100:103]
ds_read_b128 v[40:43], v7 offset:51200
v_lshlrev_b32 v198, 16, v51
v_mfma_f32_16x16x32_bf16 v[108:111], v[44:47], a[108:111], v[108:111]
v_and_b32 v199, 0xffff0000, v51
v_add_f32 v198, v198, v230
v_mfma_f32_16x16x32_bf16 v[112:115], v[16:19], a[104:107], v[112:115]
ds_read_b128 v[44:47], v7 offset:52224
v_add_f32 v199, v199, v231
v_mfma_f32_16x16x32_bf16 v[120:123], v[16:19], a[108:111], v[120:123]
v_lshlrev_b32 v200, 16, v52
s_waitcnt vmcnt(18) lgkmcnt(3)
v_mfma_f32_16x16x32_bf16 v[116:119], v[20:23], a[104:107], v[116:119]
ds_read_b128 v[16:19], v7 offset:53248
global_load_lds_dwordx4 v4, s[20:21] offset:2048 sc1
v_mfma_f32_16x16x32_bf16 v[124:127], v[20:23], a[108:111], v[124:127]
v_and_b32 v201, 0xffff0000, v52
v_add_f32 v200, v200, v224
v_mfma_f32_16x16x32_bf16 v[128:131], v[24:27], a[104:107], v[128:131]
ds_read_b128 v[20:23], v7 offset:54272
v_add_f32 v201, v201, v225
v_mfma_f32_16x16x32_bf16 v[136:139], v[24:27], a[108:111], v[136:139]
v_lshlrev_b32 v202, 16, v53
v_and_b32 v203, 0xffff0000, v53
v_mfma_f32_16x16x32_bf16 v[132:135], v[28:31], a[104:107], v[132:135]
ds_read_b128 v[24:27], v7 offset:55296
global_load_lds_dwordx4 v4, s[20:21] offset:3072 sc1
v_mfma_f32_16x16x32_bf16 v[140:143], v[28:31], a[108:111], v[140:143]
v_add_f32 v202, v202, v226
v_add_f32 v203, v203, v227
v_mfma_f32_16x16x32_bf16 v[80:83], v[32:35], a[112:115], v[80:83]
ds_read_b128 v[28:31], v7 offset:56320
v_lshlrev_b32 v204, 16, v54
v_mfma_f32_16x16x32_bf16 v[88:91], v[32:35], a[116:119], v[88:91]
v_and_b32 v205, 0xffff0000, v54
s_waitcnt lgkmcnt(3)
v_mfma_f32_16x16x32_bf16 v[84:87], v[36:39], a[112:115], v[84:87]
ds_read_b128 v[32:35], v7 offset:57344
global_load_dwordx4 a[152:155], v5, s[20:21] offset:2048 sc1
v_mfma_f32_16x16x32_bf16 v[92:95], v[36:39], a[116:119], v[92:95]
v_add_f32 v204, v204, v228
v_add_f32 v205, v205, v229
v_mfma_f32_16x16x32_bf16 v[96:99], v[40:43], a[112:115], v[96:99]
ds_read_b128 v[36:39], v7 offset:58368
v_lshlrev_b32 v206, 16, v55
v_mfma_f32_16x16x32_bf16 v[104:107], v[40:43], a[116:119], v[104:107]
v_and_b32 v207, 0xffff0000, v55
v_add_f32 v206, v206, v230
v_mfma_f32_16x16x32_bf16 v[100:103], v[44:47], a[112:115], v[100:103]
ds_read_b128 v[40:43], v7 offset:59392
global_load_dwordx4 a[156:159], v5, s[20:21] offset:3072 sc1
v_mfma_f32_16x16x32_bf16 v[108:111], v[44:47], a[116:119], v[108:111]
v_add_f32 v207, v207, v231
v_mfma_f32_16x16x32_bf16 v[112:115], v[16:19], a[112:115], v[112:115]
ds_read_b128 v[44:47], v7 offset:60416
v_mfma_f32_16x16x32_bf16 v[120:123], v[16:19], a[116:119], v[120:123]
s_waitcnt vmcnt(16) lgkmcnt(3)
v_mfma_f32_16x16x32_bf16 v[116:119], v[20:23], a[112:115], v[116:119]
ds_read_b128 v[16:19], v7 offset:61440
v_add_u32 v5, 8192, v5
v_mfma_f32_16x16x32_bf16 v[124:127], v[20:23], a[116:119], v[124:127]
global_load_dwordx4 a[160:163], v5, s[20:21] offset:-4096 sc1
v_mfma_f32_16x16x32_bf16 v[128:131], v[24:27], a[112:115], v[128:131]
ds_read_b128 v[20:23], v7 offset:62464
v_mfma_f32_16x16x32_bf16 v[136:139], v[24:27], a[116:119], v[136:139]
v_mfma_f32_16x16x32_bf16 v[132:135], v[28:31], a[112:115], v[132:135]
ds_read_b128 v[24:27], v7 offset:63488
v_mfma_f32_16x16x32_bf16 v[140:143], v[28:31], a[116:119], v[140:143]
v_mfma_f32_16x16x32_bf16 v[80:83], v[32:35], a[120:123], v[80:83]
ds_read_b128 v[28:31], v7 offset:64512
global_load_dwordx4 a[164:167], v5, s[20:21] offset:-3072 sc1
v_mfma_f32_16x16x32_bf16 v[88:91], v[32:35], a[124:127], v[88:91]
s_waitcnt lgkmcnt(3)
v_mfma_f32_16x16x32_bf16 v[84:87], v[36:39], a[120:123], v[84:87]
s_barrier
ds_read_b128 v[32:35], v6 offset:0
v_mfma_f32_16x16x32_bf16 v[92:95], v[36:39], a[124:127], v[92:95]
v_mfma_f32_16x16x32_bf16 v[96:99], v[40:43], a[120:123], v[96:99]
ds_read_b128 v[36:39], v6 offset:1024
s_add_u32 m0, s43, 49152
v_mfma_f32_16x16x32_bf16 v[104:107], v[40:43], a[124:127], v[104:107]
v_add_u32 v4, 16384, v4
v_mfma_f32_16x16x32_bf16 v[100:103], v[44:47], a[120:123], v[100:103]
ds_read_b128 v[40:43], v6 offset:2048
global_load_lds_dwordx4 v4, s[20:21] offset:0 sc1
v_mfma_f32_16x16x32_bf16 v[108:111], v[44:47], a[124:127], v[108:111]
v_mfma_f32_16x16x32_bf16 v[112:115], v[16:19], a[120:123], v[112:115]
ds_read_b128 v[44:47], v6 offset:3072
global_load_lds_dwordx4 v4, s[20:21] offset:1024 sc1
v_mfma_f32_16x16x32_bf16 v[120:123], v[16:19], a[124:127], v[120:123]
s_waitcnt vmcnt(18) lgkmcnt(3)
v_mfma_f32_16x16x32_bf16 v[116:119], v[20:23], a[120:123], v[116:119]
ds_read_b128 v[16:19], v6 offset:4096
v_mfma_f32_16x16x32_bf16 v[124:127], v[20:23], a[124:127], v[124:127]
v_mfma_f32_16x16x32_bf16 v[128:131], v[24:27], a[120:123], v[128:131]
ds_read_b128 v[20:23], v6 offset:5120
global_load_lds_dwordx4 v4, s[20:21] offset:2048 sc1
v_mfma_f32_16x16x32_bf16 v[136:139], v[24:27], a[124:127], v[136:139]
v_mfma_f32_16x16x32_bf16 v[132:135], v[28:31], a[120:123], v[132:135]
ds_read_b128 v[24:27], v6 offset:6144
v_mfma_f32_16x16x32_bf16 v[140:143], v[28:31], a[124:127], v[140:143]
v_mfma_f32_16x16x32_bf16 v[80:83], v[32:35], a[128:131], v[80:83]
ds_read_b128 v[28:31], v6 offset:7168
v_mfma_f32_16x16x32_bf16 v[88:91], v[32:35], a[132:135], v[88:91]
s_waitcnt lgkmcnt(3)
v_mfma_f32_16x16x32_bf16 v[84:87], v[36:39], a[128:131], v[84:87]
ds_read_b128 v[32:35], v6 offset:8192
global_load_lds_dwordx4 v4, s[20:21] offset:3072 sc1
v_mfma_f32_16x16x32_bf16 v[92:95], v[36:39], a[132:135], v[92:95]
v_mfma_f32_16x16x32_bf16 v[96:99], v[40:43], a[128:131], v[96:99]
ds_read_b128 v[36:39], v6 offset:9216
v_mfma_f32_16x16x32_bf16 v[104:107], v[40:43], a[132:135], v[104:107]
v_mfma_f32_16x16x32_bf16 v[100:103], v[44:47], a[128:131], v[100:103]
ds_read_b128 v[40:43], v6 offset:10240
global_load_dwordx4 a[168:171], v5, s[20:21] offset:-2048 sc1
v_mfma_f32_16x16x32_bf16 v[108:111], v[44:47], a[132:135], v[108:111]
v_mfma_f32_16x16x32_bf16 v[112:115], v[16:19], a[128:131], v[112:115]
ds_read_b128 v[44:47], v6 offset:11264
v_mfma_f32_16x16x32_bf16 v[120:123], v[16:19], a[132:135], v[120:123]
s_waitcnt vmcnt(15) lgkmcnt(3)
v_mfma_f32_16x16x32_bf16 v[116:119], v[20:23], a[128:131], v[116:119]
ds_read_b128 v[16:19], v6 offset:12288
global_load_dwordx4 a[172:175], v5, s[20:21] offset:-1024 sc1
v_mfma_f32_16x16x32_bf16 v[124:127], v[20:23], a[132:135], v[124:127]
v_mfma_f32_16x16x32_bf16 v[128:131], v[24:27], a[128:131], v[128:131]
ds_read_b128 v[20:23], v6 offset:13312
v_mfma_f32_16x16x32_bf16 v[136:139], v[24:27], a[132:135], v[136:139]
v_mfma_f32_16x16x32_bf16 v[132:135], v[28:31], a[128:131], v[132:135]
ds_read_b128 v[24:27], v6 offset:14336
global_load_dwordx4 a[176:179], v5, s[20:21] offset:0 sc1
v_mfma_f32_16x16x32_bf16 v[140:143], v[28:31], a[132:135], v[140:143]
v_mfma_f32_16x16x32_bf16 v[80:83], v[32:35], a[136:139], v[80:83]
ds_read_b128 v[28:31], v6 offset:15360
v_mfma_f32_16x16x32_bf16 v[88:91], v[32:35], a[140:143], v[88:91]
s_waitcnt lgkmcnt(3)
v_mfma_f32_16x16x32_bf16 v[84:87], v[36:39], a[136:139], v[84:87]
s_barrier
ds_read_b128 v[32:35], v6 offset:16384
v_mfma_f32_16x16x32_bf16 v[92:95], v[36:39], a[140:143], v[92:95]
v_mfma_f32_16x16x32_bf16 v[96:99], v[40:43], a[136:139], v[96:99]
ds_read_b128 v[36:39], v6 offset:17408
global_load_dwordx4 a[180:183], v5, s[20:21] offset:1024 sc1
v_mfma_f32_16x16x32_bf16 v[104:107], v[40:43], a[140:143], v[104:107]
v_mfma_f32_16x16x32_bf16 v[100:103], v[44:47], a[136:139], v[100:103]
ds_read_b128 v[40:43], v6 offset:18432
v_mfma_f32_16x16x32_bf16 v[108:111], v[44:47], a[140:143], v[108:111]
v_mfma_f32_16x16x32_bf16 v[112:115], v[16:19], a[136:139], v[112:115]
ds_read_b128 v[44:47], v6 offset:19456
s_add_u32 m0, s43, 65536
v_mfma_f32_16x16x32_bf16 v[120:123], v[16:19], a[140:143], v[120:123]
v_add_u32 v4, 16384, v4
s_waitcnt vmcnt(16) lgkmcnt(3)
v_mfma_f32_16x16x32_bf16 v[116:119], v[20:23], a[136:139], v[116:119]
ds_read_b128 v[16:19], v6 offset:20480
global_load_lds_dwordx4 v4, s[20:21] offset:0 sc1
v_mfma_f32_16x16x32_bf16 v[124:127], v[20:23], a[140:143], v[124:127]
v_mfma_f32_16x16x32_bf16 v[128:131], v[24:27], a[136:139], v[128:131]
ds_read_b128 v[20:23], v6 offset:21504
global_load_lds_dwordx4 v4, s[20:21] offset:1024 sc1
v_mfma_f32_16x16x32_bf16 v[136:139], v[24:27], a[140:143], v[136:139]
v_mfma_f32_16x16x32_bf16 v[132:135], v[28:31], a[136:139], v[132:135]
ds_read_b128 v[24:27], v6 offset:22528
v_mfma_f32_16x16x32_bf16 v[140:143], v[28:31], a[140:143], v[140:143]
v_mfma_f32_16x16x32_bf16 v[80:83], v[32:35], a[144:147], v[80:83]
ds_read_b128 v[28:31], v6 offset:23552
global_load_lds_dwordx4 v4, s[20:21] offset:2048 sc1
v_mfma_f32_16x16x32_bf16 v[88:91], v[32:35], a[148:151], v[88:91]
s_waitcnt lgkmcnt(3)
v_mfma_f32_16x16x32_bf16 v[84:87], v[36:39], a[144:147], v[84:87]
ds_read_b128 v[32:35], v6 offset:24576
v_mfma_f32_16x16x32_bf16 v[92:95], v[36:39], a[148:151], v[92:95]
v_mfma_f32_16x16x32_bf16 v[96:99], v[40:43], a[144:147], v[96:99]
ds_read_b128 v[36:39], v6 offset:25600
v_mfma_f32_16x16x32_bf16 v[104:107], v[40:43], a[148:151], v[104:107]
v_mfma_f32_16x16x32_bf16 v[100:103], v[44:47], a[144:147], v[100:103]
ds_read_b128 v[40:43], v6 offset:26624
global_load_lds_dwordx4 v4, s[20:21] offset:3072 sc1
v_mfma_f32_16x16x32_bf16 v[108:111], v[44:47], a[148:151], v[108:111]
v_mfma_f32_16x16x32_bf16 v[112:115], v[16:19], a[144:147], v[112:115]
ds_read_b128 v[44:47], v6 offset:27648
v_mfma_f32_16x16x32_bf16 v[120:123], v[16:19], a[148:151], v[120:123]
s_waitcnt vmcnt(14) lgkmcnt(3)
v_mfma_f32_16x16x32_bf16 v[116:119], v[20:23], a[144:147], v[116:119]
ds_read_b128 v[16:19], v6 offset:28672
global_load_dwordx4 a[184:187], v5, s[20:21] offset:2048 sc1
v_mfma_f32_16x16x32_bf16 v[124:127], v[20:23], a[148:151], v[124:127]
v_mfma_f32_16x16x32_bf16 v[128:131], v[24:27], a[144:147], v[128:131]
ds_read_b128 v[20:23], v6 offset:29696
v_mfma_f32_16x16x32_bf16 v[136:139], v[24:27], a[148:151], v[136:139]
v_mfma_f32_16x16x32_bf16 v[132:135], v[28:31], a[144:147], v[132:135]
ds_read_b128 v[24:27], v6 offset:30720
global_load_dwordx4 a[188:191], v5, s[20:21] offset:3072 sc1
v_mfma_f32_16x16x32_bf16 v[140:143], v[28:31], a[148:151], v[140:143]
v_mfma_f32_16x16x32_bf16 v[80:83], v[32:35], a[152:155], v[80:83]
ds_read_b128 v[28:31], v6 offset:31744
v_mfma_f32_16x16x32_bf16 v[88:91], v[32:35], a[156:159], v[88:91]
s_waitcnt lgkmcnt(3)
v_mfma_f32_16x16x32_bf16 v[84:87], v[36:39], a[152:155], v[84:87]
s_barrier
ds_read_b128 v[32:35], v6 offset:32768
v_mfma_f32_16x16x32_bf16 v[92:95], v[36:39], a[156:159], v[92:95]
v_add_u32 v5, s60, v5
v_mfma_f32_16x16x32_bf16 v[96:99], v[40:43], a[152:155], v[96:99]
ds_read_b128 v[36:39], v6 offset:33792
global_load_dwordx4 a[192:195], v5, s[20:21] offset:-4096 sc1
v_mfma_f32_16x16x32_bf16 v[104:107], v[40:43], a[156:159], v[104:107]
v_mfma_f32_16x16x32_bf16 v[100:103], v[44:47], a[152:155], v[100:103]
ds_read_b128 v[40:43], v6 offset:34816
v_mfma_f32_16x16x32_bf16 v[108:111], v[44:47], a[156:159], v[108:111]
v_mfma_f32_16x16x32_bf16 v[112:115], v[16:19], a[152:155], v[112:115]
ds_read_b128 v[44:47], v6 offset:35840
global_load_dwordx4 a[196:199], v5, s[20:21] offset:-3072 sc1
v_mfma_f32_16x16x32_bf16 v[120:123], v[16:19], a[156:159], v[120:123]
s_waitcnt vmcnt(16) lgkmcnt(3)
v_mfma_f32_16x16x32_bf16 v[116:119], v[20:23], a[152:155], v[116:119]
ds_read_b128 v[16:19], v6 offset:36864
v_mfma_f32_16x16x32_bf16 v[124:127], v[20:23], a[156:159], v[124:127]
v_mfma_f32_16x16x32_bf16 v[128:131], v[24:27], a[152:155], v[128:131]
ds_read_b128 v[20:23], v6 offset:37888
s_add_u32 m0, s43, 81920
v_mfma_f32_16x16x32_bf16 v[136:139], v[24:27], a[156:159], v[136:139]
v_add_u32 v4, 16384, v4
v_mfma_f32_16x16x32_bf16 v[132:135], v[28:31], a[152:155], v[132:135]
ds_read_b128 v[24:27], v6 offset:38912
global_load_lds_dwordx4 v4, s[20:21] offset:0 sc1
v_mfma_f32_16x16x32_bf16 v[140:143], v[28:31], a[156:159], v[140:143]
v_mfma_f32_16x16x32_bf16 v[80:83], v[32:35], a[160:163], v[80:83]
ds_read_b128 v[28:31], v6 offset:39936
global_load_lds_dwordx4 v4, s[20:21] offset:1024 sc1
v_mfma_f32_16x16x32_bf16 v[88:91], v[32:35], a[164:167], v[88:91]
s_waitcnt lgkmcnt(3)
v_mfma_f32_16x16x32_bf16 v[84:87], v[36:39], a[160:163], v[84:87]
ds_read_b128 v[32:35], v6 offset:40960
v_mfma_f32_16x16x32_bf16 v[92:95], v[36:39], a[164:167], v[92:95]
v_mfma_f32_16x16x32_bf16 v[96:99], v[40:43], a[160:163], v[96:99]
ds_read_b128 v[36:39], v6 offset:41984
global_load_lds_dwordx4 v4, s[20:21] offset:2048 sc1
v_mfma_f32_16x16x32_bf16 v[104:107], v[40:43], a[164:167], v[104:107]
v_mfma_f32_16x16x32_bf16 v[100:103], v[44:47], a[160:163], v[100:103]
ds_read_b128 v[40:43], v6 offset:43008
v_mfma_f32_16x16x32_bf16 v[108:111], v[44:47], a[164:167], v[108:111]
v_mfma_f32_16x16x32_bf16 v[112:115], v[16:19], a[160:163], v[112:115]
ds_read_b128 v[44:47], v6 offset:44032
v_mfma_f32_16x16x32_bf16 v[120:123], v[16:19], a[164:167], v[120:123]
s_waitcnt vmcnt(13) lgkmcnt(3)
v_mfma_f32_16x16x32_bf16 v[116:119], v[20:23], a[160:163], v[116:119]
ds_read_b128 v[16:19], v6 offset:45056
global_load_lds_dwordx4 v4, s[20:21] offset:3072 sc1
v_mfma_f32_16x16x32_bf16 v[124:127], v[20:23], a[164:167], v[124:127]
v_mfma_f32_16x16x32_bf16 v[128:131], v[24:27], a[160:163], v[128:131]
ds_read_b128 v[20:23], v6 offset:46080
v_mfma_f32_16x16x32_bf16 v[136:139], v[24:27], a[164:167], v[136:139]
v_mfma_f32_16x16x32_bf16 v[132:135], v[28:31], a[160:163], v[132:135]
ds_read_b128 v[24:27], v6 offset:47104
global_load_dwordx4 a[200:203], v5, s[20:21] offset:-2048 sc1
v_mfma_f32_16x16x32_bf16 v[140:143], v[28:31], a[164:167], v[140:143]
v_mfma_f32_16x16x32_bf16 v[80:83], v[32:35], a[168:171], v[80:83]
ds_read_b128 v[28:31], v6 offset:48128
v_mfma_f32_16x16x32_bf16 v[88:91], v[32:35], a[172:175], v[88:91]
s_waitcnt lgkmcnt(3)
v_mfma_f32_16x16x32_bf16 v[84:87], v[36:39], a[168:171], v[84:87]
s_barrier
ds_read_b128 v[32:35], v6 offset:49152
v_mfma_f32_16x16x32_bf16 v[92:95], v[36:39], a[172:175], v[92:95]
global_load_dwordx4 a[204:207], v5, s[20:21] offset:-1024 sc1
v_mfma_f32_16x16x32_bf16 v[96:99], v[40:43], a[168:171], v[96:99]
ds_read_b128 v[36:39], v6 offset:50176
v_mfma_f32_16x16x32_bf16 v[104:107], v[40:43], a[172:175], v[104:107]
v_mfma_f32_16x16x32_bf16 v[100:103], v[44:47], a[168:171], v[100:103]
ds_read_b128 v[40:43], v6 offset:51200
global_load_dwordx4 a[208:211], v5, s[20:21] offset:0 sc1
v_mfma_f32_16x16x32_bf16 v[108:111], v[44:47], a[172:175], v[108:111]
v_mfma_f32_16x16x32_bf16 v[112:115], v[16:19], a[168:171], v[112:115]
ds_read_b128 v[44:47], v6 offset:52224
v_mfma_f32_16x16x32_bf16 v[120:123], v[16:19], a[172:175], v[120:123]
s_waitcnt vmcnt(15) lgkmcnt(3)
v_mfma_f32_16x16x32_bf16 v[116:119], v[20:23], a[168:171], v[116:119]
ds_read_b128 v[16:19], v6 offset:53248
v_mfma_f32_16x16x32_bf16 v[124:127], v[20:23], a[172:175], v[124:127]
v_mfma_f32_16x16x32_bf16 v[128:131], v[24:27], a[168:171], v[128:131]
ds_read_b128 v[20:23], v6 offset:54272
global_load_dwordx4 a[212:215], v5, s[20:21] offset:1024 sc1
v_mfma_f32_16x16x32_bf16 v[136:139], v[24:27], a[172:175], v[136:139]
v_mfma_f32_16x16x32_bf16 v[132:135], v[28:31], a[168:171], v[132:135]
ds_read_b128 v[24:27], v6 offset:55296
v_mfma_f32_16x16x32_bf16 v[140:143], v[28:31], a[172:175], v[140:143]
v_mfma_f32_16x16x32_bf16 v[80:83], v[32:35], a[176:179], v[80:83]
ds_read_b128 v[28:31], v6 offset:56320
global_load_dwordx4 a[216:219], v5, s[20:21] offset:2048 sc1
v_mfma_f32_16x16x32_bf16 v[88:91], v[32:35], a[180:183], v[88:91]
s_waitcnt lgkmcnt(3)
v_mfma_f32_16x16x32_bf16 v[84:87], v[36:39], a[176:179], v[84:87]
ds_read_b128 v[32:35], v6 offset:57344
v_mfma_f32_16x16x32_bf16 v[92:95], v[36:39], a[180:183], v[92:95]
v_mfma_f32_16x16x32_bf16 v[96:99], v[40:43], a[176:179], v[96:99]
ds_read_b128 v[36:39], v6 offset:58368
global_load_dwordx4 a[220:223], v5, s[20:21] offset:3072 sc1
v_mfma_f32_16x16x32_bf16 v[104:107], v[40:43], a[180:183], v[104:107]
v_mfma_f32_16x16x32_bf16 v[100:103], v[44:47], a[176:179], v[100:103]
ds_read_b128 v[40:43], v6 offset:59392
v_mfma_f32_16x16x32_bf16 v[108:111], v[44:47], a[180:183], v[108:111]
v_mfma_f32_16x16x32_bf16 v[112:115], v[16:19], a[176:179], v[112:115]
ds_read_b128 v[44:47], v6 offset:60416
s_add_u32 m0, s43, 98304
v_mfma_f32_16x16x32_bf16 v[120:123], v[16:19], a[180:183], v[120:123]
v_add_u32 v4, 16384, v4
s_waitcnt vmcnt(12) lgkmcnt(3)
v_mfma_f32_16x16x32_bf16 v[116:119], v[20:23], a[176:179], v[116:119]
ds_read_b128 v[16:19], v6 offset:61440
global_load_lds_dwordx4 v4, s[20:21] offset:0 sc1
v_mfma_f32_16x16x32_bf16 v[124:127], v[20:23], a[180:183], v[124:127]
v_mfma_f32_16x16x32_bf16 v[128:131], v[24:27], a[176:179], v[128:131]
ds_read_b128 v[20:23], v6 offset:62464
v_mfma_f32_16x16x32_bf16 v[136:139], v[24:27], a[180:183], v[136:139]
v_mfma_f32_16x16x32_bf16 v[132:135], v[28:31], a[176:179], v[132:135]
ds_read_b128 v[24:27], v6 offset:63488
global_load_lds_dwordx4 v4, s[20:21] offset:1024 sc1
v_mfma_f32_16x16x32_bf16 v[140:143], v[28:31], a[180:183], v[140:143]
v_mfma_f32_16x16x32_bf16 v[80:83], v[32:35], a[184:187], v[80:83]
ds_read_b128 v[28:31], v6 offset:64512
v_mfma_f32_16x16x32_bf16 v[88:91], v[32:35], a[188:191], v[88:91]
s_waitcnt lgkmcnt(3)
v_mfma_f32_16x16x32_bf16 v[84:87], v[36:39], a[184:187], v[84:87]
s_barrier
ds_read_b128 v[32:35], v7 offset:0
v_mfma_f32_16x16x32_bf16 v[92:95], v[36:39], a[188:191], v[92:95]
global_load_lds_dwordx4 v4, s[20:21] offset:2048 sc1
v_mfma_f32_16x16x32_bf16 v[96:99], v[40:43], a[184:187], v[96:99]
ds_read_b128 v[36:39], v7 offset:1024
v_mfma_f32_16x16x32_bf16 v[104:107], v[40:43], a[188:191], v[104:107]
v_mfma_f32_16x16x32_bf16 v[100:103], v[44:47], a[184:187], v[100:103]
ds_read_b128 v[40:43], v7 offset:2048
global_load_lds_dwordx4 v4, s[20:21] offset:3072 sc1
v_mfma_f32_16x16x32_bf16 v[108:111], v[44:47], a[188:191], v[108:111]
v_mfma_f32_16x16x32_bf16 v[112:115], v[16:19], a[184:187], v[112:115]
ds_read_b128 v[44:47], v7 offset:3072
v_mfma_f32_16x16x32_bf16 v[120:123], v[16:19], a[188:191], v[120:123]
s_waitcnt vmcnt(14) lgkmcnt(3)
v_mfma_f32_16x16x32_bf16 v[116:119], v[20:23], a[184:187], v[116:119]
ds_read_b128 v[16:19], v7 offset:4096
v_add_u32 v5, 8192, v5
v_mfma_f32_16x16x32_bf16 v[124:127], v[20:23], a[188:191], v[124:127]
global_load_dwordx4 a[224:227], v5, s[20:21] offset:-4096 sc1
v_mfma_f32_16x16x32_bf16 v[128:131], v[24:27], a[184:187], v[128:131]
ds_read_b128 v[20:23], v7 offset:5120
v_mfma_f32_16x16x32_bf16 v[136:139], v[24:27], a[188:191], v[136:139]
v_mfma_f32_16x16x32_bf16 v[132:135], v[28:31], a[184:187], v[132:135]
ds_read_b128 v[24:27], v7 offset:6144
v_mfma_f32_16x16x32_bf16 v[140:143], v[28:31], a[188:191], v[140:143]
v_mfma_f32_16x16x32_bf16 v[80:83], v[32:35], a[192:195], v[80:83]
ds_read_b128 v[28:31], v7 offset:7168
global_load_dwordx4 a[228:231], v5, s[20:21] offset:-3072 sc1
v_mfma_f32_16x16x32_bf16 v[88:91], v[32:35], a[196:199], v[88:91]
s_waitcnt lgkmcnt(3)
v_mfma_f32_16x16x32_bf16 v[84:87], v[36:39], a[192:195], v[84:87]
ds_read_b128 v[32:35], v7 offset:8192
v_mfma_f32_16x16x32_bf16 v[92:95], v[36:39], a[196:199], v[92:95]
v_mfma_f32_16x16x32_bf16 v[96:99], v[40:43], a[192:195], v[96:99]
ds_read_b128 v[36:39], v7 offset:9216
s_add_u32 m0, s43, 114688
v_mfma_f32_16x16x32_bf16 v[104:107], v[40:43], a[196:199], v[104:107]
v_add_u32 v4, 16384, v4
v_mfma_f32_16x16x32_bf16 v[100:103], v[44:47], a[192:195], v[100:103]
ds_read_b128 v[40:43], v7 offset:10240
global_load_lds_dwordx4 v4, s[20:21] offset:0 sc1
v_mfma_f32_16x16x32_bf16 v[108:111], v[44:47], a[196:199], v[108:111]
v_mfma_f32_16x16x32_bf16 v[112:115], v[16:19], a[192:195], v[112:115]
ds_read_b128 v[44:47], v7 offset:11264
global_load_lds_dwordx4 v4, s[20:21] offset:1024 sc1
v_mfma_f32_16x16x32_bf16 v[120:123], v[16:19], a[196:199], v[120:123]
s_waitcnt vmcnt(12) lgkmcnt(3)
v_mfma_f32_16x16x32_bf16 v[116:119], v[20:23], a[192:195], v[116:119]
ds_read_b128 v[16:19], v7 offset:12288
v_mfma_f32_16x16x32_bf16 v[124:127], v[20:23], a[196:199], v[124:127]
v_mfma_f32_16x16x32_bf16 v[128:131], v[24:27], a[192:195], v[128:131]
ds_read_b128 v[20:23], v7 offset:13312
global_load_lds_dwordx4 v4, s[20:21] offset:2048 sc1
v_mfma_f32_16x16x32_bf16 v[136:139], v[24:27], a[196:199], v[136:139]
v_mfma_f32_16x16x32_bf16 v[132:135], v[28:31], a[192:195], v[132:135]
ds_read_b128 v[24:27], v7 offset:14336
v_mfma_f32_16x16x32_bf16 v[140:143], v[28:31], a[196:199], v[140:143]
v_mfma_f32_16x16x32_bf16 v[80:83], v[32:35], a[200:203], v[80:83]
ds_read_b128 v[28:31], v7 offset:15360
v_mfma_f32_16x16x32_bf16 v[88:91], v[32:35], a[204:207], v[88:91]
s_waitcnt lgkmcnt(3)
v_mfma_f32_16x16x32_bf16 v[84:87], v[36:39], a[200:203], v[84:87]
s_barrier
ds_read_b128 v[32:35], v7 offset:16384
v_mfma_f32_16x16x32_bf16 v[92:95], v[36:39], a[204:207], v[92:95]
global_load_lds_dwordx4 v4, s[20:21] offset:3072 sc1
v_mfma_f32_16x16x32_bf16 v[96:99], v[40:43], a[200:203], v[96:99]
ds_read_b128 v[36:39], v7 offset:17408
v_mfma_f32_16x16x32_bf16 v[104:107], v[40:43], a[204:207], v[104:107]
v_mfma_f32_16x16x32_bf16 v[100:103], v[44:47], a[200:203], v[100:103]
ds_read_b128 v[40:43], v7 offset:18432
global_load_dwordx4 a[232:235], v5, s[20:21] offset:-2048 sc1
v_mfma_f32_16x16x32_bf16 v[108:111], v[44:47], a[204:207], v[108:111]
v_mfma_f32_16x16x32_bf16 v[112:115], v[16:19], a[200:203], v[112:115]
ds_read_b128 v[44:47], v7 offset:19456
v_mfma_f32_16x16x32_bf16 v[120:123], v[16:19], a[204:207], v[120:123]
s_waitcnt vmcnt(13) lgkmcnt(3)
v_mfma_f32_16x16x32_bf16 v[116:119], v[20:23], a[200:203], v[116:119]
ds_read_b128 v[16:19], v7 offset:20480
global_load_dwordx4 a[236:239], v5, s[20:21] offset:-1024 sc1
v_mfma_f32_16x16x32_bf16 v[124:127], v[20:23], a[204:207], v[124:127]
v_mfma_f32_16x16x32_bf16 v[128:131], v[24:27], a[200:203], v[128:131]
ds_read_b128 v[20:23], v7 offset:21504
v_mfma_f32_16x16x32_bf16 v[136:139], v[24:27], a[204:207], v[136:139]
v_mfma_f32_16x16x32_bf16 v[132:135], v[28:31], a[200:203], v[132:135]
ds_read_b128 v[24:27], v7 offset:22528
global_load_dwordx4 a[240:243], v5, s[20:21] offset:0 sc1
v_mfma_f32_16x16x32_bf16 v[140:143], v[28:31], a[204:207], v[140:143]
v_mfma_f32_16x16x32_bf16 v[80:83], v[32:35], a[208:211], v[80:83]
ds_read_b128 v[28:31], v7 offset:23552
v_mfma_f32_16x16x32_bf16 v[88:91], v[32:35], a[212:215], v[88:91]
s_waitcnt lgkmcnt(3)
v_mfma_f32_16x16x32_bf16 v[84:87], v[36:39], a[208:211], v[84:87]
ds_read_b128 v[32:35], v7 offset:24576
v_mfma_f32_16x16x32_bf16 v[92:95], v[36:39], a[212:215], v[92:95]
v_mfma_f32_16x16x32_bf16 v[96:99], v[40:43], a[208:211], v[96:99]
ds_read_b128 v[36:39], v7 offset:25600
global_load_dwordx4 a[244:247], v5, s[20:21] offset:1024 sc1
v_mfma_f32_16x16x32_bf16 v[104:107], v[40:43], a[212:215], v[104:107]
v_mfma_f32_16x16x32_bf16 v[100:103], v[44:47], a[208:211], v[100:103]
ds_read_b128 v[40:43], v7 offset:26624
v_mfma_f32_16x16x32_bf16 v[108:111], v[44:47], a[212:215], v[108:111]
v_mfma_f32_16x16x32_bf16 v[112:115], v[16:19], a[208:211], v[112:115]
ds_read_b128 v[44:47], v7 offset:27648
global_load_dwordx4 a[248:251], v5, s[20:21] offset:2048 sc1
v_mfma_f32_16x16x32_bf16 v[120:123], v[16:19], a[212:215], v[120:123]
s_waitcnt vmcnt(15) lgkmcnt(3)
v_mfma_f32_16x16x32_bf16 v[116:119], v[20:23], a[208:211], v[116:119]
ds_read_b128 v[16:19], v7 offset:28672
v_mfma_f32_16x16x32_bf16 v[124:127], v[20:23], a[212:215], v[124:127]
v_mfma_f32_16x16x32_bf16 v[128:131], v[24:27], a[208:211], v[128:131]
ds_read_b128 v[20:23], v7 offset:29696
global_load_dwordx4 a[252:255], v5, s[20:21] offset:3072 sc1
v_mfma_f32_16x16x32_bf16 v[136:139], v[24:27], a[212:215], v[136:139]
v_mfma_f32_16x16x32_bf16 v[132:135], v[28:31], a[208:211], v[132:135]
ds_read_b128 v[24:27], v7 offset:30720
v_mfma_f32_16x16x32_bf16 v[140:143], v[28:31], a[212:215], v[140:143]
v_mfma_f32_16x16x32_bf16 v[80:83], v[32:35], a[216:219], v[80:83]
ds_read_b128 v[28:31], v7 offset:31744
s_add_u32 m0, s43, 0
v_mfma_f32_16x16x32_bf16 v[88:91], v[32:35], a[220:223], v[88:91]
v_add_u32 v4, 16384, v4
s_waitcnt lgkmcnt(3)
v_mfma_f32_16x16x32_bf16 v[84:87], v[36:39], a[216:219], v[84:87]
ds_read_b128 v[32:35], v8 offset:4096
global_load_lds_dwordx4 v4, s[20:21] offset:0 sc1
v_mfma_f32_16x16x32_bf16 v[92:95], v[36:39], a[220:223], v[92:95]
v_mfma_f32_16x16x32_bf16 v[96:99], v[40:43], a[216:219], v[96:99]
ds_read_b128 v[36:39], v8 offset:4352
v_mfma_f32_16x16x32_bf16 v[104:107], v[40:43], a[220:223], v[104:107]
v_mfma_f32_16x16x32_bf16 v[100:103], v[44:47], a[216:219], v[100:103]
ds_read_b128 v[40:43], v8 offset:4608
global_load_lds_dwordx4 v4, s[20:21] offset:1024 sc1
v_mfma_f32_16x16x32_bf16 v[108:111], v[44:47], a[220:223], v[108:111]
v_mfma_f32_16x16x32_bf16 v[112:115], v[16:19], a[216:219], v[112:115]
ds_read_b128 v[44:47], v8 offset:4864
v_mfma_f32_16x16x32_bf16 v[120:123], v[16:19], a[220:223], v[120:123]
s_waitcnt lgkmcnt(3)
v_mfma_f32_16x16x32_bf16 v[116:119], v[20:23], a[216:219], v[116:119]
ds_read_b128 v[16:19], v8 offset:5120
global_load_lds_dwordx4 v4, s[20:21] offset:2048 sc1
v_mfma_f32_16x16x32_bf16 v[124:127], v[20:23], a[220:223], v[124:127]
v_mfma_f32_16x16x32_bf16 v[128:131], v[24:27], a[216:219], v[128:131]
ds_read_b128 v[20:23], v8 offset:5376
v_mfma_f32_16x16x32_bf16 v[136:139], v[24:27], a[220:223], v[136:139]
v_mfma_f32_16x16x32_bf16 v[132:135], v[28:31], a[216:219], v[132:135]
ds_read_b128 v[24:27], v8 offset:5632
global_load_lds_dwordx4 v4, s[20:21] offset:3072 sc1
v_mfma_f32_16x16x32_bf16 v[140:143], v[28:31], a[220:223], v[140:143]
v_mfma_f32_16x16x32_bf16 v[80:83], v[32:35], v[64:67], v[80:83]
ds_read_b128 v[28:31], v8 offset:5888
v_mfma_f32_16x16x32_bf16 v[88:91], v[32:35], v[68:71], v[88:91]
s_waitcnt vmcnt(16) lgkmcnt(3)
v_mfma_f32_16x16x32_bf16 v[84:87], v[36:39], v[64:67], v[84:87]
s_barrier
ds_read_b128 v[32:35], v7 offset:32768
v_mfma_f32_16x16x32_bf16 v[92:95], v[36:39], v[68:71], v[92:95]
s_add_u32 m0, s43, 16384
v_add_u32 v4, 16384, v4
v_mfma_f32_16x16x32_bf16 v[96:99], v[40:43], v[64:67], v[96:99]
ds_read_b128 v[36:39], v7 offset:33792
global_load_lds_dwordx4 v4, s[20:21] offset:0 sc1
v_mfma_f32_16x16x32_bf16 v[104:107], v[40:43], v[68:71], v[104:107]
v_mfma_f32_16x16x32_bf16 v[100:103], v[44:47], v[64:67], v[100:103]
ds_read_b128 v[40:43], v7 offset:34816
global_load_lds_dwordx4 v4, s[20:21] offset:1024 sc1
v_mfma_f32_16x16x32_bf16 v[108:111], v[44:47], v[68:71], v[108:111]
v_mfma_f32_16x16x32_bf16 v[112:115], v[16:19], v[64:67], v[112:115]
ds_read_b128 v[44:47], v7 offset:35840
v_mfma_f32_16x16x32_bf16 v[120:123], v[16:19], v[68:71], v[120:123]
s_waitcnt vmcnt(16) lgkmcnt(3)
v_mfma_f32_16x16x32_bf16 v[116:119], v[20:23], v[64:67], v[116:119]
ds_read_b128 v[16:19], v7 offset:36864
v_mfma_f32_16x16x32_bf16 v[124:127], v[20:23], v[68:71], v[124:127]
v_mfma_f32_16x16x32_bf16 v[128:131], v[24:27], v[64:67], v[128:131]
ds_read_b128 v[20:23], v7 offset:37888
global_load_lds_dwordx4 v4, s[20:21] offset:2048 sc1
v_mfma_f32_16x16x32_bf16 v[136:139], v[24:27], v[68:71], v[136:139]
v_mfma_f32_16x16x32_bf16 v[132:135], v[28:31], v[64:67], v[132:135]
ds_read_b128 v[24:27], v7 offset:38912
v_mfma_f32_16x16x32_bf16 v[140:143], v[28:31], v[68:71], v[140:143]
v_mfma_f32_16x16x32_bf16 v[80:83], v[32:35], a[224:227], v[80:83]
ds_read_b128 v[28:31], v7 offset:39936
global_load_lds_dwordx4 v4, s[20:21] offset:3072 sc1
v_mfma_f32_16x16x32_bf16 v[88:91], v[32:35], a[228:231], v[88:91]
s_waitcnt lgkmcnt(3)
v_mfma_f32_16x16x32_bf16 v[84:87], v[36:39], a[224:227], v[84:87]
ds_read_b128 v[32:35], v7 offset:40960
v_mfma_f32_16x16x32_bf16 v[92:95], v[36:39], a[228:231], v[92:95]
v_mfma_f32_16x16x32_bf16 v[96:99], v[40:43], a[224:227], v[96:99]
ds_read_b128 v[36:39], v7 offset:41984
s_add_u32 m0, s43, 32768
v_mfma_f32_16x16x32_bf16 v[104:107], v[40:43], a[228:231], v[104:107]
v_add_u32 v4, 16384, v4
v_mfma_f32_16x16x32_bf16 v[100:103], v[44:47], a[224:227], v[100:103]
ds_read_b128 v[40:43], v7 offset:43008
global_load_lds_dwordx4 v4, s[20:21] offset:0 sc1
v_mfma_f32_16x16x32_bf16 v[108:111], v[44:47], a[228:231], v[108:111]
v_mfma_f32_16x16x32_bf16 v[112:115], v[16:19], a[224:227], v[112:115]
ds_read_b128 v[44:47], v7 offset:44032
global_load_lds_dwordx4 v4, s[20:21] offset:1024 sc1
v_mfma_f32_16x16x32_bf16 v[120:123], v[16:19], a[228:231], v[120:123]
s_waitcnt vmcnt(14) lgkmcnt(3)
v_mfma_f32_16x16x32_bf16 v[116:119], v[20:23], a[224:227], v[116:119]
ds_read_b128 v[16:19], v7 offset:45056
v_mfma_f32_16x16x32_bf16 v[124:127], v[20:23], a[228:231], v[124:127]
v_mfma_f32_16x16x32_bf16 v[128:131], v[24:27], a[224:227], v[128:131]
ds_read_b128 v[20:23], v7 offset:46080
v_mfma_f32_16x16x32_bf16 v[136:139], v[24:27], a[228:231], v[136:139]
v_mfma_f32_16x16x32_bf16 v[132:135], v[28:31], a[224:227], v[132:135]
ds_read_b128 v[24:27], v7 offset:47104
global_load_lds_dwordx4 v4, s[20:21] offset:2048 sc1
v_mfma_f32_16x16x32_bf16 v[140:143], v[28:31], a[228:231], v[140:143]
v_mfma_f32_16x16x32_bf16 v[80:83], v[32:35], a[232:235], v[80:83]
ds_read_b128 v[28:31], v7 offset:48128
v_mfma_f32_16x16x32_bf16 v[88:91], v[32:35], a[236:239], v[88:91]
s_waitcnt lgkmcnt(3)
v_mfma_f32_16x16x32_bf16 v[84:87], v[36:39], a[232:235], v[84:87]
s_barrier
ds_read_b128 v[32:35], v7 offset:49152
v_mfma_f32_16x16x32_bf16 v[92:95], v[36:39], a[236:239], v[92:95]
global_load_lds_dwordx4 v4, s[20:21] offset:3072 sc1
v_mfma_f32_16x16x32_bf16 v[96:99], v[40:43], a[232:235], v[96:99]
ds_read_b128 v[36:39], v7 offset:50176
v_mfma_f32_16x16x32_bf16 v[104:107], v[40:43], a[236:239], v[104:107]
v_mfma_f32_16x16x32_bf16 v[100:103], v[44:47], a[232:235], v[100:103]
ds_read_b128 v[40:43], v7 offset:51200
s_add_u32 m0, s43, 49152
v_mfma_f32_16x16x32_bf16 v[108:111], v[44:47], a[236:239], v[108:111]
v_add_u32 v4, 16384, v4
v_mfma_f32_16x16x32_bf16 v[112:115], v[16:19], a[232:235], v[112:115]
ds_read_b128 v[44:47], v7 offset:52224
global_load_lds_dwordx4 v4, s[20:21] offset:0 sc1
v_mfma_f32_16x16x32_bf16 v[120:123], v[16:19], a[236:239], v[120:123]
s_getpc_b64 s[4:5]
s_waitcnt vmcnt(15) lgkmcnt(3)
v_mfma_f32_16x16x32_bf16 v[116:119], v[20:23], a[232:235], v[116:119]
ds_read_b128 v[16:19], v7 offset:53248
global_load_dword v13, v12, s[4:5]
v_mfma_f32_16x16x32_bf16 v[124:127], v[20:23], a[236:239], v[124:127]
v_mfma_f32_16x16x32_bf16 v[128:131], v[24:27], a[232:235], v[128:131]
ds_read_b128 v[20:23], v7 offset:54272
global_load_lds_dwordx4 v4, s[20:21] offset:1024 sc1
v_mfma_f32_16x16x32_bf16 v[136:139], v[24:27], a[236:239], v[136:139]
v_mfma_f32_16x16x32_bf16 v[132:135], v[28:31], a[232:235], v[132:135]
ds_read_b128 v[24:27], v7 offset:55296
v_mfma_f32_16x16x32_bf16 v[140:143], v[28:31], a[236:239], v[140:143]
v_mfma_f32_16x16x32_bf16 v[80:83], v[32:35], a[240:243], v[80:83]
ds_read_b128 v[28:31], v7 offset:56320
global_load_lds_dwordx4 v4, s[20:21] offset:2048 sc1
v_mfma_f32_16x16x32_bf16 v[88:91], v[32:35], a[244:247], v[88:91]
s_waitcnt lgkmcnt(3)
v_mfma_f32_16x16x32_bf16 v[84:87], v[36:39], a[240:243], v[84:87]
ds_read_b128 v[32:35], v7 offset:57344
v_mfma_f32_16x16x32_bf16 v[92:95], v[36:39], a[244:247], v[92:95]
v_mfma_f32_16x16x32_bf16 v[96:99], v[40:43], a[240:243], v[96:99]
ds_read_b128 v[36:39], v7 offset:58368
global_load_lds_dwordx4 v4, s[20:21] offset:3072 sc1
v_mfma_f32_16x16x32_bf16 v[104:107], v[40:43], a[244:247], v[104:107]
v_mfma_f32_16x16x32_bf16 v[100:103], v[44:47], a[240:243], v[100:103]
ds_read_b128 v[40:43], v7 offset:59392
v_mfma_f32_16x16x32_bf16 v[108:111], v[44:47], a[244:247], v[108:111]
v_mfma_f32_16x16x32_bf16 v[112:115], v[16:19], a[240:243], v[112:115]
ds_read_b128 v[44:47], v7 offset:60416
s_add_u32 m0, s43, 65536
v_mfma_f32_16x16x32_bf16 v[120:123], v[16:19], a[244:247], v[120:123]
v_add_u32 v4, 16384, v4
s_waitcnt vmcnt(17) lgkmcnt(3)
v_mfma_f32_16x16x32_bf16 v[116:119], v[20:23], a[240:243], v[116:119]
ds_read_b128 v[16:19], v7 offset:61440
global_load_lds_dwordx4 v4, s[20:21] offset:0 sc1
v_mfma_f32_16x16x32_bf16 v[124:127], v[20:23], a[244:247], v[124:127]
v_mfma_f32_16x16x32_bf16 v[128:131], v[24:27], a[240:243], v[128:131]
ds_read_b128 v[20:23], v7 offset:62464
v_mfma_f32_16x16x32_bf16 v[136:139], v[24:27], a[244:247], v[136:139]
v_mfma_f32_16x16x32_bf16 v[132:135], v[28:31], a[240:243], v[132:135]
ds_read_b128 v[24:27], v7 offset:63488
global_load_lds_dwordx4 v4, s[20:21] offset:1024 sc1
v_mfma_f32_16x16x32_bf16 v[140:143], v[28:31], a[244:247], v[140:143]
v_mfma_f32_16x16x32_bf16 v[80:83], v[32:35], a[248:251], v[80:83]
ds_read_b128 v[28:31], v7 offset:64512
v_mfma_f32_16x16x32_bf16 v[88:91], v[32:35], a[252:255], v[88:91]
s_waitcnt lgkmcnt(3)
v_mfma_f32_16x16x32_bf16 v[84:87], v[36:39], a[248:251], v[84:87]
ds_read_b128 v[32:35], v8 offset:6144
global_load_lds_dwordx4 v4, s[20:21] offset:2048 sc1
v_mfma_f32_16x16x32_bf16 v[92:95], v[36:39], a[252:255], v[92:95]
v_mfma_f32_16x16x32_bf16 v[96:99], v[40:43], a[248:251], v[96:99]
ds_read_b128 v[36:39], v8 offset:6400
v_mfma_f32_16x16x32_bf16 v[104:107], v[40:43], a[252:255], v[104:107]
v_mul_f32 v208, v80, v80
v_mul_f32 v209, v81, v81
v_fma_f32 v208, v208, v73, v72
v_mul_f32 v210, v82, v82
v_fma_f32 v209, v209, v73, v72
v_mfma_f32_16x16x32_bf16 v[100:103], v[44:47], a[248:251], v[100:103]
ds_read_b128 v[40:43], v8 offset:6656
global_load_lds_dwordx4 v4, s[20:21] offset:3072 sc1
v_mfma_f32_16x16x32_bf16 v[108:111], v[44:47], a[252:255], v[108:111]
v_mul_f32 v208, v208, v80
v_mul_f32 v211, v83, v83
v_fma_f32 v210, v210, v73, v72
v_mfma_f32_16x16x32_bf16 v[112:115], v[16:19], a[248:251], v[112:115]
ds_read_b128 v[44:47], v8 offset:6912
v_mul_f32 v209, v209, v81
v_mfma_f32_16x16x32_bf16 v[120:123], v[16:19], a[252:255], v[120:123]
v_mul_f32 v212, v84, v84
v_exp_f32 v208, v208
s_waitcnt vmcnt(17) lgkmcnt(3)
v_mfma_f32_16x16x32_bf16 v[116:119], v[20:23], a[248:251], v[116:119]
ds_read_b128 v[16:19], v8 offset:7168
s_add_u32 m0, s43, 81920
v_mfma_f32_16x16x32_bf16 v[124:127], v[20:23], a[252:255], v[124:127]
v_add_u32 v4, 16384, v4
v_fma_f32 v211, v211, v73, v72
v_mul_f32 v210, v210, v82
v_mfma_f32_16x16x32_bf16 v[128:131], v[24:27], a[248:251], v[128:131]
ds_read_b128 v[20:23], v8 offset:7424
global_load_lds_dwordx4 v4, s[20:21] offset:0 sc1
v_mfma_f32_16x16x32_bf16 v[136:139], v[24:27], a[252:255], v[136:139]
v_exp_f32 v209, v209
v_fma_f32 v208, v208, v74, v74
v_mul_f32 v213, v85, v85
v_fma_f32 v212, v212, v73, v72
v_mfma_f32_16x16x32_bf16 v[132:135], v[28:31], a[248:251], v[132:135]
s_barrier
ds_read_b128 v[24:27], v6 offset:0
v_mfma_f32_16x16x32_bf16 v[140:143], v[28:31], a[252:255], v[140:143]
global_load_lds_dwordx4 v4, s[20:21] offset:1024 sc1
v_mul_f32 v211, v211, v83
v_exp_f32 v210, v210
v_mfma_f32_16x16x32_bf16 v[144:147], v[32:35], v[64:67], 0
ds_read_b128 v[28:31], v6 offset:1024
v_fma_f32 v209, v209, v74, v74
v_mfma_f32_16x16x32_bf16 v[152:155], v[32:35], v[68:71], 0
v_mul_f32 v214, v86, v86
s_waitcnt lgkmcnt(3)
v_mfma_f32_16x16x32_bf16 v[148:151], v[36:39], v[64:67], 0
ds_read_b128 v[32:35], v6 offset:2048
global_load_lds_dwordx4 v4, s[20:21] offset:2048 sc1
v_mfma_f32_16x16x32_bf16 v[156:159], v[36:39], v[68:71], 0
v_rcp_f32 v208, v208
v_fma_f32 v213, v213, v73, v72
v_mul_f32 v212, v212, v84
v_mfma_f32_16x16x32_bf16 v[160:163], v[40:43], v[64:67], 0
ds_read_b128 v[36:39], v6 offset:3072
global_load_lds_dwordx4 v4, s[20:21] offset:3072 sc1
v_mfma_f32_16x16x32_bf16 v[168:171], v[40:43], v[68:71], 0
v_exp_f32 v211, v211
v_fma_f32 v210, v210, v74, v74
v_mfma_f32_16x16x32_bf16 v[164:167], v[44:47], v[64:67], 0
ds_read_b128 v[40:43], v6 offset:4096
v_mul_f32 v80, v208, v80
v_mfma_f32_16x16x32_bf16 v[172:175], v[44:47], v[68:71], 0
v_rcp_f32 v209, v209
v_mul_f32 v215, v87, v87
v_fma_f32 v214, v214, v73, v72
v_mfma_f32_16x16x32_bf16 v[176:179], v[16:19], v[64:67], 0
ds_read_b128 v[44:47], v6 offset:5120
s_add_u32 m0, s43, 98304
v_mfma_f32_16x16x32_bf16 v[184:187], v[16:19], v[68:71], 0
v_add_u32 v4, 16384, v4
v_mul_f32 v213, v213, v85
v_exp_f32 v212, v212
s_waitcnt lgkmcnt(3)
v_mfma_f32_16x16x32_bf16 v[180:183], v[20:23], v[64:67], 0
ds_read_b128 v[16:19], v6 offset:6144
global_load_lds_dwordx4 v4, s[20:21] offset:0 sc1
v_mfma_f32_16x16x32_bf16 v[188:191], v[20:23], v[68:71], 0
v_rcp_f32 v210, v210
v_fma_f32 v211, v211, v74, v74
v_mfma_f32_16x16x32_bf16 v[144:147], v[24:27], a[0:3], v[144:147]
ds_read_b128 v[20:23], v6 offset:7168
global_load_lds_dwordx4 v4, s[20:21] offset:1024 sc1
v_mfma_f32_16x16x32_bf16 v[152:155], v[24:27], a[4:7], v[152:155]
v_mul_f32 v81, v209, v81
v_mul_f32 v208, v88, v88
v_fma_f32 v215, v215, v73, v72
v_mul_f32 v214, v214, v86
v_mfma_f32_16x16x32_bf16 v[148:151], v[28:31], a[0:3], v[148:151]
ds_read_b128 v[24:27], v6 offset:8192
v_fma_f32 v212, v212, v74, v74
v_mfma_f32_16x16x32_bf16 v[156:159], v[28:31], a[4:7], v[156:159]
v_exp_f32 v213, v213
v_mfma_f32_16x16x32_bf16 v[160:163], v[32:35], a[0:3], v[160:163]
ds_read_b128 v[28:31], v6 offset:9216
global_load_lds_dwordx4 v4, s[20:21] offset:2048 sc1
v_mfma_f32_16x16x32_bf16 v[168:171], v[32:35], a[4:7], v[168:171]
v_mul_f32 v82, v210, v82
v_rcp_f32 v211, v211
s_waitcnt lgkmcnt(3)
v_mfma_f32_16x16x32_bf16 v[164:167], v[36:39], a[0:3], v[164:167]
ds_read_b128 v[32:35], v6 offset:10240
v_cvt_pk_bf16_f32 v240, v80, v81
v_mfma_f32_16x16x32_bf16 v[172:175], v[36:39], a[4:7], v[172:175]
v_exp_f32 v214, v214
v_mul_f32 v209, v89, v89
v_mfma_f32_16x16x32_bf16 v[176:179], v[40:43], a[0:3], v[176:179]
ds_read_b128 v[36:39], v6 offset:11264
global_load_lds_dwordx4 v4, s[20:21] offset:3072 sc1
v_mfma_f32_16x16x32_bf16 v[184:187], v[40:43], a[4:7], v[184:187]
v_rcp_f32 v212, v212
v_fma_f32 v208, v208, v76, v75
v_mfma_f32_16x16x32_bf16 v[180:183], v[44:47], a[0:3], v[180:183]
ds_read_b128 v[40:43], v6 offset:12288
v_mul_f32 v215, v215, v87
v_mfma_f32_16x16x32_bf16 v[188:191], v[44:47], a[4:7], v[188:191]
v_fma_f32 v213, v213, v74, v74
v_mul_f32 v83, v211, v83
v_mul_f32 v210, v90, v90
v_mfma_f32_16x16x32_bf16 v[144:147], v[16:19], a[8:11], v[144:147]
ds_read_b128 v[44:47], v6 offset:13312
s_add_u32 m0, s43, 114688
v_mfma_f32_16x16x32_bf16 v[152:155], v[16:19], a[12:15], v[152:155]
v_add_u32 v4, 16384, v4
v_fma_f32 v209, v209, v76, v75
v_mul_f32 v208, v208, v88
s_waitcnt vmcnt(21) lgkmcnt(3)
v_mfma_f32_16x16x32_bf16 v[148:151], v[20:23], a[8:11], v[148:151]
ds_read_b128 v[16:19], v6 offset:14336
global_load_lds_dwordx4 v4, s[20:21] offset:0 sc1
v_mfma_f32_16x16x32_bf16 v[156:159], v[20:23], a[12:15], v[156:159]
v_exp_f32 v215, v215
v_fma_f32 v214, v214, v74, v74
v_mfma_f32_16x16x32_bf16 v[160:163], v[24:27], a[8:11], v[160:163]
ds_read_b128 v[20:23], v6 offset:15360
global_load_lds_dwordx4 v4, s[20:21] offset:1024 sc1
v_mfma_f32_16x16x32_bf16 v[168:171], v[24:27], a[12:15], v[168:171]
v_rcp_f32 v213, v213
v_mul_f32 v84, v212, v84
v_cvt_pk_bf16_f32 v241, v82, v83
v_mul_f32 v211, v91, v91
v_mfma_f32_16x16x32_bf16 v[164:167], v[28:31], a[8:11], v[164:167]
s_barrier
ds_read_b128 v[24:27], v6 offset:16384
v_mfma_f32_16x16x32_bf16 v[172:175], v[28:31], a[12:15], v[172:175]
v_exp_f32 v208, v208
v_fma_f32 v210, v210, v76, v75
v_mfma_f32_16x16x32_bf16 v[176:179], v[32:35], a[8:11], v[176:179]
ds_read_b128 v[28:31], v6 offset:17408
global_load_lds_dwordx4 v4, s[20:21] offset:2048 sc1
v_mfma_f32_16x16x32_bf16 v[184:187], v[32:35], a[12:15], v[184:187]
v_mul_f32 v209, v209, v89
v_fma_f32 v215, v215, v74, v74
v_rcp_f32 v214, v214
s_waitcnt lgkmcnt(3)
v_mfma_f32_16x16x32_bf16 v[180:183], v[36:39], a[8:11], v[180:183]
ds_read_b128 v[32:35], v6 offset:18432
v_mul_f32 v85, v213, v85
v_mfma_f32_16x16x32_bf16 v[188:191], v[36:39], a[12:15], v[188:191]
v_exp_f32 v209, v209
v_mfma_f32_16x16x32_bf16 v[144:147], v[40:43], a[16:19], v[144:147]
ds_read_b128 v[36:39], v6 offset:19456
global_load_lds_dwordx4 v4, s[20:21] offset:3072 sc1
v_mfma_f32_16x16x32_bf16 v[152:155], v[40:43], a[20:23], v[152:155]
v_mul_f32 v212, v92, v92
v_fma_f32 v211, v211, v76, v75
v_mul_f32 v210, v210, v90
v_mfma_f32_16x16x32_bf16 v[148:151], v[44:47], a[16:19], v[148:151]
ds_read_b128 v[40:43], v6 offset:20480
v_fma_f32 v208, v208, v77, v77
v_mfma_f32_16x16x32_bf16 v[156:159], v[44:47], a[20:23], v[156:159]
v_rcp_f32 v215, v215
v_mul_f32 v86, v214, v86
v_mfma_f32_16x16x32_bf16 v[160:163], v[16:19], a[16:19], v[160:163]
ds_read_b128 v[44:47], v6 offset:21504
v_cvt_pk_bf16_f32 v242, v84, v85
v_mfma_f32_16x16x32_bf16 v[168:171], v[16:19], a[20:23], v[168:171]
v_mul_f32 v213, v93, v93
v_fma_f32 v212, v212, v76, v75
s_waitcnt lgkmcnt(3)
v_mfma_f32_16x16x32_bf16 v[164:167], v[20:23], a[16:19], v[164:167]
ds_read_b128 v[16:19], v6 offset:22528
v_mul_f32 v211, v211, v91
v_mfma_f32_16x16x32_bf16 v[172:175], v[20:23], a[20:23], v[172:175]
v_exp_f32 v210, v210
v_fma_f32 v209, v209, v77, v77
v_mfma_f32_16x16x32_bf16 v[176:179], v[24:27], a[16:19], v[176:179]
ds_read_b128 v[20:23], v6 offset:23552
v_mul_f32 v87, v215, v87
v_mfma_f32_16x16x32_bf16 v[184:187], v[24:27], a[20:23], v[184:187]
v_rcp_f32 v208, v208
v_mfma_f32_16x16x32_bf16 v[180:183], v[28:31], a[16:19], v[180:183]
ds_read_b128 v[24:27], v6 offset:24576
v_mul_f32 v214, v94, v94
v_mfma_f32_16x16x32_bf16 v[188:191], v[28:31], a[20:23], v[188:191]
v_exp_f32 v211, v211
v_mfma_f32_16x16x32_bf16 v[144:147], v[32:35], a[24:27], v[144:147]
ds_read_b128 v[28:31], v6 offset:25600
v_fma_f32 v213, v213, v76, v75
v_mfma_f32_16x16x32_bf16 v[152:155], v[32:35], a[28:31], v[152:155]
v_mul_f32 v212, v212, v92
v_fma_f32 v210, v210, v77, v77
s_waitcnt lgkmcnt(3)
v_mfma_f32_16x16x32_bf16 v[148:151], v[36:39], a[24:27], v[148:151]
ds_read_b128 v[32:35], v6 offset:26624
v_mul_f32 v88, v208, v88
v_mfma_f32_16x16x32_bf16 v[156:159], v[36:39], a[28:31], v[156:159]
v_rcp_f32 v209, v209
v_cvt_pk_bf16_f32 v243, v86, v87
v_mfma_f32_16x16x32_bf16 v[160:163], v[40:43], a[24:27], v[160:163]
ds_read_b128 v[36:39], v6 offset:27648
v_mul_f32 v215, v95, v95
v_mfma_f32_16x16x32_bf16 v[168:171], v[40:43], a[28:31], v[168:171]
v_exp_f32 v212, v212
v_fma_f32 v214, v214, v76, v75
v_mfma_f32_16x16x32_bf16 v[164:167], v[44:47], a[24:27], v[164:167]
ds_read_b128 v[40:43], v6 offset:28672
v_mul_f32 v213, v213, v93
v_mfma_f32_16x16x32_bf16 v[172:175], v[44:47], a[28:31], v[172:175]
v_rcp_f32 v210, v210
v_mfma_f32_16x16x32_bf16 v[176:179], v[16:19], a[24:27], v[176:179]
ds_read_b128 v[44:47], v6 offset:29696
v_fma_f32 v211, v211, v77, v77
v_mfma_f32_16x16x32_bf16 v[184:187], v[16:19], a[28:31], v[184:187]
v_mul_f32 v89, v209, v89
v_fma_f32 v215, v215, v76, v75
s_waitcnt vmcnt(21) lgkmcnt(3)
v_mfma_f32_16x16x32_bf16 v[180:183], v[20:23], a[24:27], v[180:183]
s_barrier
ds_read_b128 v[16:19], v6 offset:30720
v_mfma_f32_16x16x32_bf16 v[188:191], v[20:23], a[28:31], v[188:191]
s_add_u32 m0, s43, 0
v_add_u32 v4, 16384, v4
v_mul_f32 v214, v214, v94
v_exp_f32 v213, v213
v_fma_f32 v212, v212, v77, v77
v_mfma_f32_16x16x32_bf16 v[144:147], v[24:27], a[32:35], v[144:147]
ds_read_b128 v[20:23], v6 offset:31744
global_load_lds_dwordx4 v4, s[20:21] offset:0 sc1
v_mfma_f32_16x16x32_bf16 v[152:155], v[24:27], a[36:39], v[152:155]
global_load_lds_dwordx4 v4, s[20:21] offset:1024 sc1
global_load_lds_dwordx4 v4, s[20:21] offset:2048 sc1
v_rcp_f32 v211, v211
v_mul_f32 v90, v210, v90
v_mfma_f32_16x16x32_bf16 v[148:151], v[28:31], a[32:35], v[148:151]
s_barrier
ds_read_b128 v[24:27], v6 offset:32768
v_mfma_f32_16x16x32_bf16 v[156:159], v[28:31], a[36:39], v[156:159]
global_load_lds_dwordx4 v4, s[20:21] offset:3072 sc1
v_cvt_pk_bf16_f32 v244, v88, v89
v_mul_f32 v215, v215, v95
v_exp_f32 v214, v214
v_mfma_f32_16x16x32_bf16 v[160:163], v[32:35], a[32:35], v[160:163]
ds_read_b128 v[28:31], v6 offset:33792
v_fma_f32 v213, v213, v77, v77
v_mfma_f32_16x16x32_bf16 v[168:171], v[32:35], a[36:39], v[168:171]
v_mul_f32 v91, v211, v91
s_waitcnt lgkmcnt(3)
v_mfma_f32_16x16x32_bf16 v[164:167], v[36:39], a[32:35], v[164:167]
ds_read_b128 v[32:35], v6 offset:34816
v_fma_f32 v214, v214, v77, v77
v_mfma_f32_16x16x32_bf16 v[172:175], v[36:39], a[36:39], v[172:175]
v_rcp_f32 v212, v212
v_mfma_f32_16x16x32_bf16 v[176:179], v[40:43], a[32:35], v[176:179]
ds_read_b128 v[36:39], v6 offset:35840
v_mul_f32 v92, v212, v92
v_mfma_f32_16x16x32_bf16 v[184:187], v[40:43], a[36:39], v[184:187]
v_exp_f32 v215, v215
v_rcp_f32 v213, v213
v_mfma_f32_16x16x32_bf16 v[180:183], v[44:47], a[32:35], v[180:183]
ds_read_b128 v[40:43], v6 offset:36864
v_cvt_pk_bf16_f32 v245, v90, v91
v_mfma_f32_16x16x32_bf16 v[188:191], v[44:47], a[36:39], v[188:191]
v_rcp_f32 v214, v214
v_mfma_f32_16x16x32_bf16 v[144:147], v[16:19], a[40:43], v[144:147]
ds_read_b128 v[44:47], v6 offset:37888
v_fma_f32 v215, v215, v77, v77
v_mfma_f32_16x16x32_bf16 v[152:155], v[16:19], a[44:47], v[152:155]
v_mul_f32 v93, v213, v93
v_rcp_f32 v215, v215
s_waitcnt lgkmcnt(3)
v_mfma_f32_16x16x32_bf16 v[148:151], v[20:23], a[40:43], v[148:151]
s_barrier
ds_read_b128 v[16:19], v6 offset:38912
v_mfma_f32_16x16x32_bf16 v[156:159], v[20:23], a[44:47], v[156:159]
s_add_u32 m0, s43, 16384
v_add_u32 v4, 16384, v4
v_mul_f32 v94, v214, v94
v_cvt_pk_bf16_f32 v246, v92, v93
v_mul_f32 v95, v215, v95
v_mfma_f32_16x16x32_bf16 v[160:163], v[24:27], a[40:43], v[160:163]
ds_read_b128 v[20:23], v6 offset:39936
global_load_lds_dwordx4 v4, s[20:21] offset:0 sc1
v_mfma_f32_16x16x32_bf16 v[168:171], v[24:27], a[44:47], v[168:171]
global_load_lds_dwordx4 v4, s[20:21] offset:1024 sc1
global_load_lds_dwordx4 v4, s[20:21] offset:2048 sc1
v_cvt_pk_bf16_f32 v247, v94, v95
s_add_u32 s38, s47, 39845888
v_mfma_f32_16x16x32_bf16 v[164:167], v[28:31], a[40:43], v[164:167]
ds_read_b128 v[24:27], v6 offset:40960
global_load_lds_dwordx4 v4, s[20:21] offset:3072 sc1
buffer_store_dwordx4 v[240:243], v0, s[20:23], s38 offen offset:0 sc1
buffer_store_dwordx4 v[244:247], v0, s[20:23], s38 offen offset:1024 sc1
v_mfma_f32_16x16x32_bf16 v[172:175], v[28:31], a[44:47], v[172:175]
s_mov_b32 s58, 0
v_lshlrev_b32 v80, 16, v56
v_and_b32 v81, 0xffff0000, v56
v_mfma_f32_16x16x32_bf16 v[176:179], v[32:35], a[40:43], v[176:179]
ds_read_b128 v[28:31], v6 offset:41984
v_add_f32 v80, v80, v232
v_mfma_f32_16x16x32_bf16 v[184:187], v[32:35], a[44:47], v[184:187]
v_add_f32 v81, v81, v233
v_lshlrev_b32 v82, 16, v57
s_waitcnt lgkmcnt(3)
v_mfma_f32_16x16x32_bf16 v[180:183], v[36:39], a[40:43], v[180:183]
ds_read_b128 v[32:35], v6 offset:43008
v_and_b32 v83, 0xffff0000, v57
v_mfma_f32_16x16x32_bf16 v[188:191], v[36:39], a[44:47], v[188:191]
v_add_f32 v82, v82, v234
v_add_f32 v83, v83, v235
v_lshlrev_b32 v84, 16, v58
v_mfma_f32_16x16x32_bf16 v[144:147], v[40:43], a[48:51], v[144:147]
ds_read_b128 v[36:39], v6 offset:44032
v_and_b32 v85, 0xffff0000, v58
v_mfma_f32_16x16x32_bf16 v[152:155], v[40:43], a[52:55], v[152:155]
v_add_f32 v84, v84, v236
v_add_f32 v85, v85, v237
v_mfma_f32_16x16x32_bf16 v[148:151], v[44:47], a[48:51], v[148:151]
ds_read_b128 v[40:43], v6 offset:45056
v_lshlrev_b32 v86, 16, v59
v_mfma_f32_16x16x32_bf16 v[156:159], v[44:47], a[52:55], v[156:159]
v_and_b32 v87, 0xffff0000, v59
v_add_f32 v86, v86, v238
v_mfma_f32_16x16x32_bf16 v[160:163], v[16:19], a[48:51], v[160:163]
ds_read_b128 v[44:47], v6 offset:46080
v_add_f32 v87, v87, v239
v_mfma_f32_16x16x32_bf16 v[168:171], v[16:19], a[52:55], v[168:171]
v_lshlrev_b32 v88, 16, v60
v_and_b32 v89, 0xffff0000, v60
v_add_f32 v88, v88, v232
s_waitcnt vmcnt(26) lgkmcnt(3)
v_mfma_f32_16x16x32_bf16 v[164:167], v[20:23], a[48:51], v[164:167]
ds_read_b128 v[16:19], v6 offset:47104
v_add_f32 v89, v89, v233
v_mfma_f32_16x16x32_bf16 v[172:175], v[20:23], a[52:55], v[172:175]
v_lshlrev_b32 v90, 16, v61
v_and_b32 v91, 0xffff0000, v61
v_mfma_f32_16x16x32_bf16 v[176:179], v[24:27], a[48:51], v[176:179]
ds_read_b128 v[20:23], v6 offset:48128
v_add_f32 v90, v90, v234
v_mfma_f32_16x16x32_bf16 v[184:187], v[24:27], a[52:55], v[184:187]
v_add_f32 v91, v91, v235
v_lshlrev_b32 v92, 16, v62
v_and_b32 v93, 0xffff0000, v62
v_mfma_f32_16x16x32_bf16 v[180:183], v[28:31], a[48:51], v[180:183]
s_barrier
ds_read_b128 v[24:27], v6 offset:49152
v_mfma_f32_16x16x32_bf16 v[188:191], v[28:31], a[52:55], v[188:191]
v_add_f32 v92, v92, v236
v_add_f32 v93, v93, v237
v_lshlrev_b32 v94, 16, v63
v_mfma_f32_16x16x32_bf16 v[144:147], v[32:35], a[56:59], v[144:147]
ds_read_b128 v[28:31], v6 offset:50176
v_and_b32 v95, 0xffff0000, v63
v_mfma_f32_16x16x32_bf16 v[152:155], v[32:35], a[60:63], v[152:155]
v_add_f32 v94, v94, v238
v_add_f32 v95, v95, v239
s_waitcnt lgkmcnt(3)
v_mfma_f32_16x16x32_bf16 v[148:151], v[36:39], a[56:59], v[148:151]
ds_read_b128 v[32:35], v6 offset:51200
v_mul_f32 v208, v96, v96
v_mfma_f32_16x16x32_bf16 v[156:159], v[36:39], a[60:63], v[156:159]
v_mul_f32 v209, v97, v97
v_fma_f32 v208, v208, v73, v72
v_mul_f32 v210, v98, v98
v_mfma_f32_16x16x32_bf16 v[160:163], v[40:43], a[56:59], v[160:163]
ds_read_b128 v[36:39], v6 offset:52224
v_fma_f32 v209, v209, v73, v72
v_mfma_f32_16x16x32_bf16 v[168:171], v[40:43], a[60:63], v[168:171]
v_mul_f32 v208, v208, v96
v_mul_f32 v211, v99, v99
v_mfma_f32_16x16x32_bf16 v[164:167], v[44:47], a[56:59], v[164:167]
ds_read_b128 v[40:43], v6 offset:53248
v_fma_f32 v210, v210, v73, v72
v_mfma_f32_16x16x32_bf16 v[172:175], v[44:47], a[60:63], v[172:175]
v_exp_f32 v208, v208
v_mul_f32 v209, v209, v97
v_mfma_f32_16x16x32_bf16 v[176:179], v[16:19], a[56:59], v[176:179]
ds_read_b128 v[44:47], v6 offset:54272
v_mul_f32 v212, v100, v100
v_mfma_f32_16x16x32_bf16 v[184:187], v[16:19], a[60:63], v[184:187]
v_fma_f32 v211, v211, v73, v72
v_mul_f32 v210, v210, v98
s_waitcnt lgkmcnt(3)
v_mfma_f32_16x16x32_bf16 v[180:183], v[20:23], a[56:59], v[180:183]
s_barrier
ds_read_b128 v[16:19], v6 offset:55296
v_mfma_f32_16x16x32_bf16 v[188:191], v[20:23], a[60:63], v[188:191]
s_add_u32 m0, s43, 32768
v_add_u32 v4, 16384, v4
v_exp_f32 v209, v209
v_fma_f32 v208, v208, v74, v74
v_mfma_f32_16x16x32_bf16 v[144:147], v[24:27], a[64:67], v[144:147]
ds_read_b128 v[20:23], v6 offset:56320
global_load_lds_dwordx4 v4, s[20:21] offset:0 sc1
v_mfma_f32_16x16x32_bf16 v[152:155], v[24:27], a[68:71], v[152:155]
global_load_lds_dwordx4 v4, s[20:21] offset:1024 sc1
global_load_lds_dwordx4 v4, s[20:21] offset:2048 sc1
v_mul_f32 v213, v101, v101
v_fma_f32 v212, v212, v73, v72
v_mul_f32 v211, v211, v99
v_mfma_f32_16x16x32_bf16 v[148:151], v[28:31], a[64:67], v[148:151]
ds_read_b128 v[24:27], v6 offset:57344
global_load_lds_dwordx4 v4, s[20:21] offset:3072 sc1
v_mfma_f32_16x16x32_bf16 v[156:159], v[28:31], a[68:71], v[156:159]
v_exp_f32 v210, v210
v_fma_f32 v209, v209, v74, v74
v_mfma_f32_16x16x32_bf16 v[160:163], v[32:35], a[64:67], v[160:163]
v_rcp_f32 v208, v208
v_mfma_f32_16x16x32_bf16 v[168:171], v[32:35], a[68:71], v[168:171]
ds_read_b128 v[28:31], v6 offset:58368
v_mul_f32 v214, v102, v102
v_fma_f32 v213, v213, v73, v72
v_mul_f32 v212, v212, v100
s_waitcnt lgkmcnt(3)
v_mfma_f32_16x16x32_bf16 v[164:167], v[36:39], a[64:67], v[164:167]
ds_read_b128 v[32:35], v6 offset:59392
v_fma_f32 v210, v210, v74, v74
v_mfma_f32_16x16x32_bf16 v[172:175], v[36:39], a[68:71], v[172:175]
v_exp_f32 v211, v211
v_mfma_f32_16x16x32_bf16 v[176:179], v[40:43], a[64:67], v[176:179]
ds_read_b128 v[36:39], v6 offset:60416
v_mfma_f32_16x16x32_bf16 v[184:187], v[40:43], a[68:71], v[184:187]
s_waitcnt vmcnt(4)
s_atomic_add s45, s[20:21], s57 offset:128
v_mfma_f32_16x16x32_bf16 v[180:183], v[44:47], a[64:67], v[180:183]
ds_read_b128 v[40:43], v6 offset:61440
v_mul_f32 v96, v208, v96
v_mfma_f32_16x16x32_bf16 v[188:191], v[44:47], a[68:71], v[188:191]
v_rcp_f32 v209, v209
v_mul_f32 v215, v103, v103
v_fma_f32 v214, v214, v73, v72
v_mfma_f32_16x16x32_bf16 v[144:147], v[16:19], a[72:75], v[144:147]
ds_read_b128 v[44:47], v6 offset:62464
v_mul_f32 v213, v213, v101
v_mfma_f32_16x16x32_bf16 v[152:155], v[16:19], a[76:79], v[152:155]
v_fma_f32 v211, v211, v74, v74
s_waitcnt lgkmcnt(4)
v_mfma_f32_16x16x32_bf16 v[148:151], v[20:23], a[72:75], v[148:151]
ds_read_b128 v[16:19], v6 offset:63488
v_mul_f32 v97, v209, v97
v_mfma_f32_16x16x32_bf16 v[156:159], v[20:23], a[76:79], v[156:159]
v_exp_f32 v212, v212
v_rcp_f32 v210, v210
v_mfma_f32_16x16x32_bf16 v[160:163], v[24:27], a[72:75], v[160:163]
ds_read_b128 v[20:23], v6 offset:64512
v_mul_f32 v208, v104, v104
v_mfma_f32_16x16x32_bf16 v[168:171], v[24:27], a[76:79], v[168:171]
v_exp_f32 v213, v213
v_mfma_f32_16x16x32_bf16 v[164:167], v[28:31], a[72:75], v[164:167]
s_barrier
ds_read_b128 v[24:27], v7 offset:0
v_mfma_f32_16x16x32_bf16 v[172:175], v[28:31], a[76:79], v[172:175]
v_fma_f32 v215, v215, v73, v72
v_mul_f32 v214, v214, v102
v_fma_f32 v212, v212, v74, v74
s_waitcnt lgkmcnt(4)
v_mfma_f32_16x16x32_bf16 v[176:179], v[32:35], a[72:75], v[176:179]
ds_read_b128 v[28:31], v7 offset:1024
v_mul_f32 v98, v210, v98
v_mfma_f32_16x16x32_bf16 v[184:187], v[32:35], a[76:79], v[184:187]
v_rcp_f32 v211, v211
v_cvt_pk_bf16_f32 v248, v96, v97
v_mfma_f32_16x16x32_bf16 v[180:183], v[36:39], a[72:75], v[180:183]
ds_read_b128 v[32:35], v7 offset:2048
v_mul_f32 v209, v105, v105
v_mfma_f32_16x16x32_bf16 v[188:191], v[36:39], a[76:79], v[188:191]
v_exp_f32 v214, v214
v_mfma_f32_16x16x32_bf16 v[144:147], v[40:43], a[80:83], v[144:147]
ds_read_b128 v[36:39], v7 offset:3072
v_fma_f32 v208, v208, v76, v75
v_mfma_f32_16x16x32_bf16 v[152:155], v[40:43], a[84:87], v[152:155]
v_mul_f32 v215, v215, v103
v_fma_f32 v213, v213, v74, v74
s_waitcnt lgkmcnt(4)
v_mfma_f32_16x16x32_bf16 v[148:151], v[44:47], a[80:83], v[148:151]
s_barrier
ds_read_b128 v[40:43], v7 offset:4096
v_mfma_f32_16x16x32_bf16 v[156:159], v[44:47], a[84:87], v[156:159]
s_add_u32 m0, s43, 49152
v_add_u32 v4, 16384, v4
v_rcp_f32 v212, v212
v_mul_f32 v99, v211, v99
v_mul_f32 v210, v106, v106
v_mfma_f32_16x16x32_bf16 v[160:163], v[16:19], a[80:83], v[160:163]
ds_read_b128 v[44:47], v7 offset:5120
global_load_lds_dwordx4 v4, s[20:21] offset:0 sc1
v_mfma_f32_16x16x32_bf16 v[168:171], v[16:19], a[84:87], v[168:171]
global_load_lds_dwordx4 v4, s[20:21] offset:1024 sc1
global_load_lds_dwordx4 v4, s[20:21] offset:2048 sc1
v_fma_f32 v209, v209, v76, v75
v_mul_f32 v208, v208, v104
v_mfma_f32_16x16x32_bf16 v[164:167], v[20:23], a[80:83], v[164:167]
ds_read_b128 v[16:19], v7 offset:6144
global_load_lds_dwordx4 v4, s[20:21] offset:3072 sc1
v_mfma_f32_16x16x32_bf16 v[172:175], v[20:23], a[84:87], v[172:175]
v_fma_f32 v214, v214, v74, v74
v_exp_f32 v215, v215
v_rcp_f32 v213, v213
s_waitcnt lgkmcnt(4)
v_mfma_f32_16x16x32_bf16 v[176:179], v[24:27], a[80:83], v[176:179]
ds_read_b128 v[20:23], v7 offset:7168
v_mul_f32 v100, v212, v100
v_mfma_f32_16x16x32_bf16 v[184:187], v[24:27], a[84:87], v[184:187]
v_cvt_pk_bf16_f32 v249, v98, v99
v_mul_f32 v211, v107, v107
v_mfma_f32_16x16x32_bf16 v[180:183], v[28:31], a[80:83], v[180:183]
ds_read_b128 v[24:27], v7 offset:8192
v_fma_f32 v210, v210, v76, v75
v_mfma_f32_16x16x32_bf16 v[188:191], v[28:31], a[84:87], v[188:191]
v_exp_f32 v208, v208
v_mul_f32 v209, v209, v105
v_mfma_f32_16x16x32_bf16 v[144:147], v[32:35], a[88:91], v[144:147]
ds_read_b128 v[28:31], v7 offset:9216
v_fma_f32 v215, v215, v74, v74
v_mfma_f32_16x16x32_bf16 v[152:155], v[32:35], a[92:95], v[152:155]
v_mul_f32 v101, v213, v101
s_waitcnt lgkmcnt(4)
v_mfma_f32_16x16x32_bf16 v[148:151], v[36:39], a[88:91], v[148:151]
ds_read_b128 v[32:35], v7 offset:10240
v_mul_f32 v212, v108, v108
v_mfma_f32_16x16x32_bf16 v[156:159], v[36:39], a[92:95], v[156:159]
v_rcp_f32 v214, v214
v_fma_f32 v211, v211, v76, v75
v_mfma_f32_16x16x32_bf16 v[160:163], v[40:43], a[88:91], v[160:163]
ds_read_b128 v[36:39], v7 offset:11264
v_mul_f32 v210, v210, v106
v_mfma_f32_16x16x32_bf16 v[168:171], v[40:43], a[92:95], v[168:171]
v_exp_f32 v209, v209
v_fma_f32 v208, v208, v77, v77
v_mfma_f32_16x16x32_bf16 v[164:167], v[44:47], a[88:91], v[164:167]
v_rcp_f32 v215, v215
v_mfma_f32_16x16x32_bf16 v[172:175], v[44:47], a[92:95], v[172:175]
ds_read_b128 v[40:43], v7 offset:12288
v_mul_f32 v102, v214, v102
s_waitcnt lgkmcnt(4)
v_mfma_f32_16x16x32_bf16 v[176:179], v[16:19], a[88:91], v[176:179]
ds_read_b128 v[44:47], v7 offset:13312
v_cvt_pk_bf16_f32 v250, v100, v101
v_mfma_f32_16x16x32_bf16 v[184:187], v[16:19], a[92:95], v[184:187]
v_exp_f32 v210, v210
v_mul_f32 v213, v109, v109
v_mfma_f32_16x16x32_bf16 v[180:183], v[20:23], a[88:91], v[180:183]
ds_read_b128 v[16:19], v7 offset:14336
v_fma_f32 v212, v212, v76, v75
v_mfma_f32_16x16x32_bf16 v[188:191], v[20:23], a[92:95], v[188:191]
v_rcp_f32 v208, v208
v_mfma_f32_16x16x32_bf16 v[144:147], v[24:27], a[96:99], v[144:147]
ds_read_b128 v[20:23], v7 offset:15360
v_mul_f32 v211, v211, v107
v_mfma_f32_16x16x32_bf16 v[152:155], v[24:27], a[100:103], v[152:155]
v_fma_f32 v209, v209, v77, v77
v_mul_f32 v103, v215, v103
s_waitcnt lgkmcnt(4)
v_mfma_f32_16x16x32_bf16 v[148:151], v[28:31], a[96:99], v[148:151]
s_barrier
ds_read_b128 v[24:27], v7 offset:16384
v_mfma_f32_16x16x32_bf16 v[156:159], v[28:31], a[100:103], v[156:159]
v_exp_f32 v211, v211
v_mul_f32 v214, v110, v110
v_fma_f32 v213, v213, v76, v75
v_mfma_f32_16x16x32_bf16 v[160:163], v[32:35], a[96:99], v[160:163]
ds_read_b128 v[28:31], v7 offset:17408
v_mfma_f32_16x16x32_bf16 v[168:171], v[32:35], a[100:103], v[168:171]
s_atomic_add s58, s[20:21], s57 offset:128 glc
v_mul_f32 v212, v212, v108
v_mfma_f32_16x16x32_bf16 v[164:167], v[36:39], a[96:99], v[164:167]
ds_read_b128 v[32:35], v7 offset:18432
v_fma_f32 v210, v210, v77, v77
v_mfma_f32_16x16x32_bf16 v[172:175], v[36:39], a[100:103], v[172:175]
v_mul_f32 v104, v208, v104
v_rcp_f32 v209, v209
s_waitcnt lgkmcnt(4)
v_mfma_f32_16x16x32_bf16 v[176:179], v[40:43], a[96:99], v[176:179]
ds_read_b128 v[36:39], v7 offset:19456
v_cvt_pk_bf16_f32 v251, v102, v103
v_mfma_f32_16x16x32_bf16 v[184:187], v[40:43], a[100:103], v[184:187]
v_exp_f32 v212, v212
v_mfma_f32_16x16x32_bf16 v[180:183], v[44:47], a[96:99], v[180:183]
ds_read_b128 v[40:43], v7 offset:20480
v_mul_f32 v215, v111, v111
v_mfma_f32_16x16x32_bf16 v[188:191], v[44:47], a[100:103], v[188:191]
v_rcp_f32 v210, v210
v_mfma_f32_16x16x32_bf16 v[144:147], v[16:19], a[104:107], v[144:147]
ds_read_b128 v[44:47], v7 offset:21504
v_fma_f32 v214, v214, v76, v75
v_mfma_f32_16x16x32_bf16 v[152:155], v[16:19], a[108:111], v[152:155]
v_mul_f32 v213, v213, v109
v_fma_f32 v211, v211, v77, v77
v_mul_f32 v105, v209, v105
s_waitcnt lgkmcnt(4)
v_mfma_f32_16x16x32_bf16 v[148:151], v[20:23], a[104:107], v[148:151]
s_barrier
ds_read_b128 v[16:19], v7 offset:22528
v_mfma_f32_16x16x32_bf16 v[156:159], v[20:23], a[108:111], v[156:159]
s_add_u32 m0, s43, 65536
v_add_u32 v4, 16384, v4
v_fma_f32 v215, v215, v76, v75
v_mul_f32 v214, v214, v110
v_mfma_f32_16x16x32_bf16 v[160:163], v[24:27], a[104:107], v[160:163]
ds_read_b128 v[20:23], v7 offset:23552
global_load_lds_dwordx4 v4, s[20:21] offset:0 sc1
v_mfma_f32_16x16x32_bf16 v[168:171], v[24:27], a[108:111], v[168:171]
global_load_lds_dwordx4 v4, s[20:21] offset:1024 sc1
global_load_lds_dwordx4 v4, s[20:21] offset:2048 sc1
v_exp_f32 v213, v213
v_fma_f32 v212, v212, v77, v77
v_rcp_f32 v211, v211
v_mfma_f32_16x16x32_bf16 v[164:167], v[28:31], a[104:107], v[164:167]
ds_read_b128 v[24:27], v7 offset:24576
global_load_lds_dwordx4 v4, s[20:21] offset:3072 sc1
v_mfma_f32_16x16x32_bf16 v[172:175], v[28:31], a[108:111], v[172:175]
v_mul_f32 v106, v210, v106
v_cvt_pk_bf16_f32 v252, v104, v105
v_mul_f32 v215, v215, v111
s_waitcnt lgkmcnt(4)
v_mfma_f32_16x16x32_bf16 v[176:179], v[32:35], a[104:107], v[176:179]
ds_read_b128 v[28:31], v7 offset:25600
v_fma_f32 v213, v213, v77, v77
v_mfma_f32_16x16x32_bf16 v[184:187], v[32:35], a[108:111], v[184:187]
v_exp_f32 v214, v214
v_mfma_f32_16x16x32_bf16 v[180:183], v[36:39], a[104:107], v[180:183]
ds_read_b128 v[32:35], v7 offset:26624
v_mul_f32 v107, v211, v107
v_mfma_f32_16x16x32_bf16 v[188:191], v[36:39], a[108:111], v[188:191]
v_rcp_f32 v212, v212
v_mfma_f32_16x16x32_bf16 v[144:147], v[40:43], a[112:115], v[144:147]
v_exp_f32 v215, v215
v_mfma_f32_16x16x32_bf16 v[152:155], v[40:43], a[116:119], v[152:155]
ds_read_b128 v[36:39], v7 offset:27648
v_fma_f32 v214, v214, v77, v77
s_waitcnt lgkmcnt(4)
v_mfma_f32_16x16x32_bf16 v[148:151], v[44:47], a[112:115], v[148:151]
ds_read_b128 v[40:43], v7 offset:28672
v_mul_f32 v108, v212, v108
v_mfma_f32_16x16x32_bf16 v[156:159], v[44:47], a[116:119], v[156:159]
v_rcp_f32 v213, v213
v_cvt_pk_bf16_f32 v253, v106, v107
v_fma_f32 v215, v215, v77, v77
v_mfma_f32_16x16x32_bf16 v[160:163], v[16:19], a[112:115], v[160:163]
ds_read_b128 v[44:47], v7 offset:29696
v_mul_f32 v109, v213, v109
v_mfma_f32_16x16x32_bf16 v[168:171], v[16:19], a[116:119], v[168:171]
v_rcp_f32 v214, v214
v_mfma_f32_16x16x32_bf16 v[164:167], v[20:23], a[112:115], v[164:167]
v_rcp_f32 v215, v215
v_mfma_f32_16x16x32_bf16 v[172:175], v[20:23], a[116:119], v[172:175]
ds_read_b128 v[16:19], v7 offset:30720
v_mul_f32 v110, v214, v110
s_waitcnt lgkmcnt(4)
v_mfma_f32_16x16x32_bf16 v[176:179], v[24:27], a[112:115], v[176:179]
ds_read_b128 v[20:23], v7 offset:31744
v_cvt_pk_bf16_f32 v254, v108, v109
v_mfma_f32_16x16x32_bf16 v[184:187], v[24:27], a[116:119], v[184:187]
v_mul_f32 v111, v215, v111
v_cvt_pk_bf16_f32 v255, v110, v111
s_add_u32 s37, s47, 39862272
v_mfma_f32_16x16x32_bf16 v[180:183], v[28:31], a[112:115], v[180:183]
s_barrier
ds_read_b128 v[24:27], v7 offset:32768
buffer_store_dwordx4 v[248:251], v0, s[20:23], s37 offen offset:0 sc1
buffer_store_dwordx4 v[252:255], v0, s[20:23], s37 offen offset:1024 sc1
v_mfma_f32_16x16x32_bf16 v[188:191], v[28:31], a[116:119], v[188:191]
s_mov_b32 s59, 0
v_mul_f32 v208, v112, v112
v_mfma_f32_16x16x32_bf16 v[144:147], v[32:35], a[120:123], v[144:147]
ds_read_b128 v[28:31], v7 offset:33792
v_mul_f32 v209, v113, v113
v_mfma_f32_16x16x32_bf16 v[152:155], v[32:35], a[124:127], v[152:155]
v_fma_f32 v208, v208, v73, v72
v_mul_f32 v210, v114, v114
s_waitcnt lgkmcnt(4)
v_mfma_f32_16x16x32_bf16 v[148:151], v[36:39], a[120:123], v[148:151]
ds_read_b128 v[32:35], v7 offset:34816
v_fma_f32 v209, v209, v73, v72
v_mfma_f32_16x16x32_bf16 v[156:159], v[36:39], a[124:127], v[156:159]
v_mul_f32 v208, v208, v112
v_mul_f32 v211, v115, v115
v_mfma_f32_16x16x32_bf16 v[160:163], v[40:43], a[120:123], v[160:163]
ds_read_b128 v[36:39], v7 offset:35840
v_mfma_f32_16x16x32_bf16 v[168:171], v[40:43], a[124:127], v[168:171]
s_cmp_lt_u32 s58, 8
s_cbranch_scc0 L_back6
L_slow6:
s_waitcnt lgkmcnt(0)
s_cmp_ge_u32 s58, 8
s_cbranch_scc1 L_back6
s_mov_b32 s58, 0
s_atomic_add s58, s[20:21], s57 offset:128 glc
s_sub_u32 s46, s46, 1
s_cbranch_scc0 L_slow6
s_endpgm
L_back6:
v_fma_f32 v210, v210, v73, v72
v_mfma_f32_16x16x32_bf16 v[164:167], v[44:47], a[120:123], v[164:167]
ds_read_b128 v[40:43], v7 offset:36864
v_add_u32 v5, 39849984, v15
v_mfma_f32_16x16x32_bf16 v[172:175], v[44:47], a[124:127], v[172:175]
global_load_dwordx4 a[0:3], v5, s[20:21] offset:-4096 sc1
v_mul_f32 v209, v209, v113
v_exp_f32 v208, v208
v_mul_f32 v212, v116, v116
s_waitcnt lgkmcnt(3)
v_mfma_f32_16x16x32_bf16 v[176:179], v[16:19], a[120:123], v[176:179]
ds_read_b128 v[44:47], v7 offset:37888
global_load_dwordx4 a[4:7], v5, s[20:21] offset:-3072 sc1
v_mfma_f32_16x16x32_bf16 v[184:187], v[16:19], a[124:127], v[184:187]
global_load_dwordx4 a[8:11], v5, s[20:21] offset:-2048 sc1
global_load_dwordx4 a[12:15], v5, s[20:21] offset:-1024 sc1
v_fma_f32 v211, v211, v73, v72
v_mul_f32 v210, v210, v114
v_mfma_f32_16x16x32_bf16 v[180:183], v[20:23], a[120:123], v[180:183]
ds_read_b128 v[16:19], v7 offset:38912
global_load_dwordx4 a[16:19], v5, s[20:21] offset:0 sc1
v_mfma_f32_16x16x32_bf16 v[188:191], v[20:23], a[124:127], v[188:191]
global_load_dwordx4 a[20:23], v5, s[20:21] offset:1024 sc1
v_fma_f32 v208, v208, v74, v74
v_exp_f32 v209, v209
v_mul_f32 v213, v117, v117
v_fma_f32 v212, v212, v73, v72
v_mfma_f32_16x16x32_bf16 v[144:147], v[24:27], a[128:131], v[144:147]
ds_read_b128 v[20:23], v7 offset:39936
v_mul_f32 v211, v211, v115
v_mfma_f32_16x16x32_bf16 v[152:155], v[24:27], a[132:135], v[152:155]
v_exp_f32 v210, v210
v_mfma_f32_16x16x32_bf16 v[148:151], v[28:31], a[128:131], v[148:151]
ds_read_b128 v[24:27], v7 offset:40960
global_load_dwordx4 a[24:27], v5, s[20:21] offset:2048 sc1
v_mfma_f32_16x16x32_bf16 v[156:159], v[28:31], a[132:135], v[156:159]
v_fma_f32 v209, v209, v74, v74
v_rcp_f32 v208, v208
s_waitcnt lgkmcnt(3)
v_mfma_f32_16x16x32_bf16 v[160:163], v[32:35], a[128:131], v[160:163]
ds_read_b128 v[28:31], v7 offset:41984
v_mul_f32 v214, v118, v118
v_mfma_f32_16x16x32_bf16 v[168:171], v[32:35], a[132:135], v[168:171]
v_exp_f32 v211, v211
v_fma_f32 v213, v213, v73, v72
v_mfma_f32_16x16x32_bf16 v[164:167], v[36:39], a[128:131], v[164:167]
ds_read_b128 v[32:35], v7 offset:43008
global_load_dwordx4 a[28:31], v5, s[20:21] offset:3072 sc1
v_mfma_f32_16x16x32_bf16 v[172:175], v[36:39], a[132:135], v[172:175]
v_rcp_f32 v209, v209
v_mul_f32 v212, v212, v116
v_mfma_f32_16x16x32_bf16 v[176:179], v[40:43], a[128:131], v[176:179]
ds_read_b128 v[36:39], v7 offset:44032
v_fma_f32 v210, v210, v74, v74
v_mfma_f32_16x16x32_bf16 v[184:187], v[40:43], a[132:135], v[184:187]
v_mul_f32 v112, v208, v112
v_mul_f32 v215, v119, v119
v_fma_f32 v214, v214, v73, v72
v_mfma_f32_16x16x32_bf16 v[180:183], v[44:47], a[128:131], v[180:183]
ds_read_b128 v[40:43], v7 offset:45056
v_add_u32 v5, 8192, v5
v_mfma_f32_16x16x32_bf16 v[188:191], v[44:47], a[132:135], v[188:191]
global_load_dwordx4 a[32:35], v5, s[20:21] offset:-4096 sc1
v_mul_f32 v213, v213, v117
v_exp_f32 v212, v212
s_waitcnt lgkmcnt(3)
v_mfma_f32_16x16x32_bf16 v[144:147], v[16:19], a[136:139], v[144:147]
ds_read_b128 v[44:47], v7 offset:46080
v_fma_f32 v211, v211, v74, v74
v_mfma_f32_16x16x32_bf16 v[152:155], v[16:19], a[140:143], v[152:155]
v_rcp_f32 v210, v210
v_mfma_f32_16x16x32_bf16 v[148:151], v[20:23], a[136:139], v[148:151]
ds_read_b128 v[16:19], v7 offset:47104
global_load_dwordx4 a[36:39], v5, s[20:21] offset:-3072 sc1
v_mfma_f32_16x16x32_bf16 v[156:159], v[20:23], a[140:143], v[156:159]
v_mul_f32 v113, v209, v113
v_mul_f32 v208, v120, v120
v_fma_f32 v215, v215, v73, v72
v_mul_f32 v214, v214, v118
v_mfma_f32_16x16x32_bf16 v[160:163], v[24:27], a[136:139], v[160:163]
ds_read_b128 v[20:23], v7 offset:48128
v_fma_f32 v212, v212, v74, v74
v_mfma_f32_16x16x32_bf16 v[168:171], v[24:27], a[140:143], v[168:171]
v_exp_f32 v213, v213
v_mfma_f32_16x16x32_bf16 v[164:167], v[28:31], a[136:139], v[164:167]
s_barrier
ds_read_b128 v[24:27], v7 offset:49152
v_mfma_f32_16x16x32_bf16 v[172:175], v[28:31], a[140:143], v[172:175]
global_load_dwordx4 a[40:43], v5, s[20:21] offset:-2048 sc1
v_rcp_f32 v211, v211
v_mul_f32 v114, v210, v114
v_cvt_pk_bf16_f32 v240, v112, v113
s_waitcnt lgkmcnt(3)
v_mfma_f32_16x16x32_bf16 v[176:179], v[32:35], a[136:139], v[176:179]
ds_read_b128 v[28:31], v7 offset:50176
s_add_u32 m0, s43, 81920
v_mfma_f32_16x16x32_bf16 v[184:187], v[32:35], a[140:143], v[184:187]
v_add_u32 v4, 16384, v4
v_mul_f32 v209, v121, v121
v_fma_f32 v208, v208, v76, v75
v_mul_f32 v215, v215, v119
v_mfma_f32_16x16x32_bf16 v[180:183], v[36:39], a[136:139], v[180:183]
ds_read_b128 v[32:35], v7 offset:51200
global_load_lds_dwordx4 v4, s[20:21] offset:0 sc1
v_mfma_f32_16x16x32_bf16 v[188:191], v[36:39], a[140:143], v[188:191]
v_exp_f32 v214, v214
v_fma_f32 v213, v213, v74, v74
v_mfma_f32_16x16x32_bf16 v[144:147], v[40:43], a[144:147], v[144:147]
ds_read_b128 v[36:39], v7 offset:52224
global_load_lds_dwordx4 v4, s[20:21] offset:1024 sc1
v_mfma_f32_16x16x32_bf16 v[152:155], v[40:43], a[148:151], v[152:155]
s_waitcnt vmcnt(13)
s_atomic_add s45, s[20:21], s57 offset:136
v_rcp_f32 v212, v212
v_mfma_f32_16x16x32_bf16 v[148:151], v[44:47], a[144:147], v[148:151]
ds_read_b128 v[40:43], v7 offset:53248
v_mul_f32 v115, v211, v115
v_mfma_f32_16x16x32_bf16 v[156:159], v[44:47], a[148:151], v[156:159]
v_mul_f32 v210, v122, v122
v_fma_f32 v209, v209, v76, v75
s_waitcnt lgkmcnt(4)
v_mfma_f32_16x16x32_bf16 v[160:163], v[16:19], a[144:147], v[160:163]
ds_read_b128 v[44:47], v7 offset:54272
global_load_lds_dwordx4 v4, s[20:21] offset:2048 sc1
v_mfma_f32_16x16x32_bf16 v[168:171], v[16:19], a[148:151], v[168:171]
v_exp_f32 v215, v215
v_mul_f32 v208, v208, v120
v_fma_f32 v214, v214, v74, v74
v_mfma_f32_16x16x32_bf16 v[164:167], v[20:23], a[144:147], v[164:167]
ds_read_b128 v[16:19], v7 offset:55296
v_mul_f32 v116, v212, v116
v_mfma_f32_16x16x32_bf16 v[172:175], v[20:23], a[148:151], v[172:175]
v_rcp_f32 v213, v213
v_mfma_f32_16x16x32_bf16 v[176:179], v[24:27], a[144:147], v[176:179]
ds_read_b128 v[20:23], v7 offset:56320
global_load_lds_dwordx4 v4, s[20:21] offset:3072 sc1
v_mfma_f32_16x16x32_bf16 v[184:187], v[24:27], a[148:151], v[184:187]
v_cvt_pk_bf16_f32 v241, v114, v115
v_mul_f32 v211, v123, v123
v_fma_f32 v210, v210, v76, v75
s_waitcnt lgkmcnt(4)
v_mfma_f32_16x16x32_bf16 v[180:183], v[28:31], a[144:147], v[180:183]
ds_read_b128 v[24:27], v7 offset:57344
v_mul_f32 v209, v209, v121
v_mfma_f32_16x16x32_bf16 v[188:191], v[28:31], a[148:151], v[188:191]
v_exp_f32 v208, v208
v_fma_f32 v215, v215, v74, v74
v_mfma_f32_16x16x32_bf16 v[144:147], v[32:35], a[152:155], v[144:147]
ds_read_b128 v[28:31], v7 offset:58368
global_load_dwordx4 a[44:47], v5, s[20:21] offset:-1024 sc1
v_mfma_f32_16x16x32_bf16 v[152:155], v[32:35], a[156:159], v[152:155]
v_rcp_f32 v214, v214
v_mul_f32 v117, v213, v117
v_mfma_f32_16x16x32_bf16 v[148:151], v[36:39], a[152:155], v[148:151]
ds_read_b128 v[32:35], v7 offset:59392
v_mul_f32 v212, v124, v124
v_mfma_f32_16x16x32_bf16 v[156:159], v[36:39], a[156:159], v[156:159]
v_fma_f32 v211, v211, v76, v75
v_mul_f32 v210, v210, v122
s_waitcnt lgkmcnt(4)
v_mfma_f32_16x16x32_bf16 v[160:163], v[40:43], a[152:155], v[160:163]
ds_read_b128 v[36:39], v7 offset:60416
global_load_dwordx4 a[48:51], v5, s[20:21] offset:0 sc1
v_mfma_f32_16x16x32_bf16 v[168:171], v[40:43], a[156:159], v[168:171]
v_exp_f32 v209, v209
v_fma_f32 v208, v208, v77, v77
v_mfma_f32_16x16x32_bf16 v[164:167], v[44:47], a[152:155], v[164:167]
ds_read_b128 v[40:43], v7 offset:61440
v_mul_f32 v118, v214, v118
v_mfma_f32_16x16x32_bf16 v[172:175], v[44:47], a[156:159], v[172:175]
v_rcp_f32 v215, v215
v_cvt_pk_bf16_f32 v242, v116, v117
v_mfma_f32_16x16x32_bf16 v[176:179], v[16:19], a[152:155], v[176:179]
ds_read_b128 v[44:47], v7 offset:62464
global_load_dwordx4 a[52:55], v5, s[20:21] offset:1024 sc1
v_mfma_f32_16x16x32_bf16 v[184:187], v[16:19], a[156:159], v[184:187]
v_mul_f32 v213, v125, v125
v_fma_f32 v212, v212, v76, v75
v_mul_f32 v211, v211, v123
s_waitcnt lgkmcnt(4)
v_mfma_f32_16x16x32_bf16 v[180:183], v[20:23], a[152:155], v[180:183]
ds_read_b128 v[16:19], v7 offset:63488
v_fma_f32 v209, v209, v77, v77
v_mfma_f32_16x16x32_bf16 v[188:191], v[20:23], a[156:159], v[188:191]
v_exp_f32 v210, v210
v_mfma_f32_16x16x32_bf16 v[144:147], v[24:27], a[160:163], v[144:147]
ds_read_b128 v[20:23], v7 offset:64512
global_load_dwordx4 a[56:59], v5, s[20:21] offset:2048 sc1
v_mfma_f32_16x16x32_bf16 v[152:155], v[24:27], a[164:167], v[152:155]
v_rcp_f32 v208, v208
v_mul_f32 v119, v215, v119
v_mul_f32 v214, v126, v126
v_fma_f32 v213, v213, v76, v75
v_mfma_f32_16x16x32_bf16 v[148:151], v[28:31], a[160:163], v[148:151]
s_barrier
ds_read_b128 v[24:27], v6 offset:0
v_mfma_f32_16x16x32_bf16 v[156:159], v[28:31], a[164:167], v[156:159]
v_mul_f32 v212, v212, v124
v_exp_f32 v211, v211
s_waitcnt lgkmcnt(4)
v_mfma_f32_16x16x32_bf16 v[160:163], v[32:35], a[160:163], v[160:163]
ds_read_b128 v[28:31], v6 offset:1024
s_add_u32 m0, s43, 98304
v_mfma_f32_16x16x32_bf16 v[168:171], v[32:35], a[164:167], v[168:171]
v_add_u32 v4, 16384, v4
v_fma_f32 v210, v210, v77, v77
v_rcp_f32 v209, v209
v_mfma_f32_16x16x32_bf16 v[164:167], v[36:39], a[160:163], v[164:167]
ds_read_b128 v[32:35], v6 offset:2048
global_load_lds_dwordx4 v4, s[20:21] offset:0 sc1
v_mfma_f32_16x16x32_bf16 v[172:175], v[36:39], a[164:167], v[172:175]
v_mul_f32 v120, v208, v120
v_cvt_pk_bf16_f32 v243, v118, v119
v_mul_f32 v215, v127, v127
v_fma_f32 v214, v214, v76, v75
v_mfma_f32_16x16x32_bf16 v[176:179], v[40:43], a[160:163], v[176:179]
ds_read_b128 v[36:39], v6 offset:3072
global_load_lds_dwordx4 v4, s[20:21] offset:1024 sc1
v_mfma_f32_16x16x32_bf16 v[184:187], v[40:43], a[164:167], v[184:187]
v_mul_f32 v213, v213, v125
v_exp_f32 v212, v212
s_waitcnt lgkmcnt(4)
v_mfma_f32_16x16x32_bf16 v[180:183], v[44:47], a[160:163], v[180:183]
ds_read_b128 v[40:43], v6 offset:4096
global_load_lds_dwordx4 v4, s[20:21] offset:2048 sc1
v_mfma_f32_16x16x32_bf16 v[188:191], v[44:47], a[164:167], v[188:191]
v_rcp_f32 v210, v210
v_fma_f32 v211, v211, v77, v77
v_mul_f32 v121, v209, v121
v_mfma_f32_16x16x32_bf16 v[144:147], v[16:19], a[168:171], v[144:147]
ds_read_b128 v[44:47], v6 offset:5120
v_fma_f32 v215, v215, v76, v75
v_mfma_f32_16x16x32_bf16 v[152:155], v[16:19], a[172:175], v[152:155]
v_exp_f32 v213, v213
v_mfma_f32_16x16x32_bf16 v[148:151], v[20:23], a[168:171], v[148:151]
ds_read_b128 v[16:19], v6 offset:6144
global_load_lds_dwordx4 v4, s[20:21] offset:3072 sc1
v_mfma_f32_16x16x32_bf16 v[156:159], v[20:23], a[172:175], v[156:159]
v_mul_f32 v214, v214, v126
v_fma_f32 v212, v212, v77, v77
s_waitcnt lgkmcnt(4)
v_mfma_f32_16x16x32_bf16 v[160:163], v[24:27], a[168:171], v[160:163]
ds_read_b128 v[20:23], v6 offset:7168
v_mul_f32 v122, v210, v122
v_mfma_f32_16x16x32_bf16 v[168:171], v[24:27], a[172:175], v[168:171]
v_rcp_f32 v211, v211
v_cvt_pk_bf16_f32 v244, v120, v121
v_mul_f32 v215, v215, v127
v_mfma_f32_16x16x32_bf16 v[164:167], v[28:31], a[168:171], v[164:167]
ds_read_b128 v[24:27], v6 offset:8192
global_load_dwordx4 a[60:63], v5, s[20:21] offset:3072 sc1
v_mfma_f32_16x16x32_bf16 v[172:175], v[28:31], a[172:175], v[172:175]
v_exp_f32 v214, v214
v_fma_f32 v213, v213, v77, v77
v_mfma_f32_16x16x32_bf16 v[176:179], v[32:35], a[168:171], v[176:179]
s_atomic_add s59, s[20:21], s57 offset:136 glc
v_mul_f32 v123, v211, v123
v_mfma_f32_16x16x32_bf16 v[184:187], v[32:35], a[172:175], v[184:187]
ds_read_b128 v[28:31], v6 offset:9216
s_waitcnt lgkmcnt(4)
v_mfma_f32_16x16x32_bf16 v[180:183], v[36:39], a[168:171], v[180:183]
ds_read_b128 v[32:35], v6 offset:10240
v_fma_f32 v214, v214, v77, v77
v_mfma_f32_16x16x32_bf16 v[188:191], v[36:39], a[172:175], v[188:191]
v_rcp_f32 v212, v212
v_mfma_f32_16x16x32_bf16 v[144:147], v[40:43], a[176:179], v[144:147]
ds_read_b128 v[36:39], v6 offset:11264
v_mul_f32 v124, v212, v124
v_mfma_f32_16x16x32_bf16 v[152:155], v[40:43], a[180:183], v[152:155]
v_exp_f32 v215, v215
v_mfma_f32_16x16x32_bf16 v[148:151], v[44:47], a[176:179], v[148:151]
v_rcp_f32 v213, v213
v_mfma_f32_16x16x32_bf16 v[156:159], v[44:47], a[180:183], v[156:159]
ds_read_b128 v[40:43], v6 offset:12288
v_cvt_pk_bf16_f32 v245, v122, v123
v_fma_f32 v215, v215, v77, v77
s_waitcnt lgkmcnt(4)
v_mfma_f32_16x16x32_bf16 v[160:163], v[16:19], a[176:179], v[160:163]
ds_read_b128 v[44:47], v6 offset:13312
v_mul_f32 v125, v213, v125
v_mfma_f32_16x16x32_bf16 v[168:171], v[16:19], a[180:183], v[168:171]
v_rcp_f32 v214, v214
v_mfma_f32_16x16x32_bf16 v[164:167], v[20:23], a[176:179], v[164:167]
ds_read_b128 v[16:19], v6 offset:14336
v_mul_f32 v126, v214, v126
v_mfma_f32_16x16x32_bf16 v[172:175], v[20:23], a[180:183], v[172:175]
v_rcp_f32 v215, v215
v_cvt_pk_bf16_f32 v246, v124, v125
v_mul_f32 v127, v215, v127
v_mfma_f32_16x16x32_bf16 v[176:179], v[24:27], a[176:179], v[176:179]
ds_read_b128 v[20:23], v6 offset:15360
v_cvt_pk_bf16_f32 v247, v126, v127
v_mfma_f32_16x16x32_bf16 v[184:187], v[24:27], a[180:183], v[184:187]
s_add_u32 s38, s47, 39878656
s_waitcnt lgkmcnt(4)
v_mfma_f32_16x16x32_bf16 v[180:183], v[28:31], a[176:179], v[180:183]
s_barrier
ds_read_b128 v[24:27], v6 offset:16384
buffer_store_dwordx4 v[240:243], v0, s[20:23], s38 offen offset:0 sc1
buffer_store_dwordx4 v[244:247], v0, s[20:23], s38 offen offset:1024 sc1
v_mfma_f32_16x16x32_bf16 v[188:191], v[28:31], a[180:183], v[188:191]
s_add_u32 m0, s43, 114688
v_add_u32 v4, 16384, v4
s_mov_b32 s58, 0
v_mul_f32 v208, v128, v128
v_mfma_f32_16x16x32_bf16 v[144:147], v[32:35], a[184:187], v[144:147]
ds_read_b128 v[28:31], v6 offset:17408
global_load_lds_dwordx4 v4, s[20:21] offset:0 sc1
v_mfma_f32_16x16x32_bf16 v[152:155], v[32:35], a[188:191], v[152:155]
v_mul_f32 v209, v129, v129
v_fma_f32 v208, v208, v73, v72
v_mul_f32 v210, v130, v130
v_fma_f32 v209, v209, v73, v72
v_mfma_f32_16x16x32_bf16 v[148:151], v[36:39], a[184:187], v[148:151]
ds_read_b128 v[32:35], v6 offset:18432
v_mul_f32 v208, v208, v128
v_mfma_f32_16x16x32_bf16 v[156:159], v[36:39], a[188:191], v[156:159]
v_mul_f32 v211, v131, v131
v_fma_f32 v210, v210, v73, v72
s_waitcnt lgkmcnt(4)
v_mfma_f32_16x16x32_bf16 v[160:163], v[40:43], a[184:187], v[160:163]
ds_read_b128 v[36:39], v6 offset:19456
v_mul_f32 v209, v209, v129
v_mfma_f32_16x16x32_bf16 v[168:171], v[40:43], a[188:191], v[168:171]
v_exp_f32 v208, v208
v_mul_f32 v212, v132, v132
v_mfma_f32_16x16x32_bf16 v[164:167], v[44:47], a[184:187], v[164:167]
ds_read_b128 v[40:43], v6 offset:20480
global_load_lds_dwordx4 v4, s[20:21] offset:1024 sc1
v_mfma_f32_16x16x32_bf16 v[172:175], v[44:47], a[188:191], v[172:175]
v_exp_f32 v209, v209
v_fma_f32 v211, v211, v73, v72
v_mfma_f32_16x16x32_bf16 v[176:179], v[16:19], a[184:187], v[176:179]
ds_read_b128 v[44:47], v6 offset:21504
v_mul_f32 v210, v210, v130
v_mfma_f32_16x16x32_bf16 v[184:187], v[16:19], a[188:191], v[184:187]
v_fma_f32 v208, v208, v74, v74
v_mul_f32 v213, v133, v133
s_waitcnt lgkmcnt(4)
v_mfma_f32_16x16x32_bf16 v[180:183], v[20:23], a[184:187], v[180:183]
ds_read_b128 v[16:19], v6 offset:22528
global_load_lds_dwordx4 v4, s[20:21] offset:2048 sc1
v_mfma_f32_16x16x32_bf16 v[188:191], v[20:23], a[188:191], v[188:191]
v_exp_f32 v210, v210
v_fma_f32 v212, v212, v73, v72
v_mul_f32 v211, v211, v131
v_mfma_f32_16x16x32_bf16 v[144:147], v[24:27], a[192:195], v[144:147]
ds_read_b128 v[20:23], v6 offset:23552
v_fma_f32 v209, v209, v74, v74
v_mfma_f32_16x16x32_bf16 v[152:155], v[24:27], a[196:199], v[152:155]
v_rcp_f32 v208, v208
v_mfma_f32_16x16x32_bf16 v[148:151], v[28:31], a[192:195], v[148:151]
ds_read_b128 v[24:27], v6 offset:24576
global_load_lds_dwordx4 v4, s[20:21] offset:3072 sc1
v_mfma_f32_16x16x32_bf16 v[156:159], v[28:31], a[196:199], v[156:159]
v_mul_f32 v214, v134, v134
v_fma_f32 v213, v213, v73, v72
v_mul_f32 v212, v212, v132
s_waitcnt lgkmcnt(4)
v_mfma_f32_16x16x32_bf16 v[160:163], v[32:35], a[192:195], v[160:163]
ds_read_b128 v[28:31], v6 offset:25600
v_fma_f32 v210, v210, v74, v74
v_mfma_f32_16x16x32_bf16 v[168:171], v[32:35], a[196:199], v[168:171]
v_exp_f32 v211, v211
v_mfma_f32_16x16x32_bf16 v[164:167], v[36:39], a[192:195], v[164:167]
ds_read_b128 v[32:35], v6 offset:26624
v_mul_f32 v128, v208, v128
v_mfma_f32_16x16x32_bf16 v[172:175], v[36:39], a[196:199], v[172:175]
v_rcp_f32 v209, v209
v_mul_f32 v215, v135, v135
v_mfma_f32_16x16x32_bf16 v[176:179], v[40:43], a[192:195], v[176:179]
s_cmp_lt_u32 s59, 8
s_cbranch_scc0 L_back7
L_slow7:
s_waitcnt lgkmcnt(0)
s_cmp_ge_u32 s59, 8
s_cbranch_scc1 L_back7
s_mov_b32 s59, 0
s_atomic_add s59, s[20:21], s57 offset:136 glc
s_sub_u32 s46, s46, 1
s_cbranch_scc0 L_slow7
s_endpgm
L_back7:
v_mfma_f32_16x16x32_bf16 v[184:187], v[40:43], a[196:199], v[184:187]
ds_read_b128 v[36:39], v6 offset:27648
v_fma_f32 v214, v214, v73, v72
v_mul_f32 v213, v213, v133
s_waitcnt lgkmcnt(3)
v_mfma_f32_16x16x32_bf16 v[180:183], v[44:47], a[192:195], v[180:183]
ds_read_b128 v[40:43], v6 offset:28672
v_add_u32 v5, 8192, v5
v_mfma_f32_16x16x32_bf16 v[188:191], v[44:47], a[196:199], v[188:191]
global_load_dwordx4 a[64:67], v5, s[20:21] offset:-4096 sc1
global_load_dwordx4 a[68:71], v5, s[20:21] offset:-3072 sc1
v_exp_f32 v212, v212
v_fma_f32 v211, v211, v74, v74
v_mfma_f32_16x16x32_bf16 v[144:147], v[16:19], a[200:203], v[144:147]
ds_read_b128 v[44:47], v6 offset:29696
v_mul_f32 v129, v209, v129
v_mfma_f32_16x16x32_bf16 v[152:155], v[16:19], a[204:207], v[152:155]
v_rcp_f32 v210, v210
v_mul_f32 v208, v136, v136
v_mfma_f32_16x16x32_bf16 v[148:151], v[20:23], a[200:203], v[148:151]
ds_read_b128 v[16:19], v6 offset:30720
global_load_dwordx4 a[72:75], v5, s[20:21] offset:-2048 sc1
v_mfma_f32_16x16x32_bf16 v[156:159], v[20:23], a[204:207], v[156:159]
v_exp_f32 v213, v213
v_fma_f32 v215, v215, v73, v72
v_mfma_f32_16x16x32_bf16 v[160:163], v[24:27], a[200:203], v[160:163]
ds_read_b128 v[20:23], v6 offset:31744
v_mul_f32 v214, v214, v134
v_mfma_f32_16x16x32_bf16 v[168:171], v[24:27], a[204:207], v[168:171]
v_fma_f32 v212, v212, v74, v74
s_waitcnt lgkmcnt(3)
v_mfma_f32_16x16x32_bf16 v[164:167], v[28:31], a[200:203], v[164:167]
s_barrier
ds_read_b128 v[24:27], v6 offset:32768
v_mfma_f32_16x16x32_bf16 v[172:175], v[28:31], a[204:207], v[172:175]
global_load_dwordx4 a[76:79], v5, s[20:21] offset:-1024 sc1
v_mul_f32 v130, v210, v130
v_rcp_f32 v211, v211
v_cvt_pk_bf16_f32 v248, v128, v129
v_mul_f32 v209, v137, v137
v_mfma_f32_16x16x32_bf16 v[176:179], v[32:35], a[200:203], v[176:179]
ds_read_b128 v[28:31], v6 offset:33792
s_add_u32 m0, s43, 0
v_mfma_f32_16x16x32_bf16 v[184:187], v[32:35], a[204:207], v[184:187]
v_add_u32 v4, 16384, v4
v_fma_f32 v208, v208, v76, v75
v_mul_f32 v215, v215, v135
v_mfma_f32_16x16x32_bf16 v[180:183], v[36:39], a[200:203], v[180:183]
ds_read_b128 v[32:35], v6 offset:34816
global_load_lds_dwordx4 v4, s[20:21] offset:0 sc1
v_mfma_f32_16x16x32_bf16 v[188:191], v[36:39], a[204:207], v[188:191]
v_exp_f32 v214, v214
v_fma_f32 v213, v213, v74, v74
v_rcp_f32 v212, v212
v_mfma_f32_16x16x32_bf16 v[144:147], v[40:43], a[208:211], v[144:147]
ds_read_b128 v[36:39], v6 offset:35840
global_load_lds_dwordx4 v4, s[20:21] offset:1024 sc1
v_mfma_f32_16x16x32_bf16 v[152:155], v[40:43], a[212:215], v[152:155]
s_waitcnt vmcnt(10)
s_atomic_add s45, s[20:21], s57 offset:144
v_mul_f32 v131, v211, v131
s_waitcnt lgkmcnt(4)
v_mfma_f32_16x16x32_bf16 v[148:151], v[44:47], a[208:211], v[148:151]
ds_read_b128 v[40:43], v6 offset:36864
v_mul_f32 v210, v138, v138
v_mfma_f32_16x16x32_bf16 v[156:159], v[44:47], a[212:215], v[156:159]
v_exp_f32 v215, v215
v_mfma_f32_16x16x32_bf16 v[160:163], v[16:19], a[208:211], v[160:163]
ds_read_b128 v[44:47], v6 offset:37888
global_load_lds_dwordx4 v4, s[20:21] offset:2048 sc1
v_mfma_f32_16x16x32_bf16 v[168:171], v[16:19], a[212:215], v[168:171]
v_rcp_f32 v213, v213
v_fma_f32 v209, v209, v76, v75
v_mul_f32 v208, v208, v136
v_mfma_f32_16x16x32_bf16 v[164:167], v[20:23], a[208:211], v[164:167]
ds_read_b128 v[16:19], v6 offset:38912
v_fma_f32 v214, v214, v74, v74
v_mfma_f32_16x16x32_bf16 v[172:175], v[20:23], a[212:215], v[172:175]
v_mul_f32 v132, v212, v132
v_cvt_pk_bf16_f32 v249, v130, v131
s_waitcnt lgkmcnt(4)
v_mfma_f32_16x16x32_bf16 v[176:179], v[24:27], a[208:211], v[176:179]
ds_read_b128 v[20:23], v6 offset:39936
global_load_lds_dwordx4 v4, s[20:21] offset:3072 sc1
v_mfma_f32_16x16x32_bf16 v[184:187], v[24:27], a[212:215], v[184:187]
v_exp_f32 v208, v208
v_mul_f32 v211, v139, v139
v_fma_f32 v210, v210, v76, v75
v_mfma_f32_16x16x32_bf16 v[180:183], v[28:31], a[208:211], v[180:183]
ds_read_b128 v[24:27], v6 offset:40960
v_mul_f32 v209, v209, v137
v_mfma_f32_16x16x32_bf16 v[188:191], v[28:31], a[212:215], v[188:191]
v_rcp_f32 v214, v214
v_mfma_f32_16x16x32_bf16 v[144:147], v[32:35], a[216:219], v[144:147]
ds_read_b128 v[28:31], v6 offset:41984
global_load_dwordx4 a[80:83], v5, s[20:21] offset:0 sc1
v_mfma_f32_16x16x32_bf16 v[152:155], v[32:35], a[220:223], v[152:155]
v_fma_f32 v215, v215, v74, v74
v_mul_f32 v133, v213, v133
v_mul_f32 v212, v140, v140
s_waitcnt lgkmcnt(4)
v_mfma_f32_16x16x32_bf16 v[148:151], v[36:39], a[216:219], v[148:151]
ds_read_b128 v[32:35], v6 offset:43008
v_fma_f32 v211, v211, v76, v75
v_mfma_f32_16x16x32_bf16 v[156:159], v[36:39], a[220:223], v[156:159]
v_exp_f32 v209, v209
v_mul_f32 v210, v210, v138
v_mfma_f32_16x16x32_bf16 v[160:163], v[40:43], a[216:219], v[160:163]
ds_read_b128 v[36:39], v6 offset:44032
global_load_dwordx4 a[84:87], v5, s[20:21] offset:1024 sc1
v_mfma_f32_16x16x32_bf16 v[168:171], v[40:43], a[220:223], v[168:171]
v_rcp_f32 v215, v215
v_fma_f32 v208, v208, v77, v77
v_mfma_f32_16x16x32_bf16 v[164:167], v[44:47], a[216:219], v[164:167]
ds_read_b128 v[40:43], v6 offset:45056
v_mul_f32 v134, v214, v134
v_mfma_f32_16x16x32_bf16 v[172:175], v[44:47], a[220:223], v[172:175]
v_cvt_pk_bf16_f32 v250, v132, v133
v_mul_f32 v213, v141, v141
v_fma_f32 v212, v212, v76, v75
s_waitcnt lgkmcnt(4)
v_mfma_f32_16x16x32_bf16 v[176:179], v[16:19], a[216:219], v[176:179]
ds_read_b128 v[44:47], v6 offset:46080
s_getpc_b64 s[4:5]
v_mfma_f32_16x16x32_bf16 v[184:187], v[16:19], a[220:223], v[184:187]
global_load_dword v13, v12, s[4:5]
global_load_dwordx4 a[88:91], v5, s[20:21] offset:2048 sc1
v_mul_f32 v211, v211, v139
v_exp_f32 v210, v210
v_mfma_f32_16x16x32_bf16 v[180:183], v[20:23], a[216:219], v[180:183]
ds_read_b128 v[16:19], v6 offset:47104
v_fma_f32 v209, v209, v77, v77
v_mfma_f32_16x16x32_bf16 v[188:191], v[20:23], a[220:223], v[188:191]
v_rcp_f32 v208, v208
v_mfma_f32_16x16x32_bf16 v[144:147], v[24:27], a[224:227], v[144:147]
ds_read_b128 v[20:23], v6 offset:48128
global_load_dwordx4 a[92:95], v5, s[20:21] offset:3072 sc1
v_mfma_f32_16x16x32_bf16 v[152:155], v[24:27], a[228:231], v[152:155]
v_mul_f32 v135, v215, v135
v_mul_f32 v214, v142, v142
v_fma_f32 v213, v213, v76, v75
v_mul_f32 v212, v212, v140
s_waitcnt lgkmcnt(4)
v_mfma_f32_16x16x32_bf16 v[148:151], v[28:31], a[224:227], v[148:151]
s_barrier
ds_read_b128 v[24:27], v6 offset:49152
v_mfma_f32_16x16x32_bf16 v[156:159], v[28:31], a[228:231], v[156:159]
v_exp_f32 v211, v211
v_fma_f32 v210, v210, v77, v77
v_mfma_f32_16x16x32_bf16 v[160:163], v[32:35], a[224:227], v[160:163]
ds_read_b128 v[28:31], v6 offset:50176
s_add_u32 m0, s43, 16384
v_mfma_f32_16x16x32_bf16 v[168:171], v[32:35], a[228:231], v[168:171]
v_add_u32 v4, 16384, v4
v_mul_f32 v136, v208, v136
v_rcp_f32 v209, v209
v_cvt_pk_bf16_f32 v251, v134, v135
v_mfma_f32_16x16x32_bf16 v[164:167], v[36:39], a[224:227], v[164:167]
ds_read_b128 v[32:35], v6 offset:51200
global_load_lds_dwordx4 v4, s[20:21] offset:0 sc1
v_mfma_f32_16x16x32_bf16 v[172:175], v[36:39], a[228:231], v[172:175]
v_mul_f32 v215, v143, v143
v_fma_f32 v214, v214, v76, v75
v_mul_f32 v213, v213, v141
s_waitcnt lgkmcnt(4)
v_mfma_f32_16x16x32_bf16 v[176:179], v[40:43], a[224:227], v[176:179]
ds_read_b128 v[36:39], v6 offset:52224
global_load_lds_dwordx4 v4, s[20:21] offset:1024 sc1
v_mfma_f32_16x16x32_bf16 v[184:187], v[40:43], a[228:231], v[184:187]
v_exp_f32 v212, v212
v_fma_f32 v211, v211, v77, v77
v_mfma_f32_16x16x32_bf16 v[180:183], v[44:47], a[224:227], v[180:183]
ds_read_b128 v[40:43], v6 offset:53248
global_load_lds_dwordx4 v4, s[20:21] offset:2048 sc1
v_mfma_f32_16x16x32_bf16 v[188:191], v[44:47], a[228:231], v[188:191]
v_rcp_f32 v210, v210
v_mul_f32 v137, v209, v137
v_fma_f32 v215, v215, v76, v75
v_mfma_f32_16x16x32_bf16 v[144:147], v[16:19], a[232:235], v[144:147]
ds_read_b128 v[44:47], v6 offset:54272
v_mul_f32 v214, v214, v142
v_mfma_f32_16x16x32_bf16 v[152:155], v[16:19], a[236:239], v[152:155]
v_fma_f32 v212, v212, v77, v77
s_waitcnt lgkmcnt(4)
v_mfma_f32_16x16x32_bf16 v[148:151], v[20:23], a[232:235], v[148:151]
ds_read_b128 v[16:19], v6 offset:55296
global_load_lds_dwordx4 v4, s[20:21] offset:3072 sc1
v_mfma_f32_16x16x32_bf16 v[156:159], v[20:23], a[236:239], v[156:159]
v_exp_f32 v213, v213
v_rcp_f32 v211, v211
v_mul_f32 v138, v210, v138
v_mfma_f32_16x16x32_bf16 v[160:163], v[24:27], a[232:235], v[160:163]
ds_read_b128 v[20:23], v6 offset:56320
v_cvt_pk_bf16_f32 v252, v136, v137
v_mfma_f32_16x16x32_bf16 v[168:171], v[24:27], a[236:239], v[168:171]
v_exp_f32 v214, v214
v_mfma_f32_16x16x32_bf16 v[164:167], v[28:31], a[232:235], v[164:167]
ds_read_b128 v[24:27], v6 offset:57344
v_add_u32 v5, 8192, v5
v_mfma_f32_16x16x32_bf16 v[172:175], v[28:31], a[236:239], v[172:175]
global_load_dwordx4 a[96:99], v5, s[20:21] offset:-4096 sc1
s_atomic_add s58, s[20:21], s57 offset:144 glc
v_mul_f32 v215, v215, v143
s_waitcnt lgkmcnt(4)
v_mfma_f32_16x16x32_bf16 v[176:179], v[32:35], a[232:235], v[176:179]
ds_read_b128 v[28:31], v6 offset:58368
v_fma_f32 v213, v213, v77, v77
v_mfma_f32_16x16x32_bf16 v[184:187], v[32:35], a[236:239], v[184:187]
v_rcp_f32 v212, v212
v_mul_f32 v139, v211, v139
v_mfma_f32_16x16x32_bf16 v[180:183], v[36:39], a[232:235], v[180:183]
ds_read_b128 v[32:35], v6 offset:59392
global_load_dwordx4 a[100:103], v5, s[20:21] offset:-3072 sc1
v_mfma_f32_16x16x32_bf16 v[188:191], v[36:39], a[236:239], v[188:191]
v_exp_f32 v215, v215
v_fma_f32 v214, v214, v77, v77
v_mfma_f32_16x16x32_bf16 v[144:147], v[40:43], a[240:243], v[144:147]
v_rcp_f32 v213, v213
v_mfma_f32_16x16x32_bf16 v[152:155], v[40:43], a[244:247], v[152:155]
ds_read_b128 v[36:39], v6 offset:60416
v_mul_f32 v140, v212, v140
v_cvt_pk_bf16_f32 v253, v138, v139
s_waitcnt lgkmcnt(4)
v_mfma_f32_16x16x32_bf16 v[148:151], v[44:47], a[240:243], v[148:151]
ds_read_b128 v[40:43], v6 offset:61440
global_load_dwordx4 a[104:107], v5, s[20:21] offset:-2048 sc1
v_mfma_f32_16x16x32_bf16 v[156:159], v[44:47], a[244:247], v[156:159]
v_rcp_f32 v214, v214
v_fma_f32 v215, v215, v77, v77
v_mfma_f32_16x16x32_bf16 v[160:163], v[16:19], a[240:243], v[160:163]
ds_read_b128 v[44:47], v6 offset:62464
v_mul_f32 v141, v213, v141
v_mfma_f32_16x16x32_bf16 v[168:171], v[16:19], a[244:247], v[168:171]
v_rcp_f32 v215, v215
v_mfma_f32_16x16x32_bf16 v[164:167], v[20:23], a[240:243], v[164:167]
ds_read_b128 v[16:19], v6 offset:63488
global_load_dwordx4 a[108:111], v5, s[20:21] offset:-1024 sc1
v_mfma_f32_16x16x32_bf16 v[172:175], v[20:23], a[244:247], v[172:175]
v_mul_f32 v142, v214, v142
v_cvt_pk_bf16_f32 v254, v140, v141
v_mul_f32 v143, v215, v143
v_cvt_pk_bf16_f32 v255, v142, v143
s_waitcnt lgkmcnt(4)
v_mfma_f32_16x16x32_bf16 v[176:179], v[24:27], a[240:243], v[176:179]
ds_read_b128 v[20:23], v6 offset:64512
s_add_u32 s37, s47, 39895040
buffer_store_dwordx4 v[248:251], v0, s[20:23], s37 offen offset:0 sc1
buffer_store_dwordx4 v[252:255], v0, s[20:23], s37 offen offset:1024 sc1
v_mfma_f32_16x16x32_bf16 v[184:187], v[24:27], a[244:247], v[184:187]
s_mov_b32 s59, 0
v_mfma_f32_16x16x32_bf16 v[180:183], v[28:31], a[240:243], v[180:183]
s_barrier
ds_read_b128 v[24:27], v7 offset:0
v_mfma_f32_16x16x32_bf16 v[188:191], v[28:31], a[244:247], v[188:191]
v_mfma_f32_16x16x32_bf16 v[144:147], v[32:35], a[248:251], v[144:147]
ds_read_b128 v[28:31], v7 offset:1024
v_mfma_f32_16x16x32_bf16 v[152:155], v[32:35], a[252:255], v[152:155]
s_waitcnt lgkmcnt(4)
v_mfma_f32_16x16x32_bf16 v[148:151], v[36:39], a[248:251], v[148:151]
ds_read_b128 v[32:35], v7 offset:2048
v_mfma_f32_16x16x32_bf16 v[156:159], v[36:39], a[252:255], v[156:159]
v_mfma_f32_16x16x32_bf16 v[160:163], v[40:43], a[248:251], v[160:163]
ds_read_b128 v[36:39], v7 offset:3072
v_mfma_f32_16x16x32_bf16 v[168:171], v[40:43], a[252:255], v[168:171]
v_mul_f32 v208, v144, v144
v_mul_f32 v209, v145, v145
v_fma_f32 v208, v208, v73, v72
v_mul_f32 v210, v146, v146
v_fma_f32 v209, v209, v73, v72
v_mfma_f32_16x16x32_bf16 v[164:167], v[44:47], a[248:251], v[164:167]
ds_read_b128 v[40:43], v7 offset:4096
s_add_u32 m0, s43, 32768
v_mfma_f32_16x16x32_bf16 v[172:175], v[44:47], a[252:255], v[172:175]
v_add_u32 v4, 16384, v4
v_mul_f32 v208, v208, v144
v_mul_f32 v211, v147, v147
v_fma_f32 v210, v210, v73, v72
s_waitcnt lgkmcnt(4)
v_mfma_f32_16x16x32_bf16 v[176:179], v[16:19], a[248:251], v[176:179]
ds_read_b128 v[44:47], v7 offset:5120
global_load_lds_dwordx4 v4, s[20:21] offset:0 sc1
v_mfma_f32_16x16x32_bf16 v[184:187], v[16:19], a[252:255], v[184:187]
v_exp_f32 v208, v208
v_mul_f32 v209, v209, v145
v_mul_f32 v212, v148, v148
v_mfma_f32_16x16x32_bf16 v[180:183], v[20:23], a[248:251], v[180:183]
ds_read_b128 v[16:19], v7 offset:6144
global_load_lds_dwordx4 v4, s[20:21] offset:1024 sc1
v_mfma_f32_16x16x32_bf16 v[188:191], v[20:23], a[252:255], v[188:191]
s_cmp_lt_u32 s58, 8
s_cbranch_scc0 L_back8
L_slow8:
s_waitcnt lgkmcnt(0)
s_cmp_ge_u32 s58, 8
s_cbranch_scc1 L_back8
s_mov_b32 s58, 0
s_atomic_add s58, s[20:21], s57 offset:144 glc
s_sub_u32 s46, s46, 1
s_cbranch_scc0 L_slow8
s_endpgm
L_back8:
v_fma_f32 v211, v211, v73, v72
v_mfma_f32_16x16x32_bf16 v[96:99], v[24:27], a[0:3], 0
ds_read_b128 v[20:23], v7 offset:7168
v_mul_f32 v210, v210, v146
v_mfma_f32_16x16x32_bf16 v[104:107], v[24:27], a[4:7], 0
v_fma_f32 v208, v208, v74, v74
s_waitcnt lgkmcnt(3)
v_mfma_f32_16x16x32_bf16 v[100:103], v[28:31], a[0:3], 0
ds_read_b128 v[24:27], v7 offset:8192
global_load_lds_dwordx4 v4, s[20:21] offset:2048 sc1
v_mfma_f32_16x16x32_bf16 v[108:111], v[28:31], a[4:7], 0
v_exp_f32 v209, v209
v_mul_f32 v213, v149, v149
v_fma_f32 v212, v212, v73, v72
v_mfma_f32_16x16x32_bf16 v[112:115], v[32:35], a[0:3], 0
ds_read_b128 v[28:31], v7 offset:9216
v_mul_f32 v211, v211, v147
v_mfma_f32_16x16x32_bf16 v[120:123], v[32:35], a[4:7], 0
v_exp_f32 v210, v210
v_mfma_f32_16x16x32_bf16 v[116:119], v[36:39], a[0:3], 0
ds_read_b128 v[32:35], v7 offset:10240
global_load_lds_dwordx4 v4, s[20:21] offset:3072 sc1
v_mfma_f32_16x16x32_bf16 v[124:127], v[36:39], a[4:7], 0
v_rcp_f32 v208, v208
v_mfma_f32_16x16x32_bf16 v[192:195], v[40:43], a[0:3], v[192:195]
ds_read_b128 v[36:39], v7 offset:11264
v_fma_f32 v209, v209, v74, v74
v_mfma_f32_16x16x32_bf16 v[200:203], v[40:43], a[4:7], v[200:203]
v_mul_f32 v214, v150, v150
v_fma_f32 v213, v213, v73, v72
s_waitcnt lgkmcnt(3)
v_mfma_f32_16x16x32_bf16 v[196:199], v[44:47], a[0:3], v[196:199]
ds_read_b128 v[40:43], v7 offset:12288
global_load_dwordx4 a[112:115], v5, s[20:21] offset:0 sc1
v_mfma_f32_16x16x32_bf16 v[204:207], v[44:47], a[4:7], v[204:207]
v_exp_f32 v211, v211
v_mul_f32 v212, v212, v148
v_mfma_f32_16x16x32_bf16 v[80:83], v[16:19], a[0:3], v[80:83]
ds_read_b128 v[44:47], v7 offset:13312
v_fma_f32 v210, v210, v74, v74
v_mfma_f32_16x16x32_bf16 v[88:91], v[16:19], a[4:7], v[88:91]
v_rcp_f32 v209, v209
v_mfma_f32_16x16x32_bf16 v[84:87], v[20:23], a[0:3], v[84:87]
ds_read_b128 v[16:19], v7 offset:14336
global_load_dwordx4 a[116:119], v5, s[20:21] offset:1024 sc1
v_mfma_f32_16x16x32_bf16 v[92:95], v[20:23], a[4:7], v[92:95]
v_mul_f32 v144, v208, v144
v_mul_f32 v215, v151, v151
v_mfma_f32_16x16x32_bf16 v[96:99], v[24:27], a[8:11], v[96:99]
ds_read_b128 v[20:23], v7 offset:15360
v_fma_f32 v214, v214, v73, v72
v_mfma_f32_16x16x32_bf16 v[104:107], v[24:27], a[12:15], v[104:107]
v_mul_f32 v213, v213, v149
s_waitcnt lgkmcnt(3)
v_mfma_f32_16x16x32_bf16 v[100:103], v[28:31], a[8:11], v[100:103]
s_barrier
ds_read_b128 v[24:27], v7 offset:16384
v_mfma_f32_16x16x32_bf16 v[108:111], v[28:31], a[12:15], v[108:111]
v_exp_f32 v212, v212
v_fma_f32 v211, v211, v74, v74
v_mfma_f32_16x16x32_bf16 v[112:115], v[32:35], a[8:11], v[112:115]
ds_read_b128 v[28:31], v7 offset:17408
s_add_u32 m0, s43, 49152
v_mfma_f32_16x16x32_bf16 v[120:123], v[32:35], a[12:15], v[120:123]
v_add_u32 v4, 16384, v4
v_mul_f32 v145, v209, v145
v_rcp_f32 v210, v210
v_mul_f32 v208, v152, v152
v_mfma_f32_16x16x32_bf16 v[116:119], v[36:39], a[8:11], v[116:119]
ds_read_b128 v[32:35], v7 offset:18432
global_load_lds_dwordx4 v4, s[20:21] offset:0 sc1
v_mfma_f32_16x16x32_bf16 v[124:127], v[36:39], a[12:15], v[124:127]
global_load_lds_dwordx4 v4, s[20:21] offset:1024 sc1
v_fma_f32 v215, v215, v73, v72
v_mul_f32 v214, v214, v150
v_mfma_f32_16x16x32_bf16 v[192:195], v[40:43], a[8:11], v[192:195]
s_waitcnt vmcnt(8)
s_atomic_add s45, s[20:21], s57 offset:152
v_mfma_f32_16x16x32_bf16 v[200:203], v[40:43], a[12:15], v[200:203]
ds_read_b128 v[36:39], v7 offset:19456
s_waitcnt lgkmcnt(4)
v_mfma_f32_16x16x32_bf16 v[196:199], v[44:47], a[8:11], v[196:199]
ds_read_b128 v[40:43], v7 offset:20480
global_load_lds_dwordx4 v4, s[20:21] offset:2048 sc1
v_mfma_f32_16x16x32_bf16 v[204:207], v[44:47], a[12:15], v[204:207]
v_exp_f32 v213, v213
v_fma_f32 v212, v212, v74, v74
v_mfma_f32_16x16x32_bf16 v[80:83], v[16:19], a[8:11], v[80:83]
ds_read_b128 v[44:47], v7 offset:21504
v_mul_f32 v146, v210, v146
v_mfma_f32_16x16x32_bf16 v[88:91], v[16:19], a[12:15], v[88:91]
v_rcp_f32 v211, v211
v_cvt_pk_bf16_f32 v240, v144, v145
v_mfma_f32_16x16x32_bf16 v[84:87], v[20:23], a[8:11], v[84:87]
ds_read_b128 v[16:19], v7 offset:22528
global_load_lds_dwordx4 v4, s[20:21] offset:3072 sc1
v_mfma_f32_16x16x32_bf16 v[92:95], v[20:23], a[12:15], v[92:95]
v_mul_f32 v209, v153, v153
v_fma_f32 v208, v208, v76, v75
v_mul_f32 v215, v215, v151
s_waitcnt lgkmcnt(4)
v_mfma_f32_16x16x32_bf16 v[96:99], v[24:27], a[16:19], v[96:99]
ds_read_b128 v[20:23], v7 offset:23552
v_fma_f32 v213, v213, v74, v74
v_mfma_f32_16x16x32_bf16 v[104:107], v[24:27], a[20:23], v[104:107]
v_exp_f32 v214, v214
v_mfma_f32_16x16x32_bf16 v[100:103], v[28:31], a[16:19], v[100:103]
ds_read_b128 v[24:27], v7 offset:24576
global_load_dwordx4 a[120:123], v5, s[20:21] offset:2048 sc1
v_mfma_f32_16x16x32_bf16 v[108:111], v[28:31], a[20:23], v[108:111]
v_rcp_f32 v212, v212
v_mfma_f32_16x16x32_bf16 v[112:115], v[32:35], a[16:19], v[112:115]
ds_read_b128 v[28:31], v7 offset:25600
v_mul_f32 v147, v211, v147
v_mfma_f32_16x16x32_bf16 v[120:123], v[32:35], a[20:23], v[120:123]
v_mul_f32 v210, v154, v154
v_fma_f32 v209, v209, v76, v75
s_waitcnt lgkmcnt(4)
v_mfma_f32_16x16x32_bf16 v[116:119], v[36:39], a[16:19], v[116:119]
ds_read_b128 v[32:35], v7 offset:26624
global_load_dwordx4 a[124:127], v5, s[20:21] offset:3072 sc1
v_mfma_f32_16x16x32_bf16 v[124:127], v[36:39], a[20:23], v[124:127]
v_exp_f32 v215, v215
v_mul_f32 v208, v208, v152
v_mfma_f32_16x16x32_bf16 v[192:195], v[40:43], a[16:19], v[192:195]
ds_read_b128 v[36:39], v7 offset:27648
v_fma_f32 v214, v214, v74, v74
v_mfma_f32_16x16x32_bf16 v[200:203], v[40:43], a[20:23], v[200:203]
v_rcp_f32 v213, v213
v_mfma_f32_16x16x32_bf16 v[196:199], v[44:47], a[16:19], v[196:199]
ds_read_b128 v[40:43], v7 offset:28672
v_add_u32 v5, 8192, v5
v_mfma_f32_16x16x32_bf16 v[204:207], v[44:47], a[20:23], v[204:207]
global_load_dwordx4 a[128:131], v5, s[20:21] offset:-4096 sc1
v_mul_f32 v148, v212, v148
v_cvt_pk_bf16_f32 v241, v146, v147
v_mul_f32 v211, v155, v155
s_waitcnt lgkmcnt(4)
v_mfma_f32_16x16x32_bf16 v[80:83], v[16:19], a[16:19], v[80:83]
ds_read_b128 v[44:47], v7 offset:29696
v_fma_f32 v210, v210, v76, v75
v_mfma_f32_16x16x32_bf16 v[88:91], v[16:19], a[20:23], v[88:91]
v_exp_f32 v208, v208
v_mfma_f32_16x16x32_bf16 v[84:87], v[20:23], a[16:19], v[84:87]
ds_read_b128 v[16:19], v7 offset:30720
global_load_dwordx4 a[132:135], v5, s[20:21] offset:-3072 sc1
v_mfma_f32_16x16x32_bf16 v[92:95], v[20:23], a[20:23], v[92:95]
v_rcp_f32 v214, v214
v_mfma_f32_16x16x32_bf16 v[96:99], v[24:27], a[24:27], v[96:99]
ds_read_b128 v[20:23], v7 offset:31744
v_mul_f32 v209, v209, v153
v_mfma_f32_16x16x32_bf16 v[104:107], v[24:27], a[28:31], v[104:107]
v_fma_f32 v215, v215, v74, v74
v_mul_f32 v149, v213, v149
s_waitcnt lgkmcnt(4)
v_mfma_f32_16x16x32_bf16 v[100:103], v[28:31], a[24:27], v[100:103]
s_barrier
ds_read_b128 v[24:27], v7 offset:32768
v_mfma_f32_16x16x32_bf16 v[108:111], v[28:31], a[28:31], v[108:111]
v_exp_f32 v209, v209
v_mul_f32 v212, v156, v156
v_mfma_f32_16x16x32_bf16 v[112:115], v[32:35], a[24:27], v[112:115]
ds_read_b128 v[28:31], v7 offset:33792
s_add_u32 m0, s43, 65536
v_mfma_f32_16x16x32_bf16 v[120:123], v[32:35], a[28:31], v[120:123]
v_add_u32 v4, 16384, v4
v_fma_f32 v211, v211, v76, v75
v_mul_f32 v210, v210, v154
v_fma_f32 v208, v208, v77, v77
v_mfma_f32_16x16x32_bf16 v[116:119], v[36:39], a[24:27], v[116:119]
ds_read_b128 v[32:35], v7 offset:34816
global_load_lds_dwordx4 v4, s[20:21] offset:0 sc1
v_mfma_f32_16x16x32_bf16 v[124:127], v[36:39], a[28:31], v[124:127]
global_load_lds_dwordx4 v4, s[20:21] offset:1024 sc1
v_rcp_f32 v215, v215
s_waitcnt lgkmcnt(4)
v_mfma_f32_16x16x32_bf16 v[192:195], v[40:43], a[24:27], v[192:195]
ds_read_b128 v[36:39], v7 offset:35840
v_mul_f32 v150, v214, v150
v_mfma_f32_16x16x32_bf16 v[200:203], v[40:43], a[28:31], v[200:203]
v_cvt_pk_bf16_f32 v242, v148, v149
v_mul_f32 v213, v157, v157
v_mfma_f32_16x16x32_bf16 v[196:199], v[44:47], a[24:27], v[196:199]
ds_read_b128 v[40:43], v7 offset:36864
global_load_lds_dwordx4 v4, s[20:21] offset:2048 sc1
v_mfma_f32_16x16x32_bf16 v[204:207], v[44:47], a[28:31], v[204:207]
v_exp_f32 v210, v210
v_fma_f32 v212, v212, v76, v75
v_mfma_f32_16x16x32_bf16 v[80:83], v[16:19], a[24:27], v[80:83]
ds_read_b128 v[44:47], v7 offset:37888
v_mul_f32 v211, v211, v155
v_mfma_f32_16x16x32_bf16 v[88:91], v[16:19], a[28:31], v[88:91]
v_fma_f32 v209, v209, v77, v77
s_waitcnt lgkmcnt(4)
v_mfma_f32_16x16x32_bf16 v[84:87], v[20:23], a[24:27], v[84:87]
ds_read_b128 v[16:19], v7 offset:38912
global_load_lds_dwordx4 v4, s[20:21] offset:3072 sc1
v_mfma_f32_16x16x32_bf16 v[92:95], v[20:23], a[28:31], v[92:95]
v_rcp_f32 v208, v208
v_mul_f32 v151, v215, v151
v_mul_f32 v214, v158, v158
v_mfma_f32_16x16x32_bf16 v[96:99], v[24:27], a[32:35], v[96:99]
ds_read_b128 v[20:23], v7 offset:39936
v_fma_f32 v213, v213, v76, v75
v_mfma_f32_16x16x32_bf16 v[104:107], v[24:27], a[36:39], v[104:107]
v_exp_f32 v211, v211
v_mfma_f32_16x16x32_bf16 v[100:103], v[28:31], a[32:35], v[100:103]
ds_read_b128 v[24:27], v7 offset:40960
global_load_dwordx4 a[136:139], v5, s[20:21] offset:-2048 sc1
v_mfma_f32_16x16x32_bf16 v[108:111], v[28:31], a[36:39], v[108:111]
v_mul_f32 v212, v212, v156
v_fma_f32 v210, v210, v77, v77
s_waitcnt lgkmcnt(4)
v_mfma_f32_16x16x32_bf16 v[112:115], v[32:35], a[32:35], v[112:115]
ds_read_b128 v[28:31], v7 offset:41984
v_mul_f32 v152, v208, v152
v_mfma_f32_16x16x32_bf16 v[120:123], v[32:35], a[36:39], v[120:123]
v_rcp_f32 v209, v209
v_mfma_f32_16x16x32_bf16 v[116:119], v[36:39], a[32:35], v[116:119]
ds_read_b128 v[32:35], v7 offset:43008
global_load_dwordx4 a[140:143], v5, s[20:21] offset:-1024 sc1
v_mfma_f32_16x16x32_bf16 v[124:127], v[36:39], a[36:39], v[124:127]
s_atomic_add s59, s[20:21], s57 offset:152 glc
v_cvt_pk_bf16_f32 v243, v150, v151
v_mfma_f32_16x16x32_bf16 v[192:195], v[40:43], a[32:35], v[192:195]
ds_read_b128 v[36:39], v7 offset:44032
v_mul_f32 v215, v159, v159
v_mfma_f32_16x16x32_bf16 v[200:203], v[40:43], a[36:39], v[200:203]
v_fma_f32 v214, v214, v76, v75
v_mul_f32 v213, v213, v157
s_waitcnt lgkmcnt(4)
v_mfma_f32_16x16x32_bf16 v[196:199], v[44:47], a[32:35], v[196:199]
ds_read_b128 v[40:43], v7 offset:45056
v_fma_f32 v211, v211, v77, v77
v_mfma_f32_16x16x32_bf16 v[204:207], v[44:47], a[36:39], v[204:207]
v_exp_f32 v212, v212
v_mfma_f32_16x16x32_bf16 v[80:83], v[16:19], a[32:35], v[80:83]
ds_read_b128 v[44:47], v7 offset:46080
global_load_dwordx4 a[144:147], v5, s[20:21] offset:0 sc1
v_mfma_f32_16x16x32_bf16 v[88:91], v[16:19], a[36:39], v[88:91]
v_rcp_f32 v210, v210
v_mfma_f32_16x16x32_bf16 v[84:87], v[20:23], a[32:35], v[84:87]
ds_read_b128 v[16:19], v7 offset:47104
v_mul_f32 v153, v209, v153
v_mfma_f32_16x16x32_bf16 v[92:95], v[20:23], a[36:39], v[92:95]
v_fma_f32 v215, v215, v76, v75
v_mul_f32 v214, v214, v158
s_waitcnt lgkmcnt(4)
v_mfma_f32_16x16x32_bf16 v[96:99], v[24:27], a[40:43], v[96:99]
ds_read_b128 v[20:23], v7 offset:48128
global_load_dwordx4 a[148:151], v5, s[20:21] offset:1024 sc1
v_mfma_f32_16x16x32_bf16 v[104:107], v[24:27], a[44:47], v[104:107]
v_exp_f32 v213, v213
v_fma_f32 v212, v212, v77, v77
v_mfma_f32_16x16x32_bf16 v[100:103], v[28:31], a[40:43], v[100:103]
s_barrier
ds_read_b128 v[24:27], v7 offset:49152
v_mfma_f32_16x16x32_bf16 v[108:111], v[28:31], a[44:47], v[108:111]
v_rcp_f32 v211, v211
v_mul_f32 v154, v210, v154
v_mfma_f32_16x16x32_bf16 v[112:115], v[32:35], a[40:43], v[112:115]
ds_read_b128 v[28:31], v7 offset:50176
s_add_u32 m0, s43, 81920
v_mfma_f32_16x16x32_bf16 v[120:123], v[32:35], a[44:47], v[120:123]
v_add_u32 v4, 16384, v4
v_cvt_pk_bf16_f32 v244, v152, v153
v_mul_f32 v215, v215, v159
s_waitcnt lgkmcnt(4)
v_mfma_f32_16x16x32_bf16 v[116:119], v[36:39], a[40:43], v[116:119]
ds_read_b128 v[32:35], v7 offset:51200
global_load_lds_dwordx4 v4, s[20:21] offset:0 sc1
v_mfma_f32_16x16x32_bf16 v[124:127], v[36:39], a[44:47], v[124:127]
v_exp_f32 v214, v214
v_fma_f32 v213, v213, v77, v77
v_mfma_f32_16x16x32_bf16 v[192:195], v[40:43], a[40:43], v[192:195]
ds_read_b128 v[36:39], v7 offset:52224
global_load_lds_dwordx4 v4, s[20:21] offset:1024 sc1
v_mfma_f32_16x16x32_bf16 v[200:203], v[40:43], a[44:47], v[200:203]
v_rcp_f32 v212, v212
v_mul_f32 v155, v211, v155
v_mfma_f32_16x16x32_bf16 v[196:199], v[44:47], a[40:43], v[196:199]
v_exp_f32 v215, v215
v_mfma_f32_16x16x32_bf16 v[204:207], v[44:47], a[44:47], v[204:207]
ds_read_b128 v[40:43], v7 offset:53248
v_fma_f32 v214, v214, v77, v77
s_waitcnt lgkmcnt(4)
v_mfma_f32_16x16x32_bf16 v[80:83], v[16:19], a[40:43], v[80:83]
ds_read_b128 v[44:47], v7 offset:54272
global_load_lds_dwordx4 v4, s[20:21] offset:2048 sc1
v_mfma_f32_16x16x32_bf16 v[88:91], v[16:19], a[44:47], v[88:91]
v_rcp_f32 v213, v213
v_mul_f32 v156, v212, v156
v_mfma_f32_16x16x32_bf16 v[84:87], v[20:23], a[40:43], v[84:87]
ds_read_b128 v[16:19], v7 offset:55296
v_cvt_pk_bf16_f32 v245, v154, v155
v_mfma_f32_16x16x32_bf16 v[92:95], v[20:23], a[44:47], v[92:95]
v_rcp_f32 v214, v214
v_mfma_f32_16x16x32_bf16 v[96:99], v[24:27], a[48:51], v[96:99]
ds_read_b128 v[20:23], v7 offset:56320
global_load_lds_dwordx4 v4, s[20:21] offset:3072 sc1
v_mfma_f32_16x16x32_bf16 v[104:107], v[24:27], a[52:55], v[104:107]
v_fma_f32 v215, v215, v77, v77
v_mul_f32 v157, v213, v157
s_waitcnt lgkmcnt(4)
v_mfma_f32_16x16x32_bf16 v[100:103], v[28:31], a[48:51], v[100:103]
ds_read_b128 v[24:27], v7 offset:57344
v_mul_f32 v158, v214, v158
v_mfma_f32_16x16x32_bf16 v[108:111], v[28:31], a[52:55], v[108:111]
v_rcp_f32 v215, v215
v_mfma_f32_16x16x32_bf16 v[112:115], v[32:35], a[48:51], v[112:115]
ds_read_b128 v[28:31], v7 offset:58368
global_load_dwordx4 a[152:155], v5, s[20:21] offset:2048 sc1
v_mfma_f32_16x16x32_bf16 v[120:123], v[32:35], a[52:55], v[120:123]
v_cvt_pk_bf16_f32 v246, v156, v157
v_mul_f32 v159, v215, v159
v_cvt_pk_bf16_f32 v247, v158, v159
v_mfma_f32_16x16x32_bf16 v[116:119], v[36:39], a[48:51], v[116:119]
ds_read_b128 v[32:35], v7 offset:59392
s_add_u32 s38, s47, 39911424
buffer_store_dwordx4 v[240:243], v0, s[20:23], s38 offen offset:0 sc1
buffer_store_dwordx4 v[244:247], v0, s[20:23], s38 offen offset:1024 sc1
v_mfma_f32_16x16x32_bf16 v[124:127], v[36:39], a[52:55], v[124:127]
s_mov_b32 s58, 0
s_waitcnt lgkmcnt(4)
v_mfma_f32_16x16x32_bf16 v[192:195], v[40:43], a[48:51], v[192:195]
ds_read_b128 v[36:39], v7 offset:60416
v_mfma_f32_16x16x32_bf16 v[200:203], v[40:43], a[52:55], v[200:203]
s_cmp_lt_u32 s59, 8
s_cbranch_scc0 L_back9
L_slow9:
s_waitcnt lgkmcnt(0)
s_cmp_ge_u32 s59, 8
s_cbranch_scc1 L_back9
s_mov_b32 s59, 0
s_atomic_add s59, s[20:21], s57 offset:152 glc
s_sub_u32 s46, s46, 1
s_cbranch_scc0 L_slow9
s_endpgm
L_back9:
v_mfma_f32_16x16x32_bf16 v[196:199], v[44:47], a[48:51], v[196:199]
ds_read_b128 v[40:43], v7 offset:61440
v_mul_f32 v208, v160, v160
v_mfma_f32_16x16x32_bf16 v[204:207], v[44:47], a[52:55], v[204:207]
v_mul_f32 v209, v161, v161
v_fma_f32 v208, v208, v73, v72
v_mfma_f32_16x16x32_bf16 v[80:83], v[16:19], a[48:51], v[80:83]
ds_read_b128 v[44:47], v7 offset:62464
v_mul_f32 v210, v162, v162
v_mfma_f32_16x16x32_bf16 v[88:91], v[16:19], a[52:55], v[88:91]
v_fma_f32 v209, v209, v73, v72
s_waitcnt lgkmcnt(3)
v_mfma_f32_16x16x32_bf16 v[84:87], v[20:23], a[48:51], v[84:87]
ds_read_b128 v[16:19], v7 offset:63488
v_mul_f32 v208, v208, v160
v_mfma_f32_16x16x32_bf16 v[92:95], v[20:23], a[52:55], v[92:95]
v_exp_f32 v208, v208
v_mfma_f32_16x16x32_bf16 v[96:99], v[24:27], a[56:59], v[96:99]
ds_read_b128 v[20:23], v7 offset:64512
v_mul_f32 v211, v163, v163
v_mfma_f32_16x16x32_bf16 v[104:107], v[24:27], a[60:63], v[104:107]
v_fma_f32 v210, v210, v73, v72
v_mul_f32 v209, v209, v161
v_mfma_f32_16x16x32_bf16 v[100:103], v[28:31], a[56:59], v[100:103]
s_barrier
ds_read_b128 v[24:27], v6 offset:0
v_mfma_f32_16x16x32_bf16 v[108:111], v[28:31], a[60:63], v[108:111]
global_load_dwordx4 a[156:159], v5, s[20:21] offset:3072 sc1
v_mul_f32 v212, v164, v164
v_fma_f32 v211, v211, v73, v72
v_mfma_f32_16x16x32_bf16 v[112:115], v[32:35], a[56:59], v[112:115]
ds_read_b128 v[28:31], v6 offset:1024
v_mul_f32 v210, v210, v162
v_mfma_f32_16x16x32_bf16 v[120:123], v[32:35], a[60:63], v[120:123]
v_fma_f32 v208, v208, v74, v74
s_waitcnt lgkmcnt(3)
v_mfma_f32_16x16x32_bf16 v[116:119], v[36:39], a[56:59], v[116:119]
ds_read_b128 v[32:35], v6 offset:2048
s_add_u32 m0, s43, 98304
v_mfma_f32_16x16x32_bf16 v[124:127], v[36:39], a[60:63], v[124:127]
v_add_u32 v4, 16384, v4
v_mul_f32 v213, v165, v165
v_exp_f32 v209, v209
v_fma_f32 v212, v212, v73, v72
v_mfma_f32_16x16x32_bf16 v[192:195], v[40:43], a[56:59], v[192:195]
ds_read_b128 v[36:39], v6 offset:3072
global_load_lds_dwordx4 v4, s[20:21] offset:0 sc1
v_mfma_f32_16x16x32_bf16 v[200:203], v[40:43], a[60:63], v[200:203]
v_exp_f32 v210, v210
v_mul_f32 v211, v211, v163
v_mfma_f32_16x16x32_bf16 v[196:199], v[44:47], a[56:59], v[196:199]
ds_read_b128 v[40:43], v6 offset:4096
global_load_lds_dwordx4 v4, s[20:21] offset:1024 sc1
v_mfma_f32_16x16x32_bf16 v[204:207], v[44:47], a[60:63], v[204:207]
v_rcp_f32 v208, v208
v_fma_f32 v209, v209, v74, v74
v_mfma_f32_16x16x32_bf16 v[80:83], v[16:19], a[56:59], v[80:83]
ds_read_b128 v[44:47], v6 offset:5120
v_mul_f32 v214, v166, v166
v_mfma_f32_16x16x32_bf16 v[88:91], v[16:19], a[60:63], v[88:91]
v_fma_f32 v213, v213, v73, v72
s_waitcnt lgkmcnt(3)
v_mfma_f32_16x16x32_bf16 v[84:87], v[20:23], a[56:59], v[84:87]
ds_read_b128 v[16:19], v6 offset:6144
global_load_lds_dwordx4 v4, s[20:21] offset:2048 sc1
v_mfma_f32_16x16x32_bf16 v[92:95], v[20:23], a[60:63], v[92:95]
v_exp_f32 v211, v211
v_mul_f32 v212, v212, v164
v_mfma_f32_16x16x32_bf16 v[96:99], v[24:27], a[64:67], v[96:99]
ds_read_b128 v[20:23], v6 offset:7168
v_fma_f32 v210, v210, v74, v74
v_mfma_f32_16x16x32_bf16 v[104:107], v[24:27], a[68:71], v[104:107]
v_rcp_f32 v209, v209
v_mfma_f32_16x16x32_bf16 v[100:103], v[28:31], a[64:67], v[100:103]
ds_read_b128 v[24:27], v6 offset:8192
global_load_lds_dwordx4 v4, s[20:21] offset:3072 sc1
v_mfma_f32_16x16x32_bf16 v[108:111], v[28:31], a[68:71], v[108:111]
v_mul_f32 v160, v208, v160
v_mul_f32 v215, v167, v167
v_fma_f32 v214, v214, v73, v72
v_mfma_f32_16x16x32_bf16 v[112:115], v[32:35], a[64:67], v[112:115]
ds_read_b128 v[28:31], v6 offset:9216
v_mul_f32 v213, v213, v165
v_mfma_f32_16x16x32_bf16 v[120:123], v[32:35], a[68:71], v[120:123]
v_fma_f32 v211, v211, v74, v74
s_waitcnt lgkmcnt(3)
v_mfma_f32_16x16x32_bf16 v[116:119], v[36:39], a[64:67], v[116:119]
ds_read_b128 v[32:35], v6 offset:10240
v_add_u32 v5, 8192, v5
v_mfma_f32_16x16x32_bf16 v[124:127], v[36:39], a[68:71], v[124:127]
global_load_dwordx4 a[160:163], v5, s[20:21] offset:-4096 sc1
v_mul_f32 v161, v209, v161
v_exp_f32 v212, v212
v_mfma_f32_16x16x32_bf16 v[192:195], v[40:43], a[64:67], v[192:195]
ds_read_b128 v[36:39], v6 offset:11264
v_mul_f32 v208, v168, v168
v_mfma_f32_16x16x32_bf16 v[200:203], v[40:43], a[68:71], v[200:203]
v_rcp_f32 v210, v210
v_mfma_f32_16x16x32_bf16 v[196:199], v[44:47], a[64:67], v[196:199]
ds_read_b128 v[40:43], v6 offset:12288
global_load_dwordx4 a[164:167], v5, s[20:21] offset:-3072 sc1
v_mfma_f32_16x16x32_bf16 v[204:207], v[44:47], a[68:71], v[204:207]
v_exp_f32 v213, v213
v_fma_f32 v215, v215, v73, v72
v_mfma_f32_16x16x32_bf16 v[80:83], v[16:19], a[64:67], v[80:83]
ds_read_b128 v[44:47], v6 offset:13312
v_mul_f32 v214, v214, v166
v_mfma_f32_16x16x32_bf16 v[88:91], v[16:19], a[68:71], v[88:91]
v_fma_f32 v212, v212, v74, v74
s_waitcnt lgkmcnt(3)
v_mfma_f32_16x16x32_bf16 v[84:87], v[20:23], a[64:67], v[84:87]
ds_read_b128 v[16:19], v6 offset:14336
global_load_dwordx4 a[168:171], v5, s[20:21] offset:-2048 sc1
v_mfma_f32_16x16x32_bf16 v[92:95], v[20:23], a[68:71], v[92:95]
s_waitcnt vmcnt(8)
s_atomic_add s45, s[20:21], s57 offset:160
v_rcp_f32 v211, v211
v_mfma_f32_16x16x32_bf16 v[96:99], v[24:27], a[72:75], v[96:99]
ds_read_b128 v[20:23], v6 offset:15360
v_mul_f32 v162, v210, v162
v_mfma_f32_16x16x32_bf16 v[104:107], v[24:27], a[76:79], v[104:107]
v_cvt_pk_bf16_f32 v248, v160, v161
v_mul_f32 v209, v169, v169
v_mfma_f32_16x16x32_bf16 v[100:103], v[28:31], a[72:75], v[100:103]
s_barrier
ds_read_b128 v[24:27], v6 offset:16384
v_mfma_f32_16x16x32_bf16 v[108:111], v[28:31], a[76:79], v[108:111]
global_load_dwordx4 a[172:175], v5, s[20:21] offset:-1024 sc1
v_fma_f32 v208, v208, v76, v75
v_mul_f32 v215, v215, v167
v_mfma_f32_16x16x32_bf16 v[112:115], v[32:35], a[72:75], v[112:115]
v_exp_f32 v214, v214
v_mfma_f32_16x16x32_bf16 v[120:123], v[32:35], a[76:79], v[120:123]
ds_read_b128 v[28:31], v6 offset:17408
v_fma_f32 v213, v213, v74, v74
s_waitcnt lgkmcnt(4)
v_mfma_f32_16x16x32_bf16 v[116:119], v[36:39], a[72:75], v[116:119]
ds_read_b128 v[32:35], v6 offset:18432
s_add_u32 m0, s43, 114688
v_mfma_f32_16x16x32_bf16 v[124:127], v[36:39], a[76:79], v[124:127]
v_add_u32 v4, 16384, v4
v_mul_f32 v163, v211, v163
v_rcp_f32 v212, v212
v_mfma_f32_16x16x32_bf16 v[192:195], v[40:43], a[72:75], v[192:195]
ds_read_b128 v[36:39], v6 offset:19456
global_load_lds_dwordx4 v4, s[20:21] offset:0 sc1
v_mfma_f32_16x16x32_bf16 v[200:203], v[40:43], a[76:79], v[200:203]
v_exp_f32 v215, v215
v_mul_f32 v210, v170, v170
v_mfma_f32_16x16x32_bf16 v[196:199], v[44:47], a[72:75], v[196:199]
ds_read_b128 v[40:43], v6 offset:20480
global_load_lds_dwordx4 v4, s[20:21] offset:1024 sc1
v_mfma_f32_16x16x32_bf16 v[204:207], v[44:47], a[76:79], v[204:207]
v_fma_f32 v209, v209, v76, v75
v_mul_f32 v208, v208, v168
s_waitcnt lgkmcnt(4)
v_mfma_f32_16x16x32_bf16 v[80:83], v[16:19], a[72:75], v[80:83]
ds_read_b128 v[44:47], v6 offset:21504
v_fma_f32 v214, v214, v74, v74
v_mfma_f32_16x16x32_bf16 v[88:91], v[16:19], a[76:79], v[88:91]
v_rcp_f32 v213, v213
v_mfma_f32_16x16x32_bf16 v[84:87], v[20:23], a[72:75], v[84:87]
ds_read_b128 v[16:19], v6 offset:22528
global_load_lds_dwordx4 v4, s[20:21] offset:2048 sc1
v_mfma_f32_16x16x32_bf16 v[92:95], v[20:23], a[76:79], v[92:95]
v_mul_f32 v164, v212, v164
v_cvt_pk_bf16_f32 v249, v162, v163
v_mul_f32 v211, v171, v171
v_mfma_f32_16x16x32_bf16 v[96:99], v[24:27], a[80:83], v[96:99]
ds_read_b128 v[20:23], v6 offset:23552
v_fma_f32 v210, v210, v76, v75
v_mfma_f32_16x16x32_bf16 v[104:107], v[24:27], a[84:87], v[104:107]
v_mul_f32 v209, v209, v169
s_waitcnt lgkmcnt(4)
v_mfma_f32_16x16x32_bf16 v[100:103], v[28:31], a[80:83], v[100:103]
ds_read_b128 v[24:27], v6 offset:24576
global_load_lds_dwordx4 v4, s[20:21] offset:3072 sc1
v_mfma_f32_16x16x32_bf16 v[108:111], v[28:31], a[84:87], v[108:111]
v_exp_f32 v208, v208
v_fma_f32 v215, v215, v74, v74
v_mfma_f32_16x16x32_bf16 v[112:115], v[32:35], a[80:83], v[112:115]
ds_read_b128 v[28:31], v6 offset:25600
v_mul_f32 v165, v213, v165
v_mfma_f32_16x16x32_bf16 v[120:123], v[32:35], a[84:87], v[120:123]
v_rcp_f32 v214, v214
v_mfma_f32_16x16x32_bf16 v[116:119], v[36:39], a[80:83], v[116:119]
ds_read_b128 v[32:35], v6 offset:26624
global_load_dwordx4 a[176:179], v5, s[20:21] offset:0 sc1
v_mfma_f32_16x16x32_bf16 v[124:127], v[36:39], a[84:87], v[124:127]
v_mul_f32 v212, v172, v172
v_fma_f32 v211, v211, v76, v75
v_mul_f32 v210, v210, v170
s_waitcnt lgkmcnt(4)
v_mfma_f32_16x16x32_bf16 v[192:195], v[40:43], a[80:83], v[192:195]
ds_read_b128 v[36:39], v6 offset:27648
v_fma_f32 v208, v208, v77, v77
v_mfma_f32_16x16x32_bf16 v[200:203], v[40:43], a[84:87], v[200:203]
v_exp_f32 v209, v209
v_mfma_f32_16x16x32_bf16 v[196:199], v[44:47], a[80:83], v[196:199]
ds_read_b128 v[40:43], v6 offset:28672
global_load_dwordx4 a[180:183], v5, s[20:21] offset:1024 sc1
v_mfma_f32_16x16x32_bf16 v[204:207], v[44:47], a[84:87], v[204:207]
v_rcp_f32 v215, v215
v_mul_f32 v166, v214, v166
v_mfma_f32_16x16x32_bf16 v[80:83], v[16:19], a[80:83], v[80:83]
ds_read_b128 v[44:47], v6 offset:29696
v_cvt_pk_bf16_f32 v250, v164, v165
v_mfma_f32_16x16x32_bf16 v[88:91], v[16:19], a[84:87], v[88:91]
v_mul_f32 v213, v173, v173
v_fma_f32 v212, v212, v76, v75
s_waitcnt lgkmcnt(4)
v_mfma_f32_16x16x32_bf16 v[84:87], v[20:23], a[80:83], v[84:87]
ds_read_b128 v[16:19], v6 offset:30720
global_load_dwordx4 a[184:187], v5, s[20:21] offset:2048 sc1
v_mfma_f32_16x16x32_bf16 v[92:95], v[20:23], a[84:87], v[92:95]
v_exp_f32 v210, v210
v_mfma_f32_16x16x32_bf16 v[96:99], v[24:27], a[88:91], v[96:99]
ds_read_b128 v[20:23], v6 offset:31744
v_mul_f32 v211, v211, v171
v_mfma_f32_16x16x32_bf16 v[104:107], v[24:27], a[92:95], v[104:107]
v_rcp_f32 v208, v208
v_mfma_f32_16x16x32_bf16 v[100:103], v[28:31], a[88:91], v[100:103]
s_barrier
ds_read_b128 v[24:27], v6 offset:32768
v_mfma_f32_16x16x32_bf16 v[108:111], v[28:31], a[92:95], v[108:111]
global_load_dwordx4 a[188:191], v5, s[20:21] offset:3072 sc1
v_fma_f32 v209, v209, v77, v77
v_mul_f32 v167, v215, v167
v_mul_f32 v214, v174, v174
s_waitcnt lgkmcnt(4)
v_mfma_f32_16x16x32_bf16 v[112:115], v[32:35], a[88:91], v[112:115]
ds_read_b128 v[28:31], v6 offset:33792
v_fma_f32 v213, v213, v76, v75
v_mfma_f32_16x16x32_bf16 v[120:123], v[32:35], a[92:95], v[120:123]
v_exp_f32 v211, v211
v_mfma_f32_16x16x32_bf16 v[116:119], v[36:39], a[88:91], v[116:119]
ds_read_b128 v[32:35], v6 offset:34816
s_add_u32 m0, s43, 0
v_mfma_f32_16x16x32_bf16 v[124:127], v[36:39], a[92:95], v[124:127]
v_add_u32 v4, 16384, v4
v_mul_f32 v212, v212, v172
v_fma_f32 v210, v210, v77, v77
v_mfma_f32_16x16x32_bf16 v[192:195], v[40:43], a[88:91], v[192:195]
ds_read_b128 v[36:39], v6 offset:35840
global_load_lds_dwordx4 v4, s[20:21] offset:0 sc1
v_mfma_f32_16x16x32_bf16 v[200:203], v[40:43], a[92:95], v[200:203]
v_mul_f32 v168, v208, v168
v_rcp_f32 v209, v209
s_waitcnt lgkmcnt(4)
v_mfma_f32_16x16x32_bf16 v[196:199], v[44:47], a[88:91], v[196:199]
ds_read_b128 v[40:43], v6 offset:36864
global_load_lds_dwordx4 v4, s[20:21] offset:1024 sc1
v_mfma_f32_16x16x32_bf16 v[204:207], v[44:47], a[92:95], v[204:207]
v_cvt_pk_bf16_f32 v251, v166, v167
v_mul_f32 v215, v175, v175
v_fma_f32 v214, v214, v76, v75
v_mfma_f32_16x16x32_bf16 v[80:83], v[16:19], a[88:91], v[80:83]
ds_read_b128 v[44:47], v6 offset:37888
v_mfma_f32_16x16x32_bf16 v[88:91], v[16:19], a[92:95], v[88:91]
s_atomic_add s58, s[20:21], s57 offset:160 glc
v_mul_f32 v213, v213, v173
v_mfma_f32_16x16x32_bf16 v[84:87], v[20:23], a[88:91], v[84:87]
ds_read_b128 v[16:19], v6 offset:38912
global_load_lds_dwordx4 v4, s[20:21] offset:2048 sc1
v_mfma_f32_16x16x32_bf16 v[92:95], v[20:23], a[92:95], v[92:95]
v_fma_f32 v211, v211, v77, v77
v_exp_f32 v212, v212
s_waitcnt lgkmcnt(4)
v_mfma_f32_16x16x32_bf16 v[96:99], v[24:27], a[96:99], v[96:99]
ds_read_b128 v[20:23], v6 offset:39936
v_mul_f32 v169, v209, v169
v_mfma_f32_16x16x32_bf16 v[104:107], v[24:27], a[100:103], v[104:107]
v_rcp_f32 v210, v210
v_mfma_f32_16x16x32_bf16 v[100:103], v[28:31], a[96:99], v[100:103]
ds_read_b128 v[24:27], v6 offset:40960
global_load_lds_dwordx4 v4, s[20:21] offset:3072 sc1
v_mfma_f32_16x16x32_bf16 v[108:111], v[28:31], a[100:103], v[108:111]
v_exp_f32 v213, v213
v_mfma_f32_16x16x32_bf16 v[112:115], v[32:35], a[96:99], v[112:115]
ds_read_b128 v[28:31], v6 offset:41984
v_fma_f32 v215, v215, v76, v75
v_mfma_f32_16x16x32_bf16 v[120:123], v[32:35], a[100:103], v[120:123]
v_mul_f32 v214, v214, v174
v_fma_f32 v212, v212, v77, v77
s_waitcnt lgkmcnt(4)
v_mfma_f32_16x16x32_bf16 v[116:119], v[36:39], a[96:99], v[116:119]
ds_read_b128 v[32:35], v6 offset:43008
v_add_u32 v5, 8192, v5
v_mfma_f32_16x16x32_bf16 v[124:127], v[36:39], a[100:103], v[124:127]
global_load_dwordx4 a[192:195], v5, s[20:21] offset:-4096 sc1
v_mul_f32 v170, v210, v170
v_rcp_f32 v211, v211
v_mfma_f32_16x16x32_bf16 v[192:195], v[40:43], a[96:99], v[192:195]
ds_read_b128 v[36:39], v6 offset:44032
v_cvt_pk_bf16_f32 v252, v168, v169
v_mfma_f32_16x16x32_bf16 v[200:203], v[40:43], a[100:103], v[200:203]
v_exp_f32 v214, v214
v_mfma_f32_16x16x32_bf16 v[196:199], v[44:47], a[96:99], v[196:199]
ds_read_b128 v[40:43], v6 offset:45056
global_load_dwordx4 a[196:199], v5, s[20:21] offset:-3072 sc1
v_mfma_f32_16x16x32_bf16 v[204:207], v[44:47], a[100:103], v[204:207]
v_mul_f32 v215, v215, v175
v_fma_f32 v213, v213, v77, v77
s_waitcnt lgkmcnt(4)
v_mfma_f32_16x16x32_bf16 v[80:83], v[16:19], a[96:99], v[80:83]
ds_read_b128 v[44:47], v6 offset:46080
v_mul_f32 v171, v211, v171
v_mfma_f32_16x16x32_bf16 v[88:91], v[16:19], a[100:103], v[88:91]
v_rcp_f32 v212, v212
v_mfma_f32_16x16x32_bf16 v[84:87], v[20:23], a[96:99], v[84:87]
ds_read_b128 v[16:19], v6 offset:47104
global_load_dwordx4 a[200:203], v5, s[20:21] offset:-2048 sc1
v_mfma_f32_16x16x32_bf16 v[92:95], v[20:23], a[100:103], v[92:95]
v_exp_f32 v215, v215
v_fma_f32 v214, v214, v77, v77
v_mfma_f32_16x16x32_bf16 v[96:99], v[24:27], a[104:107], v[96:99]
v_rcp_f32 v213, v213
v_mfma_f32_16x16x32_bf16 v[104:107], v[24:27], a[108:111], v[104:107]
ds_read_b128 v[20:23], v6 offset:48128
v_mul_f32 v172, v212, v172
s_waitcnt lgkmcnt(4)
v_mfma_f32_16x16x32_bf16 v[100:103], v[28:31], a[104:107], v[100:103]
s_barrier
ds_read_b128 v[24:27], v6 offset:49152
v_mfma_f32_16x16x32_bf16 v[108:111], v[28:31], a[108:111], v[108:111]
global_load_dwordx4 a[204:207], v5, s[20:21] offset:-1024 sc1
v_cvt_pk_bf16_f32 v253, v170, v171
v_fma_f32 v215, v215, v77, v77
v_mfma_f32_16x16x32_bf16 v[112:115], v[32:35], a[104:107], v[112:115]
ds_read_b128 v[28:31], v6 offset:50176
v_mul_f32 v173, v213, v173
v_mfma_f32_16x16x32_bf16 v[120:123], v[32:35], a[108:111], v[120:123]
v_rcp_f32 v214, v214
v_mfma_f32_16x16x32_bf16 v[116:119], v[36:39], a[104:107], v[116:119]
ds_read_b128 v[32:35], v6 offset:51200
s_add_u32 m0, s43, 16384
v_mfma_f32_16x16x32_bf16 v[124:127], v[36:39], a[108:111], v[124:127]
v_add_u32 v4, 16384, v4
v_rcp_f32 v215, v215
v_mul_f32 v174, v214, v174
s_waitcnt lgkmcnt(4)
v_mfma_f32_16x16x32_bf16 v[192:195], v[40:43], a[104:107], v[192:195]
ds_read_b128 v[36:39], v6 offset:52224
global_load_lds_dwordx4 v4, s[20:21] offset:0 sc1
v_mfma_f32_16x16x32_bf16 v[200:203], v[40:43], a[108:111], v[200:203]
v_cvt_pk_bf16_f32 v254, v172, v173
v_mul_f32 v175, v215, v175
v_cvt_pk_bf16_f32 v255, v174, v175
v_mfma_f32_16x16x32_bf16 v[196:199], v[44:47], a[104:107], v[196:199]
ds_read_b128 v[40:43], v6 offset:53248
global_load_lds_dwordx4 v4, s[20:21] offset:1024 sc1
v_mfma_f32_16x16x32_bf16 v[204:207], v[44:47], a[108:111], v[204:207]
s_add_u32 s37, s47, 39927808
buffer_store_dwordx4 v[248:251], v0, s[20:23], s37 offen offset:0 sc1
buffer_store_dwordx4 v[252:255], v0, s[20:23], s37 offen offset:1024 sc1
s_mov_b32 s59, 0
v_mfma_f32_16x16x32_bf16 v[80:83], v[16:19], a[104:107], v[80:83]
s_cmp_lt_u32 s58, 8
s_cbranch_scc0 L_back10
L_slow10:
s_waitcnt lgkmcnt(0)
s_cmp_ge_u32 s58, 8
s_cbranch_scc1 L_back10
s_mov_b32 s58, 0
s_atomic_add s58, s[20:21], s57 offset:160 glc
s_sub_u32 s46, s46, 1
s_cbranch_scc0 L_slow10
s_endpgm
L_back10:
v_mfma_f32_16x16x32_bf16 v[88:91], v[16:19], a[108:111], v[88:91]
ds_read_b128 v[44:47], v6 offset:54272
s_waitcnt lgkmcnt(3)
v_mfma_f32_16x16x32_bf16 v[84:87], v[20:23], a[104:107], v[84:87]
ds_read_b128 v[16:19], v6 offset:55296
v_mul_f32 v208, v176, v176
v_mfma_f32_16x16x32_bf16 v[92:95], v[20:23], a[108:111], v[92:95]
v_mul_f32 v209, v177, v177
v_fma_f32 v208, v208, v73, v72
v_mfma_f32_16x16x32_bf16 v[96:99], v[24:27], a[112:115], v[96:99]
ds_read_b128 v[20:23], v6 offset:56320
v_mul_f32 v210, v178, v178
v_mfma_f32_16x16x32_bf16 v[104:107], v[24:27], a[116:119], v[104:107]
v_fma_f32 v209, v209, v73, v72
v_mul_f32 v208, v208, v176
v_mfma_f32_16x16x32_bf16 v[100:103], v[28:31], a[112:115], v[100:103]
ds_read_b128 v[24:27], v6 offset:57344
v_mul_f32 v211, v179, v179
v_mfma_f32_16x16x32_bf16 v[108:111], v[28:31], a[116:119], v[108:111]
v_exp_f32 v208, v208
v_mfma_f32_16x16x32_bf16 v[112:115], v[32:35], a[112:115], v[112:115]
ds_read_b128 v[28:31], v6 offset:58368
v_fma_f32 v210, v210, v73, v72
v_mfma_f32_16x16x32_bf16 v[120:123], v[32:35], a[116:119], v[120:123]
v_mul_f32 v209, v209, v177
s_waitcnt lgkmcnt(3)
v_mfma_f32_16x16x32_bf16 v[116:119], v[36:39], a[112:115], v[116:119]
ds_read_b128 v[32:35], v6 offset:59392
global_load_lds_dwordx4 v4, s[20:21] offset:2048 sc1
v_mfma_f32_16x16x32_bf16 v[124:127], v[36:39], a[116:119], v[124:127]
v_exp_f32 v209, v209
v_mul_f32 v212, v180, v180
v_mfma_f32_16x16x32_bf16 v[192:195], v[40:43], a[112:115], v[192:195]
ds_read_b128 v[36:39], v6 offset:60416
v_fma_f32 v211, v211, v73, v72
v_mfma_f32_16x16x32_bf16 v[200:203], v[40:43], a[116:119], v[200:203]
v_mul_f32 v210, v210, v178
v_fma_f32 v208, v208, v74, v74
v_mfma_f32_16x16x32_bf16 v[196:199], v[44:47], a[112:115], v[196:199]
ds_read_b128 v[40:43], v6 offset:61440
global_load_lds_dwordx4 v4, s[20:21] offset:3072 sc1
v_mfma_f32_16x16x32_bf16 v[204:207], v[44:47], a[116:119], v[204:207]
v_exp_f32 v210, v210
v_mfma_f32_16x16x32_bf16 v[80:83], v[16:19], a[112:115], v[80:83]
ds_read_b128 v[44:47], v6 offset:62464
v_mul_f32 v213, v181, v181
v_mfma_f32_16x16x32_bf16 v[88:91], v[16:19], a[116:119], v[88:91]
v_fma_f32 v212, v212, v73, v72
v_mul_f32 v211, v211, v179
s_waitcnt lgkmcnt(3)
v_mfma_f32_16x16x32_bf16 v[84:87], v[20:23], a[112:115], v[84:87]
ds_read_b128 v[16:19], v6 offset:63488
global_load_dwordx4 a[208:211], v5, s[20:21] offset:0 sc1
v_mfma_f32_16x16x32_bf16 v[92:95], v[20:23], a[116:119], v[92:95]
v_rcp_f32 v208, v208
v_fma_f32 v209, v209, v74, v74
v_mfma_f32_16x16x32_bf16 v[96:99], v[24:27], a[120:123], v[96:99]
ds_read_b128 v[20:23], v6 offset:64512
v_mul_f32 v214, v182, v182
v_mfma_f32_16x16x32_bf16 v[104:107], v[24:27], a[124:127], v[104:107]
v_exp_f32 v211, v211
v_mfma_f32_16x16x32_bf16 v[100:103], v[28:31], a[120:123], v[100:103]
s_barrier
ds_read_b128 v[24:27], v7 offset:0
v_mfma_f32_16x16x32_bf16 v[108:111], v[28:31], a[124:127], v[108:111]
global_load_dwordx4 a[212:215], v5, s[20:21] offset:1024 sc1
v_fma_f32 v213, v213, v73, v72
v_mul_f32 v212, v212, v180
v_fma_f32 v210, v210, v74, v74
v_mfma_f32_16x16x32_bf16 v[112:115], v[32:35], a[120:123], v[112:115]
v_rcp_f32 v209, v209
v_mfma_f32_16x16x32_bf16 v[120:123], v[32:35], a[124:127], v[120:123]
ds_read_b128 v[28:31], v7 offset:1024
s_waitcnt lgkmcnt(3)
v_mfma_f32_16x16x32_bf16 v[116:119], v[36:39], a[120:123], v[116:119]
ds_read_b128 v[32:35], v7 offset:2048
s_add_u32 m0, s43, 32768
v_mfma_f32_16x16x32_bf16 v[124:127], v[36:39], a[124:127], v[124:127]
v_add_u32 v4, 16384, v4
v_mul_f32 v176, v208, v176
v_mul_f32 v215, v183, v183
v_fma_f32 v214, v214, v73, v72
v_mfma_f32_16x16x32_bf16 v[192:195], v[40:43], a[120:123], v[192:195]
ds_read_b128 v[36:39], v7 offset:3072
global_load_lds_dwordx4 v4, s[20:21] offset:0 sc1
v_mfma_f32_16x16x32_bf16 v[200:203], v[40:43], a[124:127], v[200:203]
v_exp_f32 v212, v212
v_mul_f32 v213, v213, v181
v_mfma_f32_16x16x32_bf16 v[196:199], v[44:47], a[120:123], v[196:199]
ds_read_b128 v[40:43], v7 offset:4096
global_load_lds_dwordx4 v4, s[20:21] offset:1024 sc1
v_mfma_f32_16x16x32_bf16 v[204:207], v[44:47], a[124:127], v[204:207]
v_rcp_f32 v210, v210
v_fma_f32 v211, v211, v74, v74
v_mfma_f32_16x16x32_bf16 v[80:83], v[16:19], a[120:123], v[80:83]
ds_read_b128 v[44:47], v7 offset:5120
v_mul_f32 v177, v209, v177
v_mfma_f32_16x16x32_bf16 v[88:91], v[16:19], a[124:127], v[88:91]
v_mul_f32 v208, v184, v184
v_fma_f32 v215, v215, v73, v72
s_waitcnt lgkmcnt(3)
v_mfma_f32_16x16x32_bf16 v[84:87], v[20:23], a[120:123], v[84:87]
ds_read_b128 v[16:19], v7 offset:6144
global_load_lds_dwordx4 v4, s[20:21] offset:2048 sc1
v_mfma_f32_16x16x32_bf16 v[92:95], v[20:23], a[124:127], v[92:95]
v_exp_f32 v213, v213
v_mfma_f32_16x16x32_bf16 v[96:99], v[24:27], a[128:131], v[96:99]
ds_read_b128 v[20:23], v7 offset:7168
v_mul_f32 v214, v214, v182
v_mfma_f32_16x16x32_bf16 v[104:107], v[24:27], a[132:135], v[104:107]
v_rcp_f32 v211, v211
v_mfma_f32_16x16x32_bf16 v[100:103], v[28:31], a[128:131], v[100:103]
ds_read_b128 v[24:27], v7 offset:8192
global_load_lds_dwordx4 v4, s[20:21] offset:3072 sc1
v_mfma_f32_16x16x32_bf16 v[108:111], v[28:31], a[132:135], v[108:111]
s_waitcnt vmcnt(8)
s_atomic_add s45, s[20:21], s57 offset:168
v_fma_f32 v212, v212, v74, v74
v_mfma_f32_16x16x32_bf16 v[112:115], v[32:35], a[128:131], v[112:115]
ds_read_b128 v[28:31], v7 offset:9216
v_mul_f32 v178, v210, v178
v_mfma_f32_16x16x32_bf16 v[120:123], v[32:35], a[132:135], v[120:123]
v_cvt_pk_bf16_f32 v240, v176, v177
v_mul_f32 v209, v185, v185
s_waitcnt lgkmcnt(4)
v_mfma_f32_16x16x32_bf16 v[116:119], v[36:39], a[128:131], v[116:119]
ds_read_b128 v[32:35], v7 offset:10240
global_load_dwordx4 a[216:219], v5, s[20:21] offset:2048 sc1
v_mfma_f32_16x16x32_bf16 v[124:127], v[36:39], a[132:135], v[124:127]
v_exp_f32 v214, v214
v_fma_f32 v208, v208, v76, v75
v_mfma_f32_16x16x32_bf16 v[192:195], v[40:43], a[128:131], v[192:195]
ds_read_b128 v[36:39], v7 offset:11264
v_mul_f32 v215, v215, v183
v_mfma_f32_16x16x32_bf16 v[200:203], v[40:43], a[132:135], v[200:203]
v_rcp_f32 v212, v212
v_mfma_f32_16x16x32_bf16 v[196:199], v[44:47], a[128:131], v[196:199]
ds_read_b128 v[40:43], v7 offset:12288
global_load_dwordx4 a[220:223], v5, s[20:21] offset:3072 sc1
v_mfma_f32_16x16x32_bf16 v[204:207], v[44:47], a[132:135], v[204:207]
v_fma_f32 v213, v213, v74, v74
v_mul_f32 v179, v211, v179
s_waitcnt lgkmcnt(4)
v_mfma_f32_16x16x32_bf16 v[80:83], v[16:19], a[128:131], v[80:83]
ds_read_b128 v[44:47], v7 offset:13312
v_mul_f32 v210, v186, v186
v_mfma_f32_16x16x32_bf16 v[88:91], v[16:19], a[132:135], v[88:91]
v_exp_f32 v215, v215
v_mfma_f32_16x16x32_bf16 v[84:87], v[20:23], a[128:131], v[84:87]
ds_read_b128 v[16:19], v7 offset:14336
v_add_u32 v5, 8192, v5
v_mfma_f32_16x16x32_bf16 v[92:95], v[20:23], a[132:135], v[92:95]
global_load_dwordx4 a[224:227], v5, s[20:21] offset:-4096 sc1
v_fma_f32 v209, v209, v76, v75
v_mul_f32 v208, v208, v184
v_fma_f32 v214, v214, v74, v74
v_mfma_f32_16x16x32_bf16 v[96:99], v[24:27], a[136:139], v[96:99]
v_rcp_f32 v213, v213
v_mfma_f32_16x16x32_bf16 v[104:107], v[24:27], a[140:143], v[104:107]
ds_read_b128 v[20:23], v7 offset:15360
v_mul_f32 v180, v212, v180
s_waitcnt lgkmcnt(4)
v_mfma_f32_16x16x32_bf16 v[100:103], v[28:31], a[136:139], v[100:103]
s_barrier
ds_read_b128 v[24:27], v7 offset:16384
v_mfma_f32_16x16x32_bf16 v[108:111], v[28:31], a[140:143], v[108:111]
global_load_dwordx4 a[228:231], v5, s[20:21] offset:-3072 sc1
v_cvt_pk_bf16_f32 v241, v178, v179
v_mul_f32 v211, v187, v187
v_mfma_f32_16x16x32_bf16 v[112:115], v[32:35], a[136:139], v[112:115]
ds_read_b128 v[28:31], v7 offset:17408
v_fma_f32 v210, v210, v76, v75
v_mfma_f32_16x16x32_bf16 v[120:123], v[32:35], a[140:143], v[120:123]
v_exp_f32 v208, v208
v_mfma_f32_16x16x32_bf16 v[116:119], v[36:39], a[136:139], v[116:119]
ds_read_b128 v[32:35], v7 offset:18432
s_add_u32 m0, s43, 49152
v_mfma_f32_16x16x32_bf16 v[124:127], v[36:39], a[140:143], v[124:127]
v_add_u32 v4, 16384, v4
v_mul_f32 v209, v209, v185
v_fma_f32 v215, v215, v74, v74
s_waitcnt lgkmcnt(4)
v_mfma_f32_16x16x32_bf16 v[192:195], v[40:43], a[136:139], v[192:195]
ds_read_b128 v[36:39], v7 offset:19456
global_load_lds_dwordx4 v4, s[20:21] offset:0 sc1
v_mfma_f32_16x16x32_bf16 v[200:203], v[40:43], a[140:143], v[200:203]
v_rcp_f32 v214, v214
v_mul_f32 v181, v213, v181
v_mul_f32 v212, v188, v188
v_mfma_f32_16x16x32_bf16 v[196:199], v[44:47], a[136:139], v[196:199]
ds_read_b128 v[40:43], v7 offset:20480
global_load_lds_dwordx4 v4, s[20:21] offset:1024 sc1
v_mfma_f32_16x16x32_bf16 v[204:207], v[44:47], a[140:143], v[204:207]
v_exp_f32 v209, v209
v_fma_f32 v211, v211, v76, v75
v_mfma_f32_16x16x32_bf16 v[80:83], v[16:19], a[136:139], v[80:83]
ds_read_b128 v[44:47], v7 offset:21504
v_mul_f32 v210, v210, v186
v_mfma_f32_16x16x32_bf16 v[88:91], v[16:19], a[140:143], v[88:91]
v_fma_f32 v208, v208, v77, v77
s_waitcnt lgkmcnt(4)
v_mfma_f32_16x16x32_bf16 v[84:87], v[20:23], a[136:139], v[84:87]
ds_read_b128 v[16:19], v7 offset:22528
global_load_lds_dwordx4 v4, s[20:21] offset:2048 sc1
v_mfma_f32_16x16x32_bf16 v[92:95], v[20:23], a[140:143], v[92:95]
v_rcp_f32 v215, v215
v_mul_f32 v182, v214, v182
v_mfma_f32_16x16x32_bf16 v[96:99], v[24:27], a[144:147], v[96:99]
ds_read_b128 v[20:23], v7 offset:23552
v_cvt_pk_bf16_f32 v242, v180, v181
v_mfma_f32_16x16x32_bf16 v[104:107], v[24:27], a[148:151], v[104:107]
v_exp_f32 v210, v210
v_mfma_f32_16x16x32_bf16 v[100:103], v[28:31], a[144:147], v[100:103]
ds_read_b128 v[24:27], v7 offset:24576
global_load_lds_dwordx4 v4, s[20:21] offset:3072 sc1
v_mfma_f32_16x16x32_bf16 v[108:111], v[28:31], a[148:151], v[108:111]
v_mul_f32 v213, v189, v189
v_fma_f32 v212, v212, v76, v75
v_mul_f32 v211, v211, v187
s_waitcnt lgkmcnt(4)
v_mfma_f32_16x16x32_bf16 v[112:115], v[32:35], a[144:147], v[112:115]
ds_read_b128 v[28:31], v7 offset:25600
v_fma_f32 v209, v209, v77, v77
v_mfma_f32_16x16x32_bf16 v[120:123], v[32:35], a[148:151], v[120:123]
v_rcp_f32 v208, v208
v_mfma_f32_16x16x32_bf16 v[116:119], v[36:39], a[144:147], v[116:119]
ds_read_b128 v[32:35], v7 offset:26624
global_load_dwordx4 a[232:235], v5, s[20:21] offset:-2048 sc1
v_mfma_f32_16x16x32_bf16 v[124:127], v[36:39], a[148:151], v[124:127]
v_mul_f32 v183, v215, v183
v_mul_f32 v214, v190, v190
v_mfma_f32_16x16x32_bf16 v[192:195], v[40:43], a[144:147], v[192:195]
ds_read_b128 v[36:39], v7 offset:27648
v_fma_f32 v213, v213, v76, v75
v_mfma_f32_16x16x32_bf16 v[200:203], v[40:43], a[148:151], v[200:203]
v_mul_f32 v212, v212, v188
s_waitcnt lgkmcnt(4)
v_mfma_f32_16x16x32_bf16 v[196:199], v[44:47], a[144:147], v[196:199]
ds_read_b128 v[40:43], v7 offset:28672
global_load_dwordx4 a[236:239], v5, s[20:21] offset:-1024 sc1
v_mfma_f32_16x16x32_bf16 v[204:207], v[44:47], a[148:151], v[204:207]
v_exp_f32 v211, v211
v_fma_f32 v210, v210, v77, v77
v_mfma_f32_16x16x32_bf16 v[80:83], v[16:19], a[144:147], v[80:83]
ds_read_b128 v[44:47], v7 offset:29696
v_mul_f32 v184, v208, v184
v_mfma_f32_16x16x32_bf16 v[88:91], v[16:19], a[148:151], v[88:91]
v_rcp_f32 v209, v209
v_cvt_pk_bf16_f32 v243, v182, v183
v_mfma_f32_16x16x32_bf16 v[84:87], v[20:23], a[144:147], v[84:87]
ds_read_b128 v[16:19], v7 offset:30720
global_load_dwordx4 a[240:243], v5, s[20:21] offset:0 sc1
v_mfma_f32_16x16x32_bf16 v[92:95], v[20:23], a[148:151], v[92:95]
v_mul_f32 v215, v191, v191
v_fma_f32 v214, v214, v76, v75
v_mul_f32 v213, v213, v189
s_waitcnt lgkmcnt(3)
v_mfma_f32_16x16x32_bf16 v[96:99], v[24:27], a[152:155], v[96:99]
ds_read_b128 v[20:23], v7 offset:31744
v_mfma_f32_16x16x32_bf16 v[104:107], v[24:27], a[156:159], v[104:107]
s_atomic_add s59, s[20:21], s57 offset:168 glc
v_fma_f32 v211, v211, v77, v77
v_mfma_f32_16x16x32_bf16 v[100:103], v[28:31], a[152:155], v[100:103]
s_barrier
ds_read_b128 v[24:27], v7 offset:32768
v_mfma_f32_16x16x32_bf16 v[108:111], v[28:31], a[156:159], v[108:111]
global_load_dwordx4 a[244:247], v5, s[20:21] offset:1024 sc1
v_mul_f32 v185, v209, v185
v_mfma_f32_16x16x32_bf16 v[112:115], v[32:35], a[152:155], v[112:115]
ds_read_b128 v[28:31], v7 offset:33792
v_fma_f32 v215, v215, v76, v75
v_mfma_f32_16x16x32_bf16 v[120:123], v[32:35], a[156:159], v[120:123]
v_exp_f32 v212, v212
v_mfma_f32_16x16x32_bf16 v[116:119], v[36:39], a[152:155], v[116:119]
ds_read_b128 v[32:35], v7 offset:34816
global_load_dwordx4 a[248:251], v5, s[20:21] offset:2048 sc1
v_mfma_f32_16x16x32_bf16 v[124:127], v[36:39], a[156:159], v[124:127]
v_mul_f32 v214, v214, v190
v_rcp_f32 v210, v210
s_waitcnt lgkmcnt(4)
v_mfma_f32_16x16x32_bf16 v[192:195], v[40:43], a[152:155], v[192:195]
ds_read_b128 v[36:39], v7 offset:35840
v_fma_f32 v212, v212, v77, v77
v_mfma_f32_16x16x32_bf16 v[200:203], v[40:43], a[156:159], v[200:203]
v_exp_f32 v213, v213
v_mfma_f32_16x16x32_bf16 v[196:199], v[44:47], a[152:155], v[196:199]
ds_read_b128 v[40:43], v7 offset:36864
global_load_dwordx4 a[252:255], v5, s[20:21] offset:3072 sc1
v_mfma_f32_16x16x32_bf16 v[204:207], v[44:47], a[156:159], v[204:207]
v_rcp_f32 v211, v211
v_mul_f32 v186, v210, v186
v_mfma_f32_16x16x32_bf16 v[80:83], v[16:19], a[152:155], v[80:83]
ds_read_b128 v[44:47], v7 offset:37888
v_cvt_pk_bf16_f32 v244, v184, v185
v_mfma_f32_16x16x32_bf16 v[88:91], v[16:19], a[156:159], v[88:91]
v_mul_f32 v215, v215, v191
s_waitcnt lgkmcnt(4)
v_mfma_f32_16x16x32_bf16 v[84:87], v[20:23], a[152:155], v[84:87]
ds_read_b128 v[16:19], v7 offset:38912
v_fma_f32 v213, v213, v77, v77
v_mfma_f32_16x16x32_bf16 v[92:95], v[20:23], a[156:159], v[92:95]
v_exp_f32 v214, v214
v_mfma_f32_16x16x32_bf16 v[96:99], v[24:27], a[160:163], v[96:99]
ds_read_b128 v[20:23], v7 offset:39936
s_add_u32 m0, s43, 65536
v_mfma_f32_16x16x32_bf16 v[104:107], v[24:27], a[164:167], v[104:107]
v_add_u32 v4, 16384, v4
v_mul_f32 v187, v211, v187
v_rcp_f32 v212, v212
v_mfma_f32_16x16x32_bf16 v[100:103], v[28:31], a[160:163], v[100:103]
ds_read_b128 v[24:27], v7 offset:40960
global_load_lds_dwordx4 v4, s[20:21] offset:0 sc1
v_mfma_f32_16x16x32_bf16 v[108:111], v[28:31], a[164:167], v[108:111]
global_load_lds_dwordx4 v4, s[20:21] offset:1024 sc1
v_exp_f32 v215, v215
v_fma_f32 v214, v214, v77, v77
s_waitcnt lgkmcnt(4)
v_mfma_f32_16x16x32_bf16 v[112:115], v[32:35], a[160:163], v[112:115]
ds_read_b128 v[28:31], v7 offset:41984
v_mul_f32 v188, v212, v188
v_mfma_f32_16x16x32_bf16 v[120:123], v[32:35], a[164:167], v[120:123]
v_rcp_f32 v213, v213
v_mfma_f32_16x16x32_bf16 v[116:119], v[36:39], a[160:163], v[116:119]
ds_read_b128 v[32:35], v7 offset:43008
global_load_lds_dwordx4 v4, s[20:21] offset:2048 sc1
v_mfma_f32_16x16x32_bf16 v[124:127], v[36:39], a[164:167], v[124:127]
v_rcp_f32 v214, v214
v_cvt_pk_bf16_f32 v245, v186, v187
v_mfma_f32_16x16x32_bf16 v[192:195], v[40:43], a[160:163], v[192:195]
ds_read_b128 v[36:39], v7 offset:44032
v_fma_f32 v215, v215, v77, v77
v_mfma_f32_16x16x32_bf16 v[200:203], v[40:43], a[164:167], v[200:203]
v_mul_f32 v189, v213, v189
s_waitcnt lgkmcnt(4)
v_mfma_f32_16x16x32_bf16 v[196:199], v[44:47], a[160:163], v[196:199]
ds_read_b128 v[40:43], v7 offset:45056
global_load_lds_dwordx4 v4, s[20:21] offset:3072 sc1
v_mfma_f32_16x16x32_bf16 v[204:207], v[44:47], a[164:167], v[204:207]
v_rcp_f32 v215, v215
v_mul_f32 v190, v214, v190
v_cvt_pk_bf16_f32 v246, v188, v189
v_mfma_f32_16x16x32_bf16 v[80:83], v[16:19], a[160:163], v[80:83]
ds_read_b128 v[44:47], v7 offset:46080
s_getpc_b64 s[4:5]
v_mfma_f32_16x16x32_bf16 v[88:91], v[16:19], a[164:167], v[88:91]
global_load_dword v13, v12, s[4:5]
v_mul_f32 v191, v215, v191
v_cvt_pk_bf16_f32 v247, v190, v191
s_add_u32 s38, s47, 39944192
v_mfma_f32_16x16x32_bf16 v[84:87], v[20:23], a[160:163], v[84:87]
ds_read_b128 v[16:19], v7 offset:47104
buffer_store_dwordx4 v[240:243], v0, s[20:23], s38 offen offset:0 sc1
buffer_store_dwordx4 v[244:247], v0, s[20:23], s38 offen offset:1024 sc1
v_mfma_f32_16x16x32_bf16 v[92:95], v[20:23], a[164:167], v[92:95]
v_add_u32 v5, 8192, v5
s_mov_b32 s58, 0
s_waitcnt lgkmcnt(4)
v_mfma_f32_16x16x32_bf16 v[96:99], v[24:27], a[168:171], v[96:99]
ds_read_b128 v[20:23], v7 offset:48128
global_load_dwordx4 a[0:3], v5, s[20:21] offset:-4096 sc1
v_mfma_f32_16x16x32_bf16 v[104:107], v[24:27], a[172:175], v[104:107]
s_cmp_lt_u32 s59, 8
s_cbranch_scc0 L_back11
L_slow11:
s_waitcnt lgkmcnt(0)
s_cmp_ge_u32 s59, 8
s_cbranch_scc1 L_back11
s_mov_b32 s59, 0
s_atomic_add s59, s[20:21], s57 offset:168 glc
s_sub_u32 s46, s46, 1
s_cbranch_scc0 L_slow11
s_endpgm
L_back11:
s_add_u32 s41, s52, 0
v_mfma_f32_16x16x32_bf16 v[100:103], v[28:31], a[168:171], v[100:103]
s_barrier
ds_read_b128 v[24:27], v7 offset:49152
v_mfma_f32_16x16x32_bf16 v[108:111], v[28:31], a[172:175], v[108:111]
s_add_u32 s37, s51, 0
v_mfma_f32_16x16x32_bf16 v[112:115], v[32:35], a[168:171], v[112:115]
ds_read_b128 v[28:31], v7 offset:50176
v_mfma_f32_16x16x32_bf16 v[120:123], v[32:35], a[172:175], v[120:123]
s_waitcnt lgkmcnt(3)
v_mfma_f32_16x16x32_bf16 v[116:119], v[36:39], a[168:171], v[116:119]
ds_read_b128 v[32:35], v7 offset:51200
v_mfma_f32_16x16x32_bf16 v[124:127], v[36:39], a[172:175], v[124:127]
v_mfma_f32_16x16x32_bf16 v[192:195], v[40:43], a[168:171], v[192:195]
ds_read_b128 v[36:39], v7 offset:52224
v_mfma_f32_16x16x32_bf16 v[200:203], v[40:43], a[172:175], v[200:203]
v_mfma_f32_16x16x32_bf16 v[196:199], v[44:47], a[168:171], v[196:199]
ds_read_b128 v[40:43], v7 offset:53248
global_load_dwordx4 a[4:7], v5, s[20:21] offset:-3072 sc1
v_mfma_f32_16x16x32_bf16 v[204:207], v[44:47], a[172:175], v[204:207]
v_mfma_f32_16x16x32_bf16 v[80:83], v[16:19], a[168:171], v[80:83]
ds_read_b128 v[44:47], v7 offset:54272
v_mfma_f32_16x16x32_bf16 v[88:91], v[16:19], a[172:175], v[88:91]
s_waitcnt lgkmcnt(3)
v_mfma_f32_16x16x32_bf16 v[84:87], v[20:23], a[168:171], v[84:87]
ds_read_b128 v[16:19], v7 offset:55296
global_load_dwordx4 a[8:11], v5, s[20:21] offset:-2048 sc1
v_mfma_f32_16x16x32_bf16 v[92:95], v[20:23], a[172:175], v[92:95]
v_mfma_f32_16x16x32_bf16 v[96:99], v[24:27], a[176:179], v[96:99]
ds_read_b128 v[20:23], v7 offset:56320
v_mfma_f32_16x16x32_bf16 v[104:107], v[24:27], a[180:183], v[104:107]
v_mfma_f32_16x16x32_bf16 v[100:103], v[28:31], a[176:179], v[100:103]
ds_read_b128 v[24:27], v7 offset:57344
global_load_dwordx4 a[12:15], v5, s[20:21] offset:-1024 sc1
v_mfma_f32_16x16x32_bf16 v[108:111], v[28:31], a[180:183], v[108:111]
v_mfma_f32_16x16x32_bf16 v[112:115], v[32:35], a[176:179], v[112:115]
ds_read_b128 v[28:31], v7 offset:58368
v_mfma_f32_16x16x32_bf16 v[120:123], v[32:35], a[180:183], v[120:123]
s_waitcnt lgkmcnt(3)
v_mfma_f32_16x16x32_bf16 v[116:119], v[36:39], a[176:179], v[116:119]
ds_read_b128 v[32:35], v7 offset:59392
v_mfma_f32_16x16x32_bf16 v[124:127], v[36:39], a[180:183], v[124:127]
v_mfma_f32_16x16x32_bf16 v[192:195], v[40:43], a[176:179], v[192:195]
ds_read_b128 v[36:39], v7 offset:60416
global_load_dwordx4 a[16:19], v5, s[20:21] offset:0 sc1
v_mfma_f32_16x16x32_bf16 v[200:203], v[40:43], a[180:183], v[200:203]
v_mfma_f32_16x16x32_bf16 v[196:199], v[44:47], a[176:179], v[196:199]
ds_read_b128 v[40:43], v7 offset:61440
v_mfma_f32_16x16x32_bf16 v[204:207], v[44:47], a[180:183], v[204:207]
v_mfma_f32_16x16x32_bf16 v[80:83], v[16:19], a[176:179], v[80:83]
ds_read_b128 v[44:47], v7 offset:62464
global_load_dwordx4 a[20:23], v5, s[20:21] offset:1024 sc1
v_mfma_f32_16x16x32_bf16 v[88:91], v[16:19], a[180:183], v[88:91]
s_waitcnt lgkmcnt(3)
v_mfma_f32_16x16x32_bf16 v[84:87], v[20:23], a[176:179], v[84:87]
ds_read_b128 v[16:19], v7 offset:63488
v_mfma_f32_16x16x32_bf16 v[92:95], v[20:23], a[180:183], v[92:95]
v_mfma_f32_16x16x32_bf16 v[96:99], v[24:27], a[184:187], v[96:99]
ds_read_b128 v[20:23], v7 offset:64512
global_load_dwordx4 a[24:27], v5, s[20:21] offset:2048 sc1
v_mfma_f32_16x16x32_bf16 v[104:107], v[24:27], a[188:191], v[104:107]
v_mfma_f32_16x16x32_bf16 v[100:103], v[28:31], a[184:187], v[100:103]
s_barrier
ds_read_b128 v[24:27], v6 offset:0
v_mfma_f32_16x16x32_bf16 v[108:111], v[28:31], a[188:191], v[108:111]
v_mfma_f32_16x16x32_bf16 v[112:115], v[32:35], a[184:187], v[112:115]
ds_read_b128 v[28:31], v6 offset:1024
global_load_dwordx4 a[28:31], v5, s[20:21] offset:3072 sc1
v_mfma_f32_16x16x32_bf16 v[120:123], v[32:35], a[188:191], v[120:123]
s_waitcnt lgkmcnt(3)
v_mfma_f32_16x16x32_bf16 v[116:119], v[36:39], a[184:187], v[116:119]
ds_read_b128 v[32:35], v6 offset:2048
v_mfma_f32_16x16x32_bf16 v[124:127], v[36:39], a[188:191], v[124:127]
s_waitcnt vmcnt(8)
s_atomic_add s45, s[20:21], s57 offset:176
v_mfma_f32_16x16x32_bf16 v[192:195], v[40:43], a[184:187], v[192:195]
ds_read_b128 v[36:39], v6 offset:3072
v_mfma_f32_16x16x32_bf16 v[200:203], v[40:43], a[188:191], v[200:203]
v_mfma_f32_16x16x32_bf16 v[196:199], v[44:47], a[184:187], v[196:199]
ds_read_b128 v[40:43], v6 offset:4096
s_add_u32 m0, s43, 81920
v_mfma_f32_16x16x32_bf16 v[204:207], v[44:47], a[188:191], v[204:207]
v_add_u32 v4, 16384, v4
v_mfma_f32_16x16x32_bf16 v[80:83], v[16:19], a[184:187], v[80:83]
ds_read_b128 v[44:47], v6 offset:5120
global_load_lds_dwordx4 v4, s[20:21] offset:0 sc1
v_mfma_f32_16x16x32_bf16 v[88:91], v[16:19], a[188:191], v[88:91]
s_waitcnt lgkmcnt(4)
v_mfma_f32_16x16x32_bf16 v[84:87], v[20:23], a[184:187], v[84:87]
ds_read_b128 v[16:19], v6 offset:6144
global_load_lds_dwordx4 v4, s[20:21] offset:1024 sc1
v_mfma_f32_16x16x32_bf16 v[92:95], v[20:23], a[188:191], v[92:95]
v_mfma_f32_16x16x32_bf16 v[96:99], v[24:27], a[192:195], v[96:99]
ds_read_b128 v[20:23], v6 offset:7168
v_mfma_f32_16x16x32_bf16 v[104:107], v[24:27], a[196:199], v[104:107]
v_mfma_f32_16x16x32_bf16 v[100:103], v[28:31], a[192:195], v[100:103]
ds_read_b128 v[24:27], v6 offset:8192
global_load_lds_dwordx4 v4, s[20:21] offset:2048 sc1
v_mfma_f32_16x16x32_bf16 v[108:111], v[28:31], a[196:199], v[108:111]
s_waitcnt lgkmcnt(4)
v_mfma_f32_16x16x32_bf16 v[112:115], v[32:35], a[192:195], v[112:115]
ds_read_b128 v[28:31], v6 offset:9216
v_mfma_f32_16x16x32_bf16 v[120:123], v[32:35], a[196:199], v[120:123]
v_mfma_f32_16x16x32_bf16 v[116:119], v[36:39], a[192:195], v[116:119]
ds_read_b128 v[32:35], v6 offset:10240
global_load_lds_dwordx4 v4, s[20:21] offset:3072 sc1
v_mfma_f32_16x16x32_bf16 v[124:127], v[36:39], a[196:199], v[124:127]
v_mfma_f32_16x16x32_bf16 v[192:195], v[40:43], a[192:195], v[192:195]
ds_read_b128 v[36:39], v6 offset:11264
v_mfma_f32_16x16x32_bf16 v[200:203], v[40:43], a[196:199], v[200:203]
s_waitcnt lgkmcnt(4)
v_mfma_f32_16x16x32_bf16 v[196:199], v[44:47], a[192:195], v[196:199]
ds_read_b128 v[40:43], v6 offset:12288
v_mfma_f32_16x16x32_bf16 v[204:207], v[44:47], a[196:199], v[204:207]
v_mfma_f32_16x16x32_bf16 v[80:83], v[16:19], a[192:195], v[80:83]
ds_read_b128 v[44:47], v6 offset:13312
v_add_u32 v5, 8192, v5
v_mfma_f32_16x16x32_bf16 v[88:91], v[16:19], a[196:199], v[88:91]
global_load_dwordx4 a[32:35], v5, s[20:21] offset:-4096 sc1
v_mfma_f32_16x16x32_bf16 v[84:87], v[20:23], a[192:195], v[84:87]
ds_read_b128 v[16:19], v6 offset:14336
v_mfma_f32_16x16x32_bf16 v[92:95], v[20:23], a[196:199], v[92:95]
s_waitcnt lgkmcnt(4)
v_mfma_f32_16x16x32_bf16 v[96:99], v[24:27], a[200:203], v[96:99]
ds_read_b128 v[20:23], v6 offset:15360
global_load_dwordx4 a[36:39], v5, s[20:21] offset:-3072 sc1
v_mfma_f32_16x16x32_bf16 v[104:107], v[24:27], a[204:207], v[104:107]
v_mfma_f32_16x16x32_bf16 v[100:103], v[28:31], a[200:203], v[100:103]
s_barrier
ds_read_b128 v[24:27], v6 offset:16384
v_mfma_f32_16x16x32_bf16 v[108:111], v[28:31], a[204:207], v[108:111]
v_mfma_f32_16x16x32_bf16 v[112:115], v[32:35], a[200:203], v[112:115]
ds_read_b128 v[28:31], v6 offset:17408
global_load_dwordx4 a[40:43], v5, s[20:21] offset:-2048 sc1
v_mfma_f32_16x16x32_bf16 v[120:123], v[32:35], a[204:207], v[120:123]
s_waitcnt lgkmcnt(4)
v_mfma_f32_16x16x32_bf16 v[116:119], v[36:39], a[200:203], v[116:119]
ds_read_b128 v[32:35], v6 offset:18432
v_mfma_f32_16x16x32_bf16 v[124:127], v[36:39], a[204:207], v[124:127]
v_mfma_f32_16x16x32_bf16 v[192:195], v[40:43], a[200:203], v[192:195]
ds_read_b128 v[36:39], v6 offset:19456
global_load_dwordx4 a[44:47], v5, s[20:21] offset:-1024 sc1
v_mfma_f32_16x16x32_bf16 v[200:203], v[40:43], a[204:207], v[200:203]
v_mfma_f32_16x16x32_bf16 v[196:199], v[44:47], a[200:203], v[196:199]
ds_read_b128 v[40:43], v6 offset:20480
v_mfma_f32_16x16x32_bf16 v[204:207], v[44:47], a[204:207], v[204:207]
s_waitcnt lgkmcnt(4)
v_mfma_f32_16x16x32_bf16 v[80:83], v[16:19], a[200:203], v[80:83]
ds_read_b128 v[44:47], v6 offset:21504
v_mfma_f32_16x16x32_bf16 v[88:91], v[16:19], a[204:207], v[88:91]
v_mfma_f32_16x16x32_bf16 v[84:87], v[20:23], a[200:203], v[84:87]
ds_read_b128 v[16:19], v6 offset:22528
global_load_dwordx4 a[48:51], v5, s[20:21] offset:0 sc1
v_mfma_f32_16x16x32_bf16 v[92:95], v[20:23], a[204:207], v[92:95]
v_mfma_f32_16x16x32_bf16 v[96:99], v[24:27], a[208:211], v[96:99]
ds_read_b128 v[20:23], v6 offset:23552
v_mfma_f32_16x16x32_bf16 v[104:107], v[24:27], a[212:215], v[104:107]
s_waitcnt lgkmcnt(4)
v_mfma_f32_16x16x32_bf16 v[100:103], v[28:31], a[208:211], v[100:103]
ds_read_b128 v[24:27], v6 offset:24576
global_load_dwordx4 a[52:55], v5, s[20:21] offset:1024 sc1
v_mfma_f32_16x16x32_bf16 v[108:111], v[28:31], a[212:215], v[108:111]
v_mfma_f32_16x16x32_bf16 v[112:115], v[32:35], a[208:211], v[112:115]
ds_read_b128 v[28:31], v6 offset:25600
v_mfma_f32_16x16x32_bf16 v[120:123], v[32:35], a[212:215], v[120:123]
v_mfma_f32_16x16x32_bf16 v[116:119], v[36:39], a[208:211], v[116:119]
ds_read_b128 v[32:35], v6 offset:26624
global_load_dwordx4 a[56:59], v5, s[20:21] offset:2048 sc1
v_mfma_f32_16x16x32_bf16 v[124:127], v[36:39], a[212:215], v[124:127]
s_waitcnt lgkmcnt(3)
v_mfma_f32_16x16x32_bf16 v[192:195], v[40:43], a[208:211], v[192:195]
ds_read_b128 v[36:39], v6 offset:27648
v_mfma_f32_16x16x32_bf16 v[200:203], v[40:43], a[212:215], v[200:203]
s_atomic_add s58, s[20:21], s57 offset:176 glc
v_mfma_f32_16x16x32_bf16 v[196:199], v[44:47], a[208:211], v[196:199]
ds_read_b128 v[40:43], v6 offset:28672
global_load_dwordx4 a[60:63], v5, s[20:21] offset:3072 sc1
v_mfma_f32_16x16x32_bf16 v[204:207], v[44:47], a[212:215], v[204:207]
v_mfma_f32_16x16x32_bf16 v[80:83], v[16:19], a[208:211], v[80:83]
ds_read_b128 v[44:47], v6 offset:29696
v_mfma_f32_16x16x32_bf16 v[88:91], v[16:19], a[212:215], v[88:91]
v_mfma_f32_16x16x32_bf16 v[84:87], v[20:23], a[208:211], v[84:87]
ds_read_b128 v[16:19], v6 offset:30720
v_mfma_f32_16x16x32_bf16 v[92:95], v[20:23], a[212:215], v[92:95]
s_waitcnt lgkmcnt(4)
v_mfma_f32_16x16x32_bf16 v[96:99], v[24:27], a[216:219], v[96:99]
ds_read_b128 v[20:23], v6 offset:31744
s_add_u32 m0, s43, 98304
v_mfma_f32_16x16x32_bf16 v[104:107], v[24:27], a[220:223], v[104:107]
v_add_u32 v4, 16384, v4
v_mfma_f32_16x16x32_bf16 v[100:103], v[28:31], a[216:219], v[100:103]
s_barrier
ds_read_b128 v[24:27], v6 offset:32768
v_mfma_f32_16x16x32_bf16 v[108:111], v[28:31], a[220:223], v[108:111]
global_load_lds_dwordx4 v4, s[20:21] offset:0 sc1
v_mfma_f32_16x16x32_bf16 v[112:115], v[32:35], a[216:219], v[112:115]
ds_read_b128 v[28:31], v6 offset:33792
global_load_lds_dwordx4 v4, s[20:21] offset:1024 sc1
v_mfma_f32_16x16x32_bf16 v[120:123], v[32:35], a[220:223], v[120:123]
s_waitcnt lgkmcnt(4)
v_mfma_f32_16x16x32_bf16 v[116:119], v[36:39], a[216:219], v[116:119]
ds_read_b128 v[32:35], v6 offset:34816
v_mfma_f32_16x16x32_bf16 v[124:127], v[36:39], a[220:223], v[124:127]
v_mfma_f32_16x16x32_bf16 v[192:195], v[40:43], a[216:219], v[192:195]
ds_read_b128 v[36:39], v6 offset:35840
global_load_lds_dwordx4 v4, s[20:21] offset:2048 sc1
v_mfma_f32_16x16x32_bf16 v[200:203], v[40:43], a[220:223], v[200:203]
v_mfma_f32_16x16x32_bf16 v[196:199], v[44:47], a[216:219], v[196:199]
ds_read_b128 v[40:43], v6 offset:36864
v_mfma_f32_16x16x32_bf16 v[204:207], v[44:47], a[220:223], v[204:207]
s_waitcnt lgkmcnt(4)
v_mfma_f32_16x16x32_bf16 v[80:83], v[16:19], a[216:219], v[80:83]
ds_read_b128 v[44:47], v6 offset:37888
global_load_lds_dwordx4 v4, s[20:21] offset:3072 sc1
v_mfma_f32_16x16x32_bf16 v[88:91], v[16:19], a[220:223], v[88:91]
v_mfma_f32_16x16x32_bf16 v[84:87], v[20:23], a[216:219], v[84:87]
ds_read_b128 v[16:19], v6 offset:38912
v_mfma_f32_16x16x32_bf16 v[92:95], v[20:23], a[220:223], v[92:95]
v_mfma_f32_16x16x32_bf16 v[96:99], v[24:27], a[224:227], v[96:99]
ds_read_b128 v[20:23], v6 offset:39936
v_mfma_f32_16x16x32_bf16 v[104:107], v[24:27], a[228:231], v[104:107]
s_waitcnt lgkmcnt(4)
v_mfma_f32_16x16x32_bf16 v[100:103], v[28:31], a[224:227], v[100:103]
ds_read_b128 v[24:27], v6 offset:40960
v_add_u32 v5, 8192, v5
v_mfma_f32_16x16x32_bf16 v[108:111], v[28:31], a[228:231], v[108:111]
global_load_dwordx4 a[64:67], v5, s[20:21] offset:-4096 sc1
v_mfma_f32_16x16x32_bf16 v[112:115], v[32:35], a[224:227], v[112:115]
ds_read_b128 v[28:31], v6 offset:41984
v_mfma_f32_16x16x32_bf16 v[120:123], v[32:35], a[228:231], v[120:123]
v_mfma_f32_16x16x32_bf16 v[116:119], v[36:39], a[224:227], v[116:119]
ds_read_b128 v[32:35], v6 offset:43008
global_load_dwordx4 a[68:71], v5, s[20:21] offset:-3072 sc1
v_mfma_f32_16x16x32_bf16 v[124:127], v[36:39], a[228:231], v[124:127]
s_waitcnt lgkmcnt(4)
v_mfma_f32_16x16x32_bf16 v[192:195], v[40:43], a[224:227], v[192:195]
ds_read_b128 v[36:39], v6 offset:44032
v_mfma_f32_16x16x32_bf16 v[200:203], v[40:43], a[228:231], v[200:203]
v_mfma_f32_16x16x32_bf16 v[196:199], v[44:47], a[224:227], v[196:199]
ds_read_b128 v[40:43], v6 offset:45056
global_load_dwordx4 a[72:75], v5, s[20:21] offset:-2048 sc1
v_mfma_f32_16x16x32_bf16 v[204:207], v[44:47], a[228:231], v[204:207]
v_mfma_f32_16x16x32_bf16 v[96:99], v[16:19], a[232:235], v[96:99]
ds_read_b128 v[44:47], v6 offset:46080
v_mfma_f32_16x16x32_bf16 v[104:107], v[16:19], a[236:239], v[104:107]
s_waitcnt lgkmcnt(4)
v_mfma_f32_16x16x32_bf16 v[100:103], v[20:23], a[232:235], v[100:103]
ds_read_b128 v[16:19], v6 offset:47104
global_load_dwordx4 a[76:79], v5, s[20:21] offset:-1024 sc1
v_mfma_f32_16x16x32_bf16 v[108:111], v[20:23], a[236:239], v[108:111]
v_mfma_f32_16x16x32_bf16 v[112:115], v[24:27], a[232:235], v[112:115]
ds_read_b128 v[20:23], v6 offset:48128
v_mfma_f32_16x16x32_bf16 v[120:123], v[24:27], a[236:239], v[120:123]
v_mfma_f32_16x16x32_bf16 v[116:119], v[28:31], a[232:235], v[116:119]
s_barrier
ds_read_b128 v[24:27], v6 offset:49152
v_mfma_f32_16x16x32_bf16 v[124:127], v[28:31], a[236:239], v[124:127]
s_waitcnt lgkmcnt(4)
v_mfma_f32_16x16x32_bf16 v[192:195], v[32:35], a[232:235], v[192:195]
ds_read_b128 v[28:31], v6 offset:50176
global_load_dwordx4 a[80:83], v5, s[20:21] offset:0 sc1
v_mfma_f32_16x16x32_bf16 v[200:203], v[32:35], a[236:239], v[200:203]
v_mfma_f32_16x16x32_bf16 v[196:199], v[36:39], a[232:235], v[196:199]
ds_read_b128 v[32:35], v6 offset:51200
v_mfma_f32_16x16x32_bf16 v[204:207], v[36:39], a[236:239], v[204:207]
v_mfma_f32_16x16x32_bf16 v[96:99], v[40:43], a[240:243], v[96:99]
ds_read_b128 v[36:39], v6 offset:52224
global_load_dwordx4 a[84:87], v5, s[20:21] offset:1024 sc1
v_mfma_f32_16x16x32_bf16 v[104:107], v[40:43], a[244:247], v[104:107]
s_cmp_lt_u32 s58, 8
s_cbranch_scc0 L_back12
L_slow12:
s_waitcnt lgkmcnt(0)
s_cmp_ge_u32 s58, 8
s_cbranch_scc1 L_back12
s_mov_b32 s58, 0
s_atomic_add s58, s[20:21], s57 offset:176 glc
s_sub_u32 s46, s46, 1
s_cbranch_scc0 L_slow12
s_endpgm
L_back12:
s_waitcnt lgkmcnt(3)
v_mfma_f32_16x16x32_bf16 v[100:103], v[44:47], a[240:243], v[100:103]
ds_read_b128 v[40:43], v6 offset:53248
v_mfma_f32_16x16x32_bf16 v[108:111], v[44:47], a[244:247], v[108:111]
v_mfma_f32_16x16x32_bf16 v[112:115], v[16:19], a[240:243], v[112:115]
ds_read_b128 v[44:47], v6 offset:54272
global_load_dwordx4 a[88:91], v5, s[20:21] offset:2048 sc1
v_mfma_f32_16x16x32_bf16 v[120:123], v[16:19], a[244:247], v[120:123]
v_mfma_f32_16x16x32_bf16 v[116:119], v[20:23], a[240:243], v[116:119]
ds_read_b128 v[16:19], v6 offset:55296
v_mfma_f32_16x16x32_bf16 v[124:127], v[20:23], a[244:247], v[124:127]
v_mfma_f32_16x16x32_bf16 v[192:195], v[24:27], a[240:243], v[192:195]
ds_read_b128 v[20:23], v6 offset:56320
global_load_dwordx4 a[92:95], v5, s[20:21] offset:3072 sc1
v_mfma_f32_16x16x32_bf16 v[200:203], v[24:27], a[244:247], v[200:203]
s_waitcnt lgkmcnt(3)
v_mfma_f32_16x16x32_bf16 v[196:199], v[28:31], a[240:243], v[196:199]
ds_read_b128 v[24:27], v6 offset:57344
v_mfma_f32_16x16x32_bf16 v[204:207], v[28:31], a[244:247], v[204:207]
v_mfma_f32_16x16x32_bf16 v[96:99], v[32:35], a[248:251], v[96:99]
ds_read_b128 v[28:31], v6 offset:58368
v_mfma_f32_16x16x32_bf16 v[104:107], v[32:35], a[252:255], v[104:107]
v_mfma_f32_16x16x32_bf16 v[100:103], v[36:39], a[248:251], v[100:103]
ds_read_b128 v[32:35], v6 offset:59392
s_add_u32 m0, s43, 114688
v_mfma_f32_16x16x32_bf16 v[108:111], v[36:39], a[252:255], v[108:111]
v_add_u32 v4, 16384, v4
v_mfma_f32_16x16x32_bf16 v[112:115], v[40:43], a[248:251], v[112:115]
ds_read_b128 v[36:39], v6 offset:60416
global_load_lds_dwordx4 v4, s[20:21] offset:0 sc1
v_mfma_f32_16x16x32_bf16 v[120:123], v[40:43], a[252:255], v[120:123]
s_waitcnt vmcnt(31) lgkmcnt(3)
v_mfma_f32_16x16x32_bf16 v[116:119], v[44:47], a[248:251], v[116:119]
ds_read_b128 v[40:43], v6 offset:61440
global_load_lds_dwordx4 v4, s[20:21] offset:1024 sc1
v_mfma_f32_16x16x32_bf16 v[124:127], v[44:47], a[252:255], v[124:127]
v_mfma_f32_16x16x32_bf16 v[192:195], v[16:19], a[248:251], v[192:195]
ds_read_b128 v[44:47], v6 offset:62464
v_mfma_f32_16x16x32_bf16 v[200:203], v[16:19], a[252:255], v[200:203]
v_mfma_f32_16x16x32_bf16 v[196:199], v[20:23], a[248:251], v[196:199]
ds_read_b128 v[16:19], v6 offset:63488
global_load_lds_dwordx4 v4, s[20:21] offset:2048 sc1
v_mfma_f32_16x16x32_bf16 v[204:207], v[20:23], a[252:255], v[204:207]
v_mfma_f32_16x16x32_bf16 v[96:99], v[24:27], a[0:3], v[96:99]
ds_read_b128 v[20:23], v6 offset:64512
v_mfma_f32_16x16x32_bf16 v[104:107], v[24:27], a[4:7], v[104:107]
s_waitcnt vmcnt(31) lgkmcnt(3)
v_mfma_f32_16x16x32_bf16 v[100:103], v[28:31], a[0:3], v[100:103]
s_barrier
ds_read_b128 v[24:27], v7 offset:0
v_mfma_f32_16x16x32_bf16 v[108:111], v[28:31], a[4:7], v[108:111]
global_load_lds_dwordx4 v4, s[20:21] offset:3072 sc1
v_mfma_f32_16x16x32_bf16 v[112:115], v[32:35], a[0:3], v[112:115]
ds_read_b128 v[28:31], v7 offset:1024
v_mfma_f32_16x16x32_bf16 v[120:123], v[32:35], a[4:7], v[120:123]
v_mfma_f32_16x16x32_bf16 v[116:119], v[36:39], a[0:3], v[116:119]
ds_read_b128 v[32:35], v7 offset:2048
v_mfma_f32_16x16x32_bf16 v[124:127], v[36:39], a[4:7], v[124:127]
v_mfma_f32_16x16x32_bf16 v[96:99], v[40:43], a[8:11], v[96:99]
ds_read_b128 v[36:39], v7 offset:3072
v_add_u32 v5, 8192, v5
v_mfma_f32_16x16x32_bf16 v[104:107], v[40:43], a[12:15], v[104:107]
global_load_dwordx4 a[96:99], v5, s[20:21] offset:-4096 sc1
s_waitcnt vmcnt(31) lgkmcnt(3)
v_mfma_f32_16x16x32_bf16 v[100:103], v[44:47], a[8:11], v[100:103]
ds_read_b128 v[40:43], v7 offset:4096
v_mfma_f32_16x16x32_bf16 v[108:111], v[44:47], a[12:15], v[108:111]
v_mfma_f32_16x16x32_bf16 v[112:115], v[16:19], a[8:11], v[112:115]
ds_read_b128 v[44:47], v7 offset:5120
global_load_dwordx4 a[100:103], v5, s[20:21] offset:-3072 sc1
v_mfma_f32_16x16x32_bf16 v[120:123], v[16:19], a[12:15], v[120:123]
v_mfma_f32_16x16x32_bf16 v[116:119], v[20:23], a[8:11], v[116:119]
ds_read_b128 v[16:19], v7 offset:6144
v_mfma_f32_16x16x32_bf16 v[124:127], v[20:23], a[12:15], v[124:127]
v_mfma_f32_16x16x32_bf16 v[96:99], v[24:27], a[16:19], v[96:99]
ds_read_b128 v[20:23], v7 offset:7168
global_load_dwordx4 a[104:107], v5, s[20:21] offset:-2048 sc1
v_mfma_f32_16x16x32_bf16 v[104:107], v[24:27], a[20:23], v[104:107]
s_waitcnt vmcnt(31) lgkmcnt(3)
v_mfma_f32_16x16x32_bf16 v[100:103], v[28:31], a[16:19], v[100:103]
ds_read_b128 v[24:27], v7 offset:8192
v_mfma_f32_16x16x32_bf16 v[108:111], v[28:31], a[20:23], v[108:111]
v_mfma_f32_16x16x32_bf16 v[112:115], v[32:35], a[16:19], v[112:115]
ds_read_b128 v[28:31], v7 offset:9216
global_load_dwordx4 a[108:111], v5, s[20:21] offset:-1024 sc1
v_mfma_f32_16x16x32_bf16 v[120:123], v[32:35], a[20:23], v[120:123]
v_mfma_f32_16x16x32_bf16 v[116:119], v[36:39], a[16:19], v[116:119]
ds_read_b128 v[32:35], v7 offset:10240
v_mfma_f32_16x16x32_bf16 v[124:127], v[36:39], a[20:23], v[124:127]
v_mfma_f32_16x16x32_bf16 v[96:99], v[40:43], a[24:27], v[96:99]
ds_read_b128 v[36:39], v7 offset:11264
v_mfma_f32_16x16x32_bf16 v[104:107], v[40:43], a[28:31], v[104:107]
s_waitcnt vmcnt(26) lgkmcnt(3)
v_mfma_f32_16x16x32_bf16 v[100:103], v[44:47], a[24:27], v[100:103]
ds_read_b128 v[40:43], v7 offset:12288
global_load_dwordx4 a[112:115], v5, s[20:21] offset:0 sc1
v_mfma_f32_16x16x32_bf16 v[108:111], v[44:47], a[28:31], v[108:111]
v_mfma_f32_16x16x32_bf16 v[112:115], v[16:19], a[24:27], v[112:115]
ds_read_b128 v[44:47], v7 offset:13312
v_mfma_f32_16x16x32_bf16 v[120:123], v[16:19], a[28:31], v[120:123]
v_mfma_f32_16x16x32_bf16 v[116:119], v[20:23], a[24:27], v[116:119]
ds_read_b128 v[16:19], v7 offset:14336
global_load_dwordx4 a[116:119], v5, s[20:21] offset:1024 sc1
v_mfma_f32_16x16x32_bf16 v[124:127], v[20:23], a[28:31], v[124:127]
v_mfma_f32_16x16x32_bf16 v[96:99], v[24:27], a[32:35], v[96:99]
ds_read_b128 v[20:23], v7 offset:15360
v_mfma_f32_16x16x32_bf16 v[104:107], v[24:27], a[36:39], v[104:107]
s_waitcnt vmcnt(26) lgkmcnt(3)
v_mfma_f32_16x16x32_bf16 v[100:103], v[28:31], a[32:35], v[100:103]
s_barrier
ds_read_b128 v[24:27], v7 offset:16384
v_mfma_f32_16x16x32_bf16 v[108:111], v[28:31], a[36:39], v[108:111]
global_load_dwordx4 a[120:123], v5, s[20:21] offset:2048 sc1
v_mfma_f32_16x16x32_bf16 v[112:115], v[32:35], a[32:35], v[112:115]
ds_read_b128 v[28:31], v7 offset:17408
v_mfma_f32_16x16x32_bf16 v[120:123], v[32:35], a[36:39], v[120:123]
v_mfma_f32_16x16x32_bf16 v[116:119], v[36:39], a[32:35], v[116:119]
ds_read_b128 v[32:35], v7 offset:18432
global_load_dwordx4 a[124:127], v5, s[20:21] offset:3072 sc1
v_mfma_f32_16x16x32_bf16 v[124:127], v[36:39], a[36:39], v[124:127]
v_mfma_f32_16x16x32_bf16 v[96:99], v[40:43], a[40:43], v[96:99]
ds_read_b128 v[36:39], v7 offset:19456
v_mfma_f32_16x16x32_bf16 v[104:107], v[40:43], a[44:47], v[104:107]
s_waitcnt vmcnt(26) lgkmcnt(3)
v_mfma_f32_16x16x32_bf16 v[100:103], v[44:47], a[40:43], v[100:103]
ds_read_b128 v[40:43], v7 offset:20480
v_mfma_f32_16x16x32_bf16 v[108:111], v[44:47], a[44:47], v[108:111]
v_mfma_f32_16x16x32_bf16 v[112:115], v[16:19], a[40:43], v[112:115]
ds_read_b128 v[44:47], v7 offset:21504
s_add_u32 m0, s43, 0
v_mfma_f32_16x16x32_bf16 v[120:123], v[16:19], a[44:47], v[120:123]
v_add_u32 v4, 16384, v4
v_mfma_f32_16x16x32_bf16 v[116:119], v[20:23], a[40:43], v[116:119]
ds_read_b128 v[16:19], v7 offset:22528
global_load_lds_dwordx4 v4, s[20:21] offset:0 sc1
v_mfma_f32_16x16x32_bf16 v[124:127], v[20:23], a[44:47], v[124:127]
v_mfma_f32_16x16x32_bf16 v[96:99], v[24:27], a[48:51], v[96:99]
ds_read_b128 v[20:23], v7 offset:23552
global_load_lds_dwordx4 v4, s[20:21] offset:1024 sc1
v_mfma_f32_16x16x32_bf16 v[104:107], v[24:27], a[52:55], v[104:107]
s_waitcnt vmcnt(26) lgkmcnt(3)
v_mfma_f32_16x16x32_bf16 v[100:103], v[28:31], a[48:51], v[100:103]
ds_read_b128 v[24:27], v7 offset:24576
v_mfma_f32_16x16x32_bf16 v[108:111], v[28:31], a[52:55], v[108:111]
v_mfma_f32_16x16x32_bf16 v[112:115], v[32:35], a[48:51], v[112:115]
ds_read_b128 v[28:31], v7 offset:25600
global_load_lds_dwordx4 v4, s[20:21] offset:2048 sc1
v_mfma_f32_16x16x32_bf16 v[120:123], v[32:35], a[52:55], v[120:123]
v_mfma_f32_16x16x32_bf16 v[116:119], v[36:39], a[48:51], v[116:119]
ds_read_b128 v[32:35], v7 offset:26624
v_mfma_f32_16x16x32_bf16 v[124:127], v[36:39], a[52:55], v[124:127]
v_mfma_f32_16x16x32_bf16 v[96:99], v[40:43], a[56:59], v[96:99]
ds_read_b128 v[36:39], v7 offset:27648
global_load_lds_dwordx4 v4, s[20:21] offset:3072 sc1
v_mfma_f32_16x16x32_bf16 v[104:107], v[40:43], a[60:63], v[104:107]
s_waitcnt vmcnt(22) lgkmcnt(3)
v_mfma_f32_16x16x32_bf16 v[100:103], v[44:47], a[56:59], v[100:103]
ds_read_b128 v[40:43], v7 offset:28672
v_mfma_f32_16x16x32_bf16 v[108:111], v[44:47], a[60:63], v[108:111]
v_mfma_f32_16x16x32_bf16 v[112:115], v[16:19], a[56:59], v[112:115]
ds_read_b128 v[44:47], v7 offset:29696
v_mfma_f32_16x16x32_bf16 v[120:123], v[16:19], a[60:63], v[120:123]
v_mfma_f32_16x16x32_bf16 v[116:119], v[20:23], a[56:59], v[116:119]
ds_read_b128 v[16:19], v7 offset:30720
v_add_u32 v5, 8192, v5
v_mfma_f32_16x16x32_bf16 v[124:127], v[20:23], a[60:63], v[124:127]
global_load_dwordx4 a[128:131], v5, s[20:21] offset:-4096 sc1
v_mfma_f32_16x16x32_bf16 v[96:99], v[24:27], a[64:67], v[96:99]
ds_read_b128 v[20:23], v7 offset:31744
v_mfma_f32_16x16x32_bf16 v[104:107], v[24:27], a[68:71], v[104:107]
s_waitcnt vmcnt(21) lgkmcnt(3)
v_mfma_f32_16x16x32_bf16 v[100:103], v[28:31], a[64:67], v[100:103]
s_barrier
ds_read_b128 v[24:27], v7 offset:32768
v_mfma_f32_16x16x32_bf16 v[108:111], v[28:31], a[68:71], v[108:111]
global_load_dwordx4 a[132:135], v5, s[20:21] offset:-3072 sc1
v_mfma_f32_16x16x32_bf16 v[112:115], v[32:35], a[64:67], v[112:115]
ds_read_b128 v[28:31], v7 offset:33792
v_mfma_f32_16x16x32_bf16 v[120:123], v[32:35], a[68:71], v[120:123]
v_mfma_f32_16x16x32_bf16 v[116:119], v[36:39], a[64:67], v[116:119]
ds_read_b128 v[32:35], v7 offset:34816
global_load_dwordx4 a[136:139], v5, s[20:21] offset:-2048 sc1
v_mfma_f32_16x16x32_bf16 v[124:127], v[36:39], a[68:71], v[124:127]
v_mfma_f32_16x16x32_bf16 v[96:99], v[40:43], a[72:75], v[96:99]
ds_read_b128 v[36:39], v7 offset:35840
v_mfma_f32_16x16x32_bf16 v[104:107], v[40:43], a[76:79], v[104:107]
s_waitcnt vmcnt(21) lgkmcnt(3)
v_mfma_f32_16x16x32_bf16 v[100:103], v[44:47], a[72:75], v[100:103]
ds_read_b128 v[40:43], v7 offset:36864
global_load_dwordx4 a[140:143], v5, s[20:21] offset:-1024 sc1
v_mfma_f32_16x16x32_bf16 v[108:111], v[44:47], a[76:79], v[108:111]
v_mfma_f32_16x16x32_bf16 v[112:115], v[16:19], a[72:75], v[112:115]
ds_read_b128 v[44:47], v7 offset:37888
v_mfma_f32_16x16x32_bf16 v[120:123], v[16:19], a[76:79], v[120:123]
v_mfma_f32_16x16x32_bf16 v[116:119], v[20:23], a[72:75], v[116:119]
ds_read_b128 v[16:19], v7 offset:38912
v_mfma_f32_16x16x32_bf16 v[124:127], v[20:23], a[76:79], v[124:127]
v_mfma_f32_16x16x32_bf16 v[96:99], v[24:27], a[80:83], v[96:99]
ds_read_b128 v[20:23], v7 offset:39936
global_load_dwordx4 a[144:147], v5, s[20:21] offset:0 sc1
v_mfma_f32_16x16x32_bf16 v[104:107], v[24:27], a[84:87], v[104:107]
s_waitcnt vmcnt(21) lgkmcnt(3)
v_mfma_f32_16x16x32_bf16 v[100:103], v[28:31], a[80:83], v[100:103]
ds_read_b128 v[24:27], v7 offset:40960
v_mfma_f32_16x16x32_bf16 v[108:111], v[28:31], a[84:87], v[108:111]
v_mfma_f32_16x16x32_bf16 v[112:115], v[32:35], a[80:83], v[112:115]
ds_read_b128 v[28:31], v7 offset:41984
global_load_dwordx4 a[148:151], v5, s[20:21] offset:1024 sc1
v_mfma_f32_16x16x32_bf16 v[120:123], v[32:35], a[84:87], v[120:123]
v_mfma_f32_16x16x32_bf16 v[116:119], v[36:39], a[80:83], v[116:119]
ds_read_b128 v[32:35], v7 offset:43008
v_mfma_f32_16x16x32_bf16 v[124:127], v[36:39], a[84:87], v[124:127]
v_mfma_f32_16x16x32_bf16 v[96:99], v[40:43], a[88:91], v[96:99]
ds_read_b128 v[36:39], v7 offset:44032
global_load_dwordx4 a[152:155], v5, s[20:21] offset:2048 sc1
v_mfma_f32_16x16x32_bf16 v[104:107], v[40:43], a[92:95], v[104:107]
s_waitcnt vmcnt(17) lgkmcnt(3)
v_mfma_f32_16x16x32_bf16 v[100:103], v[44:47], a[88:91], v[100:103]
ds_read_b128 v[40:43], v7 offset:45056
v_mfma_f32_16x16x32_bf16 v[108:111], v[44:47], a[92:95], v[108:111]
v_mfma_f32_16x16x32_bf16 v[112:115], v[16:19], a[88:91], v[112:115]
ds_read_b128 v[44:47], v7 offset:46080
global_load_dwordx4 a[156:159], v5, s[20:21] offset:3072 sc1
v_mfma_f32_16x16x32_bf16 v[120:123], v[16:19], a[92:95], v[120:123]
v_mfma_f32_16x16x32_bf16 v[116:119], v[20:23], a[88:91], v[116:119]
ds_read_b128 v[16:19], v7 offset:47104
v_mfma_f32_16x16x32_bf16 v[124:127], v[20:23], a[92:95], v[124:127]
v_mfma_f32_16x16x32_bf16 v[96:99], v[24:27], a[96:99], v[96:99]
ds_read_b128 v[20:23], v7 offset:48128
v_mfma_f32_16x16x32_bf16 v[104:107], v[24:27], a[100:103], v[104:107]
v_add_u32 v5, 8192, v5
s_waitcnt vmcnt(16) lgkmcnt(3)
v_mfma_f32_16x16x32_bf16 v[100:103], v[28:31], a[96:99], v[100:103]
s_barrier
ds_read_b128 v[24:27], v7 offset:49152
v_mfma_f32_16x16x32_bf16 v[108:111], v[28:31], a[100:103], v[108:111]
global_load_dwordx4 a[160:163], v5, s[20:21] offset:-4096 sc1
global_load_dwordx4 a[164:167], v5, s[20:21] offset:-3072 sc1
v_mfma_f32_16x16x32_bf16 v[112:115], v[32:35], a[96:99], v[112:115]
ds_read_b128 v[28:31], v7 offset:50176
v_mfma_f32_16x16x32_bf16 v[120:123], v[32:35], a[100:103], v[120:123]
global_load_dwordx4 a[168:171], v5, s[20:21] offset:-2048 sc1
global_load_dwordx4 a[172:175], v5, s[20:21] offset:-1024 sc1
v_mfma_f32_16x16x32_bf16 v[116:119], v[36:39], a[96:99], v[116:119]
ds_read_b128 v[32:35], v7 offset:51200
v_mfma_f32_16x16x32_bf16 v[124:127], v[36:39], a[100:103], v[124:127]
v_mfma_f32_16x16x32_bf16 v[96:99], v[40:43], a[104:107], v[96:99]
ds_read_b128 v[36:39], v7 offset:52224
v_mfma_f32_16x16x32_bf16 v[104:107], v[40:43], a[108:111], v[104:107]
global_load_dwordx4 a[176:179], v5, s[20:21] offset:0 sc1
s_waitcnt vmcnt(19) lgkmcnt(3)
v_mfma_f32_16x16x32_bf16 v[100:103], v[44:47], a[104:107], v[100:103]
ds_read_b128 v[40:43], v7 offset:53248
global_load_dwordx4 a[180:183], v5, s[20:21] offset:1024 sc1
v_mfma_f32_16x16x32_bf16 v[108:111], v[44:47], a[108:111], v[108:111]
s_add_u32 m0, s43, 16384
v_add_u32 v4, 16384, v4
v_mfma_f32_16x16x32_bf16 v[112:115], v[16:19], a[104:107], v[112:115]
ds_read_b128 v[44:47], v7 offset:54272
global_load_lds_dwordx4 v4, s[20:21] offset:0 sc1
v_mfma_f32_16x16x32_bf16 v[120:123], v[16:19], a[108:111], v[120:123]
global_load_lds_dwordx4 v4, s[20:21] offset:1024 sc1
global_load_lds_dwordx4 v4, s[20:21] offset:2048 sc1
v_mfma_f32_16x16x32_bf16 v[116:119], v[20:23], a[104:107], v[116:119]
ds_read_b128 v[16:19], v7 offset:55296
global_load_lds_dwordx4 v4, s[20:21] offset:3072 sc1
v_mfma_f32_16x16x32_bf16 v[124:127], v[20:23], a[108:111], v[124:127]
global_load_dwordx4 a[184:187], v5, s[20:21] offset:2048 sc1
global_load_dwordx4 a[188:191], v5, s[20:21] offset:3072 sc1
v_mfma_f32_16x16x32_bf16 v[96:99], v[24:27], a[112:115], v[96:99]
ds_read_b128 v[20:23], v7 offset:56320
v_mfma_f32_16x16x32_bf16 v[104:107], v[24:27], a[116:119], v[104:107]
s_waitcnt vmcnt(24) lgkmcnt(3)
v_mfma_f32_16x16x32_bf16 v[100:103], v[28:31], a[112:115], v[100:103]
ds_read_b128 v[24:27], v7 offset:57344
v_mfma_f32_16x16x32_bf16 v[108:111], v[28:31], a[116:119], v[108:111]
v_mfma_f32_16x16x32_bf16 v[112:115], v[32:35], a[112:115], v[112:115]
ds_read_b128 v[28:31], v7 offset:58368
v_mfma_f32_16x16x32_bf16 v[120:123], v[32:35], a[116:119], v[120:123]
v_mfma_f32_16x16x32_bf16 v[116:119], v[36:39], a[112:115], v[116:119]
ds_read_b128 v[32:35], v7 offset:59392
v_mfma_f32_16x16x32_bf16 v[124:127], v[36:39], a[116:119], v[124:127]
v_mfma_f32_16x16x32_bf16 v[96:99], v[40:43], a[120:123], v[96:99]
ds_read_b128 v[36:39], v7 offset:60416
s_add_u32 m0, s43, 32768
v_mfma_f32_16x16x32_bf16 v[104:107], v[40:43], a[124:127], v[104:107]
v_add_u32 v4, 16384, v4
s_waitcnt vmcnt(18) lgkmcnt(3)
v_mfma_f32_16x16x32_bf16 v[100:103], v[44:47], a[120:123], v[100:103]
ds_read_b128 v[40:43], v7 offset:61440
global_load_lds_dwordx4 v4, s[20:21] offset:0 sc1
v_mfma_f32_16x16x32_bf16 v[108:111], v[44:47], a[124:127], v[108:111]
v_mfma_f32_16x16x32_bf16 v[112:115], v[16:19], a[120:123], v[112:115]
ds_read_b128 v[44:47], v7 offset:62464
global_load_lds_dwordx4 v4, s[20:21] offset:1024 sc1
v_mfma_f32_16x16x32_bf16 v[120:123], v[16:19], a[124:127], v[120:123]
v_mfma_f32_16x16x32_bf16 v[116:119], v[20:23], a[120:123], v[116:119]
ds_read_b128 v[16:19], v7 offset:63488
v_mfma_f32_16x16x32_bf16 v[124:127], v[20:23], a[124:127], v[124:127]
v_mfma_f32_16x16x32_bf16 v[96:99], v[24:27], a[128:131], v[96:99]
ds_read_b128 v[20:23], v7 offset:64512
v_mfma_f32_16x16x32_bf16 v[104:107], v[24:27], a[132:135], v[104:107]
s_waitcnt vmcnt(16) lgkmcnt(3)
v_mfma_f32_16x16x32_bf16 v[100:103], v[28:31], a[128:131], v[100:103]
s_barrier
ds_read_b128 v[24:27], v6 offset:0
v_mfma_f32_16x16x32_bf16 v[108:111], v[28:31], a[132:135], v[108:111]
global_load_lds_dwordx4 v4, s[20:21] offset:2048 sc1
v_mfma_f32_16x16x32_bf16 v[96:99], v[32:35], a[136:139], v[96:99]
ds_read_b128 v[28:31], v6 offset:1024
v_mfma_f32_16x16x32_bf16 v[104:107], v[32:35], a[140:143], v[104:107]
v_mfma_f32_16x16x32_bf16 v[100:103], v[36:39], a[136:139], v[100:103]
ds_read_b128 v[32:35], v6 offset:2048
global_load_lds_dwordx4 v4, s[20:21] offset:3072 sc1
v_mfma_f32_16x16x32_bf16 v[108:111], v[36:39], a[140:143], v[108:111]
v_mfma_f32_16x16x32_bf16 v[96:99], v[40:43], a[144:147], v[96:99]
ds_read_b128 v[36:39], v6 offset:3072
v_mfma_f32_16x16x32_bf16 v[104:107], v[40:43], a[148:151], v[104:107]
s_waitcnt vmcnt(14) lgkmcnt(3)
v_mfma_f32_16x16x32_bf16 v[100:103], v[44:47], a[144:147], v[100:103]
ds_read_b128 v[40:43], v6 offset:4096
s_add_u32 m0, s43, 49152
v_mfma_f32_16x16x32_bf16 v[108:111], v[44:47], a[148:151], v[108:111]
v_add_u32 v4, 16384, v4
v_mfma_f32_16x16x32_bf16 v[96:99], v[16:19], a[152:155], v[96:99]
ds_read_b128 v[44:47], v6 offset:5120
global_load_lds_dwordx4 v4, s[20:21] offset:0 sc1
v_mfma_f32_16x16x32_bf16 v[104:107], v[16:19], a[156:159], v[104:107]
v_mfma_f32_16x16x32_bf16 v[100:103], v[20:23], a[152:155], v[100:103]
ds_read_b128 v[16:19], v6 offset:6144
global_load_lds_dwordx4 v4, s[20:21] offset:1024 sc1
v_mfma_f32_16x16x32_bf16 v[108:111], v[20:23], a[156:159], v[108:111]
v_mfma_f32_16x16x32_bf16 v[96:99], v[24:27], a[160:163], v[96:99]
ds_read_b128 v[20:23], v6 offset:7168
v_mfma_f32_16x16x32_bf16 v[104:107], v[24:27], a[164:167], v[104:107]
s_waitcnt vmcnt(12) lgkmcnt(3)
v_mfma_f32_16x16x32_bf16 v[100:103], v[28:31], a[160:163], v[100:103]
ds_read_b128 v[24:27], v6 offset:8192
v_mfma_f32_16x16x32_bf16 v[108:111], v[28:31], a[164:167], v[108:111]
v_mfma_f32_16x16x32_bf16 v[96:99], v[32:35], a[168:171], v[96:99]
ds_read_b128 v[28:31], v6 offset:9216
global_load_lds_dwordx4 v4, s[20:21] offset:2048 sc1
v_mfma_f32_16x16x32_bf16 v[104:107], v[32:35], a[172:175], v[104:107]
v_mfma_f32_16x16x32_bf16 v[100:103], v[36:39], a[168:171], v[100:103]
ds_read_b128 v[32:35], v6 offset:10240
v_mfma_f32_16x16x32_bf16 v[108:111], v[36:39], a[172:175], v[108:111]
v_mfma_f32_16x16x32_bf16 v[96:99], v[40:43], a[176:179], v[96:99]
ds_read_b128 v[36:39], v6 offset:11264
global_load_lds_dwordx4 v4, s[20:21] offset:3072 sc1
v_mfma_f32_16x16x32_bf16 v[104:107], v[40:43], a[180:183], v[104:107]
s_waitcnt vmcnt(8) lgkmcnt(3)
v_mfma_f32_16x16x32_bf16 v[100:103], v[44:47], a[176:179], v[100:103]
ds_read_b128 v[40:43], v6 offset:12288
v_mfma_f32_16x16x32_bf16 v[108:111], v[44:47], a[180:183], v[108:111]
v_mfma_f32_16x16x32_bf16 v[96:99], v[16:19], a[184:187], v[96:99]
ds_read_b128 v[44:47], v6 offset:13312
s_add_u32 m0, s43, 65536
v_mfma_f32_16x16x32_bf16 v[104:107], v[16:19], a[188:191], v[104:107]
v_add_u32 v4, 16384, v4
v_mfma_f32_16x16x32_bf16 v[100:103], v[20:23], a[184:187], v[100:103]
ds_read_b128 v[16:19], v6 offset:14336
global_load_lds_dwordx4 v4, s[20:21] offset:0 sc1
v_mfma_f32_16x16x32_bf16 v[108:111], v[20:23], a[188:191], v[108:111]
v_mfma_f32_16x16x32_bf16 v[112:115], v[24:27], a[128:131], v[112:115]
ds_read_b128 v[20:23], v6 offset:15360
global_load_lds_dwordx4 v4, s[20:21] offset:1024 sc1
v_mfma_f32_16x16x32_bf16 v[120:123], v[24:27], a[132:135], v[120:123]
v_cvt_pk_bf16_f32 v128, v96, v97
v_cvt_pk_bf16_f32 v129, v98, v99
v_cvt_pk_bf16_f32 v130, v100, v101
v_cvt_pk_bf16_f32 v131, v102, v103
v_cvt_pk_bf16_f32 v132, v104, v105
s_waitcnt lgkmcnt(3)
v_mfma_f32_16x16x32_bf16 v[116:119], v[28:31], a[128:131], v[116:119]
s_barrier
ds_read_b128 v[24:27], v6 offset:16384
v_mfma_f32_16x16x32_bf16 v[124:127], v[28:31], a[132:135], v[124:127]
v_cvt_pk_bf16_f32 v133, v106, v107
v_cvt_pk_bf16_f32 v134, v108, v109
v_cvt_pk_bf16_f32 v135, v110, v111
v_mfma_f32_16x16x32_bf16 v[112:115], v[32:35], a[136:139], v[112:115]
ds_read_b128 v[28:31], v6 offset:17408
global_load_lds_dwordx4 v4, s[20:21] offset:2048 sc1
buffer_store_dwordx4 v[128:131], v0, s[20:23], s37 offen offset:0 sc1
buffer_store_dwordx4 v[132:135], v0, s[20:23], s37 offen offset:1024 sc1
v_mfma_f32_16x16x32_bf16 v[120:123], v[32:35], a[140:143], v[120:123]
s_mov_b32 s59, 0
s_add_u32 s37, s51, 0
v_mfma_f32_16x16x32_bf16 v[116:119], v[36:39], a[136:139], v[116:119]
ds_read_b128 v[32:35], v6 offset:18432
v_mfma_f32_16x16x32_bf16 v[124:127], v[36:39], a[140:143], v[124:127]
v_mfma_f32_16x16x32_bf16 v[112:115], v[40:43], a[144:147], v[112:115]
ds_read_b128 v[36:39], v6 offset:19456
v_mfma_f32_16x16x32_bf16 v[120:123], v[40:43], a[148:151], v[120:123]
s_waitcnt lgkmcnt(3)
v_mfma_f32_16x16x32_bf16 v[116:119], v[44:47], a[144:147], v[116:119]
ds_read_b128 v[40:43], v6 offset:20480
v_mfma_f32_16x16x32_bf16 v[124:127], v[44:47], a[148:151], v[124:127]
v_mfma_f32_16x16x32_bf16 v[112:115], v[16:19], a[152:155], v[112:115]
ds_read_b128 v[44:47], v6 offset:21504
v_mfma_f32_16x16x32_bf16 v[120:123], v[16:19], a[156:159], v[120:123]
v_mfma_f32_16x16x32_bf16 v[116:119], v[20:23], a[152:155], v[116:119]
ds_read_b128 v[16:19], v6 offset:22528
v_mfma_f32_16x16x32_bf16 v[124:127], v[20:23], a[156:159], v[124:127]
v_mfma_f32_16x16x32_bf16 v[112:115], v[24:27], a[160:163], v[112:115]
ds_read_b128 v[20:23], v6 offset:23552
global_load_lds_dwordx4 v4, s[20:21] offset:3072 sc1
v_mfma_f32_16x16x32_bf16 v[120:123], v[24:27], a[164:167], v[120:123]
s_waitcnt lgkmcnt(3)
v_mfma_f32_16x16x32_bf16 v[116:119], v[28:31], a[160:163], v[116:119]
ds_read_b128 v[24:27], v6 offset:24576
v_mfma_f32_16x16x32_bf16 v[124:127], v[28:31], a[164:167], v[124:127]
v_mfma_f32_16x16x32_bf16 v[112:115], v[32:35], a[168:171], v[112:115]
ds_read_b128 v[28:31], v6 offset:25600
s_add_u32 m0, s43, 81920
v_mfma_f32_16x16x32_bf16 v[120:123], v[32:35], a[172:175], v[120:123]
v_add_u32 v4, 16384, v4
v_mfma_f32_16x16x32_bf16 v[116:119], v[36:39], a[168:171], v[116:119]
ds_read_b128 v[32:35], v6 offset:26624
global_load_lds_dwordx4 v4, s[20:21] offset:0 sc1
v_mfma_f32_16x16x32_bf16 v[124:127], v[36:39], a[172:175], v[124:127]
v_mfma_f32_16x16x32_bf16 v[112:115], v[40:43], a[176:179], v[112:115]
ds_read_b128 v[36:39], v6 offset:27648
global_load_lds_dwordx4 v4, s[20:21] offset:1024 sc1
v_mfma_f32_16x16x32_bf16 v[120:123], v[40:43], a[180:183], v[120:123]
s_waitcnt lgkmcnt(3)
v_mfma_f32_16x16x32_bf16 v[116:119], v[44:47], a[176:179], v[116:119]
ds_read_b128 v[40:43], v6 offset:28672
v_mfma_f32_16x16x32_bf16 v[124:127], v[44:47], a[180:183], v[124:127]
v_mfma_f32_16x16x32_bf16 v[112:115], v[16:19], a[184:187], v[112:115]
ds_read_b128 v[44:47], v6 offset:29696
global_load_lds_dwordx4 v4, s[20:21] offset:2048 sc1
v_mfma_f32_16x16x32_bf16 v[120:123], v[16:19], a[188:191], v[120:123]
v_mfma_f32_16x16x32_bf16 v[116:119], v[20:23], a[184:187], v[116:119]
ds_read_b128 v[16:19], v6 offset:30720
v_mfma_f32_16x16x32_bf16 v[124:127], v[20:23], a[188:191], v[124:127]
v_mfma_f32_16x16x32_bf16 v[192:195], v[24:27], a[0:3], v[192:195]
ds_read_b128 v[20:23], v6 offset:31744
v_mfma_f32_16x16x32_bf16 v[200:203], v[24:27], a[4:7], v[200:203]
v_cvt_pk_bf16_f32 v136, v112, v113
v_cvt_pk_bf16_f32 v137, v114, v115
s_nop 0
v_cvt_pk_bf16_f32 v138, v116, v117
v_cvt_pk_bf16_f32 v139, v118, v119
v_cvt_pk_bf16_f32 v140, v120, v121
s_waitcnt vmcnt(13) lgkmcnt(3)
v_mfma_f32_16x16x32_bf16 v[196:199], v[28:31], a[0:3], v[196:199]
s_barrier
ds_read_b128 v[24:27], v6 offset:32768
v_mfma_f32_16x16x32_bf16 v[204:207], v[28:31], a[4:7], v[204:207]
global_load_lds_dwordx4 v4, s[20:21] offset:3072 sc1
v_cvt_pk_bf16_f32 v141, v122, v123
v_cvt_pk_bf16_f32 v142, v124, v125
v_cvt_pk_bf16_f32 v143, v126, v127
v_mfma_f32_16x16x32_bf16 v[192:195], v[32:35], a[8:11], v[192:195]
ds_read_b128 v[28:31], v6 offset:33792
buffer_store_dwordx4 v[136:139], v0, s[20:23], s37 offen offset:2048 sc1
buffer_store_dwordx4 v[140:143], v0, s[20:23], s37 offen offset:3072 sc1
v_mfma_f32_16x16x32_bf16 v[200:203], v[32:35], a[12:15], v[200:203]
s_add_u32 m0, s43, 98304
v_add_u32 v4, 16384, v4
s_waitcnt vmcnt(7)
s_atomic_add s45, s[20:21], s54 offset:64
v_mfma_f32_16x16x32_bf16 v[196:199], v[36:39], a[8:11], v[196:199]
ds_read_b128 v[32:35], v6 offset:34816
global_load_lds_dwordx4 v4, s[20:21] offset:0 sc1
v_mfma_f32_16x16x32_bf16 v[204:207], v[36:39], a[12:15], v[204:207]
v_mfma_f32_16x16x32_bf16 v[192:195], v[40:43], a[16:19], v[192:195]
ds_read_b128 v[36:39], v6 offset:35840
v_mfma_f32_16x16x32_bf16 v[200:203], v[40:43], a[20:23], v[200:203]
s_waitcnt lgkmcnt(4)
v_mfma_f32_16x16x32_bf16 v[196:199], v[44:47], a[16:19], v[196:199]
ds_read_b128 v[40:43], v6 offset:36864
v_mfma_f32_16x16x32_bf16 v[204:207], v[44:47], a[20:23], v[204:207]
v_mfma_f32_16x16x32_bf16 v[192:195], v[16:19], a[24:27], v[192:195]
ds_read_b128 v[44:47], v6 offset:37888
v_mfma_f32_16x16x32_bf16 v[200:203], v[16:19], a[28:31], v[200:203]
v_mfma_f32_16x16x32_bf16 v[196:199], v[20:23], a[24:27], v[196:199]
ds_read_b128 v[16:19], v6 offset:38912
v_mfma_f32_16x16x32_bf16 v[204:207], v[20:23], a[28:31], v[204:207]
s_waitcnt lgkmcnt(4)
v_mfma_f32_16x16x32_bf16 v[192:195], v[24:27], a[32:35], v[192:195]
ds_read_b128 v[20:23], v6 offset:39936
global_load_lds_dwordx4 v4, s[20:21] offset:1024 sc1
v_mfma_f32_16x16x32_bf16 v[200:203], v[24:27], a[36:39], v[200:203]
v_mfma_f32_16x16x32_bf16 v[196:199], v[28:31], a[32:35], v[196:199]
ds_read_b128 v[24:27], v6 offset:40960
v_mfma_f32_16x16x32_bf16 v[204:207], v[28:31], a[36:39], v[204:207]
v_mfma_f32_16x16x32_bf16 v[192:195], v[32:35], a[40:43], v[192:195]
ds_read_b128 v[28:31], v6 offset:41984
global_load_lds_dwordx4 v4, s[20:21] offset:2048 sc1
v_mfma_f32_16x16x32_bf16 v[200:203], v[32:35], a[44:47], v[200:203]
s_waitcnt lgkmcnt(4)
v_mfma_f32_16x16x32_bf16 v[196:199], v[36:39], a[40:43], v[196:199]
ds_read_b128 v[32:35], v6 offset:43008
v_mfma_f32_16x16x32_bf16 v[204:207], v[36:39], a[44:47], v[204:207]
v_mfma_f32_16x16x32_bf16 v[192:195], v[40:43], a[48:51], v[192:195]
ds_read_b128 v[36:39], v6 offset:44032
v_mfma_f32_16x16x32_bf16 v[200:203], v[40:43], a[52:55], v[200:203]
v_mfma_f32_16x16x32_bf16 v[196:199], v[44:47], a[48:51], v[196:199]
ds_read_b128 v[40:43], v6 offset:45056
global_load_lds_dwordx4 v4, s[20:21] offset:3072 sc1
v_mfma_f32_16x16x32_bf16 v[204:207], v[44:47], a[52:55], v[204:207]
s_waitcnt lgkmcnt(4)
v_mfma_f32_16x16x32_bf16 v[192:195], v[16:19], a[56:59], v[192:195]
ds_read_b128 v[44:47], v6 offset:46080
s_getpc_b64 s[4:5]
v_mfma_f32_16x16x32_bf16 v[200:203], v[16:19], a[60:63], v[200:203]
global_load_dword v13, v12, s[4:5]
v_mfma_f32_16x16x32_bf16 v[196:199], v[20:23], a[56:59], v[196:199]
ds_read_b128 v[16:19], v6 offset:47104
s_add_u32 m0, s43, 114688
v_mfma_f32_16x16x32_bf16 v[204:207], v[20:23], a[60:63], v[204:207]
v_add_u32 v4, 16384, v4
v_mfma_f32_16x16x32_bf16 v[192:195], v[24:27], a[64:67], v[192:195]
ds_read_b128 v[20:23], v6 offset:48128
global_load_lds_dwordx4 v4, s[20:21] offset:0 sc1
v_mfma_f32_16x16x32_bf16 v[200:203], v[24:27], a[68:71], v[200:203]
s_atomic_add s59, s[20:21], s55 offset:64 glc
s_waitcnt lgkmcnt(5)
v_mfma_f32_16x16x32_bf16 v[196:199], v[28:31], a[64:67], v[196:199]
s_barrier
ds_read_b128 v[24:27], v6 offset:49152
v_mfma_f32_16x16x32_bf16 v[204:207], v[28:31], a[68:71], v[204:207]
global_load_lds_dwordx4 v4, s[20:21] offset:1024 sc1
v_mfma_f32_16x16x32_bf16 v[192:195], v[32:35], a[72:75], v[192:195]
ds_read_b128 v[28:31], v6 offset:50176
v_mfma_f32_16x16x32_bf16 v[200:203], v[32:35], a[76:79], v[200:203]
s_waitcnt lgkmcnt(5)
v_mfma_f32_16x16x32_bf16 v[196:199], v[36:39], a[72:75], v[196:199]
ds_read_b128 v[32:35], v6 offset:51200
v_mfma_f32_16x16x32_bf16 v[204:207], v[36:39], a[76:79], v[204:207]
v_mfma_f32_16x16x32_bf16 v[192:195], v[40:43], a[80:83], v[192:195]
ds_read_b128 v[36:39], v6 offset:52224
global_load_lds_dwordx4 v4, s[20:21] offset:2048 sc1
v_mfma_f32_16x16x32_bf16 v[200:203], v[40:43], a[84:87], v[200:203]
s_waitcnt lgkmcnt(5)
v_mfma_f32_16x16x32_bf16 v[196:199], v[44:47], a[80:83], v[196:199]
ds_read_b128 v[40:43], v6 offset:53248
v_mfma_f32_16x16x32_bf16 v[204:207], v[44:47], a[84:87], v[204:207]
v_mfma_f32_16x16x32_bf16 v[192:195], v[16:19], a[88:91], v[192:195]
ds_read_b128 v[44:47], v6 offset:54272
global_load_lds_dwordx4 v4, s[20:21] offset:3072 sc1
v_mfma_f32_16x16x32_bf16 v[200:203], v[16:19], a[92:95], v[200:203]
s_waitcnt lgkmcnt(4)
v_mfma_f32_16x16x32_bf16 v[196:199], v[20:23], a[88:91], v[196:199]
ds_read_b128 v[16:19], v6 offset:55296
v_mfma_f32_16x16x32_bf16 v[204:207], v[20:23], a[92:95], v[204:207]
v_mfma_f32_16x16x32_bf16 v[192:195], v[24:27], a[96:99], v[192:195]
ds_read_b128 v[20:23], v6 offset:56320
s_add_u32 m0, s43, 0
v_mfma_f32_16x16x32_bf16 v[200:203], v[24:27], a[100:103], v[200:203]
v_add_u32 v4, 0xffea4000, v4
v_mfma_f32_16x16x32_bf16 v[196:199], v[28:31], a[96:99], v[196:199]
ds_read_b128 v[24:27], v6 offset:57344
global_load_lds_dwordx4 v4, s[20:21] offset:0 sc1
v_mfma_f32_16x16x32_bf16 v[204:207], v[28:31], a[100:103], v[204:207]
s_waitcnt lgkmcnt(4)
v_mfma_f32_16x16x32_bf16 v[192:195], v[32:35], a[104:107], v[192:195]
ds_read_b128 v[28:31], v6 offset:58368
global_load_lds_dwordx4 v4, s[20:21] offset:1024 sc1
v_mfma_f32_16x16x32_bf16 v[200:203], v[32:35], a[108:111], v[200:203]
v_mfma_f32_16x16x32_bf16 v[196:199], v[36:39], a[104:107], v[196:199]
ds_read_b128 v[32:35], v6 offset:59392
v_mfma_f32_16x16x32_bf16 v[204:207], v[36:39], a[108:111], v[204:207]
v_mfma_f32_16x16x32_bf16 v[192:195], v[40:43], a[112:115], v[192:195]
ds_read_b128 v[36:39], v6 offset:60416
v_mfma_f32_16x16x32_bf16 v[200:203], v[40:43], a[116:119], v[200:203]
s_waitcnt lgkmcnt(4)
v_mfma_f32_16x16x32_bf16 v[196:199], v[44:47], a[112:115], v[196:199]
ds_read_b128 v[40:43], v6 offset:61440
global_load_lds_dwordx4 v4, s[20:21] offset:2048 sc1
v_mfma_f32_16x16x32_bf16 v[204:207], v[44:47], a[116:119], v[204:207]
v_mfma_f32_16x16x32_bf16 v[192:195], v[16:19], a[120:123], v[192:195]
ds_read_b128 v[44:47], v6 offset:62464
v_mfma_f32_16x16x32_bf16 v[200:203], v[16:19], a[124:127], v[200:203]
v_mfma_f32_16x16x32_bf16 v[196:199], v[20:23], a[120:123], v[196:199]
ds_read_b128 v[16:19], v6 offset:63488
global_load_lds_dwordx4 v4, s[20:21] offset:3072 sc1
v_mfma_f32_16x16x32_bf16 v[204:207], v[20:23], a[124:127], v[204:207]
s_waitcnt vmcnt(19) lgkmcnt(4)
v_mfma_f32_16x16x32_bf16 v[192:195], v[24:27], a[128:131], v[192:195]
ds_read_b128 v[20:23], v6 offset:64512
v_mfma_f32_16x16x32_bf16 v[200:203], v[24:27], a[132:135], v[200:203]
v_mfma_f32_16x16x32_bf16 v[196:199], v[28:31], a[128:131], v[196:199]
s_barrier
ds_read_b128 v[24:27], v7 offset:0
v_mfma_f32_16x16x32_bf16 v[204:207], v[28:31], a[132:135], v[204:207]
s_add_u32 m0, s43, 16384
v_add_u32 v4, 16384, v4
v_mfma_f32_16x16x32_bf16 v[192:195], v[32:35], a[136:139], v[192:195]
ds_read_b128 v[28:31], v7 offset:1024
global_load_lds_dwordx4 v4, s[20:21] offset:0 sc1
v_mfma_f32_16x16x32_bf16 v[200:203], v[32:35], a[140:143], v[200:203]
s_waitcnt lgkmcnt(4)
v_mfma_f32_16x16x32_bf16 v[196:199], v[36:39], a[136:139], v[196:199]
ds_read_b128 v[32:35], v7 offset:2048
global_load_lds_dwordx4 v4, s[20:21] offset:1024 sc1
v_mfma_f32_16x16x32_bf16 v[204:207], v[36:39], a[140:143], v[204:207]
v_mfma_f32_16x16x32_bf16 v[192:195], v[40:43], a[144:147], v[192:195]
ds_read_b128 v[36:39], v7 offset:3072
v_mfma_f32_16x16x32_bf16 v[200:203], v[40:43], a[148:151], v[200:203]
v_mfma_f32_16x16x32_bf16 v[196:199], v[44:47], a[144:147], v[196:199]
ds_read_b128 v[40:43], v7 offset:4096
v_mfma_f32_16x16x32_bf16 v[204:207], v[44:47], a[148:151], v[204:207]
s_waitcnt lgkmcnt(4)
v_mfma_f32_16x16x32_bf16 v[192:195], v[16:19], a[152:155], v[192:195]
ds_read_b128 v[44:47], v7 offset:5120
global_load_lds_dwordx4 v4, s[20:21] offset:2048 sc1
v_mfma_f32_16x16x32_bf16 v[200:203], v[16:19], a[156:159], v[200:203]
v_mfma_f32_16x16x32_bf16 v[196:199], v[20:23], a[152:155], v[196:199]
ds_read_b128 v[16:19], v7 offset:6144
v_mfma_f32_16x16x32_bf16 v[204:207], v[20:23], a[156:159], v[204:207]
v_mfma_f32_16x16x32_bf16 v[192:195], v[24:27], a[160:163], v[192:195]
ds_read_b128 v[20:23], v7 offset:7168
global_load_lds_dwordx4 v4, s[20:21] offset:3072 sc1
v_mfma_f32_16x16x32_bf16 v[200:203], v[24:27], a[164:167], v[200:203]
s_waitcnt lgkmcnt(4)
v_mfma_f32_16x16x32_bf16 v[196:199], v[28:31], a[160:163], v[196:199]
ds_read_b128 v[24:27], v7 offset:8192
v_mfma_f32_16x16x32_bf16 v[204:207], v[28:31], a[164:167], v[204:207]
v_mfma_f32_16x16x32_bf16 v[192:195], v[32:35], a[168:171], v[192:195]
ds_read_b128 v[28:31], v7 offset:9216
s_add_u32 m0, s43, 32768
v_mfma_f32_16x16x32_bf16 v[200:203], v[32:35], a[172:175], v[200:203]
v_add_u32 v4, 16384, v4
v_mfma_f32_16x16x32_bf16 v[196:199], v[36:39], a[168:171], v[196:199]
ds_read_b128 v[32:35], v7 offset:10240
global_load_lds_dwordx4 v4, s[20:21] offset:0 sc1
v_mfma_f32_16x16x32_bf16 v[204:207], v[36:39], a[172:175], v[204:207]
s_cmp_lt_u32 s59, 1
s_cbranch_scc0 L_back13
L_slow13:
s_waitcnt lgkmcnt(0)
s_cmp_ge_u32 s59, 1
s_cbranch_scc1 L_back13
s_mov_b32 s59, 0
s_atomic_add s59, s[20:21], s55 offset:64 glc
s_sub_u32 s46, s46, 1
s_cbranch_scc0 L_slow13
s_endpgm
L_back13:
buffer_load_dwordx4 v[128:131], v0, s[20:23], s41 offen offset:0 sc1
buffer_load_dwordx4 v[132:135], v0, s[20:23], s41 offen offset:1024 sc1
s_add_u32 s41, s52, 0
s_mov_b32 s59, 0
s_waitcnt vmcnt(20)
s_atomic_add s45, s[20:21], s54 offset:64
s_waitcnt lgkmcnt(4)
v_mfma_f32_16x16x32_bf16 v[192:195], v[40:43], a[176:179], v[192:195]
ds_read_b128 v[36:39], v7 offset:11264
v_mfma_f32_16x16x32_bf16 v[200:203], v[40:43], a[180:183], v[200:203]
v_mfma_f32_16x16x32_bf16 v[196:199], v[44:47], a[176:179], v[196:199]
ds_read_b128 v[40:43], v7 offset:12288
v_mfma_f32_16x16x32_bf16 v[204:207], v[44:47], a[180:183], v[204:207]
v_mfma_f32_16x16x32_bf16 v[192:195], v[16:19], a[184:187], v[192:195]
ds_read_b128 v[44:47], v7 offset:13312
v_mfma_f32_16x16x32_bf16 v[200:203], v[16:19], a[188:191], v[200:203]
s_waitcnt lgkmcnt(4)
v_mfma_f32_16x16x32_bf16 v[196:199], v[20:23], a[184:187], v[196:199]
ds_read_b128 v[16:19], v7 offset:14336
global_load_lds_dwordx4 v4, s[20:21] offset:1024 sc1
v_mfma_f32_16x16x32_bf16 v[204:207], v[20:23], a[188:191], v[204:207]
v_mfma_f32_16x16x32_bf16 v[80:83], v[24:27], a[224:227], v[80:83]
ds_read_b128 v[20:23], v7 offset:15360
v_mfma_f32_16x16x32_bf16 v[88:91], v[24:27], a[228:231], v[88:91]
v_mfma_f32_16x16x32_bf16 v[84:87], v[28:31], a[224:227], v[84:87]
s_barrier
ds_read_b128 v[24:27], v7 offset:16384
v_mfma_f32_16x16x32_bf16 v[92:95], v[28:31], a[228:231], v[92:95]
global_load_lds_dwordx4 v4, s[20:21] offset:2048 sc1
s_waitcnt lgkmcnt(4)
v_mfma_f32_16x16x32_bf16 v[80:83], v[32:35], a[232:235], v[80:83]
ds_read_b128 v[28:31], v7 offset:17408
v_mfma_f32_16x16x32_bf16 v[88:91], v[32:35], a[236:239], v[88:91]
v_mfma_f32_16x16x32_bf16 v[84:87], v[36:39], a[232:235], v[84:87]
ds_read_b128 v[32:35], v7 offset:18432
v_mfma_f32_16x16x32_bf16 v[92:95], v[36:39], a[236:239], v[92:95]
v_mfma_f32_16x16x32_bf16 v[80:83], v[40:43], a[240:243], v[80:83]
ds_read_b128 v[36:39], v7 offset:19456
global_load_lds_dwordx4 v4, s[20:21] offset:3072 sc1
v_mfma_f32_16x16x32_bf16 v[88:91], v[40:43], a[244:247], v[88:91]
s_waitcnt lgkmcnt(4)
v_mfma_f32_16x16x32_bf16 v[84:87], v[44:47], a[240:243], v[84:87]
ds_read_b128 v[40:43], v7 offset:20480
v_mfma_f32_16x16x32_bf16 v[92:95], v[44:47], a[244:247], v[92:95]
v_mfma_f32_16x16x32_bf16 v[80:83], v[16:19], a[248:251], v[80:83]
ds_read_b128 v[44:47], v7 offset:21504
s_add_u32 m0, s43, 49152
v_mfma_f32_16x16x32_bf16 v[88:91], v[16:19], a[252:255], v[88:91]
v_add_u32 v4, 16384, v4
v_mfma_f32_16x16x32_bf16 v[84:87], v[20:23], a[248:251], v[84:87]
ds_read_b128 v[16:19], v7 offset:22528
global_load_lds_dwordx4 v4, s[20:21] offset:0 sc1
v_mfma_f32_16x16x32_bf16 v[92:95], v[20:23], a[252:255], v[92:95]
s_waitcnt lgkmcnt(4)
v_mfma_f32_16x16x32_bf16 v[80:83], v[24:27], a[0:3], v[80:83]
ds_read_b128 v[20:23], v7 offset:23552
global_load_lds_dwordx4 v4, s[20:21] offset:1024 sc1
v_mfma_f32_16x16x32_bf16 v[88:91], v[24:27], a[4:7], v[88:91]
v_mfma_f32_16x16x32_bf16 v[84:87], v[28:31], a[0:3], v[84:87]
ds_read_b128 v[24:27], v7 offset:24576
v_mfma_f32_16x16x32_bf16 v[92:95], v[28:31], a[4:7], v[92:95]
v_mfma_f32_16x16x32_bf16 v[80:83], v[32:35], a[8:11], v[80:83]
ds_read_b128 v[28:31], v7 offset:25600
global_load_lds_dwordx4 v4, s[20:21] offset:2048 sc1
v_mfma_f32_16x16x32_bf16 v[88:91], v[32:35], a[12:15], v[88:91]
s_waitcnt lgkmcnt(4)
v_mfma_f32_16x16x32_bf16 v[84:87], v[36:39], a[8:11], v[84:87]
ds_read_b128 v[32:35], v7 offset:26624
v_mfma_f32_16x16x32_bf16 v[92:95], v[36:39], a[12:15], v[92:95]
v_mfma_f32_16x16x32_bf16 v[80:83], v[40:43], a[16:19], v[80:83]
ds_read_b128 v[36:39], v7 offset:27648
v_mfma_f32_16x16x32_bf16 v[88:91], v[40:43], a[20:23], v[88:91]
v_mfma_f32_16x16x32_bf16 v[84:87], v[44:47], a[16:19], v[84:87]
ds_read_b128 v[40:43], v7 offset:28672
global_load_lds_dwordx4 v4, s[20:21] offset:3072 sc1
v_mfma_f32_16x16x32_bf16 v[92:95], v[44:47], a[20:23], v[92:95]
s_atomic_add s59, s[20:21], s55 offset:64 glc
s_waitcnt vmcnt(8)
v_lshlrev_b32 v96, 16, v128
v_and_b32 v97, 0xffff0000, v128
v_lshlrev_b32 v98, 16, v129
s_waitcnt lgkmcnt(5)
v_mfma_f32_16x16x32_bf16 v[80:83], v[16:19], a[24:27], v[80:83]
ds_read_b128 v[44:47], v7 offset:29696
v_and_b32 v99, 0xffff0000, v129
v_mfma_f32_16x16x32_bf16 v[88:91], v[16:19], a[28:31], v[88:91]
v_lshlrev_b32 v100, 16, v130
v_and_b32 v101, 0xffff0000, v130
v_mfma_f32_16x16x32_bf16 v[84:87], v[20:23], a[24:27], v[84:87]
ds_read_b128 v[16:19], v7 offset:30720
v_lshlrev_b32 v102, 16, v131
v_mfma_f32_16x16x32_bf16 v[92:95], v[20:23], a[28:31], v[92:95]
v_and_b32 v103, 0xffff0000, v131
s_waitcnt vmcnt(7)
v_lshlrev_b32 v104, 16, v132
s_waitcnt lgkmcnt(5)
v_mfma_f32_16x16x32_bf16 v[80:83], v[24:27], a[32:35], v[80:83]
ds_read_b128 v[20:23], v7 offset:31744
v_and_b32 v105, 0xffff0000, v132
v_mfma_f32_16x16x32_bf16 v[88:91], v[24:27], a[36:39], v[88:91]
v_lshlrev_b32 v106, 16, v133
v_and_b32 v107, 0xffff0000, v133
v_mfma_f32_16x16x32_bf16 v[84:87], v[28:31], a[32:35], v[84:87]
s_barrier
ds_read_b128 v[24:27], v7 offset:32768
v_mfma_f32_16x16x32_bf16 v[92:95], v[28:31], a[36:39], v[92:95]
s_add_u32 m0, s43, 65536
v_lshlrev_b32 v108, 16, v134
v_and_b32 v109, 0xffff0000, v134
v_lshlrev_b32 v110, 16, v135
s_waitcnt lgkmcnt(4)
v_mfma_f32_16x16x32_bf16 v[80:83], v[32:35], a[40:43], v[80:83]
ds_read_b128 v[28:31], v7 offset:33792
v_add_u32 v4, 16384, v4
v_mfma_f32_16x16x32_bf16 v[88:91], v[32:35], a[44:47], v[88:91]
global_load_lds_dwordx4 v4, s[20:21] offset:0 sc1
global_load_lds_dwordx4 v4, s[20:21] offset:1024 sc1
v_and_b32 v111, 0xffff0000, v135
v_add_f32 v192, v192, v96
v_add_f32 v193, v193, v97
v_mfma_f32_16x16x32_bf16 v[84:87], v[36:39], a[40:43], v[84:87]
ds_read_b128 v[32:35], v7 offset:34816
global_load_lds_dwordx4 v4, s[20:21] offset:2048 sc1
v_mfma_f32_16x16x32_bf16 v[92:95], v[36:39], a[44:47], v[92:95]
v_cvt_pk_bf16_f32 v48, v192, v193
v_add_f32 v194, v194, v98
v_add_f32 v195, v195, v99
v_mfma_f32_16x16x32_bf16 v[80:83], v[40:43], a[48:51], v[80:83]
ds_read_b128 v[36:39], v7 offset:35840
global_load_lds_dwordx4 v4, s[20:21] offset:3072 sc1
v_mfma_f32_16x16x32_bf16 v[88:91], v[40:43], a[52:55], v[88:91]
v_cvt_pk_bf16_f32 v49, v194, v195
v_add_f32 v196, v196, v100
v_add_f32 v197, v197, v101
s_waitcnt lgkmcnt(4)
v_mfma_f32_16x16x32_bf16 v[84:87], v[44:47], a[48:51], v[84:87]
ds_read_b128 v[40:43], v7 offset:36864
v_cvt_pk_bf16_f32 v50, v196, v197
v_mfma_f32_16x16x32_bf16 v[92:95], v[44:47], a[52:55], v[92:95]
v_add_f32 v198, v198, v102
v_add_f32 v199, v199, v103
v_mfma_f32_16x16x32_bf16 v[80:83], v[16:19], a[56:59], v[80:83]
ds_read_b128 v[44:47], v7 offset:37888
v_cvt_pk_bf16_f32 v51, v198, v199
v_mfma_f32_16x16x32_bf16 v[88:91], v[16:19], a[60:63], v[88:91]
v_add_f32 v200, v200, v104
v_add_f32 v201, v201, v105
v_mfma_f32_16x16x32_bf16 v[84:87], v[20:23], a[56:59], v[84:87]
ds_read_b128 v[16:19], v7 offset:38912
v_cvt_pk_bf16_f32 v52, v200, v201
v_mfma_f32_16x16x32_bf16 v[92:95], v[20:23], a[60:63], v[92:95]
v_add_f32 v202, v202, v106
v_add_f32 v203, v203, v107
s_waitcnt lgkmcnt(4)
v_mfma_f32_16x16x32_bf16 v[80:83], v[24:27], a[64:67], v[80:83]
ds_read_b128 v[20:23], v7 offset:39936
v_cvt_pk_bf16_f32 v53, v202, v203
v_mfma_f32_16x16x32_bf16 v[88:91], v[24:27], a[68:71], v[88:91]
v_add_f32 v204, v204, v108
v_add_f32 v205, v205, v109
v_mfma_f32_16x16x32_bf16 v[84:87], v[28:31], a[64:67], v[84:87]
ds_read_b128 v[24:27], v7 offset:40960
v_cvt_pk_bf16_f32 v54, v204, v205
v_mfma_f32_16x16x32_bf16 v[92:95], v[28:31], a[68:71], v[92:95]
v_add_f32 v206, v206, v110
v_add_f32 v207, v207, v111
v_mfma_f32_16x16x32_bf16 v[80:83], v[32:35], a[72:75], v[80:83]
ds_read_b128 v[28:31], v7 offset:41984
v_cvt_pk_bf16_f32 v55, v206, v207
v_mfma_f32_16x16x32_bf16 v[88:91], v[32:35], a[76:79], v[88:91]
s_add_u32 s37, s48, 12058624
s_waitcnt lgkmcnt(4)
v_mfma_f32_16x16x32_bf16 v[84:87], v[36:39], a[72:75], v[84:87]
ds_read_b128 v[32:35], v7 offset:43008
buffer_store_dwordx4 v[48:51], v0, s[20:23], s37 offen offset:0 sc1
buffer_store_dwordx4 v[52:55], v0, s[20:23], s37 offen offset:1024 sc1
v_mfma_f32_16x16x32_bf16 v[92:95], v[36:39], a[76:79], v[92:95]
s_mov_b32 s58, 0
v_mov_b32 v212, 0x3f803f80
v_mfma_f32_16x16x32_bf16 v[80:83], v[40:43], a[80:83], v[80:83]
ds_read_b128 v[36:39], v7 offset:44032
v_mfma_f32_16x16x32_bf16 v[88:91], v[40:43], a[84:87], v[88:91]
v_dot2_f32_bf16 v208, v48, v212, 0
v_dot2_f32_bf16 v209, v48, v48, 0
v_dot2_f32_bf16 v210, v52, v212, 0
v_dot2_f32_bf16 v211, v52, v52, 0
v_dot2_f32_bf16 v208, v49, v212, v208
v_dot2_f32_bf16 v209, v49, v49, v209
v_dot2_f32_bf16 v210, v53, v212, v210
v_dot2_f32_bf16 v211, v53, v53, v211
v_dot2_f32_bf16 v208, v50, v212, v208
v_dot2_f32_bf16 v209, v50, v50, v209
v_dot2_f32_bf16 v210, v54, v212, v210
v_dot2_f32_bf16 v211, v54, v54, v211
v_dot2_f32_bf16 v208, v51, v212, v208
v_dot2_f32_bf16 v209, v51, v51, v209
v_dot2_f32_bf16 v210, v55, v212, v210
v_dot2_f32_bf16 v211, v55, v55, v211
v_mfma_f32_16x16x32_bf16 v[84:87], v[44:47], a[80:83], v[84:87]
ds_read_b128 v[40:43], v7 offset:45056
v_mfma_f32_16x16x32_bf16 v[92:95], v[44:47], a[84:87], v[92:95]
s_waitcnt lgkmcnt(4)
v_mfma_f32_16x16x32_bf16 v[80:83], v[16:19], a[88:91], v[80:83]
ds_read_b128 v[44:47], v7 offset:46080
v_mfma_f32_16x16x32_bf16 v[88:91], v[16:19], a[92:95], v[88:91]
v_mfma_f32_16x16x32_bf16 v[84:87], v[20:23], a[88:91], v[84:87]
ds_read_b128 v[16:19], v7 offset:47104
v_mfma_f32_16x16x32_bf16 v[92:95], v[20:23], a[92:95], v[92:95]
v_mfma_f32_16x16x32_bf16 v[80:83], v[24:27], a[96:99], v[80:83]
s_cmp_lt_u32 s59, 2
s_cbranch_scc0 L_back14
L_slow14:
s_waitcnt lgkmcnt(0)
s_cmp_ge_u32 s59, 2
s_cbranch_scc1 L_back14
s_mov_b32 s59, 0
s_atomic_add s59, s[20:21], s55 offset:64 glc
s_sub_u32 s46, s46, 1
s_cbranch_scc0 L_slow14
s_endpgm
L_back14:
buffer_load_dwordx4 v[136:139], v0, s[20:23], s41 offen offset:2048 sc1
buffer_load_dwordx4 v[140:143], v0, s[20:23], s41 offen offset:3072 sc1
v_mfma_f32_16x16x32_bf16 v[88:91], v[24:27], a[100:103], v[88:91]
ds_read_b128 v[20:23], v7 offset:48128
s_add_u32 s41, s50, 139264
s_add_u32 s42, s50, 147456
s_waitcnt lgkmcnt(3)
v_mfma_f32_16x16x32_bf16 v[84:87], v[28:31], a[96:99], v[84:87]
s_barrier
ds_read_b128 v[24:27], v7 offset:49152
v_mfma_f32_16x16x32_bf16 v[92:95], v[28:31], a[100:103], v[92:95]
s_add_u32 m0, s43, 81920
v_add_u32 v4, 16384, v4
v_mfma_f32_16x16x32_bf16 v[80:83], v[32:35], a[104:107], v[80:83]
ds_read_b128 v[28:31], v7 offset:50176
global_load_lds_dwordx4 v4, s[20:21] offset:0 sc1
v_mfma_f32_16x16x32_bf16 v[88:91], v[32:35], a[108:111], v[88:91]
v_mfma_f32_16x16x32_bf16 v[84:87], v[36:39], a[104:107], v[84:87]
ds_read_b128 v[32:35], v7 offset:51200
global_load_lds_dwordx4 v4, s[20:21] offset:1024 sc1
v_mfma_f32_16x16x32_bf16 v[92:95], v[36:39], a[108:111], v[92:95]
v_mfma_f32_16x16x32_bf16 v[80:83], v[40:43], a[112:115], v[80:83]
ds_read_b128 v[36:39], v7 offset:52224
v_mfma_f32_16x16x32_bf16 v[88:91], v[40:43], a[116:119], v[88:91]
s_waitcnt lgkmcnt(3)
v_mfma_f32_16x16x32_bf16 v[84:87], v[44:47], a[112:115], v[84:87]
ds_read_b128 v[40:43], v7 offset:53248
global_load_lds_dwordx4 v4, s[20:21] offset:2048 sc1
v_mfma_f32_16x16x32_bf16 v[92:95], v[44:47], a[116:119], v[92:95]
v_mfma_f32_16x16x32_bf16 v[80:83], v[16:19], a[120:123], v[80:83]
ds_read_b128 v[44:47], v7 offset:54272
v_mfma_f32_16x16x32_bf16 v[88:91], v[16:19], a[124:127], v[88:91]
v_mfma_f32_16x16x32_bf16 v[84:87], v[20:23], a[120:123], v[84:87]
ds_read_b128 v[16:19], v7 offset:55296
global_load_lds_dwordx4 v4, s[20:21] offset:3072 sc1
v_mfma_f32_16x16x32_bf16 v[92:95], v[20:23], a[124:127], v[92:95]
v_mfma_f32_16x16x32_bf16 v[80:83], v[24:27], a[128:131], v[80:83]
ds_read_b128 v[20:23], v7 offset:56320
v_mfma_f32_16x16x32_bf16 v[88:91], v[24:27], a[132:135], v[88:91]
s_waitcnt lgkmcnt(3)
v_mfma_f32_16x16x32_bf16 v[84:87], v[28:31], a[128:131], v[84:87]
ds_read_b128 v[24:27], v7 offset:57344
v_mfma_f32_16x16x32_bf16 v[92:95], v[28:31], a[132:135], v[92:95]
v_mfma_f32_16x16x32_bf16 v[80:83], v[32:35], a[136:139], v[80:83]
ds_read_b128 v[28:31], v7 offset:58368
v_mfma_f32_16x16x32_bf16 v[88:91], v[32:35], a[140:143], v[88:91]
v_mfma_f32_16x16x32_bf16 v[84:87], v[36:39], a[136:139], v[84:87]
ds_read_b128 v[32:35], v7 offset:59392
v_mfma_f32_16x16x32_bf16 v[92:95], v[36:39], a[140:143], v[92:95]
v_mfma_f32_16x16x32_bf16 v[80:83], v[40:43], a[144:147], v[80:83]
ds_read_b128 v[36:39], v7 offset:60416
v_mfma_f32_16x16x32_bf16 v[88:91], v[40:43], a[148:151], v[88:91]
s_waitcnt lgkmcnt(3)
v_mfma_f32_16x16x32_bf16 v[84:87], v[44:47], a[144:147], v[84:87]
ds_read_b128 v[40:43], v7 offset:61440
v_mfma_f32_16x16x32_bf16 v[92:95], v[44:47], a[148:151], v[92:95]
s_waitcnt vmcnt(6)
s_atomic_add s45, s[20:21], s53 offset:16
v_mfma_f32_16x16x32_bf16 v[80:83], v[16:19], a[152:155], v[80:83]
ds_read_b128 v[44:47], v7 offset:62464
v_mfma_f32_16x16x32_bf16 v[88:91], v[16:19], a[156:159], v[88:91]
v_mfma_f32_16x16x32_bf16 v[84:87], v[20:23], a[152:155], v[84:87]
ds_read_b128 v[16:19], v7 offset:63488
v_mfma_f32_16x16x32_bf16 v[92:95], v[20:23], a[156:159], v[92:95]
v_mfma_f32_16x16x32_bf16 v[80:83], v[24:27], a[160:163], v[80:83]
ds_read_b128 v[20:23], v7 offset:64512
v_mfma_f32_16x16x32_bf16 v[88:91], v[24:27], a[164:167], v[88:91]
s_waitcnt lgkmcnt(4)
v_mfma_f32_16x16x32_bf16 v[84:87], v[28:31], a[160:163], v[84:87]
s_barrier
ds_read_b128 v[24:27], v6 offset:0
v_mfma_f32_16x16x32_bf16 v[92:95], v[28:31], a[164:167], v[92:95]
s_add_u32 m0, s43, 98304
v_add_u32 v4, 16384, v4
v_mfma_f32_16x16x32_bf16 v[80:83], v[32:35], a[168:171], v[80:83]
ds_read_b128 v[28:31], v6 offset:1024
global_load_lds_dwordx4 v4, s[20:21] offset:0 sc1
v_mfma_f32_16x16x32_bf16 v[88:91], v[32:35], a[172:175], v[88:91]
global_load_lds_dwordx4 v4, s[20:21] offset:1024 sc1
global_load_lds_dwordx4 v4, s[20:21] offset:2048 sc1
s_waitcnt vmcnt(8)
v_lshlrev_b32 v112, 16, v136
v_and_b32 v113, 0xffff0000, v136
v_lshlrev_b32 v114, 16, v137
v_and_b32 v115, 0xffff0000, v137
v_lshlrev_b32 v116, 16, v138
v_mfma_f32_16x16x32_bf16 v[84:87], v[36:39], a[168:171], v[84:87]
ds_read_b128 v[32:35], v6 offset:2048
global_load_lds_dwordx4 v4, s[20:21] offset:3072 sc1
v_mfma_f32_16x16x32_bf16 v[92:95], v[36:39], a[172:175], v[92:95]
v_and_b32 v117, 0xffff0000, v138
v_lshlrev_b32 v118, 16, v139
v_and_b32 v119, 0xffff0000, v139
s_waitcnt lgkmcnt(4)
v_mfma_f32_16x16x32_bf16 v[80:83], v[40:43], a[176:179], v[80:83]
ds_read_b128 v[36:39], v6 offset:3072
s_waitcnt vmcnt(8)
v_lshlrev_b32 v120, 16, v140
v_mfma_f32_16x16x32_bf16 v[88:91], v[40:43], a[180:183], v[88:91]
v_and_b32 v121, 0xffff0000, v140
v_lshlrev_b32 v122, 16, v141
v_mfma_f32_16x16x32_bf16 v[84:87], v[44:47], a[176:179], v[84:87]
ds_read_b128 v[40:43], v6 offset:4096
v_and_b32 v123, 0xffff0000, v141
v_mfma_f32_16x16x32_bf16 v[92:95], v[44:47], a[180:183], v[92:95]
v_lshlrev_b32 v124, 16, v142
v_and_b32 v125, 0xffff0000, v142
v_mfma_f32_16x16x32_bf16 v[80:83], v[16:19], a[184:187], v[80:83]
ds_read_b128 v[44:47], v6 offset:5120
v_lshlrev_b32 v126, 16, v143
v_mfma_f32_16x16x32_bf16 v[88:91], v[16:19], a[188:191], v[88:91]
v_and_b32 v127, 0xffff0000, v143
s_waitcnt lgkmcnt(4)
v_mfma_f32_16x16x32_bf16 v[84:87], v[20:23], a[184:187], v[84:87]
ds_read_b128 v[16:19], v6 offset:6144
v_mfma_f32_16x16x32_bf16 v[92:95], v[20:23], a[188:191], v[92:95]
v_add_f32 v80, v80, v112
v_add_f32 v81, v81, v113
v_cvt_pk_bf16_f32 v56, v80, v81
v_add_f32 v82, v82, v114
s_branch L_over
L_end:
s_endpgm
L_slowx:
s_mov_b32 exec_hi, 0
v_mov_b32 v9, 0
buffer_atomic_add v9, v225, s[20:23], s40 offen sc0 sc1
s_mov_b32 exec_hi, -1
s_sub_u32 s46, s46, 1
s_cbranch_scc1 L_end
s_waitcnt vmcnt(0)
v_cmp_ne_u32 s[100:101], s44, v9
s_nop 0
s_cmp_lg_u32 s100, 0
s_cbranch_scc1 L_slowx
s_branch L_backx
L_over:
v_add_f32 v83, v83, v115
v_cvt_pk_bf16_f32 v57, v82, v83
v_add_f32 v84, v84, v116
v_add_f32 v85, v85, v117
v_cvt_pk_bf16_f32 v58, v84, v85
v_add_f32 v86, v86, v118
v_add_f32 v87, v87, v119
v_cvt_pk_bf16_f32 v59, v86, v87
v_add_f32 v88, v88, v120
v_add_f32 v89, v89, v121
v_cvt_pk_bf16_f32 v60, v88, v89
v_add_f32 v90, v90, v122
v_add_f32 v91, v91, v123
s_atomic_add s58, s[20:21], s53 offset:16 glc
v_cvt_pk_bf16_f32 v61, v90, v91
v_add_f32 v92, v92, v124
v_add_f32 v93, v93, v125
v_cvt_pk_bf16_f32 v62, v92, v93
v_add_f32 v94, v94, v126
v_add_f32 v95, v95, v127
v_cvt_pk_bf16_f32 v63, v94, v95
s_add_u32 s37, s48, 12091392
buffer_store_dwordx4 v[56:59], v0, s[20:23], s37 offen offset:0 sc1
buffer_store_dwordx4 v[60:63], v0, s[20:23], s37 offen offset:1024 sc1
v_dot2_f32_bf16 v208, v56, v212, v208
v_dot2_f32_bf16 v209, v56, v56, v209
v_dot2_f32_bf16 v210, v60, v212, v210
v_dot2_f32_bf16 v211, v60, v60, v211
v_dot2_f32_bf16 v208, v57, v212, v208
v_dot2_f32_bf16 v209, v57, v57, v209
v_dot2_f32_bf16 v210, v61, v212, v210
v_dot2_f32_bf16 v211, v61, v61, v211
v_dot2_f32_bf16 v208, v58, v212, v208
v_dot2_f32_bf16 v209, v58, v58, v209
v_dot2_f32_bf16 v210, v62, v212, v210
v_dot2_f32_bf16 v211, v62, v62, v211
v_dot2_f32_bf16 v208, v59, v212, v208
v_dot2_f32_bf16 v209, v59, v59, v209
v_dot2_f32_bf16 v210, v63, v212, v210
v_dot2_f32_bf16 v211, v63, v63, v211
s_add_u32 s37, s53, 81920
s_nop 0
v_permlane32_swap_b32 v208, v210
v_permlane32_swap_b32 v209, v211
v_add_f32 v208, v208, v210
v_add_f32 v209, v209, v211
s_nop 1
v_permlane16_swap_b32 v208, v209
v_add_f32 v208, v208, v209
buffer_atomic_add_f32 v208, v3, s[20:23], s37 offen sc1
s_cmp_lt_u32 s58, 16
s_cbranch_scc0 L_back15
L_slow15:
s_waitcnt lgkmcnt(0)
s_cmp_ge_u32 s58, 16
s_cbranch_scc1 L_back15
s_mov_b32 s58, 0
s_atomic_add s58, s[20:21], s53 offset:16 glc
s_sub_u32 s46, s46, 1
s_cbranch_scc0 L_slow15
s_endpgm
L_back15:
v_add_u32 v5, 12062720, v14
global_load_dwordx4 a[192:195], v5, s[20:21] offset:-4096 sc1
global_load_dwordx4 a[196:199], v5, s[20:21] offset:-3072 sc1
global_load_dwordx4 a[200:203], v5, s[20:21] offset:-2048 sc1
global_load_dwordx4 a[204:207], v5, s[20:21] offset:-1024 sc1
global_load_dwordx4 a[208:211], v5, s[20:21] offset:0 sc1
global_load_dwordx4 a[212:215], v5, s[20:21] offset:1024 sc1
global_load_dwordx4 a[216:219], v5, s[20:21] offset:2048 sc1
global_load_dwordx4 a[220:223], v5, s[20:21] offset:3072 sc1
s_waitcnt vmcnt(6)
v_mfma_f32_16x16x32_bf16 v[144:147], a[192:195], v[24:27], 0
ds_read_b128 v[20:23], v6 offset:7168
v_add_u32 v5, 8192, v5
v_mfma_f32_16x16x32_bf16 v[148:151], a[196:199], v[24:27], 0
global_load_dwordx4 a[224:227], v5, s[20:21] offset:-4096 sc1
global_load_dwordx4 a[228:231], v5, s[20:21] offset:-3072 sc1
s_mov_b32 s58, 0
v_mfma_f32_16x16x32_bf16 v[152:155], a[192:195], v[28:31], 0
ds_read_b128 v[24:27], v6 offset:8192
global_load_dwordx4 a[232:235], v5, s[20:21] offset:-2048 sc1
v_mfma_f32_16x16x32_bf16 v[156:159], a[196:199], v[28:31], 0
global_load_dwordx4 a[236:239], v5, s[20:21] offset:-1024 sc1
s_atomic_add s45, s[20:21], s53 offset:20
s_waitcnt lgkmcnt(4)
v_mfma_f32_16x16x32_bf16 v[160:163], a[192:195], v[32:35], 0
ds_read_b128 v[28:31], v6 offset:9216
global_load_dwordx4 a[240:243], v5, s[20:21] offset:0 sc1
v_mfma_f32_16x16x32_bf16 v[164:167], a[196:199], v[32:35], 0
v_mfma_f32_16x16x32_bf16 v[168:171], a[192:195], v[36:39], 0
ds_read_b128 v[32:35], v6 offset:10240
global_load_dwordx4 a[244:247], v5, s[20:21] offset:1024 sc1
v_mfma_f32_16x16x32_bf16 v[172:175], a[196:199], v[36:39], 0
v_mfma_f32_16x16x32_bf16 v[176:179], a[192:195], v[40:43], 0
ds_read_b128 v[36:39], v6 offset:11264
v_mfma_f32_16x16x32_bf16 v[180:183], a[196:199], v[40:43], 0
s_waitcnt lgkmcnt(4)
v_mfma_f32_16x16x32_bf16 v[184:187], a[192:195], v[44:47], 0
ds_read_b128 v[40:43], v6 offset:12288
v_mfma_f32_16x16x32_bf16 v[188:191], a[196:199], v[44:47], 0
v_mfma_f32_16x16x32_bf16 v[192:195], a[192:195], v[16:19], 0
ds_read_b128 v[44:47], v6 offset:13312
global_load_dwordx4 a[248:251], v5, s[20:21] offset:2048 sc1
v_mfma_f32_16x16x32_bf16 v[196:199], a[196:199], v[16:19], 0
v_mfma_f32_16x16x32_bf16 v[200:203], a[192:195], v[20:23], 0
ds_read_b128 v[16:19], v6 offset:14336
v_mfma_f32_16x16x32_bf16 v[204:207], a[196:199], v[20:23], 0
s_waitcnt vmcnt(11) lgkmcnt(4)
v_mfma_f32_16x16x32_bf16 v[144:147], a[200:203], v[24:27], v[144:147]
ds_read_b128 v[20:23], v6 offset:15360
global_load_dwordx4 a[252:255], v5, s[20:21] offset:3072 sc1
v_mfma_f32_16x16x32_bf16 v[148:151], a[204:207], v[24:27], v[148:151]
v_mfma_f32_16x16x32_bf16 v[152:155], a[200:203], v[28:31], v[152:155]
s_barrier
ds_read_b128 v[24:27], v6 offset:16384
v_mfma_f32_16x16x32_bf16 v[156:159], a[204:207], v[28:31], v[156:159]
v_mfma_f32_16x16x32_bf16 v[160:163], a[200:203], v[32:35], v[160:163]
ds_read_b128 v[28:31], v6 offset:17408
v_add_u32 v5, s60, v5
v_mfma_f32_16x16x32_bf16 v[164:167], a[204:207], v[32:35], v[164:167]
global_load_dwordx4 a[0:3], v5, s[20:21] offset:-4096 sc1
s_waitcnt lgkmcnt(4)
v_mfma_f32_16x16x32_bf16 v[168:171], a[200:203], v[36:39], v[168:171]
ds_read_b128 v[32:35], v6 offset:18432
v_mfma_f32_16x16x32_bf16 v[172:175], a[204:207], v[36:39], v[172:175]
v_mfma_f32_16x16x32_bf16 v[176:179], a[200:203], v[40:43], v[176:179]
ds_read_b128 v[36:39], v6 offset:19456
global_load_dwordx4 a[4:7], v5, s[20:21] offset:-3072 sc1
v_mfma_f32_16x16x32_bf16 v[180:183], a[204:207], v[40:43], v[180:183]
v_mfma_f32_16x16x32_bf16 v[184:187], a[200:203], v[44:47], v[184:187]
ds_read_b128 v[40:43], v6 offset:20480
v_mfma_f32_16x16x32_bf16 v[188:191], a[204:207], v[44:47], v[188:191]
s_waitcnt vmcnt(12) lgkmcnt(4)
v_mfma_f32_16x16x32_bf16 v[192:195], a[200:203], v[16:19], v[192:195]
ds_read_b128 v[44:47], v6 offset:21504
v_mfma_f32_16x16x32_bf16 v[196:199], a[204:207], v[16:19], v[196:199]
v_mfma_f32_16x16x32_bf16 v[200:203], a[200:203], v[20:23], v[200:203]
ds_read_b128 v[16:19], v6 offset:22528
global_load_dwordx4 a[8:11], v5, s[20:21] offset:-2048 sc1
v_mfma_f32_16x16x32_bf16 v[204:207], a[204:207], v[20:23], v[204:207]
v_mfma_f32_16x16x32_bf16 v[144:147], a[208:211], v[24:27], v[144:147]
s_atomic_add s58, s[20:21], s53 offset:20 glc
v_mfma_f32_16x16x32_bf16 v[148:151], a[212:215], v[24:27], v[148:151]
ds_read_b128 v[20:23], v6 offset:23552
s_waitcnt lgkmcnt(5)
v_mfma_f32_16x16x32_bf16 v[152:155], a[208:211], v[28:31], v[152:155]
ds_read_b128 v[24:27], v6 offset:24576
global_load_dwordx4 a[12:15], v5, s[20:21] offset:-1024 sc1
v_mfma_f32_16x16x32_bf16 v[156:159], a[212:215], v[28:31], v[156:159]
v_mfma_f32_16x16x32_bf16 v[160:163], a[208:211], v[32:35], v[160:163]
ds_read_b128 v[28:31], v6 offset:25600
v_mfma_f32_16x16x32_bf16 v[164:167], a[212:215], v[32:35], v[164:167]
s_waitcnt lgkmcnt(5)
v_mfma_f32_16x16x32_bf16 v[168:171], a[208:211], v[36:39], v[168:171]
ds_read_b128 v[32:35], v6 offset:26624
global_load_dwordx4 a[16:19], v5, s[20:21] offset:0 sc1
v_mfma_f32_16x16x32_bf16 v[172:175], a[212:215], v[36:39], v[172:175]
v_mfma_f32_16x16x32_bf16 v[176:179], a[208:211], v[40:43], v[176:179]
ds_read_b128 v[36:39], v6 offset:27648
v_mfma_f32_16x16x32_bf16 v[180:183], a[212:215], v[40:43], v[180:183]
s_waitcnt lgkmcnt(5)
v_mfma_f32_16x16x32_bf16 v[184:187], a[208:211], v[44:47], v[184:187]
ds_read_b128 v[40:43], v6 offset:28672
global_load_dwordx4 a[20:23], v5, s[20:21] offset:1024 sc1
v_mfma_f32_16x16x32_bf16 v[188:191], a[212:215], v[44:47], v[188:191]
v_mfma_f32_16x16x32_bf16 v[192:195], a[208:211], v[16:19], v[192:195]
ds_read_b128 v[44:47], v6 offset:29696
v_mfma_f32_16x16x32_bf16 v[196:199], a[212:215], v[16:19], v[196:199]
s_waitcnt vmcnt(14) lgkmcnt(5)
v_mfma_f32_16x16x32_bf16 v[200:203], a[208:211], v[20:23], v[200:203]
ds_read_b128 v[16:19], v6 offset:30720
v_mfma_f32_16x16x32_bf16 v[204:207], a[212:215], v[20:23], v[204:207]
v_mfma_f32_16x16x32_bf16 v[144:147], a[216:219], v[24:27], v[144:147]
ds_read_b128 v[20:23], v6 offset:31744
global_load_dwordx4 a[24:27], v5, s[20:21] offset:2048 sc1
v_mfma_f32_16x16x32_bf16 v[148:151], a[220:223], v[24:27], v[148:151]
s_waitcnt lgkmcnt(5)
v_mfma_f32_16x16x32_bf16 v[152:155], a[216:219], v[28:31], v[152:155]
s_barrier
ds_read_b128 v[24:27], v6 offset:32768
v_mfma_f32_16x16x32_bf16 v[156:159], a[220:223], v[28:31], v[156:159]
v_mfma_f32_16x16x32_bf16 v[160:163], a[216:219], v[32:35], v[160:163]
ds_read_b128 v[28:31], v6 offset:33792
global_load_dwordx4 a[28:31], v5, s[20:21] offset:3072 sc1
v_mfma_f32_16x16x32_bf16 v[164:167], a[220:223], v[32:35], v[164:167]
s_waitcnt lgkmcnt(4)
v_mfma_f32_16x16x32_bf16 v[168:171], a[216:219], v[36:39], v[168:171]
ds_read_b128 v[32:35], v6 offset:34816
v_mfma_f32_16x16x32_bf16 v[172:175], a[220:223], v[36:39], v[172:175]
v_mfma_f32_16x16x32_bf16 v[176:179], a[216:219], v[40:43], v[176:179]
ds_read_b128 v[36:39], v6 offset:35840
v_add_u32 v5, 8192, v5
v_mfma_f32_16x16x32_bf16 v[180:183], a[220:223], v[40:43], v[180:183]
global_load_dwordx4 a[32:35], v5, s[20:21] offset:-4096 sc1
v_mfma_f32_16x16x32_bf16 v[184:187], a[216:219], v[44:47], v[184:187]
ds_read_b128 v[40:43], v6 offset:36864
v_mfma_f32_16x16x32_bf16 v[188:191], a[220:223], v[44:47], v[188:191]
s_waitcnt vmcnt(15) lgkmcnt(4)
v_mfma_f32_16x16x32_bf16 v[192:195], a[216:219], v[16:19], v[192:195]
ds_read_b128 v[44:47], v6 offset:37888
global_load_dwordx4 a[36:39], v5, s[20:21] offset:-3072 sc1
v_mfma_f32_16x16x32_bf16 v[196:199], a[220:223], v[16:19], v[196:199]
v_mfma_f32_16x16x32_bf16 v[200:203], a[216:219], v[20:23], v[200:203]
ds_read_b128 v[16:19], v6 offset:38912
v_mfma_f32_16x16x32_bf16 v[204:207], a[220:223], v[20:23], v[204:207]
v_mfma_f32_16x16x32_bf16 v[144:147], a[224:227], v[24:27], v[144:147]
ds_read_b128 v[20:23], v6 offset:39936
v_mfma_f32_16x16x32_bf16 v[148:151], a[228:231], v[24:27], v[148:151]
s_waitcnt lgkmcnt(4)
v_mfma_f32_16x16x32_bf16 v[152:155], a[224:227], v[28:31], v[152:155]
ds_read_b128 v[24:27], v6 offset:40960
s_add_u32 m0, s43, 114688
v_mfma_f32_16x16x32_bf16 v[156:159], a[228:231], v[28:31], v[156:159]
v_add_u32 v4, 16384, v4
v_mfma_f32_16x16x32_bf16 v[160:163], a[224:227], v[32:35], v[160:163]
ds_read_b128 v[28:31], v6 offset:41984
global_load_lds_dwordx4 v4, s[20:21] offset:0 sc1
v_mfma_f32_16x16x32_bf16 v[164:167], a[228:231], v[32:35], v[164:167]
v_mfma_f32_16x16x32_bf16 v[168:171], a[224:227], v[36:39], v[168:171]
ds_read_b128 v[32:35], v6 offset:43008
global_load_lds_dwordx4 v4, s[20:21] offset:1024 sc1
v_mfma_f32_16x16x32_bf16 v[172:175], a[228:231], v[36:39], v[172:175]
s_waitcnt lgkmcnt(4)
v_mfma_f32_16x16x32_bf16 v[176:179], a[224:227], v[40:43], v[176:179]
ds_read_b128 v[36:39], v6 offset:44032
v_mfma_f32_16x16x32_bf16 v[180:183], a[228:231], v[40:43], v[180:183]
v_mfma_f32_16x16x32_bf16 v[184:187], a[224:227], v[44:47], v[184:187]
ds_read_b128 v[40:43], v6 offset:45056
global_load_lds_dwordx4 v4, s[20:21] offset:2048 sc1
v_mfma_f32_16x16x32_bf16 v[188:191], a[228:231], v[44:47], v[188:191]
v_mfma_f32_16x16x32_bf16 v[192:195], a[224:227], v[16:19], v[192:195]
s_cmp_lt_u32 s58, 16
s_cbranch_scc0 L_back16
L_slow16:
s_waitcnt lgkmcnt(0)
s_cmp_ge_u32 s58, 16
s_cbranch_scc1 L_back16
s_mov_b32 s58, 0
s_atomic_add s58, s[20:21], s53 offset:20 glc
s_sub_u32 s46, s46, 1
s_cbranch_scc0 L_slow16
s_endpgm
L_back16:
v_mfma_f32_16x16x32_bf16 v[196:199], a[228:231], v[16:19], v[196:199]
ds_read_b128 v[44:47], v6 offset:46080
s_add_u32 s37, s53, 81920
v_lshlrev_b32 v212, 2, v2
s_waitcnt vmcnt(17) lgkmcnt(3)
v_mfma_f32_16x16x32_bf16 v[200:203], a[224:227], v[20:23], v[200:203]
ds_read_b128 v[16:19], v6 offset:47104
global_load_lds_dwordx4 v4, s[20:21] offset:3072 sc1
buffer_load_dwordx4 v[208:211], v212, s[20:23], s37 offen sc1
v_mfma_f32_16x16x32_bf16 v[204:207], a[228:231], v[20:23], v[204:207]
v_mfma_f32_16x16x32_bf16 v[144:147], a[232:235], v[24:27], v[144:147]
ds_read_b128 v[20:23], v6 offset:48128
v_mfma_f32_16x16x32_bf16 v[148:151], a[236:239], v[24:27], v[148:151]
v_mfma_f32_16x16x32_bf16 v[152:155], a[232:235], v[28:31], v[152:155]
s_barrier
ds_read_b128 v[24:27], v6 offset:49152
v_mfma_f32_16x16x32_bf16 v[156:159], a[236:239], v[28:31], v[156:159]
v_mfma_f32_16x16x32_bf16 v[160:163], a[232:235], v[32:35], v[160:163]
ds_read_b128 v[28:31], v6 offset:50176
global_load_dwordx4 a[40:43], v5, s[20:21] offset:-2048 sc1
v_mfma_f32_16x16x32_bf16 v[164:167], a[236:239], v[32:35], v[164:167]
s_waitcnt lgkmcnt(3)
v_mfma_f32_16x16x32_bf16 v[168:171], a[232:235], v[36:39], v[168:171]
ds_read_b128 v[32:35], v6 offset:51200
v_mfma_f32_16x16x32_bf16 v[172:175], a[236:239], v[36:39], v[172:175]
v_mfma_f32_16x16x32_bf16 v[176:179], a[232:235], v[40:43], v[176:179]
ds_read_b128 v[36:39], v6 offset:52224
global_load_dwordx4 a[44:47], v5, s[20:21] offset:-1024 sc1
v_mfma_f32_16x16x32_bf16 v[180:183], a[236:239], v[40:43], v[180:183]
v_mfma_f32_16x16x32_bf16 v[184:187], a[232:235], v[44:47], v[184:187]
ds_read_b128 v[40:43], v6 offset:53248
v_mfma_f32_16x16x32_bf16 v[188:191], a[236:239], v[44:47], v[188:191]
v_mfma_f32_16x16x32_bf16 v[192:195], a[232:235], v[16:19], v[192:195]
ds_read_b128 v[44:47], v6 offset:54272
v_mfma_f32_16x16x32_bf16 v[196:199], a[236:239], v[16:19], v[196:199]
s_waitcnt vmcnt(19) lgkmcnt(3)
v_mfma_f32_16x16x32_bf16 v[200:203], a[232:235], v[20:23], v[200:203]
ds_read_b128 v[16:19], v6 offset:55296
global_load_dwordx4 a[48:51], v5, s[20:21] offset:0 sc1
v_mfma_f32_16x16x32_bf16 v[204:207], a[236:239], v[20:23], v[204:207]
v_mfma_f32_16x16x32_bf16 v[144:147], a[240:243], v[24:27], v[144:147]
ds_read_b128 v[20:23], v6 offset:56320
v_mfma_f32_16x16x32_bf16 v[148:151], a[244:247], v[24:27], v[148:151]
v_mfma_f32_16x16x32_bf16 v[152:155], a[240:243], v[28:31], v[152:155]
ds_read_b128 v[24:27], v6 offset:57344
global_load_dwordx4 a[52:55], v5, s[20:21] offset:1024 sc1
v_mfma_f32_16x16x32_bf16 v[156:159], a[244:247], v[28:31], v[156:159]
v_mfma_f32_16x16x32_bf16 v[160:163], a[240:243], v[32:35], v[160:163]
ds_read_b128 v[28:31], v6 offset:58368
v_mfma_f32_16x16x32_bf16 v[164:167], a[244:247], v[32:35], v[164:167]
s_waitcnt lgkmcnt(3)
v_mfma_f32_16x16x32_bf16 v[168:171], a[240:243], v[36:39], v[168:171]
ds_read_b128 v[32:35], v6 offset:59392
s_add_u32 m0, s43, 0
v_mfma_f32_16x16x32_bf16 v[172:175], a[244:247], v[36:39], v[172:175]
v_add_u32 v4, 16384, v4
v_mfma_f32_16x16x32_bf16 v[176:179], a[240:243], v[40:43], v[176:179]
ds_read_b128 v[36:39], v6 offset:60416
global_load_lds_dwordx4 v4, s[20:21] offset:0 sc1
v_mfma_f32_16x16x32_bf16 v[180:183], a[244:247], v[40:43], v[180:183]
v_mfma_f32_16x16x32_bf16 v[184:187], a[240:243], v[44:47], v[184:187]
ds_read_b128 v[40:43], v6 offset:61440
global_load_lds_dwordx4 v4, s[20:21] offset:1024 sc1
v_mfma_f32_16x16x32_bf16 v[188:191], a[244:247], v[44:47], v[188:191]
v_mfma_f32_16x16x32_bf16 v[192:195], a[240:243], v[16:19], v[192:195]
ds_read_b128 v[44:47], v6 offset:62464
v_mfma_f32_16x16x32_bf16 v[196:199], a[244:247], v[16:19], v[196:199]
s_waitcnt vmcnt(21) lgkmcnt(3)
v_mfma_f32_16x16x32_bf16 v[200:203], a[240:243], v[20:23], v[200:203]
ds_read_b128 v[16:19], v6 offset:63488
v_mfma_f32_16x16x32_bf16 v[204:207], a[244:247], v[20:23], v[204:207]
v_mfma_f32_16x16x32_bf16 v[144:147], a[248:251], v[24:27], v[144:147]
ds_read_b128 v[20:23], v6 offset:64512
global_load_lds_dwordx4 v4, s[20:21] offset:2048 sc1
v_mfma_f32_16x16x32_bf16 v[148:151], a[252:255], v[24:27], v[148:151]
v_mfma_f32_16x16x32_bf16 v[152:155], a[248:251], v[28:31], v[152:155]
s_barrier
ds_read_b128 v[24:27], v7 offset:0
v_mfma_f32_16x16x32_bf16 v[156:159], a[252:255], v[28:31], v[156:159]
v_mfma_f32_16x16x32_bf16 v[160:163], a[248:251], v[32:35], v[160:163]
ds_read_b128 v[28:31], v7 offset:1024
global_load_lds_dwordx4 v4, s[20:21] offset:3072 sc1
v_mfma_f32_16x16x32_bf16 v[164:167], a[252:255], v[32:35], v[164:167]
s_waitcnt lgkmcnt(3)
v_mfma_f32_16x16x32_bf16 v[168:171], a[248:251], v[36:39], v[168:171]
ds_read_b128 v[32:35], v7 offset:2048
v_mfma_f32_16x16x32_bf16 v[172:175], a[252:255], v[36:39], v[172:175]
v_mfma_f32_16x16x32_bf16 v[176:179], a[248:251], v[40:43], v[176:179]
ds_read_b128 v[36:39], v7 offset:3072
global_load_dwordx4 a[56:59], v5, s[20:21] offset:2048 sc1
v_mfma_f32_16x16x32_bf16 v[180:183], a[252:255], v[40:43], v[180:183]
v_mfma_f32_16x16x32_bf16 v[184:187], a[248:251], v[44:47], v[184:187]
ds_read_b128 v[40:43], v7 offset:4096
v_mfma_f32_16x16x32_bf16 v[188:191], a[252:255], v[44:47], v[188:191]
v_mfma_f32_16x16x32_bf16 v[192:195], a[248:251], v[16:19], v[192:195]
ds_read_b128 v[44:47], v7 offset:5120
global_load_dwordx4 a[60:63], v5, s[20:21] offset:3072 sc1
v_mfma_f32_16x16x32_bf16 v[196:199], a[252:255], v[16:19], v[196:199]
s_waitcnt vmcnt(23) lgkmcnt(3)
v_mfma_f32_16x16x32_bf16 v[200:203], a[248:251], v[20:23], v[200:203]
ds_read_b128 v[16:19], v7 offset:6144
v_mfma_f32_16x16x32_bf16 v[204:207], a[252:255], v[20:23], v[204:207]
v_mfma_f32_16x16x32_bf16 v[144:147], a[0:3], v[24:27], v[144:147]
ds_read_b128 v[20:23], v7 offset:7168
v_mfma_f32_16x16x32_bf16 v[148:151], a[4:7], v[24:27], v[148:151]
v_mfma_f32_16x16x32_bf16 v[152:155], a[0:3], v[28:31], v[152:155]
ds_read_b128 v[24:27], v7 offset:8192
v_add_u32 v5, s61, v5
v_mfma_f32_16x16x32_bf16 v[156:159], a[4:7], v[28:31], v[156:159]
global_load_dwordx4 a[64:67], v5, s[20:21] offset:-4096 sc1
v_mfma_f32_16x16x32_bf16 v[160:163], a[0:3], v[32:35], v[160:163]
ds_read_b128 v[28:31], v7 offset:9216
v_mfma_f32_16x16x32_bf16 v[164:167], a[4:7], v[32:35], v[164:167]
s_waitcnt lgkmcnt(3)
v_mfma_f32_16x16x32_bf16 v[168:171], a[0:3], v[36:39], v[168:171]
ds_read_b128 v[32:35], v7 offset:10240
global_load_dwordx4 a[68:71], v5, s[20:21] offset:-3072 sc1
v_mfma_f32_16x16x32_bf16 v[172:175], a[4:7], v[36:39], v[172:175]
v_mfma_f32_16x16x32_bf16 v[176:179], a[0:3], v[40:43], v[176:179]
ds_read_b128 v[36:39], v7 offset:11264
v_mfma_f32_16x16x32_bf16 v[180:183], a[4:7], v[40:43], v[180:183]
v_mfma_f32_16x16x32_bf16 v[184:187], a[0:3], v[44:47], v[184:187]
ds_read_b128 v[40:43], v7 offset:12288
global_load_dwordx4 a[72:75], v5, s[20:21] offset:-2048 sc1
v_mfma_f32_16x16x32_bf16 v[188:191], a[4:7], v[44:47], v[188:191]
v_mfma_f32_16x16x32_bf16 v[192:195], a[0:3], v[16:19], v[192:195]
ds_read_b128 v[44:47], v7 offset:13312
v_mfma_f32_16x16x32_bf16 v[196:199], a[4:7], v[16:19], v[196:199]
s_waitcnt vmcnt(24) lgkmcnt(3)
v_mfma_f32_16x16x32_bf16 v[200:203], a[0:3], v[20:23], v[200:203]
ds_read_b128 v[16:19], v7 offset:14336
global_load_dwordx4 a[76:79], v5, s[20:21] offset:-1024 sc1
v_mfma_f32_16x16x32_bf16 v[204:207], a[4:7], v[20:23], v[204:207]
v_mfma_f32_16x16x32_bf16 v[144:147], a[8:11], v[24:27], v[144:147]
ds_read_b128 v[20:23], v7 offset:15360
v_mfma_f32_16x16x32_bf16 v[148:151], a[12:15], v[24:27], v[148:151]
v_mfma_f32_16x16x32_bf16 v[152:155], a[8:11], v[28:31], v[152:155]
s_barrier
ds_read_b128 v[24:27], v7 offset:16384
v_mfma_f32_16x16x32_bf16 v[156:159], a[12:15], v[28:31], v[156:159]
v_mfma_f32_16x16x32_bf16 v[160:163], a[8:11], v[32:35], v[160:163]
ds_read_b128 v[28:31], v7 offset:17408
s_add_u32 m0, s43, 16384
v_mfma_f32_16x16x32_bf16 v[164:167], a[12:15], v[32:35], v[164:167]
v_add_u32 v4, 16384, v4
s_waitcnt vmcnt(14)
v_mul_f32 v208, 0xba800000, v208
v_mul_f32 v209, 0x3a800000, v209
v_mul_f32 v210, 0xba800000, v210
v_mul_f32 v211, 0x3a800000, v211
s_waitcnt lgkmcnt(3)
v_mfma_f32_16x16x32_bf16 v[168:171], a[8:11], v[36:39], v[168:171]
ds_read_b128 v[32:35], v7 offset:18432
global_load_lds_dwordx4 v4, s[20:21] offset:0 sc1
v_mfma_f32_16x16x32_bf16 v[172:175], a[12:15], v[36:39], v[172:175]
global_load_lds_dwordx4 v4, s[20:21] offset:1024 sc1
v_fma_f32 v209, -v208, v208, v209
v_fma_f32 v211, -v210, v210, v211
v_mfma_f32_16x16x32_bf16 v[176:179], a[8:11], v[40:43], v[176:179]
ds_read_b128 v[36:39], v7 offset:19456
v_max_f32 v209, 0, v209
v_mfma_f32_16x16x32_bf16 v[180:183], a[12:15], v[40:43], v[180:183]
v_max_f32 v211, 0, v211
v_add_f32 v209, 0x3727c5ac, v209
v_mfma_f32_16x16x32_bf16 v[184:187], a[8:11], v[44:47], v[184:187]
ds_read_b128 v[40:43], v7 offset:20480
global_load_lds_dwordx4 v4, s[20:21] offset:2048 sc1
v_mfma_f32_16x16x32_bf16 v[188:191], a[12:15], v[44:47], v[188:191]
v_rsq_f32 v212, v209
v_mfma_f32_16x16x32_bf16 v[192:195], a[8:11], v[16:19], v[192:195]
ds_read_b128 v[44:47], v7 offset:21504
v_add_f32 v211, 0x3727c5ac, v211
v_mfma_f32_16x16x32_bf16 v[196:199], a[12:15], v[16:19], v[196:199]
v_mul_f32 v209, v209, v212
s_waitcnt lgkmcnt(3)
v_mfma_f32_16x16x32_bf16 v[200:203], a[8:11], v[20:23], v[200:203]
ds_read_b128 v[16:19], v7 offset:22528
v_cvt_pk_bf16_f32 v214, v208, v208
v_mfma_f32_16x16x32_bf16 v[204:207], a[12:15], v[20:23], v[204:207]
v_rsq_f32 v213, v211
v_mfma_f32_16x16x32_bf16 v[144:147], a[16:19], v[24:27], v[144:147]
ds_read_b128 v[20:23], v7 offset:23552
global_load_lds_dwordx4 v4, s[20:21] offset:3072 sc1
v_mfma_f32_16x16x32_bf16 v[148:151], a[20:23], v[24:27], v[148:151]
v_mul_f32 v211, v211, v213
v_cvt_pk_bf16_f32 v215, v209, v209
v_mfma_f32_16x16x32_bf16 v[152:155], a[16:19], v[28:31], v[152:155]
ds_read_b128 v[24:27], v7 offset:24576
v_lshlrev_b32 v216, 16, v214
v_mfma_f32_16x16x32_bf16 v[156:159], a[20:23], v[28:31], v[156:159]
v_lshlrev_b32 v217, 16, v215
v_sub_f32 v216, v208, v216
v_mfma_f32_16x16x32_bf16 v[160:163], a[16:19], v[32:35], v[160:163]
ds_read_b128 v[28:31], v7 offset:25600
global_load_dwordx4 a[80:83], v5, s[20:21] offset:0 sc1
v_mfma_f32_16x16x32_bf16 v[164:167], a[20:23], v[32:35], v[164:167]
v_sub_f32 v217, v209, v217
s_waitcnt lgkmcnt(3)
v_mfma_f32_16x16x32_bf16 v[168:171], a[16:19], v[36:39], v[168:171]
ds_read_b128 v[32:35], v7 offset:26624
v_cvt_pk_bf16_f32 v216, v216, v209
v_mfma_f32_16x16x32_bf16 v[172:175], a[20:23], v[36:39], v[172:175]
v_cvt_pk_bf16_f32 v217, v217, 0
v_cndmask_b32 v64, 0, v214, s[98:99]
v_mfma_f32_16x16x32_bf16 v[176:179], a[16:19], v[40:43], v[176:179]
ds_read_b128 v[36:39], v7 offset:27648
global_load_dwordx4 a[84:87], v5, s[20:21] offset:1024 sc1
v_mfma_f32_16x16x32_bf16 v[180:183], a[20:23], v[40:43], v[180:183]
v_cndmask_b32 v65, 0, v216, s[98:99]
v_cndmask_b32 v66, 0, v217, s[98:99]
v_mfma_f32_16x16x32_bf16 v[184:187], a[16:19], v[44:47], v[184:187]
ds_read_b128 v[40:43], v7 offset:28672
v_cvt_pk_bf16_f32 v214, v210, v210
v_mfma_f32_16x16x32_bf16 v[188:191], a[20:23], v[44:47], v[188:191]
v_cvt_pk_bf16_f32 v215, v211, v211
v_lshlrev_b32 v216, 16, v214
v_mfma_f32_16x16x32_bf16 v[192:195], a[16:19], v[16:19], v[192:195]
ds_read_b128 v[44:47], v7 offset:29696
global_load_dwordx4 a[88:91], v5, s[20:21] offset:2048 sc1
v_mfma_f32_16x16x32_bf16 v[196:199], a[20:23], v[16:19], v[196:199]
v_lshlrev_b32 v217, 16, v215
s_waitcnt lgkmcnt(3)
v_mfma_f32_16x16x32_bf16 v[200:203], a[16:19], v[20:23], v[200:203]
ds_read_b128 v[16:19], v7 offset:30720
v_sub_f32 v216, v210, v216
v_mfma_f32_16x16x32_bf16 v[204:207], a[20:23], v[20:23], v[204:207]
v_sub_f32 v217, v211, v217
v_cvt_pk_bf16_f32 v216, v216, v211
v_mfma_f32_16x16x32_bf16 v[144:147], a[24:27], v[24:27], v[144:147]
ds_read_b128 v[20:23], v7 offset:31744
global_load_dwordx4 a[92:95], v5, s[20:21] offset:3072 sc1
v_mfma_f32_16x16x32_bf16 v[148:151], a[28:31], v[24:27], v[148:151]
v_cvt_pk_bf16_f32 v217, v217, 0
v_cndmask_b32 v68, 0, v214, s[98:99]
v_mfma_f32_16x16x32_bf16 v[152:155], a[24:27], v[28:31], v[152:155]
s_barrier
ds_read_b128 v[24:27], v7 offset:32768
v_mfma_f32_16x16x32_bf16 v[156:159], a[28:31], v[28:31], v[156:159]
v_cndmask_b32 v69, 0, v216, s[98:99]
v_cndmask_b32 v70, 0, v217, s[98:99]
v_mfma_f32_16x16x32_bf16 v[160:163], a[24:27], v[32:35], v[160:163]
ds_read_b128 v[28:31], v7 offset:33792
v_mul_f32 v254, 0x3fb8aa3b, v212
v_mfma_f32_16x16x32_bf16 v[164:167], a[28:31], v[32:35], v[164:167]
v_mul_f32 v255, 0x3fb8aa3b, v213
s_waitcnt lgkmcnt(3)
v_mfma_f32_16x16x32_bf16 v[168:171], a[24:27], v[36:39], v[168:171]
ds_read_b128 v[32:35], v7 offset:34816
v_add_u32 v5, 8192, v5
v_mfma_f32_16x16x32_bf16 v[172:175], a[28:31], v[36:39], v[172:175]
global_load_dwordx4 a[96:99], v5, s[20:21] offset:-4096 sc1
v_and_b32 v214, 48, v11
v_mfma_f32_16x16x32_bf16 v[176:179], a[24:27], v[40:43], v[176:179]
ds_read_b128 v[36:39], v7 offset:35840
ds_bpermute_b32 v72, v214, v254 offset:0
v_mfma_f32_16x16x32_bf16 v[180:183], a[28:31], v[40:43], v[180:183]
ds_bpermute_b32 v73, v214, v254 offset:4
ds_bpermute_b32 v74, v214, v254 offset:8
v_mfma_f32_16x16x32_bf16 v[184:187], a[24:27], v[44:47], v[184:187]
ds_read_b128 v[40:43], v7 offset:36864
global_load_dwordx4 a[100:103], v5, s[20:21] offset:-3072 sc1
v_mfma_f32_16x16x32_bf16 v[188:191], a[28:31], v[44:47], v[188:191]
ds_bpermute_b32 v75, v214, v254 offset:12
ds_bpermute_b32 v76, v214, v255 offset:0
v_mfma_f32_16x16x32_bf16 v[192:195], a[24:27], v[16:19], v[192:195]
ds_read_b128 v[44:47], v7 offset:37888
ds_bpermute_b32 v77, v214, v255 offset:4
v_mfma_f32_16x16x32_bf16 v[196:199], a[28:31], v[16:19], v[196:199]
ds_bpermute_b32 v78, v214, v255 offset:8
s_waitcnt lgkmcnt(10)
v_mfma_f32_16x16x32_bf16 v[200:203], a[24:27], v[20:23], v[200:203]
ds_read_b128 v[16:19], v7 offset:38912
ds_bpermute_b32 v79, v214, v255 offset:12
v_mfma_f32_16x16x32_bf16 v[204:207], a[28:31], v[20:23], v[204:207]
s_add_u32 m0, s43, 32768
v_add_u32 v4, 16384, v4
v_mfma_f32_16x16x32_bf16 v[144:147], a[32:35], v[24:27], v[144:147]
ds_read_b128 v[20:23], v7 offset:39936
global_load_lds_dwordx4 v4, s[20:21] offset:0 sc1
v_mfma_f32_16x16x32_bf16 v[148:151], a[36:39], v[24:27], v[148:151]
s_add_u32 s37, s43, 131072
v_add_u32 v247, s37, v0
v_mfma_f32_16x16x32_bf16 v[152:155], a[32:35], v[28:31], v[152:155]
ds_read_b128 v[24:27], v7 offset:40960
global_load_lds_dwordx4 v4, s[20:21] offset:1024 sc1
v_mfma_f32_16x16x32_bf16 v[156:159], a[36:39], v[28:31], v[156:159]
s_lshr_b32 s37, s34, 1
s_and_b32 s38, s34, 1
v_mfma_f32_16x16x32_bf16 v[160:163], a[32:35], v[32:35], v[160:163]
ds_read_b128 v[28:31], v7 offset:41984
s_lshl_b32 s39, s37, 10
v_mfma_f32_16x16x32_bf16 v[164:167], a[36:39], v[32:35], v[164:167]
s_add_u32 s40, s39, 131072
s_waitcnt lgkmcnt(4)
v_mfma_f32_16x16x32_bf16 v[168:171], a[32:35], v[36:39], v[168:171]
ds_read_b128 v[32:35], v7 offset:43008
global_load_lds_dwordx4 v4, s[20:21] offset:2048 sc1
v_mfma_f32_16x16x32_bf16 v[172:175], a[36:39], v[36:39], v[172:175]
v_add_u32 v248, s40, v0
s_lshl_b32 s40, s38, 10
v_mfma_f32_16x16x32_bf16 v[176:179], a[32:35], v[40:43], v[176:179]
ds_read_b128 v[36:39], v7 offset:44032
s_add_u32 s40, s40, 133120
v_mfma_f32_16x16x32_bf16 v[180:183], a[36:39], v[40:43], v[180:183]
v_add_u32 v249, s40, v0
v_and_b32 v253, 48, v11
v_mfma_f32_16x16x32_bf16 v[184:187], a[32:35], v[44:47], v[184:187]
ds_read_b128 v[40:43], v7 offset:45056
global_load_lds_dwordx4 v4, s[20:21] offset:3072 sc1
v_mfma_f32_16x16x32_bf16 v[188:191], a[36:39], v[44:47], v[188:191]
v_lshl_add_u32 v252, v2, 4, v253
v_lshl_add_u32 v251, v253, 25, v2
v_mfma_f32_16x16x32_bf16 v[192:195], a[32:35], v[16:19], v[192:195]
ds_read_b128 v[44:47], v7 offset:46080
s_getpc_b64 s[4:5]
v_mfma_f32_16x16x32_bf16 v[196:199], a[36:39], v[16:19], v[196:199]
global_load_dword v13, v12, s[4:5]
s_waitcnt vmcnt(27) lgkmcnt(3)
v_mfma_f32_16x16x32_bf16 v[200:203], a[32:35], v[20:23], v[200:203]
ds_read_b128 v[16:19], v7 offset:47104
v_lshl_add_u32 v250, v253, 4, v2
v_mfma_f32_16x16x32_bf16 v[204:207], a[36:39], v[20:23], v[204:207]
s_lshl_b32 s40, s38, 11
s_add_u32 s39, s39, s40
v_mfma_f32_16x16x32_bf16 v[144:147], a[40:43], v[24:27], v[144:147]
ds_read_b128 v[20:23], v7 offset:48128
global_load_dwordx4 a[104:107], v5, s[20:21] offset:-2048 sc1
v_mfma_f32_16x16x32_bf16 v[148:151], a[44:47], v[24:27], v[148:151]
v_add_u32 v250, s39, v250
s_lshl_b32 s37, s37, 6
v_mfma_f32_16x16x32_bf16 v[152:155], a[40:43], v[28:31], v[152:155]
s_barrier
ds_read_b128 v[24:27], v7 offset:49152
v_mfma_f32_16x16x32_bf16 v[156:159], a[44:47], v[28:31], v[156:159]
s_lshl_b32 s38, s38, 28
s_add_u32 s37, s37, s38
v_mfma_f32_16x16x32_bf16 v[160:163], a[40:43], v[32:35], v[160:163]
ds_read_b128 v[28:31], v7 offset:50176
global_load_dwordx4 a[108:111], v5, s[20:21] offset:-1024 sc1
v_mfma_f32_16x16x32_bf16 v[164:167], a[44:47], v[32:35], v[164:167]
v_add_u32 v251, s37, v251
s_waitcnt lgkmcnt(3)
v_mfma_f32_16x16x32_bf16 v[168:171], a[40:43], v[36:39], v[168:171]
ds_read_b128 v[32:35], v7 offset:51200
v_mov_b32 v246, 0x3fb8aa3b
v_mfma_f32_16x16x32_bf16 v[172:175], a[44:47], v[36:39], v[172:175]
v_mov_b32 v240, 0x3f803f80
v_mov_b32 v241, 0x3f803f80
v_mfma_f32_16x16x32_bf16 v[176:179], a[40:43], v[40:43], v[176:179]
ds_read_b128 v[36:39], v7 offset:52224
global_load_dwordx4 a[112:115], v5, s[20:21] offset:0 sc1
v_mfma_f32_16x16x32_bf16 v[180:183], a[44:47], v[40:43], v[180:183]
v_mov_b32 v242, 0x3f803f80
v_mov_b32 v243, 0x3f803f80
v_mfma_f32_16x16x32_bf16 v[184:187], a[40:43], v[44:47], v[184:187]
ds_read_b128 v[40:43], v7 offset:53248
v_mfma_f32_16x16x32_bf16 v[188:191], a[44:47], v[44:47], v[188:191]
v_mfma_f32_16x16x32_bf16 v[192:195], a[40:43], v[16:19], v[192:195]
ds_read_b128 v[44:47], v7 offset:54272
global_load_dwordx4 a[116:119], v5, s[20:21] offset:1024 sc1
v_mfma_f32_16x16x32_bf16 v[196:199], a[44:47], v[16:19], v[196:199]
s_waitcnt vmcnt(29) lgkmcnt(3)
v_mfma_f32_16x16x32_bf16 v[200:203], a[40:43], v[20:23], v[200:203]
ds_read_b128 v[16:19], v7 offset:55296
v_mfma_f32_16x16x32_bf16 v[204:207], a[44:47], v[20:23], v[204:207]
v_mfma_f32_16x16x32_bf16 v[144:147], a[48:51], v[24:27], v[144:147]
ds_read_b128 v[20:23], v7 offset:56320
v_mfma_f32_16x16x32_bf16 v[148:151], a[52:55], v[24:27], v[148:151]
v_mfma_f32_16x16x32_bf16 v[152:155], a[48:51], v[28:31], v[152:155]
ds_read_b128 v[24:27], v7 offset:57344
global_load_dwordx4 a[120:123], v5, s[20:21] offset:2048 sc1
v_mfma_f32_16x16x32_bf16 v[156:159], a[52:55], v[28:31], v[156:159]
v_mfma_f32_16x16x32_bf16 v[160:163], a[48:51], v[32:35], v[160:163]
ds_read_b128 v[28:31], v7 offset:58368
v_mfma_f32_16x16x32_bf16 v[164:167], a[52:55], v[32:35], v[164:167]
s_waitcnt lgkmcnt(3)
v_mfma_f32_16x16x32_bf16 v[168:171], a[48:51], v[36:39], v[168:171]
ds_read_b128 v[32:35], v7 offset:59392
global_load_dwordx4 a[124:127], v5, s[20:21] offset:3072 sc1
v_mfma_f32_16x16x32_bf16 v[172:175], a[52:55], v[36:39], v[172:175]
v_mfma_f32_16x16x32_bf16 v[176:179], a[48:51], v[40:43], v[176:179]
ds_read_b128 v[36:39], v7 offset:60416
v_mfma_f32_16x16x32_bf16 v[180:183], a[52:55], v[40:43], v[180:183]
v_mfma_f32_16x16x32_bf16 v[184:187], a[48:51], v[44:47], v[184:187]
ds_read_b128 v[40:43], v7 offset:61440
v_add_u32 v5, s60, v5
v_mfma_f32_16x16x32_bf16 v[188:191], a[52:55], v[44:47], v[188:191]
global_load_dwordx4 a[128:131], v5, s[20:21] offset:-4096 sc1
v_mfma_f32_16x16x32_bf16 v[192:195], a[48:51], v[16:19], v[192:195]
ds_read_b128 v[44:47], v7 offset:62464
v_mfma_f32_16x16x32_bf16 v[196:199], a[52:55], v[16:19], v[196:199]
s_waitcnt vmcnt(26) lgkmcnt(3)
v_mfma_f32_16x16x32_bf16 v[200:203], a[48:51], v[20:23], v[200:203]
ds_read_b128 v[16:19], v7 offset:63488
global_load_dwordx4 a[132:135], v5, s[20:21] offset:-3072 sc1
v_mfma_f32_16x16x32_bf16 v[204:207], a[52:55], v[20:23], v[204:207]
v_mfma_f32_16x16x32_bf16 v[144:147], a[56:59], v[24:27], v[144:147]
ds_read_b128 v[20:23], v7 offset:64512
v_mfma_f32_16x16x32_bf16 v[148:151], a[60:63], v[24:27], v[148:151]
v_mfma_f32_16x16x32_bf16 v[152:155], a[56:59], v[28:31], v[152:155]
s_barrier
ds_read_b128 v[24:27], v6 offset:0
v_mfma_f32_16x16x32_bf16 v[156:159], a[60:63], v[28:31], v[156:159]
v_mfma_f32_16x16x32_bf16 v[160:163], a[56:59], v[32:35], v[160:163]
ds_read_b128 v[28:31], v6 offset:1024
global_load_dwordx4 a[136:139], v5, s[20:21] offset:-2048 sc1
v_mfma_f32_16x16x32_bf16 v[164:167], a[60:63], v[32:35], v[164:167]
s_waitcnt lgkmcnt(3)
v_mfma_f32_16x16x32_bf16 v[168:171], a[56:59], v[36:39], v[168:171]
ds_read_b128 v[32:35], v6 offset:2048
v_mfma_f32_16x16x32_bf16 v[172:175], a[60:63], v[36:39], v[172:175]
v_mfma_f32_16x16x32_bf16 v[176:179], a[56:59], v[40:43], v[176:179]
ds_read_b128 v[36:39], v6 offset:3072
global_load_dwordx4 a[140:143], v5, s[20:21] offset:-1024 sc1
v_mfma_f32_16x16x32_bf16 v[180:183], a[60:63], v[40:43], v[180:183]
v_mfma_f32_16x16x32_bf16 v[184:187], a[56:59], v[44:47], v[184:187]
ds_read_b128 v[40:43], v6 offset:4096
v_mfma_f32_16x16x32_bf16 v[188:191], a[60:63], v[44:47], v[188:191]
v_mfma_f32_16x16x32_bf16 v[192:195], a[56:59], v[16:19], v[192:195]
ds_read_b128 v[44:47], v6 offset:5120
global_load_dwordx4 a[144:147], v5, s[20:21] offset:0 sc1
v_mfma_f32_16x16x32_bf16 v[196:199], a[60:63], v[16:19], v[196:199]
s_waitcnt vmcnt(28) lgkmcnt(3)
v_mfma_f32_16x16x32_bf16 v[200:203], a[56:59], v[20:23], v[200:203]
ds_read_b128 v[16:19], v6 offset:6144
v_mfma_f32_16x16x32_bf16 v[204:207], a[60:63], v[20:23], v[204:207]
v_mfma_f32_16x16x32_bf16 v[144:147], a[64:67], v[24:27], v[144:147]
ds_read_b128 v[20:23], v6 offset:7168
global_load_dwordx4 a[148:151], v5, s[20:21] offset:1024 sc1
v_mfma_f32_16x16x32_bf16 v[148:151], a[68:71], v[24:27], v[148:151]
v_mfma_f32_16x16x32_bf16 v[152:155], a[64:67], v[28:31], v[152:155]
ds_read_b128 v[24:27], v6 offset:8192
v_mfma_f32_16x16x32_bf16 v[156:159], a[68:71], v[28:31], v[156:159]
v_mfma_f32_16x16x32_bf16 v[160:163], a[64:67], v[32:35], v[160:163]
ds_read_b128 v[28:31], v6 offset:9216
v_mfma_f32_16x16x32_bf16 v[164:167], a[68:71], v[32:35], v[164:167]
s_waitcnt lgkmcnt(3)
v_mfma_f32_16x16x32_bf16 v[168:171], a[64:67], v[36:39], v[168:171]
ds_read_b128 v[32:35], v6 offset:10240
global_load_dwordx4 a[152:155], v5, s[20:21] offset:2048 sc1
v_mfma_f32_16x16x32_bf16 v[172:175], a[68:71], v[36:39], v[172:175]
v_mfma_f32_16x16x32_bf16 v[176:179], a[64:67], v[40:43], v[176:179]
ds_read_b128 v[36:39], v6 offset:11264
v_mfma_f32_16x16x32_bf16 v[180:183], a[68:71], v[40:43], v[180:183]
v_mfma_f32_16x16x32_bf16 v[184:187], a[64:67], v[44:47], v[184:187]
ds_read_b128 v[40:43], v6 offset:12288
global_load_dwordx4 a[156:159], v5, s[20:21] offset:3072 sc1
v_mfma_f32_16x16x32_bf16 v[188:191], a[68:71], v[44:47], v[188:191]
v_mfma_f32_16x16x32_bf16 v[192:195], a[64:67], v[16:19], v[192:195]
ds_read_b128 v[44:47], v6 offset:13312
v_mfma_f32_16x16x32_bf16 v[196:199], a[68:71], v[16:19], v[196:199]
s_waitcnt vmcnt(29) lgkmcnt(3)
v_mfma_f32_16x16x32_bf16 v[200:203], a[64:67], v[20:23], v[200:203]
ds_read_b128 v[16:19], v6 offset:14336
v_add_u32 v5, 8192, v5
v_mfma_f32_16x16x32_bf16 v[204:207], a[68:71], v[20:23], v[204:207]
global_load_dwordx4 a[160:163], v5, s[20:21] offset:-4096 sc1
v_mfma_f32_16x16x32_bf16 v[144:147], a[72:75], v[24:27], v[144:147]
ds_read_b128 v[20:23], v6 offset:15360
v_mfma_f32_16x16x32_bf16 v[148:151], a[76:79], v[24:27], v[148:151]
v_mfma_f32_16x16x32_bf16 v[152:155], a[72:75], v[28:31], v[152:155]
ds_read_b128 v[24:27], v8 offset:0
global_load_dwordx4 a[164:167], v5, s[20:21] offset:-3072 sc1
v_mfma_f32_16x16x32_bf16 v[156:159], a[76:79], v[28:31], v[156:159]
v_mfma_f32_16x16x32_bf16 v[160:163], a[72:75], v[32:35], v[160:163]
ds_read_b128 v[28:31], v8 offset:256
v_mfma_f32_16x16x32_bf16 v[164:167], a[76:79], v[32:35], v[164:167]
s_waitcnt lgkmcnt(3)
v_mfma_f32_16x16x32_bf16 v[168:171], a[72:75], v[36:39], v[168:171]
ds_read_b128 v[32:35], v8 offset:512
v_mfma_f32_16x16x32_bf16 v[172:175], a[76:79], v[36:39], v[172:175]
v_mfma_f32_16x16x32_bf16 v[176:179], a[72:75], v[40:43], v[176:179]
ds_read_b128 v[36:39], v8 offset:768
s_add_u32 m0, s43, 49152
v_mfma_f32_16x16x32_bf16 v[180:183], a[76:79], v[40:43], v[180:183]
v_add_u32 v4, 16384, v4
v_mfma_f32_16x16x32_bf16 v[184:187], a[72:75], v[44:47], v[184:187]
ds_read_b128 v[40:43], v8 offset:1024
global_load_lds_dwordx4 v4, s[20:21] offset:0 sc1
v_mfma_f32_16x16x32_bf16 v[188:191], a[76:79], v[44:47], v[188:191]
v_mfma_f32_16x16x32_bf16 v[192:195], a[72:75], v[16:19], v[192:195]
ds_read_b128 v[44:47], v8 offset:1280
global_load_lds_dwordx4 v4, s[20:21] offset:1024 sc1
v_mfma_f32_16x16x32_bf16 v[196:199], a[76:79], v[16:19], v[196:199]
s_waitcnt vmcnt(29) lgkmcnt(3)
v_mfma_f32_16x16x32_bf16 v[200:203], a[72:75], v[20:23], v[200:203]
ds_read_b128 v[16:19], v8 offset:1536
v_mfma_f32_16x16x32_bf16 v[204:207], a[76:79], v[20:23], v[204:207]
v_mfma_f32_16x16x32_bf16 v[144:147], v[64:67], v[24:27], v[144:147]
ds_read_b128 v[20:23], v8 offset:1792
global_load_lds_dwordx4 v4, s[20:21] offset:2048 sc1
v_mfma_f32_16x16x32_bf16 v[148:151], v[68:71], v[24:27], v[148:151]
v_mfma_f32_16x16x32_bf16 v[152:155], v[64:67], v[28:31], v[152:155]
s_barrier
ds_read_b128 v[24:27], v6 offset:16384
v_mfma_f32_16x16x32_bf16 v[156:159], v[68:71], v[28:31], v[156:159]
v_mfma_f32_16x16x32_bf16 v[176:179], v[64:67], v[32:35], v[176:179]
ds_read_b128 v[28:31], v6 offset:17408
global_load_lds_dwordx4 v4, s[20:21] offset:3072 sc1
v_mfma_f32_16x16x32_bf16 v[180:183], v[68:71], v[32:35], v[180:183]
s_waitcnt lgkmcnt(3)
v_mfma_f32_16x16x32_bf16 v[184:187], v[64:67], v[36:39], v[184:187]
ds_read_b128 v[32:35], v6 offset:18432
v_mfma_f32_16x16x32_bf16 v[188:191], v[68:71], v[36:39], v[188:191]
v_mfma_f32_16x16x32_bf16 v[160:163], v[64:67], v[40:43], v[160:163]
ds_read_b128 v[36:39], v6 offset:19456
v_mfma_f32_16x16x32_bf16 v[164:167], v[68:71], v[40:43], v[164:167]
v_mfma_f32_16x16x32_bf16 v[168:171], v[64:67], v[44:47], v[168:171]
ds_read_b128 v[40:43], v6 offset:20480
global_load_dwordx4 a[168:171], v5, s[20:21] offset:-2048 sc1
v_mfma_f32_16x16x32_bf16 v[172:175], v[68:71], v[44:47], v[172:175]
v_mfma_f32_16x16x32_bf16 v[192:195], v[64:67], v[16:19], v[192:195]
ds_read_b128 v[44:47], v6 offset:21504
v_mfma_f32_16x16x32_bf16 v[196:199], v[68:71], v[16:19], v[196:199]
global_load_dwordx4 a[172:175], v5, s[20:21] offset:-1024 sc1
s_waitcnt vmcnt(29) lgkmcnt(3)
v_mfma_f32_16x16x32_bf16 v[200:203], v[64:67], v[20:23], v[200:203]
ds_read_b128 v[16:19], v6 offset:22528
v_mfma_f32_16x16x32_bf16 v[204:207], v[68:71], v[20:23], v[204:207]
v_mfma_f32_16x16x32_bf16 v[144:147], a[80:83], v[24:27], v[144:147]
ds_read_b128 v[20:23], v6 offset:23552
v_mfma_f32_16x16x32_bf16 v[148:151], a[84:87], v[24:27], v[148:151]
global_load_dwordx4 a[176:179], v5, s[20:21] offset:0 sc1
global_load_dwordx4 a[180:183], v5, s[20:21] offset:1024 sc1
v_mfma_f32_16x16x32_bf16 v[152:155], a[80:83], v[28:31], v[152:155]
ds_read_b128 v[24:27], v6 offset:24576
v_mfma_f32_16x16x32_bf16 v[156:159], a[84:87], v[28:31], v[156:159]
v_mfma_f32_16x16x32_bf16 v[144:147], a[88:91], v[32:35], v[144:147]
ds_read_b128 v[28:31], v6 offset:25600
v_mfma_f32_16x16x32_bf16 v[148:151], a[92:95], v[32:35], v[148:151]
global_load_dwordx4 a[184:187], v5, s[20:21] offset:2048 sc1
s_waitcnt vmcnt(23) lgkmcnt(3)
v_mfma_f32_16x16x32_bf16 v[152:155], a[88:91], v[36:39], v[152:155]
ds_read_b128 v[32:35], v6 offset:26624
global_load_dwordx4 a[188:191], v5, s[20:21] offset:3072 sc1
v_mfma_f32_16x16x32_bf16 v[156:159], a[92:95], v[36:39], v[156:159]
v_mfma_f32_16x16x32_bf16 v[144:147], a[96:99], v[40:43], v[144:147]
ds_read_b128 v[36:39], v6 offset:27648
v_mfma_f32_16x16x32_bf16 v[148:151], a[100:103], v[40:43], v[148:151]
v_mfma_f32_16x16x32_bf16 v[152:155], a[96:99], v[44:47], v[152:155]
ds_read_b128 v[40:43], v6 offset:28672
v_mfma_f32_16x16x32_bf16 v[156:159], a[100:103], v[44:47], v[156:159]
v_mfma_f32_16x16x32_bf16 v[144:147], a[104:107], v[16:19], v[144:147]
ds_read_b128 v[44:47], v6 offset:29696
v_mfma_f32_16x16x32_bf16 v[148:151], a[108:111], v[16:19], v[148:151]
s_waitcnt vmcnt(20) lgkmcnt(3)
v_mfma_f32_16x16x32_bf16 v[152:155], a[104:107], v[20:23], v[152:155]
ds_read_b128 v[16:19], v6 offset:30720
v_mfma_f32_16x16x32_bf16 v[156:159], a[108:111], v[20:23], v[156:159]
v_mfma_f32_16x16x32_bf16 v[144:147], a[112:115], v[24:27], v[144:147]
ds_read_b128 v[20:23], v6 offset:31744
s_add_u32 m0, s43, 65536
v_mfma_f32_16x16x32_bf16 v[148:151], a[116:119], v[24:27], v[148:151]
v_add_u32 v4, 16384, v4
v_mfma_f32_16x16x32_bf16 v[152:155], a[112:115], v[28:31], v[152:155]
s_barrier
ds_read_b128 v[24:27], v6 offset:32768
v_mfma_f32_16x16x32_bf16 v[156:159], a[116:119], v[28:31], v[156:159]
global_load_lds_dwordx4 v4, s[20:21] offset:0 sc1
v_mfma_f32_16x16x32_bf16 v[144:147], a[120:123], v[32:35], v[144:147]
ds_read_b128 v[28:31], v6 offset:33792
global_load_lds_dwordx4 v4, s[20:21] offset:1024 sc1
v_mfma_f32_16x16x32_bf16 v[148:151], a[124:127], v[32:35], v[148:151]
s_waitcnt vmcnt(18) lgkmcnt(3)
v_mfma_f32_16x16x32_bf16 v[152:155], a[120:123], v[36:39], v[152:155]
ds_read_b128 v[32:35], v6 offset:34816
v_mfma_f32_16x16x32_bf16 v[156:159], a[124:127], v[36:39], v[156:159]
v_mfma_f32_16x16x32_bf16 v[144:147], a[128:131], v[40:43], v[144:147]
ds_read_b128 v[36:39], v6 offset:35840
v_mfma_f32_16x16x32_bf16 v[148:151], a[132:135], v[40:43], v[148:151]
v_mfma_f32_16x16x32_bf16 v[152:155], a[128:131], v[44:47], v[152:155]
ds_read_b128 v[40:43], v6 offset:36864
global_load_lds_dwordx4 v4, s[20:21] offset:2048 sc1
v_mfma_f32_16x16x32_bf16 v[156:159], a[132:135], v[44:47], v[156:159]
global_load_lds_dwordx4 v4, s[20:21] offset:3072 sc1
v_mfma_f32_16x16x32_bf16 v[144:147], a[136:139], v[16:19], v[144:147]
ds_read_b128 v[44:47], v6 offset:37888
v_mfma_f32_16x16x32_bf16 v[148:151], a[140:143], v[16:19], v[148:151]
s_waitcnt vmcnt(16) lgkmcnt(3)
v_mfma_f32_16x16x32_bf16 v[152:155], a[136:139], v[20:23], v[152:155]
ds_read_b128 v[16:19], v6 offset:38912
v_mfma_f32_16x16x32_bf16 v[156:159], a[140:143], v[20:23], v[156:159]
v_mfma_f32_16x16x32_bf16 v[144:147], a[144:147], v[24:27], v[144:147]
ds_read_b128 v[20:23], v6 offset:39936
v_mfma_f32_16x16x32_bf16 v[148:151], a[148:151], v[24:27], v[148:151]
v_mfma_f32_16x16x32_bf16 v[152:155], a[144:147], v[28:31], v[152:155]
ds_read_b128 v[24:27], v6 offset:40960
s_add_u32 m0, s43, 81920
v_mfma_f32_16x16x32_bf16 v[156:159], a[148:151], v[28:31], v[156:159]
v_add_u32 v4, 16384, v4
v_mfma_f32_16x16x32_bf16 v[144:147], a[152:155], v[32:35], v[144:147]
ds_read_b128 v[28:31], v6 offset:41984
global_load_lds_dwordx4 v4, s[20:21] offset:0 sc1
v_mfma_f32_16x16x32_bf16 v[148:151], a[156:159], v[32:35], v[148:151]
s_waitcnt vmcnt(9) lgkmcnt(3)
v_mfma_f32_16x16x32_bf16 v[152:155], a[152:155], v[36:39], v[152:155]
ds_read_b128 v[32:35], v6 offset:43008
global_load_lds_dwordx4 v4, s[20:21] offset:1024 sc1
v_mfma_f32_16x16x32_bf16 v[156:159], a[156:159], v[36:39], v[156:159]
v_mfma_f32_16x16x32_bf16 v[144:147], a[160:163], v[40:43], v[144:147]
ds_read_b128 v[36:39], v6 offset:44032
v_mfma_f32_16x16x32_bf16 v[148:151], a[164:167], v[40:43], v[148:151]
v_mfma_f32_16x16x32_bf16 v[152:155], a[160:163], v[44:47], v[152:155]
ds_read_b128 v[40:43], v6 offset:45056
v_mfma_f32_16x16x32_bf16 v[156:159], a[164:167], v[44:47], v[156:159]
v_mfma_f32_16x16x32_bf16 v[144:147], a[168:171], v[16:19], v[144:147]
ds_read_b128 v[44:47], v6 offset:46080
global_load_lds_dwordx4 v4, s[20:21] offset:2048 sc1
v_mfma_f32_16x16x32_bf16 v[148:151], a[172:175], v[16:19], v[148:151]
s_waitcnt vmcnt(7) lgkmcnt(3)
v_mfma_f32_16x16x32_bf16 v[152:155], a[168:171], v[20:23], v[152:155]
ds_read_b128 v[16:19], v6 offset:47104
v_mfma_f32_16x16x32_bf16 v[156:159], a[172:175], v[20:23], v[156:159]
v_mfma_f32_16x16x32_bf16 v[144:147], a[176:179], v[24:27], v[144:147]
ds_read_b128 v[20:23], v6 offset:48128
global_load_lds_dwordx4 v4, s[20:21] offset:3072 sc1
v_mfma_f32_16x16x32_bf16 v[148:151], a[180:183], v[24:27], v[148:151]
v_mfma_f32_16x16x32_bf16 v[152:155], a[176:179], v[28:31], v[152:155]
s_barrier
ds_read_b128 v[24:27], v6 offset:49152
v_mfma_f32_16x16x32_bf16 v[156:159], a[180:183], v[28:31], v[156:159]
v_mfma_f32_16x16x32_bf16 v[144:147], a[184:187], v[32:35], v[144:147]
ds_read_b128 v[28:31], v6 offset:50176
s_add_u32 m0, s43, 98304
v_mfma_f32_16x16x32_bf16 v[148:151], a[188:191], v[32:35], v[148:151]
v_add_u32 v4, 16384, v4
s_waitcnt lgkmcnt(3)
v_mfma_f32_16x16x32_bf16 v[152:155], a[184:187], v[36:39], v[152:155]
ds_read_b128 v[32:35], v6 offset:51200
global_load_lds_dwordx4 v4, s[20:21] offset:0 sc1
v_mfma_f32_16x16x32_bf16 v[156:159], a[188:191], v[36:39], v[156:159]
v_mfma_f32_16x16x32_bf16 v[160:163], a[80:83], v[40:43], v[160:163]
ds_read_b128 v[36:39], v6 offset:52224
global_load_lds_dwordx4 v4, s[20:21] offset:1024 sc1
v_mfma_f32_16x16x32_bf16 v[164:167], a[84:87], v[40:43], v[164:167]
v_mul_f32 v144, v144, v72
v_mul_f32 v145, v145, v73
v_exp_f32 v208, v144 clamp
v_mul_f32 v146, v146, v74
v_mfma_f32_16x16x32_bf16 v[168:171], a[80:83], v[44:47], v[168:171]
ds_read_b128 v[40:43], v6 offset:53248
v_max_f32 v144, s62, v144
v_mfma_f32_16x16x32_bf16 v[172:175], a[84:87], v[44:47], v[172:175]
v_exp_f32 v209, v145 clamp
v_mfma_f32_16x16x32_bf16 v[160:163], a[88:91], v[16:19], v[160:163]
ds_read_b128 v[44:47], v6 offset:54272
global_load_lds_dwordx4 v4, s[20:21] offset:2048 sc1
v_mfma_f32_16x16x32_bf16 v[164:167], a[92:95], v[16:19], v[164:167]
v_mul_f32 v147, v147, v75
v_exp_f32 v210, v146 clamp
s_waitcnt lgkmcnt(3)
v_mfma_f32_16x16x32_bf16 v[168:171], a[88:91], v[20:23], v[168:171]
ds_read_b128 v[16:19], v6 offset:55296
v_max_f32 v145, s62, v145
v_mfma_f32_16x16x32_bf16 v[172:175], a[92:95], v[20:23], v[172:175]
v_exp_f32 v211, v147 clamp
v_mfma_f32_16x16x32_bf16 v[160:163], a[96:99], v[24:27], v[160:163]
ds_read_b128 v[20:23], v6 offset:56320
global_load_lds_dwordx4 v4, s[20:21] offset:3072 sc1
v_mfma_f32_16x16x32_bf16 v[164:167], a[100:103], v[24:27], v[164:167]
v_fma_f32 v144, v144, s63, v208
v_mul_f32 v148, v148, v76
v_max_f32 v146, s62, v146
v_fma_f32 v145, v145, s63, v209
v_mfma_f32_16x16x32_bf16 v[168:171], a[96:99], v[28:31], v[168:171]
ds_read_b128 v[24:27], v6 offset:57344
v_mul_f32 v149, v149, v77
v_mfma_f32_16x16x32_bf16 v[172:175], a[100:103], v[28:31], v[172:175]
v_exp_f32 v208, v148 clamp
v_mfma_f32_16x16x32_bf16 v[160:163], a[104:107], v[32:35], v[160:163]
ds_read_b128 v[28:31], v6 offset:58368
s_add_u32 m0, s43, 114688
v_mfma_f32_16x16x32_bf16 v[164:167], a[108:111], v[32:35], v[164:167]
v_add_u32 v4, 16384, v4
v_max_f32 v147, s62, v147
v_fma_f32 v146, v146, s63, v210
v_cvt_pk_bf16_f32 v216, v144, v145
s_waitcnt lgkmcnt(3)
v_mfma_f32_16x16x32_bf16 v[168:171], a[104:107], v[36:39], v[168:171]
ds_read_b128 v[32:35], v6 offset:59392
global_load_lds_dwordx4 v4, s[20:21] offset:0 sc1
v_mfma_f32_16x16x32_bf16 v[172:175], a[108:111], v[36:39], v[172:175]
v_exp_f32 v209, v149 clamp
v_mul_f32 v150, v150, v78
v_mfma_f32_16x16x32_bf16 v[160:163], a[112:115], v[40:43], v[160:163]
ds_read_b128 v[36:39], v6 offset:60416
global_load_lds_dwordx4 v4, s[20:21] offset:1024 sc1
v_mfma_f32_16x16x32_bf16 v[164:167], a[116:119], v[40:43], v[164:167]
v_exp_f32 v210, v150 clamp
v_max_f32 v148, s62, v148
v_mfma_f32_16x16x32_bf16 v[168:171], a[112:115], v[44:47], v[168:171]
ds_read_b128 v[40:43], v6 offset:61440
v_fma_f32 v147, v147, s63, v211
v_mfma_f32_16x16x32_bf16 v[172:175], a[116:119], v[44:47], v[172:175]
v_mul_f32 v151, v151, v79
v_max_f32 v149, s62, v149
v_fma_f32 v148, v148, s63, v208
v_mfma_f32_16x16x32_bf16 v[160:163], a[120:123], v[16:19], v[160:163]
ds_read_b128 v[44:47], v6 offset:62464
global_load_lds_dwordx4 v4, s[20:21] offset:2048 sc1
v_mfma_f32_16x16x32_bf16 v[164:167], a[124:127], v[16:19], v[164:167]
v_cvt_pk_bf16_f32 v217, v146, v147
v_mul_f32 v152, v152, v72
s_waitcnt vmcnt(11) lgkmcnt(3)
v_mfma_f32_16x16x32_bf16 v[168:171], a[120:123], v[20:23], v[168:171]
ds_read_b128 v[16:19], v6 offset:63488
v_max_f32 v150, s62, v150
v_mfma_f32_16x16x32_bf16 v[172:175], a[124:127], v[20:23], v[172:175]
v_exp_f32 v211, v151 clamp
v_fma_f32 v149, v149, s63, v209
v_mfma_f32_16x16x32_bf16 v[160:163], a[128:131], v[24:27], v[160:163]
ds_read_b128 v[20:23], v6 offset:64512
global_load_lds_dwordx4 v4, s[20:21] offset:3072 sc1
v_mfma_f32_16x16x32_bf16 v[164:167], a[132:135], v[24:27], v[164:167]
v_exp_f32 v208, v152 clamp
v_mul_f32 v153, v153, v73
v_mfma_f32_16x16x32_bf16 v[168:171], a[128:131], v[28:31], v[168:171]
s_barrier
ds_read_b128 v[24:27], v7 offset:0
v_mfma_f32_16x16x32_bf16 v[172:175], a[132:135], v[28:31], v[172:175]
v_max_f32 v151, s62, v151
v_fma_f32 v150, v150, s63, v210
v_cvt_pk_bf16_f32 v218, v148, v149
v_mfma_f32_16x16x32_bf16 v[160:163], a[136:139], v[32:35], v[160:163]
ds_read_b128 v[28:31], v7 offset:1024
s_add_u32 m0, s43, 0
v_mfma_f32_16x16x32_bf16 v[164:167], a[140:143], v[32:35], v[164:167]
v_add_u32 v4, 16384, v4
v_mul_f32 v154, v154, v74
v_exp_f32 v209, v153 clamp
v_max_f32 v152, s62, v152
s_waitcnt lgkmcnt(3)
v_mfma_f32_16x16x32_bf16 v[168:171], a[136:139], v[36:39], v[168:171]
ds_read_b128 v[32:35], v7 offset:2048
global_load_lds_dwordx4 v4, s[20:21] offset:0 sc1
v_mfma_f32_16x16x32_bf16 v[172:175], a[140:143], v[36:39], v[172:175]
v_exp_f32 v210, v154 clamp
v_fma_f32 v151, v151, s63, v211
v_mfma_f32_16x16x32_bf16 v[160:163], a[144:147], v[40:43], v[160:163]
ds_read_b128 v[36:39], v7 offset:3072
global_load_lds_dwordx4 v4, s[20:21] offset:1024 sc1
v_mfma_f32_16x16x32_bf16 v[164:167], a[148:151], v[40:43], v[164:167]
v_mul_f32 v155, v155, v75
v_max_f32 v153, s62, v153
v_fma_f32 v152, v152, s63, v208
v_mfma_f32_16x16x32_bf16 v[168:171], a[144:147], v[44:47], v[168:171]
ds_read_b128 v[40:43], v7 offset:4096
v_cvt_pk_bf16_f32 v219, v150, v151
v_mfma_f32_16x16x32_bf16 v[172:175], a[148:151], v[44:47], v[172:175]
v_exp_f32 v211, v155 clamp
v_mfma_f32_16x16x32_bf16 v[160:163], a[152:155], v[16:19], v[160:163]
ds_read_b128 v[44:47], v7 offset:5120
global_load_lds_dwordx4 v4, s[20:21] offset:2048 sc1
v_mfma_f32_16x16x32_bf16 v[164:167], a[156:159], v[16:19], v[164:167]
v_mul_f32 v156, v156, v76
v_max_f32 v154, s62, v154
v_fma_f32 v153, v153, s63, v209
s_waitcnt lgkmcnt(3)
v_mfma_f32_16x16x32_bf16 v[168:171], a[152:155], v[20:23], v[168:171]
ds_read_b128 v[16:19], v7 offset:6144
v_mul_f32 v157, v157, v77
v_mfma_f32_16x16x32_bf16 v[172:175], a[156:159], v[20:23], v[172:175]
v_exp_f32 v208, v156 clamp
v_max_f32 v155, s62, v155
v_mfma_f32_16x16x32_bf16 v[160:163], a[160:163], v[24:27], v[160:163]
ds_read_b128 v[20:23], v7 offset:7168
global_load_lds_dwordx4 v4, s[20:21] offset:3072 sc1
v_mfma_f32_16x16x32_bf16 v[164:167], a[164:167], v[24:27], v[164:167]
v_exp_f32 v209, v157 clamp
v_fma_f32 v154, v154, s63, v210
v_mfma_f32_16x16x32_bf16 v[168:171], a[160:163], v[28:31], v[168:171]
ds_read_b128 v[24:27], v7 offset:8192
v_cvt_pk_bf16_f32 v220, v152, v153
v_mfma_f32_16x16x32_bf16 v[172:175], a[164:167], v[28:31], v[172:175]
v_mul_f32 v158, v158, v78
v_max_f32 v156, s62, v156
v_mfma_f32_16x16x32_bf16 v[160:163], a[168:171], v[32:35], v[160:163]
ds_read_b128 v[28:31], v7 offset:9216
s_add_u32 m0, s43, 16384
v_mfma_f32_16x16x32_bf16 v[164:167], a[172:175], v[32:35], v[164:167]
v_add_u32 v4, 16384, v4
v_fma_f32 v155, v155, s63, v211
v_mul_f32 v159, v159, v79
s_waitcnt lgkmcnt(3)
v_mfma_f32_16x16x32_bf16 v[168:171], a[168:171], v[36:39], v[168:171]
ds_read_b128 v[32:35], v7 offset:10240
global_load_lds_dwordx4 v4, s[20:21] offset:0 sc1
v_mfma_f32_16x16x32_bf16 v[172:175], a[172:175], v[36:39], v[172:175]
v_exp_f32 v210, v158 clamp
v_max_f32 v157, s62, v157
v_fma_f32 v156, v156, s63, v208
v_mfma_f32_16x16x32_bf16 v[160:163], a[176:179], v[40:43], v[160:163]
ds_read_b128 v[36:39], v7 offset:11264
global_load_lds_dwordx4 v4, s[20:21] offset:1024 sc1
v_mfma_f32_16x16x32_bf16 v[164:167], a[180:183], v[40:43], v[164:167]
v_exp_f32 v211, v159 clamp
v_cvt_pk_bf16_f32 v221, v154, v155
v_max_f32 v158, s62, v158
v_mfma_f32_16x16x32_bf16 v[168:171], a[176:179], v[44:47], v[168:171]
ds_read_b128 v[40:43], v7 offset:12288
v_fma_f32 v157, v157, s63, v209
v_mfma_f32_16x16x32_bf16 v[172:175], a[180:183], v[44:47], v[172:175]
v_max_f32 v159, s62, v159
v_fma_f32 v158, v158, s63, v210
v_mfma_f32_16x16x32_bf16 v[160:163], a[184:187], v[16:19], v[160:163]
ds_read_b128 v[44:47], v7 offset:13312
global_load_lds_dwordx4 v4, s[20:21] offset:2048 sc1
v_mfma_f32_16x16x32_bf16 v[164:167], a[188:191], v[16:19], v[164:167]
v_cvt_pk_bf16_f32 v222, v156, v157
v_fma_f32 v159, v159, s63, v211
v_cvt_pk_bf16_f32 v223, v158, v159
s_waitcnt vmcnt(15) lgkmcnt(3)
v_mfma_f32_16x16x32_bf16 v[168:171], a[184:187], v[20:23], v[168:171]
ds_read_b128 v[16:19], v7 offset:14336
ds_write_b128 v247, v[216:219] offset:0
v_mfma_f32_16x16x32_bf16 v[172:175], a[188:191], v[20:23], v[172:175]
v_mfma_f32_16x16x32_bf16 v[176:179], a[80:83], v[24:27], v[176:179]
ds_read_b128 v[20:23], v7 offset:15360
global_load_lds_dwordx4 v4, s[20:21] offset:3072 sc1
v_mfma_f32_16x16x32_bf16 v[180:183], a[84:87], v[24:27], v[180:183]
v_mfma_f32_16x16x32_bf16 v[184:187], a[80:83], v[28:31], v[184:187]
s_barrier
ds_read_b128 v[24:27], v7 offset:16384
ds_write_b128 v247, v[220:223] offset:1024
v_mfma_f32_16x16x32_bf16 v[188:191], a[84:87], v[28:31], v[188:191]
v_mfma_f32_16x16x32_bf16 v[176:179], a[88:91], v[32:35], v[176:179]
ds_read_b128 v[28:31], v7 offset:17408
s_add_u32 m0, s43, 32768
v_mfma_f32_16x16x32_bf16 v[180:183], a[92:95], v[32:35], v[180:183]
v_add_u32 v4, 16384, v4
s_waitcnt lgkmcnt(5)
v_mfma_f32_16x16x32_bf16 v[184:187], a[88:91], v[36:39], v[184:187]
ds_read_b128 v[32:35], v7 offset:18432
global_load_lds_dwordx4 v4, s[20:21] offset:0 sc1
v_mfma_f32_16x16x32_bf16 v[188:191], a[92:95], v[36:39], v[188:191]
s_add_u32 s37, s50, 139264
s_add_u32 s38, s50, 147456
v_mul_f32 v160, v160, v72
v_mul_f32 v161, v161, v73
v_mul_f32 v162, v162, v74
v_mfma_f32_16x16x32_bf16 v[176:179], a[96:99], v[40:43], v[176:179]
ds_read_b128 v[36:39], v7 offset:19456
global_load_lds_dwordx4 v4, s[20:21] offset:1024 sc1
v_mfma_f32_16x16x32_bf16 v[180:183], a[100:103], v[40:43], v[180:183]
v_mul_f32 v163, v163, v75
v_mul_f32 v164, v164, v76
v_mul_f32 v165, v165, v77
v_mfma_f32_16x16x32_bf16 v[184:187], a[96:99], v[44:47], v[184:187]
ds_read_b128 v[40:43], v7 offset:20480
v_mul_f32 v166, v166, v78
v_mfma_f32_16x16x32_bf16 v[188:191], a[100:103], v[44:47], v[188:191]
v_mul_f32 v167, v167, v79
v_cvt_pk_bf16_f32 v216, v160, v161
v_mfma_f32_16x16x32_bf16 v[176:179], a[104:107], v[16:19], v[176:179]
ds_read_b128 v[44:47], v7 offset:21504
global_load_lds_dwordx4 v4, s[20:21] offset:2048 sc1
v_mfma_f32_16x16x32_bf16 v[180:183], a[108:111], v[16:19], v[180:183]
v_cvt_pk_bf16_f32 v217, v162, v163
v_cvt_pk_bf16_f32 v218, v164, v165
v_cvt_pk_bf16_f32 v219, v166, v167
s_waitcnt lgkmcnt(3)
v_mfma_f32_16x16x32_bf16 v[184:187], a[104:107], v[20:23], v[184:187]
ds_read_b128 v[16:19], v7 offset:22528
ds_write_b128 v247, v[216:219] offset:2048
v_mfma_f32_16x16x32_bf16 v[188:191], a[108:111], v[20:23], v[188:191]
v_mul_f32 v168, v168, v72
v_mul_f32 v169, v169, v73
v_mfma_f32_16x16x32_bf16 v[176:179], a[112:115], v[24:27], v[176:179]
ds_read_b128 v[20:23], v7 offset:23552
global_load_lds_dwordx4 v4, s[20:21] offset:3072 sc1
v_mfma_f32_16x16x32_bf16 v[180:183], a[116:119], v[24:27], v[180:183]
v_mul_f32 v170, v170, v74
v_mul_f32 v171, v171, v75
v_mul_f32 v172, v172, v76
v_mfma_f32_16x16x32_bf16 v[184:187], a[112:115], v[28:31], v[184:187]
ds_read_b128 v[24:27], v7 offset:24576
v_mul_f32 v173, v173, v77
v_mfma_f32_16x16x32_bf16 v[188:191], a[116:119], v[28:31], v[188:191]
v_mul_f32 v174, v174, v78
v_mul_f32 v175, v175, v79
v_mfma_f32_16x16x32_bf16 v[176:179], a[120:123], v[32:35], v[176:179]
ds_read_b128 v[28:31], v7 offset:25600
s_add_u32 m0, s43, 49152
v_mfma_f32_16x16x32_bf16 v[180:183], a[124:127], v[32:35], v[180:183]
v_add_u32 v4, 16384, v4
v_cvt_pk_bf16_f32 v220, v168, v169
v_cvt_pk_bf16_f32 v221, v170, v171
v_cvt_pk_bf16_f32 v222, v172, v173
s_waitcnt lgkmcnt(4)
v_mfma_f32_16x16x32_bf16 v[184:187], a[120:123], v[36:39], v[184:187]
ds_read_b128 v[32:35], v7 offset:26624
global_load_lds_dwordx4 v4, s[20:21] offset:0 sc1
v_mfma_f32_16x16x32_bf16 v[188:191], a[124:127], v[36:39], v[188:191]
v_cvt_pk_bf16_f32 v223, v174, v175
v_mfma_f32_16x16x32_bf16 v[176:179], a[128:131], v[40:43], v[176:179]
ds_read_b128 v[36:39], v7 offset:27648
global_load_lds_dwordx4 v4, s[20:21] offset:1024 sc1
ds_write_b128 v247, v[220:223] offset:3072
v_mfma_f32_16x16x32_bf16 v[180:183], a[132:135], v[40:43], v[180:183]
v_mfma_f32_16x16x32_bf16 v[184:187], a[128:131], v[44:47], v[184:187]
ds_read_b128 v[40:43], v7 offset:28672
v_mfma_f32_16x16x32_bf16 v[188:191], a[132:135], v[44:47], v[188:191]
v_mfma_f32_16x16x32_bf16 v[176:179], a[136:139], v[16:19], v[176:179]
ds_read_b128 v[44:47], v7 offset:29696
global_load_lds_dwordx4 v4, s[20:21] offset:2048 sc1
v_mfma_f32_16x16x32_bf16 v[180:183], a[140:143], v[16:19], v[180:183]
s_waitcnt vmcnt(19) lgkmcnt(4)
v_mfma_f32_16x16x32_bf16 v[184:187], a[136:139], v[20:23], v[184:187]
ds_read_b128 v[16:19], v7 offset:30720
v_mfma_f32_16x16x32_bf16 v[188:191], a[140:143], v[20:23], v[188:191]
v_mfma_f32_16x16x32_bf16 v[176:179], a[144:147], v[24:27], v[176:179]
ds_read_b128 v[20:23], v7 offset:31744
global_load_lds_dwordx4 v4, s[20:21] offset:3072 sc1
v_mfma_f32_16x16x32_bf16 v[180:183], a[148:151], v[24:27], v[180:183]
s_waitcnt lgkmcnt(4)
s_barrier
ds_read_b128 v[144:147], v248 offset:0
ds_read_b128 v[160:163], v249 offset:0
v_mfma_f32_16x16x32_bf16 v[184:187], a[144:147], v[28:31], v[184:187]
s_barrier
ds_read_b128 v[24:27], v7 offset:32768
ds_read_b128 v[148:151], v248 offset:4096
ds_read_b128 v[164:167], v249 offset:4096
v_mfma_f32_16x16x32_bf16 v[188:191], a[148:151], v[28:31], v[188:191]
v_mfma_f32_16x16x32_bf16 v[176:179], a[152:155], v[32:35], v[176:179]
ds_read_b128 v[28:31], v7 offset:33792
ds_read_b128 v[152:155], v248 offset:8192
ds_read_b128 v[168:171], v249 offset:8192
v_mfma_f32_16x16x32_bf16 v[180:183], a[156:159], v[32:35], v[180:183]
s_add_u32 m0, s43, 65536
v_add_u32 v4, 16384, v4
v_mfma_f32_16x16x32_bf16 v[184:187], a[152:155], v[36:39], v[184:187]
ds_read_b128 v[32:35], v7 offset:34816
global_load_lds_dwordx4 v4, s[20:21] offset:0 sc1
ds_read_b128 v[156:159], v248 offset:12288
ds_read_b128 v[172:175], v249 offset:12288
v_mfma_f32_16x16x32_bf16 v[188:191], a[156:159], v[36:39], v[188:191]
s_waitcnt lgkmcnt(11)
v_mfma_f32_16x16x32_bf16 v[176:179], a[160:163], v[40:43], v[176:179]
ds_read_b128 v[36:39], v7 offset:35840
v_mfma_f32_16x16x32_bf16 v[180:183], a[164:167], v[40:43], v[180:183]
v_mfma_f32_16x16x32_bf16 v[184:187], a[160:163], v[44:47], v[184:187]
ds_read_b128 v[40:43], v7 offset:36864
global_load_lds_dwordx4 v4, s[20:21] offset:1024 sc1
v_mfma_f32_16x16x32_bf16 v[188:191], a[164:167], v[44:47], v[188:191]
v_mfma_f32_16x16x32_bf16 v[176:179], a[168:171], v[16:19], v[176:179]
ds_read_b128 v[44:47], v7 offset:37888
v_mfma_f32_16x16x32_bf16 v[180:183], a[172:175], v[16:19], v[180:183]
v_mfma_f32_16x16x32_bf16 v[184:187], a[168:171], v[20:23], v[184:187]
ds_read_b128 v[16:19], v7 offset:38912
global_load_lds_dwordx4 v4, s[20:21] offset:2048 sc1
v_mfma_f32_16x16x32_bf16 v[188:191], a[172:175], v[20:23], v[188:191]
s_waitcnt lgkmcnt(3)
v_mfma_f32_16x16x32_bf16 v[176:179], a[176:179], v[24:27], v[176:179]
ds_read_b128 v[20:23], v7 offset:39936
v_mfma_f32_16x16x32_bf16 v[180:183], a[180:183], v[24:27], v[180:183]
v_mfma_f32_16x16x32_bf16 v[232:235], v[160:163], v[144:147], 0
v_mfma_f32_16x16x32_bf16 v[236:239], v[240:243], v[144:147], 0
v_mfma_f32_16x16x32_bf16 v[184:187], a[176:179], v[28:31], v[184:187]
ds_read_b128 v[24:27], v7 offset:40960
global_load_lds_dwordx4 v4, s[20:21] offset:3072 sc1
v_mfma_f32_16x16x32_bf16 v[188:191], a[180:183], v[28:31], v[188:191]
v_mfma_f32_16x16x32_bf16 v[232:235], v[164:167], v[148:151], v[232:235]
v_mfma_f32_16x16x32_bf16 v[236:239], v[240:243], v[148:151], v[236:239]
v_mfma_f32_16x16x32_bf16 v[176:179], a[184:187], v[32:35], v[176:179]
ds_read_b128 v[28:31], v7 offset:41984
v_mfma_f32_16x16x32_bf16 v[180:183], a[188:191], v[32:35], v[180:183]
v_mfma_f32_16x16x32_bf16 v[232:235], v[168:171], v[152:155], v[232:235]
v_mfma_f32_16x16x32_bf16 v[184:187], a[184:187], v[36:39], v[184:187]
v_mfma_f32_16x16x32_bf16 v[236:239], v[240:243], v[152:155], v[236:239]
v_mfma_f32_16x16x32_bf16 v[188:191], a[188:191], v[36:39], v[188:191]
ds_read_b128 v[32:35], v7 offset:43008
v_mfma_f32_16x16x32_bf16 v[232:235], v[172:175], v[156:159], v[232:235]
s_waitcnt lgkmcnt(3)
v_mfma_f32_16x16x32_bf16 v[192:195], a[80:83], v[40:43], v[192:195]
ds_read_b128 v[36:39], v7 offset:44032
v_mfma_f32_16x16x32_bf16 v[196:199], a[84:87], v[40:43], v[196:199]
v_mfma_f32_16x16x32_bf16 v[236:239], v[240:243], v[156:159], v[236:239]
v_mfma_f32_16x16x32_bf16 v[200:203], a[80:83], v[44:47], v[200:203]
ds_read_b128 v[40:43], v7 offset:45056
v_mfma_f32_16x16x32_bf16 v[204:207], a[84:87], v[44:47], v[204:207]
v_mfma_f32_16x16x32_bf16 v[192:195], a[88:91], v[16:19], v[192:195]
ds_read_b128 v[44:47], v7 offset:46080
v_mfma_f32_16x16x32_bf16 v[196:199], a[92:95], v[16:19], v[196:199]
v_mfma_f32_16x16x32_bf16 v[200:203], a[88:91], v[20:23], v[200:203]
buffer_atomic_add_f32 v232, v250, s[20:23], s37 offen offset:0 sc1
buffer_atomic_add_f32 v233, v250, s[20:23], s37 offen offset:64 sc1
v_mfma_f32_16x16x32_bf16 v[204:207], a[92:95], v[20:23], v[204:207]
ds_read_b128 v[16:19], v7 offset:47104
s_waitcnt vmcnt(22) lgkmcnt(3)
v_mfma_f32_16x16x32_bf16 v[192:195], a[96:99], v[24:27], v[192:195]
ds_read_b128 v[20:23], v7 offset:48128
buffer_atomic_add_f32 v234, v250, s[20:23], s37 offen offset:128 sc1
buffer_atomic_add_f32 v235, v250, s[20:23], s37 offen offset:192 sc1
v_mfma_f32_16x16x32_bf16 v[196:199], a[100:103], v[24:27], v[196:199]
buffer_atomic_add_f32 v236, v251, s[20:23], s38 offen sc1
s_mov_b32 s59, 0
v_mfma_f32_16x16x32_bf16 v[200:203], a[96:99], v[28:31], v[200:203]
s_barrier
ds_read_b128 v[24:27], v7 offset:49152
v_mfma_f32_16x16x32_bf16 v[204:207], a[100:103], v[28:31], v[204:207]
s_add_u32 m0, s43, 81920
v_add_u32 v4, 16384, v4
v_mfma_f32_16x16x32_bf16 v[192:195], a[104:107], v[32:35], v[192:195]
ds_read_b128 v[28:31], v7 offset:50176
global_load_lds_dwordx4 v4, s[20:21] offset:0 sc1
v_mfma_f32_16x16x32_bf16 v[196:199], a[108:111], v[32:35], v[196:199]
global_load_lds_dwordx4 v4, s[20:21] offset:1024 sc1
global_load_lds_dwordx4 v4, s[20:21] offset:2048 sc1
v_mul_f32 v176, v176, v72
v_mul_f32 v177, v177, v73
v_mfma_f32_16x16x32_bf16 v[200:203], a[104:107], v[36:39], v[200:203]
ds_read_b128 v[32:35], v7 offset:51200
global_load_lds_dwordx4 v4, s[20:21] offset:3072 sc1
v_mfma_f32_16x16x32_bf16 v[204:207], a[108:111], v[36:39], v[204:207]
v_mul_f32 v178, v178, v74
v_exp_f32 v208, v176 clamp
v_exp_f32 v209, v177 clamp
s_waitcnt lgkmcnt(3)
v_mfma_f32_16x16x32_bf16 v[192:195], a[112:115], v[40:43], v[192:195]
ds_read_b128 v[36:39], v7 offset:52224
v_max_f32 v176, s62, v176
v_mfma_f32_16x16x32_bf16 v[196:199], a[116:119], v[40:43], v[196:199]
v_exp_f32 v210, v178 clamp
v_mfma_f32_16x16x32_bf16 v[200:203], a[112:115], v[44:47], v[200:203]
ds_read_b128 v[40:43], v7 offset:53248
v_mul_f32 v179, v179, v75
v_mfma_f32_16x16x32_bf16 v[204:207], a[116:119], v[44:47], v[204:207]
v_exp_f32 v211, v179 clamp
v_mfma_f32_16x16x32_bf16 v[192:195], a[120:123], v[16:19], v[192:195]
ds_read_b128 v[44:47], v7 offset:54272
v_max_f32 v177, s62, v177
v_mfma_f32_16x16x32_bf16 v[196:199], a[124:127], v[16:19], v[196:199]
v_fma_f32 v176, v176, s63, v208
v_mul_f32 v180, v180, v76
v_mfma_f32_16x16x32_bf16 v[200:203], a[120:123], v[20:23], v[200:203]
ds_read_b128 v[16:19], v7 offset:55296
v_max_f32 v178, s62, v178
v_mfma_f32_16x16x32_bf16 v[204:207], a[124:127], v[20:23], v[204:207]
v_fma_f32 v177, v177, s63, v209
v_mul_f32 v181, v181, v77
s_waitcnt lgkmcnt(3)
v_mfma_f32_16x16x32_bf16 v[192:195], a[128:131], v[24:27], v[192:195]
ds_read_b128 v[20:23], v7 offset:56320
v_max_f32 v179, s62, v179
v_mfma_f32_16x16x32_bf16 v[196:199], a[132:135], v[24:27], v[196:199]
v_exp_f32 v208, v180 clamp
v_fma_f32 v178, v178, s63, v210
v_mfma_f32_16x16x32_bf16 v[200:203], a[128:131], v[28:31], v[200:203]
ds_read_b128 v[24:27], v7 offset:57344
v_cvt_pk_bf16_f32 v216, v176, v177
v_mfma_f32_16x16x32_bf16 v[204:207], a[132:135], v[28:31], v[204:207]
v_exp_f32 v209, v181 clamp
v_mfma_f32_16x16x32_bf16 v[192:195], a[136:139], v[32:35], v[192:195]
ds_read_b128 v[28:31], v7 offset:58368
v_mul_f32 v182, v182, v78
v_mfma_f32_16x16x32_bf16 v[196:199], a[140:143], v[32:35], v[196:199]
v_exp_f32 v210, v182 clamp
v_mfma_f32_16x16x32_bf16 v[200:203], a[136:139], v[36:39], v[200:203]
ds_read_b128 v[32:35], v7 offset:59392
v_max_f32 v180, s62, v180
v_mfma_f32_16x16x32_bf16 v[204:207], a[140:143], v[36:39], v[204:207]
v_fma_f32 v179, v179, s63, v211
v_mul_f32 v183, v183, v79
s_waitcnt lgkmcnt(3)
v_mfma_f32_16x16x32_bf16 v[192:195], a[144:147], v[40:43], v[192:195]
ds_read_b128 v[36:39], v7 offset:60416
v_max_f32 v181, s62, v181
v_mfma_f32_16x16x32_bf16 v[196:199], a[148:151], v[40:43], v[196:199]
v_exp_f32 v211, v183 clamp
v_mfma_f32_16x16x32_bf16 v[200:203], a[144:147], v[44:47], v[200:203]
ds_read_b128 v[40:43], v7 offset:61440
v_fma_f32 v180, v180, s63, v208
v_mfma_f32_16x16x32_bf16 v[204:207], a[148:151], v[44:47], v[204:207]
v_cvt_pk_bf16_f32 v217, v178, v179
v_mul_f32 v184, v184, v72
v_max_f32 v182, s62, v182
v_mfma_f32_16x16x32_bf16 v[192:195], a[152:155], v[16:19], v[192:195]
s_barrier
ds_read_b128 v[44:47], v7 offset:62464
v_mfma_f32_16x16x32_bf16 v[196:199], a[156:159], v[16:19], v[196:199]
s_add_u32 m0, s43, 98304
v_add_u32 v4, 16384, v4
v_fma_f32 v181, v181, s63, v209
v_mul_f32 v185, v185, v73
v_mfma_f32_16x16x32_bf16 v[200:203], a[152:155], v[20:23], v[200:203]
ds_read_b128 v[16:19], v7 offset:63488
global_load_lds_dwordx4 v4, s[20:21] offset:0 sc1
v_mfma_f32_16x16x32_bf16 v[204:207], a[156:159], v[20:23], v[204:207]
global_load_lds_dwordx4 v4, s[20:21] offset:1024 sc1
v_exp_f32 v208, v184 clamp
v_max_f32 v183, s62, v183
v_fma_f32 v182, v182, s63, v210
s_waitcnt lgkmcnt(3)
v_mfma_f32_16x16x32_bf16 v[192:195], a[160:163], v[24:27], v[192:195]
ds_read_b128 v[20:23], v7 offset:64512
global_load_lds_dwordx4 v4, s[20:21] offset:2048 sc1
v_mfma_f32_16x16x32_bf16 v[196:199], a[164:167], v[24:27], v[196:199]
global_load_lds_dwordx4 v4, s[20:21] offset:3072 sc1
v_cvt_pk_bf16_f32 v218, v180, v181
v_mul_f32 v186, v186, v74
v_mfma_f32_16x16x32_bf16 v[200:203], a[160:163], v[28:31], v[200:203]
ds_read_b128 v[24:27], v8 offset:2048
v_max_f32 v184, s62, v184
v_mfma_f32_16x16x32_bf16 v[204:207], a[164:167], v[28:31], v[204:207]
v_exp_f32 v209, v185 clamp
v_fma_f32 v183, v183, s63, v211
v_mfma_f32_16x16x32_bf16 v[192:195], a[168:171], v[32:35], v[192:195]
ds_read_b128 v[28:31], v8 offset:2304
v_mul_f32 v187, v187, v75
v_mfma_f32_16x16x32_bf16 v[196:199], a[172:175], v[32:35], v[196:199]
v_exp_f32 v210, v186 clamp
v_max_f32 v185, s62, v185
v_mfma_f32_16x16x32_bf16 v[200:203], a[168:171], v[36:39], v[200:203]
ds_read_b128 v[32:35], v8 offset:2560
v_fma_f32 v184, v184, s63, v208
v_mfma_f32_16x16x32_bf16 v[204:207], a[172:175], v[36:39], v[204:207]
v_cvt_pk_bf16_f32 v219, v182, v183
v_mul_f32 v188, v188, v76
s_waitcnt vmcnt(29) lgkmcnt(3)
v_mfma_f32_16x16x32_bf16 v[192:195], a[176:179], v[40:43], v[192:195]
ds_read_b128 v[36:39], v8 offset:2816
v_max_f32 v186, s62, v186
v_mfma_f32_16x16x32_bf16 v[196:199], a[180:183], v[40:43], v[196:199]
v_exp_f32 v211, v187 clamp
v_mfma_f32_16x16x32_bf16 v[200:203], a[176:179], v[44:47], v[200:203]
s_barrier
ds_read_b128 v[40:43], v6 offset:0
v_mfma_f32_16x16x32_bf16 v[204:207], a[180:183], v[44:47], v[204:207]
s_add_u32 m0, s43, 114688
v_add_u32 v4, 16384, v4
v_fma_f32 v185, v185, s63, v209
v_mul_f32 v189, v189, v77
v_mfma_f32_16x16x32_bf16 v[192:195], a[184:187], v[16:19], v[192:195]
ds_read_b128 v[44:47], v6 offset:1024
global_load_lds_dwordx4 v4, s[20:21] offset:0 sc1
v_mfma_f32_16x16x32_bf16 v[196:199], a[188:191], v[16:19], v[196:199]
global_load_lds_dwordx4 v4, s[20:21] offset:1024 sc1
global_load_lds_dwordx4 v4, s[20:21] offset:2048 sc1
v_exp_f32 v208, v188 clamp
v_max_f32 v187, s62, v187
v_fma_f32 v186, v186, s63, v210
v_mfma_f32_16x16x32_bf16 v[200:203], a[184:187], v[20:23], v[200:203]
ds_read_b128 v[16:19], v6 offset:2048
global_load_lds_dwordx4 v4, s[20:21] offset:3072 sc1
v_mfma_f32_16x16x32_bf16 v[204:207], a[188:191], v[20:23], v[204:207]
v_cvt_pk_bf16_f32 v220, v184, v185
v_mul_f32 v190, v190, v78
v_exp_f32 v209, v189 clamp
s_waitcnt lgkmcnt(3)
v_mfma_f32_16x16x32_bf16 v[80:83], v[24:27], v[64:67], 0
ds_read_b128 v[20:23], v6 offset:3072
v_max_f32 v188, s62, v188
v_mfma_f32_16x16x32_bf16 v[88:91], v[24:27], v[68:71], 0
v_exp_f32 v210, v190 clamp
v_fma_f32 v187, v187, s63, v211
v_mul_f32 v191, v191, v79
v_mfma_f32_16x16x32_bf16 v[84:87], v[28:31], v[64:67], 0
ds_read_b128 v[24:27], v6 offset:4096
v_max_f32 v189, s62, v189
v_mfma_f32_16x16x32_bf16 v[92:95], v[28:31], v[68:71], 0
v_exp_f32 v211, v191 clamp
v_fma_f32 v188, v188, s63, v208
v_cvt_pk_bf16_f32 v221, v186, v187
v_mfma_f32_16x16x32_bf16 v[96:99], v[32:35], v[64:67], 0
ds_read_b128 v[28:31], v6 offset:5120
v_max_f32 v190, s62, v190
v_mfma_f32_16x16x32_bf16 v[104:107], v[32:35], v[68:71], 0
v_fma_f32 v189, v189, s63, v209
v_max_f32 v191, s62, v191
v_fma_f32 v190, v190, s63, v210
v_cvt_pk_bf16_f32 v222, v188, v189
v_mfma_f32_16x16x32_bf16 v[100:103], v[36:39], v[64:67], 0
ds_read_b128 v[32:35], v6 offset:6144
v_fma_f32 v191, v191, s63, v211
v_mfma_f32_16x16x32_bf16 v[108:111], v[36:39], v[68:71], 0
v_cvt_pk_bf16_f32 v223, v190, v191
s_barrier
s_waitcnt lgkmcnt(3)
v_mfma_f32_16x16x32_bf16 v[80:83], v[40:43], a[192:195], v[80:83]
ds_read_b128 v[36:39], v6 offset:7168
ds_write_b128 v247, v[216:219] offset:0
v_mfma_f32_16x16x32_bf16 v[88:91], v[40:43], a[196:199], v[88:91]
v_mfma_f32_16x16x32_bf16 v[84:87], v[44:47], a[192:195], v[84:87]
ds_read_b128 v[40:43], v6 offset:8192
v_mfma_f32_16x16x32_bf16 v[92:95], v[44:47], a[196:199], v[92:95]
v_mfma_f32_16x16x32_bf16 v[80:83], v[16:19], a[200:203], v[80:83]
ds_read_b128 v[44:47], v6 offset:9216
v_mfma_f32_16x16x32_bf16 v[88:91], v[16:19], a[204:207], v[88:91]
s_waitcnt vmcnt(12)
s_atomic_add s45, s[20:21], s56 offset:8
ds_write_b128 v247, v[220:223] offset:1024
v_mfma_f32_16x16x32_bf16 v[84:87], v[20:23], a[200:203], v[84:87]
ds_read_b128 v[16:19], v6 offset:10240
v_mfma_f32_16x16x32_bf16 v[92:95], v[20:23], a[204:207], v[92:95]
s_waitcnt lgkmcnt(6)
v_mfma_f32_16x16x32_bf16 v[80:83], v[24:27], a[208:211], v[80:83]
ds_read_b128 v[20:23], v6 offset:11264
s_add_u32 s37, s50, 143360
v_mfma_f32_16x16x32_bf16 v[88:91], v[24:27], a[212:215], v[88:91]
s_add_u32 s38, s50, 147584
v_mul_f32 v192, v192, v72
v_mul_f32 v193, v193, v73
v_mul_f32 v194, v194, v74
v_mul_f32 v195, v195, v75
v_mul_f32 v196, v196, v76
v_mfma_f32_16x16x32_bf16 v[84:87], v[28:31], a[208:211], v[84:87]
ds_read_b128 v[24:27], v6 offset:12288
v_mul_f32 v197, v197, v77
v_mfma_f32_16x16x32_bf16 v[92:95], v[28:31], a[212:215], v[92:95]
v_mul_f32 v198, v198, v78
v_mul_f32 v199, v199, v79
v_cvt_pk_bf16_f32 v216, v192, v193
v_cvt_pk_bf16_f32 v217, v194, v195
v_mfma_f32_16x16x32_bf16 v[80:83], v[32:35], a[216:219], v[80:83]
ds_read_b128 v[28:31], v6 offset:13312
v_cvt_pk_bf16_f32 v218, v196, v197
v_mfma_f32_16x16x32_bf16 v[88:91], v[32:35], a[220:223], v[88:91]
v_cvt_pk_bf16_f32 v219, v198, v199
s_waitcnt lgkmcnt(5)
v_mfma_f32_16x16x32_bf16 v[84:87], v[36:39], a[216:219], v[84:87]
ds_read_b128 v[32:35], v6 offset:14336
ds_write_b128 v247, v[216:219] offset:2048
v_mfma_f32_16x16x32_bf16 v[92:95], v[36:39], a[220:223], v[92:95]
v_mul_f32 v200, v200, v72
v_mul_f32 v201, v201, v73
v_mul_f32 v202, v202, v74
v_mul_f32 v203, v203, v75
v_mul_f32 v204, v204, v76
v_mfma_f32_16x16x32_bf16 v[80:83], v[40:43], a[224:227], v[80:83]
ds_read_b128 v[36:39], v6 offset:15360
v_mul_f32 v205, v205, v77
v_mfma_f32_16x16x32_bf16 v[88:91], v[40:43], a[228:231], v[88:91]
v_mul_f32 v206, v206, v78
v_mul_f32 v207, v207, v79
v_cvt_pk_bf16_f32 v220, v200, v201
v_cvt_pk_bf16_f32 v221, v202, v203
v_mfma_f32_16x16x32_bf16 v[84:87], v[44:47], a[224:227], v[84:87]
s_barrier
ds_read_b128 v[40:43], v6 offset:16384
v_mfma_f32_16x16x32_bf16 v[92:95], v[44:47], a[228:231], v[92:95]
v_cvt_pk_bf16_f32 v222, v204, v205
v_cvt_pk_bf16_f32 v223, v206, v207
s_waitcnt lgkmcnt(5)
v_mfma_f32_16x16x32_bf16 v[80:83], v[16:19], a[232:235], v[80:83]
ds_read_b128 v[44:47], v6 offset:17408
ds_write_b128 v247, v[220:223] offset:3072
v_mfma_f32_16x16x32_bf16 v[88:91], v[16:19], a[236:239], v[88:91]
v_mfma_f32_16x16x32_bf16 v[84:87], v[20:23], a[232:235], v[84:87]
ds_read_b128 v[16:19], v6 offset:18432
v_mfma_f32_16x16x32_bf16 v[92:95], v[20:23], a[236:239], v[92:95]
v_mfma_f32_16x16x32_bf16 v[80:83], v[24:27], a[240:243], v[80:83]
ds_read_b128 v[20:23], v6 offset:19456
v_mfma_f32_16x16x32_bf16 v[88:91], v[24:27], a[244:247], v[88:91]
s_waitcnt lgkmcnt(5)
v_mfma_f32_16x16x32_bf16 v[84:87], v[28:31], a[240:243], v[84:87]
s_barrier
ds_read_b128 v[24:27], v6 offset:20480
v_mfma_f32_16x16x32_bf16 v[92:95], v[28:31], a[244:247], v[92:95]
s_add_u32 m0, s43, 0
v_add_u32 v4, 16384, v4
v_mfma_f32_16x16x32_bf16 v[80:83], v[32:35], a[248:251], v[80:83]
ds_read_b128 v[28:31], v6 offset:21504
global_load_lds_dwordx4 v4, s[20:21] offset:0 sc1
v_mfma_f32_16x16x32_bf16 v[88:91], v[32:35], a[252:255], v[88:91]
global_load_lds_dwordx4 v4, s[20:21] offset:1024 sc1
global_load_lds_dwordx4 v4, s[20:21] offset:2048 sc1
s_waitcnt lgkmcnt(4)
s_barrier
ds_read_b128 v[176:179], v248 offset:0
ds_read_b128 v[192:195], v249 offset:0
v_mfma_f32_16x16x32_bf16 v[84:87], v[36:39], a[248:251], v[84:87]
ds_read_b128 v[32:35], v6 offset:22528
global_load_lds_dwordx4 v4, s[20:21] offset:3072 sc1
ds_read_b128 v[180:183], v248 offset:4096
ds_read_b128 v[196:199], v249 offset:4096
v_mfma_f32_16x16x32_bf16 v[92:95], v[36:39], a[252:255], v[92:95]
v_mfma_f32_16x16x32_bf16 v[80:83], v[40:43], a[0:3], v[80:83]
ds_read_b128 v[36:39], v6 offset:23552
ds_read_b128 v[184:187], v248 offset:8192
ds_read_b128 v[200:203], v249 offset:8192
v_mfma_f32_16x16x32_bf16 v[88:91], v[40:43], a[4:7], v[88:91]
v_mfma_f32_16x16x32_bf16 v[84:87], v[44:47], a[0:3], v[84:87]
ds_read_b128 v[40:43], v6 offset:24576
ds_read_b128 v[188:191], v248 offset:12288
ds_read_b128 v[204:207], v249 offset:12288
v_mfma_f32_16x16x32_bf16 v[92:95], v[44:47], a[4:7], v[92:95]
s_waitcnt lgkmcnt(12)
v_mfma_f32_16x16x32_bf16 v[80:83], v[16:19], a[8:11], v[80:83]
ds_read_b128 v[44:47], v6 offset:25600
v_mfma_f32_16x16x32_bf16 v[88:91], v[16:19], a[12:15], v[88:91]
v_mfma_f32_16x16x32_bf16 v[84:87], v[20:23], a[8:11], v[84:87]
ds_read_b128 v[16:19], v6 offset:26624
v_mfma_f32_16x16x32_bf16 v[92:95], v[20:23], a[12:15], v[92:95]
v_mfma_f32_16x16x32_bf16 v[80:83], v[24:27], a[16:19], v[80:83]
ds_read_b128 v[20:23], v6 offset:27648
v_mfma_f32_16x16x32_bf16 v[88:91], v[24:27], a[20:23], v[88:91]
s_waitcnt lgkmcnt(8)
v_mfma_f32_16x16x32_bf16 v[84:87], v[28:31], a[16:19], v[84:87]
ds_read_b128 v[24:27], v6 offset:28672
v_mfma_f32_16x16x32_bf16 v[92:95], v[28:31], a[20:23], v[92:95]
v_mfma_f32_16x16x32_bf16 v[80:83], v[32:35], a[24:27], v[80:83]
ds_read_b128 v[28:31], v6 offset:29696
v_mfma_f32_16x16x32_bf16 v[88:91], v[32:35], a[28:31], v[88:91]
s_atomic_add s59, s[20:21], s56 offset:8 glc
v_mfma_f32_16x16x32_bf16 v[232:235], v[192:195], v[176:179], 0
v_mfma_f32_16x16x32_bf16 v[236:239], v[240:243], v[176:179], 0
v_mfma_f32_16x16x32_bf16 v[84:87], v[36:39], a[24:27], v[84:87]
v_mfma_f32_16x16x32_bf16 v[232:235], v[196:199], v[180:183], v[232:235]
v_mfma_f32_16x16x32_bf16 v[92:95], v[36:39], a[28:31], v[92:95]
ds_read_b128 v[32:35], v6 offset:30720
v_mfma_f32_16x16x32_bf16 v[236:239], v[240:243], v[180:183], v[236:239]
s_waitcnt lgkmcnt(9)
v_mfma_f32_16x16x32_bf16 v[232:235], v[200:203], v[184:187], v[232:235]
s_waitcnt lgkmcnt(4)
v_mfma_f32_16x16x32_bf16 v[80:83], v[40:43], a[32:35], v[80:83]
ds_read_b128 v[36:39], v6 offset:31744
v_mfma_f32_16x16x32_bf16 v[88:91], v[40:43], a[36:39], v[88:91]
v_mfma_f32_16x16x32_bf16 v[236:239], v[240:243], v[184:187], v[236:239]
v_mfma_f32_16x16x32_bf16 v[232:235], v[204:207], v[188:191], v[232:235]
v_mfma_f32_16x16x32_bf16 v[84:87], v[44:47], a[32:35], v[84:87]
s_barrier
ds_read_b128 v[40:43], v6 offset:32768
v_mfma_f32_16x16x32_bf16 v[92:95], v[44:47], a[36:39], v[92:95]
v_mfma_f32_16x16x32_bf16 v[236:239], v[240:243], v[188:191], v[236:239]
v_mfma_f32_16x16x32_bf16 v[80:83], v[16:19], a[40:43], v[80:83]
ds_read_b128 v[44:47], v6 offset:33792
s_getpc_b64 s[4:5]
v_mfma_f32_16x16x32_bf16 v[88:91], v[16:19], a[44:47], v[88:91]
global_load_dword v13, v12, s[4:5]
s_waitcnt lgkmcnt(4)
v_mfma_f32_16x16x32_bf16 v[84:87], v[20:23], a[40:43], v[84:87]
ds_read_b128 v[16:19], v6 offset:34816
v_mfma_f32_16x16x32_bf16 v[92:95], v[20:23], a[44:47], v[92:95]
v_mfma_f32_16x16x32_bf16 v[80:83], v[24:27], a[48:51], v[80:83]
ds_read_b128 v[20:23], v6 offset:35840
buffer_atomic_add_f32 v232, v250, s[20:23], s37 offen offset:0 sc1
buffer_atomic_add_f32 v233, v250, s[20:23], s37 offen offset:64 sc1
buffer_atomic_add_f32 v234, v250, s[20:23], s37 offen offset:128 sc1
v_mfma_f32_16x16x32_bf16 v[88:91], v[24:27], a[52:55], v[88:91]
buffer_atomic_add_f32 v235, v250, s[20:23], s37 offen offset:192 sc1
v_mfma_f32_16x16x32_bf16 v[84:87], v[28:31], a[48:51], v[84:87]
buffer_atomic_add_f32 v236, v251, s[20:23], s38 offen sc1
v_mfma_f32_16x16x32_bf16 v[92:95], v[28:31], a[52:55], v[92:95]
ds_read_b128 v[24:27], v6 offset:36864
v_lshlrev_b32 v112, 16, v48
v_and_b32 v113, 0xffff0000, v48
s_waitcnt lgkmcnt(4)
v_mfma_f32_16x16x32_bf16 v[80:83], v[32:35], a[56:59], v[80:83]
s_barrier
ds_read_b128 v[28:31], v6 offset:37888
v_mfma_f32_16x16x32_bf16 v[88:91], v[32:35], a[60:63], v[88:91]
s_add_u32 m0, s43, 16384
v_add_u32 v4, 16384, v4
v_lshlrev_b32 v114, 16, v49
v_and_b32 v115, 0xffff0000, v49
v_lshlrev_b32 v116, 16, v50
v_and_b32 v117, 0xffff0000, v50
v_lshlrev_b32 v118, 16, v51
v_mfma_f32_16x16x32_bf16 v[84:87], v[36:39], a[56:59], v[84:87]
ds_read_b128 v[32:35], v6 offset:38912
global_load_lds_dwordx4 v4, s[20:21] offset:0 sc1
v_mfma_f32_16x16x32_bf16 v[92:95], v[36:39], a[60:63], v[92:95]
global_load_lds_dwordx4 v4, s[20:21] offset:1024 sc1
global_load_lds_dwordx4 v4, s[20:21] offset:2048 sc1
v_and_b32 v119, 0xffff0000, v51
v_lshlrev_b32 v120, 16, v52
v_and_b32 v121, 0xffff0000, v52
v_lshlrev_b32 v122, 16, v53
v_and_b32 v123, 0xffff0000, v53
v_mfma_f32_16x16x32_bf16 v[80:83], v[40:43], a[64:67], v[80:83]
ds_read_b128 v[36:39], v6 offset:39936
global_load_lds_dwordx4 v4, s[20:21] offset:3072 sc1
v_mfma_f32_16x16x32_bf16 v[88:91], v[40:43], a[68:71], v[88:91]
v_lshlrev_b32 v124, 16, v54
v_and_b32 v125, 0xffff0000, v54
v_lshlrev_b32 v126, 16, v55
v_and_b32 v127, 0xffff0000, v55
v_lshlrev_b32 v128, 16, v56
s_waitcnt lgkmcnt(4)
v_mfma_f32_16x16x32_bf16 v[84:87], v[44:47], a[64:67], v[84:87]
ds_read_b128 v[40:43], v6 offset:40960
v_and_b32 v129, 0xffff0000, v56
v_mfma_f32_16x16x32_bf16 v[92:95], v[44:47], a[68:71], v[92:95]
v_lshlrev_b32 v130, 16, v57
v_and_b32 v131, 0xffff0000, v57
v_lshlrev_b32 v132, 16, v58
v_and_b32 v133, 0xffff0000, v58
v_mfma_f32_16x16x32_bf16 v[80:83], v[16:19], a[72:75], v[80:83]
ds_read_b128 v[44:47], v6 offset:41984
v_lshlrev_b32 v134, 16, v59
v_mfma_f32_16x16x32_bf16 v[88:91], v[16:19], a[76:79], v[88:91]
v_and_b32 v135, 0xffff0000, v59
v_lshlrev_b32 v136, 16, v60
v_and_b32 v137, 0xffff0000, v60
v_lshlrev_b32 v138, 16, v61
v_mfma_f32_16x16x32_bf16 v[84:87], v[20:23], a[72:75], v[84:87]
ds_read_b128 v[16:19], v6 offset:43008
v_and_b32 v139, 0xffff0000, v61
v_mfma_f32_16x16x32_bf16 v[92:95], v[20:23], a[76:79], v[92:95]
v_lshlrev_b32 v140, 16, v62
v_and_b32 v141, 0xffff0000, v62
v_lshlrev_b32 v142, 16, v63
v_and_b32 v143, 0xffff0000, v63
s_waitcnt lgkmcnt(4)
v_mfma_f32_16x16x32_bf16 v[80:83], v[24:27], a[80:83], v[80:83]
ds_read_b128 v[20:23], v6 offset:44032
s_add_u32 s39, s2, s34
v_mfma_f32_16x16x32_bf16 v[88:91], v[24:27], a[84:87], v[88:91]
s_min_u32 s39, s39, 1
s_lshl_b32 s39, s39, 30
s_add_u32 s39, s39, 24576
v_mov_b32 v9, s44
v_mfma_f32_16x16x32_bf16 v[84:87], v[28:31], a[80:83], v[84:87]
ds_read_b128 v[24:27], v6 offset:45056
buffer_store_dword v9, v1, s[20:23], s39 offen sc1
v_mfma_f32_16x16x32_bf16 v[92:95], v[28:31], a[84:87], v[92:95]
v_mfma_f32_16x16x32_bf16 v[80:83], v[32:35], a[88:91], v[80:83]
ds_read_b128 v[28:31], v6 offset:46080
v_mfma_f32_16x16x32_bf16 v[88:91], v[32:35], a[92:95], v[88:91]
s_waitcnt lgkmcnt(4)
v_mfma_f32_16x16x32_bf16 v[84:87], v[36:39], a[88:91], v[84:87]
ds_read_b128 v[32:35], v6 offset:47104
v_mfma_f32_16x16x32_bf16 v[92:95], v[36:39], a[92:95], v[92:95]
v_mfma_f32_16x16x32_bf16 v[80:83], v[40:43], a[96:99], v[80:83]
ds_read_b128 v[36:39], v6 offset:48128
v_mfma_f32_16x16x32_bf16 v[88:91], v[40:43], a[100:103], v[88:91]
v_mfma_f32_16x16x32_bf16 v[84:87], v[44:47], a[96:99], v[84:87]
s_barrier
ds_read_b128 v[40:43], v6 offset:49152
v_mfma_f32_16x16x32_bf16 v[92:95], v[44:47], a[100:103], v[92:95]
s_waitcnt lgkmcnt(4)
v_mfma_f32_16x16x32_bf16 v[80:83], v[16:19], a[104:107], v[80:83]
ds_read_b128 v[44:47], v6 offset:50176
v_mfma_f32_16x16x32_bf16 v[88:91], v[16:19], a[108:111], v[88:91]
s_cmp_lt_u32 s59, 16
s_cbranch_scc0 L_back17
L_slow17:
s_waitcnt lgkmcnt(0)
s_cmp_ge_u32 s59, 16
s_cbranch_scc1 L_back17
s_mov_b32 s59, 0
s_atomic_add s59, s[20:21], s56 offset:8 glc
s_sub_u32 s46, s46, 1
s_cbranch_scc0 L_slow17
s_endpgm
L_back17:
s_barrier
buffer_load_dwordx4 v[144:147], v252, s[20:23], s41 offen offset:0 sc1
v_mfma_f32_16x16x32_bf16 v[84:87], v[20:23], a[104:107], v[84:87]
ds_read_b128 v[16:19], v6 offset:51200
v_mfma_f32_16x16x32_bf16 v[92:95], v[20:23], a[108:111], v[92:95]
v_mfma_f32_16x16x32_bf16 v[80:83], v[24:27], a[112:115], v[80:83]
ds_read_b128 v[20:23], v6 offset:52224
v_mfma_f32_16x16x32_bf16 v[88:91], v[24:27], a[116:119], v[88:91]
s_waitcnt lgkmcnt(3)
v_mfma_f32_16x16x32_bf16 v[84:87], v[28:31], a[112:115], v[84:87]
s_barrier
ds_read_b128 v[24:27], v6 offset:53248
buffer_load_dwordx4 v[148:151], v252, s[20:23], s41 offen offset:1024 sc1
v_mfma_f32_16x16x32_bf16 v[92:95], v[28:31], a[116:119], v[92:95]
s_add_u32 m0, s43, 32768
v_add_u32 v4, 16384, v4
v_mfma_f32_16x16x32_bf16 v[80:83], v[32:35], a[120:123], v[80:83]
ds_read_b128 v[28:31], v6 offset:54272
global_load_lds_dwordx4 v4, s[20:21] offset:0 sc1
v_mfma_f32_16x16x32_bf16 v[88:91], v[32:35], a[124:127], v[88:91]
global_load_lds_dwordx4 v4, s[20:21] offset:1024 sc1
global_load_lds_dwordx4 v4, s[20:21] offset:2048 sc1
v_mfma_f32_16x16x32_bf16 v[84:87], v[36:39], a[120:123], v[84:87]
ds_read_b128 v[32:35], v6 offset:55296
global_load_lds_dwordx4 v4, s[20:21] offset:3072 sc1
v_mfma_f32_16x16x32_bf16 v[92:95], v[36:39], a[124:127], v[92:95]
v_mfma_f32_16x16x32_bf16 v[80:83], v[40:43], a[128:131], v[80:83]
buffer_load_dwordx4 v[152:155], v252, s[20:23], s41 offen offset:2048 sc1
v_mfma_f32_16x16x32_bf16 v[88:91], v[40:43], a[132:135], v[88:91]
ds_read_b128 v[36:39], v6 offset:56320
s_waitcnt lgkmcnt(3)
v_mfma_f32_16x16x32_bf16 v[84:87], v[44:47], a[128:131], v[84:87]
ds_read_b128 v[40:43], v6 offset:57344
v_mfma_f32_16x16x32_bf16 v[92:95], v[44:47], a[132:135], v[92:95]
v_mfma_f32_16x16x32_bf16 v[80:83], v[16:19], a[136:139], v[80:83]
ds_read_b128 v[44:47], v6 offset:58368
v_mfma_f32_16x16x32_bf16 v[88:91], v[16:19], a[140:143], v[88:91]
v_mfma_f32_16x16x32_bf16 v[84:87], v[20:23], a[136:139], v[84:87]
ds_read_b128 v[16:19], v6 offset:59392
v_mfma_f32_16x16x32_bf16 v[92:95], v[20:23], a[140:143], v[92:95]
v_mfma_f32_16x16x32_bf16 v[80:83], v[24:27], a[144:147], v[80:83]
buffer_load_dwordx4 v[156:159], v252, s[20:23], s41 offen offset:3072 sc1
v_mfma_f32_16x16x32_bf16 v[88:91], v[24:27], a[148:151], v[88:91]
ds_read_b128 v[20:23], v6 offset:60416
s_waitcnt lgkmcnt(3)
v_mfma_f32_16x16x32_bf16 v[84:87], v[28:31], a[144:147], v[84:87]
ds_read_b128 v[24:27], v6 offset:61440
v_mfma_f32_16x16x32_bf16 v[92:95], v[28:31], a[148:151], v[92:95]
v_mfma_f32_16x16x32_bf16 v[80:83], v[32:35], a[152:155], v[80:83]
ds_read_b128 v[28:31], v6 offset:62464
v_mfma_f32_16x16x32_bf16 v[88:91], v[32:35], a[156:159], v[88:91]
v_mfma_f32_16x16x32_bf16 v[84:87], v[36:39], a[152:155], v[84:87]
ds_read_b128 v[32:35], v6 offset:63488
v_mfma_f32_16x16x32_bf16 v[92:95], v[36:39], a[156:159], v[92:95]
v_mfma_f32_16x16x32_bf16 v[80:83], v[40:43], a[160:163], v[80:83]
buffer_load_dwordx4 v[160:163], v253, s[20:23], s42 offen offset:0 sc1
buffer_load_dwordx4 v[164:167], v253, s[20:23], s42 offen offset:64 sc1
v_mfma_f32_16x16x32_bf16 v[88:91], v[40:43], a[164:167], v[88:91]
ds_read_b128 v[36:39], v6 offset:64512
s_add_u32 s41, s50, 143360
s_add_u32 s42, s50, 147584
s_mov_b32 s59, 0
s_waitcnt lgkmcnt(3)
v_mfma_f32_16x16x32_bf16 v[84:87], v[44:47], a[160:163], v[84:87]
s_barrier
ds_read_b128 v[40:43], v7 offset:0
v_mfma_f32_16x16x32_bf16 v[92:95], v[44:47], a[164:167], v[92:95]
v_mfma_f32_16x16x32_bf16 v[80:83], v[16:19], a[168:171], v[80:83]
ds_read_b128 v[44:47], v7 offset:1024
v_mfma_f32_16x16x32_bf16 v[88:91], v[16:19], a[172:175], v[88:91]
v_mfma_f32_16x16x32_bf16 v[84:87], v[20:23], a[168:171], v[84:87]
ds_read_b128 v[16:19], v7 offset:2048
v_mfma_f32_16x16x32_bf16 v[92:95], v[20:23], a[172:175], v[92:95]
s_waitcnt vmcnt(15)
s_atomic_add s45, s[20:21], s56 offset:12
v_mfma_f32_16x16x32_bf16 v[80:83], v[24:27], a[176:179], v[80:83]
ds_read_b128 v[20:23], v7 offset:3072
v_mfma_f32_16x16x32_bf16 v[88:91], v[24:27], a[180:183], v[88:91]
s_waitcnt lgkmcnt(4)
v_mfma_f32_16x16x32_bf16 v[84:87], v[28:31], a[176:179], v[84:87]
ds_read_b128 v[24:27], v7 offset:4096
v_mfma_f32_16x16x32_bf16 v[92:95], v[28:31], a[180:183], v[92:95]
v_mfma_f32_16x16x32_bf16 v[80:83], v[32:35], a[184:187], v[80:83]
ds_read_b128 v[28:31], v7 offset:5120
v_mfma_f32_16x16x32_bf16 v[88:91], v[32:35], a[188:191], v[88:91]
v_mfma_f32_16x16x32_bf16 v[84:87], v[36:39], a[184:187], v[84:87]
ds_read_b128 v[32:35], v7 offset:6144
v_mfma_f32_16x16x32_bf16 v[92:95], v[36:39], a[188:191], v[92:95]
s_waitcnt lgkmcnt(4)
v_mfma_f32_16x16x32_bf16 v[96:99], v[40:43], a[192:195], v[96:99]
ds_read_b128 v[36:39], v7 offset:7168
v_mfma_f32_16x16x32_bf16 v[104:107], v[40:43], a[196:199], v[104:107]
v_mul_f32 v80, v80, v254
v_mul_f32 v81, v81, v254
v_exp_f32 v208, v80 clamp
v_mul_f32 v82, v82, v254
v_exp_f32 v209, v81 clamp
v_mfma_f32_16x16x32_bf16 v[100:103], v[44:47], a[192:195], v[100:103]
s_barrier
ds_read_b128 v[40:43], v7 offset:8192
v_mfma_f32_16x16x32_bf16 v[108:111], v[44:47], a[196:199], v[108:111]
s_add_u32 m0, s43, 49152
v_add_u32 v4, 16384, v4
v_max_f32 v80, s62, v80
v_mul_f32 v83, v83, v254
v_exp_f32 v210, v82 clamp
v_max_f32 v81, s62, v81
v_mfma_f32_16x16x32_bf16 v[96:99], v[16:19], a[200:203], v[96:99]
ds_read_b128 v[44:47], v7 offset:9216
global_load_lds_dwordx4 v4, s[20:21] offset:0 sc1
v_mfma_f32_16x16x32_bf16 v[104:107], v[16:19], a[204:207], v[104:107]
global_load_lds_dwordx4 v4, s[20:21] offset:1024 sc1
v_fma_f32 v80, v80, s63, v208
v_mul_f32 v84, v84, v254
v_exp_f32 v211, v83 clamp
v_max_f32 v82, s62, v82
s_waitcnt lgkmcnt(4)
v_mfma_f32_16x16x32_bf16 v[100:103], v[20:23], a[200:203], v[100:103]
ds_read_b128 v[16:19], v7 offset:10240
global_load_lds_dwordx4 v4, s[20:21] offset:2048 sc1
v_mfma_f32_16x16x32_bf16 v[108:111], v[20:23], a[204:207], v[108:111]
global_load_lds_dwordx4 v4, s[20:21] offset:3072 sc1
v_fma_f32 v81, v81, s63, v209
v_mul_f32 v85, v85, v254
v_exp_f32 v208, v84 clamp
v_max_f32 v83, s62, v83
v_mfma_f32_16x16x32_bf16 v[96:99], v[24:27], a[208:211], v[96:99]
ds_read_b128 v[20:23], v7 offset:11264
v_fma_f32 v82, v82, s63, v210
v_mfma_f32_16x16x32_bf16 v[104:107], v[24:27], a[212:215], v[104:107]
v_exp_f32 v209, v85 clamp
v_cvt_pk_bf16_f32 v224, v80, v81
v_mul_f32 v86, v86, v254
v_mfma_f32_16x16x32_bf16 v[100:103], v[28:31], a[208:211], v[100:103]
ds_read_b128 v[24:27], v7 offset:12288
v_max_f32 v84, s62, v84
v_mfma_f32_16x16x32_bf16 v[108:111], v[28:31], a[212:215], v[108:111]
v_fma_f32 v83, v83, s63, v211
v_mul_f32 v87, v87, v254
v_exp_f32 v210, v86 clamp
s_waitcnt lgkmcnt(4)
v_mfma_f32_16x16x32_bf16 v[96:99], v[32:35], a[216:219], v[96:99]
ds_read_b128 v[28:31], v7 offset:13312
v_max_f32 v85, s62, v85
v_mfma_f32_16x16x32_bf16 v[104:107], v[32:35], a[220:223], v[104:107]
v_exp_f32 v211, v87 clamp
v_fma_f32 v84, v84, s63, v208
v_cvt_pk_bf16_f32 v225, v82, v83
v_mfma_f32_16x16x32_bf16 v[100:103], v[36:39], a[216:219], v[100:103]
ds_read_b128 v[32:35], v7 offset:14336
v_mul_f32 v88, v88, v255
v_mfma_f32_16x16x32_bf16 v[108:111], v[36:39], a[220:223], v[108:111]
v_exp_f32 v208, v88 clamp
v_max_f32 v86, s62, v86
v_fma_f32 v85, v85, s63, v209
v_mfma_f32_16x16x32_bf16 v[96:99], v[40:43], a[224:227], v[96:99]
ds_read_b128 v[36:39], v7 offset:15360
v_mul_f32 v89, v89, v255
v_mfma_f32_16x16x32_bf16 v[104:107], v[40:43], a[228:231], v[104:107]
v_max_f32 v87, s62, v87
v_fma_f32 v86, v86, s63, v210
v_cvt_pk_bf16_f32 v226, v84, v85
v_mul_f32 v90, v90, v255
s_waitcnt lgkmcnt(4)
v_mfma_f32_16x16x32_bf16 v[100:103], v[44:47], a[224:227], v[100:103]
s_barrier
ds_read_b128 v[40:43], v7 offset:16384
v_mfma_f32_16x16x32_bf16 v[108:111], v[44:47], a[228:231], v[108:111]
v_exp_f32 v209, v89 clamp
v_max_f32 v88, s62, v88
v_fma_f32 v87, v87, s63, v211
v_mul_f32 v91, v91, v255
v_mfma_f32_16x16x32_bf16 v[96:99], v[16:19], a[232:235], v[96:99]
ds_read_b128 v[44:47], v7 offset:17408
v_max_f32 v89, s62, v89
v_mfma_f32_16x16x32_bf16 v[104:107], v[16:19], a[236:239], v[104:107]
v_exp_f32 v210, v90 clamp
v_fma_f32 v88, v88, s63, v208
v_cvt_pk_bf16_f32 v227, v86, v87
v_mfma_f32_16x16x32_bf16 v[100:103], v[20:23], a[232:235], v[100:103]
ds_read_b128 v[16:19], v7 offset:18432
v_mul_f32 v92, v92, v255
v_mfma_f32_16x16x32_bf16 v[108:111], v[20:23], a[236:239], v[108:111]
v_max_f32 v90, s62, v90
v_exp_f32 v211, v91 clamp
v_fma_f32 v89, v89, s63, v209
s_waitcnt lgkmcnt(4)
v_mfma_f32_16x16x32_bf16 v[96:99], v[24:27], a[240:243], v[96:99]
ds_read_b128 v[20:23], v7 offset:19456
v_mul_f32 v93, v93, v255
v_mfma_f32_16x16x32_bf16 v[104:107], v[24:27], a[244:247], v[104:107]
v_exp_f32 v208, v92 clamp
v_max_f32 v91, s62, v91
v_fma_f32 v90, v90, s63, v210
v_mfma_f32_16x16x32_bf16 v[100:103], v[28:31], a[240:243], v[100:103]
ds_read_b128 v[24:27], v7 offset:20480
v_mfma_f32_16x16x32_bf16 v[108:111], v[28:31], a[244:247], v[108:111]
s_atomic_add s59, s[20:21], s56 offset:12 glc
v_cvt_pk_bf16_f32 v228, v88, v89
v_mul_f32 v94, v94, v255
v_mfma_f32_16x16x32_bf16 v[96:99], v[32:35], a[248:251], v[96:99]
v_exp_f32 v209, v93 clamp
v_mfma_f32_16x16x32_bf16 v[104:107], v[32:35], a[252:255], v[104:107]
ds_read_b128 v[28:31], v7 offset:21504
v_max_f32 v92, s62, v92
v_fma_f32 v91, v91, s63, v211
v_mul_f32 v95, v95, v255
s_waitcnt lgkmcnt(4)
v_mfma_f32_16x16x32_bf16 v[100:103], v[36:39], a[248:251], v[100:103]
s_barrier
ds_read_b128 v[32:35], v7 offset:22528
v_mfma_f32_16x16x32_bf16 v[108:111], v[36:39], a[252:255], v[108:111]
s_add_u32 m0, s43, 65536
v_add_u32 v4, 16384, v4
v_exp_f32 v210, v94 clamp
v_max_f32 v93, s62, v93
v_fma_f32 v92, v92, s63, v208
v_cvt_pk_bf16_f32 v229, v90, v91
v_mfma_f32_16x16x32_bf16 v[96:99], v[40:43], a[0:3], v[96:99]
ds_read_b128 v[36:39], v7 offset:23552
global_load_lds_dwordx4 v4, s[20:21] offset:0 sc1
v_mfma_f32_16x16x32_bf16 v[104:107], v[40:43], a[4:7], v[104:107]
global_load_lds_dwordx4 v4, s[20:21] offset:1024 sc1
global_load_lds_dwordx4 v4, s[20:21] offset:2048 sc1
v_exp_f32 v211, v95 clamp
v_max_f32 v94, s62, v94
v_fma_f32 v93, v93, s63, v209
v_max_f32 v95, s62, v95
v_fma_f32 v94, v94, s63, v210
v_mfma_f32_16x16x32_bf16 v[100:103], v[44:47], a[0:3], v[100:103]
ds_read_b128 v[40:43], v7 offset:24576
global_load_lds_dwordx4 v4, s[20:21] offset:3072 sc1
v_mfma_f32_16x16x32_bf16 v[108:111], v[44:47], a[4:7], v[108:111]
v_cvt_pk_bf16_f32 v230, v92, v93
v_fma_f32 v95, v95, s63, v211
v_cvt_pk_bf16_f32 v231, v94, v95
s_add_u32 s37, s48, 25427968
s_waitcnt vmcnt(17)
v_cvt_pk_bf16_f32 v144, v144, v145
s_waitcnt lgkmcnt(4)
v_mfma_f32_16x16x32_bf16 v[96:99], v[16:19], a[8:11], v[96:99]
ds_read_b128 v[44:47], v7 offset:25600
v_cvt_pk_bf16_f32 v145, v146, v147
v_mfma_f32_16x16x32_bf16 v[104:107], v[16:19], a[12:15], v[104:107]
s_waitcnt vmcnt(16)
v_cvt_pk_bf16_f32 v146, v148, v149
v_cvt_pk_bf16_f32 v147, v150, v151
s_waitcnt vmcnt(11)
v_cvt_pk_bf16_f32 v152, v152, v153
v_cvt_pk_bf16_f32 v153, v154, v155
v_mfma_f32_16x16x32_bf16 v[100:103], v[20:23], a[8:11], v[100:103]
ds_read_b128 v[16:19], v7 offset:26624
s_waitcnt vmcnt(10)
v_cvt_pk_bf16_f32 v154, v156, v157
v_mfma_f32_16x16x32_bf16 v[108:111], v[20:23], a[12:15], v[108:111]
v_cvt_pk_bf16_f32 v155, v158, v159
s_waitcnt vmcnt(9)
v_cvt_pk_bf16_f32 v160, v160, v161
v_cvt_pk_bf16_f32 v161, v162, v163
s_waitcnt vmcnt(8)
v_cvt_pk_bf16_f32 v162, v164, v165
v_mfma_f32_16x16x32_bf16 v[96:99], v[24:27], a[16:19], v[96:99]
ds_read_b128 v[20:23], v7 offset:27648
v_cvt_pk_bf16_f32 v163, v166, v167
v_mfma_f32_16x16x32_bf16 v[104:107], v[24:27], a[20:23], v[104:107]
s_nop 0
v_mfma_f32_16x16x32_bf16 v[168:171], v[160:163], v[224:227], 0
v_mfma_f32_16x16x32_bf16 v[172:175], v[160:163], v[228:231], 0
s_waitcnt lgkmcnt(4)
v_mfma_f32_16x16x32_bf16 v[100:103], v[28:31], a[16:19], v[100:103]
ds_read_b128 v[24:27], v7 offset:28672
v_mfma_f32_16x16x32_bf16 v[108:111], v[28:31], a[20:23], v[108:111]
v_mfma_f32_16x16x32_bf16 v[80:83], v[144:147], v[224:227], 0
v_mfma_f32_16x16x32_bf16 v[88:91], v[144:147], v[228:231], 0
v_mfma_f32_16x16x32_bf16 v[96:99], v[32:35], a[24:27], v[96:99]
ds_read_b128 v[28:31], v7 offset:29696
v_mfma_f32_16x16x32_bf16 v[104:107], v[32:35], a[28:31], v[104:107]
v_mfma_f32_16x16x32_bf16 v[84:87], v[152:155], v[224:227], 0
v_mfma_f32_16x16x32_bf16 v[92:95], v[152:155], v[228:231], 0
v_fma_f32 v244, v168, v246, s62
v_fma_f32 v245, v172, v246, s62
v_mfma_f32_16x16x32_bf16 v[100:103], v[36:39], a[24:27], v[100:103]
v_rcp_f32 v244, v244
v_mfma_f32_16x16x32_bf16 v[108:111], v[36:39], a[28:31], v[108:111]
ds_read_b128 v[32:35], v7 offset:30720
v_rcp_f32 v245, v245
v_mul_f32 v80, v80, v244
s_waitcnt lgkmcnt(4)
v_mfma_f32_16x16x32_bf16 v[96:99], v[40:43], a[32:35], v[96:99]
ds_read_b128 v[36:39], v7 offset:31744
v_mul_f32 v81, v81, v244
v_mfma_f32_16x16x32_bf16 v[104:107], v[40:43], a[36:39], v[104:107]
v_mul_f32 v82, v82, v244
v_mul_f32 v83, v83, v244
v_mul_f32 v84, v84, v244
v_mul_f32 v85, v85, v244
v_mfma_f32_16x16x32_bf16 v[100:103], v[44:47], a[32:35], v[100:103]
s_barrier
ds_read_b128 v[40:43], v7 offset:32768
v_mfma_f32_16x16x32_bf16 v[108:111], v[44:47], a[36:39], v[108:111]
v_mul_f32 v86, v86, v244
v_mul_f32 v87, v87, v244
v_cvt_pk_bf16_f32 v168, v80, v81
v_cvt_pk_bf16_f32 v169, v82, v83
v_cvt_pk_bf16_f32 v170, v84, v85
v_mfma_f32_16x16x32_bf16 v[96:99], v[16:19], a[40:43], v[96:99]
ds_read_b128 v[44:47], v7 offset:33792
v_cvt_pk_bf16_f32 v171, v86, v87
v_mfma_f32_16x16x32_bf16 v[104:107], v[16:19], a[44:47], v[104:107]
v_mul_f32 v88, v88, v245
v_mul_f32 v89, v89, v245
v_mul_f32 v90, v90, v245
v_mul_f32 v91, v91, v245
s_waitcnt lgkmcnt(4)
v_mfma_f32_16x16x32_bf16 v[100:103], v[20:23], a[40:43], v[100:103]
ds_read_b128 v[16:19], v7 offset:34816
v_mul_f32 v92, v92, v245
v_mfma_f32_16x16x32_bf16 v[108:111], v[20:23], a[44:47], v[108:111]
v_mul_f32 v93, v93, v245
v_mul_f32 v94, v94, v245
v_mul_f32 v95, v95, v245
v_cvt_pk_bf16_f32 v172, v88, v89
v_mfma_f32_16x16x32_bf16 v[96:99], v[24:27], a[48:51], v[96:99]
ds_read_b128 v[20:23], v7 offset:35840
v_cvt_pk_bf16_f32 v173, v90, v91
v_mfma_f32_16x16x32_bf16 v[104:107], v[24:27], a[52:55], v[104:107]
v_cvt_pk_bf16_f32 v174, v92, v93
v_cvt_pk_bf16_f32 v175, v94, v95
v_mfma_f32_16x16x32_bf16 v[100:103], v[28:31], a[48:51], v[100:103]
buffer_store_dwordx4 v[168:171], v0, s[20:23], s37 offen offset:0 sc1
buffer_store_dwordx4 v[172:175], v0, s[20:23], s37 offen offset:1024 sc1
v_mfma_f32_16x16x32_bf16 v[108:111], v[28:31], a[52:55], v[108:111]
ds_read_b128 v[24:27], v7 offset:36864
s_mov_b32 s58, 0
s_waitcnt lgkmcnt(4)
v_mfma_f32_16x16x32_bf16 v[96:99], v[32:35], a[56:59], v[96:99]
ds_read_b128 v[28:31], v7 offset:37888
v_mfma_f32_16x16x32_bf16 v[104:107], v[32:35], a[60:63], v[104:107]
s_cmp_lt_u32 s59, 16
s_cbranch_scc0 L_back18
L_slow18:
s_waitcnt lgkmcnt(0)
s_cmp_ge_u32 s59, 16
s_cbranch_scc1 L_back18
s_mov_b32 s59, 0
s_atomic_add s59, s[20:21], s56 offset:12 glc
s_sub_u32 s46, s46, 1
s_cbranch_scc0 L_slow18
s_endpgm
L_back18:
s_barrier
buffer_load_dwordx4 v[176:179], v252, s[20:23], s41 offen offset:0 sc1
v_mfma_f32_16x16x32_bf16 v[100:103], v[36:39], a[56:59], v[100:103]
ds_read_b128 v[32:35], v7 offset:38912
s_add_u32 m0, s43, 81920
v_mfma_f32_16x16x32_bf16 v[108:111], v[36:39], a[60:63], v[108:111]
v_add_u32 v4, 16384, v4
v_mfma_f32_16x16x32_bf16 v[96:99], v[40:43], a[64:67], v[96:99]
ds_read_b128 v[36:39], v7 offset:39936
global_load_lds_dwordx4 v4, s[20:21] offset:0 sc1
v_mfma_f32_16x16x32_bf16 v[104:107], v[40:43], a[68:71], v[104:107]
global_load_lds_dwordx4 v4, s[20:21] offset:1024 sc1
s_waitcnt lgkmcnt(3)
v_mfma_f32_16x16x32_bf16 v[100:103], v[44:47], a[64:67], v[100:103]
ds_read_b128 v[40:43], v7 offset:40960
global_load_lds_dwordx4 v4, s[20:21] offset:2048 sc1
buffer_load_dwordx4 v[180:183], v252, s[20:23], s41 offen offset:1024 sc1
v_mfma_f32_16x16x32_bf16 v[108:111], v[44:47], a[68:71], v[108:111]
v_mfma_f32_16x16x32_bf16 v[96:99], v[16:19], a[72:75], v[96:99]
ds_read_b128 v[44:47], v7 offset:41984
v_mfma_f32_16x16x32_bf16 v[104:107], v[16:19], a[76:79], v[104:107]
v_mfma_f32_16x16x32_bf16 v[100:103], v[20:23], a[72:75], v[100:103]
ds_read_b128 v[16:19], v7 offset:43008
v_mfma_f32_16x16x32_bf16 v[108:111], v[20:23], a[76:79], v[108:111]
v_mfma_f32_16x16x32_bf16 v[96:99], v[24:27], a[80:83], v[96:99]
buffer_load_dwordx4 v[184:187], v252, s[20:23], s41 offen offset:2048 sc1
v_mfma_f32_16x16x32_bf16 v[104:107], v[24:27], a[84:87], v[104:107]
ds_read_b128 v[20:23], v7 offset:44032
s_waitcnt lgkmcnt(3)
v_mfma_f32_16x16x32_bf16 v[100:103], v[28:31], a[80:83], v[100:103]
ds_read_b128 v[24:27], v7 offset:45056
v_mfma_f32_16x16x32_bf16 v[108:111], v[28:31], a[84:87], v[108:111]
v_mfma_f32_16x16x32_bf16 v[96:99], v[32:35], a[88:91], v[96:99]
ds_read_b128 v[28:31], v7 offset:46080
v_mfma_f32_16x16x32_bf16 v[104:107], v[32:35], a[92:95], v[104:107]
v_mfma_f32_16x16x32_bf16 v[100:103], v[36:39], a[88:91], v[100:103]
ds_read_b128 v[32:35], v7 offset:47104
v_mfma_f32_16x16x32_bf16 v[108:111], v[36:39], a[92:95], v[108:111]
v_mfma_f32_16x16x32_bf16 v[96:99], v[40:43], a[96:99], v[96:99]
buffer_load_dwordx4 v[188:191], v252, s[20:23], s41 offen offset:3072 sc1
v_mfma_f32_16x16x32_bf16 v[104:107], v[40:43], a[100:103], v[104:107]
ds_read_b128 v[36:39], v7 offset:48128
s_waitcnt lgkmcnt(3)
v_mfma_f32_16x16x32_bf16 v[100:103], v[44:47], a[96:99], v[100:103]
s_barrier
ds_read_b128 v[40:43], v7 offset:49152
v_mfma_f32_16x16x32_bf16 v[108:111], v[44:47], a[100:103], v[108:111]
v_mfma_f32_16x16x32_bf16 v[96:99], v[16:19], a[104:107], v[96:99]
ds_read_b128 v[44:47], v7 offset:50176
v_mfma_f32_16x16x32_bf16 v[104:107], v[16:19], a[108:111], v[104:107]
v_mfma_f32_16x16x32_bf16 v[100:103], v[20:23], a[104:107], v[100:103]
ds_read_b128 v[16:19], v7 offset:51200
v_mfma_f32_16x16x32_bf16 v[108:111], v[20:23], a[108:111], v[108:111]
v_mfma_f32_16x16x32_bf16 v[96:99], v[24:27], a[112:115], v[96:99]
buffer_load_dwordx4 v[192:195], v253, s[20:23], s42 offen offset:0 sc1
buffer_load_dwordx4 v[196:199], v253, s[20:23], s42 offen offset:64 sc1
v_mfma_f32_16x16x32_bf16 v[104:107], v[24:27], a[116:119], v[104:107]
ds_read_b128 v[20:23], v7 offset:52224
s_waitcnt lgkmcnt(3)
v_mfma_f32_16x16x32_bf16 v[100:103], v[28:31], a[112:115], v[100:103]
ds_read_b128 v[24:27], v7 offset:53248
v_mfma_f32_16x16x32_bf16 v[108:111], v[28:31], a[116:119], v[108:111]
v_mfma_f32_16x16x32_bf16 v[96:99], v[32:35], a[120:123], v[96:99]
ds_read_b128 v[28:31], v7 offset:54272
v_mfma_f32_16x16x32_bf16 v[104:107], v[32:35], a[124:127], v[104:107]
v_mfma_f32_16x16x32_bf16 v[100:103], v[36:39], a[120:123], v[100:103]
ds_read_b128 v[32:35], v7 offset:55296
global_load_lds_dwordx4 v4, s[20:21] offset:3072 sc1
v_mfma_f32_16x16x32_bf16 v[108:111], v[36:39], a[124:127], v[108:111]
s_waitcnt vmcnt(10)
s_atomic_add s45, s[20:21], s53 offset:24
v_mfma_f32_16x16x32_bf16 v[96:99], v[40:43], a[128:131], v[96:99]
ds_read_b128 v[36:39], v7 offset:56320
v_mfma_f32_16x16x32_bf16 v[104:107], v[40:43], a[132:135], v[104:107]
s_waitcnt lgkmcnt(4)
v_mfma_f32_16x16x32_bf16 v[100:103], v[44:47], a[128:131], v[100:103]
ds_read_b128 v[40:43], v7 offset:57344
v_mfma_f32_16x16x32_bf16 v[108:111], v[44:47], a[132:135], v[108:111]
v_mfma_f32_16x16x32_bf16 v[96:99], v[16:19], a[136:139], v[96:99]
ds_read_b128 v[44:47], v7 offset:58368
v_mfma_f32_16x16x32_bf16 v[104:107], v[16:19], a[140:143], v[104:107]
v_mfma_f32_16x16x32_bf16 v[100:103], v[20:23], a[136:139], v[100:103]
ds_read_b128 v[16:19], v7 offset:59392
v_mfma_f32_16x16x32_bf16 v[108:111], v[20:23], a[140:143], v[108:111]
s_waitcnt lgkmcnt(4)
v_mfma_f32_16x16x32_bf16 v[96:99], v[24:27], a[144:147], v[96:99]
ds_read_b128 v[20:23], v7 offset:60416
v_mfma_f32_16x16x32_bf16 v[104:107], v[24:27], a[148:151], v[104:107]
v_mfma_f32_16x16x32_bf16 v[100:103], v[28:31], a[144:147], v[100:103]
ds_read_b128 v[24:27], v7 offset:61440
v_mfma_f32_16x16x32_bf16 v[108:111], v[28:31], a[148:151], v[108:111]
v_mfma_f32_16x16x32_bf16 v[96:99], v[32:35], a[152:155], v[96:99]
ds_read_b128 v[28:31], v7 offset:62464
v_mfma_f32_16x16x32_bf16 v[104:107], v[32:35], a[156:159], v[104:107]
s_waitcnt lgkmcnt(4)
v_mfma_f32_16x16x32_bf16 v[100:103], v[36:39], a[152:155], v[100:103]
ds_read_b128 v[32:35], v7 offset:63488
v_mfma_f32_16x16x32_bf16 v[108:111], v[36:39], a[156:159], v[108:111]
v_mfma_f32_16x16x32_bf16 v[96:99], v[40:43], a[160:163], v[96:99]
ds_read_b128 v[36:39], v7 offset:64512
v_mfma_f32_16x16x32_bf16 v[104:107], v[40:43], a[164:167], v[104:107]
v_mfma_f32_16x16x32_bf16 v[100:103], v[44:47], a[160:163], v[100:103]
s_barrier
ds_read_b128 v[40:43], v6 offset:0
v_mfma_f32_16x16x32_bf16 v[108:111], v[44:47], a[164:167], v[108:111]
s_add_u32 m0, s43, 98304
s_waitcnt lgkmcnt(4)
v_mfma_f32_16x16x32_bf16 v[96:99], v[16:19], a[168:171], v[96:99]
ds_read_b128 v[44:47], v6 offset:1024
v_add_u32 v4, 16384, v4
v_mfma_f32_16x16x32_bf16 v[104:107], v[16:19], a[172:175], v[104:107]
global_load_lds_dwordx4 v4, s[20:21] offset:0 sc1
global_load_lds_dwordx4 v4, s[20:21] offset:1024 sc1
v_mfma_f32_16x16x32_bf16 v[100:103], v[20:23], a[168:171], v[100:103]
ds_read_b128 v[16:19], v6 offset:2048
global_load_lds_dwordx4 v4, s[20:21] offset:2048 sc1
v_mfma_f32_16x16x32_bf16 v[108:111], v[20:23], a[172:175], v[108:111]
global_load_lds_dwordx4 v4, s[20:21] offset:3072 sc1
v_mfma_f32_16x16x32_bf16 v[96:99], v[24:27], a[176:179], v[96:99]
ds_read_b128 v[20:23], v6 offset:3072
v_mfma_f32_16x16x32_bf16 v[104:107], v[24:27], a[180:183], v[104:107]
s_waitcnt lgkmcnt(4)
v_mfma_f32_16x16x32_bf16 v[100:103], v[28:31], a[176:179], v[100:103]
ds_read_b128 v[24:27], v6 offset:4096
v_mfma_f32_16x16x32_bf16 v[108:111], v[28:31], a[180:183], v[108:111]
s_atomic_add s58, s[20:21], s53 offset:24 glc
v_mfma_f32_16x16x32_bf16 v[96:99], v[32:35], a[184:187], v[96:99]
ds_read_b128 v[28:31], v6 offset:5120
v_mfma_f32_16x16x32_bf16 v[104:107], v[32:35], a[188:191], v[104:107]
v_mfma_f32_16x16x32_bf16 v[100:103], v[36:39], a[184:187], v[100:103]
ds_read_b128 v[32:35], v6 offset:6144
v_mfma_f32_16x16x32_bf16 v[108:111], v[36:39], a[188:191], v[108:111]
s_nop 2
v_mul_f32 v96, v96, v254
v_mul_f32 v97, v97, v254
v_exp_f32 v208, v96 clamp
v_mul_f32 v98, v98, v254
v_exp_f32 v209, v97 clamp
v_max_f32 v96, s62, v96
v_mul_f32 v99, v99, v254
v_exp_f32 v210, v98 clamp
v_max_f32 v97, s62, v97
v_fma_f32 v96, v96, s63, v208
v_mul_f32 v100, v100, v254
v_exp_f32 v211, v99 clamp
v_max_f32 v98, s62, v98
v_fma_f32 v97, v97, s63, v209
v_mul_f32 v101, v101, v254
v_exp_f32 v208, v100 clamp
v_max_f32 v99, s62, v99
v_fma_f32 v98, v98, s63, v210
v_cvt_pk_bf16_f32 v224, v96, v97
v_mul_f32 v102, v102, v254
v_exp_f32 v209, v101 clamp
v_max_f32 v100, s62, v100
v_fma_f32 v99, v99, s63, v211
v_mul_f32 v103, v103, v254
v_exp_f32 v210, v102 clamp
v_max_f32 v101, s62, v101
v_fma_f32 v100, v100, s63, v208
v_cvt_pk_bf16_f32 v225, v98, v99
v_mul_f32 v104, v104, v255
v_exp_f32 v211, v103 clamp
v_max_f32 v102, s62, v102
v_fma_f32 v101, v101, s63, v209
v_mul_f32 v105, v105, v255
v_exp_f32 v208, v104 clamp
v_max_f32 v103, s62, v103
v_fma_f32 v102, v102, s63, v210
v_cvt_pk_bf16_f32 v226, v100, v101
v_mul_f32 v106, v106, v255
v_exp_f32 v209, v105 clamp
v_max_f32 v104, s62, v104
v_fma_f32 v103, v103, s63, v211
v_mul_f32 v107, v107, v255
v_exp_f32 v210, v106 clamp
v_max_f32 v105, s62, v105
v_fma_f32 v104, v104, s63, v208
v_cvt_pk_bf16_f32 v227, v102, v103
v_mul_f32 v108, v108, v255
v_exp_f32 v211, v107 clamp
v_max_f32 v106, s62, v106
v_fma_f32 v105, v105, s63, v209
v_mul_f32 v109, v109, v255
v_exp_f32 v208, v108 clamp
v_max_f32 v107, s62, v107
v_fma_f32 v106, v106, s63, v210
v_cvt_pk_bf16_f32 v228, v104, v105
v_mul_f32 v110, v110, v255
v_exp_f32 v209, v109 clamp
v_max_f32 v108, s62, v108
v_fma_f32 v107, v107, s63, v211
v_mul_f32 v111, v111, v255
v_exp_f32 v210, v110 clamp
v_max_f32 v109, s62, v109
v_fma_f32 v108, v108, s63, v208
v_cvt_pk_bf16_f32 v229, v106, v107
v_exp_f32 v211, v111 clamp
v_max_f32 v110, s62, v110
v_fma_f32 v109, v109, s63, v209
v_max_f32 v111, s62, v111
v_fma_f32 v110, v110, s63, v210
v_cvt_pk_bf16_f32 v230, v108, v109
v_fma_f32 v111, v111, s63, v211
v_cvt_pk_bf16_f32 v231, v110, v111
s_add_u32 s37, s48, 25460736
s_waitcnt vmcnt(13)
v_cvt_pk_bf16_f32 v176, v176, v177
v_cvt_pk_bf16_f32 v177, v178, v179
s_waitcnt vmcnt(9)
v_cvt_pk_bf16_f32 v178, v180, v181
v_cvt_pk_bf16_f32 v179, v182, v183
s_waitcnt vmcnt(8)
v_cvt_pk_bf16_f32 v184, v184, v185
v_cvt_pk_bf16_f32 v185, v186, v187
s_waitcnt vmcnt(7)
v_cvt_pk_bf16_f32 v186, v188, v189
v_cvt_pk_bf16_f32 v187, v190, v191
s_waitcnt vmcnt(6)
v_cvt_pk_bf16_f32 v192, v192, v193
v_cvt_pk_bf16_f32 v193, v194, v195
s_waitcnt vmcnt(5)
v_cvt_pk_bf16_f32 v194, v196, v197
v_cvt_pk_bf16_f32 v195, v198, v199
s_nop 1
v_mfma_f32_16x16x32_bf16 v[200:203], v[192:195], v[224:227], 0
v_mfma_f32_16x16x32_bf16 v[204:207], v[192:195], v[228:231], 0
v_mfma_f32_16x16x32_bf16 v[96:99], v[176:179], v[224:227], 0
v_mfma_f32_16x16x32_bf16 v[104:107], v[176:179], v[228:231], 0
v_mfma_f32_16x16x32_bf16 v[100:103], v[184:187], v[224:227], 0
v_mfma_f32_16x16x32_bf16 v[108:111], v[184:187], v[228:231], 0
s_nop 2
v_fma_f32 v244, v200, v246, s62
v_fma_f32 v245, v204, v246, s62
v_rcp_f32 v244, v244
v_rcp_f32 v245, v245
v_mul_f32 v96, v96, v244
v_mul_f32 v97, v97, v244
v_mul_f32 v98, v98, v244
v_mul_f32 v99, v99, v244
v_mul_f32 v100, v100, v244
v_mul_f32 v101, v101, v244
v_mul_f32 v102, v102, v244
v_mul_f32 v103, v103, v244
v_cvt_pk_bf16_f32 v200, v96, v97
s_cmp_lt_u32 s58, 16
s_cbranch_scc0 L_back19
L_slow19:
s_waitcnt lgkmcnt(0)
s_cmp_ge_u32 s58, 16
s_cbranch_scc1 L_back19
s_mov_b32 s58, 0
s_atomic_add s58, s[20:21], s53 offset:24 glc
s_sub_u32 s46, s46, 1
s_cbranch_scc0 L_slow19
s_endpgm
L_back19:
v_add_u32 v5, 25432064, v14
global_load_dwordx4 a[192:195], v5, s[20:21] offset:-4096 sc1
global_load_dwordx4 a[196:199], v5, s[20:21] offset:-3072 sc1
global_load_dwordx4 a[200:203], v5, s[20:21] offset:-2048 sc1
global_load_dwordx4 a[204:207], v5, s[20:21] offset:-1024 sc1
global_load_dwordx4 a[208:211], v5, s[20:21] offset:0 sc1
global_load_dwordx4 a[212:215], v5, s[20:21] offset:1024 sc1
global_load_dwordx4 a[216:219], v5, s[20:21] offset:2048 sc1
global_load_dwordx4 a[220:223], v5, s[20:21] offset:3072 sc1
s_waitcnt vmcnt(6) lgkmcnt(5)
v_mfma_f32_16x16x32_bf16 v[112:115], v[40:43], a[192:195], v[112:115]
ds_read_b128 v[36:39], v6 offset:7168
v_add_u32 v5, 8192, v5
v_mfma_f32_16x16x32_bf16 v[120:123], v[40:43], a[196:199], v[120:123]
global_load_dwordx4 a[224:227], v5, s[20:21] offset:-4096 sc1
global_load_dwordx4 a[228:231], v5, s[20:21] offset:-3072 sc1
v_cvt_pk_bf16_f32 v201, v98, v99
v_cvt_pk_bf16_f32 v202, v100, v101
v_cvt_pk_bf16_f32 v203, v102, v103
v_mul_f32 v104, v104, v245
v_mul_f32 v105, v105, v245
v_mul_f32 v106, v106, v245
v_mul_f32 v107, v107, v245
v_mul_f32 v108, v108, v245
v_mfma_f32_16x16x32_bf16 v[116:119], v[44:47], a[192:195], v[116:119]
ds_read_b128 v[40:43], v6 offset:8192
global_load_dwordx4 a[232:235], v5, s[20:21] offset:-2048 sc1
global_load_dwordx4 a[236:239], v5, s[20:21] offset:-1024 sc1
v_mfma_f32_16x16x32_bf16 v[124:127], v[44:47], a[196:199], v[124:127]
global_load_dwordx4 a[240:243], v5, s[20:21] offset:0 sc1
v_mul_f32 v109, v109, v245
v_mul_f32 v110, v110, v245
v_mul_f32 v111, v111, v245
v_cvt_pk_bf16_f32 v204, v104, v105
v_cvt_pk_bf16_f32 v205, v106, v107
v_cvt_pk_bf16_f32 v206, v108, v109
v_cvt_pk_bf16_f32 v207, v110, v111
s_waitcnt vmcnt(9) lgkmcnt(3)
v_mfma_f32_16x16x32_bf16 v[128:131], v[16:19], a[192:195], v[128:131]
ds_read_b128 v[44:47], v6 offset:9216
global_load_dwordx4 a[244:247], v5, s[20:21] offset:1024 sc1
buffer_store_dwordx4 v[200:203], v0, s[20:23], s37 offen offset:0 sc1
buffer_store_dwordx4 v[204:207], v0, s[20:23], s37 offen offset:1024 sc1
v_mfma_f32_16x16x32_bf16 v[136:139], v[16:19], a[196:199], v[136:139]
s_mov_b32 s58, 0
v_mfma_f32_16x16x32_bf16 v[132:135], v[20:23], a[192:195], v[132:135]
ds_read_b128 v[16:19], v6 offset:10240
v_mfma_f32_16x16x32_bf16 v[140:143], v[20:23], a[196:199], v[140:143]
v_mfma_f32_16x16x32_bf16 v[112:115], v[24:27], a[200:203], v[112:115]
ds_read_b128 v[20:23], v6 offset:11264
v_mfma_f32_16x16x32_bf16 v[120:123], v[24:27], a[204:207], v[120:123]
global_load_dwordx4 a[248:251], v5, s[20:21] offset:2048 sc1
global_load_dwordx4 a[252:255], v5, s[20:21] offset:3072 sc1
v_mfma_f32_16x16x32_bf16 v[116:119], v[28:31], a[200:203], v[116:119]
ds_read_b128 v[24:27], v6 offset:12288
v_mfma_f32_16x16x32_bf16 v[124:127], v[28:31], a[204:207], v[124:127]
s_waitcnt vmcnt(12) lgkmcnt(3)
v_mfma_f32_16x16x32_bf16 v[128:131], v[32:35], a[200:203], v[128:131]
ds_read_b128 v[28:31], v6 offset:13312
v_mfma_f32_16x16x32_bf16 v[136:139], v[32:35], a[204:207], v[136:139]
v_mfma_f32_16x16x32_bf16 v[132:135], v[36:39], a[200:203], v[132:135]
ds_read_b128 v[32:35], v6 offset:14336
v_mfma_f32_16x16x32_bf16 v[140:143], v[36:39], a[204:207], v[140:143]
v_mfma_f32_16x16x32_bf16 v[112:115], v[40:43], a[208:211], v[112:115]
ds_read_b128 v[36:39], v6 offset:15360
v_mfma_f32_16x16x32_bf16 v[120:123], v[40:43], a[212:215], v[120:123]
v_add_u32 v5, s60, v5
v_mfma_f32_16x16x32_bf16 v[116:119], v[44:47], a[208:211], v[116:119]
s_barrier
ds_read_b128 v[40:43], v6 offset:16384
v_mfma_f32_16x16x32_bf16 v[124:127], v[44:47], a[212:215], v[124:127]
global_load_dwordx4 a[0:3], v5, s[20:21] offset:-4096 sc1
s_waitcnt vmcnt(11) lgkmcnt(3)
v_mfma_f32_16x16x32_bf16 v[128:131], v[16:19], a[208:211], v[128:131]
ds_read_b128 v[44:47], v6 offset:17408
global_load_dwordx4 a[4:7], v5, s[20:21] offset:-3072 sc1
v_mfma_f32_16x16x32_bf16 v[136:139], v[16:19], a[212:215], v[136:139]
v_mfma_f32_16x16x32_bf16 v[132:135], v[20:23], a[208:211], v[132:135]
ds_read_b128 v[16:19], v6 offset:18432
v_mfma_f32_16x16x32_bf16 v[140:143], v[20:23], a[212:215], v[140:143]
v_mfma_f32_16x16x32_bf16 v[112:115], v[24:27], a[216:219], v[112:115]
ds_read_b128 v[20:23], v6 offset:19456
v_mfma_f32_16x16x32_bf16 v[120:123], v[24:27], a[220:223], v[120:123]
global_load_dwordx4 a[8:11], v5, s[20:21] offset:-2048 sc1
global_load_dwordx4 a[12:15], v5, s[20:21] offset:-1024 sc1
v_mfma_f32_16x16x32_bf16 v[116:119], v[28:31], a[216:219], v[116:119]
ds_read_b128 v[24:27], v6 offset:20480
v_mfma_f32_16x16x32_bf16 v[124:127], v[28:31], a[220:223], v[124:127]
s_waitcnt vmcnt(12) lgkmcnt(3)
v_mfma_f32_16x16x32_bf16 v[128:131], v[32:35], a[216:219], v[128:131]
ds_read_b128 v[28:31], v6 offset:21504
v_mfma_f32_16x16x32_bf16 v[136:139], v[32:35], a[220:223], v[136:139]
v_mfma_f32_16x16x32_bf16 v[132:135], v[36:39], a[216:219], v[132:135]
ds_read_b128 v[32:35], v6 offset:22528
v_mfma_f32_16x16x32_bf16 v[140:143], v[36:39], a[220:223], v[140:143]
v_mfma_f32_16x16x32_bf16 v[112:115], v[40:43], a[224:227], v[112:115]
ds_read_b128 v[36:39], v6 offset:23552
v_mfma_f32_16x16x32_bf16 v[120:123], v[40:43], a[228:231], v[120:123]
global_load_dwordx4 a[16:19], v5, s[20:21] offset:0 sc1
global_load_dwordx4 a[20:23], v5, s[20:21] offset:1024 sc1
v_mfma_f32_16x16x32_bf16 v[116:119], v[44:47], a[224:227], v[116:119]
ds_read_b128 v[40:43], v6 offset:24576
v_mfma_f32_16x16x32_bf16 v[124:127], v[44:47], a[228:231], v[124:127]
s_waitcnt vmcnt(12) lgkmcnt(3)
v_mfma_f32_16x16x32_bf16 v[128:131], v[16:19], a[224:227], v[128:131]
ds_read_b128 v[44:47], v6 offset:25600
v_mfma_f32_16x16x32_bf16 v[136:139], v[16:19], a[228:231], v[136:139]
s_waitcnt vmcnt(8)
s_atomic_add s45, s[20:21], s53 offset:28
v_mfma_f32_16x16x32_bf16 v[132:135], v[20:23], a[224:227], v[132:135]
ds_read_b128 v[16:19], v6 offset:26624
v_mfma_f32_16x16x32_bf16 v[140:143], v[20:23], a[228:231], v[140:143]
v_mfma_f32_16x16x32_bf16 v[112:115], v[24:27], a[232:235], v[112:115]
ds_read_b128 v[20:23], v6 offset:27648
v_mfma_f32_16x16x32_bf16 v[120:123], v[24:27], a[236:239], v[120:123]
global_load_dwordx4 a[24:27], v5, s[20:21] offset:2048 sc1
global_load_dwordx4 a[28:31], v5, s[20:21] offset:3072 sc1
v_mfma_f32_16x16x32_bf16 v[116:119], v[28:31], a[232:235], v[116:119]
ds_read_b128 v[24:27], v6 offset:28672
v_mfma_f32_16x16x32_bf16 v[124:127], v[28:31], a[236:239], v[124:127]
s_waitcnt lgkmcnt(4)
v_mfma_f32_16x16x32_bf16 v[128:131], v[32:35], a[232:235], v[128:131]
ds_read_b128 v[28:31], v6 offset:29696
v_mfma_f32_16x16x32_bf16 v[136:139], v[32:35], a[236:239], v[136:139]
v_mfma_f32_16x16x32_bf16 v[132:135], v[36:39], a[232:235], v[132:135]
ds_read_b128 v[32:35], v6 offset:30720
v_mfma_f32_16x16x32_bf16 v[140:143], v[36:39], a[236:239], v[140:143]
v_mfma_f32_16x16x32_bf16 v[112:115], v[40:43], a[240:243], v[112:115]
ds_read_b128 v[36:39], v6 offset:31744
v_mfma_f32_16x16x32_bf16 v[120:123], v[40:43], a[244:247], v[120:123]
v_add_u32 v5, 8192, v5
s_waitcnt lgkmcnt(4)
v_mfma_f32_16x16x32_bf16 v[116:119], v[44:47], a[240:243], v[116:119]
s_barrier
ds_read_b128 v[40:43], v6 offset:32768
v_mfma_f32_16x16x32_bf16 v[124:127], v[44:47], a[244:247], v[124:127]
global_load_dwordx4 a[32:35], v5, s[20:21] offset:-4096 sc1
global_load_dwordx4 a[36:39], v5, s[20:21] offset:-3072 sc1
v_mfma_f32_16x16x32_bf16 v[128:131], v[16:19], a[240:243], v[128:131]
ds_read_b128 v[44:47], v6 offset:33792
v_mfma_f32_16x16x32_bf16 v[136:139], v[16:19], a[244:247], v[136:139]
v_mfma_f32_16x16x32_bf16 v[132:135], v[20:23], a[240:243], v[132:135]
ds_read_b128 v[16:19], v6 offset:34816
v_mfma_f32_16x16x32_bf16 v[140:143], v[20:23], a[244:247], v[140:143]
s_waitcnt vmcnt(10) lgkmcnt(4)
v_mfma_f32_16x16x32_bf16 v[112:115], v[24:27], a[248:251], v[112:115]
ds_read_b128 v[20:23], v6 offset:35840
v_mfma_f32_16x16x32_bf16 v[120:123], v[24:27], a[252:255], v[120:123]
global_load_dwordx4 a[40:43], v5, s[20:21] offset:-2048 sc1
global_load_dwordx4 a[44:47], v5, s[20:21] offset:-1024 sc1
v_mfma_f32_16x16x32_bf16 v[116:119], v[28:31], a[248:251], v[116:119]
ds_read_b128 v[24:27], v6 offset:36864
v_mfma_f32_16x16x32_bf16 v[124:127], v[28:31], a[252:255], v[124:127]
v_mfma_f32_16x16x32_bf16 v[128:131], v[32:35], a[248:251], v[128:131]
ds_read_b128 v[28:31], v6 offset:37888
v_mfma_f32_16x16x32_bf16 v[136:139], v[32:35], a[252:255], v[136:139]
s_waitcnt vmcnt(10) lgkmcnt(4)
v_mfma_f32_16x16x32_bf16 v[132:135], v[36:39], a[248:251], v[132:135]
ds_read_b128 v[32:35], v6 offset:38912
v_mfma_f32_16x16x32_bf16 v[140:143], v[36:39], a[252:255], v[140:143]
s_atomic_add s58, s[20:21], s53 offset:28 glc
v_mfma_f32_16x16x32_bf16 v[112:115], v[40:43], a[0:3], v[112:115]
ds_read_b128 v[36:39], v6 offset:39936
v_mfma_f32_16x16x32_bf16 v[120:123], v[40:43], a[4:7], v[120:123]
global_load_dwordx4 a[48:51], v5, s[20:21] offset:0 sc1
global_load_dwordx4 a[52:55], v5, s[20:21] offset:1024 sc1
v_mfma_f32_16x16x32_bf16 v[116:119], v[44:47], a[0:3], v[116:119]
ds_read_b128 v[40:43], v6 offset:40960
v_mfma_f32_16x16x32_bf16 v[124:127], v[44:47], a[4:7], v[124:127]
s_waitcnt lgkmcnt(5)
v_mfma_f32_16x16x32_bf16 v[128:131], v[16:19], a[0:3], v[128:131]
ds_read_b128 v[44:47], v6 offset:41984
v_mfma_f32_16x16x32_bf16 v[136:139], v[16:19], a[4:7], v[136:139]
v_mfma_f32_16x16x32_bf16 v[132:135], v[20:23], a[0:3], v[132:135]
ds_read_b128 v[16:19], v6 offset:43008
v_mfma_f32_16x16x32_bf16 v[140:143], v[20:23], a[4:7], v[140:143]
s_waitcnt vmcnt(10) lgkmcnt(5)
v_mfma_f32_16x16x32_bf16 v[112:115], v[24:27], a[8:11], v[112:115]
ds_read_b128 v[20:23], v6 offset:44032
v_mfma_f32_16x16x32_bf16 v[120:123], v[24:27], a[12:15], v[120:123]
global_load_dwordx4 a[56:59], v5, s[20:21] offset:2048 sc1
global_load_dwordx4 a[60:63], v5, s[20:21] offset:3072 sc1
v_mfma_f32_16x16x32_bf16 v[116:119], v[28:31], a[8:11], v[116:119]
ds_read_b128 v[24:27], v6 offset:45056
v_mfma_f32_16x16x32_bf16 v[124:127], v[28:31], a[12:15], v[124:127]
s_waitcnt lgkmcnt(5)
v_mfma_f32_16x16x32_bf16 v[128:131], v[32:35], a[8:11], v[128:131]
ds_read_b128 v[28:31], v6 offset:46080
v_mfma_f32_16x16x32_bf16 v[136:139], v[32:35], a[12:15], v[136:139]
v_mfma_f32_16x16x32_bf16 v[132:135], v[36:39], a[8:11], v[132:135]
ds_read_b128 v[32:35], v6 offset:47104
v_mfma_f32_16x16x32_bf16 v[140:143], v[36:39], a[12:15], v[140:143]
s_waitcnt vmcnt(10) lgkmcnt(5)
v_mfma_f32_16x16x32_bf16 v[112:115], v[40:43], a[16:19], v[112:115]
ds_read_b128 v[36:39], v6 offset:48128
v_mfma_f32_16x16x32_bf16 v[120:123], v[40:43], a[20:23], v[120:123]
v_mfma_f32_16x16x32_bf16 v[116:119], v[44:47], a[16:19], v[116:119]
s_barrier
ds_read_b128 v[40:43], v6 offset:49152
v_mfma_f32_16x16x32_bf16 v[124:127], v[44:47], a[20:23], v[124:127]
s_add_u32 m0, s43, 114688
s_waitcnt vmcnt(8) lgkmcnt(4)
v_mfma_f32_16x16x32_bf16 v[128:131], v[16:19], a[16:19], v[128:131]
ds_read_b128 v[44:47], v6 offset:50176
v_add_u32 v4, 16384, v4
v_mfma_f32_16x16x32_bf16 v[136:139], v[16:19], a[20:23], v[136:139]
global_load_lds_dwordx4 v4, s[20:21] offset:0 sc1
v_mfma_f32_16x16x32_bf16 v[132:135], v[20:23], a[16:19], v[132:135]
ds_read_b128 v[16:19], v6 offset:51200
global_load_lds_dwordx4 v4, s[20:21] offset:1024 sc1
v_mfma_f32_16x16x32_bf16 v[140:143], v[20:23], a[20:23], v[140:143]
v_mfma_f32_16x16x32_bf16 v[112:115], v[24:27], a[24:27], v[112:115]
ds_read_b128 v[20:23], v6 offset:52224
v_mfma_f32_16x16x32_bf16 v[120:123], v[24:27], a[28:31], v[120:123]
s_waitcnt lgkmcnt(4)
v_mfma_f32_16x16x32_bf16 v[116:119], v[28:31], a[24:27], v[116:119]
ds_read_b128 v[24:27], v6 offset:53248
v_mfma_f32_16x16x32_bf16 v[124:127], v[28:31], a[28:31], v[124:127]
v_mfma_f32_16x16x32_bf16 v[128:131], v[32:35], a[24:27], v[128:131]
ds_read_b128 v[28:31], v6 offset:54272
global_load_lds_dwordx4 v4, s[20:21] offset:2048 sc1
v_mfma_f32_16x16x32_bf16 v[136:139], v[32:35], a[28:31], v[136:139]
v_mfma_f32_16x16x32_bf16 v[132:135], v[36:39], a[24:27], v[132:135]
ds_read_b128 v[32:35], v6 offset:55296
v_mfma_f32_16x16x32_bf16 v[140:143], v[36:39], a[28:31], v[140:143]
s_waitcnt vmcnt(9) lgkmcnt(4)
v_mfma_f32_16x16x32_bf16 v[112:115], v[40:43], a[32:35], v[112:115]
ds_read_b128 v[36:39], v6 offset:56320
global_load_lds_dwordx4 v4, s[20:21] offset:3072 sc1
v_mfma_f32_16x16x32_bf16 v[120:123], v[40:43], a[36:39], v[120:123]
v_mfma_f32_16x16x32_bf16 v[116:119], v[44:47], a[32:35], v[116:119]
ds_read_b128 v[40:43], v6 offset:57344
v_mfma_f32_16x16x32_bf16 v[124:127], v[44:47], a[36:39], v[124:127]
v_mfma_f32_16x16x32_bf16 v[128:131], v[16:19], a[32:35], v[128:131]
ds_read_b128 v[44:47], v6 offset:58368
s_add_u32 m0, s43, 0
v_mfma_f32_16x16x32_bf16 v[136:139], v[16:19], a[36:39], v[136:139]
v_add_u32 v4, 16384, v4
s_waitcnt vmcnt(8) lgkmcnt(4)
v_mfma_f32_16x16x32_bf16 v[132:135], v[20:23], a[32:35], v[132:135]
ds_read_b128 v[16:19], v6 offset:59392
global_load_lds_dwordx4 v4, s[20:21] offset:0 sc1
v_mfma_f32_16x16x32_bf16 v[140:143], v[20:23], a[36:39], v[140:143]
v_mfma_f32_16x16x32_bf16 v[112:115], v[24:27], a[40:43], v[112:115]
ds_read_b128 v[20:23], v6 offset:60416
global_load_lds_dwordx4 v4, s[20:21] offset:1024 sc1
v_mfma_f32_16x16x32_bf16 v[120:123], v[24:27], a[44:47], v[120:123]
s_cmp_lt_u32 s58, 16
s_cbranch_scc0 L_back20
L_slow20:
s_waitcnt lgkmcnt(0)
s_cmp_ge_u32 s58, 16
s_cbranch_scc1 L_back20
s_mov_b32 s58, 0
s_atomic_add s58, s[20:21], s53 offset:28 glc
s_sub_u32 s46, s46, 1
s_cbranch_scc0 L_slow20
s_endpgm
L_back20:
v_mfma_f32_16x16x32_bf16 v[116:119], v[28:31], a[40:43], v[116:119]
ds_read_b128 v[24:27], v6 offset:61440
v_add_u32 v5, s61, v5
v_mfma_f32_16x16x32_bf16 v[124:127], v[28:31], a[44:47], v[124:127]
global_load_dwordx4 a[64:67], v5, s[20:21] offset:-4096 sc1
global_load_dwordx4 a[68:71], v5, s[20:21] offset:-3072 sc1
global_load_dwordx4 a[72:75], v5, s[20:21] offset:-2048 sc1
global_load_dwordx4 a[76:79], v5, s[20:21] offset:-1024 sc1
global_load_dwordx4 a[80:83], v5, s[20:21] offset:0 sc1
global_load_dwordx4 a[84:87], v5, s[20:21] offset:1024 sc1
global_load_dwordx4 a[88:91], v5, s[20:21] offset:2048 sc1
global_load_dwordx4 a[92:95], v5, s[20:21] offset:3072 sc1
v_add_u32 v5, 8192, v5
s_waitcnt vmcnt(16) lgkmcnt(3)
v_mfma_f32_16x16x32_bf16 v[128:131], v[32:35], a[40:43], v[128:131]
ds_read_b128 v[28:31], v6 offset:62464
global_load_dwordx4 a[96:99], v5, s[20:21] offset:-4096 sc1
global_load_dwordx4 a[100:103], v5, s[20:21] offset:-3072 sc1
v_mfma_f32_16x16x32_bf16 v[136:139], v[32:35], a[44:47], v[136:139]
global_load_dwordx4 a[104:107], v5, s[20:21] offset:-2048 sc1
global_load_dwordx4 a[108:111], v5, s[20:21] offset:-1024 sc1
v_mfma_f32_16x16x32_bf16 v[132:135], v[36:39], a[40:43], v[132:135]
ds_read_b128 v[32:35], v6 offset:63488
global_load_dwordx4 a[112:115], v5, s[20:21] offset:0 sc1
v_mfma_f32_16x16x32_bf16 v[140:143], v[36:39], a[44:47], v[140:143]
global_load_dwordx4 a[116:119], v5, s[20:21] offset:1024 sc1
global_load_dwordx4 a[120:123], v5, s[20:21] offset:2048 sc1
v_mfma_f32_16x16x32_bf16 v[112:115], v[40:43], a[48:51], v[112:115]
ds_read_b128 v[36:39], v6 offset:64512
global_load_dwordx4 a[124:127], v5, s[20:21] offset:3072 sc1
v_mfma_f32_16x16x32_bf16 v[120:123], v[40:43], a[52:55], v[120:123]
v_add_u32 v5, s60, v5
v_mfma_f32_16x16x32_bf16 v[116:119], v[44:47], a[48:51], v[116:119]
s_barrier
ds_read_b128 v[40:43], v7 offset:0
v_mfma_f32_16x16x32_bf16 v[124:127], v[44:47], a[52:55], v[124:127]
global_load_dwordx4 a[128:131], v5, s[20:21] offset:-4096 sc1
s_waitcnt vmcnt(23) lgkmcnt(3)
v_mfma_f32_16x16x32_bf16 v[128:131], v[16:19], a[48:51], v[128:131]
ds_read_b128 v[44:47], v7 offset:1024
global_load_dwordx4 a[132:135], v5, s[20:21] offset:-3072 sc1
v_mfma_f32_16x16x32_bf16 v[136:139], v[16:19], a[52:55], v[136:139]
global_load_dwordx4 a[136:139], v5, s[20:21] offset:-2048 sc1
global_load_dwordx4 a[140:143], v5, s[20:21] offset:-1024 sc1
v_mfma_f32_16x16x32_bf16 v[132:135], v[20:23], a[48:51], v[132:135]
ds_read_b128 v[16:19], v7 offset:2048
v_mfma_f32_16x16x32_bf16 v[140:143], v[20:23], a[52:55], v[140:143]
v_mfma_f32_16x16x32_bf16 v[112:115], v[24:27], a[56:59], v[112:115]
ds_read_b128 v[20:23], v7 offset:3072
v_mfma_f32_16x16x32_bf16 v[120:123], v[24:27], a[60:63], v[120:123]
global_load_dwordx4 a[144:147], v5, s[20:21] offset:0 sc1
global_load_dwordx4 a[148:151], v5, s[20:21] offset:1024 sc1
v_mfma_f32_16x16x32_bf16 v[116:119], v[28:31], a[56:59], v[116:119]
ds_read_b128 v[24:27], v7 offset:4096
v_mfma_f32_16x16x32_bf16 v[124:127], v[28:31], a[60:63], v[124:127]
s_waitcnt vmcnt(20) lgkmcnt(3)
v_mfma_f32_16x16x32_bf16 v[128:131], v[32:35], a[56:59], v[128:131]
ds_read_b128 v[28:31], v7 offset:5120
v_mfma_f32_16x16x32_bf16 v[136:139], v[32:35], a[60:63], v[136:139]
global_load_dwordx4 a[152:155], v5, s[20:21] offset:2048 sc1
global_load_dwordx4 a[156:159], v5, s[20:21] offset:3072 sc1
v_mfma_f32_16x16x32_bf16 v[132:135], v[36:39], a[56:59], v[132:135]
ds_read_b128 v[32:35], v7 offset:6144
v_mfma_f32_16x16x32_bf16 v[140:143], v[36:39], a[60:63], v[140:143]
v_mfma_f32_16x16x32_bf16 v[112:115], v[40:43], a[64:67], v[112:115]
ds_read_b128 v[36:39], v7 offset:7168
v_mfma_f32_16x16x32_bf16 v[120:123], v[40:43], a[68:71], v[120:123]
v_add_u32 v5, 8192, v5
v_mfma_f32_16x16x32_bf16 v[116:119], v[44:47], a[64:67], v[116:119]
ds_read_b128 v[40:43], v7 offset:8192
global_load_dwordx4 a[160:163], v5, s[20:21] offset:-4096 sc1
v_mfma_f32_16x16x32_bf16 v[124:127], v[44:47], a[68:71], v[124:127]
global_load_dwordx4 a[164:167], v5, s[20:21] offset:-3072 sc1
s_waitcnt vmcnt(20) lgkmcnt(3)
v_mfma_f32_16x16x32_bf16 v[112:115], v[16:19], a[72:75], v[112:115]
ds_read_b128 v[44:47], v7 offset:9216
v_mfma_f32_16x16x32_bf16 v[120:123], v[16:19], a[76:79], v[120:123]
global_load_dwordx4 a[168:171], v5, s[20:21] offset:-2048 sc1
global_load_dwordx4 a[172:175], v5, s[20:21] offset:-1024 sc1
v_mfma_f32_16x16x32_bf16 v[116:119], v[20:23], a[72:75], v[116:119]
ds_read_b128 v[16:19], v7 offset:10240
v_mfma_f32_16x16x32_bf16 v[124:127], v[20:23], a[76:79], v[124:127]
v_mfma_f32_16x16x32_bf16 v[112:115], v[24:27], a[80:83], v[112:115]
ds_read_b128 v[20:23], v7 offset:11264
v_mfma_f32_16x16x32_bf16 v[120:123], v[24:27], a[84:87], v[120:123]
global_load_dwordx4 a[176:179], v5, s[20:21] offset:0 sc1
global_load_dwordx4 a[180:183], v5, s[20:21] offset:1024 sc1
v_mfma_f32_16x16x32_bf16 v[116:119], v[28:31], a[80:83], v[116:119]
ds_read_b128 v[24:27], v7 offset:12288
v_mfma_f32_16x16x32_bf16 v[124:127], v[28:31], a[84:87], v[124:127]
s_waitcnt vmcnt(20) lgkmcnt(3)
v_mfma_f32_16x16x32_bf16 v[112:115], v[32:35], a[88:91], v[112:115]
ds_read_b128 v[28:31], v7 offset:13312
v_mfma_f32_16x16x32_bf16 v[120:123], v[32:35], a[92:95], v[120:123]
global_load_dwordx4 a[184:187], v5, s[20:21] offset:2048 sc1
global_load_dwordx4 a[188:191], v5, s[20:21] offset:3072 sc1
v_mfma_f32_16x16x32_bf16 v[116:119], v[36:39], a[88:91], v[116:119]
ds_read_b128 v[32:35], v7 offset:14336
v_mfma_f32_16x16x32_bf16 v[124:127], v[36:39], a[92:95], v[124:127]
v_mfma_f32_16x16x32_bf16 v[112:115], v[40:43], a[96:99], v[112:115]
ds_read_b128 v[36:39], v7 offset:15360
v_mfma_f32_16x16x32_bf16 v[120:123], v[40:43], a[100:103], v[120:123]
v_mfma_f32_16x16x32_bf16 v[116:119], v[44:47], a[96:99], v[116:119]
s_barrier
ds_read_b128 v[40:43], v7 offset:16384
v_mfma_f32_16x16x32_bf16 v[124:127], v[44:47], a[100:103], v[124:127]
s_waitcnt vmcnt(18) lgkmcnt(3)
v_mfma_f32_16x16x32_bf16 v[112:115], v[16:19], a[104:107], v[112:115]
ds_read_b128 v[44:47], v7 offset:17408
v_mfma_f32_16x16x32_bf16 v[120:123], v[16:19], a[108:111], v[120:123]
v_mfma_f32_16x16x32_bf16 v[116:119], v[20:23], a[104:107], v[116:119]
ds_read_b128 v[16:19], v7 offset:18432
global_load_lds_dwordx4 v4, s[20:21] offset:2048 sc1
v_mfma_f32_16x16x32_bf16 v[124:127], v[20:23], a[108:111], v[124:127]
v_mfma_f32_16x16x32_bf16 v[112:115], v[24:27], a[112:115], v[112:115]
ds_read_b128 v[20:23], v7 offset:19456
v_mfma_f32_16x16x32_bf16 v[120:123], v[24:27], a[116:119], v[120:123]
v_mfma_f32_16x16x32_bf16 v[116:119], v[28:31], a[112:115], v[116:119]
ds_read_b128 v[24:27], v7 offset:20480
global_load_lds_dwordx4 v4, s[20:21] offset:3072 sc1
v_mfma_f32_16x16x32_bf16 v[124:127], v[28:31], a[116:119], v[124:127]
s_waitcnt vmcnt(16) lgkmcnt(3)
v_mfma_f32_16x16x32_bf16 v[112:115], v[32:35], a[120:123], v[112:115]
ds_read_b128 v[28:31], v7 offset:21504
v_mfma_f32_16x16x32_bf16 v[120:123], v[32:35], a[124:127], v[120:123]
v_mfma_f32_16x16x32_bf16 v[116:119], v[36:39], a[120:123], v[116:119]
ds_read_b128 v[32:35], v7 offset:22528
v_mfma_f32_16x16x32_bf16 v[124:127], v[36:39], a[124:127], v[124:127]
v_mfma_f32_16x16x32_bf16 v[112:115], v[40:43], a[128:131], v[112:115]
ds_read_b128 v[36:39], v7 offset:23552
s_add_u32 m0, s43, 16384
v_mfma_f32_16x16x32_bf16 v[120:123], v[40:43], a[132:135], v[120:123]
v_add_u32 v4, 16384, v4
v_mfma_f32_16x16x32_bf16 v[116:119], v[44:47], a[128:131], v[116:119]
ds_read_b128 v[40:43], v7 offset:24576
global_load_lds_dwordx4 v4, s[20:21] offset:0 sc1
v_mfma_f32_16x16x32_bf16 v[124:127], v[44:47], a[132:135], v[124:127]
s_waitcnt vmcnt(13) lgkmcnt(3)
v_mfma_f32_16x16x32_bf16 v[112:115], v[16:19], a[136:139], v[112:115]
ds_read_b128 v[44:47], v7 offset:25600
global_load_lds_dwordx4 v4, s[20:21] offset:1024 sc1
v_mfma_f32_16x16x32_bf16 v[120:123], v[16:19], a[140:143], v[120:123]
v_mfma_f32_16x16x32_bf16 v[116:119], v[20:23], a[136:139], v[116:119]
ds_read_b128 v[16:19], v7 offset:26624
v_mfma_f32_16x16x32_bf16 v[124:127], v[20:23], a[140:143], v[124:127]
v_mfma_f32_16x16x32_bf16 v[112:115], v[24:27], a[144:147], v[112:115]
ds_read_b128 v[20:23], v7 offset:27648
global_load_lds_dwordx4 v4, s[20:21] offset:2048 sc1
v_mfma_f32_16x16x32_bf16 v[120:123], v[24:27], a[148:151], v[120:123]
v_mfma_f32_16x16x32_bf16 v[116:119], v[28:31], a[144:147], v[116:119]
ds_read_b128 v[24:27], v7 offset:28672
v_mfma_f32_16x16x32_bf16 v[124:127], v[28:31], a[148:151], v[124:127]
s_waitcnt vmcnt(11) lgkmcnt(3)
v_mfma_f32_16x16x32_bf16 v[112:115], v[32:35], a[152:155], v[112:115]
ds_read_b128 v[28:31], v7 offset:29696
global_load_lds_dwordx4 v4, s[20:21] offset:3072 sc1
v_mfma_f32_16x16x32_bf16 v[120:123], v[32:35], a[156:159], v[120:123]
v_mfma_f32_16x16x32_bf16 v[116:119], v[36:39], a[152:155], v[116:119]
ds_read_b128 v[32:35], v7 offset:30720
v_mfma_f32_16x16x32_bf16 v[124:127], v[36:39], a[156:159], v[124:127]
v_mfma_f32_16x16x32_bf16 v[112:115], v[40:43], a[160:163], v[112:115]
ds_read_b128 v[36:39], v7 offset:31744
v_mfma_f32_16x16x32_bf16 v[120:123], v[40:43], a[164:167], v[120:123]
v_mfma_f32_16x16x32_bf16 v[116:119], v[44:47], a[160:163], v[116:119]
s_barrier
ds_read_b128 v[40:43], v7 offset:32768
v_mfma_f32_16x16x32_bf16 v[124:127], v[44:47], a[164:167], v[124:127]
s_add_u32 m0, s43, 32768
s_waitcnt vmcnt(8) lgkmcnt(3)
v_mfma_f32_16x16x32_bf16 v[112:115], v[16:19], a[168:171], v[112:115]
ds_read_b128 v[44:47], v7 offset:33792
v_add_u32 v4, 16384, v4
v_mfma_f32_16x16x32_bf16 v[120:123], v[16:19], a[172:175], v[120:123]
global_load_lds_dwordx4 v4, s[20:21] offset:0 sc1
s_getpc_b64 s[4:5]
v_mfma_f32_16x16x32_bf16 v[116:119], v[20:23], a[168:171], v[116:119]
ds_read_b128 v[16:19], v7 offset:34816
global_load_dword v13, v12, s[4:5]
v_mfma_f32_16x16x32_bf16 v[124:127], v[20:23], a[172:175], v[124:127]
global_load_lds_dwordx4 v4, s[20:21] offset:1024 sc1
v_mfma_f32_16x16x32_bf16 v[112:115], v[24:27], a[176:179], v[112:115]
ds_read_b128 v[20:23], v7 offset:35840
v_mfma_f32_16x16x32_bf16 v[120:123], v[24:27], a[180:183], v[120:123]
v_mfma_f32_16x16x32_bf16 v[116:119], v[28:31], a[176:179], v[116:119]
ds_read_b128 v[24:27], v7 offset:36864
global_load_lds_dwordx4 v4, s[20:21] offset:2048 sc1
v_mfma_f32_16x16x32_bf16 v[124:127], v[28:31], a[180:183], v[124:127]
s_waitcnt vmcnt(10) lgkmcnt(3)
v_mfma_f32_16x16x32_bf16 v[112:115], v[32:35], a[184:187], v[112:115]
ds_read_b128 v[28:31], v7 offset:37888
v_mfma_f32_16x16x32_bf16 v[120:123], v[32:35], a[188:191], v[120:123]
v_mfma_f32_16x16x32_bf16 v[116:119], v[36:39], a[184:187], v[116:119]
ds_read_b128 v[32:35], v7 offset:38912
v_mfma_f32_16x16x32_bf16 v[124:127], v[36:39], a[188:191], v[124:127]
v_mfma_f32_16x16x32_bf16 v[128:131], v[40:43], a[64:67], v[128:131]
ds_read_b128 v[36:39], v7 offset:39936
global_load_lds_dwordx4 v4, s[20:21] offset:3072 sc1
v_mfma_f32_16x16x32_bf16 v[136:139], v[40:43], a[68:71], v[136:139]
v_cvt_pk_bf16_f32 v48, v112, v113
v_cvt_pk_bf16_f32 v49, v114, v115
v_cvt_pk_bf16_f32 v50, v116, v117
v_cvt_pk_bf16_f32 v51, v118, v119
v_cvt_pk_bf16_f32 v52, v120, v121
v_cvt_pk_bf16_f32 v53, v122, v123
v_cvt_pk_bf16_f32 v54, v124, v125
v_cvt_pk_bf16_f32 v55, v126, v127
s_add_u32 s37, s48, 16515072
v_mfma_f32_16x16x32_bf16 v[132:135], v[44:47], a[64:67], v[132:135]
ds_read_b128 v[40:43], v7 offset:40960
buffer_store_dwordx4 v[48:51], v0, s[20:23], s37 offen offset:0 sc1
buffer_store_dwordx4 v[52:55], v0, s[20:23], s37 offen offset:1024 sc1
v_mfma_f32_16x16x32_bf16 v[140:143], v[44:47], a[68:71], v[140:143]
s_add_u32 m0, s43, 49152
s_mov_b32 s58, 0
v_mov_b32 v212, 0x3f803f80
v_dot2_f32_bf16 v208, v48, v212, 0
v_dot2_f32_bf16 v209, v48, v48, 0
v_dot2_f32_bf16 v210, v52, v212, 0
v_dot2_f32_bf16 v211, v52, v52, 0
v_dot2_f32_bf16 v208, v49, v212, v208
v_dot2_f32_bf16 v209, v49, v49, v209
v_dot2_f32_bf16 v210, v53, v212, v210
v_dot2_f32_bf16 v211, v53, v53, v211
v_dot2_f32_bf16 v208, v50, v212, v208
v_dot2_f32_bf16 v209, v50, v50, v209
v_dot2_f32_bf16 v210, v54, v212, v210
v_dot2_f32_bf16 v211, v54, v54, v211
v_dot2_f32_bf16 v208, v51, v212, v208
v_dot2_f32_bf16 v209, v51, v51, v209
v_dot2_f32_bf16 v210, v55, v212, v210
v_dot2_f32_bf16 v211, v55, v55, v211
s_waitcnt lgkmcnt(3)
v_mfma_f32_16x16x32_bf16 v[128:131], v[16:19], a[72:75], v[128:131]
ds_read_b128 v[44:47], v7 offset:41984
v_add_u32 v4, 16384, v4
v_mfma_f32_16x16x32_bf16 v[136:139], v[16:19], a[76:79], v[136:139]
global_load_lds_dwordx4 v4, s[20:21] offset:0 sc1
v_mfma_f32_16x16x32_bf16 v[132:135], v[20:23], a[72:75], v[132:135]
ds_read_b128 v[16:19], v7 offset:43008
v_mfma_f32_16x16x32_bf16 v[140:143], v[20:23], a[76:79], v[140:143]
v_mfma_f32_16x16x32_bf16 v[128:131], v[24:27], a[80:83], v[128:131]
ds_read_b128 v[20:23], v7 offset:44032
v_mfma_f32_16x16x32_bf16 v[136:139], v[24:27], a[84:87], v[136:139]
v_mfma_f32_16x16x32_bf16 v[132:135], v[28:31], a[80:83], v[132:135]
ds_read_b128 v[24:27], v7 offset:45056
v_mfma_f32_16x16x32_bf16 v[140:143], v[28:31], a[84:87], v[140:143]
s_waitcnt lgkmcnt(3)
v_mfma_f32_16x16x32_bf16 v[128:131], v[32:35], a[88:91], v[128:131]
ds_read_b128 v[28:31], v7 offset:46080
global_load_lds_dwordx4 v4, s[20:21] offset:1024 sc1
v_mfma_f32_16x16x32_bf16 v[136:139], v[32:35], a[92:95], v[136:139]
v_mfma_f32_16x16x32_bf16 v[132:135], v[36:39], a[88:91], v[132:135]
ds_read_b128 v[32:35], v7 offset:47104
v_mfma_f32_16x16x32_bf16 v[140:143], v[36:39], a[92:95], v[140:143]
v_mfma_f32_16x16x32_bf16 v[128:131], v[40:43], a[96:99], v[128:131]
ds_read_b128 v[36:39], v7 offset:48128
v_mfma_f32_16x16x32_bf16 v[136:139], v[40:43], a[100:103], v[136:139]
v_mfma_f32_16x16x32_bf16 v[132:135], v[44:47], a[96:99], v[132:135]
s_barrier
ds_read_b128 v[40:43], v7 offset:49152
v_mfma_f32_16x16x32_bf16 v[140:143], v[44:47], a[100:103], v[140:143]
global_load_lds_dwordx4 v4, s[20:21] offset:2048 sc1
s_waitcnt lgkmcnt(3)
v_mfma_f32_16x16x32_bf16 v[128:131], v[16:19], a[104:107], v[128:131]
ds_read_b128 v[44:47], v7 offset:50176
v_mfma_f32_16x16x32_bf16 v[136:139], v[16:19], a[108:111], v[136:139]
v_mfma_f32_16x16x32_bf16 v[132:135], v[20:23], a[104:107], v[132:135]
ds_read_b128 v[16:19], v7 offset:51200
global_load_lds_dwordx4 v4, s[20:21] offset:3072 sc1
v_mfma_f32_16x16x32_bf16 v[140:143], v[20:23], a[108:111], v[140:143]
v_mfma_f32_16x16x32_bf16 v[128:131], v[24:27], a[112:115], v[128:131]
ds_read_b128 v[20:23], v7 offset:52224
v_mfma_f32_16x16x32_bf16 v[136:139], v[24:27], a[116:119], v[136:139]
v_mfma_f32_16x16x32_bf16 v[132:135], v[28:31], a[112:115], v[132:135]
ds_read_b128 v[24:27], v7 offset:53248
s_add_u32 m0, s43, 65536
v_mfma_f32_16x16x32_bf16 v[140:143], v[28:31], a[116:119], v[140:143]
v_add_u32 v4, 16384, v4
s_waitcnt lgkmcnt(3)
v_mfma_f32_16x16x32_bf16 v[128:131], v[32:35], a[120:123], v[128:131]
ds_read_b128 v[28:31], v7 offset:54272
global_load_lds_dwordx4 v4, s[20:21] offset:0 sc1
v_mfma_f32_16x16x32_bf16 v[136:139], v[32:35], a[124:127], v[136:139]
v_mfma_f32_16x16x32_bf16 v[132:135], v[36:39], a[120:123], v[132:135]
ds_read_b128 v[32:35], v7 offset:55296
global_load_lds_dwordx4 v4, s[20:21] offset:1024 sc1
v_mfma_f32_16x16x32_bf16 v[140:143], v[36:39], a[124:127], v[140:143]
v_mfma_f32_16x16x32_bf16 v[128:131], v[40:43], a[128:131], v[128:131]
ds_read_b128 v[36:39], v7 offset:56320
v_mfma_f32_16x16x32_bf16 v[136:139], v[40:43], a[132:135], v[136:139]
v_mfma_f32_16x16x32_bf16 v[132:135], v[44:47], a[128:131], v[132:135]
ds_read_b128 v[40:43], v7 offset:57344
v_mfma_f32_16x16x32_bf16 v[140:143], v[44:47], a[132:135], v[140:143]
s_waitcnt lgkmcnt(3)
v_mfma_f32_16x16x32_bf16 v[128:131], v[16:19], a[136:139], v[128:131]
ds_read_b128 v[44:47], v7 offset:58368
global_load_lds_dwordx4 v4, s[20:21] offset:2048 sc1
v_mfma_f32_16x16x32_bf16 v[136:139], v[16:19], a[140:143], v[136:139]
v_mfma_f32_16x16x32_bf16 v[132:135], v[20:23], a[136:139], v[132:135]
ds_read_b128 v[16:19], v7 offset:59392
v_mfma_f32_16x16x32_bf16 v[140:143], v[20:23], a[140:143], v[140:143]
s_waitcnt vmcnt(7)
s_atomic_add s45, s[20:21], s53 offset:32
v_mfma_f32_16x16x32_bf16 v[128:131], v[24:27], a[144:147], v[128:131]
ds_read_b128 v[20:23], v7 offset:60416
global_load_lds_dwordx4 v4, s[20:21] offset:3072 sc1
v_mfma_f32_16x16x32_bf16 v[136:139], v[24:27], a[148:151], v[136:139]
v_mfma_f32_16x16x32_bf16 v[132:135], v[28:31], a[144:147], v[132:135]
ds_read_b128 v[24:27], v7 offset:61440
v_mfma_f32_16x16x32_bf16 v[140:143], v[28:31], a[148:151], v[140:143]
s_waitcnt lgkmcnt(4)
v_mfma_f32_16x16x32_bf16 v[128:131], v[32:35], a[152:155], v[128:131]
ds_read_b128 v[28:31], v7 offset:62464
s_add_u32 m0, s43, 81920
v_mfma_f32_16x16x32_bf16 v[136:139], v[32:35], a[156:159], v[136:139]
v_add_u32 v4, 16384, v4
v_mfma_f32_16x16x32_bf16 v[132:135], v[36:39], a[152:155], v[132:135]
ds_read_b128 v[32:35], v7 offset:63488
global_load_lds_dwordx4 v4, s[20:21] offset:0 sc1
v_mfma_f32_16x16x32_bf16 v[140:143], v[36:39], a[156:159], v[140:143]
v_mfma_f32_16x16x32_bf16 v[128:131], v[40:43], a[160:163], v[128:131]
ds_read_b128 v[36:39], v7 offset:64512
global_load_lds_dwordx4 v4, s[20:21] offset:1024 sc1
v_mfma_f32_16x16x32_bf16 v[136:139], v[40:43], a[164:167], v[136:139]
s_waitcnt lgkmcnt(4)
v_mfma_f32_16x16x32_bf16 v[132:135], v[44:47], a[160:163], v[132:135]
s_barrier
ds_read_b128 v[40:43], v6 offset:0
v_mfma_f32_16x16x32_bf16 v[140:143], v[44:47], a[164:167], v[140:143]
v_mfma_f32_16x16x32_bf16 v[128:131], v[16:19], a[168:171], v[128:131]
ds_read_b128 v[44:47], v6 offset:1024
v_mfma_f32_16x16x32_bf16 v[136:139], v[16:19], a[172:175], v[136:139]
v_mfma_f32_16x16x32_bf16 v[132:135], v[20:23], a[168:171], v[132:135]
ds_read_b128 v[16:19], v6 offset:2048
global_load_lds_dwordx4 v4, s[20:21] offset:2048 sc1
v_mfma_f32_16x16x32_bf16 v[140:143], v[20:23], a[172:175], v[140:143]
s_waitcnt lgkmcnt(4)
v_mfma_f32_16x16x32_bf16 v[128:131], v[24:27], a[176:179], v[128:131]
ds_read_b128 v[20:23], v6 offset:3072
v_mfma_f32_16x16x32_bf16 v[136:139], v[24:27], a[180:183], v[136:139]
v_mfma_f32_16x16x32_bf16 v[132:135], v[28:31], a[176:179], v[132:135]
ds_read_b128 v[24:27], v6 offset:4096
global_load_lds_dwordx4 v4, s[20:21] offset:3072 sc1
v_mfma_f32_16x16x32_bf16 v[140:143], v[28:31], a[180:183], v[140:143]
v_mfma_f32_16x16x32_bf16 v[128:131], v[32:35], a[184:187], v[128:131]
ds_read_b128 v[28:31], v6 offset:5120
v_mfma_f32_16x16x32_bf16 v[136:139], v[32:35], a[188:191], v[136:139]
s_waitcnt lgkmcnt(4)
v_mfma_f32_16x16x32_bf16 v[132:135], v[36:39], a[184:187], v[132:135]
ds_read_b128 v[32:35], v6 offset:6144
s_add_u32 m0, s43, 98304
v_mfma_f32_16x16x32_bf16 v[140:143], v[36:39], a[188:191], v[140:143]
v_add_u32 v4, 16384, v4
v_cvt_pk_bf16_f32 v56, v128, v129
v_cvt_pk_bf16_f32 v57, v130, v131
s_nop 1
v_cvt_pk_bf16_f32 v58, v132, v133
v_cvt_pk_bf16_f32 v59, v134, v135
v_cvt_pk_bf16_f32 v60, v136, v137
v_cvt_pk_bf16_f32 v61, v138, v139
v_cvt_pk_bf16_f32 v62, v140, v141
v_cvt_pk_bf16_f32 v63, v142, v143
s_add_u32 s37, s48, 16547840
global_load_lds_dwordx4 v4, s[20:21] offset:0 sc1
s_atomic_add s58, s[20:21], s53 offset:32 glc
buffer_store_dwordx4 v[56:59], v0, s[20:23], s37 offen offset:0 sc1
buffer_store_dwordx4 v[60:63], v0, s[20:23], s37 offen offset:1024 sc1
v_dot2_f32_bf16 v208, v56, v212, v208
v_dot2_f32_bf16 v209, v56, v56, v209
v_dot2_f32_bf16 v210, v60, v212, v210
v_dot2_f32_bf16 v211, v60, v60, v211
v_dot2_f32_bf16 v208, v57, v212, v208
v_dot2_f32_bf16 v209, v57, v57, v209
v_dot2_f32_bf16 v210, v61, v212, v210
v_dot2_f32_bf16 v211, v61, v61, v211
v_dot2_f32_bf16 v208, v58, v212, v208
v_dot2_f32_bf16 v209, v58, v58, v209
v_dot2_f32_bf16 v210, v62, v212, v210
v_dot2_f32_bf16 v211, v62, v62, v211
v_dot2_f32_bf16 v208, v59, v212, v208
v_dot2_f32_bf16 v209, v59, v59, v209
v_dot2_f32_bf16 v210, v63, v212, v210
v_dot2_f32_bf16 v211, v63, v63, v211
s_add_u32 s37, s53, 98304
s_nop 0
v_permlane32_swap_b32 v208, v210
v_permlane32_swap_b32 v209, v211
v_add_f32 v208, v208, v210
v_add_f32 v209, v209, v211
s_nop 1
v_permlane16_swap_b32 v208, v209
v_add_f32 v208, v208, v209
buffer_atomic_add_f32 v208, v3, s[20:23], s37 offen sc1
s_cmp_lt_u32 s58, 16
s_cbranch_scc0 L_back21
L_slow21:
s_waitcnt lgkmcnt(0)
s_cmp_ge_u32 s58, 16
s_cbranch_scc1 L_back21
s_mov_b32 s58, 0
s_atomic_add s58, s[20:21], s53 offset:32 glc
s_sub_u32 s46, s46, 1
s_cbranch_scc0 L_slow21
s_endpgm
L_back21:
v_add_u32 v5, 16519168, v14
global_load_dwordx4 a[192:195], v5, s[20:21] offset:-4096 sc1
global_load_dwordx4 a[196:199], v5, s[20:21] offset:-3072 sc1
global_load_dwordx4 a[200:203], v5, s[20:21] offset:-2048 sc1
global_load_dwordx4 a[204:207], v5, s[20:21] offset:-1024 sc1
global_load_dwordx4 a[208:211], v5, s[20:21] offset:0 sc1
global_load_dwordx4 a[212:215], v5, s[20:21] offset:1024 sc1
global_load_dwordx4 a[216:219], v5, s[20:21] offset:2048 sc1
global_load_dwordx4 a[220:223], v5, s[20:21] offset:3072 sc1
s_waitcnt vmcnt(6)
v_mfma_f32_16x16x32_bf16 v[144:147], v[40:43], a[192:195], 0
ds_read_b128 v[36:39], v6 offset:7168
v_add_u32 v5, 8192, v5
v_mfma_f32_16x16x32_bf16 v[152:155], v[40:43], a[196:199], 0
global_load_dwordx4 a[224:227], v5, s[20:21] offset:-4096 sc1
global_load_dwordx4 a[228:231], v5, s[20:21] offset:-3072 sc1
s_mov_b32 s58, 0
v_mfma_f32_16x16x32_bf16 v[148:151], v[44:47], a[192:195], 0
ds_read_b128 v[40:43], v6 offset:8192
global_load_dwordx4 a[232:235], v5, s[20:21] offset:-2048 sc1
v_mfma_f32_16x16x32_bf16 v[156:159], v[44:47], a[196:199], 0
global_load_dwordx4 a[236:239], v5, s[20:21] offset:-1024 sc1
s_atomic_add s45, s[20:21], s53 offset:36
s_waitcnt lgkmcnt(4)
v_mfma_f32_16x16x32_bf16 v[160:163], v[16:19], a[192:195], 0
ds_read_b128 v[44:47], v6 offset:9216
global_load_dwordx4 a[240:243], v5, s[20:21] offset:0 sc1
v_mfma_f32_16x16x32_bf16 v[168:171], v[16:19], a[196:199], 0
v_mfma_f32_16x16x32_bf16 v[164:167], v[20:23], a[192:195], 0
ds_read_b128 v[16:19], v6 offset:10240
v_mfma_f32_16x16x32_bf16 v[172:175], v[20:23], a[196:199], 0
v_mfma_f32_16x16x32_bf16 v[176:179], v[24:27], a[192:195], 0
ds_read_b128 v[20:23], v6 offset:11264
global_load_dwordx4 a[244:247], v5, s[20:21] offset:1024 sc1
v_mfma_f32_16x16x32_bf16 v[184:187], v[24:27], a[196:199], 0
s_waitcnt lgkmcnt(4)
v_mfma_f32_16x16x32_bf16 v[180:183], v[28:31], a[192:195], 0
ds_read_b128 v[24:27], v6 offset:12288
v_mfma_f32_16x16x32_bf16 v[188:191], v[28:31], a[196:199], 0
v_mfma_f32_16x16x32_bf16 v[192:195], v[32:35], a[192:195], 0
ds_read_b128 v[28:31], v6 offset:13312
global_load_dwordx4 a[248:251], v5, s[20:21] offset:2048 sc1
v_mfma_f32_16x16x32_bf16 v[200:203], v[32:35], a[196:199], 0
v_mfma_f32_16x16x32_bf16 v[196:199], v[36:39], a[192:195], 0
ds_read_b128 v[32:35], v6 offset:14336
v_mfma_f32_16x16x32_bf16 v[204:207], v[36:39], a[196:199], 0
s_waitcnt vmcnt(11) lgkmcnt(4)
v_mfma_f32_16x16x32_bf16 v[144:147], v[40:43], a[200:203], v[144:147]
ds_read_b128 v[36:39], v6 offset:15360
global_load_dwordx4 a[252:255], v5, s[20:21] offset:3072 sc1
v_mfma_f32_16x16x32_bf16 v[152:155], v[40:43], a[204:207], v[152:155]
v_mfma_f32_16x16x32_bf16 v[148:151], v[44:47], a[200:203], v[148:151]
s_barrier
ds_read_b128 v[40:43], v6 offset:16384
v_mfma_f32_16x16x32_bf16 v[156:159], v[44:47], a[204:207], v[156:159]
v_mfma_f32_16x16x32_bf16 v[160:163], v[16:19], a[200:203], v[160:163]
ds_read_b128 v[44:47], v6 offset:17408
v_add_u32 v5, s60, v5
v_mfma_f32_16x16x32_bf16 v[168:171], v[16:19], a[204:207], v[168:171]
global_load_dwordx4 a[0:3], v5, s[20:21] offset:-4096 sc1
s_waitcnt lgkmcnt(4)
v_mfma_f32_16x16x32_bf16 v[164:167], v[20:23], a[200:203], v[164:167]
ds_read_b128 v[16:19], v6 offset:18432
v_mfma_f32_16x16x32_bf16 v[172:175], v[20:23], a[204:207], v[172:175]
v_mfma_f32_16x16x32_bf16 v[176:179], v[24:27], a[200:203], v[176:179]
ds_read_b128 v[20:23], v6 offset:19456
v_mfma_f32_16x16x32_bf16 v[184:187], v[24:27], a[204:207], v[184:187]
v_mfma_f32_16x16x32_bf16 v[180:183], v[28:31], a[200:203], v[180:183]
ds_read_b128 v[24:27], v6 offset:20480
global_load_dwordx4 a[4:7], v5, s[20:21] offset:-3072 sc1
v_mfma_f32_16x16x32_bf16 v[188:191], v[28:31], a[204:207], v[188:191]
s_waitcnt vmcnt(12) lgkmcnt(4)
v_mfma_f32_16x16x32_bf16 v[192:195], v[32:35], a[200:203], v[192:195]
ds_read_b128 v[28:31], v6 offset:21504
v_mfma_f32_16x16x32_bf16 v[200:203], v[32:35], a[204:207], v[200:203]
v_mfma_f32_16x16x32_bf16 v[196:199], v[36:39], a[200:203], v[196:199]
ds_read_b128 v[32:35], v6 offset:22528
global_load_dwordx4 a[8:11], v5, s[20:21] offset:-2048 sc1
v_mfma_f32_16x16x32_bf16 v[204:207], v[36:39], a[204:207], v[204:207]
v_mfma_f32_16x16x32_bf16 v[144:147], v[40:43], a[208:211], v[144:147]
s_atomic_add s58, s[20:21], s53 offset:36 glc
v_mfma_f32_16x16x32_bf16 v[152:155], v[40:43], a[212:215], v[152:155]
ds_read_b128 v[36:39], v6 offset:23552
s_waitcnt lgkmcnt(5)
v_mfma_f32_16x16x32_bf16 v[148:151], v[44:47], a[208:211], v[148:151]
ds_read_b128 v[40:43], v6 offset:24576
global_load_dwordx4 a[12:15], v5, s[20:21] offset:-1024 sc1
v_mfma_f32_16x16x32_bf16 v[156:159], v[44:47], a[212:215], v[156:159]
v_mfma_f32_16x16x32_bf16 v[160:163], v[16:19], a[208:211], v[160:163]
ds_read_b128 v[44:47], v6 offset:25600
v_mfma_f32_16x16x32_bf16 v[168:171], v[16:19], a[212:215], v[168:171]
s_waitcnt lgkmcnt(5)
v_mfma_f32_16x16x32_bf16 v[164:167], v[20:23], a[208:211], v[164:167]
ds_read_b128 v[16:19], v6 offset:26624
global_load_dwordx4 a[16:19], v5, s[20:21] offset:0 sc1
v_mfma_f32_16x16x32_bf16 v[172:175], v[20:23], a[212:215], v[172:175]
v_mfma_f32_16x16x32_bf16 v[176:179], v[24:27], a[208:211], v[176:179]
ds_read_b128 v[20:23], v6 offset:27648
v_mfma_f32_16x16x32_bf16 v[184:187], v[24:27], a[212:215], v[184:187]
s_waitcnt lgkmcnt(5)
v_mfma_f32_16x16x32_bf16 v[180:183], v[28:31], a[208:211], v[180:183]
ds_read_b128 v[24:27], v6 offset:28672
v_mfma_f32_16x16x32_bf16 v[188:191], v[28:31], a[212:215], v[188:191]
v_mfma_f32_16x16x32_bf16 v[192:195], v[32:35], a[208:211], v[192:195]
ds_read_b128 v[28:31], v6 offset:29696
global_load_dwordx4 a[20:23], v5, s[20:21] offset:1024 sc1
v_mfma_f32_16x16x32_bf16 v[200:203], v[32:35], a[212:215], v[200:203]
s_waitcnt vmcnt(14) lgkmcnt(5)
v_mfma_f32_16x16x32_bf16 v[196:199], v[36:39], a[208:211], v[196:199]
ds_read_b128 v[32:35], v6 offset:30720
v_mfma_f32_16x16x32_bf16 v[204:207], v[36:39], a[212:215], v[204:207]
v_mfma_f32_16x16x32_bf16 v[144:147], v[40:43], a[216:219], v[144:147]
ds_read_b128 v[36:39], v6 offset:31744
global_load_lds_dwordx4 v4, s[20:21] offset:1024 sc1
v_mfma_f32_16x16x32_bf16 v[152:155], v[40:43], a[220:223], v[152:155]
s_waitcnt lgkmcnt(5)
v_mfma_f32_16x16x32_bf16 v[148:151], v[44:47], a[216:219], v[148:151]
s_barrier
ds_read_b128 v[40:43], v6 offset:32768
v_mfma_f32_16x16x32_bf16 v[156:159], v[44:47], a[220:223], v[156:159]
v_mfma_f32_16x16x32_bf16 v[160:163], v[16:19], a[216:219], v[160:163]
ds_read_b128 v[44:47], v6 offset:33792
global_load_lds_dwordx4 v4, s[20:21] offset:2048 sc1
v_mfma_f32_16x16x32_bf16 v[168:171], v[16:19], a[220:223], v[168:171]
s_waitcnt lgkmcnt(4)
v_mfma_f32_16x16x32_bf16 v[164:167], v[20:23], a[216:219], v[164:167]
ds_read_b128 v[16:19], v6 offset:34816
v_mfma_f32_16x16x32_bf16 v[172:175], v[20:23], a[220:223], v[172:175]
v_mfma_f32_16x16x32_bf16 v[176:179], v[24:27], a[216:219], v[176:179]
ds_read_b128 v[20:23], v6 offset:35840
global_load_lds_dwordx4 v4, s[20:21] offset:3072 sc1
v_mfma_f32_16x16x32_bf16 v[184:187], v[24:27], a[220:223], v[184:187]
v_mfma_f32_16x16x32_bf16 v[180:183], v[28:31], a[216:219], v[180:183]
ds_read_b128 v[24:27], v6 offset:36864
v_mfma_f32_16x16x32_bf16 v[188:191], v[28:31], a[220:223], v[188:191]
s_waitcnt vmcnt(15) lgkmcnt(4)
v_mfma_f32_16x16x32_bf16 v[192:195], v[32:35], a[216:219], v[192:195]
ds_read_b128 v[28:31], v6 offset:37888
v_mfma_f32_16x16x32_bf16 v[200:203], v[32:35], a[220:223], v[200:203]
v_mfma_f32_16x16x32_bf16 v[196:199], v[36:39], a[216:219], v[196:199]
ds_read_b128 v[32:35], v6 offset:38912
global_load_dwordx4 a[24:27], v5, s[20:21] offset:2048 sc1
v_mfma_f32_16x16x32_bf16 v[204:207], v[36:39], a[220:223], v[204:207]
v_mfma_f32_16x16x32_bf16 v[144:147], v[40:43], a[224:227], v[144:147]
ds_read_b128 v[36:39], v6 offset:39936
v_mfma_f32_16x16x32_bf16 v[152:155], v[40:43], a[228:231], v[152:155]
s_waitcnt lgkmcnt(4)
v_mfma_f32_16x16x32_bf16 v[148:151], v[44:47], a[224:227], v[148:151]
ds_read_b128 v[40:43], v6 offset:40960
global_load_dwordx4 a[28:31], v5, s[20:21] offset:3072 sc1
v_mfma_f32_16x16x32_bf16 v[156:159], v[44:47], a[228:231], v[156:159]
v_mfma_f32_16x16x32_bf16 v[160:163], v[16:19], a[224:227], v[160:163]
ds_read_b128 v[44:47], v6 offset:41984
v_mfma_f32_16x16x32_bf16 v[168:171], v[16:19], a[228:231], v[168:171]
v_mfma_f32_16x16x32_bf16 v[164:167], v[20:23], a[224:227], v[164:167]
ds_read_b128 v[16:19], v6 offset:43008
v_add_u32 v5, 8192, v5
v_mfma_f32_16x16x32_bf16 v[172:175], v[20:23], a[228:231], v[172:175]
global_load_dwordx4 a[32:35], v5, s[20:21] offset:-4096 sc1
s_waitcnt lgkmcnt(4)
v_mfma_f32_16x16x32_bf16 v[176:179], v[24:27], a[224:227], v[176:179]
ds_read_b128 v[20:23], v6 offset:44032
v_mfma_f32_16x16x32_bf16 v[184:187], v[24:27], a[228:231], v[184:187]
v_mfma_f32_16x16x32_bf16 v[180:183], v[28:31], a[224:227], v[180:183]
ds_read_b128 v[24:27], v6 offset:45056
global_load_dwordx4 a[36:39], v5, s[20:21] offset:-3072 sc1
v_mfma_f32_16x16x32_bf16 v[188:191], v[28:31], a[228:231], v[188:191]
v_mfma_f32_16x16x32_bf16 v[192:195], v[32:35], a[224:227], v[192:195]
s_cmp_lt_u32 s58, 16
s_cbranch_scc0 L_back22
L_slow22:
s_waitcnt lgkmcnt(0)
s_cmp_ge_u32 s58, 16
s_cbranch_scc1 L_back22
s_mov_b32 s58, 0
s_atomic_add s58, s[20:21], s53 offset:36 glc
s_sub_u32 s46, s46, 1
s_cbranch_scc0 L_slow22
s_endpgm
L_back22:
v_mfma_f32_16x16x32_bf16 v[200:203], v[32:35], a[228:231], v[200:203]
ds_read_b128 v[28:31], v6 offset:46080
s_add_u32 s37, s53, 98304
v_lshlrev_b32 v212, 2, v2
s_waitcnt vmcnt(17) lgkmcnt(3)
v_mfma_f32_16x16x32_bf16 v[196:199], v[36:39], a[224:227], v[196:199]
ds_read_b128 v[32:35], v6 offset:47104
buffer_load_dwordx4 v[208:211], v212, s[20:23], s37 offen sc1
v_mfma_f32_16x16x32_bf16 v[204:207], v[36:39], a[228:231], v[204:207]
s_add_u32 m0, s43, 114688
v_add_u32 v4, 16384, v4
v_mfma_f32_16x16x32_bf16 v[144:147], v[40:43], a[232:235], v[144:147]
ds_read_b128 v[36:39], v6 offset:48128
global_load_lds_dwordx4 v4, s[20:21] offset:0 sc1
v_mfma_f32_16x16x32_bf16 v[152:155], v[40:43], a[236:239], v[152:155]
v_mfma_f32_16x16x32_bf16 v[148:151], v[44:47], a[232:235], v[148:151]
s_barrier
ds_read_b128 v[40:43], v6 offset:49152
v_mfma_f32_16x16x32_bf16 v[156:159], v[44:47], a[236:239], v[156:159]
v_mfma_f32_16x16x32_bf16 v[160:163], v[16:19], a[232:235], v[160:163]
ds_read_b128 v[44:47], v6 offset:50176
global_load_lds_dwordx4 v4, s[20:21] offset:1024 sc1
v_mfma_f32_16x16x32_bf16 v[168:171], v[16:19], a[236:239], v[168:171]
s_waitcnt lgkmcnt(3)
v_mfma_f32_16x16x32_bf16 v[164:167], v[20:23], a[232:235], v[164:167]
ds_read_b128 v[16:19], v6 offset:51200
v_mfma_f32_16x16x32_bf16 v[172:175], v[20:23], a[236:239], v[172:175]
v_mfma_f32_16x16x32_bf16 v[176:179], v[24:27], a[232:235], v[176:179]
ds_read_b128 v[20:23], v6 offset:52224
global_load_lds_dwordx4 v4, s[20:21] offset:2048 sc1
v_mfma_f32_16x16x32_bf16 v[184:187], v[24:27], a[236:239], v[184:187]
v_mfma_f32_16x16x32_bf16 v[180:183], v[28:31], a[232:235], v[180:183]
ds_read_b128 v[24:27], v6 offset:53248
v_mfma_f32_16x16x32_bf16 v[188:191], v[28:31], a[236:239], v[188:191]
v_mfma_f32_16x16x32_bf16 v[192:195], v[32:35], a[232:235], v[192:195]
ds_read_b128 v[28:31], v6 offset:54272
v_mfma_f32_16x16x32_bf16 v[200:203], v[32:35], a[236:239], v[200:203]
s_waitcnt vmcnt(19) lgkmcnt(3)
v_mfma_f32_16x16x32_bf16 v[196:199], v[36:39], a[232:235], v[196:199]
ds_read_b128 v[32:35], v6 offset:55296
global_load_lds_dwordx4 v4, s[20:21] offset:3072 sc1
v_mfma_f32_16x16x32_bf16 v[204:207], v[36:39], a[236:239], v[204:207]
v_mfma_f32_16x16x32_bf16 v[144:147], v[40:43], a[240:243], v[144:147]
ds_read_b128 v[36:39], v6 offset:56320
v_mfma_f32_16x16x32_bf16 v[152:155], v[40:43], a[244:247], v[152:155]
v_mfma_f32_16x16x32_bf16 v[148:151], v[44:47], a[240:243], v[148:151]
ds_read_b128 v[40:43], v6 offset:57344
global_load_dwordx4 a[40:43], v5, s[20:21] offset:-2048 sc1
v_mfma_f32_16x16x32_bf16 v[156:159], v[44:47], a[244:247], v[156:159]
v_mfma_f32_16x16x32_bf16 v[160:163], v[16:19], a[240:243], v[160:163]
ds_read_b128 v[44:47], v6 offset:58368
v_mfma_f32_16x16x32_bf16 v[168:171], v[16:19], a[244:247], v[168:171]
s_waitcnt lgkmcnt(3)
v_mfma_f32_16x16x32_bf16 v[164:167], v[20:23], a[240:243], v[164:167]
ds_read_b128 v[16:19], v6 offset:59392
global_load_dwordx4 a[44:47], v5, s[20:21] offset:-1024 sc1
v_mfma_f32_16x16x32_bf16 v[172:175], v[20:23], a[244:247], v[172:175]
v_mfma_f32_16x16x32_bf16 v[176:179], v[24:27], a[240:243], v[176:179]
ds_read_b128 v[20:23], v6 offset:60416
v_mfma_f32_16x16x32_bf16 v[184:187], v[24:27], a[244:247], v[184:187]
v_mfma_f32_16x16x32_bf16 v[180:183], v[28:31], a[240:243], v[180:183]
ds_read_b128 v[24:27], v6 offset:61440
global_load_dwordx4 a[48:51], v5, s[20:21] offset:0 sc1
v_mfma_f32_16x16x32_bf16 v[188:191], v[28:31], a[244:247], v[188:191]
v_mfma_f32_16x16x32_bf16 v[192:195], v[32:35], a[240:243], v[192:195]
ds_read_b128 v[28:31], v6 offset:62464
v_mfma_f32_16x16x32_bf16 v[200:203], v[32:35], a[244:247], v[200:203]
s_waitcnt vmcnt(21) lgkmcnt(3)
v_mfma_f32_16x16x32_bf16 v[196:199], v[36:39], a[240:243], v[196:199]
ds_read_b128 v[32:35], v6 offset:63488
v_mfma_f32_16x16x32_bf16 v[204:207], v[36:39], a[244:247], v[204:207]
v_mfma_f32_16x16x32_bf16 v[144:147], v[40:43], a[248:251], v[144:147]
ds_read_b128 v[36:39], v6 offset:64512
global_load_dwordx4 a[52:55], v5, s[20:21] offset:1024 sc1
v_mfma_f32_16x16x32_bf16 v[152:155], v[40:43], a[252:255], v[152:155]
v_mfma_f32_16x16x32_bf16 v[148:151], v[44:47], a[248:251], v[148:151]
s_barrier
ds_read_b128 v[40:43], v7 offset:0
v_mfma_f32_16x16x32_bf16 v[156:159], v[44:47], a[252:255], v[156:159]
v_mfma_f32_16x16x32_bf16 v[160:163], v[16:19], a[248:251], v[160:163]
ds_read_b128 v[44:47], v7 offset:1024
s_add_u32 m0, s43, 0
v_mfma_f32_16x16x32_bf16 v[168:171], v[16:19], a[252:255], v[168:171]
v_add_u32 v4, 16384, v4
s_waitcnt lgkmcnt(3)
v_mfma_f32_16x16x32_bf16 v[164:167], v[20:23], a[248:251], v[164:167]
ds_read_b128 v[16:19], v7 offset:2048
global_load_lds_dwordx4 v4, s[20:21] offset:0 sc1
v_mfma_f32_16x16x32_bf16 v[172:175], v[20:23], a[252:255], v[172:175]
v_mfma_f32_16x16x32_bf16 v[176:179], v[24:27], a[248:251], v[176:179]
ds_read_b128 v[20:23], v7 offset:3072
global_load_lds_dwordx4 v4, s[20:21] offset:1024 sc1
v_mfma_f32_16x16x32_bf16 v[184:187], v[24:27], a[252:255], v[184:187]
v_mfma_f32_16x16x32_bf16 v[180:183], v[28:31], a[248:251], v[180:183]
ds_read_b128 v[24:27], v7 offset:4096
v_mfma_f32_16x16x32_bf16 v[188:191], v[28:31], a[252:255], v[188:191]
v_mfma_f32_16x16x32_bf16 v[192:195], v[32:35], a[248:251], v[192:195]
ds_read_b128 v[28:31], v7 offset:5120
global_load_lds_dwordx4 v4, s[20:21] offset:2048 sc1
v_mfma_f32_16x16x32_bf16 v[200:203], v[32:35], a[252:255], v[200:203]
s_waitcnt vmcnt(23) lgkmcnt(3)
v_mfma_f32_16x16x32_bf16 v[196:199], v[36:39], a[248:251], v[196:199]
ds_read_b128 v[32:35], v7 offset:6144
v_mfma_f32_16x16x32_bf16 v[204:207], v[36:39], a[252:255], v[204:207]
v_mfma_f32_16x16x32_bf16 v[144:147], v[40:43], a[0:3], v[144:147]
ds_read_b128 v[36:39], v7 offset:7168
v_mfma_f32_16x16x32_bf16 v[152:155], v[40:43], a[4:7], v[152:155]
v_mfma_f32_16x16x32_bf16 v[148:151], v[44:47], a[0:3], v[148:151]
ds_read_b128 v[40:43], v7 offset:8192
global_load_lds_dwordx4 v4, s[20:21] offset:3072 sc1
v_mfma_f32_16x16x32_bf16 v[156:159], v[44:47], a[4:7], v[156:159]
v_mfma_f32_16x16x32_bf16 v[160:163], v[16:19], a[0:3], v[160:163]
ds_read_b128 v[44:47], v7 offset:9216
v_mfma_f32_16x16x32_bf16 v[168:171], v[16:19], a[4:7], v[168:171]
s_waitcnt lgkmcnt(3)
v_mfma_f32_16x16x32_bf16 v[164:167], v[20:23], a[0:3], v[164:167]
ds_read_b128 v[16:19], v7 offset:10240
global_load_dwordx4 a[56:59], v5, s[20:21] offset:2048 sc1
v_mfma_f32_16x16x32_bf16 v[172:175], v[20:23], a[4:7], v[172:175]
v_mfma_f32_16x16x32_bf16 v[176:179], v[24:27], a[0:3], v[176:179]
ds_read_b128 v[20:23], v7 offset:11264
v_mfma_f32_16x16x32_bf16 v[184:187], v[24:27], a[4:7], v[184:187]
v_mfma_f32_16x16x32_bf16 v[180:183], v[28:31], a[0:3], v[180:183]
ds_read_b128 v[24:27], v7 offset:12288
global_load_dwordx4 a[60:63], v5, s[20:21] offset:3072 sc1
v_mfma_f32_16x16x32_bf16 v[188:191], v[28:31], a[4:7], v[188:191]
v_mfma_f32_16x16x32_bf16 v[192:195], v[32:35], a[0:3], v[192:195]
ds_read_b128 v[28:31], v7 offset:13312
v_mfma_f32_16x16x32_bf16 v[200:203], v[32:35], a[4:7], v[200:203]
s_waitcnt vmcnt(24) lgkmcnt(3)
v_mfma_f32_16x16x32_bf16 v[196:199], v[36:39], a[0:3], v[196:199]
ds_read_b128 v[32:35], v7 offset:14336
v_add_u32 v5, s61, v5
v_mfma_f32_16x16x32_bf16 v[204:207], v[36:39], a[4:7], v[204:207]
global_load_dwordx4 a[64:67], v5, s[20:21] offset:-4096 sc1
v_mfma_f32_16x16x32_bf16 v[144:147], v[40:43], a[8:11], v[144:147]
ds_read_b128 v[36:39], v7 offset:15360
v_mfma_f32_16x16x32_bf16 v[152:155], v[40:43], a[12:15], v[152:155]
v_mfma_f32_16x16x32_bf16 v[148:151], v[44:47], a[8:11], v[148:151]
s_barrier
ds_read_b128 v[40:43], v7 offset:16384
v_mfma_f32_16x16x32_bf16 v[156:159], v[44:47], a[12:15], v[156:159]
v_mfma_f32_16x16x32_bf16 v[160:163], v[16:19], a[8:11], v[160:163]
ds_read_b128 v[44:47], v7 offset:17408
global_load_dwordx4 a[68:71], v5, s[20:21] offset:-3072 sc1
v_mfma_f32_16x16x32_bf16 v[168:171], v[16:19], a[12:15], v[168:171]
s_waitcnt vmcnt(16)
v_mul_f32 v208, 0xba800000, v208
v_mul_f32 v209, 0x3a800000, v209
v_mul_f32 v210, 0xba800000, v210
v_mul_f32 v211, 0x3a800000, v211
s_waitcnt lgkmcnt(3)
v_mfma_f32_16x16x32_bf16 v[164:167], v[20:23], a[8:11], v[164:167]
ds_read_b128 v[16:19], v7 offset:18432
v_fma_f32 v209, -v208, v208, v209
v_mfma_f32_16x16x32_bf16 v[172:175], v[20:23], a[12:15], v[172:175]
v_fma_f32 v211, -v210, v210, v211
v_max_f32 v209, 0, v209
v_mfma_f32_16x16x32_bf16 v[176:179], v[24:27], a[8:11], v[176:179]
ds_read_b128 v[20:23], v7 offset:19456
s_add_u32 m0, s43, 16384
v_mfma_f32_16x16x32_bf16 v[184:187], v[24:27], a[12:15], v[184:187]
v_add_u32 v4, 16384, v4
v_max_f32 v211, 0, v211
v_mfma_f32_16x16x32_bf16 v[180:183], v[28:31], a[8:11], v[180:183]
ds_read_b128 v[24:27], v7 offset:20480
global_load_lds_dwordx4 v4, s[20:21] offset:0 sc1
v_mfma_f32_16x16x32_bf16 v[188:191], v[28:31], a[12:15], v[188:191]
v_add_f32 v209, 0x3727c5ac, v209
v_add_f32 v211, 0x3727c5ac, v211
v_mfma_f32_16x16x32_bf16 v[192:195], v[32:35], a[8:11], v[192:195]
ds_read_b128 v[28:31], v7 offset:21504
global_load_lds_dwordx4 v4, s[20:21] offset:1024 sc1
v_mfma_f32_16x16x32_bf16 v[200:203], v[32:35], a[12:15], v[200:203]
v_rsq_f32 v212, v209
s_waitcnt lgkmcnt(3)
v_mfma_f32_16x16x32_bf16 v[196:199], v[36:39], a[8:11], v[196:199]
ds_read_b128 v[32:35], v7 offset:22528
v_mul_f32 v209, v209, v212
v_mfma_f32_16x16x32_bf16 v[204:207], v[36:39], a[12:15], v[204:207]
v_rsq_f32 v213, v211
v_mfma_f32_16x16x32_bf16 v[144:147], v[40:43], a[16:19], v[144:147]
ds_read_b128 v[36:39], v7 offset:23552
global_load_lds_dwordx4 v4, s[20:21] offset:2048 sc1
v_mfma_f32_16x16x32_bf16 v[152:155], v[40:43], a[20:23], v[152:155]
v_mul_f32 v211, v211, v213
v_cvt_pk_bf16_f32 v214, v208, v208
v_mfma_f32_16x16x32_bf16 v[148:151], v[44:47], a[16:19], v[148:151]
ds_read_b128 v[40:43], v7 offset:24576
v_cvt_pk_bf16_f32 v215, v209, v209
v_mfma_f32_16x16x32_bf16 v[156:159], v[44:47], a[20:23], v[156:159]
v_lshlrev_b32 v216, 16, v214
v_lshlrev_b32 v217, 16, v215
v_mfma_f32_16x16x32_bf16 v[160:163], v[16:19], a[16:19], v[160:163]
ds_read_b128 v[44:47], v7 offset:25600
global_load_lds_dwordx4 v4, s[20:21] offset:3072 sc1
v_mfma_f32_16x16x32_bf16 v[168:171], v[16:19], a[20:23], v[168:171]
v_sub_f32 v216, v208, v216
s_waitcnt lgkmcnt(3)
v_mfma_f32_16x16x32_bf16 v[164:167], v[20:23], a[16:19], v[164:167]
ds_read_b128 v[16:19], v7 offset:26624
v_sub_f32 v217, v209, v217
v_mfma_f32_16x16x32_bf16 v[172:175], v[20:23], a[20:23], v[172:175]
v_cvt_pk_bf16_f32 v216, v216, v209
v_cvt_pk_bf16_f32 v217, v217, 0
v_mfma_f32_16x16x32_bf16 v[176:179], v[24:27], a[16:19], v[176:179]
ds_read_b128 v[20:23], v7 offset:27648
global_load_dwordx4 a[72:75], v5, s[20:21] offset:-2048 sc1
v_mfma_f32_16x16x32_bf16 v[184:187], v[24:27], a[20:23], v[184:187]
v_cndmask_b32 v64, 0, v214, s[98:99]
v_cndmask_b32 v65, 0, v216, s[98:99]
v_mfma_f32_16x16x32_bf16 v[180:183], v[28:31], a[16:19], v[180:183]
ds_read_b128 v[24:27], v7 offset:28672
v_cndmask_b32 v66, 0, v217, s[98:99]
v_mfma_f32_16x16x32_bf16 v[188:191], v[28:31], a[20:23], v[188:191]
v_cvt_pk_bf16_f32 v214, v210, v210
v_cvt_pk_bf16_f32 v215, v211, v211
v_mfma_f32_16x16x32_bf16 v[192:195], v[32:35], a[16:19], v[192:195]
ds_read_b128 v[28:31], v7 offset:29696
global_load_dwordx4 a[76:79], v5, s[20:21] offset:-1024 sc1
v_mfma_f32_16x16x32_bf16 v[200:203], v[32:35], a[20:23], v[200:203]
v_lshlrev_b32 v216, 16, v214
s_waitcnt lgkmcnt(3)
v_mfma_f32_16x16x32_bf16 v[196:199], v[36:39], a[16:19], v[196:199]
ds_read_b128 v[32:35], v7 offset:30720
v_lshlrev_b32 v217, 16, v215
v_mfma_f32_16x16x32_bf16 v[204:207], v[36:39], a[20:23], v[204:207]
v_sub_f32 v216, v210, v216
v_sub_f32 v217, v211, v217
v_mfma_f32_16x16x32_bf16 v[144:147], v[40:43], a[24:27], v[144:147]
ds_read_b128 v[36:39], v7 offset:31744
v_cvt_pk_bf16_f32 v216, v216, v211
v_mfma_f32_16x16x32_bf16 v[152:155], v[40:43], a[28:31], v[152:155]
v_cvt_pk_bf16_f32 v217, v217, 0
v_cndmask_b32 v68, 0, v214, s[98:99]
v_mfma_f32_16x16x32_bf16 v[148:151], v[44:47], a[24:27], v[148:151]
s_barrier
ds_read_b128 v[40:43], v7 offset:32768
v_mfma_f32_16x16x32_bf16 v[156:159], v[44:47], a[28:31], v[156:159]
global_load_dwordx4 a[80:83], v5, s[20:21] offset:0 sc1
v_cndmask_b32 v69, 0, v216, s[98:99]
v_mfma_f32_16x16x32_bf16 v[160:163], v[16:19], a[24:27], v[160:163]
ds_read_b128 v[44:47], v7 offset:33792
v_cndmask_b32 v70, 0, v217, s[98:99]
v_mfma_f32_16x16x32_bf16 v[168:171], v[16:19], a[28:31], v[168:171]
v_mul_f32 v72, 0xc0135761, v212
s_waitcnt lgkmcnt(3)
v_mfma_f32_16x16x32_bf16 v[164:167], v[20:23], a[24:27], v[164:167]
ds_read_b128 v[16:19], v7 offset:34816
global_load_dwordx4 a[84:87], v5, s[20:21] offset:1024 sc1
v_mfma_f32_16x16x32_bf16 v[172:175], v[20:23], a[28:31], v[172:175]
v_mul_f32 v214, v212, v212
v_mov_b32 v74, v209
v_mfma_f32_16x16x32_bf16 v[176:179], v[24:27], a[24:27], v[176:179]
ds_read_b128 v[20:23], v7 offset:35840
v_mul_f32 v214, 0x3d372713, v214
v_mfma_f32_16x16x32_bf16 v[184:187], v[24:27], a[28:31], v[184:187]
v_mul_f32 v73, v214, v72
v_mul_f32 v75, 0xc0135761, v213
v_mfma_f32_16x16x32_bf16 v[180:183], v[28:31], a[24:27], v[180:183]
ds_read_b128 v[24:27], v7 offset:36864
s_add_u32 m0, s43, 32768
v_mfma_f32_16x16x32_bf16 v[188:191], v[28:31], a[28:31], v[188:191]
v_add_u32 v4, 16384, v4
v_mul_f32 v214, v213, v213
v_mfma_f32_16x16x32_bf16 v[192:195], v[32:35], a[24:27], v[192:195]
ds_read_b128 v[28:31], v7 offset:37888
global_load_lds_dwordx4 v4, s[20:21] offset:0 sc1
v_mfma_f32_16x16x32_bf16 v[200:203], v[32:35], a[28:31], v[200:203]
v_mov_b32 v77, v211
s_waitcnt lgkmcnt(3)
v_mfma_f32_16x16x32_bf16 v[196:199], v[36:39], a[24:27], v[196:199]
ds_read_b128 v[32:35], v7 offset:38912
global_load_lds_dwordx4 v4, s[20:21] offset:1024 sc1
v_mfma_f32_16x16x32_bf16 v[204:207], v[36:39], a[28:31], v[204:207]
v_mul_f32 v214, 0x3d372713, v214
v_mul_f32 v76, v214, v75
v_mfma_f32_16x16x32_bf16 v[144:147], v[40:43], a[32:35], v[144:147]
ds_read_b128 v[36:39], v7 offset:39936
v_and_b32 v208, 48, v11
v_mfma_f32_16x16x32_bf16 v[152:155], v[40:43], a[36:39], v[152:155]
v_add_u32 v208, 155648, v208
v_mfma_f32_16x16x32_bf16 v[148:151], v[44:47], a[32:35], v[148:151]
ds_read_b128 v[40:43], v7 offset:40960
global_load_lds_dwordx4 v4, s[20:21] offset:2048 sc1
v_mfma_f32_16x16x32_bf16 v[156:159], v[44:47], a[36:39], v[156:159]
ds_read_b128 v[224:227], v208 offset:0
ds_read_b128 v[228:231], v208 offset:64
v_mfma_f32_16x16x32_bf16 v[160:163], v[16:19], a[32:35], v[160:163]
ds_read_b128 v[44:47], v7 offset:41984
ds_read_b128 v[232:235], v208 offset:128
v_mfma_f32_16x16x32_bf16 v[168:171], v[16:19], a[36:39], v[168:171]
ds_read_b128 v[236:239], v208 offset:192
s_waitcnt lgkmcnt(7)
v_mfma_f32_16x16x32_bf16 v[164:167], v[20:23], a[32:35], v[164:167]
ds_read_b128 v[16:19], v7 offset:43008
v_mfma_f32_16x16x32_bf16 v[172:175], v[20:23], a[36:39], v[172:175]
v_mfma_f32_16x16x32_bf16 v[176:179], v[24:27], a[32:35], v[176:179]
ds_read_b128 v[20:23], v7 offset:44032
global_load_lds_dwordx4 v4, s[20:21] offset:3072 sc1
v_mfma_f32_16x16x32_bf16 v[184:187], v[24:27], a[36:39], v[184:187]
v_mfma_f32_16x16x32_bf16 v[180:183], v[28:31], a[32:35], v[180:183]
ds_read_b128 v[24:27], v7 offset:45056
v_mfma_f32_16x16x32_bf16 v[188:191], v[28:31], a[36:39], v[188:191]
v_mfma_f32_16x16x32_bf16 v[192:195], v[32:35], a[32:35], v[192:195]
ds_read_b128 v[28:31], v7 offset:46080
global_load_dwordx4 a[88:91], v5, s[20:21] offset:2048 sc1
v_mfma_f32_16x16x32_bf16 v[200:203], v[32:35], a[36:39], v[200:203]
v_lshlrev_b32 v128, 16, v48
v_and_b32 v129, 0xffff0000, v48
s_waitcnt lgkmcnt(8)
v_add_f32 v128, v128, v224
v_add_f32 v129, v129, v225
v_mfma_f32_16x16x32_bf16 v[196:199], v[36:39], a[32:35], v[196:199]
ds_read_b128 v[32:35], v7 offset:47104
v_lshlrev_b32 v130, 16, v49
v_mfma_f32_16x16x32_bf16 v[204:207], v[36:39], a[36:39], v[204:207]
v_and_b32 v131, 0xffff0000, v49
v_add_f32 v130, v130, v226
s_waitcnt vmcnt(23)
v_mfma_f32_16x16x32_bf16 v[144:147], v[40:43], a[40:43], v[144:147]
ds_read_b128 v[36:39], v7 offset:48128
global_load_dwordx4 a[92:95], v5, s[20:21] offset:3072 sc1
v_mfma_f32_16x16x32_bf16 v[152:155], v[40:43], a[44:47], v[152:155]
v_add_f32 v131, v131, v227
s_waitcnt lgkmcnt(3)
v_mfma_f32_16x16x32_bf16 v[148:151], v[44:47], a[40:43], v[148:151]
s_barrier
ds_read_b128 v[40:43], v7 offset:49152
v_mfma_f32_16x16x32_bf16 v[156:159], v[44:47], a[44:47], v[156:159]
v_lshlrev_b32 v132, 16, v50
v_and_b32 v133, 0xffff0000, v50
v_mfma_f32_16x16x32_bf16 v[160:163], v[16:19], a[40:43], v[160:163]
ds_read_b128 v[44:47], v7 offset:50176
v_add_u32 v5, 8192, v5
v_mfma_f32_16x16x32_bf16 v[168:171], v[16:19], a[44:47], v[168:171]
global_load_dwordx4 a[96:99], v5, s[20:21] offset:-4096 sc1
v_add_f32 v132, v132, v228
v_add_f32 v133, v133, v229
v_mfma_f32_16x16x32_bf16 v[164:167], v[20:23], a[40:43], v[164:167]
ds_read_b128 v[16:19], v7 offset:51200
v_lshlrev_b32 v134, 16, v51
v_mfma_f32_16x16x32_bf16 v[172:175], v[20:23], a[44:47], v[172:175]
v_and_b32 v135, 0xffff0000, v51
v_add_f32 v134, v134, v230
v_mfma_f32_16x16x32_bf16 v[176:179], v[24:27], a[40:43], v[176:179]
ds_read_b128 v[20:23], v7 offset:52224
global_load_dwordx4 a[100:103], v5, s[20:21] offset:-3072 sc1
v_mfma_f32_16x16x32_bf16 v[184:187], v[24:27], a[44:47], v[184:187]
v_add_f32 v135, v135, v231
s_waitcnt vmcnt(24) lgkmcnt(3)
v_mfma_f32_16x16x32_bf16 v[180:183], v[28:31], a[40:43], v[180:183]
ds_read_b128 v[24:27], v7 offset:53248
v_lshlrev_b32 v136, 16, v52
v_mfma_f32_16x16x32_bf16 v[188:191], v[28:31], a[44:47], v[188:191]
v_and_b32 v137, 0xffff0000, v52
v_add_f32 v136, v136, v224
v_mfma_f32_16x16x32_bf16 v[192:195], v[32:35], a[40:43], v[192:195]
ds_read_b128 v[28:31], v7 offset:54272
s_add_u32 m0, s43, 49152
v_mfma_f32_16x16x32_bf16 v[200:203], v[32:35], a[44:47], v[200:203]
v_add_u32 v4, 16384, v4
v_add_f32 v137, v137, v225
v_mfma_f32_16x16x32_bf16 v[196:199], v[36:39], a[40:43], v[196:199]
ds_read_b128 v[32:35], v7 offset:55296
global_load_lds_dwordx4 v4, s[20:21] offset:0 sc1
v_mfma_f32_16x16x32_bf16 v[204:207], v[36:39], a[44:47], v[204:207]
v_lshlrev_b32 v138, 16, v53
v_and_b32 v139, 0xffff0000, v53
v_mfma_f32_16x16x32_bf16 v[144:147], v[40:43], a[48:51], v[144:147]
ds_read_b128 v[36:39], v7 offset:56320
global_load_lds_dwordx4 v4, s[20:21] offset:1024 sc1
v_mfma_f32_16x16x32_bf16 v[152:155], v[40:43], a[52:55], v[152:155]
v_add_f32 v138, v138, v226
v_add_f32 v139, v139, v227
s_waitcnt lgkmcnt(3)
v_mfma_f32_16x16x32_bf16 v[148:151], v[44:47], a[48:51], v[148:151]
ds_read_b128 v[40:43], v7 offset:57344
v_lshlrev_b32 v140, 16, v54
v_mfma_f32_16x16x32_bf16 v[156:159], v[44:47], a[52:55], v[156:159]
v_and_b32 v141, 0xffff0000, v54
v_add_f32 v140, v140, v228
v_mfma_f32_16x16x32_bf16 v[160:163], v[16:19], a[48:51], v[160:163]
ds_read_b128 v[44:47], v7 offset:58368
global_load_lds_dwordx4 v4, s[20:21] offset:2048 sc1
v_mfma_f32_16x16x32_bf16 v[168:171], v[16:19], a[52:55], v[168:171]
v_add_f32 v141, v141, v229
v_lshlrev_b32 v142, 16, v55
v_mfma_f32_16x16x32_bf16 v[164:167], v[20:23], a[48:51], v[164:167]
ds_read_b128 v[16:19], v7 offset:59392
v_and_b32 v143, 0xffff0000, v55
v_mfma_f32_16x16x32_bf16 v[172:175], v[20:23], a[52:55], v[172:175]
v_add_f32 v142, v142, v230
v_add_f32 v143, v143, v231
v_mfma_f32_16x16x32_bf16 v[176:179], v[24:27], a[48:51], v[176:179]
ds_read_b128 v[20:23], v7 offset:60416
v_mfma_f32_16x16x32_bf16 v[184:187], v[24:27], a[52:55], v[184:187]
s_waitcnt vmcnt(21) lgkmcnt(3)
v_mfma_f32_16x16x32_bf16 v[180:183], v[28:31], a[48:51], v[180:183]
ds_read_b128 v[24:27], v7 offset:61440
global_load_lds_dwordx4 v4, s[20:21] offset:3072 sc1
v_mfma_f32_16x16x32_bf16 v[188:191], v[28:31], a[52:55], v[188:191]
v_mfma_f32_16x16x32_bf16 v[192:195], v[32:35], a[48:51], v[192:195]
ds_read_b128 v[28:31], v7 offset:62464
v_mfma_f32_16x16x32_bf16 v[200:203], v[32:35], a[52:55], v[200:203]
v_mfma_f32_16x16x32_bf16 v[196:199], v[36:39], a[48:51], v[196:199]
ds_read_b128 v[32:35], v7 offset:63488
global_load_dwordx4 a[104:107], v5, s[20:21] offset:-2048 sc1
v_mfma_f32_16x16x32_bf16 v[204:207], v[36:39], a[52:55], v[204:207]
v_mfma_f32_16x16x32_bf16 v[144:147], v[40:43], a[56:59], v[144:147]
ds_read_b128 v[36:39], v7 offset:64512
v_mfma_f32_16x16x32_bf16 v[152:155], v[40:43], a[60:63], v[152:155]
s_waitcnt lgkmcnt(3)
v_mfma_f32_16x16x32_bf16 v[148:151], v[44:47], a[56:59], v[148:151]
s_barrier
ds_read_b128 v[40:43], v6 offset:0
v_mfma_f32_16x16x32_bf16 v[156:159], v[44:47], a[60:63], v[156:159]
global_load_dwordx4 a[108:111], v5, s[20:21] offset:-1024 sc1
v_mfma_f32_16x16x32_bf16 v[160:163], v[16:19], a[56:59], v[160:163]
ds_read_b128 v[44:47], v6 offset:1024
v_mfma_f32_16x16x32_bf16 v[168:171], v[16:19], a[60:63], v[168:171]
v_mfma_f32_16x16x32_bf16 v[164:167], v[20:23], a[56:59], v[164:167]
ds_read_b128 v[16:19], v6 offset:2048
global_load_dwordx4 a[112:115], v5, s[20:21] offset:0 sc1
v_mfma_f32_16x16x32_bf16 v[172:175], v[20:23], a[60:63], v[172:175]
v_mfma_f32_16x16x32_bf16 v[176:179], v[24:27], a[56:59], v[176:179]
ds_read_b128 v[20:23], v6 offset:3072
v_mfma_f32_16x16x32_bf16 v[184:187], v[24:27], a[60:63], v[184:187]
s_waitcnt vmcnt(23) lgkmcnt(3)
v_mfma_f32_16x16x32_bf16 v[180:183], v[28:31], a[56:59], v[180:183]
ds_read_b128 v[24:27], v6 offset:4096
v_mfma_f32_16x16x32_bf16 v[188:191], v[28:31], a[60:63], v[188:191]
v_mfma_f32_16x16x32_bf16 v[192:195], v[32:35], a[56:59], v[192:195]
ds_read_b128 v[28:31], v6 offset:5120
global_load_dwordx4 a[116:119], v5, s[20:21] offset:1024 sc1
v_mfma_f32_16x16x32_bf16 v[200:203], v[32:35], a[60:63], v[200:203]
v_mfma_f32_16x16x32_bf16 v[196:199], v[36:39], a[56:59], v[196:199]
ds_read_b128 v[32:35], v6 offset:6144
v_mfma_f32_16x16x32_bf16 v[204:207], v[36:39], a[60:63], v[204:207]
v_mfma_f32_16x16x32_bf16 v[144:147], v[40:43], a[64:67], v[144:147]
ds_read_b128 v[36:39], v6 offset:7168
s_add_u32 m0, s43, 65536
v_mfma_f32_16x16x32_bf16 v[152:155], v[40:43], a[68:71], v[152:155]
v_add_u32 v4, 16384, v4
s_waitcnt lgkmcnt(3)
v_mfma_f32_16x16x32_bf16 v[148:151], v[44:47], a[64:67], v[148:151]
ds_read_b128 v[40:43], v6 offset:8192
global_load_lds_dwordx4 v4, s[20:21] offset:0 sc1
v_mfma_f32_16x16x32_bf16 v[156:159], v[44:47], a[68:71], v[156:159]
v_mfma_f32_16x16x32_bf16 v[160:163], v[16:19], a[64:67], v[160:163]
ds_read_b128 v[44:47], v6 offset:9216
global_load_lds_dwordx4 v4, s[20:21] offset:1024 sc1
v_mfma_f32_16x16x32_bf16 v[168:171], v[16:19], a[68:71], v[168:171]
v_mfma_f32_16x16x32_bf16 v[164:167], v[20:23], a[64:67], v[164:167]
ds_read_b128 v[16:19], v6 offset:10240
v_mfma_f32_16x16x32_bf16 v[172:175], v[20:23], a[68:71], v[172:175]
v_mfma_f32_16x16x32_bf16 v[176:179], v[24:27], a[64:67], v[176:179]
ds_read_b128 v[20:23], v6 offset:11264
global_load_lds_dwordx4 v4, s[20:21] offset:2048 sc1
v_mfma_f32_16x16x32_bf16 v[184:187], v[24:27], a[68:71], v[184:187]
s_waitcnt vmcnt(21) lgkmcnt(3)
v_mfma_f32_16x16x32_bf16 v[180:183], v[28:31], a[64:67], v[180:183]
ds_read_b128 v[24:27], v6 offset:12288
v_mfma_f32_16x16x32_bf16 v[188:191], v[28:31], a[68:71], v[188:191]
v_mfma_f32_16x16x32_bf16 v[192:195], v[32:35], a[64:67], v[192:195]
ds_read_b128 v[28:31], v6 offset:13312
v_mfma_f32_16x16x32_bf16 v[200:203], v[32:35], a[68:71], v[200:203]
v_mfma_f32_16x16x32_bf16 v[196:199], v[36:39], a[64:67], v[196:199]
ds_read_b128 v[32:35], v6 offset:14336
global_load_lds_dwordx4 v4, s[20:21] offset:3072 sc1
v_mfma_f32_16x16x32_bf16 v[204:207], v[36:39], a[68:71], v[204:207]
v_mfma_f32_16x16x32_bf16 v[144:147], v[40:43], a[72:75], v[144:147]
ds_read_b128 v[36:39], v6 offset:15360
v_mfma_f32_16x16x32_bf16 v[152:155], v[40:43], a[76:79], v[152:155]
s_waitcnt lgkmcnt(3)
v_mfma_f32_16x16x32_bf16 v[148:151], v[44:47], a[72:75], v[148:151]
s_barrier
ds_read_b128 v[40:43], v6 offset:16384
v_mfma_f32_16x16x32_bf16 v[156:159], v[44:47], a[76:79], v[156:159]
global_load_dwordx4 a[120:123], v5, s[20:21] offset:2048 sc1
v_mfma_f32_16x16x32_bf16 v[160:163], v[16:19], a[72:75], v[160:163]
ds_read_b128 v[44:47], v6 offset:17408
v_mfma_f32_16x16x32_bf16 v[168:171], v[16:19], a[76:79], v[168:171]
v_mfma_f32_16x16x32_bf16 v[164:167], v[20:23], a[72:75], v[164:167]
ds_read_b128 v[16:19], v6 offset:18432
global_load_dwordx4 a[124:127], v5, s[20:21] offset:3072 sc1
v_mfma_f32_16x16x32_bf16 v[172:175], v[20:23], a[76:79], v[172:175]
v_mfma_f32_16x16x32_bf16 v[176:179], v[24:27], a[72:75], v[176:179]
ds_read_b128 v[20:23], v6 offset:19456
v_mfma_f32_16x16x32_bf16 v[184:187], v[24:27], a[76:79], v[184:187]
s_waitcnt vmcnt(22) lgkmcnt(3)
v_mfma_f32_16x16x32_bf16 v[180:183], v[28:31], a[72:75], v[180:183]
ds_read_b128 v[24:27], v6 offset:20480
v_add_u32 v5, s60, v5
v_mfma_f32_16x16x32_bf16 v[188:191], v[28:31], a[76:79], v[188:191]
global_load_dwordx4 a[128:131], v5, s[20:21] offset:-4096 sc1
v_mfma_f32_16x16x32_bf16 v[192:195], v[32:35], a[72:75], v[192:195]
ds_read_b128 v[28:31], v6 offset:21504
v_mfma_f32_16x16x32_bf16 v[200:203], v[32:35], a[76:79], v[200:203]
v_mfma_f32_16x16x32_bf16 v[196:199], v[36:39], a[72:75], v[196:199]
ds_read_b128 v[32:35], v6 offset:22528
v_mfma_f32_16x16x32_bf16 v[204:207], v[36:39], a[76:79], v[204:207]
v_mfma_f32_16x16x32_bf16 v[144:147], v[40:43], a[80:83], v[144:147]
ds_read_b128 v[36:39], v6 offset:23552
global_load_dwordx4 a[132:135], v5, s[20:21] offset:-3072 sc1
v_mfma_f32_16x16x32_bf16 v[152:155], v[40:43], a[84:87], v[152:155]
s_waitcnt lgkmcnt(3)
v_mfma_f32_16x16x32_bf16 v[148:151], v[44:47], a[80:83], v[148:151]
ds_read_b128 v[40:43], v6 offset:24576
v_mfma_f32_16x16x32_bf16 v[156:159], v[44:47], a[84:87], v[156:159]
v_mfma_f32_16x16x32_bf16 v[160:163], v[16:19], a[80:83], v[160:163]
ds_read_b128 v[44:47], v6 offset:25600
s_add_u32 m0, s43, 81920
v_mfma_f32_16x16x32_bf16 v[168:171], v[16:19], a[84:87], v[168:171]
v_add_u32 v4, 16384, v4
v_mfma_f32_16x16x32_bf16 v[164:167], v[20:23], a[80:83], v[164:167]
ds_read_b128 v[16:19], v6 offset:26624
global_load_lds_dwordx4 v4, s[20:21] offset:0 sc1
v_mfma_f32_16x16x32_bf16 v[172:175], v[20:23], a[84:87], v[172:175]
v_mfma_f32_16x16x32_bf16 v[176:179], v[24:27], a[80:83], v[176:179]
ds_read_b128 v[20:23], v6 offset:27648
global_load_lds_dwordx4 v4, s[20:21] offset:1024 sc1
v_mfma_f32_16x16x32_bf16 v[184:187], v[24:27], a[84:87], v[184:187]
s_waitcnt vmcnt(20) lgkmcnt(3)
v_mfma_f32_16x16x32_bf16 v[180:183], v[28:31], a[80:83], v[180:183]
ds_read_b128 v[24:27], v6 offset:28672
v_mfma_f32_16x16x32_bf16 v[188:191], v[28:31], a[84:87], v[188:191]
v_mfma_f32_16x16x32_bf16 v[192:195], v[32:35], a[80:83], v[192:195]
ds_read_b128 v[28:31], v6 offset:29696
global_load_lds_dwordx4 v4, s[20:21] offset:2048 sc1
v_mfma_f32_16x16x32_bf16 v[200:203], v[32:35], a[84:87], v[200:203]
v_mfma_f32_16x16x32_bf16 v[196:199], v[36:39], a[80:83], v[196:199]
ds_read_b128 v[32:35], v6 offset:30720
v_mfma_f32_16x16x32_bf16 v[204:207], v[36:39], a[84:87], v[204:207]
v_mfma_f32_16x16x32_bf16 v[144:147], v[40:43], a[88:91], v[144:147]
ds_read_b128 v[36:39], v6 offset:31744
v_mfma_f32_16x16x32_bf16 v[152:155], v[40:43], a[92:95], v[152:155]
s_waitcnt lgkmcnt(3)
v_mfma_f32_16x16x32_bf16 v[148:151], v[44:47], a[88:91], v[148:151]
s_barrier
ds_read_b128 v[40:43], v6 offset:32768
v_mfma_f32_16x16x32_bf16 v[156:159], v[44:47], a[92:95], v[156:159]
global_load_lds_dwordx4 v4, s[20:21] offset:3072 sc1
v_mfma_f32_16x16x32_bf16 v[160:163], v[16:19], a[88:91], v[160:163]
ds_read_b128 v[44:47], v6 offset:33792
s_getpc_b64 s[4:5]
v_mfma_f32_16x16x32_bf16 v[168:171], v[16:19], a[92:95], v[168:171]
global_load_dword v13, v12, s[4:5]
v_mfma_f32_16x16x32_bf16 v[164:167], v[20:23], a[88:91], v[164:167]
ds_read_b128 v[16:19], v6 offset:34816
global_load_dwordx4 a[136:139], v5, s[20:21] offset:-2048 sc1
v_mfma_f32_16x16x32_bf16 v[172:175], v[20:23], a[92:95], v[172:175]
v_mfma_f32_16x16x32_bf16 v[176:179], v[24:27], a[88:91], v[176:179]
ds_read_b128 v[20:23], v6 offset:35840
v_mfma_f32_16x16x32_bf16 v[184:187], v[24:27], a[92:95], v[184:187]
s_waitcnt vmcnt(22) lgkmcnt(3)
v_mfma_f32_16x16x32_bf16 v[180:183], v[28:31], a[88:91], v[180:183]
ds_read_b128 v[24:27], v6 offset:36864
global_load_dwordx4 a[140:143], v5, s[20:21] offset:-1024 sc1
v_mfma_f32_16x16x32_bf16 v[188:191], v[28:31], a[92:95], v[188:191]
v_mfma_f32_16x16x32_bf16 v[192:195], v[32:35], a[88:91], v[192:195]
ds_read_b128 v[28:31], v6 offset:37888
v_mfma_f32_16x16x32_bf16 v[200:203], v[32:35], a[92:95], v[200:203]
v_mfma_f32_16x16x32_bf16 v[196:199], v[36:39], a[88:91], v[196:199]
ds_read_b128 v[32:35], v6 offset:38912
v_mfma_f32_16x16x32_bf16 v[204:207], v[36:39], a[92:95], v[204:207]
v_mfma_f32_16x16x32_bf16 v[144:147], v[40:43], a[96:99], v[144:147]
ds_read_b128 v[36:39], v6 offset:39936
global_load_dwordx4 a[144:147], v5, s[20:21] offset:0 sc1
v_mfma_f32_16x16x32_bf16 v[152:155], v[40:43], a[100:103], v[152:155]
s_waitcnt lgkmcnt(3)
v_mfma_f32_16x16x32_bf16 v[148:151], v[44:47], a[96:99], v[148:151]
ds_read_b128 v[40:43], v6 offset:40960
v_mfma_f32_16x16x32_bf16 v[156:159], v[44:47], a[100:103], v[156:159]
v_mfma_f32_16x16x32_bf16 v[160:163], v[16:19], a[96:99], v[160:163]
ds_read_b128 v[44:47], v6 offset:41984
global_load_dwordx4 a[148:151], v5, s[20:21] offset:1024 sc1
v_mfma_f32_16x16x32_bf16 v[168:171], v[16:19], a[100:103], v[168:171]
v_mfma_f32_16x16x32_bf16 v[164:167], v[20:23], a[96:99], v[164:167]
ds_read_b128 v[16:19], v6 offset:43008
v_mfma_f32_16x16x32_bf16 v[172:175], v[20:23], a[100:103], v[172:175]
v_mfma_f32_16x16x32_bf16 v[176:179], v[24:27], a[96:99], v[176:179]
ds_read_b128 v[20:23], v6 offset:44032
global_load_dwordx4 a[152:155], v5, s[20:21] offset:2048 sc1
v_mfma_f32_16x16x32_bf16 v[184:187], v[24:27], a[100:103], v[184:187]
s_waitcnt vmcnt(20) lgkmcnt(3)
v_mfma_f32_16x16x32_bf16 v[180:183], v[28:31], a[96:99], v[180:183]
ds_read_b128 v[24:27], v6 offset:45056
v_mfma_f32_16x16x32_bf16 v[188:191], v[28:31], a[100:103], v[188:191]
v_mfma_f32_16x16x32_bf16 v[192:195], v[32:35], a[96:99], v[192:195]
ds_read_b128 v[28:31], v6 offset:46080
global_load_dwordx4 a[156:159], v5, s[20:21] offset:3072 sc1
v_mfma_f32_16x16x32_bf16 v[200:203], v[32:35], a[100:103], v[200:203]
v_mfma_f32_16x16x32_bf16 v[196:199], v[36:39], a[96:99], v[196:199]
ds_read_b128 v[32:35], v6 offset:47104
v_mfma_f32_16x16x32_bf16 v[204:207], v[36:39], a[100:103], v[204:207]
v_mfma_f32_16x16x32_bf16 v[144:147], v[40:43], a[104:107], v[144:147]
ds_read_b128 v[36:39], v6 offset:48128
v_mfma_f32_16x16x32_bf16 v[152:155], v[40:43], a[108:111], v[152:155]
s_waitcnt lgkmcnt(3)
v_mfma_f32_16x16x32_bf16 v[148:151], v[44:47], a[104:107], v[148:151]
s_barrier
ds_read_b128 v[40:43], v6 offset:49152
v_mfma_f32_16x16x32_bf16 v[156:159], v[44:47], a[108:111], v[156:159]
s_add_u32 m0, s43, 98304
v_add_u32 v4, 16384, v4
v_mfma_f32_16x16x32_bf16 v[160:163], v[16:19], a[104:107], v[160:163]
ds_read_b128 v[44:47], v6 offset:50176
global_load_lds_dwordx4 v4, s[20:21] offset:0 sc1
v_mfma_f32_16x16x32_bf16 v[168:171], v[16:19], a[108:111], v[168:171]
v_mfma_f32_16x16x32_bf16 v[164:167], v[20:23], a[104:107], v[164:167]
ds_read_b128 v[16:19], v6 offset:51200
global_load_lds_dwordx4 v4, s[20:21] offset:1024 sc1
v_mfma_f32_16x16x32_bf16 v[172:175], v[20:23], a[108:111], v[172:175]
v_mfma_f32_16x16x32_bf16 v[176:179], v[24:27], a[104:107], v[176:179]
ds_read_b128 v[20:23], v6 offset:52224
v_mfma_f32_16x16x32_bf16 v[184:187], v[24:27], a[108:111], v[184:187]
s_waitcnt vmcnt(21) lgkmcnt(3)
v_mfma_f32_16x16x32_bf16 v[180:183], v[28:31], a[104:107], v[180:183]
ds_read_b128 v[24:27], v6 offset:53248
global_load_lds_dwordx4 v4, s[20:21] offset:2048 sc1
v_mfma_f32_16x16x32_bf16 v[188:191], v[28:31], a[108:111], v[188:191]
v_mfma_f32_16x16x32_bf16 v[192:195], v[32:35], a[104:107], v[192:195]
ds_read_b128 v[28:31], v6 offset:54272
v_mfma_f32_16x16x32_bf16 v[200:203], v[32:35], a[108:111], v[200:203]
v_mfma_f32_16x16x32_bf16 v[196:199], v[36:39], a[104:107], v[196:199]
ds_read_b128 v[32:35], v6 offset:55296
global_load_lds_dwordx4 v4, s[20:21] offset:3072 sc1
v_mfma_f32_16x16x32_bf16 v[204:207], v[36:39], a[108:111], v[204:207]
v_mfma_f32_16x16x32_bf16 v[144:147], v[40:43], a[112:115], v[144:147]
ds_read_b128 v[36:39], v6 offset:56320
v_mfma_f32_16x16x32_bf16 v[152:155], v[40:43], a[116:119], v[152:155]
s_waitcnt lgkmcnt(3)
v_mfma_f32_16x16x32_bf16 v[148:151], v[44:47], a[112:115], v[148:151]
ds_read_b128 v[40:43], v6 offset:57344
v_mfma_f32_16x16x32_bf16 v[156:159], v[44:47], a[116:119], v[156:159]
v_mfma_f32_16x16x32_bf16 v[160:163], v[16:19], a[112:115], v[160:163]
ds_read_b128 v[44:47], v6 offset:58368
v_add_u32 v5, 8192, v5
v_mfma_f32_16x16x32_bf16 v[168:171], v[16:19], a[116:119], v[168:171]
global_load_dwordx4 a[160:163], v5, s[20:21] offset:-4096 sc1
v_mfma_f32_16x16x32_bf16 v[164:167], v[20:23], a[112:115], v[164:167]
ds_read_b128 v[16:19], v6 offset:59392
v_mfma_f32_16x16x32_bf16 v[172:175], v[20:23], a[116:119], v[172:175]
v_mfma_f32_16x16x32_bf16 v[176:179], v[24:27], a[112:115], v[176:179]
ds_read_b128 v[20:23], v6 offset:60416
global_load_dwordx4 a[164:167], v5, s[20:21] offset:-3072 sc1
v_mfma_f32_16x16x32_bf16 v[184:187], v[24:27], a[116:119], v[184:187]
s_waitcnt vmcnt(19) lgkmcnt(3)
v_mfma_f32_16x16x32_bf16 v[180:183], v[28:31], a[112:115], v[180:183]
ds_read_b128 v[24:27], v6 offset:61440
v_mfma_f32_16x16x32_bf16 v[188:191], v[28:31], a[116:119], v[188:191]
v_mfma_f32_16x16x32_bf16 v[192:195], v[32:35], a[112:115], v[192:195]
ds_read_b128 v[28:31], v6 offset:62464
s_add_u32 m0, s43, 114688
v_mfma_f32_16x16x32_bf16 v[200:203], v[32:35], a[116:119], v[200:203]
v_add_u32 v4, 16384, v4
v_mfma_f32_16x16x32_bf16 v[196:199], v[36:39], a[112:115], v[196:199]
ds_read_b128 v[32:35], v6 offset:63488
global_load_lds_dwordx4 v4, s[20:21] offset:0 sc1
v_mfma_f32_16x16x32_bf16 v[204:207], v[36:39], a[116:119], v[204:207]
v_mfma_f32_16x16x32_bf16 v[144:147], v[40:43], a[120:123], v[144:147]
ds_read_b128 v[36:39], v6 offset:64512
global_load_lds_dwordx4 v4, s[20:21] offset:1024 sc1
v_mfma_f32_16x16x32_bf16 v[152:155], v[40:43], a[124:127], v[152:155]
s_waitcnt lgkmcnt(3)
v_mfma_f32_16x16x32_bf16 v[148:151], v[44:47], a[120:123], v[148:151]
s_barrier
ds_read_b128 v[40:43], v7 offset:0
v_mfma_f32_16x16x32_bf16 v[156:159], v[44:47], a[124:127], v[156:159]
v_mfma_f32_16x16x32_bf16 v[160:163], v[16:19], a[120:123], v[160:163]
ds_read_b128 v[44:47], v7 offset:1024
v_mfma_f32_16x16x32_bf16 v[168:171], v[16:19], a[124:127], v[168:171]
v_mfma_f32_16x16x32_bf16 v[164:167], v[20:23], a[120:123], v[164:167]
ds_read_b128 v[16:19], v7 offset:2048
global_load_lds_dwordx4 v4, s[20:21] offset:2048 sc1
v_mfma_f32_16x16x32_bf16 v[172:175], v[20:23], a[124:127], v[172:175]
v_mfma_f32_16x16x32_bf16 v[176:179], v[24:27], a[120:123], v[176:179]
ds_read_b128 v[20:23], v7 offset:3072
v_mfma_f32_16x16x32_bf16 v[184:187], v[24:27], a[124:127], v[184:187]
s_waitcnt vmcnt(20) lgkmcnt(3)
v_mfma_f32_16x16x32_bf16 v[180:183], v[28:31], a[120:123], v[180:183]
ds_read_b128 v[24:27], v7 offset:4096
global_load_lds_dwordx4 v4, s[20:21] offset:3072 sc1
v_mfma_f32_16x16x32_bf16 v[188:191], v[28:31], a[124:127], v[188:191]
v_mfma_f32_16x16x32_bf16 v[192:195], v[32:35], a[120:123], v[192:195]
ds_read_b128 v[28:31], v7 offset:5120
v_mfma_f32_16x16x32_bf16 v[200:203], v[32:35], a[124:127], v[200:203]
v_mfma_f32_16x16x32_bf16 v[196:199], v[36:39], a[120:123], v[196:199]
ds_read_b128 v[32:35], v7 offset:6144
global_load_dwordx4 a[168:171], v5, s[20:21] offset:-2048 sc1
v_mfma_f32_16x16x32_bf16 v[204:207], v[36:39], a[124:127], v[204:207]
v_mfma_f32_16x16x32_bf16 v[144:147], v[40:43], a[128:131], v[144:147]
ds_read_b128 v[36:39], v7 offset:7168
v_mfma_f32_16x16x32_bf16 v[152:155], v[40:43], a[132:135], v[152:155]
s_waitcnt lgkmcnt(3)
v_mfma_f32_16x16x32_bf16 v[148:151], v[44:47], a[128:131], v[148:151]
ds_read_b128 v[40:43], v7 offset:8192
global_load_dwordx4 a[172:175], v5, s[20:21] offset:-1024 sc1
v_mfma_f32_16x16x32_bf16 v[156:159], v[44:47], a[132:135], v[156:159]
v_mfma_f32_16x16x32_bf16 v[160:163], v[16:19], a[128:131], v[160:163]
ds_read_b128 v[44:47], v7 offset:9216
v_mfma_f32_16x16x32_bf16 v[168:171], v[16:19], a[132:135], v[168:171]
v_mfma_f32_16x16x32_bf16 v[164:167], v[20:23], a[128:131], v[164:167]
ds_read_b128 v[16:19], v7 offset:10240
v_mfma_f32_16x16x32_bf16 v[172:175], v[20:23], a[132:135], v[172:175]
v_mfma_f32_16x16x32_bf16 v[176:179], v[24:27], a[128:131], v[176:179]
ds_read_b128 v[20:23], v7 offset:11264
global_load_dwordx4 a[176:179], v5, s[20:21] offset:0 sc1
v_mfma_f32_16x16x32_bf16 v[184:187], v[24:27], a[132:135], v[184:187]
s_waitcnt vmcnt(17) lgkmcnt(3)
v_mfma_f32_16x16x32_bf16 v[180:183], v[28:31], a[128:131], v[180:183]
ds_read_b128 v[24:27], v7 offset:12288
v_mfma_f32_16x16x32_bf16 v[188:191], v[28:31], a[132:135], v[188:191]
v_mfma_f32_16x16x32_bf16 v[192:195], v[32:35], a[128:131], v[192:195]
ds_read_b128 v[28:31], v7 offset:13312
global_load_dwordx4 a[180:183], v5, s[20:21] offset:1024 sc1
v_mfma_f32_16x16x32_bf16 v[200:203], v[32:35], a[132:135], v[200:203]
v_mfma_f32_16x16x32_bf16 v[196:199], v[36:39], a[128:131], v[196:199]
ds_read_b128 v[32:35], v7 offset:14336
v_mfma_f32_16x16x32_bf16 v[204:207], v[36:39], a[132:135], v[204:207]
v_mfma_f32_16x16x32_bf16 v[144:147], v[40:43], a[136:139], v[144:147]
ds_read_b128 v[36:39], v7 offset:15360
global_load_dwordx4 a[184:187], v5, s[20:21] offset:2048 sc1
v_mfma_f32_16x16x32_bf16 v[152:155], v[40:43], a[140:143], v[152:155]
s_waitcnt lgkmcnt(3)
v_mfma_f32_16x16x32_bf16 v[148:151], v[44:47], a[136:139], v[148:151]
s_barrier
ds_read_b128 v[40:43], v7 offset:16384
v_mfma_f32_16x16x32_bf16 v[156:159], v[44:47], a[140:143], v[156:159]
v_mfma_f32_16x16x32_bf16 v[160:163], v[16:19], a[136:139], v[160:163]
ds_read_b128 v[44:47], v7 offset:17408
global_load_dwordx4 a[188:191], v5, s[20:21] offset:3072 sc1
v_mfma_f32_16x16x32_bf16 v[168:171], v[16:19], a[140:143], v[168:171]
v_mfma_f32_16x16x32_bf16 v[164:167], v[20:23], a[136:139], v[164:167]
ds_read_b128 v[16:19], v7 offset:18432
v_mfma_f32_16x16x32_bf16 v[172:175], v[20:23], a[140:143], v[172:175]
v_mfma_f32_16x16x32_bf16 v[176:179], v[24:27], a[136:139], v[176:179]
ds_read_b128 v[20:23], v7 offset:19456
v_mfma_f32_16x16x32_bf16 v[184:187], v[24:27], a[140:143], v[184:187]
s_waitcnt vmcnt(18) lgkmcnt(3)
v_mfma_f32_16x16x32_bf16 v[180:183], v[28:31], a[136:139], v[180:183]
ds_read_b128 v[24:27], v7 offset:20480
s_add_u32 m0, s43, 0
v_mfma_f32_16x16x32_bf16 v[188:191], v[28:31], a[140:143], v[188:191]
v_add_u32 v4, 16384, v4
v_mfma_f32_16x16x32_bf16 v[192:195], v[32:35], a[136:139], v[192:195]
ds_read_b128 v[28:31], v7 offset:21504
global_load_lds_dwordx4 v4, s[20:21] offset:0 sc1
v_mfma_f32_16x16x32_bf16 v[200:203], v[32:35], a[140:143], v[200:203]
v_mfma_f32_16x16x32_bf16 v[196:199], v[36:39], a[136:139], v[196:199]
ds_read_b128 v[32:35], v7 offset:22528
global_load_lds_dwordx4 v4, s[20:21] offset:1024 sc1
v_mfma_f32_16x16x32_bf16 v[204:207], v[36:39], a[140:143], v[204:207]
v_mfma_f32_16x16x32_bf16 v[144:147], v[40:43], a[144:147], v[144:147]
ds_read_b128 v[36:39], v7 offset:23552
v_mfma_f32_16x16x32_bf16 v[152:155], v[40:43], a[148:151], v[152:155]
s_waitcnt lgkmcnt(3)
v_mfma_f32_16x16x32_bf16 v[148:151], v[44:47], a[144:147], v[148:151]
ds_read_b128 v[40:43], v7 offset:24576
global_load_lds_dwordx4 v4, s[20:21] offset:2048 sc1
v_mfma_f32_16x16x32_bf16 v[156:159], v[44:47], a[148:151], v[156:159]
v_mfma_f32_16x16x32_bf16 v[160:163], v[16:19], a[144:147], v[160:163]
ds_read_b128 v[44:47], v7 offset:25600
v_mfma_f32_16x16x32_bf16 v[168:171], v[16:19], a[148:151], v[168:171]
v_mfma_f32_16x16x32_bf16 v[164:167], v[20:23], a[144:147], v[164:167]
ds_read_b128 v[16:19], v7 offset:26624
global_load_lds_dwordx4 v4, s[20:21] offset:3072 sc1
v_mfma_f32_16x16x32_bf16 v[172:175], v[20:23], a[148:151], v[172:175]
v_mfma_f32_16x16x32_bf16 v[176:179], v[24:27], a[144:147], v[176:179]
ds_read_b128 v[20:23], v7 offset:27648
v_mfma_f32_16x16x32_bf16 v[184:187], v[24:27], a[148:151], v[184:187]
s_waitcnt vmcnt(20) lgkmcnt(3)
v_mfma_f32_16x16x32_bf16 v[180:183], v[28:31], a[144:147], v[180:183]
ds_read_b128 v[24:27], v7 offset:28672
v_mfma_f32_16x16x32_bf16 v[188:191], v[28:31], a[148:151], v[188:191]
v_mfma_f32_16x16x32_bf16 v[192:195], v[32:35], a[144:147], v[192:195]
ds_read_b128 v[28:31], v7 offset:29696
s_add_u32 m0, s43, 16384
v_mfma_f32_16x16x32_bf16 v[200:203], v[32:35], a[148:151], v[200:203]
v_add_u32 v4, 16384, v4
v_mfma_f32_16x16x32_bf16 v[196:199], v[36:39], a[144:147], v[196:199]
ds_read_b128 v[32:35], v7 offset:30720
global_load_lds_dwordx4 v4, s[20:21] offset:0 sc1
v_mfma_f32_16x16x32_bf16 v[204:207], v[36:39], a[148:151], v[204:207]
v_mfma_f32_16x16x32_bf16 v[144:147], v[40:43], a[152:155], v[144:147]
ds_read_b128 v[36:39], v7 offset:31744
global_load_lds_dwordx4 v4, s[20:21] offset:1024 sc1
v_mfma_f32_16x16x32_bf16 v[152:155], v[40:43], a[156:159], v[152:155]
s_waitcnt lgkmcnt(3)
v_mfma_f32_16x16x32_bf16 v[148:151], v[44:47], a[152:155], v[148:151]
ds_read_b128 v[40:43], v8 offset:4096
v_mfma_f32_16x16x32_bf16 v[156:159], v[44:47], a[156:159], v[156:159]
v_mfma_f32_16x16x32_bf16 v[160:163], v[16:19], a[152:155], v[160:163]
ds_read_b128 v[44:47], v8 offset:4352
global_load_lds_dwordx4 v4, s[20:21] offset:2048 sc1
v_mfma_f32_16x16x32_bf16 v[168:171], v[16:19], a[156:159], v[168:171]
v_mfma_f32_16x16x32_bf16 v[164:167], v[20:23], a[152:155], v[164:167]
ds_read_b128 v[16:19], v8 offset:4608
v_mfma_f32_16x16x32_bf16 v[172:175], v[20:23], a[156:159], v[172:175]
v_mfma_f32_16x16x32_bf16 v[176:179], v[24:27], a[152:155], v[176:179]
ds_read_b128 v[20:23], v8 offset:4864
global_load_lds_dwordx4 v4, s[20:21] offset:3072 sc1
v_mfma_f32_16x16x32_bf16 v[184:187], v[24:27], a[156:159], v[184:187]
s_waitcnt lgkmcnt(3)
v_mfma_f32_16x16x32_bf16 v[180:183], v[28:31], a[152:155], v[180:183]
ds_read_b128 v[24:27], v8 offset:5120
v_mfma_f32_16x16x32_bf16 v[188:191], v[28:31], a[156:159], v[188:191]
v_mfma_f32_16x16x32_bf16 v[192:195], v[32:35], a[152:155], v[192:195]
ds_read_b128 v[28:31], v8 offset:5376
v_mfma_f32_16x16x32_bf16 v[200:203], v[32:35], a[156:159], v[200:203]
v_mfma_f32_16x16x32_bf16 v[196:199], v[36:39], a[152:155], v[196:199]
ds_read_b128 v[32:35], v8 offset:5632
s_add_u32 m0, s43, 32768
v_mfma_f32_16x16x32_bf16 v[204:207], v[36:39], a[156:159], v[204:207]
v_add_u32 v4, 16384, v4
v_mfma_f32_16x16x32_bf16 v[144:147], v[40:43], v[64:67], v[144:147]
ds_read_b128 v[36:39], v8 offset:5888
global_load_lds_dwordx4 v4, s[20:21] offset:0 sc1
v_mfma_f32_16x16x32_bf16 v[152:155], v[40:43], v[68:71], v[152:155]
s_waitcnt vmcnt(21) lgkmcnt(3)
v_mfma_f32_16x16x32_bf16 v[148:151], v[44:47], v[64:67], v[148:151]
s_barrier
ds_read_b128 v[40:43], v7 offset:32768
v_mfma_f32_16x16x32_bf16 v[156:159], v[44:47], v[68:71], v[156:159]
global_load_lds_dwordx4 v4, s[20:21] offset:1024 sc1
v_mfma_f32_16x16x32_bf16 v[160:163], v[16:19], v[64:67], v[160:163]
ds_read_b128 v[44:47], v7 offset:33792
v_mfma_f32_16x16x32_bf16 v[168:171], v[16:19], v[68:71], v[168:171]
v_mfma_f32_16x16x32_bf16 v[164:167], v[20:23], v[64:67], v[164:167]
ds_read_b128 v[16:19], v7 offset:34816
global_load_lds_dwordx4 v4, s[20:21] offset:2048 sc1
v_mfma_f32_16x16x32_bf16 v[172:175], v[20:23], v[68:71], v[172:175]
v_mfma_f32_16x16x32_bf16 v[176:179], v[24:27], v[64:67], v[176:179]
ds_read_b128 v[20:23], v7 offset:35840
v_mfma_f32_16x16x32_bf16 v[184:187], v[24:27], v[68:71], v[184:187]
s_waitcnt vmcnt(21) lgkmcnt(3)
v_mfma_f32_16x16x32_bf16 v[180:183], v[28:31], v[64:67], v[180:183]
ds_read_b128 v[24:27], v7 offset:36864
global_load_lds_dwordx4 v4, s[20:21] offset:3072 sc1
v_mfma_f32_16x16x32_bf16 v[188:191], v[28:31], v[68:71], v[188:191]
v_mfma_f32_16x16x32_bf16 v[192:195], v[32:35], v[64:67], v[192:195]
ds_read_b128 v[28:31], v7 offset:37888
v_mfma_f32_16x16x32_bf16 v[200:203], v[32:35], v[68:71], v[200:203]
v_mfma_f32_16x16x32_bf16 v[196:199], v[36:39], v[64:67], v[196:199]
ds_read_b128 v[32:35], v7 offset:38912
v_mfma_f32_16x16x32_bf16 v[204:207], v[36:39], v[68:71], v[204:207]
v_mfma_f32_16x16x32_bf16 v[144:147], v[40:43], a[160:163], v[144:147]
ds_read_b128 v[36:39], v7 offset:39936
s_add_u32 m0, s43, 49152
v_mfma_f32_16x16x32_bf16 v[152:155], v[40:43], a[164:167], v[152:155]
v_add_u32 v4, 16384, v4
s_waitcnt lgkmcnt(3)
v_mfma_f32_16x16x32_bf16 v[148:151], v[44:47], a[160:163], v[148:151]
ds_read_b128 v[40:43], v7 offset:40960
global_load_lds_dwordx4 v4, s[20:21] offset:0 sc1
v_mfma_f32_16x16x32_bf16 v[156:159], v[44:47], a[164:167], v[156:159]
v_mfma_f32_16x16x32_bf16 v[160:163], v[16:19], a[160:163], v[160:163]
ds_read_b128 v[44:47], v7 offset:41984
global_load_lds_dwordx4 v4, s[20:21] offset:1024 sc1
v_mfma_f32_16x16x32_bf16 v[168:171], v[16:19], a[164:167], v[168:171]
v_mfma_f32_16x16x32_bf16 v[164:167], v[20:23], a[160:163], v[164:167]
ds_read_b128 v[16:19], v7 offset:43008
v_mfma_f32_16x16x32_bf16 v[172:175], v[20:23], a[164:167], v[172:175]
v_mfma_f32_16x16x32_bf16 v[176:179], v[24:27], a[160:163], v[176:179]
ds_read_b128 v[20:23], v7 offset:44032
global_load_lds_dwordx4 v4, s[20:21] offset:2048 sc1
v_mfma_f32_16x16x32_bf16 v[184:187], v[24:27], a[164:167], v[184:187]
s_waitcnt vmcnt(19) lgkmcnt(3)
v_mfma_f32_16x16x32_bf16 v[180:183], v[28:31], a[160:163], v[180:183]
ds_read_b128 v[24:27], v7 offset:45056
v_mfma_f32_16x16x32_bf16 v[188:191], v[28:31], a[164:167], v[188:191]
v_mfma_f32_16x16x32_bf16 v[192:195], v[32:35], a[160:163], v[192:195]
ds_read_b128 v[28:31], v7 offset:46080
global_load_lds_dwordx4 v4, s[20:21] offset:3072 sc1
v_mfma_f32_16x16x32_bf16 v[200:203], v[32:35], a[164:167], v[200:203]
v_mfma_f32_16x16x32_bf16 v[196:199], v[36:39], a[160:163], v[196:199]
ds_read_b128 v[32:35], v7 offset:47104
v_mfma_f32_16x16x32_bf16 v[204:207], v[36:39], a[164:167], v[204:207]
v_mfma_f32_16x16x32_bf16 v[144:147], v[40:43], a[168:171], v[144:147]
ds_read_b128 v[36:39], v7 offset:48128
v_mfma_f32_16x16x32_bf16 v[152:155], v[40:43], a[172:175], v[152:155]
s_waitcnt lgkmcnt(3)
v_mfma_f32_16x16x32_bf16 v[148:151], v[44:47], a[168:171], v[148:151]
s_barrier
ds_read_b128 v[40:43], v7 offset:49152
v_mfma_f32_16x16x32_bf16 v[156:159], v[44:47], a[172:175], v[156:159]
s_add_u32 m0, s43, 65536
v_add_u32 v4, 16384, v4
v_mfma_f32_16x16x32_bf16 v[160:163], v[16:19], a[168:171], v[160:163]
ds_read_b128 v[44:47], v7 offset:50176
global_load_lds_dwordx4 v4, s[20:21] offset:0 sc1
v_mfma_f32_16x16x32_bf16 v[168:171], v[16:19], a[172:175], v[168:171]
v_mfma_f32_16x16x32_bf16 v[164:167], v[20:23], a[168:171], v[164:167]
ds_read_b128 v[16:19], v7 offset:51200
global_load_lds_dwordx4 v4, s[20:21] offset:1024 sc1
v_mfma_f32_16x16x32_bf16 v[172:175], v[20:23], a[172:175], v[172:175]
v_mfma_f32_16x16x32_bf16 v[176:179], v[24:27], a[168:171], v[176:179]
ds_read_b128 v[20:23], v7 offset:52224
v_mfma_f32_16x16x32_bf16 v[184:187], v[24:27], a[172:175], v[184:187]
s_waitcnt vmcnt(20) lgkmcnt(3)
v_mfma_f32_16x16x32_bf16 v[180:183], v[28:31], a[168:171], v[180:183]
ds_read_b128 v[24:27], v7 offset:53248
global_load_lds_dwordx4 v4, s[20:21] offset:2048 sc1
v_mfma_f32_16x16x32_bf16 v[188:191], v[28:31], a[172:175], v[188:191]
v_mfma_f32_16x16x32_bf16 v[192:195], v[32:35], a[168:171], v[192:195]
ds_read_b128 v[28:31], v7 offset:54272
v_mfma_f32_16x16x32_bf16 v[200:203], v[32:35], a[172:175], v[200:203]
v_mfma_f32_16x16x32_bf16 v[196:199], v[36:39], a[168:171], v[196:199]
ds_read_b128 v[32:35], v7 offset:55296
global_load_lds_dwordx4 v4, s[20:21] offset:3072 sc1
v_mfma_f32_16x16x32_bf16 v[204:207], v[36:39], a[172:175], v[204:207]
v_mfma_f32_16x16x32_bf16 v[144:147], v[40:43], a[176:179], v[144:147]
ds_read_b128 v[36:39], v7 offset:56320
v_mfma_f32_16x16x32_bf16 v[152:155], v[40:43], a[180:183], v[152:155]
s_waitcnt lgkmcnt(3)
v_mfma_f32_16x16x32_bf16 v[148:151], v[44:47], a[176:179], v[148:151]
ds_read_b128 v[40:43], v7 offset:57344
s_add_u32 m0, s43, 81920
v_mfma_f32_16x16x32_bf16 v[156:159], v[44:47], a[180:183], v[156:159]
v_add_u32 v4, 16384, v4
v_mfma_f32_16x16x32_bf16 v[160:163], v[16:19], a[176:179], v[160:163]
ds_read_b128 v[44:47], v7 offset:58368
global_load_lds_dwordx4 v4, s[20:21] offset:0 sc1
v_mfma_f32_16x16x32_bf16 v[168:171], v[16:19], a[180:183], v[168:171]
v_mfma_f32_16x16x32_bf16 v[164:167], v[20:23], a[176:179], v[164:167]
ds_read_b128 v[16:19], v7 offset:59392
v_mfma_f32_16x16x32_bf16 v[172:175], v[20:23], a[180:183], v[172:175]
v_mfma_f32_16x16x32_bf16 v[176:179], v[24:27], a[176:179], v[176:179]
ds_read_b128 v[20:23], v7 offset:60416
global_load_lds_dwordx4 v4, s[20:21] offset:1024 sc1
v_mfma_f32_16x16x32_bf16 v[184:187], v[24:27], a[180:183], v[184:187]
s_waitcnt vmcnt(22) lgkmcnt(3)
v_mfma_f32_16x16x32_bf16 v[180:183], v[28:31], a[176:179], v[180:183]
ds_read_b128 v[24:27], v7 offset:61440
v_mfma_f32_16x16x32_bf16 v[188:191], v[28:31], a[180:183], v[188:191]
v_mfma_f32_16x16x32_bf16 v[192:195], v[32:35], a[176:179], v[192:195]
ds_read_b128 v[28:31], v7 offset:62464
global_load_lds_dwordx4 v4, s[20:21] offset:2048 sc1
v_mfma_f32_16x16x32_bf16 v[200:203], v[32:35], a[180:183], v[200:203]
v_mfma_f32_16x16x32_bf16 v[196:199], v[36:39], a[176:179], v[196:199]
ds_read_b128 v[32:35], v7 offset:63488
v_mfma_f32_16x16x32_bf16 v[204:207], v[36:39], a[180:183], v[204:207]
v_mfma_f32_16x16x32_bf16 v[144:147], v[40:43], a[184:187], v[144:147]
ds_read_b128 v[36:39], v7 offset:64512
global_load_lds_dwordx4 v4, s[20:21] offset:3072 sc1
v_mfma_f32_16x16x32_bf16 v[152:155], v[40:43], a[188:191], v[152:155]
s_waitcnt lgkmcnt(3)
v_mfma_f32_16x16x32_bf16 v[148:151], v[44:47], a[184:187], v[148:151]
ds_read_b128 v[40:43], v8 offset:6144
v_mfma_f32_16x16x32_bf16 v[156:159], v[44:47], a[188:191], v[156:159]
v_mfma_f32_16x16x32_bf16 v[160:163], v[16:19], a[184:187], v[160:163]
ds_read_b128 v[44:47], v8 offset:6400
v_mfma_f32_16x16x32_bf16 v[168:171], v[16:19], a[188:191], v[168:171]
v_mul_f32 v208, v144, v144
v_mul_f32 v209, v145, v145
v_fma_f32 v208, v208, v73, v72
v_mul_f32 v210, v146, v146
v_fma_f32 v209, v209, v73, v72
v_mfma_f32_16x16x32_bf16 v[164:167], v[20:23], a[184:187], v[164:167]
ds_read_b128 v[16:19], v8 offset:6656
v_mul_f32 v208, v208, v144
v_mfma_f32_16x16x32_bf16 v[172:175], v[20:23], a[188:191], v[172:175]
v_exp_f32 v208, v208
v_mfma_f32_16x16x32_bf16 v[176:179], v[24:27], a[184:187], v[176:179]
ds_read_b128 v[20:23], v8 offset:6912
v_mul_f32 v211, v147, v147
v_mfma_f32_16x16x32_bf16 v[184:187], v[24:27], a[188:191], v[184:187]
v_fma_f32 v210, v210, v73, v72
v_mul_f32 v209, v209, v145
v_mul_f32 v212, v148, v148
s_waitcnt vmcnt(20) lgkmcnt(3)
v_mfma_f32_16x16x32_bf16 v[180:183], v[28:31], a[184:187], v[180:183]
ds_read_b128 v[24:27], v8 offset:7168
v_fma_f32 v211, v211, v73, v72
v_mfma_f32_16x16x32_bf16 v[188:191], v[28:31], a[188:191], v[188:191]
v_exp_f32 v209, v209
v_mfma_f32_16x16x32_bf16 v[192:195], v[32:35], a[184:187], v[192:195]
ds_read_b128 v[28:31], v8 offset:7424
v_mul_f32 v210, v210, v146
v_mfma_f32_16x16x32_bf16 v[200:203], v[32:35], a[188:191], v[200:203]
v_fma_f32 v208, v208, v74, v74
v_mul_f32 v213, v149, v149
v_fma_f32 v212, v212, v73, v72
v_mfma_f32_16x16x32_bf16 v[196:199], v[36:39], a[184:187], v[196:199]
s_barrier
ds_read_b128 v[32:35], v6 offset:0
v_mfma_f32_16x16x32_bf16 v[204:207], v[36:39], a[188:191], v[204:207]
s_add_u32 m0, s43, 98304
v_add_u32 v4, 16384, v4
v_mul_f32 v211, v211, v147
v_exp_f32 v210, v210
v_mfma_f32_16x16x32_bf16 v[80:83], v[40:43], v[64:67], 0
ds_read_b128 v[36:39], v6 offset:1024
global_load_lds_dwordx4 v4, s[20:21] offset:0 sc1
v_mfma_f32_16x16x32_bf16 v[88:91], v[40:43], v[68:71], 0
global_load_lds_dwordx4 v4, s[20:21] offset:1024 sc1
v_fma_f32 v209, v209, v74, v74
v_rcp_f32 v208, v208
s_waitcnt lgkmcnt(3)
v_mfma_f32_16x16x32_bf16 v[84:87], v[44:47], v[64:67], 0
ds_read_b128 v[40:43], v6 offset:2048
global_load_lds_dwordx4 v4, s[20:21] offset:2048 sc1
v_mfma_f32_16x16x32_bf16 v[92:95], v[44:47], v[68:71], 0
global_load_lds_dwordx4 v4, s[20:21] offset:3072 sc1
v_mul_f32 v214, v150, v150
v_fma_f32 v213, v213, v73, v72
v_mul_f32 v212, v212, v148
v_mfma_f32_16x16x32_bf16 v[96:99], v[16:19], v[64:67], 0
ds_read_b128 v[44:47], v6 offset:3072
s_add_u32 m0, s43, 114688
v_mfma_f32_16x16x32_bf16 v[104:107], v[16:19], v[68:71], 0
v_add_u32 v4, 16384, v4
v_fma_f32 v210, v210, v74, v74
v_exp_f32 v211, v211
v_mfma_f32_16x16x32_bf16 v[100:103], v[20:23], v[64:67], 0
ds_read_b128 v[16:19], v6 offset:4096
global_load_lds_dwordx4 v4, s[20:21] offset:0 sc1
v_mfma_f32_16x16x32_bf16 v[108:111], v[20:23], v[68:71], 0
v_rcp_f32 v209, v209
v_mul_f32 v144, v208, v144
v_mul_f32 v215, v151, v151
v_fma_f32 v214, v214, v73, v72
v_mfma_f32_16x16x32_bf16 v[112:115], v[24:27], v[64:67], 0
ds_read_b128 v[20:23], v6 offset:5120
global_load_lds_dwordx4 v4, s[20:21] offset:1024 sc1
v_mfma_f32_16x16x32_bf16 v[120:123], v[24:27], v[68:71], 0
v_mul_f32 v213, v213, v149
v_exp_f32 v212, v212
s_waitcnt lgkmcnt(3)
v_mfma_f32_16x16x32_bf16 v[116:119], v[28:31], v[64:67], 0
ds_read_b128 v[24:27], v6 offset:6144
v_fma_f32 v211, v211, v74, v74
v_mfma_f32_16x16x32_bf16 v[124:127], v[28:31], v[68:71], 0
v_rcp_f32 v210, v210
v_mfma_f32_16x16x32_bf16 v[80:83], v[32:35], a[192:195], v[80:83]
ds_read_b128 v[28:31], v6 offset:7168
global_load_lds_dwordx4 v4, s[20:21] offset:2048 sc1
v_mfma_f32_16x16x32_bf16 v[88:91], v[32:35], a[196:199], v[88:91]
v_mul_f32 v145, v209, v145
v_mul_f32 v208, v152, v152
v_fma_f32 v215, v215, v73, v72
v_mul_f32 v214, v214, v150
v_mfma_f32_16x16x32_bf16 v[84:87], v[36:39], a[192:195], v[84:87]
ds_read_b128 v[32:35], v6 offset:8192
global_load_lds_dwordx4 v4, s[20:21] offset:3072 sc1
v_mfma_f32_16x16x32_bf16 v[92:95], v[36:39], a[196:199], v[92:95]
v_exp_f32 v213, v213
v_fma_f32 v212, v212, v74, v74
v_mfma_f32_16x16x32_bf16 v[96:99], v[40:43], a[192:195], v[96:99]
v_rcp_f32 v211, v211
v_mfma_f32_16x16x32_bf16 v[104:107], v[40:43], a[196:199], v[104:107]
ds_read_b128 v[36:39], v6 offset:9216
v_mul_f32 v146, v210, v146
s_waitcnt lgkmcnt(3)
v_mfma_f32_16x16x32_bf16 v[100:103], v[44:47], a[192:195], v[100:103]
ds_read_b128 v[40:43], v6 offset:10240
v_cvt_pk_bf16_f32 v240, v144, v145
v_mfma_f32_16x16x32_bf16 v[108:111], v[44:47], a[196:199], v[108:111]
v_exp_f32 v214, v214
v_mul_f32 v209, v153, v153
v_mfma_f32_16x16x32_bf16 v[112:115], v[16:19], a[192:195], v[112:115]
ds_read_b128 v[44:47], v6 offset:11264
v_fma_f32 v208, v208, v76, v75
v_mfma_f32_16x16x32_bf16 v[120:123], v[16:19], a[196:199], v[120:123]
v_rcp_f32 v212, v212
v_mfma_f32_16x16x32_bf16 v[116:119], v[20:23], a[192:195], v[116:119]
ds_read_b128 v[16:19], v6 offset:12288
v_mul_f32 v215, v215, v151
v_mfma_f32_16x16x32_bf16 v[124:127], v[20:23], a[196:199], v[124:127]
v_fma_f32 v213, v213, v74, v74
v_mul_f32 v147, v211, v147
v_mul_f32 v210, v154, v154
v_mfma_f32_16x16x32_bf16 v[80:83], v[24:27], a[200:203], v[80:83]
ds_read_b128 v[20:23], v6 offset:13312
v_fma_f32 v209, v209, v76, v75
v_mfma_f32_16x16x32_bf16 v[88:91], v[24:27], a[204:207], v[88:91]
v_mul_f32 v208, v208, v152
s_waitcnt vmcnt(24) lgkmcnt(3)
v_mfma_f32_16x16x32_bf16 v[84:87], v[28:31], a[200:203], v[84:87]
ds_read_b128 v[24:27], v6 offset:14336
v_fma_f32 v214, v214, v74, v74
v_mfma_f32_16x16x32_bf16 v[92:95], v[28:31], a[204:207], v[92:95]
v_exp_f32 v215, v215
v_mfma_f32_16x16x32_bf16 v[96:99], v[32:35], a[200:203], v[96:99]
ds_read_b128 v[28:31], v6 offset:15360
v_mul_f32 v148, v212, v148
v_mfma_f32_16x16x32_bf16 v[104:107], v[32:35], a[204:207], v[104:107]
v_rcp_f32 v213, v213
v_cvt_pk_bf16_f32 v241, v146, v147
v_mul_f32 v211, v155, v155
v_mfma_f32_16x16x32_bf16 v[100:103], v[36:39], a[200:203], v[100:103]
s_barrier
ds_read_b128 v[32:35], v6 offset:16384
v_mfma_f32_16x16x32_bf16 v[108:111], v[36:39], a[204:207], v[108:111]
v_exp_f32 v208, v208
v_fma_f32 v210, v210, v76, v75
v_mfma_f32_16x16x32_bf16 v[112:115], v[40:43], a[200:203], v[112:115]
ds_read_b128 v[36:39], v6 offset:17408
v_mul_f32 v209, v209, v153
v_mfma_f32_16x16x32_bf16 v[120:123], v[40:43], a[204:207], v[120:123]
v_fma_f32 v215, v215, v74, v74
v_rcp_f32 v214, v214
s_waitcnt lgkmcnt(3)
v_mfma_f32_16x16x32_bf16 v[116:119], v[44:47], a[200:203], v[116:119]
ds_read_b128 v[40:43], v6 offset:18432
v_mul_f32 v149, v213, v149
v_mfma_f32_16x16x32_bf16 v[124:127], v[44:47], a[204:207], v[124:127]
v_exp_f32 v209, v209
v_mfma_f32_16x16x32_bf16 v[80:83], v[16:19], a[208:211], v[80:83]
ds_read_b128 v[44:47], v6 offset:19456
v_mul_f32 v212, v156, v156
v_mfma_f32_16x16x32_bf16 v[88:91], v[16:19], a[212:215], v[88:91]
v_rcp_f32 v215, v215
v_mfma_f32_16x16x32_bf16 v[84:87], v[20:23], a[208:211], v[84:87]
ds_read_b128 v[16:19], v6 offset:20480
v_fma_f32 v211, v211, v76, v75
v_mfma_f32_16x16x32_bf16 v[92:95], v[20:23], a[212:215], v[92:95]
v_mul_f32 v210, v210, v154
v_fma_f32 v208, v208, v77, v77
v_mul_f32 v150, v214, v150
v_mfma_f32_16x16x32_bf16 v[96:99], v[24:27], a[208:211], v[96:99]
ds_read_b128 v[20:23], v6 offset:21504
v_cvt_pk_bf16_f32 v242, v148, v149
v_mfma_f32_16x16x32_bf16 v[104:107], v[24:27], a[212:215], v[104:107]
v_mul_f32 v213, v157, v157
v_fma_f32 v212, v212, v76, v75
s_waitcnt lgkmcnt(3)
v_mfma_f32_16x16x32_bf16 v[100:103], v[28:31], a[208:211], v[100:103]
s_barrier
ds_read_b128 v[24:27], v6 offset:22528
v_mfma_f32_16x16x32_bf16 v[108:111], v[28:31], a[212:215], v[108:111]
s_add_u32 m0, s43, 0
v_add_u32 v4, 16384, v4
v_mul_f32 v211, v211, v155
v_exp_f32 v210, v210
v_fma_f32 v209, v209, v77, v77
v_mfma_f32_16x16x32_bf16 v[112:115], v[32:35], a[208:211], v[112:115]
ds_read_b128 v[28:31], v6 offset:23552
global_load_lds_dwordx4 v4, s[20:21] offset:0 sc1
v_mfma_f32_16x16x32_bf16 v[120:123], v[32:35], a[212:215], v[120:123]
global_load_lds_dwordx4 v4, s[20:21] offset:1024 sc1
global_load_lds_dwordx4 v4, s[20:21] offset:2048 sc1
v_rcp_f32 v208, v208
v_mul_f32 v151, v215, v151
v_mfma_f32_16x16x32_bf16 v[116:119], v[36:39], a[208:211], v[116:119]
ds_read_b128 v[32:35], v6 offset:24576
global_load_lds_dwordx4 v4, s[20:21] offset:3072 sc1
v_mfma_f32_16x16x32_bf16 v[124:127], v[36:39], a[212:215], v[124:127]
v_exp_f32 v211, v211
v_mul_f32 v214, v158, v158
v_mfma_f32_16x16x32_bf16 v[80:83], v[40:43], a[216:219], v[80:83]
ds_read_b128 v[36:39], v6 offset:25600
v_fma_f32 v213, v213, v76, v75
v_mfma_f32_16x16x32_bf16 v[88:91], v[40:43], a[220:223], v[88:91]
v_mul_f32 v212, v212, v156
v_fma_f32 v210, v210, v77, v77
s_waitcnt lgkmcnt(3)
v_mfma_f32_16x16x32_bf16 v[84:87], v[44:47], a[216:219], v[84:87]
ds_read_b128 v[40:43], v6 offset:26624
v_mul_f32 v152, v208, v152
v_mfma_f32_16x16x32_bf16 v[92:95], v[44:47], a[220:223], v[92:95]
v_rcp_f32 v209, v209
v_cvt_pk_bf16_f32 v243, v150, v151
v_mfma_f32_16x16x32_bf16 v[96:99], v[16:19], a[216:219], v[96:99]
ds_read_b128 v[44:47], v6 offset:27648
v_mul_f32 v215, v159, v159
v_mfma_f32_16x16x32_bf16 v[104:107], v[16:19], a[220:223], v[104:107]
v_exp_f32 v212, v212
v_fma_f32 v214, v214, v76, v75
v_mfma_f32_16x16x32_bf16 v[100:103], v[20:23], a[216:219], v[100:103]
ds_read_b128 v[16:19], v6 offset:28672
v_mul_f32 v213, v213, v157
v_mfma_f32_16x16x32_bf16 v[108:111], v[20:23], a[220:223], v[108:111]
v_rcp_f32 v210, v210
v_mfma_f32_16x16x32_bf16 v[112:115], v[24:27], a[216:219], v[112:115]
ds_read_b128 v[20:23], v6 offset:29696
v_fma_f32 v211, v211, v77, v77
v_mfma_f32_16x16x32_bf16 v[120:123], v[24:27], a[220:223], v[120:123]
v_mul_f32 v153, v209, v153
v_fma_f32 v215, v215, v76, v75
s_waitcnt vmcnt(24) lgkmcnt(3)
v_mfma_f32_16x16x32_bf16 v[116:119], v[28:31], a[216:219], v[116:119]
ds_read_b128 v[24:27], v6 offset:30720
v_mul_f32 v214, v214, v158
v_mfma_f32_16x16x32_bf16 v[124:127], v[28:31], a[220:223], v[124:127]
v_exp_f32 v213, v213
v_fma_f32 v212, v212, v77, v77
v_mfma_f32_16x16x32_bf16 v[80:83], v[32:35], a[224:227], v[80:83]
ds_read_b128 v[28:31], v6 offset:31744
v_mul_f32 v154, v210, v154
v_mfma_f32_16x16x32_bf16 v[88:91], v[32:35], a[228:231], v[88:91]
v_rcp_f32 v211, v211
v_mfma_f32_16x16x32_bf16 v[84:87], v[36:39], a[224:227], v[84:87]
s_barrier
ds_read_b128 v[32:35], v6 offset:32768
v_mfma_f32_16x16x32_bf16 v[92:95], v[36:39], a[228:231], v[92:95]
v_exp_f32 v214, v214
v_cvt_pk_bf16_f32 v244, v152, v153
v_mul_f32 v215, v215, v159
v_mfma_f32_16x16x32_bf16 v[96:99], v[40:43], a[224:227], v[96:99]
ds_read_b128 v[36:39], v6 offset:33792
v_fma_f32 v213, v213, v77, v77
v_mfma_f32_16x16x32_bf16 v[104:107], v[40:43], a[228:231], v[104:107]
v_mul_f32 v155, v211, v155
s_waitcnt lgkmcnt(3)
v_mfma_f32_16x16x32_bf16 v[100:103], v[44:47], a[224:227], v[100:103]
ds_read_b128 v[40:43], v6 offset:34816
v_fma_f32 v214, v214, v77, v77
v_mfma_f32_16x16x32_bf16 v[108:111], v[44:47], a[228:231], v[108:111]
v_rcp_f32 v212, v212
v_mfma_f32_16x16x32_bf16 v[112:115], v[16:19], a[224:227], v[112:115]
ds_read_b128 v[44:47], v6 offset:35840
v_mul_f32 v156, v212, v156
v_mfma_f32_16x16x32_bf16 v[120:123], v[16:19], a[228:231], v[120:123]
v_exp_f32 v215, v215
v_rcp_f32 v213, v213
v_mfma_f32_16x16x32_bf16 v[116:119], v[20:23], a[224:227], v[116:119]
ds_read_b128 v[16:19], v6 offset:36864
v_cvt_pk_bf16_f32 v245, v154, v155
v_mfma_f32_16x16x32_bf16 v[124:127], v[20:23], a[228:231], v[124:127]
v_rcp_f32 v214, v214
v_mfma_f32_16x16x32_bf16 v[80:83], v[24:27], a[232:235], v[80:83]
ds_read_b128 v[20:23], v6 offset:37888
v_fma_f32 v215, v215, v77, v77
v_mfma_f32_16x16x32_bf16 v[88:91], v[24:27], a[236:239], v[88:91]
v_mul_f32 v157, v213, v157
v_rcp_f32 v215, v215
s_waitcnt lgkmcnt(3)
v_mfma_f32_16x16x32_bf16 v[84:87], v[28:31], a[232:235], v[84:87]
s_barrier
ds_read_b128 v[24:27], v6 offset:38912
v_mfma_f32_16x16x32_bf16 v[92:95], v[28:31], a[236:239], v[92:95]
s_add_u32 m0, s43, 16384
v_add_u32 v4, 16384, v4
v_mul_f32 v158, v214, v158
v_cvt_pk_bf16_f32 v246, v156, v157
v_mul_f32 v159, v215, v159
v_mfma_f32_16x16x32_bf16 v[96:99], v[32:35], a[232:235], v[96:99]
ds_read_b128 v[28:31], v6 offset:39936
global_load_lds_dwordx4 v4, s[20:21] offset:0 sc1
v_mfma_f32_16x16x32_bf16 v[104:107], v[32:35], a[236:239], v[104:107]
global_load_lds_dwordx4 v4, s[20:21] offset:1024 sc1
global_load_lds_dwordx4 v4, s[20:21] offset:2048 sc1
v_cvt_pk_bf16_f32 v247, v158, v159
s_add_u32 s38, s47, 55574528
v_mfma_f32_16x16x32_bf16 v[100:103], v[36:39], a[232:235], v[100:103]
ds_read_b128 v[32:35], v6 offset:40960
global_load_lds_dwordx4 v4, s[20:21] offset:3072 sc1
buffer_store_dwordx4 v[240:243], v0, s[20:23], s38 offen offset:0 sc1
buffer_store_dwordx4 v[244:247], v0, s[20:23], s38 offen offset:1024 sc1
v_mfma_f32_16x16x32_bf16 v[108:111], v[36:39], a[236:239], v[108:111]
s_mov_b32 s58, 0
v_lshlrev_b32 v144, 16, v56
v_and_b32 v145, 0xffff0000, v56
v_mfma_f32_16x16x32_bf16 v[112:115], v[40:43], a[232:235], v[112:115]
ds_read_b128 v[36:39], v6 offset:41984
v_add_f32 v144, v144, v232
v_mfma_f32_16x16x32_bf16 v[120:123], v[40:43], a[236:239], v[120:123]
v_add_f32 v145, v145, v233
v_lshlrev_b32 v146, 16, v57
s_waitcnt lgkmcnt(3)
v_mfma_f32_16x16x32_bf16 v[116:119], v[44:47], a[232:235], v[116:119]
ds_read_b128 v[40:43], v6 offset:43008
v_and_b32 v147, 0xffff0000, v57
v_mfma_f32_16x16x32_bf16 v[124:127], v[44:47], a[236:239], v[124:127]
v_add_f32 v146, v146, v234
v_add_f32 v147, v147, v235
v_lshlrev_b32 v148, 16, v58
v_mfma_f32_16x16x32_bf16 v[80:83], v[16:19], a[240:243], v[80:83]
ds_read_b128 v[44:47], v6 offset:44032
v_and_b32 v149, 0xffff0000, v58
v_mfma_f32_16x16x32_bf16 v[88:91], v[16:19], a[244:247], v[88:91]
v_add_f32 v148, v148, v236
v_add_f32 v149, v149, v237
v_mfma_f32_16x16x32_bf16 v[84:87], v[20:23], a[240:243], v[84:87]
ds_read_b128 v[16:19], v6 offset:45056
v_lshlrev_b32 v150, 16, v59
v_mfma_f32_16x16x32_bf16 v[92:95], v[20:23], a[244:247], v[92:95]
v_and_b32 v151, 0xffff0000, v59
v_add_f32 v150, v150, v238
v_mfma_f32_16x16x32_bf16 v[96:99], v[24:27], a[240:243], v[96:99]
ds_read_b128 v[20:23], v6 offset:46080
v_add_f32 v151, v151, v239
v_mfma_f32_16x16x32_bf16 v[104:107], v[24:27], a[244:247], v[104:107]
v_lshlrev_b32 v152, 16, v60
v_and_b32 v153, 0xffff0000, v60
v_add_f32 v152, v152, v232
s_waitcnt vmcnt(26) lgkmcnt(3)
v_mfma_f32_16x16x32_bf16 v[100:103], v[28:31], a[240:243], v[100:103]
ds_read_b128 v[24:27], v6 offset:47104
v_add_f32 v153, v153, v233
v_mfma_f32_16x16x32_bf16 v[108:111], v[28:31], a[244:247], v[108:111]
v_lshlrev_b32 v154, 16, v61
v_and_b32 v155, 0xffff0000, v61
v_mfma_f32_16x16x32_bf16 v[112:115], v[32:35], a[240:243], v[112:115]
ds_read_b128 v[28:31], v6 offset:48128
v_add_f32 v154, v154, v234
v_mfma_f32_16x16x32_bf16 v[120:123], v[32:35], a[244:247], v[120:123]
v_add_f32 v155, v155, v235
v_lshlrev_b32 v156, 16, v62
v_and_b32 v157, 0xffff0000, v62
v_mfma_f32_16x16x32_bf16 v[116:119], v[36:39], a[240:243], v[116:119]
s_barrier
ds_read_b128 v[32:35], v6 offset:49152
v_mfma_f32_16x16x32_bf16 v[124:127], v[36:39], a[244:247], v[124:127]
v_add_f32 v156, v156, v236
v_add_f32 v157, v157, v237
v_lshlrev_b32 v158, 16, v63
v_mfma_f32_16x16x32_bf16 v[80:83], v[40:43], a[248:251], v[80:83]
ds_read_b128 v[36:39], v6 offset:50176
v_and_b32 v159, 0xffff0000, v63
v_mfma_f32_16x16x32_bf16 v[88:91], v[40:43], a[252:255], v[88:91]
v_add_f32 v158, v158, v238
v_add_f32 v159, v159, v239
s_waitcnt lgkmcnt(3)
v_mfma_f32_16x16x32_bf16 v[84:87], v[44:47], a[248:251], v[84:87]
ds_read_b128 v[40:43], v6 offset:51200
v_mul_f32 v208, v160, v160
v_mfma_f32_16x16x32_bf16 v[92:95], v[44:47], a[252:255], v[92:95]
v_mul_f32 v209, v161, v161
v_fma_f32 v208, v208, v73, v72
v_mul_f32 v210, v162, v162
v_mfma_f32_16x16x32_bf16 v[96:99], v[16:19], a[248:251], v[96:99]
ds_read_b128 v[44:47], v6 offset:52224
v_fma_f32 v209, v209, v73, v72
v_mfma_f32_16x16x32_bf16 v[104:107], v[16:19], a[252:255], v[104:107]
v_mul_f32 v208, v208, v160
v_mul_f32 v211, v163, v163
v_mfma_f32_16x16x32_bf16 v[100:103], v[20:23], a[248:251], v[100:103]
ds_read_b128 v[16:19], v6 offset:53248
v_fma_f32 v210, v210, v73, v72
v_mfma_f32_16x16x32_bf16 v[108:111], v[20:23], a[252:255], v[108:111]
v_exp_f32 v208, v208
v_mul_f32 v209, v209, v161
v_mfma_f32_16x16x32_bf16 v[112:115], v[24:27], a[248:251], v[112:115]
ds_read_b128 v[20:23], v6 offset:54272
v_mul_f32 v212, v164, v164
v_mfma_f32_16x16x32_bf16 v[120:123], v[24:27], a[252:255], v[120:123]
v_fma_f32 v211, v211, v73, v72
v_mul_f32 v210, v210, v162
s_waitcnt lgkmcnt(3)
v_mfma_f32_16x16x32_bf16 v[116:119], v[28:31], a[248:251], v[116:119]
s_barrier
ds_read_b128 v[24:27], v6 offset:55296
v_mfma_f32_16x16x32_bf16 v[124:127], v[28:31], a[252:255], v[124:127]
s_add_u32 m0, s43, 32768
v_add_u32 v4, 16384, v4
v_exp_f32 v209, v209
v_fma_f32 v208, v208, v74, v74
v_mfma_f32_16x16x32_bf16 v[80:83], v[32:35], a[0:3], v[80:83]
ds_read_b128 v[28:31], v6 offset:56320
global_load_lds_dwordx4 v4, s[20:21] offset:0 sc1
v_mfma_f32_16x16x32_bf16 v[88:91], v[32:35], a[4:7], v[88:91]
global_load_lds_dwordx4 v4, s[20:21] offset:1024 sc1
global_load_lds_dwordx4 v4, s[20:21] offset:2048 sc1
v_mul_f32 v213, v165, v165
v_fma_f32 v212, v212, v73, v72
v_mul_f32 v211, v211, v163
v_mfma_f32_16x16x32_bf16 v[84:87], v[36:39], a[0:3], v[84:87]
ds_read_b128 v[32:35], v6 offset:57344
global_load_lds_dwordx4 v4, s[20:21] offset:3072 sc1
v_mfma_f32_16x16x32_bf16 v[92:95], v[36:39], a[4:7], v[92:95]
v_exp_f32 v210, v210
v_fma_f32 v209, v209, v74, v74
v_mfma_f32_16x16x32_bf16 v[96:99], v[40:43], a[0:3], v[96:99]
v_rcp_f32 v208, v208
v_mfma_f32_16x16x32_bf16 v[104:107], v[40:43], a[4:7], v[104:107]
ds_read_b128 v[36:39], v6 offset:58368
v_mul_f32 v214, v166, v166
v_fma_f32 v213, v213, v73, v72
v_mul_f32 v212, v212, v164
s_waitcnt lgkmcnt(3)
v_mfma_f32_16x16x32_bf16 v[100:103], v[44:47], a[0:3], v[100:103]
ds_read_b128 v[40:43], v6 offset:59392
v_fma_f32 v210, v210, v74, v74
v_mfma_f32_16x16x32_bf16 v[108:111], v[44:47], a[4:7], v[108:111]
v_exp_f32 v211, v211
v_mfma_f32_16x16x32_bf16 v[112:115], v[16:19], a[0:3], v[112:115]
ds_read_b128 v[44:47], v6 offset:60416
v_mfma_f32_16x16x32_bf16 v[120:123], v[16:19], a[4:7], v[120:123]
s_waitcnt vmcnt(4)
s_atomic_add s45, s[20:21], s57 offset:184
v_mfma_f32_16x16x32_bf16 v[116:119], v[20:23], a[0:3], v[116:119]
ds_read_b128 v[16:19], v6 offset:61440
v_mul_f32 v160, v208, v160
v_mfma_f32_16x16x32_bf16 v[124:127], v[20:23], a[4:7], v[124:127]
v_rcp_f32 v209, v209
v_mul_f32 v215, v167, v167
v_fma_f32 v214, v214, v73, v72
v_mfma_f32_16x16x32_bf16 v[80:83], v[24:27], a[8:11], v[80:83]
ds_read_b128 v[20:23], v6 offset:62464
v_mul_f32 v213, v213, v165
v_mfma_f32_16x16x32_bf16 v[88:91], v[24:27], a[12:15], v[88:91]
v_fma_f32 v211, v211, v74, v74
s_waitcnt lgkmcnt(4)
v_mfma_f32_16x16x32_bf16 v[84:87], v[28:31], a[8:11], v[84:87]
ds_read_b128 v[24:27], v6 offset:63488
v_mul_f32 v161, v209, v161
v_mfma_f32_16x16x32_bf16 v[92:95], v[28:31], a[12:15], v[92:95]
v_exp_f32 v212, v212
v_rcp_f32 v210, v210
v_mfma_f32_16x16x32_bf16 v[96:99], v[32:35], a[8:11], v[96:99]
ds_read_b128 v[28:31], v6 offset:64512
v_mul_f32 v208, v168, v168
v_mfma_f32_16x16x32_bf16 v[104:107], v[32:35], a[12:15], v[104:107]
v_exp_f32 v213, v213
v_mfma_f32_16x16x32_bf16 v[100:103], v[36:39], a[8:11], v[100:103]
s_barrier
ds_read_b128 v[32:35], v7 offset:0
v_mfma_f32_16x16x32_bf16 v[108:111], v[36:39], a[12:15], v[108:111]
v_fma_f32 v215, v215, v73, v72
v_mul_f32 v214, v214, v166
v_fma_f32 v212, v212, v74, v74
s_waitcnt lgkmcnt(4)
v_mfma_f32_16x16x32_bf16 v[112:115], v[40:43], a[8:11], v[112:115]
ds_read_b128 v[36:39], v7 offset:1024
v_mul_f32 v162, v210, v162
v_mfma_f32_16x16x32_bf16 v[120:123], v[40:43], a[12:15], v[120:123]
v_rcp_f32 v211, v211
v_cvt_pk_bf16_f32 v248, v160, v161
v_mfma_f32_16x16x32_bf16 v[116:119], v[44:47], a[8:11], v[116:119]
ds_read_b128 v[40:43], v7 offset:2048
v_mul_f32 v209, v169, v169
v_mfma_f32_16x16x32_bf16 v[124:127], v[44:47], a[12:15], v[124:127]
v_exp_f32 v214, v214
v_mfma_f32_16x16x32_bf16 v[80:83], v[16:19], a[16:19], v[80:83]
ds_read_b128 v[44:47], v7 offset:3072
v_fma_f32 v208, v208, v76, v75
v_mfma_f32_16x16x32_bf16 v[88:91], v[16:19], a[20:23], v[88:91]
v_mul_f32 v215, v215, v167
v_fma_f32 v213, v213, v74, v74
s_waitcnt lgkmcnt(4)
v_mfma_f32_16x16x32_bf16 v[84:87], v[20:23], a[16:19], v[84:87]
s_barrier
ds_read_b128 v[16:19], v7 offset:4096
v_mfma_f32_16x16x32_bf16 v[92:95], v[20:23], a[20:23], v[92:95]
s_add_u32 m0, s43, 49152
v_add_u32 v4, 16384, v4
v_rcp_f32 v212, v212
v_mul_f32 v163, v211, v163
v_mul_f32 v210, v170, v170
v_mfma_f32_16x16x32_bf16 v[96:99], v[24:27], a[16:19], v[96:99]
ds_read_b128 v[20:23], v7 offset:5120
global_load_lds_dwordx4 v4, s[20:21] offset:0 sc1
v_mfma_f32_16x16x32_bf16 v[104:107], v[24:27], a[20:23], v[104:107]
global_load_lds_dwordx4 v4, s[20:21] offset:1024 sc1
global_load_lds_dwordx4 v4, s[20:21] offset:2048 sc1
v_fma_f32 v209, v209, v76, v75
v_mul_f32 v208, v208, v168
v_mfma_f32_16x16x32_bf16 v[100:103], v[28:31], a[16:19], v[100:103]
ds_read_b128 v[24:27], v7 offset:6144
global_load_lds_dwordx4 v4, s[20:21] offset:3072 sc1
v_mfma_f32_16x16x32_bf16 v[108:111], v[28:31], a[20:23], v[108:111]
v_fma_f32 v214, v214, v74, v74
v_exp_f32 v215, v215
v_rcp_f32 v213, v213
s_waitcnt lgkmcnt(4)
v_mfma_f32_16x16x32_bf16 v[112:115], v[32:35], a[16:19], v[112:115]
ds_read_b128 v[28:31], v7 offset:7168
v_mul_f32 v164, v212, v164
v_mfma_f32_16x16x32_bf16 v[120:123], v[32:35], a[20:23], v[120:123]
v_cvt_pk_bf16_f32 v249, v162, v163
v_mul_f32 v211, v171, v171
v_mfma_f32_16x16x32_bf16 v[116:119], v[36:39], a[16:19], v[116:119]
ds_read_b128 v[32:35], v7 offset:8192
v_fma_f32 v210, v210, v76, v75
v_mfma_f32_16x16x32_bf16 v[124:127], v[36:39], a[20:23], v[124:127]
v_exp_f32 v208, v208
v_mul_f32 v209, v209, v169
v_mfma_f32_16x16x32_bf16 v[80:83], v[40:43], a[24:27], v[80:83]
ds_read_b128 v[36:39], v7 offset:9216
v_fma_f32 v215, v215, v74, v74
v_mfma_f32_16x16x32_bf16 v[88:91], v[40:43], a[28:31], v[88:91]
v_mul_f32 v165, v213, v165
s_waitcnt lgkmcnt(4)
v_mfma_f32_16x16x32_bf16 v[84:87], v[44:47], a[24:27], v[84:87]
ds_read_b128 v[40:43], v7 offset:10240
v_mul_f32 v212, v172, v172
v_mfma_f32_16x16x32_bf16 v[92:95], v[44:47], a[28:31], v[92:95]
v_rcp_f32 v214, v214
v_fma_f32 v211, v211, v76, v75
v_mfma_f32_16x16x32_bf16 v[96:99], v[16:19], a[24:27], v[96:99]
ds_read_b128 v[44:47], v7 offset:11264
v_mul_f32 v210, v210, v170
v_mfma_f32_16x16x32_bf16 v[104:107], v[16:19], a[28:31], v[104:107]
v_exp_f32 v209, v209
v_fma_f32 v208, v208, v77, v77
v_mfma_f32_16x16x32_bf16 v[100:103], v[20:23], a[24:27], v[100:103]
v_rcp_f32 v215, v215
v_mfma_f32_16x16x32_bf16 v[108:111], v[20:23], a[28:31], v[108:111]
ds_read_b128 v[16:19], v7 offset:12288
v_mul_f32 v166, v214, v166
s_waitcnt lgkmcnt(4)
v_mfma_f32_16x16x32_bf16 v[112:115], v[24:27], a[24:27], v[112:115]
ds_read_b128 v[20:23], v7 offset:13312
v_cvt_pk_bf16_f32 v250, v164, v165
v_mfma_f32_16x16x32_bf16 v[120:123], v[24:27], a[28:31], v[120:123]
v_exp_f32 v210, v210
v_mul_f32 v213, v173, v173
v_mfma_f32_16x16x32_bf16 v[116:119], v[28:31], a[24:27], v[116:119]
ds_read_b128 v[24:27], v7 offset:14336
v_fma_f32 v212, v212, v76, v75
v_mfma_f32_16x16x32_bf16 v[124:127], v[28:31], a[28:31], v[124:127]
v_rcp_f32 v208, v208
v_mfma_f32_16x16x32_bf16 v[80:83], v[32:35], a[32:35], v[80:83]
ds_read_b128 v[28:31], v7 offset:15360
v_mul_f32 v211, v211, v171
v_mfma_f32_16x16x32_bf16 v[88:91], v[32:35], a[36:39], v[88:91]
v_fma_f32 v209, v209, v77, v77
v_mul_f32 v167, v215, v167
s_waitcnt lgkmcnt(4)
v_mfma_f32_16x16x32_bf16 v[84:87], v[36:39], a[32:35], v[84:87]
s_barrier
ds_read_b128 v[32:35], v7 offset:16384
v_mfma_f32_16x16x32_bf16 v[92:95], v[36:39], a[36:39], v[92:95]
v_exp_f32 v211, v211
v_mul_f32 v214, v174, v174
v_fma_f32 v213, v213, v76, v75
v_mfma_f32_16x16x32_bf16 v[96:99], v[40:43], a[32:35], v[96:99]
ds_read_b128 v[36:39], v7 offset:17408
v_mfma_f32_16x16x32_bf16 v[104:107], v[40:43], a[36:39], v[104:107]
s_atomic_add s58, s[20:21], s57 offset:184 glc
v_mul_f32 v212, v212, v172
v_mfma_f32_16x16x32_bf16 v[100:103], v[44:47], a[32:35], v[100:103]
ds_read_b128 v[40:43], v7 offset:18432
v_fma_f32 v210, v210, v77, v77
v_mfma_f32_16x16x32_bf16 v[108:111], v[44:47], a[36:39], v[108:111]
v_mul_f32 v168, v208, v168
v_rcp_f32 v209, v209
s_waitcnt lgkmcnt(4)
v_mfma_f32_16x16x32_bf16 v[112:115], v[16:19], a[32:35], v[112:115]
ds_read_b128 v[44:47], v7 offset:19456
s_getpc_b64 s[4:5]
v_mfma_f32_16x16x32_bf16 v[120:123], v[16:19], a[36:39], v[120:123]
global_load_dword v13, v12, s[4:5]
v_cvt_pk_bf16_f32 v251, v166, v167
v_mul_f32 v215, v175, v175
v_fma_f32 v214, v214, v76, v75
v_mfma_f32_16x16x32_bf16 v[116:119], v[20:23], a[32:35], v[116:119]
ds_read_b128 v[16:19], v7 offset:20480
v_mul_f32 v213, v213, v173
v_mfma_f32_16x16x32_bf16 v[124:127], v[20:23], a[36:39], v[124:127]
v_exp_f32 v212, v212
v_mfma_f32_16x16x32_bf16 v[80:83], v[24:27], a[40:43], v[80:83]
ds_read_b128 v[20:23], v7 offset:21504
v_fma_f32 v211, v211, v77, v77
v_mfma_f32_16x16x32_bf16 v[88:91], v[24:27], a[44:47], v[88:91]
v_mul_f32 v169, v209, v169
v_rcp_f32 v210, v210
s_waitcnt lgkmcnt(4)
v_mfma_f32_16x16x32_bf16 v[84:87], v[28:31], a[40:43], v[84:87]
s_barrier
ds_read_b128 v[24:27], v7 offset:22528
v_mfma_f32_16x16x32_bf16 v[92:95], v[28:31], a[44:47], v[92:95]
s_add_u32 m0, s43, 65536
v_add_u32 v4, 16384, v4
v_fma_f32 v215, v215, v76, v75
v_mul_f32 v214, v214, v174
v_mfma_f32_16x16x32_bf16 v[96:99], v[32:35], a[40:43], v[96:99]
ds_read_b128 v[28:31], v7 offset:23552
global_load_lds_dwordx4 v4, s[20:21] offset:0 sc1
v_mfma_f32_16x16x32_bf16 v[104:107], v[32:35], a[44:47], v[104:107]
global_load_lds_dwordx4 v4, s[20:21] offset:1024 sc1
global_load_lds_dwordx4 v4, s[20:21] offset:2048 sc1
v_exp_f32 v213, v213
v_fma_f32 v212, v212, v77, v77
v_rcp_f32 v211, v211
v_mfma_f32_16x16x32_bf16 v[100:103], v[36:39], a[40:43], v[100:103]
ds_read_b128 v[32:35], v7 offset:24576
global_load_lds_dwordx4 v4, s[20:21] offset:3072 sc1
v_mfma_f32_16x16x32_bf16 v[108:111], v[36:39], a[44:47], v[108:111]
v_mul_f32 v170, v210, v170
v_cvt_pk_bf16_f32 v252, v168, v169
v_mul_f32 v215, v215, v175
s_waitcnt lgkmcnt(4)
v_mfma_f32_16x16x32_bf16 v[112:115], v[40:43], a[40:43], v[112:115]
ds_read_b128 v[36:39], v7 offset:25600
v_fma_f32 v213, v213, v77, v77
v_mfma_f32_16x16x32_bf16 v[120:123], v[40:43], a[44:47], v[120:123]
v_exp_f32 v214, v214
v_mfma_f32_16x16x32_bf16 v[116:119], v[44:47], a[40:43], v[116:119]
ds_read_b128 v[40:43], v7 offset:26624
v_mul_f32 v171, v211, v171
v_mfma_f32_16x16x32_bf16 v[124:127], v[44:47], a[44:47], v[124:127]
v_rcp_f32 v212, v212
v_mfma_f32_16x16x32_bf16 v[80:83], v[16:19], a[48:51], v[80:83]
v_exp_f32 v215, v215
v_mfma_f32_16x16x32_bf16 v[88:91], v[16:19], a[52:55], v[88:91]
ds_read_b128 v[44:47], v7 offset:27648
v_fma_f32 v214, v214, v77, v77
s_waitcnt lgkmcnt(4)
v_mfma_f32_16x16x32_bf16 v[84:87], v[20:23], a[48:51], v[84:87]
ds_read_b128 v[16:19], v7 offset:28672
v_mul_f32 v172, v212, v172
v_mfma_f32_16x16x32_bf16 v[92:95], v[20:23], a[52:55], v[92:95]
v_rcp_f32 v213, v213
v_cvt_pk_bf16_f32 v253, v170, v171
v_fma_f32 v215, v215, v77, v77
v_mfma_f32_16x16x32_bf16 v[96:99], v[24:27], a[48:51], v[96:99]
ds_read_b128 v[20:23], v7 offset:29696
v_mul_f32 v173, v213, v173
v_mfma_f32_16x16x32_bf16 v[104:107], v[24:27], a[52:55], v[104:107]
v_rcp_f32 v214, v214
v_mfma_f32_16x16x32_bf16 v[100:103], v[28:31], a[48:51], v[100:103]
v_rcp_f32 v215, v215
v_mfma_f32_16x16x32_bf16 v[108:111], v[28:31], a[52:55], v[108:111]
ds_read_b128 v[24:27], v7 offset:30720
v_mul_f32 v174, v214, v174
s_waitcnt lgkmcnt(4)
v_mfma_f32_16x16x32_bf16 v[112:115], v[32:35], a[48:51], v[112:115]
ds_read_b128 v[28:31], v7 offset:31744
v_cvt_pk_bf16_f32 v254, v172, v173
v_mfma_f32_16x16x32_bf16 v[120:123], v[32:35], a[52:55], v[120:123]
v_mul_f32 v175, v215, v175
v_cvt_pk_bf16_f32 v255, v174, v175
s_add_u32 s37, s47, 55590912
v_mfma_f32_16x16x32_bf16 v[116:119], v[36:39], a[48:51], v[116:119]
s_barrier
ds_read_b128 v[32:35], v7 offset:32768
buffer_store_dwordx4 v[248:251], v0, s[20:23], s37 offen offset:0 sc1
buffer_store_dwordx4 v[252:255], v0, s[20:23], s37 offen offset:1024 sc1
v_mfma_f32_16x16x32_bf16 v[124:127], v[36:39], a[52:55], v[124:127]
s_mov_b32 s59, 0
v_mul_f32 v208, v176, v176
v_mfma_f32_16x16x32_bf16 v[80:83], v[40:43], a[56:59], v[80:83]
ds_read_b128 v[36:39], v7 offset:33792
v_mul_f32 v209, v177, v177
v_mfma_f32_16x16x32_bf16 v[88:91], v[40:43], a[60:63], v[88:91]
v_fma_f32 v208, v208, v73, v72
v_mul_f32 v210, v178, v178
s_waitcnt lgkmcnt(4)
v_mfma_f32_16x16x32_bf16 v[84:87], v[44:47], a[56:59], v[84:87]
ds_read_b128 v[40:43], v7 offset:34816
v_fma_f32 v209, v209, v73, v72
v_mfma_f32_16x16x32_bf16 v[92:95], v[44:47], a[60:63], v[92:95]
v_mul_f32 v208, v208, v176
v_mul_f32 v211, v179, v179
v_mfma_f32_16x16x32_bf16 v[96:99], v[16:19], a[56:59], v[96:99]
ds_read_b128 v[44:47], v7 offset:35840
v_mfma_f32_16x16x32_bf16 v[104:107], v[16:19], a[60:63], v[104:107]
s_cmp_lt_u32 s58, 8
s_cbranch_scc0 L_back23
L_slow23:
s_waitcnt lgkmcnt(0)
s_cmp_ge_u32 s58, 8
s_cbranch_scc1 L_back23
s_mov_b32 s58, 0
s_atomic_add s58, s[20:21], s57 offset:184 glc
s_sub_u32 s46, s46, 1
s_cbranch_scc0 L_slow23
s_endpgm
L_back23:
v_fma_f32 v210, v210, v73, v72
v_mfma_f32_16x16x32_bf16 v[100:103], v[20:23], a[56:59], v[100:103]
ds_read_b128 v[16:19], v7 offset:36864
v_add_u32 v5, 55578624, v15
v_mfma_f32_16x16x32_bf16 v[108:111], v[20:23], a[60:63], v[108:111]
global_load_dwordx4 a[192:195], v5, s[20:21] offset:-4096 sc1
v_mul_f32 v209, v209, v177
v_exp_f32 v208, v208
v_mul_f32 v212, v180, v180
s_waitcnt lgkmcnt(3)
v_mfma_f32_16x16x32_bf16 v[112:115], v[24:27], a[56:59], v[112:115]
ds_read_b128 v[20:23], v7 offset:37888
global_load_dwordx4 a[196:199], v5, s[20:21] offset:-3072 sc1
v_mfma_f32_16x16x32_bf16 v[120:123], v[24:27], a[60:63], v[120:123]
global_load_dwordx4 a[200:203], v5, s[20:21] offset:-2048 sc1
global_load_dwordx4 a[204:207], v5, s[20:21] offset:-1024 sc1
v_fma_f32 v211, v211, v73, v72
v_mul_f32 v210, v210, v178
v_mfma_f32_16x16x32_bf16 v[116:119], v[28:31], a[56:59], v[116:119]
ds_read_b128 v[24:27], v7 offset:38912
global_load_dwordx4 a[208:211], v5, s[20:21] offset:0 sc1
v_mfma_f32_16x16x32_bf16 v[124:127], v[28:31], a[60:63], v[124:127]
global_load_dwordx4 a[212:215], v5, s[20:21] offset:1024 sc1
v_fma_f32 v208, v208, v74, v74
v_exp_f32 v209, v209
v_mul_f32 v213, v181, v181
v_fma_f32 v212, v212, v73, v72
v_mfma_f32_16x16x32_bf16 v[80:83], v[32:35], a[64:67], v[80:83]
ds_read_b128 v[28:31], v7 offset:39936
v_mul_f32 v211, v211, v179
v_mfma_f32_16x16x32_bf16 v[88:91], v[32:35], a[68:71], v[88:91]
v_exp_f32 v210, v210
v_mfma_f32_16x16x32_bf16 v[84:87], v[36:39], a[64:67], v[84:87]
ds_read_b128 v[32:35], v7 offset:40960
global_load_dwordx4 a[216:219], v5, s[20:21] offset:2048 sc1
v_mfma_f32_16x16x32_bf16 v[92:95], v[36:39], a[68:71], v[92:95]
v_fma_f32 v209, v209, v74, v74
v_rcp_f32 v208, v208
s_waitcnt lgkmcnt(3)
v_mfma_f32_16x16x32_bf16 v[96:99], v[40:43], a[64:67], v[96:99]
ds_read_b128 v[36:39], v7 offset:41984
v_mul_f32 v214, v182, v182
v_mfma_f32_16x16x32_bf16 v[104:107], v[40:43], a[68:71], v[104:107]
v_exp_f32 v211, v211
v_fma_f32 v213, v213, v73, v72
v_mfma_f32_16x16x32_bf16 v[100:103], v[44:47], a[64:67], v[100:103]
ds_read_b128 v[40:43], v7 offset:43008
global_load_dwordx4 a[220:223], v5, s[20:21] offset:3072 sc1
v_mfma_f32_16x16x32_bf16 v[108:111], v[44:47], a[68:71], v[108:111]
v_rcp_f32 v209, v209
v_mul_f32 v212, v212, v180
v_mfma_f32_16x16x32_bf16 v[112:115], v[16:19], a[64:67], v[112:115]
ds_read_b128 v[44:47], v7 offset:44032
v_fma_f32 v210, v210, v74, v74
v_mfma_f32_16x16x32_bf16 v[120:123], v[16:19], a[68:71], v[120:123]
v_mul_f32 v176, v208, v176
v_mul_f32 v215, v183, v183
v_fma_f32 v214, v214, v73, v72
v_mfma_f32_16x16x32_bf16 v[116:119], v[20:23], a[64:67], v[116:119]
ds_read_b128 v[16:19], v7 offset:45056
v_add_u32 v5, 8192, v5
v_mfma_f32_16x16x32_bf16 v[124:127], v[20:23], a[68:71], v[124:127]
global_load_dwordx4 a[224:227], v5, s[20:21] offset:-4096 sc1
v_mul_f32 v213, v213, v181
v_exp_f32 v212, v212
s_waitcnt lgkmcnt(3)
v_mfma_f32_16x16x32_bf16 v[80:83], v[24:27], a[72:75], v[80:83]
ds_read_b128 v[20:23], v7 offset:46080
v_fma_f32 v211, v211, v74, v74
v_mfma_f32_16x16x32_bf16 v[88:91], v[24:27], a[76:79], v[88:91]
v_rcp_f32 v210, v210
v_mfma_f32_16x16x32_bf16 v[84:87], v[28:31], a[72:75], v[84:87]
ds_read_b128 v[24:27], v7 offset:47104
global_load_dwordx4 a[228:231], v5, s[20:21] offset:-3072 sc1
v_mfma_f32_16x16x32_bf16 v[92:95], v[28:31], a[76:79], v[92:95]
v_mul_f32 v177, v209, v177
v_mul_f32 v208, v184, v184
v_fma_f32 v215, v215, v73, v72
v_mul_f32 v214, v214, v182
v_mfma_f32_16x16x32_bf16 v[96:99], v[32:35], a[72:75], v[96:99]
ds_read_b128 v[28:31], v7 offset:48128
v_fma_f32 v212, v212, v74, v74
v_mfma_f32_16x16x32_bf16 v[104:107], v[32:35], a[76:79], v[104:107]
v_exp_f32 v213, v213
v_mfma_f32_16x16x32_bf16 v[100:103], v[36:39], a[72:75], v[100:103]
s_barrier
ds_read_b128 v[32:35], v7 offset:49152
v_mfma_f32_16x16x32_bf16 v[108:111], v[36:39], a[76:79], v[108:111]
global_load_dwordx4 a[232:235], v5, s[20:21] offset:-2048 sc1
v_rcp_f32 v211, v211
v_mul_f32 v178, v210, v178
v_cvt_pk_bf16_f32 v240, v176, v177
s_waitcnt lgkmcnt(3)
v_mfma_f32_16x16x32_bf16 v[112:115], v[40:43], a[72:75], v[112:115]
ds_read_b128 v[36:39], v7 offset:50176
s_add_u32 m0, s43, 81920
v_mfma_f32_16x16x32_bf16 v[120:123], v[40:43], a[76:79], v[120:123]
v_add_u32 v4, 16384, v4
v_mul_f32 v209, v185, v185
v_fma_f32 v208, v208, v76, v75
v_mul_f32 v215, v215, v183
v_mfma_f32_16x16x32_bf16 v[116:119], v[44:47], a[72:75], v[116:119]
ds_read_b128 v[40:43], v7 offset:51200
global_load_lds_dwordx4 v4, s[20:21] offset:0 sc1
v_mfma_f32_16x16x32_bf16 v[124:127], v[44:47], a[76:79], v[124:127]
v_exp_f32 v214, v214
v_fma_f32 v213, v213, v74, v74
v_mfma_f32_16x16x32_bf16 v[80:83], v[16:19], a[80:83], v[80:83]
ds_read_b128 v[44:47], v7 offset:52224
global_load_lds_dwordx4 v4, s[20:21] offset:1024 sc1
v_mfma_f32_16x16x32_bf16 v[88:91], v[16:19], a[84:87], v[88:91]
s_waitcnt vmcnt(13)
s_atomic_add s45, s[20:21], s57 offset:192
v_rcp_f32 v212, v212
v_mfma_f32_16x16x32_bf16 v[84:87], v[20:23], a[80:83], v[84:87]
ds_read_b128 v[16:19], v7 offset:53248
v_mul_f32 v179, v211, v179
v_mfma_f32_16x16x32_bf16 v[92:95], v[20:23], a[84:87], v[92:95]
v_mul_f32 v210, v186, v186
v_fma_f32 v209, v209, v76, v75
s_waitcnt lgkmcnt(4)
v_mfma_f32_16x16x32_bf16 v[96:99], v[24:27], a[80:83], v[96:99]
ds_read_b128 v[20:23], v7 offset:54272
global_load_lds_dwordx4 v4, s[20:21] offset:2048 sc1
v_mfma_f32_16x16x32_bf16 v[104:107], v[24:27], a[84:87], v[104:107]
v_exp_f32 v215, v215
v_mul_f32 v208, v208, v184
v_fma_f32 v214, v214, v74, v74
v_mfma_f32_16x16x32_bf16 v[100:103], v[28:31], a[80:83], v[100:103]
ds_read_b128 v[24:27], v7 offset:55296
v_mul_f32 v180, v212, v180
v_mfma_f32_16x16x32_bf16 v[108:111], v[28:31], a[84:87], v[108:111]
v_rcp_f32 v213, v213
v_mfma_f32_16x16x32_bf16 v[112:115], v[32:35], a[80:83], v[112:115]
ds_read_b128 v[28:31], v7 offset:56320
global_load_lds_dwordx4 v4, s[20:21] offset:3072 sc1
v_mfma_f32_16x16x32_bf16 v[120:123], v[32:35], a[84:87], v[120:123]
v_cvt_pk_bf16_f32 v241, v178, v179
v_mul_f32 v211, v187, v187
v_fma_f32 v210, v210, v76, v75
s_waitcnt lgkmcnt(4)
v_mfma_f32_16x16x32_bf16 v[116:119], v[36:39], a[80:83], v[116:119]
ds_read_b128 v[32:35], v7 offset:57344
v_mul_f32 v209, v209, v185
v_mfma_f32_16x16x32_bf16 v[124:127], v[36:39], a[84:87], v[124:127]
v_exp_f32 v208, v208
v_fma_f32 v215, v215, v74, v74
v_mfma_f32_16x16x32_bf16 v[80:83], v[40:43], a[88:91], v[80:83]
ds_read_b128 v[36:39], v7 offset:58368
global_load_dwordx4 a[236:239], v5, s[20:21] offset:-1024 sc1
v_mfma_f32_16x16x32_bf16 v[88:91], v[40:43], a[92:95], v[88:91]
v_rcp_f32 v214, v214
v_mul_f32 v181, v213, v181
v_mfma_f32_16x16x32_bf16 v[84:87], v[44:47], a[88:91], v[84:87]
ds_read_b128 v[40:43], v7 offset:59392
v_mul_f32 v212, v188, v188
v_mfma_f32_16x16x32_bf16 v[92:95], v[44:47], a[92:95], v[92:95]
v_fma_f32 v211, v211, v76, v75
v_mul_f32 v210, v210, v186
s_waitcnt lgkmcnt(4)
v_mfma_f32_16x16x32_bf16 v[96:99], v[16:19], a[88:91], v[96:99]
ds_read_b128 v[44:47], v7 offset:60416
global_load_dwordx4 a[240:243], v5, s[20:21] offset:0 sc1
v_mfma_f32_16x16x32_bf16 v[104:107], v[16:19], a[92:95], v[104:107]
v_exp_f32 v209, v209
v_fma_f32 v208, v208, v77, v77
v_mfma_f32_16x16x32_bf16 v[100:103], v[20:23], a[88:91], v[100:103]
ds_read_b128 v[16:19], v7 offset:61440
v_mul_f32 v182, v214, v182
v_mfma_f32_16x16x32_bf16 v[108:111], v[20:23], a[92:95], v[108:111]
v_rcp_f32 v215, v215
v_cvt_pk_bf16_f32 v242, v180, v181
v_mfma_f32_16x16x32_bf16 v[112:115], v[24:27], a[88:91], v[112:115]
ds_read_b128 v[20:23], v7 offset:62464
global_load_dwordx4 a[244:247], v5, s[20:21] offset:1024 sc1
v_mfma_f32_16x16x32_bf16 v[120:123], v[24:27], a[92:95], v[120:123]
v_mul_f32 v213, v189, v189
v_fma_f32 v212, v212, v76, v75
v_mul_f32 v211, v211, v187
s_waitcnt lgkmcnt(4)
v_mfma_f32_16x16x32_bf16 v[116:119], v[28:31], a[88:91], v[116:119]
ds_read_b128 v[24:27], v7 offset:63488
v_fma_f32 v209, v209, v77, v77
v_mfma_f32_16x16x32_bf16 v[124:127], v[28:31], a[92:95], v[124:127]
v_exp_f32 v210, v210
v_mfma_f32_16x16x32_bf16 v[80:83], v[32:35], a[96:99], v[80:83]
ds_read_b128 v[28:31], v7 offset:64512
global_load_dwordx4 a[248:251], v5, s[20:21] offset:2048 sc1
v_mfma_f32_16x16x32_bf16 v[88:91], v[32:35], a[100:103], v[88:91]
v_rcp_f32 v208, v208
v_mul_f32 v183, v215, v183
v_mul_f32 v214, v190, v190
v_fma_f32 v213, v213, v76, v75
v_mfma_f32_16x16x32_bf16 v[84:87], v[36:39], a[96:99], v[84:87]
s_barrier
ds_read_b128 v[32:35], v6 offset:0
v_mfma_f32_16x16x32_bf16 v[92:95], v[36:39], a[100:103], v[92:95]
v_mul_f32 v212, v212, v188
v_exp_f32 v211, v211
s_waitcnt lgkmcnt(4)
v_mfma_f32_16x16x32_bf16 v[96:99], v[40:43], a[96:99], v[96:99]
ds_read_b128 v[36:39], v6 offset:1024
s_add_u32 m0, s43, 98304
v_mfma_f32_16x16x32_bf16 v[104:107], v[40:43], a[100:103], v[104:107]
v_add_u32 v4, 16384, v4
v_fma_f32 v210, v210, v77, v77
v_rcp_f32 v209, v209
v_mfma_f32_16x16x32_bf16 v[100:103], v[44:47], a[96:99], v[100:103]
ds_read_b128 v[40:43], v6 offset:2048
global_load_lds_dwordx4 v4, s[20:21] offset:0 sc1
v_mfma_f32_16x16x32_bf16 v[108:111], v[44:47], a[100:103], v[108:111]
v_mul_f32 v184, v208, v184
v_cvt_pk_bf16_f32 v243, v182, v183
v_mul_f32 v215, v191, v191
v_fma_f32 v214, v214, v76, v75
v_mfma_f32_16x16x32_bf16 v[112:115], v[16:19], a[96:99], v[112:115]
ds_read_b128 v[44:47], v6 offset:3072
global_load_lds_dwordx4 v4, s[20:21] offset:1024 sc1
v_mfma_f32_16x16x32_bf16 v[120:123], v[16:19], a[100:103], v[120:123]
v_mul_f32 v213, v213, v189
v_exp_f32 v212, v212
s_waitcnt lgkmcnt(4)
v_mfma_f32_16x16x32_bf16 v[116:119], v[20:23], a[96:99], v[116:119]
ds_read_b128 v[16:19], v6 offset:4096
global_load_lds_dwordx4 v4, s[20:21] offset:2048 sc1
v_mfma_f32_16x16x32_bf16 v[124:127], v[20:23], a[100:103], v[124:127]
v_rcp_f32 v210, v210
v_fma_f32 v211, v211, v77, v77
v_mul_f32 v185, v209, v185
v_mfma_f32_16x16x32_bf16 v[80:83], v[24:27], a[104:107], v[80:83]
ds_read_b128 v[20:23], v6 offset:5120
v_fma_f32 v215, v215, v76, v75
v_mfma_f32_16x16x32_bf16 v[88:91], v[24:27], a[108:111], v[88:91]
v_exp_f32 v213, v213
v_mfma_f32_16x16x32_bf16 v[84:87], v[28:31], a[104:107], v[84:87]
ds_read_b128 v[24:27], v6 offset:6144
global_load_lds_dwordx4 v4, s[20:21] offset:3072 sc1
v_mfma_f32_16x16x32_bf16 v[92:95], v[28:31], a[108:111], v[92:95]
v_mul_f32 v214, v214, v190
v_fma_f32 v212, v212, v77, v77
s_waitcnt lgkmcnt(4)
v_mfma_f32_16x16x32_bf16 v[96:99], v[32:35], a[104:107], v[96:99]
ds_read_b128 v[28:31], v6 offset:7168
v_mul_f32 v186, v210, v186
v_mfma_f32_16x16x32_bf16 v[104:107], v[32:35], a[108:111], v[104:107]
v_rcp_f32 v211, v211
v_cvt_pk_bf16_f32 v244, v184, v185
v_mul_f32 v215, v215, v191
v_mfma_f32_16x16x32_bf16 v[100:103], v[36:39], a[104:107], v[100:103]
ds_read_b128 v[32:35], v6 offset:8192
global_load_dwordx4 a[252:255], v5, s[20:21] offset:3072 sc1
v_mfma_f32_16x16x32_bf16 v[108:111], v[36:39], a[108:111], v[108:111]
v_exp_f32 v214, v214
v_fma_f32 v213, v213, v77, v77
v_mfma_f32_16x16x32_bf16 v[112:115], v[40:43], a[104:107], v[112:115]
s_atomic_add s59, s[20:21], s57 offset:192 glc
v_mul_f32 v187, v211, v187
v_mfma_f32_16x16x32_bf16 v[120:123], v[40:43], a[108:111], v[120:123]
ds_read_b128 v[36:39], v6 offset:9216
s_waitcnt lgkmcnt(4)
v_mfma_f32_16x16x32_bf16 v[116:119], v[44:47], a[104:107], v[116:119]
ds_read_b128 v[40:43], v6 offset:10240
v_fma_f32 v214, v214, v77, v77
v_mfma_f32_16x16x32_bf16 v[124:127], v[44:47], a[108:111], v[124:127]
v_rcp_f32 v212, v212
v_mfma_f32_16x16x32_bf16 v[80:83], v[16:19], a[112:115], v[80:83]
ds_read_b128 v[44:47], v6 offset:11264
v_mul_f32 v188, v212, v188
v_mfma_f32_16x16x32_bf16 v[88:91], v[16:19], a[116:119], v[88:91]
v_exp_f32 v215, v215
v_mfma_f32_16x16x32_bf16 v[84:87], v[20:23], a[112:115], v[84:87]
v_rcp_f32 v213, v213
v_mfma_f32_16x16x32_bf16 v[92:95], v[20:23], a[116:119], v[92:95]
ds_read_b128 v[16:19], v6 offset:12288
v_cvt_pk_bf16_f32 v245, v186, v187
v_fma_f32 v215, v215, v77, v77
s_waitcnt lgkmcnt(4)
v_mfma_f32_16x16x32_bf16 v[96:99], v[24:27], a[112:115], v[96:99]
ds_read_b128 v[20:23], v6 offset:13312
v_mul_f32 v189, v213, v189
v_mfma_f32_16x16x32_bf16 v[104:107], v[24:27], a[116:119], v[104:107]
v_rcp_f32 v214, v214
v_mfma_f32_16x16x32_bf16 v[100:103], v[28:31], a[112:115], v[100:103]
ds_read_b128 v[24:27], v6 offset:14336
v_mul_f32 v190, v214, v190
v_mfma_f32_16x16x32_bf16 v[108:111], v[28:31], a[116:119], v[108:111]
v_rcp_f32 v215, v215
v_cvt_pk_bf16_f32 v246, v188, v189
v_mul_f32 v191, v215, v191
v_mfma_f32_16x16x32_bf16 v[112:115], v[32:35], a[112:115], v[112:115]
ds_read_b128 v[28:31], v6 offset:15360
v_cvt_pk_bf16_f32 v247, v190, v191
v_mfma_f32_16x16x32_bf16 v[120:123], v[32:35], a[116:119], v[120:123]
s_add_u32 s38, s47, 55607296
s_waitcnt lgkmcnt(4)
v_mfma_f32_16x16x32_bf16 v[116:119], v[36:39], a[112:115], v[116:119]
s_barrier
ds_read_b128 v[32:35], v6 offset:16384
buffer_store_dwordx4 v[240:243], v0, s[20:23], s38 offen offset:0 sc1
buffer_store_dwordx4 v[244:247], v0, s[20:23], s38 offen offset:1024 sc1
v_mfma_f32_16x16x32_bf16 v[124:127], v[36:39], a[116:119], v[124:127]
s_add_u32 m0, s43, 114688
v_add_u32 v4, 16384, v4
s_mov_b32 s58, 0
v_mul_f32 v208, v192, v192
v_mfma_f32_16x16x32_bf16 v[80:83], v[40:43], a[120:123], v[80:83]
ds_read_b128 v[36:39], v6 offset:17408
global_load_lds_dwordx4 v4, s[20:21] offset:0 sc1
v_mfma_f32_16x16x32_bf16 v[88:91], v[40:43], a[124:127], v[88:91]
v_mul_f32 v209, v193, v193
v_fma_f32 v208, v208, v73, v72
v_mul_f32 v210, v194, v194
v_fma_f32 v209, v209, v73, v72
v_mfma_f32_16x16x32_bf16 v[84:87], v[44:47], a[120:123], v[84:87]
ds_read_b128 v[40:43], v6 offset:18432
v_mul_f32 v208, v208, v192
v_mfma_f32_16x16x32_bf16 v[92:95], v[44:47], a[124:127], v[92:95]
v_mul_f32 v211, v195, v195
v_fma_f32 v210, v210, v73, v72
s_waitcnt lgkmcnt(4)
v_mfma_f32_16x16x32_bf16 v[96:99], v[16:19], a[120:123], v[96:99]
ds_read_b128 v[44:47], v6 offset:19456
v_mul_f32 v209, v209, v193
v_mfma_f32_16x16x32_bf16 v[104:107], v[16:19], a[124:127], v[104:107]
v_exp_f32 v208, v208
v_mul_f32 v212, v196, v196
v_mfma_f32_16x16x32_bf16 v[100:103], v[20:23], a[120:123], v[100:103]
ds_read_b128 v[16:19], v6 offset:20480
global_load_lds_dwordx4 v4, s[20:21] offset:1024 sc1
v_mfma_f32_16x16x32_bf16 v[108:111], v[20:23], a[124:127], v[108:111]
v_exp_f32 v209, v209
v_fma_f32 v211, v211, v73, v72
v_mfma_f32_16x16x32_bf16 v[112:115], v[24:27], a[120:123], v[112:115]
ds_read_b128 v[20:23], v6 offset:21504
v_mul_f32 v210, v210, v194
v_mfma_f32_16x16x32_bf16 v[120:123], v[24:27], a[124:127], v[120:123]
v_fma_f32 v208, v208, v74, v74
v_mul_f32 v213, v197, v197
s_waitcnt lgkmcnt(4)
v_mfma_f32_16x16x32_bf16 v[116:119], v[28:31], a[120:123], v[116:119]
ds_read_b128 v[24:27], v6 offset:22528
global_load_lds_dwordx4 v4, s[20:21] offset:2048 sc1
v_mfma_f32_16x16x32_bf16 v[124:127], v[28:31], a[124:127], v[124:127]
v_exp_f32 v210, v210
v_fma_f32 v212, v212, v73, v72
v_mul_f32 v211, v211, v195
v_mfma_f32_16x16x32_bf16 v[80:83], v[32:35], a[128:131], v[80:83]
ds_read_b128 v[28:31], v6 offset:23552
v_fma_f32 v209, v209, v74, v74
v_mfma_f32_16x16x32_bf16 v[88:91], v[32:35], a[132:135], v[88:91]
v_rcp_f32 v208, v208
v_mfma_f32_16x16x32_bf16 v[84:87], v[36:39], a[128:131], v[84:87]
ds_read_b128 v[32:35], v6 offset:24576
global_load_lds_dwordx4 v4, s[20:21] offset:3072 sc1
v_mfma_f32_16x16x32_bf16 v[92:95], v[36:39], a[132:135], v[92:95]
v_mul_f32 v214, v198, v198
v_fma_f32 v213, v213, v73, v72
v_mul_f32 v212, v212, v196
s_waitcnt lgkmcnt(4)
v_mfma_f32_16x16x32_bf16 v[96:99], v[40:43], a[128:131], v[96:99]
ds_read_b128 v[36:39], v6 offset:25600
v_fma_f32 v210, v210, v74, v74
v_mfma_f32_16x16x32_bf16 v[104:107], v[40:43], a[132:135], v[104:107]
v_exp_f32 v211, v211
v_mfma_f32_16x16x32_bf16 v[100:103], v[44:47], a[128:131], v[100:103]
ds_read_b128 v[40:43], v6 offset:26624
v_mul_f32 v192, v208, v192
v_mfma_f32_16x16x32_bf16 v[108:111], v[44:47], a[132:135], v[108:111]
v_rcp_f32 v209, v209
v_mul_f32 v215, v199, v199
v_mfma_f32_16x16x32_bf16 v[112:115], v[16:19], a[128:131], v[112:115]
s_cmp_lt_u32 s59, 8
s_cbranch_scc0 L_back24
L_slow24:
s_waitcnt lgkmcnt(0)
s_cmp_ge_u32 s59, 8
s_cbranch_scc1 L_back24
s_mov_b32 s59, 0
s_atomic_add s59, s[20:21], s57 offset:192 glc
s_sub_u32 s46, s46, 1
s_cbranch_scc0 L_slow24
s_endpgm
L_back24:
v_mfma_f32_16x16x32_bf16 v[120:123], v[16:19], a[132:135], v[120:123]
ds_read_b128 v[44:47], v6 offset:27648
v_fma_f32 v214, v214, v73, v72
v_mul_f32 v213, v213, v197
s_waitcnt lgkmcnt(3)
v_mfma_f32_16x16x32_bf16 v[116:119], v[20:23], a[128:131], v[116:119]
ds_read_b128 v[16:19], v6 offset:28672
v_add_u32 v5, 8192, v5
v_mfma_f32_16x16x32_bf16 v[124:127], v[20:23], a[132:135], v[124:127]
global_load_dwordx4 a[0:3], v5, s[20:21] offset:-4096 sc1
global_load_dwordx4 a[4:7], v5, s[20:21] offset:-3072 sc1
v_exp_f32 v212, v212
v_fma_f32 v211, v211, v74, v74
v_mfma_f32_16x16x32_bf16 v[80:83], v[24:27], a[136:139], v[80:83]
ds_read_b128 v[20:23], v6 offset:29696
v_mul_f32 v193, v209, v193
v_mfma_f32_16x16x32_bf16 v[88:91], v[24:27], a[140:143], v[88:91]
v_rcp_f32 v210, v210
v_mul_f32 v208, v200, v200
v_mfma_f32_16x16x32_bf16 v[84:87], v[28:31], a[136:139], v[84:87]
ds_read_b128 v[24:27], v6 offset:30720
global_load_dwordx4 a[8:11], v5, s[20:21] offset:-2048 sc1
v_mfma_f32_16x16x32_bf16 v[92:95], v[28:31], a[140:143], v[92:95]
v_exp_f32 v213, v213
v_fma_f32 v215, v215, v73, v72
v_mfma_f32_16x16x32_bf16 v[96:99], v[32:35], a[136:139], v[96:99]
ds_read_b128 v[28:31], v6 offset:31744
v_mul_f32 v214, v214, v198
v_mfma_f32_16x16x32_bf16 v[104:107], v[32:35], a[140:143], v[104:107]
v_fma_f32 v212, v212, v74, v74
s_waitcnt lgkmcnt(3)
v_mfma_f32_16x16x32_bf16 v[100:103], v[36:39], a[136:139], v[100:103]
s_barrier
ds_read_b128 v[32:35], v6 offset:32768
v_mfma_f32_16x16x32_bf16 v[108:111], v[36:39], a[140:143], v[108:111]
global_load_dwordx4 a[12:15], v5, s[20:21] offset:-1024 sc1
v_mul_f32 v194, v210, v194
v_rcp_f32 v211, v211
v_cvt_pk_bf16_f32 v248, v192, v193
v_mul_f32 v209, v201, v201
v_mfma_f32_16x16x32_bf16 v[112:115], v[40:43], a[136:139], v[112:115]
ds_read_b128 v[36:39], v6 offset:33792
s_add_u32 m0, s43, 0
v_mfma_f32_16x16x32_bf16 v[120:123], v[40:43], a[140:143], v[120:123]
v_add_u32 v4, 16384, v4
v_fma_f32 v208, v208, v76, v75
v_mul_f32 v215, v215, v199
v_mfma_f32_16x16x32_bf16 v[116:119], v[44:47], a[136:139], v[116:119]
ds_read_b128 v[40:43], v6 offset:34816
global_load_lds_dwordx4 v4, s[20:21] offset:0 sc1
v_mfma_f32_16x16x32_bf16 v[124:127], v[44:47], a[140:143], v[124:127]
v_exp_f32 v214, v214
v_fma_f32 v213, v213, v74, v74
v_rcp_f32 v212, v212
v_mfma_f32_16x16x32_bf16 v[80:83], v[16:19], a[144:147], v[80:83]
ds_read_b128 v[44:47], v6 offset:35840
global_load_lds_dwordx4 v4, s[20:21] offset:1024 sc1
v_mfma_f32_16x16x32_bf16 v[88:91], v[16:19], a[148:151], v[88:91]
s_waitcnt vmcnt(10)
s_atomic_add s45, s[20:21], s57 offset:200
v_mul_f32 v195, v211, v195
s_waitcnt lgkmcnt(4)
v_mfma_f32_16x16x32_bf16 v[84:87], v[20:23], a[144:147], v[84:87]
ds_read_b128 v[16:19], v6 offset:36864
v_mul_f32 v210, v202, v202
v_mfma_f32_16x16x32_bf16 v[92:95], v[20:23], a[148:151], v[92:95]
v_exp_f32 v215, v215
v_mfma_f32_16x16x32_bf16 v[96:99], v[24:27], a[144:147], v[96:99]
ds_read_b128 v[20:23], v6 offset:37888
global_load_lds_dwordx4 v4, s[20:21] offset:2048 sc1
v_mfma_f32_16x16x32_bf16 v[104:107], v[24:27], a[148:151], v[104:107]
v_rcp_f32 v213, v213
v_fma_f32 v209, v209, v76, v75
v_mul_f32 v208, v208, v200
v_mfma_f32_16x16x32_bf16 v[100:103], v[28:31], a[144:147], v[100:103]
ds_read_b128 v[24:27], v6 offset:38912
v_fma_f32 v214, v214, v74, v74
v_mfma_f32_16x16x32_bf16 v[108:111], v[28:31], a[148:151], v[108:111]
v_mul_f32 v196, v212, v196
v_cvt_pk_bf16_f32 v249, v194, v195
s_waitcnt lgkmcnt(4)
v_mfma_f32_16x16x32_bf16 v[112:115], v[32:35], a[144:147], v[112:115]
ds_read_b128 v[28:31], v6 offset:39936
global_load_lds_dwordx4 v4, s[20:21] offset:3072 sc1
v_mfma_f32_16x16x32_bf16 v[120:123], v[32:35], a[148:151], v[120:123]
v_exp_f32 v208, v208
v_mul_f32 v211, v203, v203
v_fma_f32 v210, v210, v76, v75
v_mfma_f32_16x16x32_bf16 v[116:119], v[36:39], a[144:147], v[116:119]
ds_read_b128 v[32:35], v6 offset:40960
v_mul_f32 v209, v209, v201
v_mfma_f32_16x16x32_bf16 v[124:127], v[36:39], a[148:151], v[124:127]
v_rcp_f32 v214, v214
v_mfma_f32_16x16x32_bf16 v[80:83], v[40:43], a[152:155], v[80:83]
ds_read_b128 v[36:39], v6 offset:41984
global_load_dwordx4 a[16:19], v5, s[20:21] offset:0 sc1
v_mfma_f32_16x16x32_bf16 v[88:91], v[40:43], a[156:159], v[88:91]
v_fma_f32 v215, v215, v74, v74
v_mul_f32 v197, v213, v197
v_mul_f32 v212, v204, v204
s_waitcnt lgkmcnt(4)
v_mfma_f32_16x16x32_bf16 v[84:87], v[44:47], a[152:155], v[84:87]
ds_read_b128 v[40:43], v6 offset:43008
v_fma_f32 v211, v211, v76, v75
v_mfma_f32_16x16x32_bf16 v[92:95], v[44:47], a[156:159], v[92:95]
v_exp_f32 v209, v209
v_mul_f32 v210, v210, v202
v_mfma_f32_16x16x32_bf16 v[96:99], v[16:19], a[152:155], v[96:99]
ds_read_b128 v[44:47], v6 offset:44032
global_load_dwordx4 a[20:23], v5, s[20:21] offset:1024 sc1
v_mfma_f32_16x16x32_bf16 v[104:107], v[16:19], a[156:159], v[104:107]
v_rcp_f32 v215, v215
v_fma_f32 v208, v208, v77, v77
v_mfma_f32_16x16x32_bf16 v[100:103], v[20:23], a[152:155], v[100:103]
ds_read_b128 v[16:19], v6 offset:45056
v_mul_f32 v198, v214, v198
v_mfma_f32_16x16x32_bf16 v[108:111], v[20:23], a[156:159], v[108:111]
v_cvt_pk_bf16_f32 v250, v196, v197
v_mul_f32 v213, v205, v205
v_fma_f32 v212, v212, v76, v75
s_waitcnt lgkmcnt(4)
v_mfma_f32_16x16x32_bf16 v[112:115], v[24:27], a[152:155], v[112:115]
ds_read_b128 v[20:23], v6 offset:46080
global_load_dwordx4 a[24:27], v5, s[20:21] offset:2048 sc1
v_mfma_f32_16x16x32_bf16 v[120:123], v[24:27], a[156:159], v[120:123]
v_exp_f32 v210, v210
v_mul_f32 v211, v211, v203
v_mfma_f32_16x16x32_bf16 v[116:119], v[28:31], a[152:155], v[116:119]
ds_read_b128 v[24:27], v6 offset:47104
v_fma_f32 v209, v209, v77, v77
v_mfma_f32_16x16x32_bf16 v[124:127], v[28:31], a[156:159], v[124:127]
v_rcp_f32 v208, v208
v_mfma_f32_16x16x32_bf16 v[80:83], v[32:35], a[160:163], v[80:83]
ds_read_b128 v[28:31], v6 offset:48128
global_load_dwordx4 a[28:31], v5, s[20:21] offset:3072 sc1
v_mfma_f32_16x16x32_bf16 v[88:91], v[32:35], a[164:167], v[88:91]
v_mul_f32 v199, v215, v199
v_mul_f32 v214, v206, v206
v_fma_f32 v213, v213, v76, v75
v_mul_f32 v212, v212, v204
s_waitcnt lgkmcnt(4)
v_mfma_f32_16x16x32_bf16 v[84:87], v[36:39], a[160:163], v[84:87]
s_barrier
ds_read_b128 v[32:35], v6 offset:49152
v_mfma_f32_16x16x32_bf16 v[92:95], v[36:39], a[164:167], v[92:95]
v_exp_f32 v211, v211
v_fma_f32 v210, v210, v77, v77
v_mfma_f32_16x16x32_bf16 v[96:99], v[40:43], a[160:163], v[96:99]
ds_read_b128 v[36:39], v6 offset:50176
s_add_u32 m0, s43, 16384
v_mfma_f32_16x16x32_bf16 v[104:107], v[40:43], a[164:167], v[104:107]
v_add_u32 v4, 16384, v4
v_mul_f32 v200, v208, v200
v_rcp_f32 v209, v209
v_cvt_pk_bf16_f32 v251, v198, v199
v_mfma_f32_16x16x32_bf16 v[100:103], v[44:47], a[160:163], v[100:103]
ds_read_b128 v[40:43], v6 offset:51200
global_load_lds_dwordx4 v4, s[20:21] offset:0 sc1
v_mfma_f32_16x16x32_bf16 v[108:111], v[44:47], a[164:167], v[108:111]
v_mul_f32 v215, v207, v207
v_fma_f32 v214, v214, v76, v75
v_mul_f32 v213, v213, v205
s_waitcnt lgkmcnt(4)
v_mfma_f32_16x16x32_bf16 v[112:115], v[16:19], a[160:163], v[112:115]
ds_read_b128 v[44:47], v6 offset:52224
global_load_lds_dwordx4 v4, s[20:21] offset:1024 sc1
v_mfma_f32_16x16x32_bf16 v[120:123], v[16:19], a[164:167], v[120:123]
v_exp_f32 v212, v212
v_fma_f32 v211, v211, v77, v77
v_mfma_f32_16x16x32_bf16 v[116:119], v[20:23], a[160:163], v[116:119]
ds_read_b128 v[16:19], v6 offset:53248
global_load_lds_dwordx4 v4, s[20:21] offset:2048 sc1
v_mfma_f32_16x16x32_bf16 v[124:127], v[20:23], a[164:167], v[124:127]
v_rcp_f32 v210, v210
v_mul_f32 v201, v209, v201
v_fma_f32 v215, v215, v76, v75
v_mfma_f32_16x16x32_bf16 v[80:83], v[24:27], a[168:171], v[80:83]
ds_read_b128 v[20:23], v6 offset:54272
v_mul_f32 v214, v214, v206
v_mfma_f32_16x16x32_bf16 v[88:91], v[24:27], a[172:175], v[88:91]
v_fma_f32 v212, v212, v77, v77
s_waitcnt lgkmcnt(4)
v_mfma_f32_16x16x32_bf16 v[84:87], v[28:31], a[168:171], v[84:87]
ds_read_b128 v[24:27], v6 offset:55296
global_load_lds_dwordx4 v4, s[20:21] offset:3072 sc1
v_mfma_f32_16x16x32_bf16 v[92:95], v[28:31], a[172:175], v[92:95]
v_exp_f32 v213, v213
v_rcp_f32 v211, v211
v_mul_f32 v202, v210, v202
v_mfma_f32_16x16x32_bf16 v[96:99], v[32:35], a[168:171], v[96:99]
ds_read_b128 v[28:31], v6 offset:56320
v_cvt_pk_bf16_f32 v252, v200, v201
v_mfma_f32_16x16x32_bf16 v[104:107], v[32:35], a[172:175], v[104:107]
v_exp_f32 v214, v214
v_mfma_f32_16x16x32_bf16 v[100:103], v[36:39], a[168:171], v[100:103]
ds_read_b128 v[32:35], v6 offset:57344
v_add_u32 v5, 8192, v5
v_mfma_f32_16x16x32_bf16 v[108:111], v[36:39], a[172:175], v[108:111]
global_load_dwordx4 a[32:35], v5, s[20:21] offset:-4096 sc1
v_mul_f32 v215, v215, v207
v_fma_f32 v213, v213, v77, v77
s_waitcnt lgkmcnt(3)
v_mfma_f32_16x16x32_bf16 v[112:115], v[40:43], a[168:171], v[112:115]
ds_read_b128 v[36:39], v6 offset:58368
v_mfma_f32_16x16x32_bf16 v[120:123], v[40:43], a[172:175], v[120:123]
s_atomic_add s58, s[20:21], s57 offset:200 glc
v_mul_f32 v203, v211, v203
v_rcp_f32 v212, v212
v_mfma_f32_16x16x32_bf16 v[116:119], v[44:47], a[168:171], v[116:119]
ds_read_b128 v[40:43], v6 offset:59392
global_load_dwordx4 a[36:39], v5, s[20:21] offset:-3072 sc1
v_mfma_f32_16x16x32_bf16 v[124:127], v[44:47], a[172:175], v[124:127]
v_exp_f32 v215, v215
v_fma_f32 v214, v214, v77, v77
v_mfma_f32_16x16x32_bf16 v[80:83], v[16:19], a[176:179], v[80:83]
ds_read_b128 v[44:47], v6 offset:60416
v_mul_f32 v204, v212, v204
v_mfma_f32_16x16x32_bf16 v[88:91], v[16:19], a[180:183], v[88:91]
v_rcp_f32 v213, v213
v_cvt_pk_bf16_f32 v253, v202, v203
v_mfma_f32_16x16x32_bf16 v[84:87], v[20:23], a[176:179], v[84:87]
ds_read_b128 v[16:19], v6 offset:61440
global_load_dwordx4 a[40:43], v5, s[20:21] offset:-2048 sc1
v_mfma_f32_16x16x32_bf16 v[92:95], v[20:23], a[180:183], v[92:95]
v_fma_f32 v215, v215, v77, v77
v_rcp_f32 v214, v214
s_waitcnt lgkmcnt(4)
v_mfma_f32_16x16x32_bf16 v[96:99], v[24:27], a[176:179], v[96:99]
ds_read_b128 v[20:23], v6 offset:62464
v_mul_f32 v205, v213, v205
v_mfma_f32_16x16x32_bf16 v[104:107], v[24:27], a[180:183], v[104:107]
v_rcp_f32 v215, v215
v_mfma_f32_16x16x32_bf16 v[100:103], v[28:31], a[176:179], v[100:103]
ds_read_b128 v[24:27], v6 offset:63488
global_load_dwordx4 a[44:47], v5, s[20:21] offset:-1024 sc1
v_mfma_f32_16x16x32_bf16 v[108:111], v[28:31], a[180:183], v[108:111]
v_mul_f32 v206, v214, v206
v_cvt_pk_bf16_f32 v254, v204, v205
v_mul_f32 v207, v215, v207
v_cvt_pk_bf16_f32 v255, v206, v207
v_mfma_f32_16x16x32_bf16 v[112:115], v[32:35], a[176:179], v[112:115]
ds_read_b128 v[28:31], v6 offset:64512
s_add_u32 s37, s47, 55623680
buffer_store_dwordx4 v[248:251], v0, s[20:23], s37 offen offset:0 sc1
buffer_store_dwordx4 v[252:255], v0, s[20:23], s37 offen offset:1024 sc1
v_mfma_f32_16x16x32_bf16 v[120:123], v[32:35], a[180:183], v[120:123]
s_mov_b32 s59, 0
s_waitcnt lgkmcnt(4)
v_mfma_f32_16x16x32_bf16 v[116:119], v[36:39], a[176:179], v[116:119]
s_barrier
ds_read_b128 v[32:35], v7 offset:0
v_mfma_f32_16x16x32_bf16 v[124:127], v[36:39], a[180:183], v[124:127]
v_mfma_f32_16x16x32_bf16 v[80:83], v[40:43], a[184:187], v[80:83]
ds_read_b128 v[36:39], v7 offset:1024
v_mfma_f32_16x16x32_bf16 v[88:91], v[40:43], a[188:191], v[88:91]
v_mfma_f32_16x16x32_bf16 v[84:87], v[44:47], a[184:187], v[84:87]
ds_read_b128 v[40:43], v7 offset:2048
v_mfma_f32_16x16x32_bf16 v[92:95], v[44:47], a[188:191], v[92:95]
s_waitcnt lgkmcnt(4)
v_mfma_f32_16x16x32_bf16 v[96:99], v[16:19], a[184:187], v[96:99]
ds_read_b128 v[44:47], v7 offset:3072
v_mfma_f32_16x16x32_bf16 v[104:107], v[16:19], a[188:191], v[104:107]
v_mul_f32 v208, v80, v80
v_mul_f32 v209, v81, v81
v_fma_f32 v208, v208, v73, v72
v_mul_f32 v210, v82, v82
v_fma_f32 v209, v209, v73, v72
v_mfma_f32_16x16x32_bf16 v[100:103], v[20:23], a[184:187], v[100:103]
ds_read_b128 v[16:19], v7 offset:4096
s_add_u32 m0, s43, 32768
v_mfma_f32_16x16x32_bf16 v[108:111], v[20:23], a[188:191], v[108:111]
v_add_u32 v4, 16384, v4
v_mul_f32 v208, v208, v80
v_mul_f32 v211, v83, v83
v_fma_f32 v210, v210, v73, v72
v_mfma_f32_16x16x32_bf16 v[112:115], v[24:27], a[184:187], v[112:115]
ds_read_b128 v[20:23], v7 offset:5120
global_load_lds_dwordx4 v4, s[20:21] offset:0 sc1
v_mfma_f32_16x16x32_bf16 v[120:123], v[24:27], a[188:191], v[120:123]
v_mul_f32 v209, v209, v81
v_exp_f32 v208, v208
v_mul_f32 v212, v84, v84
s_waitcnt lgkmcnt(4)
v_mfma_f32_16x16x32_bf16 v[116:119], v[28:31], a[184:187], v[116:119]
ds_read_b128 v[24:27], v7 offset:6144
global_load_lds_dwordx4 v4, s[20:21] offset:1024 sc1
v_mfma_f32_16x16x32_bf16 v[124:127], v[28:31], a[188:191], v[124:127]
v_exp_f32 v209, v209
v_fma_f32 v211, v211, v73, v72
v_mfma_f32_16x16x32_bf16 v[160:163], v[32:35], a[192:195], 0
ds_read_b128 v[28:31], v7 offset:7168
v_mfma_f32_16x16x32_bf16 v[168:171], v[32:35], a[196:199], 0
s_cmp_lt_u32 s58, 8
s_cbranch_scc0 L_back25
L_slow25:
s_waitcnt lgkmcnt(0)
s_cmp_ge_u32 s58, 8
s_cbranch_scc1 L_back25
s_mov_b32 s58, 0
s_atomic_add s58, s[20:21], s57 offset:200 glc
s_sub_u32 s46, s46, 1
s_cbranch_scc0 L_slow25
s_endpgm
L_back25:
v_mul_f32 v210, v210, v82
v_mfma_f32_16x16x32_bf16 v[164:167], v[36:39], a[192:195], 0
ds_read_b128 v[32:35], v7 offset:8192
global_load_lds_dwordx4 v4, s[20:21] offset:2048 sc1
v_mfma_f32_16x16x32_bf16 v[172:175], v[36:39], a[196:199], 0
v_fma_f32 v208, v208, v74, v74
v_mul_f32 v213, v85, v85
v_fma_f32 v212, v212, v73, v72
s_waitcnt lgkmcnt(3)
v_mfma_f32_16x16x32_bf16 v[176:179], v[40:43], a[192:195], 0
ds_read_b128 v[36:39], v7 offset:9216
v_mul_f32 v211, v211, v83
v_mfma_f32_16x16x32_bf16 v[184:187], v[40:43], a[196:199], 0
v_exp_f32 v210, v210
v_mfma_f32_16x16x32_bf16 v[180:183], v[44:47], a[192:195], 0
ds_read_b128 v[40:43], v7 offset:10240
global_load_lds_dwordx4 v4, s[20:21] offset:3072 sc1
v_mfma_f32_16x16x32_bf16 v[188:191], v[44:47], a[196:199], 0
v_rcp_f32 v208, v208
v_mfma_f32_16x16x32_bf16 v[128:131], v[16:19], a[192:195], v[128:131]
ds_read_b128 v[44:47], v7 offset:11264
v_fma_f32 v209, v209, v74, v74
v_mfma_f32_16x16x32_bf16 v[136:139], v[16:19], a[196:199], v[136:139]
v_exp_f32 v211, v211
v_mfma_f32_16x16x32_bf16 v[132:135], v[20:23], a[192:195], v[132:135]
ds_read_b128 v[16:19], v7 offset:12288
global_load_dwordx4 a[48:51], v5, s[20:21] offset:0 sc1
v_mfma_f32_16x16x32_bf16 v[140:143], v[20:23], a[196:199], v[140:143]
v_mul_f32 v214, v86, v86
v_fma_f32 v213, v213, v73, v72
v_mul_f32 v212, v212, v84
s_waitcnt lgkmcnt(3)
v_mfma_f32_16x16x32_bf16 v[144:147], v[24:27], a[192:195], v[144:147]
ds_read_b128 v[20:23], v7 offset:13312
v_fma_f32 v210, v210, v74, v74
v_mfma_f32_16x16x32_bf16 v[152:155], v[24:27], a[196:199], v[152:155]
v_rcp_f32 v209, v209
v_mfma_f32_16x16x32_bf16 v[148:151], v[28:31], a[192:195], v[148:151]
ds_read_b128 v[24:27], v7 offset:14336
global_load_dwordx4 a[52:55], v5, s[20:21] offset:1024 sc1
v_mfma_f32_16x16x32_bf16 v[156:159], v[28:31], a[196:199], v[156:159]
v_mul_f32 v80, v208, v80
v_mul_f32 v215, v87, v87
v_mfma_f32_16x16x32_bf16 v[160:163], v[32:35], a[200:203], v[160:163]
ds_read_b128 v[28:31], v7 offset:15360
v_fma_f32 v214, v214, v73, v72
v_mfma_f32_16x16x32_bf16 v[168:171], v[32:35], a[204:207], v[168:171]
v_exp_f32 v212, v212
v_mfma_f32_16x16x32_bf16 v[164:167], v[36:39], a[200:203], v[164:167]
s_barrier
ds_read_b128 v[32:35], v7 offset:16384
v_mfma_f32_16x16x32_bf16 v[172:175], v[36:39], a[204:207], v[172:175]
v_mul_f32 v213, v213, v85
v_fma_f32 v211, v211, v74, v74
s_waitcnt lgkmcnt(3)
v_mfma_f32_16x16x32_bf16 v[176:179], v[40:43], a[200:203], v[176:179]
ds_read_b128 v[36:39], v7 offset:17408
s_add_u32 m0, s43, 49152
v_mfma_f32_16x16x32_bf16 v[184:187], v[40:43], a[204:207], v[184:187]
v_add_u32 v4, 16384, v4
v_mul_f32 v81, v209, v81
v_rcp_f32 v210, v210
v_mul_f32 v208, v88, v88
v_mfma_f32_16x16x32_bf16 v[180:183], v[44:47], a[200:203], v[180:183]
ds_read_b128 v[40:43], v7 offset:18432
global_load_lds_dwordx4 v4, s[20:21] offset:0 sc1
v_mfma_f32_16x16x32_bf16 v[188:191], v[44:47], a[204:207], v[188:191]
global_load_lds_dwordx4 v4, s[20:21] offset:1024 sc1
v_fma_f32 v215, v215, v73, v72
v_mul_f32 v214, v214, v86
v_mfma_f32_16x16x32_bf16 v[128:131], v[16:19], a[200:203], v[128:131]
ds_read_b128 v[44:47], v7 offset:19456
v_mfma_f32_16x16x32_bf16 v[136:139], v[16:19], a[204:207], v[136:139]
s_waitcnt vmcnt(8)
s_atomic_add s45, s[20:21], s57 offset:208
v_mfma_f32_16x16x32_bf16 v[132:135], v[20:23], a[200:203], v[132:135]
v_exp_f32 v213, v213
v_mfma_f32_16x16x32_bf16 v[140:143], v[20:23], a[204:207], v[140:143]
ds_read_b128 v[16:19], v7 offset:20480
v_fma_f32 v212, v212, v74, v74
s_waitcnt lgkmcnt(4)
v_mfma_f32_16x16x32_bf16 v[144:147], v[24:27], a[200:203], v[144:147]
ds_read_b128 v[20:23], v7 offset:21504
global_load_lds_dwordx4 v4, s[20:21] offset:2048 sc1
v_mfma_f32_16x16x32_bf16 v[152:155], v[24:27], a[204:207], v[152:155]
v_rcp_f32 v211, v211
v_mul_f32 v82, v210, v82
v_cvt_pk_bf16_f32 v240, v80, v81
v_mfma_f32_16x16x32_bf16 v[148:151], v[28:31], a[200:203], v[148:151]
ds_read_b128 v[24:27], v7 offset:22528
global_load_lds_dwordx4 v4, s[20:21] offset:3072 sc1
v_mfma_f32_16x16x32_bf16 v[156:159], v[28:31], a[204:207], v[156:159]
v_exp_f32 v214, v214
v_mul_f32 v209, v89, v89
v_mfma_f32_16x16x32_bf16 v[160:163], v[32:35], a[208:211], v[160:163]
ds_read_b128 v[28:31], v7 offset:23552
v_fma_f32 v208, v208, v76, v75
v_mfma_f32_16x16x32_bf16 v[168:171], v[32:35], a[212:215], v[168:171]
v_mul_f32 v215, v215, v87
v_fma_f32 v213, v213, v74, v74
s_waitcnt lgkmcnt(4)
v_mfma_f32_16x16x32_bf16 v[164:167], v[36:39], a[208:211], v[164:167]
ds_read_b128 v[32:35], v7 offset:24576
v_mul_f32 v83, v211, v83
v_mfma_f32_16x16x32_bf16 v[172:175], v[36:39], a[212:215], v[172:175]
v_rcp_f32 v212, v212
v_mfma_f32_16x16x32_bf16 v[176:179], v[40:43], a[208:211], v[176:179]
ds_read_b128 v[36:39], v7 offset:25600
global_load_dwordx4 a[56:59], v5, s[20:21] offset:2048 sc1
v_mfma_f32_16x16x32_bf16 v[184:187], v[40:43], a[212:215], v[184:187]
v_exp_f32 v215, v215
v_mfma_f32_16x16x32_bf16 v[180:183], v[44:47], a[208:211], v[180:183]
ds_read_b128 v[40:43], v7 offset:26624
v_mul_f32 v210, v90, v90
v_mfma_f32_16x16x32_bf16 v[188:191], v[44:47], a[212:215], v[188:191]
v_fma_f32 v209, v209, v76, v75
v_mul_f32 v208, v208, v88
s_waitcnt lgkmcnt(4)
v_mfma_f32_16x16x32_bf16 v[128:131], v[16:19], a[208:211], v[128:131]
ds_read_b128 v[44:47], v7 offset:27648
global_load_dwordx4 a[60:63], v5, s[20:21] offset:3072 sc1
v_mfma_f32_16x16x32_bf16 v[136:139], v[16:19], a[212:215], v[136:139]
v_rcp_f32 v213, v213
v_fma_f32 v214, v214, v74, v74
v_mfma_f32_16x16x32_bf16 v[132:135], v[20:23], a[208:211], v[132:135]
ds_read_b128 v[16:19], v7 offset:28672
v_mul_f32 v84, v212, v84
v_mfma_f32_16x16x32_bf16 v[140:143], v[20:23], a[212:215], v[140:143]
v_cvt_pk_bf16_f32 v241, v82, v83
v_mul_f32 v211, v91, v91
v_mfma_f32_16x16x32_bf16 v[144:147], v[24:27], a[208:211], v[144:147]
ds_read_b128 v[20:23], v7 offset:29696
v_add_u32 v5, 8192, v5
v_mfma_f32_16x16x32_bf16 v[152:155], v[24:27], a[212:215], v[152:155]
global_load_dwordx4 a[64:67], v5, s[20:21] offset:-4096 sc1
v_fma_f32 v210, v210, v76, v75
v_mul_f32 v209, v209, v89
s_waitcnt lgkmcnt(4)
v_mfma_f32_16x16x32_bf16 v[148:151], v[28:31], a[208:211], v[148:151]
ds_read_b128 v[24:27], v7 offset:30720
v_fma_f32 v215, v215, v74, v74
v_mfma_f32_16x16x32_bf16 v[156:159], v[28:31], a[212:215], v[156:159]
v_exp_f32 v208, v208
v_mfma_f32_16x16x32_bf16 v[160:163], v[32:35], a[216:219], v[160:163]
ds_read_b128 v[28:31], v7 offset:31744
global_load_dwordx4 a[68:71], v5, s[20:21] offset:-3072 sc1
v_mfma_f32_16x16x32_bf16 v[168:171], v[32:35], a[220:223], v[168:171]
v_rcp_f32 v214, v214
v_mul_f32 v85, v213, v85
v_mfma_f32_16x16x32_bf16 v[164:167], v[36:39], a[216:219], v[164:167]
s_barrier
ds_read_b128 v[32:35], v7 offset:32768
v_mfma_f32_16x16x32_bf16 v[172:175], v[36:39], a[220:223], v[172:175]
v_mul_f32 v212, v92, v92
v_fma_f32 v211, v211, v76, v75
v_mul_f32 v210, v210, v90
s_waitcnt lgkmcnt(4)
v_mfma_f32_16x16x32_bf16 v[176:179], v[40:43], a[216:219], v[176:179]
ds_read_b128 v[36:39], v7 offset:33792
s_add_u32 m0, s43, 65536
v_mfma_f32_16x16x32_bf16 v[184:187], v[40:43], a[220:223], v[184:187]
v_add_u32 v4, 16384, v4
v_fma_f32 v208, v208, v77, v77
v_exp_f32 v209, v209
v_mfma_f32_16x16x32_bf16 v[180:183], v[44:47], a[216:219], v[180:183]
ds_read_b128 v[40:43], v7 offset:34816
global_load_lds_dwordx4 v4, s[20:21] offset:0 sc1
v_mfma_f32_16x16x32_bf16 v[188:191], v[44:47], a[220:223], v[188:191]
v_rcp_f32 v215, v215
v_mfma_f32_16x16x32_bf16 v[128:131], v[16:19], a[216:219], v[128:131]
ds_read_b128 v[44:47], v7 offset:35840
global_load_lds_dwordx4 v4, s[20:21] offset:1024 sc1
v_mfma_f32_16x16x32_bf16 v[136:139], v[16:19], a[220:223], v[136:139]
v_mul_f32 v86, v214, v86
v_cvt_pk_bf16_f32 v242, v84, v85
v_mul_f32 v213, v93, v93
s_waitcnt lgkmcnt(4)
v_mfma_f32_16x16x32_bf16 v[132:135], v[20:23], a[216:219], v[132:135]
ds_read_b128 v[16:19], v7 offset:36864
v_fma_f32 v212, v212, v76, v75
v_mfma_f32_16x16x32_bf16 v[140:143], v[20:23], a[220:223], v[140:143]
v_exp_f32 v210, v210
v_mfma_f32_16x16x32_bf16 v[144:147], v[24:27], a[216:219], v[144:147]
ds_read_b128 v[20:23], v7 offset:37888
global_load_lds_dwordx4 v4, s[20:21] offset:2048 sc1
v_mfma_f32_16x16x32_bf16 v[152:155], v[24:27], a[220:223], v[152:155]
v_rcp_f32 v208, v208
v_mul_f32 v211, v211, v91
v_mfma_f32_16x16x32_bf16 v[148:151], v[28:31], a[216:219], v[148:151]
ds_read_b128 v[24:27], v7 offset:38912
v_fma_f32 v209, v209, v77, v77
v_mfma_f32_16x16x32_bf16 v[156:159], v[28:31], a[220:223], v[156:159]
v_mul_f32 v87, v215, v87
v_mul_f32 v214, v94, v94
s_waitcnt lgkmcnt(4)
v_mfma_f32_16x16x32_bf16 v[160:163], v[32:35], a[224:227], v[160:163]
ds_read_b128 v[28:31], v7 offset:39936
global_load_lds_dwordx4 v4, s[20:21] offset:3072 sc1
v_mfma_f32_16x16x32_bf16 v[168:171], v[32:35], a[228:231], v[168:171]
v_exp_f32 v211, v211
v_mfma_f32_16x16x32_bf16 v[164:167], v[36:39], a[224:227], v[164:167]
ds_read_b128 v[32:35], v7 offset:40960
v_fma_f32 v213, v213, v76, v75
v_mfma_f32_16x16x32_bf16 v[172:175], v[36:39], a[228:231], v[172:175]
v_rcp_f32 v209, v209
v_mfma_f32_16x16x32_bf16 v[176:179], v[40:43], a[224:227], v[176:179]
ds_read_b128 v[36:39], v7 offset:41984
global_load_dwordx4 a[72:75], v5, s[20:21] offset:-2048 sc1
v_mfma_f32_16x16x32_bf16 v[184:187], v[40:43], a[228:231], v[184:187]
v_mul_f32 v212, v212, v92
v_fma_f32 v210, v210, v77, v77
v_mul_f32 v88, v208, v88
s_waitcnt lgkmcnt(3)
v_mfma_f32_16x16x32_bf16 v[180:183], v[44:47], a[224:227], v[180:183]
ds_read_b128 v[40:43], v7 offset:43008
v_mfma_f32_16x16x32_bf16 v[188:191], v[44:47], a[228:231], v[188:191]
s_atomic_add s59, s[20:21], s57 offset:208 glc
v_cvt_pk_bf16_f32 v243, v86, v87
v_mfma_f32_16x16x32_bf16 v[128:131], v[16:19], a[224:227], v[128:131]
ds_read_b128 v[44:47], v7 offset:44032
global_load_dwordx4 a[76:79], v5, s[20:21] offset:-1024 sc1
v_mfma_f32_16x16x32_bf16 v[136:139], v[16:19], a[228:231], v[136:139]
v_exp_f32 v212, v212
v_mul_f32 v215, v95, v95
v_mfma_f32_16x16x32_bf16 v[132:135], v[20:23], a[224:227], v[132:135]
ds_read_b128 v[16:19], v7 offset:45056
v_fma_f32 v214, v214, v76, v75
v_mfma_f32_16x16x32_bf16 v[140:143], v[20:23], a[228:231], v[140:143]
v_rcp_f32 v210, v210
v_mfma_f32_16x16x32_bf16 v[144:147], v[24:27], a[224:227], v[144:147]
ds_read_b128 v[20:23], v7 offset:46080
global_load_dwordx4 a[80:83], v5, s[20:21] offset:0 sc1
v_mfma_f32_16x16x32_bf16 v[152:155], v[24:27], a[228:231], v[152:155]
v_mul_f32 v213, v213, v93
v_fma_f32 v211, v211, v77, v77
s_waitcnt lgkmcnt(4)
v_mfma_f32_16x16x32_bf16 v[148:151], v[28:31], a[224:227], v[148:151]
ds_read_b128 v[24:27], v7 offset:47104
v_mul_f32 v89, v209, v89
v_mfma_f32_16x16x32_bf16 v[156:159], v[28:31], a[228:231], v[156:159]
v_exp_f32 v213, v213
v_mfma_f32_16x16x32_bf16 v[160:163], v[32:35], a[232:235], v[160:163]
ds_read_b128 v[28:31], v7 offset:48128
global_load_dwordx4 a[84:87], v5, s[20:21] offset:1024 sc1
v_mfma_f32_16x16x32_bf16 v[168:171], v[32:35], a[236:239], v[168:171]
v_rcp_f32 v211, v211
v_fma_f32 v215, v215, v76, v75
v_mfma_f32_16x16x32_bf16 v[164:167], v[36:39], a[232:235], v[164:167]
s_barrier
ds_read_b128 v[32:35], v7 offset:49152
v_mfma_f32_16x16x32_bf16 v[172:175], v[36:39], a[236:239], v[172:175]
v_mul_f32 v214, v214, v94
v_fma_f32 v212, v212, v77, v77
v_mul_f32 v90, v210, v90
s_waitcnt lgkmcnt(4)
v_mfma_f32_16x16x32_bf16 v[176:179], v[40:43], a[232:235], v[176:179]
ds_read_b128 v[36:39], v7 offset:50176
s_add_u32 m0, s43, 81920
v_mfma_f32_16x16x32_bf16 v[184:187], v[40:43], a[236:239], v[184:187]
v_add_u32 v4, 16384, v4
v_cvt_pk_bf16_f32 v244, v88, v89
v_mul_f32 v215, v215, v95
v_mfma_f32_16x16x32_bf16 v[180:183], v[44:47], a[232:235], v[180:183]
ds_read_b128 v[40:43], v7 offset:51200
global_load_lds_dwordx4 v4, s[20:21] offset:0 sc1
v_mfma_f32_16x16x32_bf16 v[188:191], v[44:47], a[236:239], v[188:191]
v_exp_f32 v214, v214
v_fma_f32 v213, v213, v77, v77
v_mfma_f32_16x16x32_bf16 v[128:131], v[16:19], a[232:235], v[128:131]
ds_read_b128 v[44:47], v7 offset:52224
global_load_lds_dwordx4 v4, s[20:21] offset:1024 sc1
v_mfma_f32_16x16x32_bf16 v[136:139], v[16:19], a[236:239], v[136:139]
v_mul_f32 v91, v211, v91
v_rcp_f32 v212, v212
s_waitcnt lgkmcnt(4)
v_mfma_f32_16x16x32_bf16 v[132:135], v[20:23], a[232:235], v[132:135]
ds_read_b128 v[16:19], v7 offset:53248
v_fma_f32 v214, v214, v77, v77
v_mfma_f32_16x16x32_bf16 v[140:143], v[20:23], a[236:239], v[140:143]
v_exp_f32 v215, v215
v_mfma_f32_16x16x32_bf16 v[144:147], v[24:27], a[232:235], v[144:147]
ds_read_b128 v[20:23], v7 offset:54272
global_load_lds_dwordx4 v4, s[20:21] offset:2048 sc1
v_mfma_f32_16x16x32_bf16 v[152:155], v[24:27], a[236:239], v[152:155]
v_rcp_f32 v213, v213
v_mul_f32 v92, v212, v92
v_mfma_f32_16x16x32_bf16 v[148:151], v[28:31], a[232:235], v[148:151]
ds_read_b128 v[24:27], v7 offset:55296
v_cvt_pk_bf16_f32 v245, v90, v91
v_mfma_f32_16x16x32_bf16 v[156:159], v[28:31], a[236:239], v[156:159]
v_fma_f32 v215, v215, v77, v77
s_waitcnt lgkmcnt(4)
v_mfma_f32_16x16x32_bf16 v[160:163], v[32:35], a[240:243], v[160:163]
ds_read_b128 v[28:31], v7 offset:56320
global_load_lds_dwordx4 v4, s[20:21] offset:3072 sc1
v_mfma_f32_16x16x32_bf16 v[168:171], v[32:35], a[244:247], v[168:171]
v_rcp_f32 v214, v214
v_mul_f32 v93, v213, v93
v_mfma_f32_16x16x32_bf16 v[164:167], v[36:39], a[240:243], v[164:167]
ds_read_b128 v[32:35], v7 offset:57344
v_mul_f32 v94, v214, v94
v_mfma_f32_16x16x32_bf16 v[172:175], v[36:39], a[244:247], v[172:175]
v_rcp_f32 v215, v215
v_mfma_f32_16x16x32_bf16 v[176:179], v[40:43], a[240:243], v[176:179]
ds_read_b128 v[36:39], v7 offset:58368
global_load_dwordx4 a[88:91], v5, s[20:21] offset:2048 sc1
v_mfma_f32_16x16x32_bf16 v[184:187], v[40:43], a[244:247], v[184:187]
v_cvt_pk_bf16_f32 v246, v92, v93
v_mul_f32 v95, v215, v95
v_cvt_pk_bf16_f32 v247, v94, v95
s_waitcnt lgkmcnt(4)
v_mfma_f32_16x16x32_bf16 v[180:183], v[44:47], a[240:243], v[180:183]
ds_read_b128 v[40:43], v7 offset:59392
s_add_u32 s38, s47, 55640064
buffer_store_dwordx4 v[240:243], v0, s[20:23], s38 offen offset:0 sc1
buffer_store_dwordx4 v[244:247], v0, s[20:23], s38 offen offset:1024 sc1
v_mfma_f32_16x16x32_bf16 v[188:191], v[44:47], a[244:247], v[188:191]
s_mov_b32 s58, 0
v_mul_f32 v208, v96, v96
v_mfma_f32_16x16x32_bf16 v[128:131], v[16:19], a[240:243], v[128:131]
ds_read_b128 v[44:47], v7 offset:60416
v_mfma_f32_16x16x32_bf16 v[136:139], v[16:19], a[244:247], v[136:139]
s_cmp_lt_u32 s59, 8
s_cbranch_scc0 L_back26
L_slow26:
s_waitcnt lgkmcnt(0)
s_cmp_ge_u32 s59, 8
s_cbranch_scc1 L_back26
s_mov_b32 s59, 0
s_atomic_add s59, s[20:21], s57 offset:208 glc
s_sub_u32 s46, s46, 1
s_cbranch_scc0 L_slow26
s_endpgm
L_back26:
v_mfma_f32_16x16x32_bf16 v[132:135], v[20:23], a[240:243], v[132:135]
ds_read_b128 v[16:19], v7 offset:61440
v_mul_f32 v209, v97, v97
v_mfma_f32_16x16x32_bf16 v[140:143], v[20:23], a[244:247], v[140:143]
v_fma_f32 v208, v208, v73, v72
s_waitcnt lgkmcnt(3)
v_mfma_f32_16x16x32_bf16 v[144:147], v[24:27], a[240:243], v[144:147]
ds_read_b128 v[20:23], v7 offset:62464
v_mul_f32 v210, v98, v98
v_mfma_f32_16x16x32_bf16 v[152:155], v[24:27], a[244:247], v[152:155]
v_fma_f32 v209, v209, v73, v72
v_mul_f32 v208, v208, v96
v_mfma_f32_16x16x32_bf16 v[148:151], v[28:31], a[240:243], v[148:151]
ds_read_b128 v[24:27], v7 offset:63488
v_mul_f32 v211, v99, v99
v_mfma_f32_16x16x32_bf16 v[156:159], v[28:31], a[244:247], v[156:159]
v_exp_f32 v208, v208
v_mfma_f32_16x16x32_bf16 v[160:163], v[32:35], a[248:251], v[160:163]
ds_read_b128 v[28:31], v7 offset:64512
global_load_dwordx4 a[92:95], v5, s[20:21] offset:3072 sc1
v_mfma_f32_16x16x32_bf16 v[168:171], v[32:35], a[252:255], v[168:171]
v_fma_f32 v210, v210, v73, v72
v_mul_f32 v209, v209, v97
v_mfma_f32_16x16x32_bf16 v[164:167], v[36:39], a[248:251], v[164:167]
s_barrier
ds_read_b128 v[32:35], v6 offset:0
v_mfma_f32_16x16x32_bf16 v[172:175], v[36:39], a[252:255], v[172:175]
v_mul_f32 v212, v100, v100
v_fma_f32 v211, v211, v73, v72
s_waitcnt lgkmcnt(3)
v_mfma_f32_16x16x32_bf16 v[176:179], v[40:43], a[248:251], v[176:179]
ds_read_b128 v[36:39], v6 offset:1024
v_mul_f32 v210, v210, v98
v_mfma_f32_16x16x32_bf16 v[184:187], v[40:43], a[252:255], v[184:187]
v_exp_f32 v209, v209
v_mfma_f32_16x16x32_bf16 v[180:183], v[44:47], a[248:251], v[180:183]
ds_read_b128 v[40:43], v6 offset:2048
s_add_u32 m0, s43, 98304
v_mfma_f32_16x16x32_bf16 v[188:191], v[44:47], a[252:255], v[188:191]
v_add_u32 v4, 16384, v4
v_fma_f32 v208, v208, v74, v74
v_mul_f32 v213, v101, v101
v_fma_f32 v212, v212, v73, v72
v_mfma_f32_16x16x32_bf16 v[128:131], v[16:19], a[248:251], v[128:131]
ds_read_b128 v[44:47], v6 offset:3072
global_load_lds_dwordx4 v4, s[20:21] offset:0 sc1
v_mfma_f32_16x16x32_bf16 v[136:139], v[16:19], a[252:255], v[136:139]
v_exp_f32 v210, v210
v_mul_f32 v211, v211, v99
v_mfma_f32_16x16x32_bf16 v[132:135], v[20:23], a[248:251], v[132:135]
ds_read_b128 v[16:19], v6 offset:4096
global_load_lds_dwordx4 v4, s[20:21] offset:1024 sc1
v_mfma_f32_16x16x32_bf16 v[140:143], v[20:23], a[252:255], v[140:143]
v_fma_f32 v209, v209, v74, v74
v_rcp_f32 v208, v208
s_waitcnt lgkmcnt(3)
v_mfma_f32_16x16x32_bf16 v[144:147], v[24:27], a[248:251], v[144:147]
ds_read_b128 v[20:23], v6 offset:5120
v_mul_f32 v214, v102, v102
v_mfma_f32_16x16x32_bf16 v[152:155], v[24:27], a[252:255], v[152:155]
v_exp_f32 v211, v211
v_mfma_f32_16x16x32_bf16 v[148:151], v[28:31], a[248:251], v[148:151]
ds_read_b128 v[24:27], v6 offset:6144
global_load_lds_dwordx4 v4, s[20:21] offset:2048 sc1
v_mfma_f32_16x16x32_bf16 v[156:159], v[28:31], a[252:255], v[156:159]
v_rcp_f32 v209, v209
v_mfma_f32_16x16x32_bf16 v[160:163], v[32:35], a[0:3], v[160:163]
ds_read_b128 v[28:31], v6 offset:7168
v_fma_f32 v213, v213, v73, v72
v_mfma_f32_16x16x32_bf16 v[168:171], v[32:35], a[4:7], v[168:171]
v_mul_f32 v212, v212, v100
v_fma_f32 v210, v210, v74, v74
v_mfma_f32_16x16x32_bf16 v[164:167], v[36:39], a[0:3], v[164:167]
ds_read_b128 v[32:35], v6 offset:8192
global_load_lds_dwordx4 v4, s[20:21] offset:3072 sc1
v_mfma_f32_16x16x32_bf16 v[172:175], v[36:39], a[4:7], v[172:175]
v_mul_f32 v96, v208, v96
v_mul_f32 v215, v103, v103
v_fma_f32 v214, v214, v73, v72
s_waitcnt lgkmcnt(3)
v_mfma_f32_16x16x32_bf16 v[176:179], v[40:43], a[0:3], v[176:179]
ds_read_b128 v[36:39], v6 offset:9216
v_mul_f32 v213, v213, v101
v_mfma_f32_16x16x32_bf16 v[184:187], v[40:43], a[4:7], v[184:187]
v_exp_f32 v212, v212
v_mfma_f32_16x16x32_bf16 v[180:183], v[44:47], a[0:3], v[180:183]
ds_read_b128 v[40:43], v6 offset:10240
v_add_u32 v5, 8192, v5
v_mfma_f32_16x16x32_bf16 v[188:191], v[44:47], a[4:7], v[188:191]
global_load_dwordx4 a[96:99], v5, s[20:21] offset:-4096 sc1
v_fma_f32 v211, v211, v74, v74
v_mfma_f32_16x16x32_bf16 v[128:131], v[16:19], a[0:3], v[128:131]
ds_read_b128 v[44:47], v6 offset:11264
v_mul_f32 v97, v209, v97
v_mfma_f32_16x16x32_bf16 v[136:139], v[16:19], a[4:7], v[136:139]
v_rcp_f32 v210, v210
v_mul_f32 v208, v104, v104
v_mfma_f32_16x16x32_bf16 v[132:135], v[20:23], a[0:3], v[132:135]
ds_read_b128 v[16:19], v6 offset:12288
global_load_dwordx4 a[100:103], v5, s[20:21] offset:-3072 sc1
v_mfma_f32_16x16x32_bf16 v[140:143], v[20:23], a[4:7], v[140:143]
v_fma_f32 v215, v215, v73, v72
v_mul_f32 v214, v214, v102
s_waitcnt lgkmcnt(3)
v_mfma_f32_16x16x32_bf16 v[144:147], v[24:27], a[0:3], v[144:147]
ds_read_b128 v[20:23], v6 offset:13312
v_fma_f32 v212, v212, v74, v74
v_mfma_f32_16x16x32_bf16 v[152:155], v[24:27], a[4:7], v[152:155]
v_exp_f32 v213, v213
v_mfma_f32_16x16x32_bf16 v[148:151], v[28:31], a[0:3], v[148:151]
ds_read_b128 v[24:27], v6 offset:14336
global_load_dwordx4 a[104:107], v5, s[20:21] offset:-2048 sc1
v_mfma_f32_16x16x32_bf16 v[156:159], v[28:31], a[4:7], v[156:159]
s_waitcnt vmcnt(8)
s_atomic_add s45, s[20:21], s57 offset:216
v_rcp_f32 v211, v211
v_mfma_f32_16x16x32_bf16 v[160:163], v[32:35], a[8:11], v[160:163]
ds_read_b128 v[28:31], v6 offset:15360
v_mul_f32 v98, v210, v98
v_mfma_f32_16x16x32_bf16 v[168:171], v[32:35], a[12:15], v[168:171]
v_cvt_pk_bf16_f32 v248, v96, v97
v_mul_f32 v209, v105, v105
v_mfma_f32_16x16x32_bf16 v[164:167], v[36:39], a[8:11], v[164:167]
s_barrier
ds_read_b128 v[32:35], v6 offset:16384
v_mfma_f32_16x16x32_bf16 v[172:175], v[36:39], a[12:15], v[172:175]
global_load_dwordx4 a[108:111], v5, s[20:21] offset:-1024 sc1
v_fma_f32 v208, v208, v76, v75
v_mul_f32 v215, v215, v103
s_waitcnt lgkmcnt(4)
v_mfma_f32_16x16x32_bf16 v[176:179], v[40:43], a[8:11], v[176:179]
ds_read_b128 v[36:39], v6 offset:17408
v_fma_f32 v213, v213, v74, v74
v_mfma_f32_16x16x32_bf16 v[184:187], v[40:43], a[12:15], v[184:187]
v_exp_f32 v214, v214
v_mfma_f32_16x16x32_bf16 v[180:183], v[44:47], a[8:11], v[180:183]
ds_read_b128 v[40:43], v6 offset:18432
s_add_u32 m0, s43, 114688
v_mfma_f32_16x16x32_bf16 v[188:191], v[44:47], a[12:15], v[188:191]
v_add_u32 v4, 16384, v4
v_mul_f32 v99, v211, v99
v_rcp_f32 v212, v212
v_mfma_f32_16x16x32_bf16 v[128:131], v[16:19], a[8:11], v[128:131]
ds_read_b128 v[44:47], v6 offset:19456
global_load_lds_dwordx4 v4, s[20:21] offset:0 sc1
v_mfma_f32_16x16x32_bf16 v[136:139], v[16:19], a[12:15], v[136:139]
s_getpc_b64 s[4:5]
v_mul_f32 v210, v106, v106
v_fma_f32 v209, v209, v76, v75
v_mul_f32 v208, v208, v104
s_waitcnt lgkmcnt(4)
v_mfma_f32_16x16x32_bf16 v[132:135], v[20:23], a[8:11], v[132:135]
ds_read_b128 v[16:19], v6 offset:20480
global_load_dword v13, v12, s[4:5]
v_mfma_f32_16x16x32_bf16 v[140:143], v[20:23], a[12:15], v[140:143]
global_load_lds_dwordx4 v4, s[20:21] offset:1024 sc1
v_fma_f32 v214, v214, v74, v74
v_mfma_f32_16x16x32_bf16 v[144:147], v[24:27], a[8:11], v[144:147]
ds_read_b128 v[20:23], v6 offset:21504
v_mul_f32 v100, v212, v100
v_mfma_f32_16x16x32_bf16 v[152:155], v[24:27], a[12:15], v[152:155]
v_exp_f32 v215, v215
v_mfma_f32_16x16x32_bf16 v[148:151], v[28:31], a[8:11], v[148:151]
ds_read_b128 v[24:27], v6 offset:22528
global_load_lds_dwordx4 v4, s[20:21] offset:2048 sc1
v_mfma_f32_16x16x32_bf16 v[156:159], v[28:31], a[12:15], v[156:159]
v_cvt_pk_bf16_f32 v249, v98, v99
v_rcp_f32 v213, v213
v_mul_f32 v211, v107, v107
s_waitcnt lgkmcnt(4)
v_mfma_f32_16x16x32_bf16 v[160:163], v[32:35], a[16:19], v[160:163]
ds_read_b128 v[28:31], v6 offset:23552
v_fma_f32 v210, v210, v76, v75
v_mfma_f32_16x16x32_bf16 v[168:171], v[32:35], a[20:23], v[168:171]
v_exp_f32 v208, v208
v_mfma_f32_16x16x32_bf16 v[164:167], v[36:39], a[16:19], v[164:167]
ds_read_b128 v[32:35], v6 offset:24576
global_load_lds_dwordx4 v4, s[20:21] offset:3072 sc1
v_mfma_f32_16x16x32_bf16 v[172:175], v[36:39], a[20:23], v[172:175]
v_rcp_f32 v214, v214
v_mul_f32 v209, v209, v105
v_mfma_f32_16x16x32_bf16 v[176:179], v[40:43], a[16:19], v[176:179]
ds_read_b128 v[36:39], v6 offset:25600
v_fma_f32 v215, v215, v74, v74
v_mfma_f32_16x16x32_bf16 v[184:187], v[40:43], a[20:23], v[184:187]
v_mul_f32 v101, v213, v101
s_waitcnt lgkmcnt(4)
v_mfma_f32_16x16x32_bf16 v[180:183], v[44:47], a[16:19], v[180:183]
ds_read_b128 v[40:43], v6 offset:26624
global_load_dwordx4 a[112:115], v5, s[20:21] offset:0 sc1
v_mfma_f32_16x16x32_bf16 v[188:191], v[44:47], a[20:23], v[188:191]
v_exp_f32 v209, v209
v_mul_f32 v212, v108, v108
v_mfma_f32_16x16x32_bf16 v[128:131], v[16:19], a[16:19], v[128:131]
ds_read_b128 v[44:47], v6 offset:27648
v_fma_f32 v211, v211, v76, v75
v_mfma_f32_16x16x32_bf16 v[136:139], v[16:19], a[20:23], v[136:139]
v_rcp_f32 v215, v215
v_mfma_f32_16x16x32_bf16 v[132:135], v[20:23], a[16:19], v[132:135]
ds_read_b128 v[16:19], v6 offset:28672
global_load_dwordx4 a[116:119], v5, s[20:21] offset:1024 sc1
v_mfma_f32_16x16x32_bf16 v[140:143], v[20:23], a[20:23], v[140:143]
v_mul_f32 v210, v210, v106
v_fma_f32 v208, v208, v77, v77
v_mul_f32 v102, v214, v102
s_waitcnt lgkmcnt(4)
v_mfma_f32_16x16x32_bf16 v[144:147], v[24:27], a[16:19], v[144:147]
ds_read_b128 v[20:23], v6 offset:29696
v_cvt_pk_bf16_f32 v250, v100, v101
v_mfma_f32_16x16x32_bf16 v[152:155], v[24:27], a[20:23], v[152:155]
v_exp_f32 v210, v210
v_mfma_f32_16x16x32_bf16 v[148:151], v[28:31], a[16:19], v[148:151]
ds_read_b128 v[24:27], v6 offset:30720
global_load_dwordx4 a[120:123], v5, s[20:21] offset:2048 sc1
v_mfma_f32_16x16x32_bf16 v[156:159], v[28:31], a[20:23], v[156:159]
v_mul_f32 v213, v109, v109
v_fma_f32 v212, v212, v76, v75
v_mfma_f32_16x16x32_bf16 v[160:163], v[32:35], a[24:27], v[160:163]
ds_read_b128 v[28:31], v6 offset:31744
v_mul_f32 v211, v211, v107
v_mfma_f32_16x16x32_bf16 v[168:171], v[32:35], a[28:31], v[168:171]
v_fma_f32 v209, v209, v77, v77
s_waitcnt lgkmcnt(4)
v_mfma_f32_16x16x32_bf16 v[164:167], v[36:39], a[24:27], v[164:167]
s_barrier
ds_read_b128 v[32:35], v6 offset:32768
v_mfma_f32_16x16x32_bf16 v[172:175], v[36:39], a[28:31], v[172:175]
global_load_dwordx4 a[124:127], v5, s[20:21] offset:3072 sc1
v_mul_f32 v103, v215, v103
v_rcp_f32 v208, v208
v_mul_f32 v214, v110, v110
v_mfma_f32_16x16x32_bf16 v[176:179], v[40:43], a[24:27], v[176:179]
ds_read_b128 v[36:39], v6 offset:33792
v_fma_f32 v213, v213, v76, v75
v_mfma_f32_16x16x32_bf16 v[184:187], v[40:43], a[28:31], v[184:187]
v_exp_f32 v211, v211
v_mfma_f32_16x16x32_bf16 v[180:183], v[44:47], a[24:27], v[180:183]
ds_read_b128 v[40:43], v6 offset:34816
s_add_u32 m0, s43, 0
v_mfma_f32_16x16x32_bf16 v[188:191], v[44:47], a[28:31], v[188:191]
v_add_u32 v4, 16384, v4
v_mul_f32 v212, v212, v108
v_fma_f32 v210, v210, v77, v77
s_waitcnt lgkmcnt(4)
v_mfma_f32_16x16x32_bf16 v[128:131], v[16:19], a[24:27], v[128:131]
ds_read_b128 v[44:47], v6 offset:35840
global_load_lds_dwordx4 v4, s[20:21] offset:0 sc1
v_mfma_f32_16x16x32_bf16 v[136:139], v[16:19], a[28:31], v[136:139]
v_rcp_f32 v209, v209
v_mul_f32 v104, v208, v104
v_mfma_f32_16x16x32_bf16 v[132:135], v[20:23], a[24:27], v[132:135]
ds_read_b128 v[16:19], v6 offset:36864
global_load_lds_dwordx4 v4, s[20:21] offset:1024 sc1
v_mfma_f32_16x16x32_bf16 v[140:143], v[20:23], a[28:31], v[140:143]
s_atomic_add s58, s[20:21], s57 offset:216 glc
v_cvt_pk_bf16_f32 v251, v102, v103
v_mfma_f32_16x16x32_bf16 v[144:147], v[24:27], a[24:27], v[144:147]
ds_read_b128 v[20:23], v6 offset:37888
v_mul_f32 v215, v111, v111
v_mfma_f32_16x16x32_bf16 v[152:155], v[24:27], a[28:31], v[152:155]
v_fma_f32 v214, v214, v76, v75
v_mul_f32 v213, v213, v109
s_waitcnt lgkmcnt(4)
v_mfma_f32_16x16x32_bf16 v[148:151], v[28:31], a[24:27], v[148:151]
ds_read_b128 v[24:27], v6 offset:38912
global_load_lds_dwordx4 v4, s[20:21] offset:2048 sc1
v_mfma_f32_16x16x32_bf16 v[156:159], v[28:31], a[28:31], v[156:159]
v_exp_f32 v212, v212
v_fma_f32 v211, v211, v77, v77
v_mfma_f32_16x16x32_bf16 v[160:163], v[32:35], a[32:35], v[160:163]
ds_read_b128 v[28:31], v6 offset:39936
v_mul_f32 v105, v209, v105
v_mfma_f32_16x16x32_bf16 v[168:171], v[32:35], a[36:39], v[168:171]
v_rcp_f32 v210, v210
v_mfma_f32_16x16x32_bf16 v[164:167], v[36:39], a[32:35], v[164:167]
ds_read_b128 v[32:35], v6 offset:40960
global_load_lds_dwordx4 v4, s[20:21] offset:3072 sc1
v_mfma_f32_16x16x32_bf16 v[172:175], v[36:39], a[36:39], v[172:175]
v_fma_f32 v215, v215, v76, v75
v_mul_f32 v214, v214, v110
s_waitcnt lgkmcnt(4)
v_mfma_f32_16x16x32_bf16 v[176:179], v[40:43], a[32:35], v[176:179]
ds_read_b128 v[36:39], v6 offset:41984
v_fma_f32 v212, v212, v77, v77
v_mfma_f32_16x16x32_bf16 v[184:187], v[40:43], a[36:39], v[184:187]
v_exp_f32 v213, v213
v_mfma_f32_16x16x32_bf16 v[180:183], v[44:47], a[32:35], v[180:183]
ds_read_b128 v[40:43], v6 offset:43008
v_add_u32 v5, 8192, v5
v_mfma_f32_16x16x32_bf16 v[188:191], v[44:47], a[36:39], v[188:191]
global_load_dwordx4 a[128:131], v5, s[20:21] offset:-4096 sc1
v_mul_f32 v106, v210, v106
v_rcp_f32 v211, v211
v_mfma_f32_16x16x32_bf16 v[128:131], v[16:19], a[32:35], v[128:131]
ds_read_b128 v[44:47], v6 offset:44032
v_cvt_pk_bf16_f32 v252, v104, v105
v_mfma_f32_16x16x32_bf16 v[136:139], v[16:19], a[36:39], v[136:139]
v_mul_f32 v215, v215, v111
s_waitcnt lgkmcnt(4)
v_mfma_f32_16x16x32_bf16 v[132:135], v[20:23], a[32:35], v[132:135]
ds_read_b128 v[16:19], v6 offset:45056
global_load_dwordx4 a[132:135], v5, s[20:21] offset:-3072 sc1
v_mfma_f32_16x16x32_bf16 v[140:143], v[20:23], a[36:39], v[140:143]
v_exp_f32 v214, v214
v_fma_f32 v213, v213, v77, v77
v_mfma_f32_16x16x32_bf16 v[144:147], v[24:27], a[32:35], v[144:147]
ds_read_b128 v[20:23], v6 offset:46080
v_mul_f32 v107, v211, v107
v_mfma_f32_16x16x32_bf16 v[152:155], v[24:27], a[36:39], v[152:155]
v_rcp_f32 v212, v212
v_mfma_f32_16x16x32_bf16 v[148:151], v[28:31], a[32:35], v[148:151]
ds_read_b128 v[24:27], v6 offset:47104
global_load_dwordx4 a[136:139], v5, s[20:21] offset:-2048 sc1
v_mfma_f32_16x16x32_bf16 v[156:159], v[28:31], a[36:39], v[156:159]
v_fma_f32 v214, v214, v77, v77
v_exp_f32 v215, v215
s_waitcnt lgkmcnt(4)
v_mfma_f32_16x16x32_bf16 v[160:163], v[32:35], a[40:43], v[160:163]
ds_read_b128 v[28:31], v6 offset:48128
v_mul_f32 v108, v212, v108
v_mfma_f32_16x16x32_bf16 v[168:171], v[32:35], a[44:47], v[168:171]
v_rcp_f32 v213, v213
v_mfma_f32_16x16x32_bf16 v[164:167], v[36:39], a[40:43], v[164:167]
s_barrier
ds_read_b128 v[32:35], v6 offset:49152
v_mfma_f32_16x16x32_bf16 v[172:175], v[36:39], a[44:47], v[172:175]
global_load_dwordx4 a[140:143], v5, s[20:21] offset:-1024 sc1
v_cvt_pk_bf16_f32 v253, v106, v107
v_fma_f32 v215, v215, v77, v77
v_mfma_f32_16x16x32_bf16 v[176:179], v[40:43], a[40:43], v[176:179]
v_rcp_f32 v214, v214
v_mfma_f32_16x16x32_bf16 v[184:187], v[40:43], a[44:47], v[184:187]
ds_read_b128 v[36:39], v6 offset:50176
v_mul_f32 v109, v213, v109
s_waitcnt lgkmcnt(4)
v_mfma_f32_16x16x32_bf16 v[180:183], v[44:47], a[40:43], v[180:183]
ds_read_b128 v[40:43], v6 offset:51200
s_add_u32 m0, s43, 16384
v_mfma_f32_16x16x32_bf16 v[188:191], v[44:47], a[44:47], v[188:191]
v_add_u32 v4, 16384, v4
v_mul_f32 v110, v214, v110
v_rcp_f32 v215, v215
v_mfma_f32_16x16x32_bf16 v[128:131], v[16:19], a[40:43], v[128:131]
ds_read_b128 v[44:47], v6 offset:52224
global_load_lds_dwordx4 v4, s[20:21] offset:0 sc1
v_mfma_f32_16x16x32_bf16 v[136:139], v[16:19], a[44:47], v[136:139]
v_cvt_pk_bf16_f32 v254, v108, v109
v_mul_f32 v111, v215, v111
v_cvt_pk_bf16_f32 v255, v110, v111
v_mfma_f32_16x16x32_bf16 v[132:135], v[20:23], a[40:43], v[132:135]
ds_read_b128 v[16:19], v6 offset:53248
global_load_lds_dwordx4 v4, s[20:21] offset:1024 sc1
v_mfma_f32_16x16x32_bf16 v[140:143], v[20:23], a[44:47], v[140:143]
s_add_u32 s37, s47, 55656448
buffer_store_dwordx4 v[248:251], v0, s[20:23], s37 offen offset:0 sc1
buffer_store_dwordx4 v[252:255], v0, s[20:23], s37 offen offset:1024 sc1
s_cmp_lt_u32 s58, 8
s_cbranch_scc0 L_back27
L_slow27:
s_waitcnt lgkmcnt(0)
s_cmp_ge_u32 s58, 8
s_cbranch_scc1 L_back27
s_mov_b32 s58, 0
s_atomic_add s58, s[20:21], s57 offset:216 glc
s_sub_u32 s46, s46, 1
s_cbranch_scc0 L_slow27
s_endpgm
L_back27:
s_mov_b32 s59, 0
s_waitcnt lgkmcnt(3)
v_mfma_f32_16x16x32_bf16 v[144:147], v[24:27], a[40:43], v[144:147]
ds_read_b128 v[20:23], v6 offset:54272
v_mul_f32 v208, v112, v112
v_mfma_f32_16x16x32_bf16 v[152:155], v[24:27], a[44:47], v[152:155]
v_mul_f32 v209, v113, v113
v_fma_f32 v208, v208, v73, v72
v_mfma_f32_16x16x32_bf16 v[148:151], v[28:31], a[40:43], v[148:151]
ds_read_b128 v[24:27], v6 offset:55296
v_mul_f32 v210, v114, v114
v_mfma_f32_16x16x32_bf16 v[156:159], v[28:31], a[44:47], v[156:159]
v_fma_f32 v209, v209, v73, v72
v_mul_f32 v208, v208, v112
v_mfma_f32_16x16x32_bf16 v[160:163], v[32:35], a[48:51], v[160:163]
ds_read_b128 v[28:31], v6 offset:56320
v_mul_f32 v211, v115, v115
v_mfma_f32_16x16x32_bf16 v[168:171], v[32:35], a[52:55], v[168:171]
v_exp_f32 v208, v208
v_mfma_f32_16x16x32_bf16 v[164:167], v[36:39], a[48:51], v[164:167]
ds_read_b128 v[32:35], v6 offset:57344
v_fma_f32 v210, v210, v73, v72
v_mfma_f32_16x16x32_bf16 v[172:175], v[36:39], a[52:55], v[172:175]
v_mul_f32 v209, v209, v113
s_waitcnt lgkmcnt(3)
v_mfma_f32_16x16x32_bf16 v[176:179], v[40:43], a[48:51], v[176:179]
ds_read_b128 v[36:39], v6 offset:58368
global_load_lds_dwordx4 v4, s[20:21] offset:2048 sc1
v_mfma_f32_16x16x32_bf16 v[184:187], v[40:43], a[52:55], v[184:187]
v_exp_f32 v209, v209
v_mfma_f32_16x16x32_bf16 v[180:183], v[44:47], a[48:51], v[180:183]
ds_read_b128 v[40:43], v6 offset:59392
v_mul_f32 v212, v116, v116
v_mfma_f32_16x16x32_bf16 v[188:191], v[44:47], a[52:55], v[188:191]
v_fma_f32 v211, v211, v73, v72
v_mul_f32 v210, v210, v114
v_mfma_f32_16x16x32_bf16 v[128:131], v[16:19], a[48:51], v[128:131]
ds_read_b128 v[44:47], v6 offset:60416
global_load_lds_dwordx4 v4, s[20:21] offset:3072 sc1
v_mfma_f32_16x16x32_bf16 v[136:139], v[16:19], a[52:55], v[136:139]
v_fma_f32 v208, v208, v74, v74
v_mul_f32 v213, v117, v117
v_mfma_f32_16x16x32_bf16 v[132:135], v[20:23], a[48:51], v[132:135]
ds_read_b128 v[16:19], v6 offset:61440
v_fma_f32 v212, v212, v73, v72
v_mfma_f32_16x16x32_bf16 v[140:143], v[20:23], a[52:55], v[140:143]
v_mul_f32 v211, v211, v115
s_waitcnt lgkmcnt(3)
v_mfma_f32_16x16x32_bf16 v[144:147], v[24:27], a[48:51], v[144:147]
ds_read_b128 v[20:23], v6 offset:62464
v_fma_f32 v209, v209, v74, v74
v_mfma_f32_16x16x32_bf16 v[152:155], v[24:27], a[52:55], v[152:155]
v_exp_f32 v210, v210
v_mfma_f32_16x16x32_bf16 v[148:151], v[28:31], a[48:51], v[148:151]
ds_read_b128 v[24:27], v6 offset:63488
global_load_dwordx4 a[144:147], v5, s[20:21] offset:0 sc1
v_mfma_f32_16x16x32_bf16 v[156:159], v[28:31], a[52:55], v[156:159]
v_rcp_f32 v208, v208
v_mfma_f32_16x16x32_bf16 v[160:163], v[32:35], a[56:59], v[160:163]
ds_read_b128 v[28:31], v6 offset:64512
v_mul_f32 v214, v118, v118
v_mfma_f32_16x16x32_bf16 v[168:171], v[32:35], a[60:63], v[168:171]
v_exp_f32 v211, v211
v_mfma_f32_16x16x32_bf16 v[164:167], v[36:39], a[56:59], v[164:167]
s_barrier
ds_read_b128 v[32:35], v7 offset:0
v_mfma_f32_16x16x32_bf16 v[172:175], v[36:39], a[60:63], v[172:175]
global_load_dwordx4 a[148:151], v5, s[20:21] offset:1024 sc1
v_fma_f32 v213, v213, v73, v72
v_mul_f32 v212, v212, v116
v_fma_f32 v210, v210, v74, v74
s_waitcnt lgkmcnt(3)
v_mfma_f32_16x16x32_bf16 v[176:179], v[40:43], a[56:59], v[176:179]
ds_read_b128 v[36:39], v7 offset:1024
v_mul_f32 v112, v208, v112
v_mfma_f32_16x16x32_bf16 v[184:187], v[40:43], a[60:63], v[184:187]
v_rcp_f32 v209, v209
v_mfma_f32_16x16x32_bf16 v[180:183], v[44:47], a[56:59], v[180:183]
ds_read_b128 v[40:43], v7 offset:2048
s_add_u32 m0, s43, 32768
v_mfma_f32_16x16x32_bf16 v[188:191], v[44:47], a[60:63], v[188:191]
v_add_u32 v4, 16384, v4
v_mul_f32 v215, v119, v119
v_fma_f32 v214, v214, v73, v72
v_mfma_f32_16x16x32_bf16 v[128:131], v[16:19], a[56:59], v[128:131]
ds_read_b128 v[44:47], v7 offset:3072
global_load_lds_dwordx4 v4, s[20:21] offset:0 sc1
v_mfma_f32_16x16x32_bf16 v[136:139], v[16:19], a[60:63], v[136:139]
v_exp_f32 v212, v212
v_mul_f32 v213, v213, v117
v_mfma_f32_16x16x32_bf16 v[132:135], v[20:23], a[56:59], v[132:135]
ds_read_b128 v[16:19], v7 offset:4096
global_load_lds_dwordx4 v4, s[20:21] offset:1024 sc1
v_mfma_f32_16x16x32_bf16 v[140:143], v[20:23], a[60:63], v[140:143]
v_fma_f32 v211, v211, v74, v74
v_rcp_f32 v210, v210
s_waitcnt lgkmcnt(3)
v_mfma_f32_16x16x32_bf16 v[144:147], v[24:27], a[56:59], v[144:147]
ds_read_b128 v[20:23], v7 offset:5120
v_mul_f32 v113, v209, v113
v_mfma_f32_16x16x32_bf16 v[152:155], v[24:27], a[60:63], v[152:155]
v_exp_f32 v213, v213
v_mfma_f32_16x16x32_bf16 v[148:151], v[28:31], a[56:59], v[148:151]
ds_read_b128 v[24:27], v7 offset:6144
global_load_lds_dwordx4 v4, s[20:21] offset:2048 sc1
v_mfma_f32_16x16x32_bf16 v[156:159], v[28:31], a[60:63], v[156:159]
v_mul_f32 v208, v120, v120
v_fma_f32 v215, v215, v73, v72
v_mfma_f32_16x16x32_bf16 v[160:163], v[32:35], a[64:67], v[160:163]
ds_read_b128 v[28:31], v7 offset:7168
v_mul_f32 v214, v214, v118
v_mfma_f32_16x16x32_bf16 v[168:171], v[32:35], a[68:71], v[168:171]
v_rcp_f32 v211, v211
v_mfma_f32_16x16x32_bf16 v[164:167], v[36:39], a[64:67], v[164:167]
ds_read_b128 v[32:35], v7 offset:8192
global_load_lds_dwordx4 v4, s[20:21] offset:3072 sc1
v_mfma_f32_16x16x32_bf16 v[172:175], v[36:39], a[68:71], v[172:175]
s_waitcnt vmcnt(8)
s_atomic_add s45, s[20:21], s57 offset:224
v_fma_f32 v212, v212, v74, v74
s_waitcnt lgkmcnt(4)
v_mfma_f32_16x16x32_bf16 v[176:179], v[40:43], a[64:67], v[176:179]
ds_read_b128 v[36:39], v7 offset:9216
v_mul_f32 v114, v210, v114
v_mfma_f32_16x16x32_bf16 v[184:187], v[40:43], a[68:71], v[184:187]
v_cvt_pk_bf16_f32 v240, v112, v113
v_mul_f32 v209, v121, v121
v_mfma_f32_16x16x32_bf16 v[180:183], v[44:47], a[64:67], v[180:183]
ds_read_b128 v[40:43], v7 offset:10240
global_load_dwordx4 a[152:155], v5, s[20:21] offset:2048 sc1
v_mfma_f32_16x16x32_bf16 v[188:191], v[44:47], a[68:71], v[188:191]
v_exp_f32 v214, v214
v_fma_f32 v208, v208, v76, v75
v_mfma_f32_16x16x32_bf16 v[128:131], v[16:19], a[64:67], v[128:131]
ds_read_b128 v[44:47], v7 offset:11264
v_mul_f32 v215, v215, v119
v_mfma_f32_16x16x32_bf16 v[136:139], v[16:19], a[68:71], v[136:139]
v_fma_f32 v213, v213, v74, v74
s_waitcnt lgkmcnt(4)
v_mfma_f32_16x16x32_bf16 v[132:135], v[20:23], a[64:67], v[132:135]
ds_read_b128 v[16:19], v7 offset:12288
global_load_dwordx4 a[156:159], v5, s[20:21] offset:3072 sc1
v_mfma_f32_16x16x32_bf16 v[140:143], v[20:23], a[68:71], v[140:143]
v_rcp_f32 v212, v212
v_mul_f32 v115, v211, v115
v_mfma_f32_16x16x32_bf16 v[144:147], v[24:27], a[64:67], v[144:147]
ds_read_b128 v[20:23], v7 offset:13312
v_mul_f32 v210, v122, v122
v_mfma_f32_16x16x32_bf16 v[152:155], v[24:27], a[68:71], v[152:155]
v_exp_f32 v215, v215
v_mfma_f32_16x16x32_bf16 v[148:151], v[28:31], a[64:67], v[148:151]
ds_read_b128 v[24:27], v7 offset:14336
v_add_u32 v5, 8192, v5
v_mfma_f32_16x16x32_bf16 v[156:159], v[28:31], a[68:71], v[156:159]
global_load_dwordx4 a[160:163], v5, s[20:21] offset:-4096 sc1
v_fma_f32 v209, v209, v76, v75
v_mul_f32 v208, v208, v120
v_fma_f32 v214, v214, v74, v74
s_waitcnt lgkmcnt(4)
v_mfma_f32_16x16x32_bf16 v[160:163], v[32:35], a[72:75], v[160:163]
ds_read_b128 v[28:31], v7 offset:15360
v_mul_f32 v116, v212, v116
v_mfma_f32_16x16x32_bf16 v[168:171], v[32:35], a[76:79], v[168:171]
v_rcp_f32 v213, v213
v_mfma_f32_16x16x32_bf16 v[164:167], v[36:39], a[72:75], v[164:167]
s_barrier
ds_read_b128 v[32:35], v7 offset:16384
v_mfma_f32_16x16x32_bf16 v[172:175], v[36:39], a[76:79], v[172:175]
global_load_dwordx4 a[164:167], v5, s[20:21] offset:-3072 sc1
v_cvt_pk_bf16_f32 v241, v114, v115
v_mul_f32 v211, v123, v123
v_mfma_f32_16x16x32_bf16 v[176:179], v[40:43], a[72:75], v[176:179]
ds_read_b128 v[36:39], v7 offset:17408
v_fma_f32 v210, v210, v76, v75
v_mfma_f32_16x16x32_bf16 v[184:187], v[40:43], a[76:79], v[184:187]
v_mul_f32 v209, v209, v121
s_waitcnt lgkmcnt(4)
v_mfma_f32_16x16x32_bf16 v[180:183], v[44:47], a[72:75], v[180:183]
ds_read_b128 v[40:43], v7 offset:18432
s_add_u32 m0, s43, 49152
v_mfma_f32_16x16x32_bf16 v[188:191], v[44:47], a[76:79], v[188:191]
v_add_u32 v4, 16384, v4
v_fma_f32 v215, v215, v74, v74
v_exp_f32 v208, v208
v_mfma_f32_16x16x32_bf16 v[128:131], v[16:19], a[72:75], v[128:131]
ds_read_b128 v[44:47], v7 offset:19456
global_load_lds_dwordx4 v4, s[20:21] offset:0 sc1
v_mfma_f32_16x16x32_bf16 v[136:139], v[16:19], a[76:79], v[136:139]
v_rcp_f32 v214, v214
v_mul_f32 v117, v213, v117
v_mul_f32 v212, v124, v124
v_mfma_f32_16x16x32_bf16 v[132:135], v[20:23], a[72:75], v[132:135]
ds_read_b128 v[16:19], v7 offset:20480
global_load_lds_dwordx4 v4, s[20:21] offset:1024 sc1
v_mfma_f32_16x16x32_bf16 v[140:143], v[20:23], a[76:79], v[140:143]
v_fma_f32 v211, v211, v76, v75
v_mul_f32 v210, v210, v122
s_waitcnt lgkmcnt(4)
v_mfma_f32_16x16x32_bf16 v[144:147], v[24:27], a[72:75], v[144:147]
ds_read_b128 v[20:23], v7 offset:21504
v_fma_f32 v208, v208, v77, v77
v_mfma_f32_16x16x32_bf16 v[152:155], v[24:27], a[76:79], v[152:155]
v_exp_f32 v209, v209
v_mfma_f32_16x16x32_bf16 v[148:151], v[28:31], a[72:75], v[148:151]
ds_read_b128 v[24:27], v7 offset:22528
global_load_lds_dwordx4 v4, s[20:21] offset:2048 sc1
v_mfma_f32_16x16x32_bf16 v[156:159], v[28:31], a[76:79], v[156:159]
v_rcp_f32 v215, v215
v_mul_f32 v118, v214, v118
v_mfma_f32_16x16x32_bf16 v[160:163], v[32:35], a[80:83], v[160:163]
ds_read_b128 v[28:31], v7 offset:23552
v_cvt_pk_bf16_f32 v242, v116, v117
v_mfma_f32_16x16x32_bf16 v[168:171], v[32:35], a[84:87], v[168:171]
v_mul_f32 v213, v125, v125
v_fma_f32 v212, v212, v76, v75
s_waitcnt lgkmcnt(4)
v_mfma_f32_16x16x32_bf16 v[164:167], v[36:39], a[80:83], v[164:167]
ds_read_b128 v[32:35], v7 offset:24576
global_load_lds_dwordx4 v4, s[20:21] offset:3072 sc1
v_mfma_f32_16x16x32_bf16 v[172:175], v[36:39], a[84:87], v[172:175]
v_exp_f32 v210, v210
v_mul_f32 v211, v211, v123
v_mfma_f32_16x16x32_bf16 v[176:179], v[40:43], a[80:83], v[176:179]
ds_read_b128 v[36:39], v7 offset:25600
v_fma_f32 v209, v209, v77, v77
v_mfma_f32_16x16x32_bf16 v[184:187], v[40:43], a[84:87], v[184:187]
v_rcp_f32 v208, v208
v_mfma_f32_16x16x32_bf16 v[180:183], v[44:47], a[80:83], v[180:183]
ds_read_b128 v[40:43], v7 offset:26624
global_load_dwordx4 a[168:171], v5, s[20:21] offset:-2048 sc1
v_mfma_f32_16x16x32_bf16 v[188:191], v[44:47], a[84:87], v[188:191]
v_mul_f32 v119, v215, v119
v_mul_f32 v214, v126, v126
s_waitcnt lgkmcnt(4)
v_mfma_f32_16x16x32_bf16 v[128:131], v[16:19], a[80:83], v[128:131]
ds_read_b128 v[44:47], v7 offset:27648
v_fma_f32 v213, v213, v76, v75
v_mfma_f32_16x16x32_bf16 v[136:139], v[16:19], a[84:87], v[136:139]
v_exp_f32 v211, v211
v_mfma_f32_16x16x32_bf16 v[132:135], v[20:23], a[80:83], v[132:135]
ds_read_b128 v[16:19], v7 offset:28672
global_load_dwordx4 a[172:175], v5, s[20:21] offset:-1024 sc1
v_mfma_f32_16x16x32_bf16 v[140:143], v[20:23], a[84:87], v[140:143]
v_rcp_f32 v209, v209
v_mul_f32 v212, v212, v124
v_mfma_f32_16x16x32_bf16 v[144:147], v[24:27], a[80:83], v[144:147]
ds_read_b128 v[20:23], v7 offset:29696
v_fma_f32 v210, v210, v77, v77
v_mfma_f32_16x16x32_bf16 v[152:155], v[24:27], a[84:87], v[152:155]
v_mul_f32 v120, v208, v120
v_cvt_pk_bf16_f32 v243, v118, v119
s_waitcnt lgkmcnt(4)
v_mfma_f32_16x16x32_bf16 v[148:151], v[28:31], a[80:83], v[148:151]
ds_read_b128 v[24:27], v7 offset:30720
global_load_dwordx4 a[176:179], v5, s[20:21] offset:0 sc1
v_mfma_f32_16x16x32_bf16 v[156:159], v[28:31], a[84:87], v[156:159]
v_exp_f32 v212, v212
v_mul_f32 v215, v127, v127
v_mfma_f32_16x16x32_bf16 v[160:163], v[32:35], a[88:91], v[160:163]
ds_read_b128 v[28:31], v7 offset:31744
v_mfma_f32_16x16x32_bf16 v[168:171], v[32:35], a[92:95], v[168:171]
s_atomic_add s59, s[20:21], s57 offset:224 glc
v_fma_f32 v214, v214, v76, v75
v_mfma_f32_16x16x32_bf16 v[164:167], v[36:39], a[88:91], v[164:167]
s_barrier
ds_read_b128 v[32:35], v7 offset:32768
v_mfma_f32_16x16x32_bf16 v[172:175], v[36:39], a[92:95], v[172:175]
global_load_dwordx4 a[180:183], v5, s[20:21] offset:1024 sc1
v_mul_f32 v213, v213, v125
v_fma_f32 v211, v211, v77, v77
s_waitcnt lgkmcnt(4)
v_mfma_f32_16x16x32_bf16 v[176:179], v[40:43], a[88:91], v[176:179]
ds_read_b128 v[36:39], v7 offset:33792
v_mul_f32 v121, v209, v121
v_mfma_f32_16x16x32_bf16 v[184:187], v[40:43], a[92:95], v[184:187]
v_rcp_f32 v210, v210
v_mfma_f32_16x16x32_bf16 v[180:183], v[44:47], a[88:91], v[180:183]
ds_read_b128 v[40:43], v7 offset:34816
global_load_dwordx4 a[184:187], v5, s[20:21] offset:2048 sc1
v_mfma_f32_16x16x32_bf16 v[188:191], v[44:47], a[92:95], v[188:191]
v_exp_f32 v213, v213
v_fma_f32 v215, v215, v76, v75
v_mfma_f32_16x16x32_bf16 v[128:131], v[16:19], a[88:91], v[128:131]
ds_read_b128 v[44:47], v7 offset:35840
v_mul_f32 v214, v214, v126
v_mfma_f32_16x16x32_bf16 v[136:139], v[16:19], a[92:95], v[136:139]
v_fma_f32 v212, v212, v77, v77
s_waitcnt lgkmcnt(4)
v_mfma_f32_16x16x32_bf16 v[132:135], v[20:23], a[88:91], v[132:135]
ds_read_b128 v[16:19], v7 offset:36864
global_load_dwordx4 a[188:191], v5, s[20:21] offset:3072 sc1
v_mfma_f32_16x16x32_bf16 v[140:143], v[20:23], a[92:95], v[140:143]
v_rcp_f32 v211, v211
v_mul_f32 v122, v210, v122
v_mfma_f32_16x16x32_bf16 v[144:147], v[24:27], a[88:91], v[144:147]
ds_read_b128 v[20:23], v7 offset:37888
v_cvt_pk_bf16_f32 v244, v120, v121
v_mfma_f32_16x16x32_bf16 v[152:155], v[24:27], a[92:95], v[152:155]
v_exp_f32 v214, v214
v_mfma_f32_16x16x32_bf16 v[148:151], v[28:31], a[88:91], v[148:151]
ds_read_b128 v[24:27], v7 offset:38912
s_add_u32 m0, s43, 65536
v_mfma_f32_16x16x32_bf16 v[156:159], v[28:31], a[92:95], v[156:159]
v_add_u32 v4, 16384, v4
v_mul_f32 v215, v215, v127
v_fma_f32 v213, v213, v77, v77
s_waitcnt lgkmcnt(4)
v_mfma_f32_16x16x32_bf16 v[160:163], v[32:35], a[96:99], v[160:163]
ds_read_b128 v[28:31], v7 offset:39936
global_load_lds_dwordx4 v4, s[20:21] offset:0 sc1
v_mfma_f32_16x16x32_bf16 v[168:171], v[32:35], a[100:103], v[168:171]
v_rcp_f32 v212, v212
v_mul_f32 v123, v211, v123
v_mfma_f32_16x16x32_bf16 v[164:167], v[36:39], a[96:99], v[164:167]
ds_read_b128 v[32:35], v7 offset:40960
global_load_lds_dwordx4 v4, s[20:21] offset:1024 sc1
v_mfma_f32_16x16x32_bf16 v[172:175], v[36:39], a[100:103], v[172:175]
v_exp_f32 v215, v215
v_fma_f32 v214, v214, v77, v77
v_mfma_f32_16x16x32_bf16 v[176:179], v[40:43], a[96:99], v[176:179]
v_rcp_f32 v213, v213
v_mfma_f32_16x16x32_bf16 v[184:187], v[40:43], a[100:103], v[184:187]
ds_read_b128 v[36:39], v7 offset:41984
v_mul_f32 v124, v212, v124
s_waitcnt lgkmcnt(4)
v_mfma_f32_16x16x32_bf16 v[180:183], v[44:47], a[96:99], v[180:183]
ds_read_b128 v[40:43], v7 offset:43008
global_load_lds_dwordx4 v4, s[20:21] offset:2048 sc1
v_mfma_f32_16x16x32_bf16 v[188:191], v[44:47], a[100:103], v[188:191]
v_rcp_f32 v214, v214
v_cvt_pk_bf16_f32 v245, v122, v123
v_mfma_f32_16x16x32_bf16 v[128:131], v[16:19], a[96:99], v[128:131]
ds_read_b128 v[44:47], v7 offset:44032
v_fma_f32 v215, v215, v77, v77
v_mfma_f32_16x16x32_bf16 v[136:139], v[16:19], a[100:103], v[136:139]
v_rcp_f32 v215, v215
v_mfma_f32_16x16x32_bf16 v[132:135], v[20:23], a[96:99], v[132:135]
ds_read_b128 v[16:19], v7 offset:45056
global_load_lds_dwordx4 v4, s[20:21] offset:3072 sc1
v_mfma_f32_16x16x32_bf16 v[140:143], v[20:23], a[100:103], v[140:143]
v_mul_f32 v125, v213, v125
v_mul_f32 v126, v214, v126
v_cvt_pk_bf16_f32 v246, v124, v125
s_waitcnt lgkmcnt(4)
v_mfma_f32_16x16x32_bf16 v[144:147], v[24:27], a[96:99], v[144:147]
ds_read_b128 v[20:23], v7 offset:46080
v_mul_f32 v127, v215, v127
v_mfma_f32_16x16x32_bf16 v[152:155], v[24:27], a[100:103], v[152:155]
v_cvt_pk_bf16_f32 v247, v126, v127
s_add_u32 s38, s47, 55672832
v_mfma_f32_16x16x32_bf16 v[148:151], v[28:31], a[96:99], v[148:151]
ds_read_b128 v[24:27], v7 offset:47104
buffer_store_dwordx4 v[240:243], v0, s[20:23], s38 offen offset:0 sc1
buffer_store_dwordx4 v[244:247], v0, s[20:23], s38 offen offset:1024 sc1
v_mfma_f32_16x16x32_bf16 v[156:159], v[28:31], a[100:103], v[156:159]
v_add_u32 v5, 8192, v5
s_mov_b32 s58, 0
v_mfma_f32_16x16x32_bf16 v[160:163], v[32:35], a[104:107], v[160:163]
ds_read_b128 v[28:31], v7 offset:48128
global_load_dwordx4 a[192:195], v5, s[20:21] offset:-4096 sc1
v_mfma_f32_16x16x32_bf16 v[168:171], v[32:35], a[108:111], v[168:171]
s_cmp_lt_u32 s59, 8
s_cbranch_scc0 L_back28
L_slow28:
s_waitcnt lgkmcnt(0)
s_cmp_ge_u32 s59, 8
s_cbranch_scc1 L_back28
s_mov_b32 s59, 0
s_atomic_add s59, s[20:21], s57 offset:224 glc
s_sub_u32 s46, s46, 1
s_cbranch_scc0 L_slow28
s_endpgm
L_back28:
s_add_u32 s41, s52, 4194304
s_waitcnt lgkmcnt(3)
v_mfma_f32_16x16x32_bf16 v[164:167], v[36:39], a[104:107], v[164:167]
s_barrier
ds_read_b128 v[32:35], v7 offset:49152
v_mfma_f32_16x16x32_bf16 v[172:175], v[36:39], a[108:111], v[172:175]
s_add_u32 s37, s51, 4194304
v_mfma_f32_16x16x32_bf16 v[176:179], v[40:43], a[104:107], v[176:179]
ds_read_b128 v[36:39], v7 offset:50176
v_mfma_f32_16x16x32_bf16 v[184:187], v[40:43], a[108:111], v[184:187]
v_mfma_f32_16x16x32_bf16 v[180:183], v[44:47], a[104:107], v[180:183]
ds_read_b128 v[40:43], v7 offset:51200
v_mfma_f32_16x16x32_bf16 v[188:191], v[44:47], a[108:111], v[188:191]
v_mfma_f32_16x16x32_bf16 v[128:131], v[16:19], a[104:107], v[128:131]
ds_read_b128 v[44:47], v7 offset:52224
v_mfma_f32_16x16x32_bf16 v[136:139], v[16:19], a[108:111], v[136:139]
s_waitcnt lgkmcnt(3)
v_mfma_f32_16x16x32_bf16 v[132:135], v[20:23], a[104:107], v[132:135]
ds_read_b128 v[16:19], v7 offset:53248
global_load_dwordx4 a[196:199], v5, s[20:21] offset:-3072 sc1
v_mfma_f32_16x16x32_bf16 v[140:143], v[20:23], a[108:111], v[140:143]
v_mfma_f32_16x16x32_bf16 v[144:147], v[24:27], a[104:107], v[144:147]
ds_read_b128 v[20:23], v7 offset:54272
v_mfma_f32_16x16x32_bf16 v[152:155], v[24:27], a[108:111], v[152:155]
v_mfma_f32_16x16x32_bf16 v[148:151], v[28:31], a[104:107], v[148:151]
ds_read_b128 v[24:27], v7 offset:55296
global_load_dwordx4 a[200:203], v5, s[20:21] offset:-2048 sc1
v_mfma_f32_16x16x32_bf16 v[156:159], v[28:31], a[108:111], v[156:159]
v_mfma_f32_16x16x32_bf16 v[160:163], v[32:35], a[112:115], v[160:163]
ds_read_b128 v[28:31], v7 offset:56320
v_mfma_f32_16x16x32_bf16 v[168:171], v[32:35], a[116:119], v[168:171]
s_waitcnt lgkmcnt(3)
v_mfma_f32_16x16x32_bf16 v[164:167], v[36:39], a[112:115], v[164:167]
ds_read_b128 v[32:35], v7 offset:57344
v_mfma_f32_16x16x32_bf16 v[172:175], v[36:39], a[116:119], v[172:175]
v_mfma_f32_16x16x32_bf16 v[176:179], v[40:43], a[112:115], v[176:179]
ds_read_b128 v[36:39], v7 offset:58368
global_load_dwordx4 a[204:207], v5, s[20:21] offset:-1024 sc1
v_mfma_f32_16x16x32_bf16 v[184:187], v[40:43], a[116:119], v[184:187]
v_mfma_f32_16x16x32_bf16 v[180:183], v[44:47], a[112:115], v[180:183]
ds_read_b128 v[40:43], v7 offset:59392
v_mfma_f32_16x16x32_bf16 v[188:191], v[44:47], a[116:119], v[188:191]
v_mfma_f32_16x16x32_bf16 v[128:131], v[16:19], a[112:115], v[128:131]
ds_read_b128 v[44:47], v7 offset:60416
global_load_dwordx4 a[208:211], v5, s[20:21] offset:0 sc1
v_mfma_f32_16x16x32_bf16 v[136:139], v[16:19], a[116:119], v[136:139]
s_waitcnt lgkmcnt(3)
v_mfma_f32_16x16x32_bf16 v[132:135], v[20:23], a[112:115], v[132:135]
ds_read_b128 v[16:19], v7 offset:61440
v_mfma_f32_16x16x32_bf16 v[140:143], v[20:23], a[116:119], v[140:143]
v_mfma_f32_16x16x32_bf16 v[144:147], v[24:27], a[112:115], v[144:147]
ds_read_b128 v[20:23], v7 offset:62464
global_load_dwordx4 a[212:215], v5, s[20:21] offset:1024 sc1
v_mfma_f32_16x16x32_bf16 v[152:155], v[24:27], a[116:119], v[152:155]
v_mfma_f32_16x16x32_bf16 v[148:151], v[28:31], a[112:115], v[148:151]
ds_read_b128 v[24:27], v7 offset:63488
v_mfma_f32_16x16x32_bf16 v[156:159], v[28:31], a[116:119], v[156:159]
v_mfma_f32_16x16x32_bf16 v[160:163], v[32:35], a[120:123], v[160:163]
ds_read_b128 v[28:31], v7 offset:64512
global_load_dwordx4 a[216:219], v5, s[20:21] offset:2048 sc1
v_mfma_f32_16x16x32_bf16 v[168:171], v[32:35], a[124:127], v[168:171]
s_waitcnt lgkmcnt(3)
v_mfma_f32_16x16x32_bf16 v[164:167], v[36:39], a[120:123], v[164:167]
s_barrier
ds_read_b128 v[32:35], v6 offset:0
v_mfma_f32_16x16x32_bf16 v[172:175], v[36:39], a[124:127], v[172:175]
v_mfma_f32_16x16x32_bf16 v[176:179], v[40:43], a[120:123], v[176:179]
ds_read_b128 v[36:39], v6 offset:1024
v_mfma_f32_16x16x32_bf16 v[184:187], v[40:43], a[124:127], v[184:187]
v_mfma_f32_16x16x32_bf16 v[180:183], v[44:47], a[120:123], v[180:183]
ds_read_b128 v[40:43], v6 offset:2048
global_load_dwordx4 a[220:223], v5, s[20:21] offset:3072 sc1
v_mfma_f32_16x16x32_bf16 v[188:191], v[44:47], a[124:127], v[188:191]
s_waitcnt vmcnt(8)
s_atomic_add s45, s[20:21], s57 offset:232
v_mfma_f32_16x16x32_bf16 v[128:131], v[16:19], a[120:123], v[128:131]
ds_read_b128 v[44:47], v6 offset:3072
v_mfma_f32_16x16x32_bf16 v[136:139], v[16:19], a[124:127], v[136:139]
s_waitcnt lgkmcnt(4)
v_mfma_f32_16x16x32_bf16 v[132:135], v[20:23], a[120:123], v[132:135]
ds_read_b128 v[16:19], v6 offset:4096
s_add_u32 m0, s43, 81920
v_mfma_f32_16x16x32_bf16 v[140:143], v[20:23], a[124:127], v[140:143]
v_add_u32 v4, 16384, v4
v_mfma_f32_16x16x32_bf16 v[144:147], v[24:27], a[120:123], v[144:147]
ds_read_b128 v[20:23], v6 offset:5120
global_load_lds_dwordx4 v4, s[20:21] offset:0 sc1
v_mfma_f32_16x16x32_bf16 v[152:155], v[24:27], a[124:127], v[152:155]
v_mfma_f32_16x16x32_bf16 v[148:151], v[28:31], a[120:123], v[148:151]
ds_read_b128 v[24:27], v6 offset:6144
global_load_lds_dwordx4 v4, s[20:21] offset:1024 sc1
v_mfma_f32_16x16x32_bf16 v[156:159], v[28:31], a[124:127], v[156:159]
s_waitcnt lgkmcnt(4)
v_mfma_f32_16x16x32_bf16 v[160:163], v[32:35], a[128:131], v[160:163]
ds_read_b128 v[28:31], v6 offset:7168
v_mfma_f32_16x16x32_bf16 v[168:171], v[32:35], a[132:135], v[168:171]
v_mfma_f32_16x16x32_bf16 v[164:167], v[36:39], a[128:131], v[164:167]
ds_read_b128 v[32:35], v6 offset:8192
global_load_lds_dwordx4 v4, s[20:21] offset:2048 sc1
v_mfma_f32_16x16x32_bf16 v[172:175], v[36:39], a[132:135], v[172:175]
v_mfma_f32_16x16x32_bf16 v[176:179], v[40:43], a[128:131], v[176:179]
ds_read_b128 v[36:39], v6 offset:9216
v_mfma_f32_16x16x32_bf16 v[184:187], v[40:43], a[132:135], v[184:187]
s_waitcnt lgkmcnt(4)
v_mfma_f32_16x16x32_bf16 v[180:183], v[44:47], a[128:131], v[180:183]
ds_read_b128 v[40:43], v6 offset:10240
v_mfma_f32_16x16x32_bf16 v[188:191], v[44:47], a[132:135], v[188:191]
v_mfma_f32_16x16x32_bf16 v[128:131], v[16:19], a[128:131], v[128:131]
ds_read_b128 v[44:47], v6 offset:11264
global_load_lds_dwordx4 v4, s[20:21] offset:3072 sc1
v_mfma_f32_16x16x32_bf16 v[136:139], v[16:19], a[132:135], v[136:139]
v_mfma_f32_16x16x32_bf16 v[132:135], v[20:23], a[128:131], v[132:135]
ds_read_b128 v[16:19], v6 offset:12288
v_mfma_f32_16x16x32_bf16 v[140:143], v[20:23], a[132:135], v[140:143]
s_waitcnt lgkmcnt(4)
v_mfma_f32_16x16x32_bf16 v[144:147], v[24:27], a[128:131], v[144:147]
ds_read_b128 v[20:23], v6 offset:13312
v_add_u32 v5, 8192, v5
v_mfma_f32_16x16x32_bf16 v[152:155], v[24:27], a[132:135], v[152:155]
global_load_dwordx4 a[224:227], v5, s[20:21] offset:-4096 sc1
v_mfma_f32_16x16x32_bf16 v[148:151], v[28:31], a[128:131], v[148:151]
ds_read_b128 v[24:27], v6 offset:14336
v_mfma_f32_16x16x32_bf16 v[156:159], v[28:31], a[132:135], v[156:159]
v_mfma_f32_16x16x32_bf16 v[160:163], v[32:35], a[136:139], v[160:163]
ds_read_b128 v[28:31], v6 offset:15360
global_load_dwordx4 a[228:231], v5, s[20:21] offset:-3072 sc1
v_mfma_f32_16x16x32_bf16 v[168:171], v[32:35], a[140:143], v[168:171]
s_waitcnt lgkmcnt(4)
v_mfma_f32_16x16x32_bf16 v[164:167], v[36:39], a[136:139], v[164:167]
s_barrier
ds_read_b128 v[32:35], v6 offset:16384
v_mfma_f32_16x16x32_bf16 v[172:175], v[36:39], a[140:143], v[172:175]
v_mfma_f32_16x16x32_bf16 v[176:179], v[40:43], a[136:139], v[176:179]
ds_read_b128 v[36:39], v6 offset:17408
global_load_dwordx4 a[232:235], v5, s[20:21] offset:-2048 sc1
v_mfma_f32_16x16x32_bf16 v[184:187], v[40:43], a[140:143], v[184:187]
v_mfma_f32_16x16x32_bf16 v[180:183], v[44:47], a[136:139], v[180:183]
ds_read_b128 v[40:43], v6 offset:18432
v_mfma_f32_16x16x32_bf16 v[188:191], v[44:47], a[140:143], v[188:191]
s_waitcnt lgkmcnt(4)
v_mfma_f32_16x16x32_bf16 v[128:131], v[16:19], a[136:139], v[128:131]
ds_read_b128 v[44:47], v6 offset:19456
v_mfma_f32_16x16x32_bf16 v[136:139], v[16:19], a[140:143], v[136:139]
v_mfma_f32_16x16x32_bf16 v[132:135], v[20:23], a[136:139], v[132:135]
ds_read_b128 v[16:19], v6 offset:20480
global_load_dwordx4 a[236:239], v5, s[20:21] offset:-1024 sc1
v_mfma_f32_16x16x32_bf16 v[140:143], v[20:23], a[140:143], v[140:143]
v_mfma_f32_16x16x32_bf16 v[144:147], v[24:27], a[136:139], v[144:147]
ds_read_b128 v[20:23], v6 offset:21504
v_mfma_f32_16x16x32_bf16 v[152:155], v[24:27], a[140:143], v[152:155]
s_waitcnt lgkmcnt(4)
v_mfma_f32_16x16x32_bf16 v[148:151], v[28:31], a[136:139], v[148:151]
ds_read_b128 v[24:27], v6 offset:22528
global_load_dwordx4 a[240:243], v5, s[20:21] offset:0 sc1
v_mfma_f32_16x16x32_bf16 v[156:159], v[28:31], a[140:143], v[156:159]
v_mfma_f32_16x16x32_bf16 v[160:163], v[32:35], a[144:147], v[160:163]
ds_read_b128 v[28:31], v6 offset:23552
v_mfma_f32_16x16x32_bf16 v[168:171], v[32:35], a[148:151], v[168:171]
v_mfma_f32_16x16x32_bf16 v[164:167], v[36:39], a[144:147], v[164:167]
ds_read_b128 v[32:35], v6 offset:24576
global_load_dwordx4 a[244:247], v5, s[20:21] offset:1024 sc1
v_mfma_f32_16x16x32_bf16 v[172:175], v[36:39], a[148:151], v[172:175]
s_waitcnt lgkmcnt(4)
v_mfma_f32_16x16x32_bf16 v[176:179], v[40:43], a[144:147], v[176:179]
ds_read_b128 v[36:39], v6 offset:25600
v_mfma_f32_16x16x32_bf16 v[184:187], v[40:43], a[148:151], v[184:187]
v_mfma_f32_16x16x32_bf16 v[180:183], v[44:47], a[144:147], v[180:183]
ds_read_b128 v[40:43], v6 offset:26624
global_load_dwordx4 a[248:251], v5, s[20:21] offset:2048 sc1
v_mfma_f32_16x16x32_bf16 v[188:191], v[44:47], a[148:151], v[188:191]
v_mfma_f32_16x16x32_bf16 v[128:131], v[16:19], a[144:147], v[128:131]
s_atomic_add s58, s[20:21], s57 offset:232 glc
v_mfma_f32_16x16x32_bf16 v[136:139], v[16:19], a[148:151], v[136:139]
ds_read_b128 v[44:47], v6 offset:27648
s_waitcnt lgkmcnt(4)
v_mfma_f32_16x16x32_bf16 v[132:135], v[20:23], a[144:147], v[132:135]
ds_read_b128 v[16:19], v6 offset:28672
v_mfma_f32_16x16x32_bf16 v[140:143], v[20:23], a[148:151], v[140:143]
v_mfma_f32_16x16x32_bf16 v[144:147], v[24:27], a[144:147], v[144:147]
ds_read_b128 v[20:23], v6 offset:29696
global_load_dwordx4 a[252:255], v5, s[20:21] offset:3072 sc1
v_mfma_f32_16x16x32_bf16 v[152:155], v[24:27], a[148:151], v[152:155]
v_mfma_f32_16x16x32_bf16 v[148:151], v[28:31], a[144:147], v[148:151]
ds_read_b128 v[24:27], v6 offset:30720
v_mfma_f32_16x16x32_bf16 v[156:159], v[28:31], a[148:151], v[156:159]
s_waitcnt lgkmcnt(4)
v_mfma_f32_16x16x32_bf16 v[160:163], v[32:35], a[152:155], v[160:163]
ds_read_b128 v[28:31], v6 offset:31744
s_add_u32 m0, s43, 98304
v_mfma_f32_16x16x32_bf16 v[168:171], v[32:35], a[156:159], v[168:171]
v_add_u32 v4, 16384, v4
v_mfma_f32_16x16x32_bf16 v[164:167], v[36:39], a[152:155], v[164:167]
s_barrier
ds_read_b128 v[32:35], v6 offset:32768
v_mfma_f32_16x16x32_bf16 v[172:175], v[36:39], a[156:159], v[172:175]
global_load_lds_dwordx4 v4, s[20:21] offset:0 sc1
v_mfma_f32_16x16x32_bf16 v[176:179], v[40:43], a[152:155], v[176:179]
ds_read_b128 v[36:39], v6 offset:33792
global_load_lds_dwordx4 v4, s[20:21] offset:1024 sc1
v_mfma_f32_16x16x32_bf16 v[184:187], v[40:43], a[156:159], v[184:187]
s_waitcnt lgkmcnt(4)
v_mfma_f32_16x16x32_bf16 v[180:183], v[44:47], a[152:155], v[180:183]
ds_read_b128 v[40:43], v6 offset:34816
v_mfma_f32_16x16x32_bf16 v[188:191], v[44:47], a[156:159], v[188:191]
v_mfma_f32_16x16x32_bf16 v[128:131], v[16:19], a[152:155], v[128:131]
ds_read_b128 v[44:47], v6 offset:35840
global_load_lds_dwordx4 v4, s[20:21] offset:2048 sc1
v_mfma_f32_16x16x32_bf16 v[136:139], v[16:19], a[156:159], v[136:139]
v_mfma_f32_16x16x32_bf16 v[132:135], v[20:23], a[152:155], v[132:135]
ds_read_b128 v[16:19], v6 offset:36864
v_mfma_f32_16x16x32_bf16 v[140:143], v[20:23], a[156:159], v[140:143]
s_waitcnt lgkmcnt(4)
v_mfma_f32_16x16x32_bf16 v[144:147], v[24:27], a[152:155], v[144:147]
ds_read_b128 v[20:23], v6 offset:37888
v_mfma_f32_16x16x32_bf16 v[152:155], v[24:27], a[156:159], v[152:155]
v_mfma_f32_16x16x32_bf16 v[148:151], v[28:31], a[152:155], v[148:151]
ds_read_b128 v[24:27], v6 offset:38912
global_load_lds_dwordx4 v4, s[20:21] offset:3072 sc1
v_mfma_f32_16x16x32_bf16 v[156:159], v[28:31], a[156:159], v[156:159]
v_mfma_f32_16x16x32_bf16 v[160:163], v[32:35], a[160:163], v[160:163]
ds_read_b128 v[28:31], v6 offset:39936
v_mfma_f32_16x16x32_bf16 v[168:171], v[32:35], a[164:167], v[168:171]
s_waitcnt lgkmcnt(4)
v_mfma_f32_16x16x32_bf16 v[164:167], v[36:39], a[160:163], v[164:167]
ds_read_b128 v[32:35], v6 offset:40960
v_add_u32 v5, 8192, v5
v_mfma_f32_16x16x32_bf16 v[172:175], v[36:39], a[164:167], v[172:175]
global_load_dwordx4 a[0:3], v5, s[20:21] offset:-4096 sc1
v_mfma_f32_16x16x32_bf16 v[176:179], v[40:43], a[160:163], v[176:179]
ds_read_b128 v[36:39], v6 offset:41984
v_mfma_f32_16x16x32_bf16 v[184:187], v[40:43], a[164:167], v[184:187]
v_mfma_f32_16x16x32_bf16 v[180:183], v[44:47], a[160:163], v[180:183]
ds_read_b128 v[40:43], v6 offset:43008
global_load_dwordx4 a[4:7], v5, s[20:21] offset:-3072 sc1
v_mfma_f32_16x16x32_bf16 v[188:191], v[44:47], a[164:167], v[188:191]
s_waitcnt lgkmcnt(4)
v_mfma_f32_16x16x32_bf16 v[128:131], v[16:19], a[160:163], v[128:131]
ds_read_b128 v[44:47], v6 offset:44032
v_mfma_f32_16x16x32_bf16 v[136:139], v[16:19], a[164:167], v[136:139]
v_mfma_f32_16x16x32_bf16 v[132:135], v[20:23], a[160:163], v[132:135]
ds_read_b128 v[16:19], v6 offset:45056
global_load_dwordx4 a[8:11], v5, s[20:21] offset:-2048 sc1
v_mfma_f32_16x16x32_bf16 v[140:143], v[20:23], a[164:167], v[140:143]
v_mfma_f32_16x16x32_bf16 v[160:163], v[24:27], a[168:171], v[160:163]
ds_read_b128 v[20:23], v6 offset:46080
v_mfma_f32_16x16x32_bf16 v[168:171], v[24:27], a[172:175], v[168:171]
s_waitcnt lgkmcnt(4)
v_mfma_f32_16x16x32_bf16 v[164:167], v[28:31], a[168:171], v[164:167]
ds_read_b128 v[24:27], v6 offset:47104
v_mfma_f32_16x16x32_bf16 v[172:175], v[28:31], a[172:175], v[172:175]
v_mfma_f32_16x16x32_bf16 v[176:179], v[32:35], a[168:171], v[176:179]
ds_read_b128 v[28:31], v6 offset:48128
global_load_dwordx4 a[12:15], v5, s[20:21] offset:-1024 sc1
v_mfma_f32_16x16x32_bf16 v[184:187], v[32:35], a[172:175], v[184:187]
v_mfma_f32_16x16x32_bf16 v[180:183], v[36:39], a[168:171], v[180:183]
s_barrier
ds_read_b128 v[32:35], v6 offset:49152
v_mfma_f32_16x16x32_bf16 v[188:191], v[36:39], a[172:175], v[188:191]
s_waitcnt lgkmcnt(4)
v_mfma_f32_16x16x32_bf16 v[128:131], v[40:43], a[168:171], v[128:131]
ds_read_b128 v[36:39], v6 offset:50176
global_load_dwordx4 a[16:19], v5, s[20:21] offset:0 sc1
v_mfma_f32_16x16x32_bf16 v[136:139], v[40:43], a[172:175], v[136:139]
v_mfma_f32_16x16x32_bf16 v[132:135], v[44:47], a[168:171], v[132:135]
ds_read_b128 v[40:43], v6 offset:51200
v_mfma_f32_16x16x32_bf16 v[140:143], v[44:47], a[172:175], v[140:143]
v_mfma_f32_16x16x32_bf16 v[160:163], v[16:19], a[176:179], v[160:163]
ds_read_b128 v[44:47], v6 offset:52224
global_load_dwordx4 a[20:23], v5, s[20:21] offset:1024 sc1
v_mfma_f32_16x16x32_bf16 v[168:171], v[16:19], a[180:183], v[168:171]
s_cmp_lt_u32 s58, 8
s_cbranch_scc0 L_back29
L_slow29:
s_waitcnt lgkmcnt(0)
s_cmp_ge_u32 s58, 8
s_cbranch_scc1 L_back29
s_mov_b32 s58, 0
s_atomic_add s58, s[20:21], s57 offset:232 glc
s_sub_u32 s46, s46, 1
s_cbranch_scc0 L_slow29
s_endpgm
L_back29:
s_waitcnt lgkmcnt(3)
v_mfma_f32_16x16x32_bf16 v[164:167], v[20:23], a[176:179], v[164:167]
ds_read_b128 v[16:19], v6 offset:53248
v_mfma_f32_16x16x32_bf16 v[172:175], v[20:23], a[180:183], v[172:175]
v_mfma_f32_16x16x32_bf16 v[176:179], v[24:27], a[176:179], v[176:179]
ds_read_b128 v[20:23], v6 offset:54272
global_load_dwordx4 a[24:27], v5, s[20:21] offset:2048 sc1
v_mfma_f32_16x16x32_bf16 v[184:187], v[24:27], a[180:183], v[184:187]
v_mfma_f32_16x16x32_bf16 v[180:183], v[28:31], a[176:179], v[180:183]
ds_read_b128 v[24:27], v6 offset:55296
v_mfma_f32_16x16x32_bf16 v[188:191], v[28:31], a[180:183], v[188:191]
v_mfma_f32_16x16x32_bf16 v[128:131], v[32:35], a[176:179], v[128:131]
ds_read_b128 v[28:31], v6 offset:56320
v_mfma_f32_16x16x32_bf16 v[136:139], v[32:35], a[180:183], v[136:139]
s_waitcnt lgkmcnt(3)
v_mfma_f32_16x16x32_bf16 v[132:135], v[36:39], a[176:179], v[132:135]
ds_read_b128 v[32:35], v6 offset:57344
global_load_dwordx4 a[28:31], v5, s[20:21] offset:3072 sc1
v_mfma_f32_16x16x32_bf16 v[140:143], v[36:39], a[180:183], v[140:143]
v_mfma_f32_16x16x32_bf16 v[160:163], v[40:43], a[184:187], v[160:163]
ds_read_b128 v[36:39], v6 offset:58368
v_mfma_f32_16x16x32_bf16 v[168:171], v[40:43], a[188:191], v[168:171]
v_mfma_f32_16x16x32_bf16 v[164:167], v[44:47], a[184:187], v[164:167]
ds_read_b128 v[40:43], v6 offset:59392
s_add_u32 m0, s43, 114688
v_mfma_f32_16x16x32_bf16 v[172:175], v[44:47], a[188:191], v[172:175]
v_add_u32 v4, 16384, v4
v_mfma_f32_16x16x32_bf16 v[176:179], v[16:19], a[184:187], v[176:179]
ds_read_b128 v[44:47], v6 offset:60416
global_load_lds_dwordx4 v4, s[20:21] offset:0 sc1
v_mfma_f32_16x16x32_bf16 v[184:187], v[16:19], a[188:191], v[184:187]
s_waitcnt vmcnt(31) lgkmcnt(3)
v_mfma_f32_16x16x32_bf16 v[180:183], v[20:23], a[184:187], v[180:183]
ds_read_b128 v[16:19], v6 offset:61440
global_load_lds_dwordx4 v4, s[20:21] offset:1024 sc1
v_mfma_f32_16x16x32_bf16 v[188:191], v[20:23], a[188:191], v[188:191]
v_mfma_f32_16x16x32_bf16 v[128:131], v[24:27], a[184:187], v[128:131]
ds_read_b128 v[20:23], v6 offset:62464
v_mfma_f32_16x16x32_bf16 v[136:139], v[24:27], a[188:191], v[136:139]
v_mfma_f32_16x16x32_bf16 v[132:135], v[28:31], a[184:187], v[132:135]
ds_read_b128 v[24:27], v6 offset:63488
global_load_lds_dwordx4 v4, s[20:21] offset:2048 sc1
v_mfma_f32_16x16x32_bf16 v[140:143], v[28:31], a[188:191], v[140:143]
v_mfma_f32_16x16x32_bf16 v[160:163], v[32:35], a[192:195], v[160:163]
ds_read_b128 v[28:31], v6 offset:64512
v_mfma_f32_16x16x32_bf16 v[168:171], v[32:35], a[196:199], v[168:171]
s_waitcnt vmcnt(31) lgkmcnt(3)
v_mfma_f32_16x16x32_bf16 v[164:167], v[36:39], a[192:195], v[164:167]
s_barrier
ds_read_b128 v[32:35], v7 offset:0
v_mfma_f32_16x16x32_bf16 v[172:175], v[36:39], a[196:199], v[172:175]
v_mfma_f32_16x16x32_bf16 v[176:179], v[40:43], a[192:195], v[176:179]
ds_read_b128 v[36:39], v7 offset:1024
global_load_lds_dwordx4 v4, s[20:21] offset:3072 sc1
v_mfma_f32_16x16x32_bf16 v[184:187], v[40:43], a[196:199], v[184:187]
v_mfma_f32_16x16x32_bf16 v[180:183], v[44:47], a[192:195], v[180:183]
ds_read_b128 v[40:43], v7 offset:2048
v_mfma_f32_16x16x32_bf16 v[188:191], v[44:47], a[196:199], v[188:191]
v_mfma_f32_16x16x32_bf16 v[160:163], v[16:19], a[200:203], v[160:163]
ds_read_b128 v[44:47], v7 offset:3072
v_add_u32 v5, 8192, v5
v_mfma_f32_16x16x32_bf16 v[168:171], v[16:19], a[204:207], v[168:171]
global_load_dwordx4 a[32:35], v5, s[20:21] offset:-4096 sc1
s_waitcnt vmcnt(31) lgkmcnt(3)
v_mfma_f32_16x16x32_bf16 v[164:167], v[20:23], a[200:203], v[164:167]
ds_read_b128 v[16:19], v7 offset:4096
v_mfma_f32_16x16x32_bf16 v[172:175], v[20:23], a[204:207], v[172:175]
v_mfma_f32_16x16x32_bf16 v[176:179], v[24:27], a[200:203], v[176:179]
ds_read_b128 v[20:23], v7 offset:5120
global_load_dwordx4 a[36:39], v5, s[20:21] offset:-3072 sc1
v_mfma_f32_16x16x32_bf16 v[184:187], v[24:27], a[204:207], v[184:187]
v_mfma_f32_16x16x32_bf16 v[180:183], v[28:31], a[200:203], v[180:183]
ds_read_b128 v[24:27], v7 offset:6144
v_mfma_f32_16x16x32_bf16 v[188:191], v[28:31], a[204:207], v[188:191]
v_mfma_f32_16x16x32_bf16 v[160:163], v[32:35], a[208:211], v[160:163]
ds_read_b128 v[28:31], v7 offset:7168
global_load_dwordx4 a[40:43], v5, s[20:21] offset:-2048 sc1
v_mfma_f32_16x16x32_bf16 v[168:171], v[32:35], a[212:215], v[168:171]
s_waitcnt vmcnt(31) lgkmcnt(3)
v_mfma_f32_16x16x32_bf16 v[164:167], v[36:39], a[208:211], v[164:167]
ds_read_b128 v[32:35], v7 offset:8192
v_mfma_f32_16x16x32_bf16 v[172:175], v[36:39], a[212:215], v[172:175]
v_mfma_f32_16x16x32_bf16 v[176:179], v[40:43], a[208:211], v[176:179]
ds_read_b128 v[36:39], v7 offset:9216
v_mfma_f32_16x16x32_bf16 v[184:187], v[40:43], a[212:215], v[184:187]
v_mfma_f32_16x16x32_bf16 v[180:183], v[44:47], a[208:211], v[180:183]
ds_read_b128 v[40:43], v7 offset:10240
global_load_dwordx4 a[44:47], v5, s[20:21] offset:-1024 sc1
v_mfma_f32_16x16x32_bf16 v[188:191], v[44:47], a[212:215], v[188:191]
v_mfma_f32_16x16x32_bf16 v[160:163], v[16:19], a[216:219], v[160:163]
ds_read_b128 v[44:47], v7 offset:11264
v_mfma_f32_16x16x32_bf16 v[168:171], v[16:19], a[220:223], v[168:171]
s_waitcnt vmcnt(26) lgkmcnt(3)
v_mfma_f32_16x16x32_bf16 v[164:167], v[20:23], a[216:219], v[164:167]
ds_read_b128 v[16:19], v7 offset:12288
global_load_dwordx4 a[48:51], v5, s[20:21] offset:0 sc1
v_mfma_f32_16x16x32_bf16 v[172:175], v[20:23], a[220:223], v[172:175]
v_mfma_f32_16x16x32_bf16 v[176:179], v[24:27], a[216:219], v[176:179]
ds_read_b128 v[20:23], v7 offset:13312
v_mfma_f32_16x16x32_bf16 v[184:187], v[24:27], a[220:223], v[184:187]
v_mfma_f32_16x16x32_bf16 v[180:183], v[28:31], a[216:219], v[180:183]
ds_read_b128 v[24:27], v7 offset:14336
global_load_dwordx4 a[52:55], v5, s[20:21] offset:1024 sc1
v_mfma_f32_16x16x32_bf16 v[188:191], v[28:31], a[220:223], v[188:191]
v_mfma_f32_16x16x32_bf16 v[160:163], v[32:35], a[224:227], v[160:163]
ds_read_b128 v[28:31], v7 offset:15360
v_mfma_f32_16x16x32_bf16 v[168:171], v[32:35], a[228:231], v[168:171]
s_waitcnt vmcnt(26) lgkmcnt(3)
v_mfma_f32_16x16x32_bf16 v[164:167], v[36:39], a[224:227], v[164:167]
s_barrier
ds_read_b128 v[32:35], v7 offset:16384
v_mfma_f32_16x16x32_bf16 v[172:175], v[36:39], a[228:231], v[172:175]
global_load_dwordx4 a[56:59], v5, s[20:21] offset:2048 sc1
v_mfma_f32_16x16x32_bf16 v[176:179], v[40:43], a[224:227], v[176:179]
ds_read_b128 v[36:39], v7 offset:17408
v_mfma_f32_16x16x32_bf16 v[184:187], v[40:43], a[228:231], v[184:187]
v_mfma_f32_16x16x32_bf16 v[180:183], v[44:47], a[224:227], v[180:183]
ds_read_b128 v[40:43], v7 offset:18432
v_mfma_f32_16x16x32_bf16 v[188:191], v[44:47], a[228:231], v[188:191]
v_mfma_f32_16x16x32_bf16 v[160:163], v[16:19], a[232:235], v[160:163]
ds_read_b128 v[44:47], v7 offset:19456
global_load_dwordx4 a[60:63], v5, s[20:21] offset:3072 sc1
v_mfma_f32_16x16x32_bf16 v[168:171], v[16:19], a[236:239], v[168:171]
s_waitcnt vmcnt(26) lgkmcnt(3)
v_mfma_f32_16x16x32_bf16 v[164:167], v[20:23], a[232:235], v[164:167]
ds_read_b128 v[16:19], v7 offset:20480
v_mfma_f32_16x16x32_bf16 v[172:175], v[20:23], a[236:239], v[172:175]
v_mfma_f32_16x16x32_bf16 v[176:179], v[24:27], a[232:235], v[176:179]
ds_read_b128 v[20:23], v7 offset:21504
s_add_u32 m0, s43, 0
v_mfma_f32_16x16x32_bf16 v[184:187], v[24:27], a[236:239], v[184:187]
v_add_u32 v4, 16384, v4
v_mfma_f32_16x16x32_bf16 v[180:183], v[28:31], a[232:235], v[180:183]
ds_read_b128 v[24:27], v7 offset:22528
global_load_lds_dwordx4 v4, s[20:21] offset:0 sc1
v_mfma_f32_16x16x32_bf16 v[188:191], v[28:31], a[236:239], v[188:191]
v_mfma_f32_16x16x32_bf16 v[160:163], v[32:35], a[240:243], v[160:163]
ds_read_b128 v[28:31], v7 offset:23552
global_load_lds_dwordx4 v4, s[20:21] offset:1024 sc1
v_mfma_f32_16x16x32_bf16 v[168:171], v[32:35], a[244:247], v[168:171]
s_waitcnt vmcnt(26) lgkmcnt(3)
v_mfma_f32_16x16x32_bf16 v[164:167], v[36:39], a[240:243], v[164:167]
ds_read_b128 v[32:35], v7 offset:24576
v_mfma_f32_16x16x32_bf16 v[172:175], v[36:39], a[244:247], v[172:175]
v_mfma_f32_16x16x32_bf16 v[176:179], v[40:43], a[240:243], v[176:179]
ds_read_b128 v[36:39], v7 offset:25600
global_load_lds_dwordx4 v4, s[20:21] offset:2048 sc1
v_mfma_f32_16x16x32_bf16 v[184:187], v[40:43], a[244:247], v[184:187]
v_mfma_f32_16x16x32_bf16 v[180:183], v[44:47], a[240:243], v[180:183]
ds_read_b128 v[40:43], v7 offset:26624
v_mfma_f32_16x16x32_bf16 v[188:191], v[44:47], a[244:247], v[188:191]
v_mfma_f32_16x16x32_bf16 v[160:163], v[16:19], a[248:251], v[160:163]
ds_read_b128 v[44:47], v7 offset:27648
v_mfma_f32_16x16x32_bf16 v[168:171], v[16:19], a[252:255], v[168:171]
s_waitcnt vmcnt(21) lgkmcnt(3)
v_mfma_f32_16x16x32_bf16 v[164:167], v[20:23], a[248:251], v[164:167]
ds_read_b128 v[16:19], v7 offset:28672
global_load_lds_dwordx4 v4, s[20:21] offset:3072 sc1
v_mfma_f32_16x16x32_bf16 v[172:175], v[20:23], a[252:255], v[172:175]
v_mfma_f32_16x16x32_bf16 v[176:179], v[24:27], a[248:251], v[176:179]
ds_read_b128 v[20:23], v7 offset:29696
v_mfma_f32_16x16x32_bf16 v[184:187], v[24:27], a[252:255], v[184:187]
v_mfma_f32_16x16x32_bf16 v[180:183], v[28:31], a[248:251], v[180:183]
ds_read_b128 v[24:27], v7 offset:30720
v_add_u32 v5, 8192, v5
v_mfma_f32_16x16x32_bf16 v[188:191], v[28:31], a[252:255], v[188:191]
global_load_dwordx4 a[64:67], v5, s[20:21] offset:-4096 sc1
v_mfma_f32_16x16x32_bf16 v[160:163], v[32:35], a[0:3], v[160:163]
ds_read_b128 v[28:31], v7 offset:31744
v_mfma_f32_16x16x32_bf16 v[168:171], v[32:35], a[4:7], v[168:171]
s_waitcnt vmcnt(21) lgkmcnt(3)
v_mfma_f32_16x16x32_bf16 v[164:167], v[36:39], a[0:3], v[164:167]
s_barrier
ds_read_b128 v[32:35], v7 offset:32768
v_mfma_f32_16x16x32_bf16 v[172:175], v[36:39], a[4:7], v[172:175]
global_load_dwordx4 a[68:71], v5, s[20:21] offset:-3072 sc1
v_mfma_f32_16x16x32_bf16 v[176:179], v[40:43], a[0:3], v[176:179]
ds_read_b128 v[36:39], v7 offset:33792
v_mfma_f32_16x16x32_bf16 v[184:187], v[40:43], a[4:7], v[184:187]
v_mfma_f32_16x16x32_bf16 v[180:183], v[44:47], a[0:3], v[180:183]
ds_read_b128 v[40:43], v7 offset:34816
global_load_dwordx4 a[72:75], v5, s[20:21] offset:-2048 sc1
v_mfma_f32_16x16x32_bf16 v[188:191], v[44:47], a[4:7], v[188:191]
v_mfma_f32_16x16x32_bf16 v[160:163], v[16:19], a[8:11], v[160:163]
ds_read_b128 v[44:47], v7 offset:35840
v_mfma_f32_16x16x32_bf16 v[168:171], v[16:19], a[12:15], v[168:171]
s_waitcnt vmcnt(21) lgkmcnt(3)
v_mfma_f32_16x16x32_bf16 v[164:167], v[20:23], a[8:11], v[164:167]
ds_read_b128 v[16:19], v7 offset:36864
v_mfma_f32_16x16x32_bf16 v[172:175], v[20:23], a[12:15], v[172:175]
v_mfma_f32_16x16x32_bf16 v[176:179], v[24:27], a[8:11], v[176:179]
ds_read_b128 v[20:23], v7 offset:37888
global_load_dwordx4 a[76:79], v5, s[20:21] offset:-1024 sc1
v_mfma_f32_16x16x32_bf16 v[184:187], v[24:27], a[12:15], v[184:187]
v_mfma_f32_16x16x32_bf16 v[180:183], v[28:31], a[8:11], v[180:183]
ds_read_b128 v[24:27], v7 offset:38912
v_mfma_f32_16x16x32_bf16 v[188:191], v[28:31], a[12:15], v[188:191]
v_mfma_f32_16x16x32_bf16 v[160:163], v[32:35], a[16:19], v[160:163]
ds_read_b128 v[28:31], v7 offset:39936
global_load_dwordx4 a[80:83], v5, s[20:21] offset:0 sc1
v_mfma_f32_16x16x32_bf16 v[168:171], v[32:35], a[20:23], v[168:171]
s_waitcnt vmcnt(21) lgkmcnt(3)
v_mfma_f32_16x16x32_bf16 v[164:167], v[36:39], a[16:19], v[164:167]
ds_read_b128 v[32:35], v7 offset:40960
v_mfma_f32_16x16x32_bf16 v[172:175], v[36:39], a[20:23], v[172:175]
v_mfma_f32_16x16x32_bf16 v[176:179], v[40:43], a[16:19], v[176:179]
ds_read_b128 v[36:39], v7 offset:41984
global_load_dwordx4 a[84:87], v5, s[20:21] offset:1024 sc1
v_mfma_f32_16x16x32_bf16 v[184:187], v[40:43], a[20:23], v[184:187]
v_mfma_f32_16x16x32_bf16 v[180:183], v[44:47], a[16:19], v[180:183]
ds_read_b128 v[40:43], v7 offset:43008
v_mfma_f32_16x16x32_bf16 v[188:191], v[44:47], a[20:23], v[188:191]
v_mfma_f32_16x16x32_bf16 v[160:163], v[16:19], a[24:27], v[160:163]
ds_read_b128 v[44:47], v7 offset:44032
global_load_dwordx4 a[88:91], v5, s[20:21] offset:2048 sc1
v_mfma_f32_16x16x32_bf16 v[168:171], v[16:19], a[28:31], v[168:171]
s_waitcnt vmcnt(17) lgkmcnt(3)
v_mfma_f32_16x16x32_bf16 v[164:167], v[20:23], a[24:27], v[164:167]
ds_read_b128 v[16:19], v7 offset:45056
v_mfma_f32_16x16x32_bf16 v[172:175], v[20:23], a[28:31], v[172:175]
v_mfma_f32_16x16x32_bf16 v[176:179], v[24:27], a[24:27], v[176:179]
ds_read_b128 v[20:23], v7 offset:46080
v_mfma_f32_16x16x32_bf16 v[184:187], v[24:27], a[28:31], v[184:187]
global_load_dwordx4 a[92:95], v5, s[20:21] offset:3072 sc1
v_mfma_f32_16x16x32_bf16 v[180:183], v[28:31], a[24:27], v[180:183]
ds_read_b128 v[24:27], v7 offset:47104
v_mfma_f32_16x16x32_bf16 v[188:191], v[28:31], a[28:31], v[188:191]
v_mfma_f32_16x16x32_bf16 v[160:163], v[32:35], a[32:35], v[160:163]
ds_read_b128 v[28:31], v7 offset:48128
v_mfma_f32_16x16x32_bf16 v[168:171], v[32:35], a[36:39], v[168:171]
v_add_u32 v5, 8192, v5
s_waitcnt vmcnt(16) lgkmcnt(3)
v_mfma_f32_16x16x32_bf16 v[164:167], v[36:39], a[32:35], v[164:167]
s_barrier
ds_read_b128 v[32:35], v7 offset:49152
v_mfma_f32_16x16x32_bf16 v[172:175], v[36:39], a[36:39], v[172:175]
global_load_dwordx4 a[96:99], v5, s[20:21] offset:-4096 sc1
global_load_dwordx4 a[100:103], v5, s[20:21] offset:-3072 sc1
v_mfma_f32_16x16x32_bf16 v[176:179], v[40:43], a[32:35], v[176:179]
ds_read_b128 v[36:39], v7 offset:50176
v_mfma_f32_16x16x32_bf16 v[184:187], v[40:43], a[36:39], v[184:187]
global_load_dwordx4 a[104:107], v5, s[20:21] offset:-2048 sc1
global_load_dwordx4 a[108:111], v5, s[20:21] offset:-1024 sc1
v_mfma_f32_16x16x32_bf16 v[180:183], v[44:47], a[32:35], v[180:183]
ds_read_b128 v[40:43], v7 offset:51200
v_mfma_f32_16x16x32_bf16 v[188:191], v[44:47], a[36:39], v[188:191]
v_mfma_f32_16x16x32_bf16 v[160:163], v[16:19], a[40:43], v[160:163]
ds_read_b128 v[44:47], v7 offset:52224
v_mfma_f32_16x16x32_bf16 v[168:171], v[16:19], a[44:47], v[168:171]
global_load_dwordx4 a[112:115], v5, s[20:21] offset:0 sc1
s_waitcnt vmcnt(19) lgkmcnt(3)
v_mfma_f32_16x16x32_bf16 v[164:167], v[20:23], a[40:43], v[164:167]
ds_read_b128 v[16:19], v7 offset:53248
global_load_dwordx4 a[116:119], v5, s[20:21] offset:1024 sc1
v_mfma_f32_16x16x32_bf16 v[172:175], v[20:23], a[44:47], v[172:175]
s_add_u32 m0, s43, 16384
v_add_u32 v4, 16384, v4
v_mfma_f32_16x16x32_bf16 v[176:179], v[24:27], a[40:43], v[176:179]
ds_read_b128 v[20:23], v7 offset:54272
global_load_lds_dwordx4 v4, s[20:21] offset:0 sc1
v_mfma_f32_16x16x32_bf16 v[184:187], v[24:27], a[44:47], v[184:187]
global_load_lds_dwordx4 v4, s[20:21] offset:1024 sc1
global_load_lds_dwordx4 v4, s[20:21] offset:2048 sc1
v_mfma_f32_16x16x32_bf16 v[180:183], v[28:31], a[40:43], v[180:183]
ds_read_b128 v[24:27], v7 offset:55296
global_load_lds_dwordx4 v4, s[20:21] offset:3072 sc1
v_mfma_f32_16x16x32_bf16 v[188:191], v[28:31], a[44:47], v[188:191]
global_load_dwordx4 a[120:123], v5, s[20:21] offset:2048 sc1
global_load_dwordx4 a[124:127], v5, s[20:21] offset:3072 sc1
v_mfma_f32_16x16x32_bf16 v[160:163], v[32:35], a[48:51], v[160:163]
ds_read_b128 v[28:31], v7 offset:56320
v_mfma_f32_16x16x32_bf16 v[168:171], v[32:35], a[52:55], v[168:171]
s_waitcnt vmcnt(24) lgkmcnt(3)
v_mfma_f32_16x16x32_bf16 v[164:167], v[36:39], a[48:51], v[164:167]
ds_read_b128 v[32:35], v7 offset:57344
v_mfma_f32_16x16x32_bf16 v[172:175], v[36:39], a[52:55], v[172:175]
v_mfma_f32_16x16x32_bf16 v[176:179], v[40:43], a[48:51], v[176:179]
ds_read_b128 v[36:39], v7 offset:58368
v_mfma_f32_16x16x32_bf16 v[184:187], v[40:43], a[52:55], v[184:187]
v_mfma_f32_16x16x32_bf16 v[180:183], v[44:47], a[48:51], v[180:183]
ds_read_b128 v[40:43], v7 offset:59392
v_mfma_f32_16x16x32_bf16 v[188:191], v[44:47], a[52:55], v[188:191]
v_mfma_f32_16x16x32_bf16 v[160:163], v[16:19], a[56:59], v[160:163]
ds_read_b128 v[44:47], v7 offset:60416
s_add_u32 m0, s43, 32768
v_mfma_f32_16x16x32_bf16 v[168:171], v[16:19], a[60:63], v[168:171]
v_add_u32 v4, 16384, v4
s_waitcnt vmcnt(18) lgkmcnt(3)
v_mfma_f32_16x16x32_bf16 v[164:167], v[20:23], a[56:59], v[164:167]
ds_read_b128 v[16:19], v7 offset:61440
global_load_lds_dwordx4 v4, s[20:21] offset:0 sc1
v_mfma_f32_16x16x32_bf16 v[172:175], v[20:23], a[60:63], v[172:175]
v_mfma_f32_16x16x32_bf16 v[176:179], v[24:27], a[56:59], v[176:179]
ds_read_b128 v[20:23], v7 offset:62464
global_load_lds_dwordx4 v4, s[20:21] offset:1024 sc1
v_mfma_f32_16x16x32_bf16 v[184:187], v[24:27], a[60:63], v[184:187]
v_mfma_f32_16x16x32_bf16 v[180:183], v[28:31], a[56:59], v[180:183]
ds_read_b128 v[24:27], v7 offset:63488
v_mfma_f32_16x16x32_bf16 v[188:191], v[28:31], a[60:63], v[188:191]
v_mfma_f32_16x16x32_bf16 v[160:163], v[32:35], a[64:67], v[160:163]
ds_read_b128 v[28:31], v7 offset:64512
v_mfma_f32_16x16x32_bf16 v[168:171], v[32:35], a[68:71], v[168:171]
s_waitcnt vmcnt(16) lgkmcnt(3)
v_mfma_f32_16x16x32_bf16 v[164:167], v[36:39], a[64:67], v[164:167]
s_barrier
ds_read_b128 v[32:35], v6 offset:0
v_mfma_f32_16x16x32_bf16 v[172:175], v[36:39], a[68:71], v[172:175]
global_load_lds_dwordx4 v4, s[20:21] offset:2048 sc1
v_mfma_f32_16x16x32_bf16 v[160:163], v[40:43], a[72:75], v[160:163]
ds_read_b128 v[36:39], v6 offset:1024
v_mfma_f32_16x16x32_bf16 v[168:171], v[40:43], a[76:79], v[168:171]
v_mfma_f32_16x16x32_bf16 v[164:167], v[44:47], a[72:75], v[164:167]
ds_read_b128 v[40:43], v6 offset:2048
global_load_lds_dwordx4 v4, s[20:21] offset:3072 sc1
v_mfma_f32_16x16x32_bf16 v[172:175], v[44:47], a[76:79], v[172:175]
v_mfma_f32_16x16x32_bf16 v[160:163], v[16:19], a[80:83], v[160:163]
ds_read_b128 v[44:47], v6 offset:3072
v_mfma_f32_16x16x32_bf16 v[168:171], v[16:19], a[84:87], v[168:171]
s_waitcnt vmcnt(14) lgkmcnt(3)
v_mfma_f32_16x16x32_bf16 v[164:167], v[20:23], a[80:83], v[164:167]
ds_read_b128 v[16:19], v6 offset:4096
s_add_u32 m0, s43, 49152
v_mfma_f32_16x16x32_bf16 v[172:175], v[20:23], a[84:87], v[172:175]
v_add_u32 v4, 16384, v4
v_mfma_f32_16x16x32_bf16 v[160:163], v[24:27], a[88:91], v[160:163]
ds_read_b128 v[20:23], v6 offset:5120
global_load_lds_dwordx4 v4, s[20:21] offset:0 sc1
v_mfma_f32_16x16x32_bf16 v[168:171], v[24:27], a[92:95], v[168:171]
v_mfma_f32_16x16x32_bf16 v[164:167], v[28:31], a[88:91], v[164:167]
ds_read_b128 v[24:27], v6 offset:6144
global_load_lds_dwordx4 v4, s[20:21] offset:1024 sc1
v_mfma_f32_16x16x32_bf16 v[172:175], v[28:31], a[92:95], v[172:175]
v_mfma_f32_16x16x32_bf16 v[160:163], v[32:35], a[96:99], v[160:163]
ds_read_b128 v[28:31], v6 offset:7168
v_mfma_f32_16x16x32_bf16 v[168:171], v[32:35], a[100:103], v[168:171]
s_waitcnt vmcnt(12) lgkmcnt(3)
v_mfma_f32_16x16x32_bf16 v[164:167], v[36:39], a[96:99], v[164:167]
ds_read_b128 v[32:35], v6 offset:8192
v_mfma_f32_16x16x32_bf16 v[172:175], v[36:39], a[100:103], v[172:175]
v_mfma_f32_16x16x32_bf16 v[160:163], v[40:43], a[104:107], v[160:163]
ds_read_b128 v[36:39], v6 offset:9216
global_load_lds_dwordx4 v4, s[20:21] offset:2048 sc1
v_mfma_f32_16x16x32_bf16 v[168:171], v[40:43], a[108:111], v[168:171]
v_mfma_f32_16x16x32_bf16 v[164:167], v[44:47], a[104:107], v[164:167]
ds_read_b128 v[40:43], v6 offset:10240
v_mfma_f32_16x16x32_bf16 v[172:175], v[44:47], a[108:111], v[172:175]
v_mfma_f32_16x16x32_bf16 v[160:163], v[16:19], a[112:115], v[160:163]
ds_read_b128 v[44:47], v6 offset:11264
global_load_lds_dwordx4 v4, s[20:21] offset:3072 sc1
v_mfma_f32_16x16x32_bf16 v[168:171], v[16:19], a[116:119], v[168:171]
s_waitcnt vmcnt(8) lgkmcnt(3)
v_mfma_f32_16x16x32_bf16 v[164:167], v[20:23], a[112:115], v[164:167]
ds_read_b128 v[16:19], v6 offset:12288
v_mfma_f32_16x16x32_bf16 v[172:175], v[20:23], a[116:119], v[172:175]
v_mfma_f32_16x16x32_bf16 v[160:163], v[24:27], a[120:123], v[160:163]
ds_read_b128 v[20:23], v6 offset:13312
s_add_u32 m0, s43, 65536
v_mfma_f32_16x16x32_bf16 v[168:171], v[24:27], a[124:127], v[168:171]
v_add_u32 v4, 16384, v4
v_mfma_f32_16x16x32_bf16 v[164:167], v[28:31], a[120:123], v[164:167]
ds_read_b128 v[24:27], v6 offset:14336
global_load_lds_dwordx4 v4, s[20:21] offset:0 sc1
v_mfma_f32_16x16x32_bf16 v[172:175], v[28:31], a[124:127], v[172:175]
v_mfma_f32_16x16x32_bf16 v[176:179], v[32:35], a[64:67], v[176:179]
ds_read_b128 v[28:31], v6 offset:15360
global_load_lds_dwordx4 v4, s[20:21] offset:1024 sc1
v_mfma_f32_16x16x32_bf16 v[184:187], v[32:35], a[68:71], v[184:187]
v_cvt_pk_bf16_f32 v192, v160, v161
v_cvt_pk_bf16_f32 v193, v162, v163
v_cvt_pk_bf16_f32 v194, v164, v165
v_cvt_pk_bf16_f32 v195, v166, v167
v_cvt_pk_bf16_f32 v196, v168, v169
s_waitcnt lgkmcnt(3)
v_mfma_f32_16x16x32_bf16 v[180:183], v[36:39], a[64:67], v[180:183]
s_barrier
ds_read_b128 v[32:35], v6 offset:16384
v_mfma_f32_16x16x32_bf16 v[188:191], v[36:39], a[68:71], v[188:191]
v_cvt_pk_bf16_f32 v197, v170, v171
v_cvt_pk_bf16_f32 v198, v172, v173
v_cvt_pk_bf16_f32 v199, v174, v175
v_mfma_f32_16x16x32_bf16 v[176:179], v[40:43], a[72:75], v[176:179]
ds_read_b128 v[36:39], v6 offset:17408
global_load_lds_dwordx4 v4, s[20:21] offset:2048 sc1
buffer_store_dwordx4 v[192:195], v0, s[20:23], s37 offen offset:0 sc1
buffer_store_dwordx4 v[196:199], v0, s[20:23], s37 offen offset:1024 sc1
v_mfma_f32_16x16x32_bf16 v[184:187], v[40:43], a[76:79], v[184:187]
s_mov_b32 s59, 0
s_add_u32 s37, s51, 4194304
v_mfma_f32_16x16x32_bf16 v[180:183], v[44:47], a[72:75], v[180:183]
ds_read_b128 v[40:43], v6 offset:18432
v_mfma_f32_16x16x32_bf16 v[188:191], v[44:47], a[76:79], v[188:191]
v_mfma_f32_16x16x32_bf16 v[176:179], v[16:19], a[80:83], v[176:179]
ds_read_b128 v[44:47], v6 offset:19456
v_mfma_f32_16x16x32_bf16 v[184:187], v[16:19], a[84:87], v[184:187]
s_waitcnt lgkmcnt(3)
v_mfma_f32_16x16x32_bf16 v[180:183], v[20:23], a[80:83], v[180:183]
ds_read_b128 v[16:19], v6 offset:20480
v_mfma_f32_16x16x32_bf16 v[188:191], v[20:23], a[84:87], v[188:191]
v_mfma_f32_16x16x32_bf16 v[176:179], v[24:27], a[88:91], v[176:179]
ds_read_b128 v[20:23], v6 offset:21504
v_mfma_f32_16x16x32_bf16 v[184:187], v[24:27], a[92:95], v[184:187]
v_mfma_f32_16x16x32_bf16 v[180:183], v[28:31], a[88:91], v[180:183]
ds_read_b128 v[24:27], v6 offset:22528
v_mfma_f32_16x16x32_bf16 v[188:191], v[28:31], a[92:95], v[188:191]
v_mfma_f32_16x16x32_bf16 v[176:179], v[32:35], a[96:99], v[176:179]
ds_read_b128 v[28:31], v6 offset:23552
global_load_lds_dwordx4 v4, s[20:21] offset:3072 sc1
v_mfma_f32_16x16x32_bf16 v[184:187], v[32:35], a[100:103], v[184:187]
s_waitcnt lgkmcnt(3)
v_mfma_f32_16x16x32_bf16 v[180:183], v[36:39], a[96:99], v[180:183]
ds_read_b128 v[32:35], v6 offset:24576
v_mfma_f32_16x16x32_bf16 v[188:191], v[36:39], a[100:103], v[188:191]
v_mfma_f32_16x16x32_bf16 v[176:179], v[40:43], a[104:107], v[176:179]
ds_read_b128 v[36:39], v6 offset:25600
s_add_u32 m0, s43, 81920
v_mfma_f32_16x16x32_bf16 v[184:187], v[40:43], a[108:111], v[184:187]
v_add_u32 v4, 16384, v4
v_mfma_f32_16x16x32_bf16 v[180:183], v[44:47], a[104:107], v[180:183]
ds_read_b128 v[40:43], v6 offset:26624
global_load_lds_dwordx4 v4, s[20:21] offset:0 sc1
v_mfma_f32_16x16x32_bf16 v[188:191], v[44:47], a[108:111], v[188:191]
v_mfma_f32_16x16x32_bf16 v[176:179], v[16:19], a[112:115], v[176:179]
ds_read_b128 v[44:47], v6 offset:27648
global_load_lds_dwordx4 v4, s[20:21] offset:1024 sc1
v_mfma_f32_16x16x32_bf16 v[184:187], v[16:19], a[116:119], v[184:187]
s_waitcnt lgkmcnt(3)
v_mfma_f32_16x16x32_bf16 v[180:183], v[20:23], a[112:115], v[180:183]
ds_read_b128 v[16:19], v6 offset:28672
v_mfma_f32_16x16x32_bf16 v[188:191], v[20:23], a[116:119], v[188:191]
v_mfma_f32_16x16x32_bf16 v[176:179], v[24:27], a[120:123], v[176:179]
ds_read_b128 v[20:23], v6 offset:29696
global_load_lds_dwordx4 v4, s[20:21] offset:2048 sc1
v_mfma_f32_16x16x32_bf16 v[184:187], v[24:27], a[124:127], v[184:187]
v_mfma_f32_16x16x32_bf16 v[180:183], v[28:31], a[120:123], v[180:183]
ds_read_b128 v[24:27], v6 offset:30720
v_mfma_f32_16x16x32_bf16 v[188:191], v[28:31], a[124:127], v[188:191]
v_mfma_f32_16x16x32_bf16 v[128:131], v[32:35], a[192:195], v[128:131]
ds_read_b128 v[28:31], v6 offset:31744
v_mfma_f32_16x16x32_bf16 v[136:139], v[32:35], a[196:199], v[136:139]
v_cvt_pk_bf16_f32 v200, v176, v177
v_cvt_pk_bf16_f32 v201, v178, v179
s_nop 0
v_cvt_pk_bf16_f32 v202, v180, v181
v_cvt_pk_bf16_f32 v203, v182, v183
v_cvt_pk_bf16_f32 v204, v184, v185
s_waitcnt vmcnt(13) lgkmcnt(3)
v_mfma_f32_16x16x32_bf16 v[132:135], v[36:39], a[192:195], v[132:135]
s_barrier
ds_read_b128 v[32:35], v6 offset:32768
v_mfma_f32_16x16x32_bf16 v[140:143], v[36:39], a[196:199], v[140:143]
global_load_lds_dwordx4 v4, s[20:21] offset:3072 sc1
v_cvt_pk_bf16_f32 v205, v186, v187
v_cvt_pk_bf16_f32 v206, v188, v189
v_cvt_pk_bf16_f32 v207, v190, v191
v_mfma_f32_16x16x32_bf16 v[128:131], v[40:43], a[200:203], v[128:131]
ds_read_b128 v[36:39], v6 offset:33792
buffer_store_dwordx4 v[200:203], v0, s[20:23], s37 offen offset:2048 sc1
buffer_store_dwordx4 v[204:207], v0, s[20:23], s37 offen offset:3072 sc1
v_mfma_f32_16x16x32_bf16 v[136:139], v[40:43], a[204:207], v[136:139]
s_add_u32 m0, s43, 98304
v_add_u32 v4, 16384, v4
s_waitcnt vmcnt(7)
s_atomic_add s45, s[20:21], s54 offset:64
v_mfma_f32_16x16x32_bf16 v[132:135], v[44:47], a[200:203], v[132:135]
ds_read_b128 v[40:43], v6 offset:34816
global_load_lds_dwordx4 v4, s[20:21] offset:0 sc1
v_mfma_f32_16x16x32_bf16 v[140:143], v[44:47], a[204:207], v[140:143]
v_lshlrev_b32 v209, 9, v2
v_and_b32 v210, 16, v11
v_lshl_add_u32 v209, v210, 1, v209
v_lshrrev_b32 v210, 5, v11
v_lshl_add_u32 v209, v210, 4, v209
s_lshl_b32 s37, s35, 16
s_lshl_b32 s38, s33, 7
s_add_u32 s37, s37, s38
s_add_u32 s38, s37, 32768
v_mfma_f32_16x16x32_bf16 v[128:131], v[16:19], a[208:211], v[128:131]
ds_read_b128 v[44:47], v6 offset:35840
v_mfma_f32_16x16x32_bf16 v[136:139], v[16:19], a[212:215], v[136:139]
s_waitcnt lgkmcnt(4)
v_mfma_f32_16x16x32_bf16 v[132:135], v[20:23], a[208:211], v[132:135]
ds_read_b128 v[16:19], v6 offset:36864
v_mfma_f32_16x16x32_bf16 v[140:143], v[20:23], a[212:215], v[140:143]
v_mfma_f32_16x16x32_bf16 v[128:131], v[24:27], a[216:219], v[128:131]
ds_read_b128 v[20:23], v6 offset:37888
v_mfma_f32_16x16x32_bf16 v[136:139], v[24:27], a[220:223], v[136:139]
v_mfma_f32_16x16x32_bf16 v[132:135], v[28:31], a[216:219], v[132:135]
ds_read_b128 v[24:27], v6 offset:38912
global_load_lds_dwordx4 v4, s[20:21] offset:1024 sc1
v_mfma_f32_16x16x32_bf16 v[140:143], v[28:31], a[220:223], v[140:143]
s_waitcnt lgkmcnt(4)
v_mfma_f32_16x16x32_bf16 v[128:131], v[32:35], a[224:227], v[128:131]
ds_read_b128 v[28:31], v6 offset:39936
v_mfma_f32_16x16x32_bf16 v[136:139], v[32:35], a[228:231], v[136:139]
v_mfma_f32_16x16x32_bf16 v[132:135], v[36:39], a[224:227], v[132:135]
ds_read_b128 v[32:35], v6 offset:40960
v_mfma_f32_16x16x32_bf16 v[140:143], v[36:39], a[228:231], v[140:143]
v_mfma_f32_16x16x32_bf16 v[128:131], v[40:43], a[232:235], v[128:131]
ds_read_b128 v[36:39], v6 offset:41984
global_load_lds_dwordx4 v4, s[20:21] offset:2048 sc1
v_mfma_f32_16x16x32_bf16 v[136:139], v[40:43], a[236:239], v[136:139]
s_waitcnt lgkmcnt(4)
v_mfma_f32_16x16x32_bf16 v[132:135], v[44:47], a[232:235], v[132:135]
ds_read_b128 v[40:43], v6 offset:43008
v_mfma_f32_16x16x32_bf16 v[140:143], v[44:47], a[236:239], v[140:143]
v_mfma_f32_16x16x32_bf16 v[128:131], v[16:19], a[240:243], v[128:131]
ds_read_b128 v[44:47], v6 offset:44032
global_load_lds_dwordx4 v4, s[20:21] offset:3072 sc1
v_mfma_f32_16x16x32_bf16 v[136:139], v[16:19], a[244:247], v[136:139]
v_mfma_f32_16x16x32_bf16 v[132:135], v[20:23], a[240:243], v[132:135]
ds_read_b128 v[16:19], v6 offset:45056
v_mfma_f32_16x16x32_bf16 v[140:143], v[20:23], a[244:247], v[140:143]
s_waitcnt lgkmcnt(4)
v_mfma_f32_16x16x32_bf16 v[128:131], v[24:27], a[248:251], v[128:131]
ds_read_b128 v[20:23], v6 offset:46080
s_add_u32 m0, s43, 114688
v_mfma_f32_16x16x32_bf16 v[136:139], v[24:27], a[252:255], v[136:139]
v_add_u32 v4, 16384, v4
v_mfma_f32_16x16x32_bf16 v[132:135], v[28:31], a[248:251], v[132:135]
ds_read_b128 v[24:27], v6 offset:47104
global_load_lds_dwordx4 v4, s[20:21] offset:0 sc1
v_mfma_f32_16x16x32_bf16 v[140:143], v[28:31], a[252:255], v[140:143]
s_atomic_add s59, s[20:21], s55 offset:64 glc
v_mfma_f32_16x16x32_bf16 v[128:131], v[32:35], a[0:3], v[128:131]
ds_read_b128 v[28:31], v6 offset:48128
global_load_lds_dwordx4 v4, s[20:21] offset:1024 sc1
v_mfma_f32_16x16x32_bf16 v[136:139], v[32:35], a[4:7], v[136:139]
s_waitcnt lgkmcnt(5)
v_mfma_f32_16x16x32_bf16 v[132:135], v[36:39], a[0:3], v[132:135]
s_barrier
ds_read_b128 v[32:35], v6 offset:49152
v_mfma_f32_16x16x32_bf16 v[140:143], v[36:39], a[4:7], v[140:143]
v_mfma_f32_16x16x32_bf16 v[128:131], v[40:43], a[8:11], v[128:131]
ds_read_b128 v[36:39], v6 offset:50176
v_mfma_f32_16x16x32_bf16 v[136:139], v[40:43], a[12:15], v[136:139]
s_waitcnt lgkmcnt(5)
v_mfma_f32_16x16x32_bf16 v[132:135], v[44:47], a[8:11], v[132:135]
ds_read_b128 v[40:43], v6 offset:51200
global_load_lds_dwordx4 v4, s[20:21] offset:2048 sc1
v_mfma_f32_16x16x32_bf16 v[140:143], v[44:47], a[12:15], v[140:143]
v_mfma_f32_16x16x32_bf16 v[128:131], v[16:19], a[16:19], v[128:131]
ds_read_b128 v[44:47], v6 offset:52224
v_mfma_f32_16x16x32_bf16 v[136:139], v[16:19], a[20:23], v[136:139]
s_waitcnt lgkmcnt(4)
v_mfma_f32_16x16x32_bf16 v[132:135], v[20:23], a[16:19], v[132:135]
ds_read_b128 v[16:19], v6 offset:53248
global_load_lds_dwordx4 v4, s[20:21] offset:3072 sc1
v_mfma_f32_16x16x32_bf16 v[140:143], v[20:23], a[20:23], v[140:143]
v_mfma_f32_16x16x32_bf16 v[128:131], v[24:27], a[24:27], v[128:131]
ds_read_b128 v[20:23], v6 offset:54272
v_mfma_f32_16x16x32_bf16 v[136:139], v[24:27], a[28:31], v[136:139]
v_mfma_f32_16x16x32_bf16 v[132:135], v[28:31], a[24:27], v[132:135]
ds_read_b128 v[24:27], v6 offset:55296
v_mfma_f32_16x16x32_bf16 v[140:143], v[28:31], a[28:31], v[140:143]
s_waitcnt lgkmcnt(4)
v_mfma_f32_16x16x32_bf16 v[128:131], v[32:35], a[32:35], v[128:131]
ds_read_b128 v[28:31], v6 offset:56320
v_mfma_f32_16x16x32_bf16 v[136:139], v[32:35], a[36:39], v[136:139]
v_mfma_f32_16x16x32_bf16 v[132:135], v[36:39], a[32:35], v[132:135]
ds_read_b128 v[32:35], v6 offset:57344
v_mfma_f32_16x16x32_bf16 v[140:143], v[36:39], a[36:39], v[140:143]
v_mfma_f32_16x16x32_bf16 v[128:131], v[40:43], a[40:43], v[128:131]
ds_read_b128 v[36:39], v6 offset:58368
v_mfma_f32_16x16x32_bf16 v[136:139], v[40:43], a[44:47], v[136:139]
s_waitcnt lgkmcnt(4)
v_mfma_f32_16x16x32_bf16 v[132:135], v[44:47], a[40:43], v[132:135]
ds_read_b128 v[40:43], v6 offset:59392
v_mfma_f32_16x16x32_bf16 v[140:143], v[44:47], a[44:47], v[140:143]
v_mfma_f32_16x16x32_bf16 v[128:131], v[16:19], a[48:51], v[128:131]
ds_read_b128 v[44:47], v6 offset:60416
v_mfma_f32_16x16x32_bf16 v[136:139], v[16:19], a[52:55], v[136:139]
v_mfma_f32_16x16x32_bf16 v[132:135], v[20:23], a[48:51], v[132:135]
ds_read_b128 v[16:19], v6 offset:61440
v_mfma_f32_16x16x32_bf16 v[140:143], v[20:23], a[52:55], v[140:143]
s_waitcnt lgkmcnt(4)
v_mfma_f32_16x16x32_bf16 v[128:131], v[24:27], a[56:59], v[128:131]
ds_read_b128 v[20:23], v6 offset:62464
v_mfma_f32_16x16x32_bf16 v[136:139], v[24:27], a[60:63], v[136:139]
v_mfma_f32_16x16x32_bf16 v[132:135], v[28:31], a[56:59], v[132:135]
ds_read_b128 v[24:27], v6 offset:63488
v_mfma_f32_16x16x32_bf16 v[140:143], v[28:31], a[60:63], v[140:143]
v_mfma_f32_16x16x32_bf16 v[128:131], v[32:35], a[64:67], v[128:131]
ds_read_b128 v[28:31], v6 offset:64512
v_mfma_f32_16x16x32_bf16 v[136:139], v[32:35], a[68:71], v[136:139]
s_waitcnt vmcnt(14) lgkmcnt(4)
v_mfma_f32_16x16x32_bf16 v[132:135], v[36:39], a[64:67], v[132:135]
s_barrier
ds_read_b128 v[32:35], v7 offset:0
v_mfma_f32_16x16x32_bf16 v[140:143], v[36:39], a[68:71], v[140:143]
v_mfma_f32_16x16x32_bf16 v[128:131], v[40:43], a[72:75], v[128:131]
ds_read_b128 v[36:39], v7 offset:1024
v_mfma_f32_16x16x32_bf16 v[136:139], v[40:43], a[76:79], v[136:139]
v_mfma_f32_16x16x32_bf16 v[132:135], v[44:47], a[72:75], v[132:135]
ds_read_b128 v[40:43], v7 offset:2048
v_mfma_f32_16x16x32_bf16 v[140:143], v[44:47], a[76:79], v[140:143]
s_waitcnt lgkmcnt(4)
v_mfma_f32_16x16x32_bf16 v[128:131], v[16:19], a[80:83], v[128:131]
ds_read_b128 v[44:47], v7 offset:3072
v_mfma_f32_16x16x32_bf16 v[136:139], v[16:19], a[84:87], v[136:139]
v_mfma_f32_16x16x32_bf16 v[132:135], v[20:23], a[80:83], v[132:135]
ds_read_b128 v[16:19], v7 offset:4096
v_mfma_f32_16x16x32_bf16 v[140:143], v[20:23], a[84:87], v[140:143]
v_mfma_f32_16x16x32_bf16 v[128:131], v[24:27], a[88:91], v[128:131]
ds_read_b128 v[20:23], v7 offset:5120
v_mfma_f32_16x16x32_bf16 v[136:139], v[24:27], a[92:95], v[136:139]
s_waitcnt lgkmcnt(4)
v_mfma_f32_16x16x32_bf16 v[132:135], v[28:31], a[88:91], v[132:135]
ds_read_b128 v[24:27], v7 offset:6144
v_mfma_f32_16x16x32_bf16 v[140:143], v[28:31], a[92:95], v[140:143]
v_mfma_f32_16x16x32_bf16 v[128:131], v[32:35], a[96:99], v[128:131]
ds_read_b128 v[28:31], v7 offset:7168
v_mfma_f32_16x16x32_bf16 v[136:139], v[32:35], a[100:103], v[136:139]
v_mfma_f32_16x16x32_bf16 v[132:135], v[36:39], a[96:99], v[132:135]
ds_read_b128 v[32:35], v7 offset:8192
v_mfma_f32_16x16x32_bf16 v[140:143], v[36:39], a[100:103], v[140:143]
s_waitcnt lgkmcnt(4)
v_mfma_f32_16x16x32_bf16 v[128:131], v[40:43], a[104:107], v[128:131]
ds_read_b128 v[36:39], v7 offset:9216
v_mfma_f32_16x16x32_bf16 v[136:139], v[40:43], a[108:111], v[136:139]
s_cmp_lt_u32 s59, 3
s_cbranch_scc0 L_back30
L_slow30:
s_waitcnt lgkmcnt(0)
s_cmp_ge_u32 s59, 3
s_cbranch_scc1 L_back30
s_mov_b32 s59, 0
s_atomic_add s59, s[20:21], s55 offset:64 glc
s_sub_u32 s46, s46, 1
s_cbranch_scc0 L_slow30
s_endpgm
L_back30:
buffer_load_dwordx4 v[192:195], v0, s[20:23], s41 offen offset:0 sc1
buffer_load_dwordx4 v[196:199], v0, s[20:23], s41 offen offset:1024 sc1
s_add_u32 s41, s52, 4194304
s_mov_b32 s59, 0
s_waitcnt vmcnt(10)
s_atomic_add s45, s[20:21], s54 offset:64
v_mfma_f32_16x16x32_bf16 v[132:135], v[44:47], a[104:107], v[132:135]
ds_read_b128 v[40:43], v7 offset:10240
v_mfma_f32_16x16x32_bf16 v[140:143], v[44:47], a[108:111], v[140:143]
v_mfma_f32_16x16x32_bf16 v[128:131], v[16:19], a[112:115], v[128:131]
ds_read_b128 v[44:47], v7 offset:11264
v_mfma_f32_16x16x32_bf16 v[136:139], v[16:19], a[116:119], v[136:139]
s_waitcnt lgkmcnt(4)
v_mfma_f32_16x16x32_bf16 v[132:135], v[20:23], a[112:115], v[132:135]
ds_read_b128 v[16:19], v7 offset:12288
v_mfma_f32_16x16x32_bf16 v[140:143], v[20:23], a[116:119], v[140:143]
v_mfma_f32_16x16x32_bf16 v[128:131], v[24:27], a[120:123], v[128:131]
ds_read_b128 v[20:23], v7 offset:13312
v_mfma_f32_16x16x32_bf16 v[136:139], v[24:27], a[124:127], v[136:139]
v_mfma_f32_16x16x32_bf16 v[132:135], v[28:31], a[120:123], v[132:135]
ds_read_b128 v[24:27], v7 offset:14336
v_mfma_f32_16x16x32_bf16 v[140:143], v[28:31], a[124:127], v[140:143]
s_waitcnt lgkmcnt(4)
v_mfma_f32_16x16x32_bf16 v[144:147], v[32:35], a[160:163], v[144:147]
ds_read_b128 v[28:31], v7 offset:15360
v_mfma_f32_16x16x32_bf16 v[152:155], v[32:35], a[164:167], v[152:155]
v_mfma_f32_16x16x32_bf16 v[148:151], v[36:39], a[160:163], v[148:151]
s_barrier
ds_read_b128 v[32:35], v7 offset:16384
v_mfma_f32_16x16x32_bf16 v[156:159], v[36:39], a[164:167], v[156:159]
v_mfma_f32_16x16x32_bf16 v[144:147], v[40:43], a[168:171], v[144:147]
ds_read_b128 v[36:39], v7 offset:17408
v_mfma_f32_16x16x32_bf16 v[152:155], v[40:43], a[172:175], v[152:155]
s_waitcnt lgkmcnt(4)
v_mfma_f32_16x16x32_bf16 v[148:151], v[44:47], a[168:171], v[148:151]
ds_read_b128 v[40:43], v7 offset:18432
v_mfma_f32_16x16x32_bf16 v[156:159], v[44:47], a[172:175], v[156:159]
v_mfma_f32_16x16x32_bf16 v[144:147], v[16:19], a[176:179], v[144:147]
ds_read_b128 v[44:47], v7 offset:19456
v_mfma_f32_16x16x32_bf16 v[152:155], v[16:19], a[180:183], v[152:155]
v_mfma_f32_16x16x32_bf16 v[148:151], v[20:23], a[176:179], v[148:151]
ds_read_b128 v[16:19], v7 offset:20480
v_mfma_f32_16x16x32_bf16 v[156:159], v[20:23], a[180:183], v[156:159]
s_waitcnt lgkmcnt(4)
v_mfma_f32_16x16x32_bf16 v[144:147], v[24:27], a[184:187], v[144:147]
ds_read_b128 v[20:23], v7 offset:21504
v_mfma_f32_16x16x32_bf16 v[152:155], v[24:27], a[188:191], v[152:155]
v_mfma_f32_16x16x32_bf16 v[148:151], v[28:31], a[184:187], v[148:151]
ds_read_b128 v[24:27], v7 offset:22528
v_mfma_f32_16x16x32_bf16 v[156:159], v[28:31], a[188:191], v[156:159]
v_mfma_f32_16x16x32_bf16 v[144:147], v[32:35], a[192:195], v[144:147]
ds_read_b128 v[28:31], v7 offset:23552
v_mfma_f32_16x16x32_bf16 v[152:155], v[32:35], a[196:199], v[152:155]
s_waitcnt lgkmcnt(4)
v_mfma_f32_16x16x32_bf16 v[148:151], v[36:39], a[192:195], v[148:151]
ds_read_b128 v[32:35], v7 offset:24576
v_mfma_f32_16x16x32_bf16 v[156:159], v[36:39], a[196:199], v[156:159]
v_mfma_f32_16x16x32_bf16 v[144:147], v[40:43], a[200:203], v[144:147]
ds_read_b128 v[36:39], v7 offset:25600
v_mfma_f32_16x16x32_bf16 v[152:155], v[40:43], a[204:207], v[152:155]
v_mfma_f32_16x16x32_bf16 v[148:151], v[44:47], a[200:203], v[148:151]
ds_read_b128 v[40:43], v7 offset:26624
v_mfma_f32_16x16x32_bf16 v[156:159], v[44:47], a[204:207], v[156:159]
s_waitcnt lgkmcnt(4)
v_mfma_f32_16x16x32_bf16 v[144:147], v[16:19], a[208:211], v[144:147]
ds_read_b128 v[44:47], v7 offset:27648
v_mfma_f32_16x16x32_bf16 v[152:155], v[16:19], a[212:215], v[152:155]
s_atomic_add s59, s[20:21], s55 offset:64 glc
s_waitcnt vmcnt(1)
v_lshlrev_b32 v160, 16, v192
v_and_b32 v161, 0xffff0000, v192
v_lshlrev_b32 v162, 16, v193
v_mfma_f32_16x16x32_bf16 v[148:151], v[20:23], a[208:211], v[148:151]
ds_read_b128 v[16:19], v7 offset:28672
v_and_b32 v163, 0xffff0000, v193
v_mfma_f32_16x16x32_bf16 v[156:159], v[20:23], a[212:215], v[156:159]
v_lshlrev_b32 v164, 16, v194
v_and_b32 v165, 0xffff0000, v194
v_mfma_f32_16x16x32_bf16 v[144:147], v[24:27], a[216:219], v[144:147]
ds_read_b128 v[20:23], v7 offset:29696
v_lshlrev_b32 v166, 16, v195
v_mfma_f32_16x16x32_bf16 v[152:155], v[24:27], a[220:223], v[152:155]
v_and_b32 v167, 0xffff0000, v195
s_waitcnt vmcnt(0)
v_lshlrev_b32 v168, 16, v196
s_waitcnt lgkmcnt(5)
v_mfma_f32_16x16x32_bf16 v[148:151], v[28:31], a[216:219], v[148:151]
ds_read_b128 v[24:27], v7 offset:30720
v_and_b32 v169, 0xffff0000, v196
v_mfma_f32_16x16x32_bf16 v[156:159], v[28:31], a[220:223], v[156:159]
v_lshlrev_b32 v170, 16, v197
v_and_b32 v171, 0xffff0000, v197
v_mfma_f32_16x16x32_bf16 v[144:147], v[32:35], a[224:227], v[144:147]
ds_read_b128 v[28:31], v7 offset:31744
v_lshlrev_b32 v172, 16, v198
v_mfma_f32_16x16x32_bf16 v[152:155], v[32:35], a[228:231], v[152:155]
v_and_b32 v173, 0xffff0000, v198
v_lshlrev_b32 v174, 16, v199
s_waitcnt lgkmcnt(5)
v_mfma_f32_16x16x32_bf16 v[148:151], v[36:39], a[224:227], v[148:151]
s_barrier
ds_read_b128 v[32:35], v7 offset:32768
v_mfma_f32_16x16x32_bf16 v[156:159], v[36:39], a[228:231], v[156:159]
v_and_b32 v175, 0xffff0000, v199
v_add_f32 v128, v128, v160
v_add_f32 v129, v129, v161
v_mfma_f32_16x16x32_bf16 v[144:147], v[40:43], a[232:235], v[144:147]
ds_read_b128 v[36:39], v7 offset:33792
v_cvt_pk_bf16_f32 v48, v128, v129
v_mfma_f32_16x16x32_bf16 v[152:155], v[40:43], a[236:239], v[152:155]
v_add_f32 v130, v130, v162
v_add_f32 v131, v131, v163
s_waitcnt lgkmcnt(4)
v_mfma_f32_16x16x32_bf16 v[148:151], v[44:47], a[232:235], v[148:151]
ds_read_b128 v[40:43], v7 offset:34816
v_cvt_pk_bf16_f32 v49, v130, v131
v_mfma_f32_16x16x32_bf16 v[156:159], v[44:47], a[236:239], v[156:159]
v_add_f32 v132, v132, v164
v_add_f32 v133, v133, v165
v_mfma_f32_16x16x32_bf16 v[144:147], v[16:19], a[240:243], v[144:147]
ds_read_b128 v[44:47], v7 offset:35840
v_cvt_pk_bf16_f32 v50, v132, v133
v_mfma_f32_16x16x32_bf16 v[152:155], v[16:19], a[244:247], v[152:155]
v_add_f32 v134, v134, v166
v_add_f32 v135, v135, v167
v_mfma_f32_16x16x32_bf16 v[148:151], v[20:23], a[240:243], v[148:151]
ds_read_b128 v[16:19], v7 offset:36864
v_cvt_pk_bf16_f32 v51, v134, v135
v_mfma_f32_16x16x32_bf16 v[156:159], v[20:23], a[244:247], v[156:159]
v_add_f32 v136, v136, v168
v_add_f32 v137, v137, v169
s_waitcnt lgkmcnt(4)
v_mfma_f32_16x16x32_bf16 v[144:147], v[24:27], a[248:251], v[144:147]
ds_read_b128 v[20:23], v7 offset:37888
v_cvt_pk_bf16_f32 v52, v136, v137
v_mfma_f32_16x16x32_bf16 v[152:155], v[24:27], a[252:255], v[152:155]
v_add_f32 v138, v138, v170
v_add_f32 v139, v139, v171
v_mfma_f32_16x16x32_bf16 v[148:151], v[28:31], a[248:251], v[148:151]
ds_read_b128 v[24:27], v7 offset:38912
v_cvt_pk_bf16_f32 v53, v138, v139
v_mfma_f32_16x16x32_bf16 v[156:159], v[28:31], a[252:255], v[156:159]
v_add_f32 v140, v140, v172
v_add_f32 v141, v141, v173
v_mfma_f32_16x16x32_bf16 v[144:147], v[32:35], a[0:3], v[144:147]
ds_read_b128 v[28:31], v7 offset:39936
v_cvt_pk_bf16_f32 v54, v140, v141
v_mfma_f32_16x16x32_bf16 v[152:155], v[32:35], a[4:7], v[152:155]
v_add_f32 v142, v142, v174
v_add_f32 v143, v143, v175
s_waitcnt lgkmcnt(4)
v_mfma_f32_16x16x32_bf16 v[148:151], v[36:39], a[0:3], v[148:151]
ds_read_b128 v[32:35], v7 offset:40960
v_cvt_pk_bf16_f32 v55, v142, v143
v_mfma_f32_16x16x32_bf16 v[156:159], v[36:39], a[4:7], v[156:159]
v_permlane16_swap_b32 v48, v50
v_permlane16_swap_b32 v49, v51
v_mfma_f32_16x16x32_bf16 v[144:147], v[40:43], a[8:11], v[144:147]
ds_read_b128 v[36:39], v7 offset:41984
buffer_store_dwordx4 v[48:51], v209, s[24:27], s37 offen offset:0 sc1
v_mfma_f32_16x16x32_bf16 v[152:155], v[40:43], a[12:15], v[152:155]
v_permlane16_swap_b32 v52, v54
v_permlane16_swap_b32 v53, v55
v_mfma_f32_16x16x32_bf16 v[148:151], v[44:47], a[8:11], v[148:151]
buffer_store_dwordx4 v[52:55], v209, s[24:27], s38 offen offset:0 sc1
v_mfma_f32_16x16x32_bf16 v[156:159], v[44:47], a[12:15], v[156:159]
ds_read_b128 v[40:43], v7 offset:43008
s_waitcnt lgkmcnt(4)
v_mfma_f32_16x16x32_bf16 v[144:147], v[16:19], a[16:19], v[144:147]
ds_read_b128 v[44:47], v7 offset:44032
v_mfma_f32_16x16x32_bf16 v[152:155], v[16:19], a[20:23], v[152:155]
v_mfma_f32_16x16x32_bf16 v[148:151], v[20:23], a[16:19], v[148:151]
ds_read_b128 v[16:19], v7 offset:45056
v_mfma_f32_16x16x32_bf16 v[156:159], v[20:23], a[20:23], v[156:159]
v_mfma_f32_16x16x32_bf16 v[144:147], v[24:27], a[24:27], v[144:147]
ds_read_b128 v[20:23], v7 offset:46080
v_mfma_f32_16x16x32_bf16 v[152:155], v[24:27], a[28:31], v[152:155]
s_waitcnt lgkmcnt(4)
v_mfma_f32_16x16x32_bf16 v[148:151], v[28:31], a[24:27], v[148:151]
ds_read_b128 v[24:27], v7 offset:47104
v_mfma_f32_16x16x32_bf16 v[156:159], v[28:31], a[28:31], v[156:159]
v_mfma_f32_16x16x32_bf16 v[144:147], v[32:35], a[32:35], v[144:147]
ds_read_b128 v[28:31], v7 offset:48128
v_mfma_f32_16x16x32_bf16 v[152:155], v[32:35], a[36:39], v[152:155]
v_mfma_f32_16x16x32_bf16 v[148:151], v[36:39], a[32:35], v[148:151]
s_barrier
ds_read_b128 v[32:35], v7 offset:49152
v_mfma_f32_16x16x32_bf16 v[156:159], v[36:39], a[36:39], v[156:159]
s_waitcnt lgkmcnt(4)
v_mfma_f32_16x16x32_bf16 v[144:147], v[40:43], a[40:43], v[144:147]
ds_read_b128 v[36:39], v7 offset:50176
v_mfma_f32_16x16x32_bf16 v[152:155], v[40:43], a[44:47], v[152:155]
v_mfma_f32_16x16x32_bf16 v[148:151], v[44:47], a[40:43], v[148:151]
ds_read_b128 v[40:43], v7 offset:51200
v_mfma_f32_16x16x32_bf16 v[156:159], v[44:47], a[44:47], v[156:159]
v_mfma_f32_16x16x32_bf16 v[144:147], v[16:19], a[48:51], v[144:147]
ds_read_b128 v[44:47], v7 offset:52224
v_mfma_f32_16x16x32_bf16 v[152:155], v[16:19], a[52:55], v[152:155]
s_waitcnt lgkmcnt(4)
v_mfma_f32_16x16x32_bf16 v[148:151], v[20:23], a[48:51], v[148:151]
ds_read_b128 v[16:19], v7 offset:53248
v_mfma_f32_16x16x32_bf16 v[156:159], v[20:23], a[52:55], v[156:159]
v_mfma_f32_16x16x32_bf16 v[144:147], v[24:27], a[56:59], v[144:147]
ds_read_b128 v[20:23], v7 offset:54272
v_mfma_f32_16x16x32_bf16 v[152:155], v[24:27], a[60:63], v[152:155]
s_cmp_lt_u32 s59, 4
s_cbranch_scc0 L_back31
L_slow31:
s_waitcnt lgkmcnt(0)
s_cmp_ge_u32 s59, 4
s_cbranch_scc1 L_back31
s_mov_b32 s59, 0
s_atomic_add s59, s[20:21], s55 offset:64 glc
s_sub_u32 s46, s46, 1
s_cbranch_scc0 L_slow31
s_endpgm
L_back31:
buffer_load_dwordx4 v[200:203], v0, s[20:23], s41 offen offset:2048 sc1
buffer_load_dwordx4 v[204:207], v0, s[20:23], s41 offen offset:3072 sc1
v_mfma_f32_16x16x32_bf16 v[148:151], v[28:31], a[56:59], v[148:151]
ds_read_b128 v[24:27], v7 offset:55296
v_mfma_f32_16x16x32_bf16 v[156:159], v[28:31], a[60:63], v[156:159]
s_waitcnt lgkmcnt(3)
v_mfma_f32_16x16x32_bf16 v[144:147], v[32:35], a[64:67], v[144:147]
ds_read_b128 v[28:31], v7 offset:56320
v_mfma_f32_16x16x32_bf16 v[152:155], v[32:35], a[68:71], v[152:155]
v_mfma_f32_16x16x32_bf16 v[148:151], v[36:39], a[64:67], v[148:151]
ds_read_b128 v[32:35], v7 offset:57344
v_mfma_f32_16x16x32_bf16 v[156:159], v[36:39], a[68:71], v[156:159]
v_mfma_f32_16x16x32_bf16 v[144:147], v[40:43], a[72:75], v[144:147]
ds_read_b128 v[36:39], v7 offset:58368
v_mfma_f32_16x16x32_bf16 v[152:155], v[40:43], a[76:79], v[152:155]
v_mfma_f32_16x16x32_bf16 v[148:151], v[44:47], a[72:75], v[148:151]
ds_read_b128 v[40:43], v7 offset:59392
v_mfma_f32_16x16x32_bf16 v[156:159], v[44:47], a[76:79], v[156:159]
s_waitcnt lgkmcnt(3)
v_mfma_f32_16x16x32_bf16 v[144:147], v[16:19], a[80:83], v[144:147]
ds_read_b128 v[44:47], v7 offset:60416
v_mfma_f32_16x16x32_bf16 v[152:155], v[16:19], a[84:87], v[152:155]
v_mfma_f32_16x16x32_bf16 v[148:151], v[20:23], a[80:83], v[148:151]
ds_read_b128 v[16:19], v7 offset:61440
v_mfma_f32_16x16x32_bf16 v[156:159], v[20:23], a[84:87], v[156:159]
v_mfma_f32_16x16x32_bf16 v[144:147], v[24:27], a[88:91], v[144:147]
ds_read_b128 v[20:23], v7 offset:62464
v_mfma_f32_16x16x32_bf16 v[152:155], v[24:27], a[92:95], v[152:155]
v_mfma_f32_16x16x32_bf16 v[148:151], v[28:31], a[88:91], v[148:151]
ds_read_b128 v[24:27], v7 offset:63488
v_mfma_f32_16x16x32_bf16 v[156:159], v[28:31], a[92:95], v[156:159]
s_waitcnt lgkmcnt(3)
v_mfma_f32_16x16x32_bf16 v[144:147], v[32:35], a[96:99], v[144:147]
ds_read_b128 v[28:31], v7 offset:64512
v_mfma_f32_16x16x32_bf16 v[152:155], v[32:35], a[100:103], v[152:155]
v_mfma_f32_16x16x32_bf16 v[148:151], v[36:39], a[96:99], v[148:151]
v_mfma_f32_16x16x32_bf16 v[156:159], v[36:39], a[100:103], v[156:159]
v_mfma_f32_16x16x32_bf16 v[144:147], v[40:43], a[104:107], v[144:147]
v_mfma_f32_16x16x32_bf16 v[152:155], v[40:43], a[108:111], v[152:155]
v_mfma_f32_16x16x32_bf16 v[148:151], v[44:47], a[104:107], v[148:151]
v_mfma_f32_16x16x32_bf16 v[156:159], v[44:47], a[108:111], v[156:159]
s_waitcnt lgkmcnt(0)
v_mfma_f32_16x16x32_bf16 v[144:147], v[16:19], a[112:115], v[144:147]
v_mfma_f32_16x16x32_bf16 v[152:155], v[16:19], a[116:119], v[152:155]
v_mfma_f32_16x16x32_bf16 v[148:151], v[20:23], a[112:115], v[148:151]
v_mfma_f32_16x16x32_bf16 v[156:159], v[20:23], a[116:119], v[156:159]
v_mfma_f32_16x16x32_bf16 v[144:147], v[24:27], a[120:123], v[144:147]
v_mfma_f32_16x16x32_bf16 v[152:155], v[24:27], a[124:127], v[152:155]
v_mfma_f32_16x16x32_bf16 v[148:151], v[28:31], a[120:123], v[148:151]
v_mfma_f32_16x16x32_bf16 v[156:159], v[28:31], a[124:127], v[156:159]
s_waitcnt vmcnt(1)
v_lshlrev_b32 v176, 16, v200
v_and_b32 v177, 0xffff0000, v200
v_lshlrev_b32 v178, 16, v201
v_and_b32 v179, 0xffff0000, v201
v_lshlrev_b32 v180, 16, v202
v_and_b32 v181, 0xffff0000, v202
v_lshlrev_b32 v182, 16, v203
v_and_b32 v183, 0xffff0000, v203
s_waitcnt vmcnt(0)
v_lshlrev_b32 v184, 16, v204
v_and_b32 v185, 0xffff0000, v204
v_lshlrev_b32 v186, 16, v205
v_and_b32 v187, 0xffff0000, v205
v_lshlrev_b32 v188, 16, v206
v_and_b32 v189, 0xffff0000, v206
v_lshlrev_b32 v190, 16, v207
v_and_b32 v191, 0xffff0000, v207
v_add_f32 v144, v144, v176
v_add_f32 v145, v145, v177
v_cvt_pk_bf16_f32 v56, v144, v145
v_add_f32 v146, v146, v178
v_add_f32 v147, v147, v179
v_cvt_pk_bf16_f32 v57, v146, v147
v_add_f32 v148, v148, v180
v_add_f32 v149, v149, v181
v_cvt_pk_bf16_f32 v58, v148, v149
v_add_f32 v150, v150, v182
v_add_f32 v151, v151, v183
v_cvt_pk_bf16_f32 v59, v150, v151
v_add_f32 v152, v152, v184
v_add_f32 v153, v153, v185
v_cvt_pk_bf16_f32 v60, v152, v153
v_add_f32 v154, v154, v186
v_add_f32 v155, v155, v187
v_cvt_pk_bf16_f32 v61, v154, v155
v_add_f32 v156, v156, v188
v_add_f32 v157, v157, v189
v_cvt_pk_bf16_f32 v62, v156, v157
v_add_f32 v158, v158, v190
v_add_f32 v159, v159, v191
v_cvt_pk_bf16_f32 v63, v158, v159
v_permlane16_swap_b32 v56, v58
v_permlane16_swap_b32 v57, v59
buffer_store_dwordx4 v[56:59], v209, s[24:27], s37 offen offset:64 sc1
v_permlane16_swap_b32 v60, v62
v_permlane16_swap_b32 v61, v63
buffer_store_dwordx4 v[60:63], v209, s[24:27], s38 offen offset:64 sc1
s_endpgm
.p2align 7
.type L_tab,@object
L_tab:
.long 2048,198656,0,229376,0,128,0,0,0,1024,4096,5120,131072,132096,135168,136192,524288,525312,526336,527360,655360,656384,657408,658432,987136,988160,989184,990208,983040,984064,985088,986112
.long 4096,200704,128,229504,917504,917632,0,0,2048,3072,6144,7168,133120,134144,137216,138240,528384,529408,530432,531456,659456,660480,661504,662528,995328,996352,997376,998400,991232,992256,993280,994304
.long 0,196608,256,229632,1835008,1835136,0,0,262144,263168,327680,328704,294912,295936,360448,361472,786432,787456,788480,789504,884736,885760,886784,887808,1003520,1004544,1005568,1006592,999424,1000448,1001472,1002496
.long 0,65536,384,229760,2752512,1073741824,0,0,393216,394240,395264,396288,458752,459776,491520,492544,790528,791552,1073741824,1073741824,888832,889856,1073741824,1073741824,1011712,1012736,1013760,1014784,1073741824,1073741824,1073741824,1073741824
.long 395264,591872,458752,688128,2752640,3670016,0,0,65536,66560,69632,70656,159744,160768,217088,218112,589824,590848,591872,592896,720896,721920,722944,723968,1007616,1008640,1009664,1010688,1019904,1020928,1021952,1022976
.long 397312,593920,458880,688256,3670144,4587520,0,0,67584,68608,71680,72704,188416,189440,245760,246784,593920,594944,595968,596992,724992,726016,727040,728064,1015808,1016832,1017856,1018880,1028096,1029120,1030144,1031168
.long 393216,589824,459008,688384,4587648,5505024,0,0,278528,279552,344064,345088,311296,312320,376832,377856,835584,836608,837632,838656,933888,934912,935936,936960,1024000,1025024,1026048,1027072,1036288,1037312,1038336,1039360
.long 131072,196608,459136,688512,5505152,1073741824,0,0,425984,427008,428032,429056,475136,476160,507904,508928,839680,840704,1073741824,1073741824,937984,939008,1073741824,1073741824,1032192,1033216,1034240,1035264,1073741824,1073741824,1073741824,1073741824
.long 788480,985088,917504,1146880,6422528,6422656,0,0,8192,9216,12288,13312,139264,140288,143360,144384,532480,533504,534528,535552,663552,664576,665600,666624,1044480,1045504,1046528,1047552,1040384,1041408,1042432,1043456
.long 790528,987136,917632,1147008,65536,65664,0,0,10240,11264,14336,15360,141312,142336,145408,146432,536576,537600,538624,539648,667648,668672,669696,670720,1052672,1053696,1054720,1055744,1048576,1049600,1050624,1051648
.long 786432,983040,917760,1147136,983040,983168,0,0,264192,265216,329728,330752,296960,297984,362496,363520,792576,793600,794624,795648,890880,891904,892928,893952,1060864,1061888,1062912,1063936,1056768,1057792,1058816,1059840
.long 262144,327680,917888,1147264,1900544,1073741824,0,0,397312,398336,399360,400384,460800,461824,493568,494592,796672,797696,1073741824,1073741824,894976,896000,1073741824,1073741824,1069056,1070080,1071104,1072128,1073741824,1073741824,1073741824,1073741824
.long 1181696,1378304,1376256,1605632,1900672,2818048,0,0,73728,74752,77824,78848,161792,162816,219136,220160,598016,599040,600064,601088,729088,730112,731136,732160,1064960,1065984,1067008,1068032,1077248,1078272,1079296,1080320
.long 1183744,1380352,1376384,1605760,2818176,3735552,0,0,75776,76800,79872,80896,190464,191488,247808,248832,602112,603136,604160,605184,733184,734208,735232,736256,1073152,1074176,1075200,1076224,1085440,1086464,1087488,1088512
.long 1179648,1376256,1376512,1605888,3735680,4653056,0,0,280576,281600,346112,347136,313344,314368,378880,379904,841728,842752,843776,844800,940032,941056,942080,943104,1081344,1082368,1083392,1084416,1093632,1094656,1095680,1096704
.long 393216,458752,1376640,1606016,4653184,1073741824,0,0,430080,431104,432128,433152,477184,478208,509952,510976,845824,846848,1073741824,1073741824,944128,945152,1073741824,1073741824,1089536,1090560,1091584,1092608,1073741824,1073741824,1073741824,1073741824
.long 1574912,1771520,1835008,2064384,5570560,5570688,0,0,16384,17408,20480,21504,147456,148480,204800,205824,540672,541696,542720,543744,671744,672768,673792,674816,1101824,1102848,1103872,1104896,1097728,1098752,1099776,1100800
.long 1576960,1773568,1835136,2064512,6488064,6488192,0,0,18432,19456,22528,23552,176128,177152,233472,234496,544768,545792,546816,547840,675840,676864,677888,678912,1110016,1111040,1112064,1113088,1105920,1106944,1107968,1108992
.long 1572864,1769472,1835264,2064640,131072,131200,0,0,266240,267264,331776,332800,299008,300032,364544,365568,798720,799744,800768,801792,897024,898048,899072,900096,1118208,1119232,1120256,1121280,1114112,1115136,1116160,1117184
.long 524288,589824,1835392,2064768,1048576,1073741824,0,0,401408,402432,403456,404480,462848,463872,495616,496640,802816,803840,1073741824,1073741824,901120,902144,1073741824,1073741824,1126400,1127424,1128448,1129472,1073741824,1073741824,1073741824,1073741824
.long 1968128,2164736,2293760,2523136,1048704,1966080,0,0,81920,82944,86016,87040,163840,164864,221184,222208,606208,607232,608256,609280,737280,738304,739328,740352,1122304,1123328,1124352,1125376,1134592,1135616,1136640,1137664
.long 1970176,2166784,2293888,2523264,1966208,2883584,0,0,83968,84992,88064,89088,192512,193536,249856,250880,610304,611328,612352,613376,741376,742400,743424,744448,1130496,1131520,1132544,1133568,1142784,1143808,1144832,1145856
.long 1966080,2162688,2294016,2523392,2883712,3801088,0,0,282624,283648,348160,349184,315392,316416,380928,381952,847872,848896,849920,850944,946176,947200,948224,949248,1138688,1139712,1140736,1141760,1150976,1152000,1153024,1154048
.long 655360,720896,2294144,2523520,3801216,1073741824,0,0,434176,435200,436224,437248,479232,480256,512000,513024,851968,852992,1073741824,1073741824,950272,951296,1073741824,1073741824,1146880,1147904,1148928,1149952,1073741824,1073741824,1073741824,1073741824
.long 2361344,2557952,2752512,2981888,4718592,4718720,0,0,24576,25600,28672,29696,149504,150528,206848,207872,548864,549888,550912,551936,679936,680960,681984,683008,1159168,1160192,1161216,1162240,1155072,1156096,1157120,1158144
.long 2363392,2560000,2752640,2982016,5636096,5636224,0,0,26624,27648,30720,31744,178176,179200,235520,236544,552960,553984,555008,556032,684032,685056,686080,687104,1167360,1168384,1169408,1170432,1163264,1164288,1165312,1166336
.long 2359296,2555904,2752768,2982144,6553600,6553728,0,0,268288,269312,333824,334848,301056,302080,366592,367616,804864,805888,806912,807936,903168,904192,905216,906240,1175552,1176576,1177600,1178624,1171456,1172480,1173504,1174528
.long 786432,851968,2752896,2982272,196608,1073741824,0,0,405504,406528,407552,408576,464896,465920,497664,498688,808960,809984,1073741824,1073741824,907264,908288,1073741824,1073741824,1183744,1184768,1185792,1186816,1073741824,1073741824,1073741824,1073741824
.long 2754560,2951168,3211264,3440640,196736,1114112,0,0,90112,91136,94208,95232,165888,166912,223232,224256,614400,615424,616448,617472,745472,746496,747520,748544,1179648,1180672,1181696,1182720,1191936,1192960,1193984,1195008
.long 2756608,2953216,3211392,3440768,1114240,2031616,0,0,92160,93184,96256,97280,194560,195584,251904,252928,618496,619520,620544,621568,749568,750592,751616,752640,1187840,1188864,1189888,1190912,1200128,1201152,1202176,1203200
.long 2752512,2949120,3211520,3440896,2031744,2949120,0,0,284672,285696,350208,351232,317440,318464,382976,384000,854016,855040,856064,857088,952320,953344,954368,955392,1196032,1197056,1198080,1199104,1208320,1209344,1210368,1211392
.long 917504,983040,3211648,3441024,2949248,1073741824,0,0,438272,439296,440320,441344,481280,482304,514048,515072,858112,859136,1073741824,1073741824,956416,957440,1073741824,1073741824,1204224,1205248,1206272,1207296,1073741824,1073741824,1073741824,1073741824
.long 3147776,3344384,3670016,3899392,3866624,3866752,0,0,32768,33792,36864,37888,151552,152576,208896,209920,557056,558080,559104,560128,688128,689152,690176,691200,1216512,1217536,1384448,1385472,1212416,1213440,1214464,1215488
.long 3149824,3346432,3670144,3899520,4784128,4784256,0,0,34816,35840,38912,39936,180224,181248,237568,238592,561152,562176,563200,564224,692224,693248,694272,695296,1222656,1223680,1386496,1387520,1218560,1219584,1220608,1221632
.long 3145728,3342336,3670272,3899648,5701632,5701760,0,0,270336,271360,335872,336896,303104,304128,368640,369664,811008,812032,813056,814080,909312,910336,911360,912384,1228800,1229824,1388544,1389568,1224704,1225728,1226752,1227776
.long 1048576,1114112,3670400,3899776,6619136,1073741824,0,0,409600,410624,411648,412672,466944,467968,499712,500736,815104,816128,1073741824,1073741824,913408,914432,1073741824,1073741824,1234944,1235968,1390592,1391616,1073741824,1073741824,1073741824,1073741824
.long 3540992,3737600,4128768,4358144,6619264,262144,0,0,98304,99328,102400,103424,167936,168960,225280,226304,622592,623616,624640,625664,753664,754688,755712,756736,1230848,1231872,1232896,1233920,1335296,1336320,1392640,1393664
.long 3543040,3739648,4128896,4358272,262272,1179648,0,0,100352,101376,104448,105472,196608,197632,253952,254976,626688,627712,628736,629760,757760,758784,759808,760832,1236992,1238016,1239040,1240064,1337344,1338368,1394688,1395712
.long 3538944,3735552,4129024,4358400,1179776,2097152,0,0,286720,287744,352256,353280,319488,320512,385024,386048,860160,861184,862208,863232,958464,959488,960512,961536,1241088,1242112,1243136,1244160,1339392,1340416,1396736,1397760
.long 1179648,1245184,4129152,4358528,2097280,1073741824,0,0,442368,443392,444416,445440,483328,484352,516096,517120,864256,865280,1073741824,1073741824,962560,963584,1073741824,1073741824,1245184,1246208,1247232,1248256,1073741824,1073741824,1073741824,1073741824
.long 3934208,4130816,4587520,4816896,3014656,3014784,0,0,40960,41984,45056,46080,153600,154624,210944,211968,565248,566272,567296,568320,696320,697344,698368,699392,1341440,1342464,1398784,1399808,1249280,1250304,1251328,1252352
.long 3936256,4132864,4587648,4817024,3932160,3932288,0,0,43008,44032,47104,48128,182272,183296,239616,240640,569344,570368,571392,572416,700416,701440,702464,703488,1343488,1344512,1400832,1401856,1253376,1254400,1255424,1256448
.long 3932160,4128768,4587776,4817152,4849664,4849792,0,0,272384,273408,337920,338944,305152,306176,370688,371712,817152,818176,819200,820224,915456,916480,917504,918528,1345536,1346560,1402880,1403904,1257472,1258496,1259520,1260544
.long 1310720,1376256,4587904,4817280,5767168,1073741824,0,0,413696,414720,415744,416768,468992,470016,501760,502784,821248,822272,1073741824,1073741824,919552,920576,1073741824,1073741824,1347584,1348608,1404928,1405952,1073741824,1073741824,1073741824,1073741824
.long 4327424,4524032,5046272,5275648,5767296,6684672,0,0,106496,107520,110592,111616,169984,171008,227328,228352,630784,631808,632832,633856,761856,762880,763904,764928,1261568,1262592,1263616,1264640,1349632,1350656,1406976,1408000
.long 4329472,4526080,5046400,5275776,6684800,327680,0,0,108544,109568,112640,113664,198656,199680,256000,257024,634880,635904,636928,637952,765952,766976,768000,769024,1265664,1266688,1267712,1268736,1351680,1352704,1409024,1410048
.long 4325376,4521984,5046528,5275904,327808,1245184,0,0,288768,289792,354304,355328,321536,322560,387072,388096,866304,867328,868352,869376,964608,965632,966656,967680,1269760,1270784,1271808,1272832,1353728,1354752,1411072,1412096
.long 1441792,1507328,5046656,5276032,1245312,1073741824,0,0,446464,447488,448512,449536,485376,486400,518144,519168,870400,871424,1073741824,1073741824,968704,969728,1073741824,1073741824,1273856,1274880,1275904,1276928,1073741824,1073741824,1073741824,1073741824
.long 4720640,4917248,5505024,5734400,2162688,2162816,0,0,49152,50176,53248,54272,155648,156672,212992,214016,573440,574464,575488,576512,704512,705536,706560,707584,1355776,1356800,1413120,1414144,1277952,1278976,1280000,1281024
.long 4722688,4919296,5505152,5734528,3080192,3080320,0,0,51200,52224,55296,56320,184320,185344,241664,242688,577536,578560,579584,580608,708608,709632,710656,711680,1357824,1358848,1415168,1416192,1282048,1283072,1284096,1285120
.long 4718592,4915200,5505280,5734656,3997696,3997824,0,0,274432,275456,339968,340992,307200,308224,372736,373760,823296,824320,825344,826368,921600,922624,923648,924672,1359872,1360896,1417216,1418240,1286144,1287168,1288192,1289216
.long 1572864,1638400,5505408,5734784,4915200,1073741824,0,0,417792,418816,419840,420864,471040,472064,503808,504832,827392,828416,1073741824,1073741824,925696,926720,1073741824,1073741824,1361920,1362944,1419264,1420288,1073741824,1073741824,1073741824,1073741824
.long 5113856,5310464,5963776,6193152,4915328,5832704,0,0,114688,115712,118784,119808,172032,173056,229376,230400,638976,640000,641024,642048,770048,771072,772096,773120,1290240,1291264,1292288,1293312,1363968,1364992,1421312,1422336
.long 5115904,5312512,5963904,6193280,5832832,6750208,0,0,116736,117760,120832,121856,200704,201728,258048,259072,643072,644096,645120,646144,774144,775168,776192,777216,1294336,1295360,1296384,1297408,1366016,1367040,1423360,1424384
.long 5111808,5308416,5964032,6193408,6750336,393216,0,0,290816,291840,356352,357376,323584,324608,389120,390144,872448,873472,874496,875520,970752,971776,972800,973824,1298432,1299456,1300480,1301504,1368064,1369088,1425408,1426432
.long 1703936,1769472,5964160,6193536,393344,1073741824,0,0,450560,451584,452608,453632,487424,488448,520192,521216,876544,877568,1073741824,1073741824,974848,975872,1073741824,1073741824,1302528,1303552,1318912,1319936,1073741824,1073741824,1073741824,1073741824
.long 5507072,5703680,6422528,6651904,1310720,1310848,0,0,57344,58368,61440,62464,157696,158720,215040,216064,581632,582656,583680,584704,712704,713728,714752,715776,1370112,1371136,1427456,1428480,1304576,1305600,1320960,1321984
.long 5509120,5705728,6422656,6652032,2228224,2228352,0,0,59392,60416,63488,64512,186368,187392,243712,244736,585728,586752,587776,588800,716800,717824,718848,719872,1372160,1373184,1429504,1430528,1306624,1307648,1323008,1324032
.long 5505024,5701632,6422784,6652160,3145728,3145856,0,0,276480,277504,342016,343040,309248,310272,374784,375808,829440,830464,831488,832512,927744,928768,929792,930816,1374208,1375232,1431552,1432576,1308672,1309696,1325056,1326080
.long 1835008,1900544,6422912,6652288,4063232,1073741824,0,0,421888,422912,423936,424960,473088,474112,505856,506880,833536,834560,1073741824,1073741824,931840,932864,1073741824,1073741824,1376256,1377280,1433600,1434624,1073741824,1073741824,1073741824,1073741824
.long 5900288,6096896,6881280,7110656,4063360,4980736,0,0,122880,123904,126976,128000,174080,175104,231424,232448,647168,648192,649216,650240,778240,779264,780288,781312,1310720,1311744,1327104,1328128,1378304,1379328,1435648,1436672
.long 5902336,6098944,6881408,7110784,4980864,5898240,0,0,124928,125952,129024,130048,202752,203776,260096,261120,651264,652288,653312,654336,782336,783360,784384,785408,1312768,1313792,1329152,1330176,1380352,1381376,1437696,1438720
.long 5898240,6094848,6881536,7110912,5898368,6815744,0,0,292864,293888,358400,359424,325632,326656,391168,392192,878592,879616,880640,881664,976896,977920,978944,979968,1314816,1315840,1331200,1332224,1382400,1383424,1439744,1440768
.long 1966080,2031616,6881664,7111040,6815872,1073741824,0,0,454656,455680,456704,457728,489472,490496,522240,523264,882688,883712,1073741824,1073741824,980992,982016,1073741824,1073741824,1316864,1317888,1333248,1334272,1073741824,1073741824,1073741824,1073741824
.long 2176,198784,512,229888,524416,524288,0,0,65536,66560,69632,70656,159744,160768,217088,218112,589824,590848,591872,592896,720896,721920,722944,723968,987136,988160,989184,990208,983040,984064,985088,986112
.long 4224,200832,640,230016,1441920,1441792,0,0,67584,68608,71680,72704,188416,189440,245760,246784,593920,594944,595968,596992,724992,726016,727040,728064,995328,996352,997376,998400,991232,992256,993280,994304
.long 128,196736,768,230144,2359424,2359296,0,0,278528,279552,344064,345088,311296,312320,376832,377856,835584,836608,837632,838656,933888,934912,935936,936960,1003520,1004544,1005568,1006592,999424,1000448,1001472,1002496
.long 128,65664,384,229760,3276928,1073741824,0,0,425984,427008,428032,429056,475136,476160,507904,508928,1073741824,1073741824,839680,840704,1073741824,1073741824,937984,939008,1011712,1012736,1013760,1014784,1073741824,1073741824,1073741824,1073741824
.long 395392,592000,459264,688640,3276800,4194432,0,0,0,1024,4096,5120,131072,132096,135168,136192,524288,525312,526336,527360,655360,656384,657408,658432,1007616,1008640,1009664,1010688,1019904,1020928,1021952,1022976
.long 397440,594048,459392,688768,4194304,5111936,0,0,2048,3072,6144,7168,133120,134144,137216,138240,528384,529408,530432,531456,659456,660480,661504,662528,1015808,1016832,1017856,1018880,1028096,1029120,1030144,1031168
.long 393344,589952,459520,688896,5111808,6029440,0,0,262144,263168,327680,328704,294912,295936,360448,361472,786432,787456,788480,789504,884736,885760,886784,887808,1024000,1025024,1026048,1027072,1036288,1037312,1038336,1039360
.long 131200,196736,459136,688512,6029312,1073741824,0,0,393216,394240,395264,396288,458752,459776,491520,492544,1073741824,1073741824,790528,791552,1073741824,1073741824,888832,889856,1032192,1033216,1034240,1035264,1073741824,1073741824,1073741824,1073741824
.long 788608,985216,918016,1147392,6946944,6946816,0,0,73728,74752,77824,78848,161792,162816,219136,220160,598016,599040,600064,601088,729088,730112,731136,732160,1044480,1045504,1046528,1047552,1040384,1041408,1042432,1043456
.long 790656,987264,918144,1147520,589952,589824,0,0,75776,76800,79872,80896,190464,191488,247808,248832,602112,603136,604160,605184,733184,734208,735232,736256,1052672,1053696,1054720,1055744,1048576,1049600,1050624,1051648
.long 786560,983168,918272,1147648,1507456,1507328,0,0,280576,281600,346112,347136,313344,314368,378880,379904,841728,842752,843776,844800,940032,941056,942080,943104,1060864,1061888,1062912,1063936,1056768,1057792,1058816,1059840
.long 262272,327808,917888,1147264,2424960,1073741824,0,0,430080,431104,432128,433152,477184,478208,509952,510976,1073741824,1073741824,845824,846848,1073741824,1073741824,944128,945152,1069056,1070080,1071104,1072128,1073741824,1073741824,1073741824,1073741824
.long 1181824,1378432,1376768,1606144,2424832,3342464,0,0,8192,9216,12288,13312,139264,140288,143360,144384,532480,533504,534528,535552,663552,664576,665600,666624,1064960,1065984,1067008,1068032,1077248,1078272,1079296,1080320
.long 1183872,1380480,1376896,1606272,3342336,4259968,0,0,10240,11264,14336,15360,141312,142336,145408,146432,536576,537600,538624,539648,667648,668672,669696,670720,1073152,1074176,1075200,1076224,1085440,1086464,1087488,1088512
.long 1179776,1376384,1377024,1606400,4259840,5177472,0,0,264192,265216,329728,330752,296960,297984,362496,363520,792576,793600,794624,795648,890880,891904,892928,893952,1081344,1082368,1083392,1084416,1093632,1094656,1095680,1096704
.long 393344,458880,1376640,1606016,5177344,1073741824,0,0,397312,398336,399360,400384,460800,461824,493568,494592,1073741824,1073741824,796672,797696,1073741824,1073741824,894976,896000,1089536,1090560,1091584,1092608,1073741824,1073741824,1073741824,1073741824
.long 1575040,1771648,1835520,2064896,6094976,6094848,0,0,81920,82944,86016,87040,163840,164864,221184,222208,606208,607232,608256,609280,737280,738304,739328,740352,1101824,1102848,1103872,1104896,1097728,1098752,1099776,1100800
.long 1577088,1773696,1835648,2065024,7012480,7012352,0,0,83968,84992,88064,89088,192512,193536,249856,250880,610304,611328,612352,613376,741376,742400,743424,744448,1110016,1111040,1112064,1113088,1105920,1106944,1107968,1108992
.long 1572992,1769600,1835776,2065152,655488,655360,0,0,282624,283648,348160,349184,315392,316416,380928,381952,847872,848896,849920,850944,946176,947200,948224,949248,1118208,1119232,1120256,1121280,1114112,1115136,1116160,1117184
.long 524416,589952,1835392,2064768,1572992,1073741824,0,0,434176,435200,436224,437248,479232,480256,512000,513024,1073741824,1073741824,851968,852992,1073741824,1073741824,950272,951296,1126400,1127424,1128448,1129472,1073741824,1073741824,1073741824,1073741824
.long 1968256,2164864,2294272,2523648,1572864,2490496,0,0,16384,17408,20480,21504,147456,148480,204800,205824,540672,541696,542720,543744,671744,672768,673792,674816,1122304,1123328,1124352,1125376,1134592,1135616,1136640,1137664
.long 1970304,2166912,2294400,2523776,2490368,3408000,0,0,18432,19456,22528,23552,176128,177152,233472,234496,544768,545792,546816,547840,675840,676864,677888,678912,1130496,1131520,1132544,1133568,1142784,1143808,1144832,1145856
.long 1966208,2162816,2294528,2523904,3407872,4325504,0,0,266240,267264,331776,332800,299008,300032,364544,365568,798720,799744,800768,801792,897024,898048,899072,900096,1138688,1139712,1140736,1141760,1150976,1152000,1153024,1154048
.long 655488,721024,2294144,2523520,4325376,1073741824,0,0,401408,402432,403456,404480,462848,463872,495616,496640,1073741824,1073741824,802816,803840,1073741824,1073741824,901120,902144,1146880,1147904,1148928,1149952,1073741824,1073741824,1073741824,1073741824
.long 2361472,2558080,2753024,2982400,5243008,5242880,0,0,90112,91136,94208,95232,165888,166912,223232,224256,614400,615424,616448,617472,745472,746496,747520,748544,1159168,1160192,1161216,1162240,1155072,1156096,1157120,1158144
.long 2363520,2560128,2753152,2982528,6160512,6160384,0,0,92160,93184,96256,97280,194560,195584,251904,252928,618496,619520,620544,621568,749568,750592,751616,752640,1167360,1168384,1169408,1170432,1163264,1164288,1165312,1166336
.long 2359424,2556032,2753280,2982656,7078016,7077888,0,0,284672,285696,350208,351232,317440,318464,382976,384000,854016,855040,856064,857088,952320,953344,954368,955392,1175552,1176576,1177600,1178624,1171456,1172480,1173504,1174528
.long 786560,852096,2752896,2982272,721024,1073741824,0,0,438272,439296,440320,441344,481280,482304,514048,515072,1073741824,1073741824,858112,859136,1073741824,1073741824,956416,957440,1183744,1184768,1185792,1186816,1073741824,1073741824,1073741824,1073741824
.long 2754688,2951296,3211776,3441152,720896,1638528,0,0,24576,25600,28672,29696,149504,150528,206848,207872,548864,549888,550912,551936,679936,680960,681984,683008,1179648,1180672,1181696,1182720,1191936,1192960,1193984,1195008
.long 2756736,2953344,3211904,3441280,1638400,2556032,0,0,26624,27648,30720,31744,178176,179200,235520,236544,552960,553984,555008,556032,684032,685056,686080,687104,1187840,1188864,1189888,1190912,1200128,1201152,1202176,1203200
.long 2752640,2949248,3212032,3441408,2555904,3473536,0,0,268288,269312,333824,334848,301056,302080,366592,367616,804864,805888,806912,807936,903168,904192,905216,906240,1196032,1197056,1198080,1199104,1208320,1209344,1210368,1211392
.long 917632,983168,3211648,3441024,3473408,1073741824,0,0,405504,406528,407552,408576,464896,465920,497664,498688,1073741824,1073741824,808960,809984,1073741824,1073741824,907264,908288,1204224,1205248,1206272,1207296,1073741824,1073741824,1073741824,1073741824
.long 3147904,3344512,3670528,3899904,4391040,4390912,0,0,98304,99328,102400,103424,167936,168960,225280,226304,622592,623616,624640,625664,753664,754688,755712,756736,1216512,1217536,1384448,1385472,1212416,1213440,1214464,1215488
.long 3149952,3346560,3670656,3900032,5308544,5308416,0,0,100352,101376,104448,105472,196608,197632,253952,254976,626688,627712,628736,629760,757760,758784,759808,760832,1222656,1223680,1386496,1387520,1218560,1219584,1220608,1221632
.long 3145856,3342464,3670784,3900160,6226048,6225920,0,0,286720,287744,352256,353280,319488,320512,385024,386048,860160,861184,862208,863232,958464,959488,960512,961536,1228800,1229824,1388544,1389568,1224704,1225728,1226752,1227776
.long 1048704,1114240,3670400,3899776,7143552,1073741824,0,0,442368,443392,444416,445440,483328,484352,516096,517120,1073741824,1073741824,864256,865280,1073741824,1073741824,962560,963584,1234944,1235968,1390592,1391616,1073741824,1073741824,1073741824,1073741824
.long 3541120,3737728,4129280,4358656,7143424,786560,0,0,32768,33792,36864,37888,151552,152576,208896,209920,557056,558080,559104,560128,688128,689152,690176,691200,1230848,1231872,1232896,1233920,1335296,1336320,1392640,1393664
.long 3543168,3739776,4129408,4358784,786432,1704064,0,0,34816,35840,38912,39936,180224,181248,237568,238592,561152,562176,563200,564224,692224,693248,694272,695296,1236992,1238016,1239040,1240064,1337344,1338368,1394688,1395712
.long 3539072,3735680,4129536,4358912,1703936,2621568,0,0,270336,271360,335872,336896,303104,304128,368640,369664,811008,812032,813056,814080,909312,910336,911360,912384,1241088,1242112,1243136,1244160,1339392,1340416,1396736,1397760
.long 1179776,1245312,4129152,4358528,2621440,1073741824,0,0,409600,410624,411648,412672,466944,467968,499712,500736,1073741824,1073741824,815104,816128,1073741824,1073741824,913408,914432,1245184,1246208,1247232,1248256,1073741824,1073741824,1073741824,1073741824
.long 3934336,4130944,4588032,4817408,3539072,3538944,0,0,106496,107520,110592,111616,169984,171008,227328,228352,630784,631808,632832,633856,761856,762880,763904,764928,1341440,1342464,1398784,1399808,1249280,1250304,1251328,1252352
.long 3936384,4132992,4588160,4817536,4456576,4456448,0,0,108544,109568,112640,113664,198656,199680,256000,257024,634880,635904,636928,637952,765952,766976,768000,769024,1343488,1344512,1400832,1401856,1253376,1254400,1255424,1256448
.long 3932288,4128896,4588288,4817664,5374080,5373952,0,0,288768,289792,354304,355328,321536,322560,387072,388096,866304,867328,868352,869376,964608,965632,966656,967680,1345536,1346560,1402880,1403904,1257472,1258496,1259520,1260544
.long 1310848,1376384,4587904,4817280,6291584,1073741824,0,0,446464,447488,448512,449536,485376,486400,518144,519168,1073741824,1073741824,870400,871424,1073741824,1073741824,968704,969728,1347584,1348608,1404928,1405952,1073741824,1073741824,1073741824,1073741824
.long 4327552,4524160,5046784,5276160,6291456,7209088,0,0,40960,41984,45056,46080,153600,154624,210944,211968,565248,566272,567296,568320,696320,697344,698368,699392,1261568,1262592,1263616,1264640,1349632,1350656,1406976,1408000
.long 4329600,4526208,5046912,5276288,7208960,852096,0,0,43008,44032,47104,48128,182272,183296,239616,240640,569344,570368,571392,572416,700416,701440,702464,703488,1265664,1266688,1267712,1268736,1351680,1352704,1409024,1410048
.long 4325504,4522112,5047040,5276416,851968,1769600,0,0,272384,273408,337920,338944,305152,306176,370688,371712,817152,818176,819200,820224,915456,916480,917504,918528,1269760,1270784,1271808,1272832,1353728,1354752,1411072,1412096
.long 1441920,1507456,5046656,5276032,1769472,1073741824,0,0,413696,414720,415744,416768,468992,470016,501760,502784,1073741824,1073741824,821248,822272,1073741824,1073741824,919552,920576,1273856,1274880,1275904,1276928,1073741824,1073741824,1073741824,1073741824
.long 4720768,4917376,5505536,5734912,2687104,2686976,0,0,114688,115712,118784,119808,172032,173056,229376,230400,638976,640000,641024,642048,770048,771072,772096,773120,1355776,1356800,1413120,1414144,1277952,1278976,1280000,1281024
.long 4722816,4919424,5505664,5735040,3604608,3604480,0,0,116736,117760,120832,121856,200704,201728,258048,259072,643072,644096,645120,646144,774144,775168,776192,777216,1357824,1358848,1415168,1416192,1282048,1283072,1284096,1285120
.long 4718720,4915328,5505792,5735168,4522112,4521984,0,0,290816,291840,356352,357376,323584,324608,389120,390144,872448,873472,874496,875520,970752,971776,972800,973824,1359872,1360896,1417216,1418240,1286144,1287168,1288192,1289216
.long 1572992,1638528,5505408,5734784,5439616,1073741824,0,0,450560,451584,452608,453632,487424,488448,520192,521216,1073741824,1073741824,876544,877568,1073741824,1073741824,974848,975872,1361920,1362944,1419264,1420288,1073741824,1073741824,1073741824,1073741824
.long 5113984,5310592,5964288,6193664,5439488,6357120,0,0,49152,50176,53248,54272,155648,156672,212992,214016,573440,574464,575488,576512,704512,705536,706560,707584,1290240,1291264,1292288,1293312,1363968,1364992,1421312,1422336
.long 5116032,5312640,5964416,6193792,6356992,7274624,0,0,51200,52224,55296,56320,184320,185344,241664,242688,577536,578560,579584,580608,708608,709632,710656,711680,1294336,1295360,1296384,1297408,1366016,1367040,1423360,1424384
.long 5111936,5308544,5964544,6193920,7274496,458880,0,0,274432,275456,339968,340992,307200,308224,372736,373760,823296,824320,825344,826368,921600,922624,923648,924672,1298432,1299456,1300480,1301504,1368064,1369088,1425408,1426432
.long 1704064,1769600,5964160,6193536,458752,1073741824,0,0,417792,418816,419840,420864,471040,472064,503808,504832,1073741824,1073741824,827392,828416,1073741824,1073741824,925696,926720,1302528,1303552,1318912,1319936,1073741824,1073741824,1073741824,1073741824
.long 5507200,5703808,6423040,6652416,1376384,1376256,0,0,122880,123904,126976,128000,174080,175104,231424,232448,647168,648192,649216,650240,778240,779264,780288,781312,1370112,1371136,1427456,1428480,1304576,1305600,1320960,1321984
.long 5509248,5705856,6423168,6652544,2293888,2293760,0,0,124928,125952,129024,130048,202752,203776,260096,261120,651264,652288,653312,654336,782336,783360,784384,785408,1372160,1373184,1429504,1430528,1306624,1307648,1323008,1324032
.long 5505152,5701760,6423296,6652672,3211392,3211264,0,0,292864,293888,358400,359424,325632,326656,391168,392192,878592,879616,880640,881664,976896,977920,978944,979968,1374208,1375232,1431552,1432576,1308672,1309696,1325056,1326080
.long 1835136,1900672,6422912,6652288,4128896,1073741824,0,0,454656,455680,456704,457728,489472,490496,522240,523264,1073741824,1073741824,882688,883712,1073741824,1073741824,980992,982016,1376256,1377280,1433600,1434624,1073741824,1073741824,1073741824,1073741824
.long 5900416,6097024,6881792,7111168,4128768,5046400,0,0,57344,58368,61440,62464,157696,158720,215040,216064,581632,582656,583680,584704,712704,713728,714752,715776,1310720,1311744,1327104,1328128,1378304,1379328,1435648,1436672
.long 5902464,6099072,6881920,7111296,5046272,5963904,0,0,59392,60416,63488,64512,186368,187392,243712,244736,585728,586752,587776,588800,716800,717824,718848,719872,1312768,1313792,1329152,1330176,1380352,1381376,1437696,1438720
.long 5898368,6094976,6882048,7111424,5963776,6881408,0,0,276480,277504,342016,343040,309248,310272,374784,375808,829440,830464,831488,832512,927744,928768,929792,930816,1314816,1315840,1331200,1332224,1382400,1383424,1439744,1440768
.long 1966208,2031744,6881664,7111040,6881280,1073741824,0,0,421888,422912,423936,424960,473088,474112,505856,506880,1073741824,1073741824,833536,834560,1073741824,1073741824,931840,932864,1316864,1317888,1333248,1334272,1073741824,1073741824,1073741824,1073741824

.section .rodata,"a"
.p2align 6
.amdhsa_kernel interleave_layers__linear_attn_block__dense_activation_gelu__prompt_kernel
  .amdhsa_next_free_vgpr 512
  .amdhsa_next_free_sgpr 102
  .amdhsa_accum_offset 256
  .amdhsa_group_segment_fixed_size 0
  .amdhsa_kernarg_size 88
  .amdhsa_user_sgpr_count 2
  .amdhsa_user_sgpr_kernarg_segment_ptr 1
  .amdhsa_system_sgpr_workgroup_id_x 1
  .amdhsa_float_denorm_mode_32 3
.end_amdhsa_kernel
```
